```python
import torch

def _softmax(x, axis=-1):
    return torch.softmax(x, dim=axis)
def _gelu(x):
    return torch.nn.functional.gelu(x, approximate="tanh")
def _silu(x):
    return torch.nn.functional.silu(x)
def _sigmoid(x):
    return torch.sigmoid(x)
def _layernorm(x, axis=-1, eps=1e-5):
    m = x.mean(dim=axis, keepdim=True)
    v = x.var(dim=axis, keepdim=True, unbiased=False)
    return (x - m) / torch.sqrt(v + eps)
def _scatter_add(tgt, idx, src, axis=0):
    return tgt.clone().index_add_(axis, idx, src)
def _segment_sum(src, seg, n):
    out = torch.zeros((n,) + src.shape[1:], dtype=src.dtype)
    return out.index_add_(0, seg, src)
def _pad(x, pw):
    flat = tuple(v for pair in reversed(pw) for v in pair)
    return torch.nn.functional.pad(x, flat)

kernel_name = 'recurrent_scan__mha_block_cached__glu_gated_glu__prompt'

def setup_inputs():

    _w = (lambda a: (lambda t: t.to(torch.bfloat16) if t.is_floating_point() else t)(torch.as_tensor(a)))
    def _A_setup():
        B, Sq, D = 1, 2048, 576
        H, Sk, Dh = 32, 2048, 128
        return {
            "x": _w((lambda *s: torch.randn(*s, dtype=torch.bfloat16) * 0.05)(B, Sq, D)),
            "k_cache": _w((lambda *s: torch.randn(*s, dtype=torch.bfloat16) * 0.8)(B, H, Sk, Dh)),
            "v_cache": _w((lambda *s: torch.randn(*s, dtype=torch.bfloat16) * 0.2)(B, H, Sk, Dh)),
            "wq": _w((lambda *s: torch.randn(*s, dtype=torch.bfloat16) * 0.8)(D, H * Dh) * (D ** -0.5)),
            "wo": _w((lambda *s: torch.randn(*s, dtype=torch.bfloat16) * 0.2)(H * Dh, D) * ((H * Dh) ** -0.5)),
        }
    _A_in = _A_setup()

    def _B_setup():
        B, S, D, F = 1, 2048, 576, 4608
        return {
            "x": _w((lambda *s: torch.randn(*s, dtype=torch.bfloat16) * 0.05)(B, S, D)),
            "w_gate": _w((lambda *s: torch.randn(*s, dtype=torch.bfloat16) * 0.2)(D, F)),
            "w_up": _w((lambda *s: torch.randn(*s, dtype=torch.bfloat16) * 0.1)(D, F)),
            "w_down": _w((lambda *s: torch.randn(*s, dtype=torch.bfloat16) * 0.1)(F, D)),
        }
    _B_in = _B_setup()

    return {
        "A_x": _A_in["x"],
        "A_k_cache": _A_in["k_cache"],
        "A_v_cache": _A_in["v_cache"],
        "A_wq": _A_in["wq"],
        "A_wo": _A_in["wo"],
        "B_x": _B_in["x"],
        "B_w_gate": _B_in["w_gate"],
        "B_w_up": _B_in["w_up"],
        "B_w_down": _B_in["w_down"],
    }

def reference(A_x, A_k_cache, A_v_cache, A_wq, A_wo, B_x, B_w_gate, B_w_up, B_w_down):
    def _A_ref(x, k_cache, v_cache, wq, wo):
        B, Sq, D = x.shape
        H, Dh = 32, 128
        q = (lambda x, *d: x.permute(*d))((x @ wq).reshape(B, Sq, H, Dh), 0, 2, 1, 3)
        scores = torch.einsum("bhqd,bhkd->bhqk", q, k_cache) * (Dh ** -0.5)
        p = _softmax(scores, axis=-1)
        o = torch.einsum("bhqk,bhkd->bhqd", p, v_cache)
        return (lambda x, *d: x.permute(*d))(o, 0, 2, 1, 3).reshape(B, Sq, H * Dh) @ wo

    def _B_ref(x, w_gate, w_up, w_down):
        g = torch.einsum("bsd,df->bsf", x, w_gate)
        u = torch.einsum("bsd,df->bsf", x, w_up)
        h = _sigmoid(g) * u
        return torch.einsum("bsf,fd->bsd", h, w_down)

    x = A_x
    xn = _layernorm(x, axis=-1)
    s = _A_ref(xn, A_k_cache, A_v_cache, A_wq, A_wo)
    g = _silu(_B_ref(xn, B_w_gate, B_w_up, B_w_down))
    return x + s * g
```

```asm
; @launch grid=(256,1,1) block=(256,1,1) lds=163840
.amdgcn_target "amdgcn-amd-amdhsa--gfx950"
.text
.globl recurrent_scan__mha_block_cached__glu_gated_glu__prompt_kernel
.p2align 8
.type recurrent_scan__mha_block_cached__glu_gated_glu__prompt_kernel,@function
recurrent_scan__mha_block_cached__glu_gated_glu__prompt_kernel:
  s_cmp_ge_u32 s2, 256
  s_cbranch_scc1 att_end
  s_load_dwordx2 s[36:37], s[0:1], 0
  s_load_dwordx4 s[40:43], s[0:1], 8
  s_load_dwordx4 s[44:47], s[0:1], 24
  s_load_dwordx4 s[48:51], s[0:1], 48
  s_load_dwordx2 s[52:53], s[0:1], 64
  s_load_dwordx2 s[54:55], s[0:1], 88
  s_load_dwordx2 s[92:93], s[0:1], 72
  s_load_dwordx2 s[84:85], s[0:1], 80
  s_getpc_b64 s[82:83]
  s_bfe_u32 s3, s2, 0x30003
  v_lshlrev_b32 v254, 2, v0
  v_lshl_add_u32 v254, s3, 10, v254
  v_mov_b32 v61, s83
  v_add_co_u32 v60, vcc, s82, v254
  v_lshrrev_b32 v255, 6, v0
  v_and_b32 v249, 63, v0
  v_addc_co_u32 v61, vcc, 0, v61, vcc
  global_load_dword v62, v[60:61], off
  s_and_b32 s56, s2, 7
  s_lshl_b32 s56, s56, 2
  s_bfe_u32 s73, s2, 0x20003
  s_add_u32 s56, s56, s73
  v_readfirstlane_b32 s57, v255
  v_lshlrev_b32 v50, 4, v249
  s_lshr_b32 s73, s2, 5
  s_lshl_b32 s58, s73, 2
  s_add_u32 s58, s58, s57
  v_lshrrev_b32 v254, 5, v0
  v_mul_u32_u24 v254, 1152, v254
  v_and_b32 v255, 31, v0
  v_lshl_add_u32 v202, v255, 2, v254
  s_mul_i32 s76, s2, 9216
  v_lshrrev_b32 v253, 4, v249
  v_and_b32 v252, 15, v249
  s_mul_i32 s75, s57, 24
  v_add_u32 v254, s75, v253
  v_lshlrev_b32 v255, 2, v253
  v_xor_b32 v255, v255, v252
  v_lshlrev_b32 v255, 4, v255
  v_lshl_add_u32 v3, v254, 13, v255
  v_add_u32 v4, 31744, v3
  v_add_u32 v5, 63488, v3
  v_lshrrev_b32 v254, 3, v249
  v_mul_u32_u24 v254, 1152, v254
  v_and_b32 v255, 7, v249
  v_xor_b32 v255, v255, v253
  v_lshl_add_u32 v52, v255, 4, v254
  v_xor_b32 v255, 4, v255
  v_lshl_add_u32 v53, v255, 4, v254
  v_add_u32 v53, 8192, v53
  v_add_u32 v54, 16384, v52
  v_add_u32 v55, 16384, v53
  s_mul_i32 s73, s73, 0
  s_and_b32 s74, s56, 3
  s_mul_i32 s74, s74, 0
  s_add_u32 s73, s73, s74
  s_mul_i32 s74, s73, 86
  s_lshr_b32 s74, s74, 8
  s_mul_i32 s74, s74, 3
  s_sub_u32 s73, s73, s74
  s_mul_i32 s65, s73, 24576
  s_mul_i32 s63, s57, 6144
  s_add_u32 s62, s63, 32768
  s_lshl_b32 s80, s56, 8
  s_lshl_b32 s72, s57, 14
  s_add_u32 s72, s72, 90112
  s_cmp_eq_u32 s57, 0
  s_cselect_b32 s72, 16384, s72
  s_lshl_b32 s69, s58, 1
  s_and_b32 s73, s56, 1
  s_add_u32 s69, s69, s73
  s_xor_b32 s70, s69, 1
  s_mul_i32 s69, s69, 36864
  s_mul_i32 s70, s70, 36864
  s_waitcnt lgkmcnt(0)
  s_and_b32 s37, s37, 0xffff
  s_mov_b32 s38, 0x240000
  s_mov_b32 s39, 0x20000
  s_mov_b32 s8, s44
  s_and_b32 s9, s45, 0xffff
  s_mov_b32 s10, 0x480000
  s_mov_b32 s11, 0x20000
  buffer_load_dword v192, v202, s[36:39], s76 offen offset:0
  buffer_load_dword v193, v202, s[36:39], s76 offen offset:128
  buffer_load_dword v194, v202, s[36:39], s76 offen offset:256
  buffer_load_dword v195, v202, s[36:39], s76 offen offset:384
  buffer_load_dword v196, v202, s[36:39], s76 offen offset:512
  buffer_load_dword v197, v202, s[36:39], s76 offen offset:640
  buffer_load_dword v198, v202, s[36:39], s76 offen offset:768
  buffer_load_dword v199, v202, s[36:39], s76 offen offset:896
  buffer_load_dword v200, v202, s[36:39], s76 offen offset:1024
  v_add_co_u32 v60, vcc, 8192, v60
  s_nop 1
  v_addc_co_u32 v61, vcc, 0, v61, vcc
  global_load_dword v62, v[60:61], off
  v_add_co_u32 v60, vcc, 8192, v60
  s_nop 1
  v_addc_co_u32 v61, vcc, 0, v61, vcc
  global_load_dword v62, v[60:61], off
  v_add_co_u32 v60, vcc, 8192, v60
  s_nop 1
  v_addc_co_u32 v61, vcc, 0, v61, vcc
  global_load_dword v62, v[60:61], off
  v_add_co_u32 v60, vcc, 8192, v60
  s_nop 1
  v_addc_co_u32 v61, vcc, 0, v61, vcc
  global_load_dword v62, v[60:61], off
  s_lshl_b32 s61, s65, 6
  s_add_u32 s61, s61, s80
  s_add_u32 m0, s62, 0
  s_nop 0
  buffer_load_dwordx4 v3, s[8:11], s61 offen offset:0 lds
  buffer_load_dwordx4 v4, s[8:11], s61 offen offset:1024 lds
  buffer_load_dwordx4 v5, s[8:11], s61 offen offset:2048 lds
  s_add_u32 s61, s61, 98304
  s_add_u32 m0, s62, 3072
  s_nop 0
  buffer_load_dwordx4 v3, s[8:11], s61 offen offset:0 lds
  buffer_load_dwordx4 v4, s[8:11], s61 offen offset:1024 lds
  buffer_load_dwordx4 v5, s[8:11], s61 offen offset:2048 lds
  s_lshr_b32 s60, s65, 6
  s_add_u32 s60, s60, s69
  s_add_u32 m0, s72, 0
  s_nop 0
  buffer_load_dwordx4 v52, s[36:39], s60 offen offset:0 lds
  buffer_load_dwordx4 v53, s[36:39], s60 offen offset:1024 lds
  buffer_load_dwordx4 v54, s[36:39], s60 offen offset:2048 lds
  buffer_load_dwordx4 v55, s[36:39], s60 offen offset:3072 lds
  s_mov_b32 s4, s54
  s_and_b32 s5, s55, 0xffff
  s_mov_b32 s6, 0x10000000
  s_mov_b32 s7, 0x20000
  v_and_b32 v250, 3, v249
  v_lshrrev_b32 v251, 2, v249
  v_and_b32 v255, 3, v251
  v_lshl_add_u32 v254, v253, 3, v255
  v_lshlrev_b32 v254, 8, v254
  v_lshl_add_u32 v254, v250, 4, v254
  v_lshl_add_u32 v254, v255, 6, v254
  v_add_u32 v6, 32768, v254
  v_lshrrev_b32 v255, 1, v252
  v_xor_b32 v255, v255, v253
  v_lshlrev_b32 v255, 4, v255
  v_lshl_add_u32 v255, v252, 7, v255
  v_add_u32 v56, s72, v255
  v_xor_b32 v57, 64, v56
  v_cmp_eq_u32 vcc, 0, v252
  v_mov_b32 v254, 0x3f803f80
  s_lshl_b32 s73, s57, 6
  v_xor_b32 v248, s73, v6
  v_cndmask_b32 v254, 0, v254, vcc
  v_accvgpr_write_b32 a32, v254
  v_accvgpr_write_b32 a33, v254
  v_accvgpr_write_b32 a34, v254
  v_accvgpr_write_b32 a35, v254
  s_add_u32 s66, s65, 12288
  s_cmp_eq_u32 s66, 73728
  s_cselect_b32 s66, 0, s66
  s_lshr_b32 s60, s65, 6
  s_add_u32 s60, s60, s70
  s_add_u32 m0, s72, 4096
  s_nop 0
  buffer_load_dwordx4 v52, s[36:39], s60 offen offset:0 lds
  buffer_load_dwordx4 v53, s[36:39], s60 offen offset:1024 lds
  buffer_load_dwordx4 v54, s[36:39], s60 offen offset:2048 lds
  buffer_load_dwordx4 v55, s[36:39], s60 offen offset:3072 lds
  s_waitcnt vmcnt(26)
  v_lshlrev_b32 v202, 16, v192
  v_and_b32 v203, 0xffff0000, v192
  s_waitcnt vmcnt(25)
  v_lshlrev_b32 v204, 16, v193
  v_and_b32 v205, 0xffff0000, v193
  s_waitcnt vmcnt(24)
  v_lshlrev_b32 v206, 16, v194
  v_and_b32 v207, 0xffff0000, v194
  s_waitcnt vmcnt(23)
  v_lshlrev_b32 v208, 16, v195
  v_and_b32 v209, 0xffff0000, v195
  s_waitcnt vmcnt(22)
  v_lshlrev_b32 v210, 16, v196
  v_and_b32 v211, 0xffff0000, v196
  s_waitcnt vmcnt(21)
  v_lshlrev_b32 v212, 16, v197
  v_and_b32 v213, 0xffff0000, v197
  s_waitcnt vmcnt(20)
  v_lshlrev_b32 v214, 16, v198
  v_and_b32 v215, 0xffff0000, v198
  s_waitcnt vmcnt(19)
  v_lshlrev_b32 v216, 16, v199
  v_and_b32 v217, 0xffff0000, v199
  s_waitcnt vmcnt(18)
  v_lshlrev_b32 v218, 16, v200
  v_and_b32 v219, 0xffff0000, v200
  v_pk_add_f32 v[222:223], v[202:203], v[204:205]
  v_pk_add_f32 v[222:223], v[222:223], v[206:207]
  v_pk_add_f32 v[222:223], v[222:223], v[208:209]
  v_pk_add_f32 v[222:223], v[222:223], v[210:211]
  v_pk_add_f32 v[222:223], v[222:223], v[212:213]
  v_pk_add_f32 v[222:223], v[222:223], v[214:215]
  v_pk_add_f32 v[222:223], v[222:223], v[216:217]
  v_pk_add_f32 v[222:223], v[222:223], v[218:219]
  v_add_f32 v220, v222, v223
  s_nop 1
  v_mov_b32_dpp v200, v220 row_ror:8 row_mask:0xf bank_mask:0xf
  v_add_f32 v220, v220, v200
  s_nop 1
  v_mov_b32_dpp v200, v220 row_ror:4 row_mask:0xf bank_mask:0xf
  v_add_f32 v220, v220, v200
  s_nop 1
  v_mov_b32_dpp v200, v220 row_ror:2 row_mask:0xf bank_mask:0xf
  v_add_f32 v220, v220, v200
  s_nop 1
  v_mov_b32_dpp v200, v220 row_ror:1 row_mask:0xf bank_mask:0xf
  v_add_f32 v220, v220, v200
  v_mov_b32 v200, v220
  s_nop 1
  v_permlane16_swap_b32 v220, v200
  v_add_f32 v220, v220, v200
  v_mul_f32 v220, -0.001736111111111111, v220
  v_mov_b32 v221, v220
  v_pk_add_f32 v[192:193], v[202:203], v[220:221]
  v_pk_mul_f32 v[222:223], v[192:193], v[192:193]
  v_pk_add_f32 v[194:195], v[204:205], v[220:221]
  v_pk_fma_f32 v[222:223], v[194:195], v[194:195], v[222:223]
  v_pk_add_f32 v[196:197], v[206:207], v[220:221]
  v_pk_fma_f32 v[222:223], v[196:197], v[196:197], v[222:223]
  v_pk_add_f32 v[198:199], v[208:209], v[220:221]
  v_pk_fma_f32 v[222:223], v[198:199], v[198:199], v[222:223]
  v_pk_add_f32 v[192:193], v[210:211], v[220:221]
  v_pk_fma_f32 v[222:223], v[192:193], v[192:193], v[222:223]
  v_pk_add_f32 v[194:195], v[212:213], v[220:221]
  v_pk_fma_f32 v[222:223], v[194:195], v[194:195], v[222:223]
  v_pk_add_f32 v[196:197], v[214:215], v[220:221]
  v_pk_fma_f32 v[222:223], v[196:197], v[196:197], v[222:223]
  v_pk_add_f32 v[198:199], v[216:217], v[220:221]
  v_pk_fma_f32 v[222:223], v[198:199], v[198:199], v[222:223]
  v_pk_add_f32 v[192:193], v[218:219], v[220:221]
  v_pk_fma_f32 v[222:223], v[192:193], v[192:193], v[222:223]
  v_add_f32 v221, v222, v223
  s_nop 1
  v_mov_b32_dpp v200, v221 row_ror:8 row_mask:0xf bank_mask:0xf
  v_add_f32 v221, v221, v200
  s_nop 1
  v_mov_b32_dpp v200, v221 row_ror:4 row_mask:0xf bank_mask:0xf
  v_add_f32 v221, v221, v200
  s_nop 1
  v_mov_b32_dpp v200, v221 row_ror:2 row_mask:0xf bank_mask:0xf
  v_add_f32 v221, v221, v200
  s_nop 1
  v_mov_b32_dpp v200, v221 row_ror:1 row_mask:0xf bank_mask:0xf
  v_add_f32 v221, v221, v200
  v_mov_b32 v200, v221
  s_nop 1
  v_permlane16_swap_b32 v221, v200
  v_add_f32 v221, v221, v200
  v_mul_f32 v221, 0.001736111111111111, v221
  v_cvt_pk_bf16_f32 v220, v220, v221
  v_and_b32 v221, 0xffff0000, v220
  v_lshlrev_b32 v220, 16, v220
  v_add_f32 v221, 0x3727c5ac, v221
  v_cvt_pk_bf16_f32 v221, v221, v221
  v_lshlrev_b32 v221, 16, v221
  v_sqrt_f32 v221, v221
  v_lshrrev_b32 v200, 5, v0
  v_cvt_pk_bf16_f32 v221, v221, v221
  v_lshlrev_b32 v221, 16, v221
  v_rcp_f32 v221, v221
  v_lshlrev_b32 v200, 2, v200
  v_and_or_b32 v200, v0, 3, v200
  v_lshlrev_b32 v200, 4, v200
  s_lshl_b32 s90, s2, 9
  s_add_u32 s90, s90, 0x4500000
  s_lshl_b32 s82, s2, 8
  s_add_u32 s82, s82, 0x4400000
  s_lshl_b32 s83, s57, 28
  s_add_u32 s82, s82, s83
  v_mov_b32 v192, 0
  v_mov_b32 v193, 0
  v_mov_b32 v194, 0
  v_mov_b32 v195, 0
  s_mov_b32 exec_lo, 15
  s_mov_b32 exec_hi, 15
  buffer_store_dwordx4 v[220:223], v200, s[4:7], s90 offen sc1
  s_mov_b64 exec, 0xffff
  buffer_store_dwordx4 v[192:195], v50, s[4:7], s82 offen sc1
  s_mov_b64 exec, -1
  s_nop 2
  s_lshr_b32 s60, s65, 6
  s_add_u32 s60, s60, s69
  s_add_u32 s60, s60, 128
  s_add_u32 m0, s72, 8192
  s_nop 0
  buffer_load_dwordx4 v52, s[36:39], s60 offen offset:0 lds
  buffer_load_dwordx4 v53, s[36:39], s60 offen offset:1024 lds
  buffer_load_dwordx4 v54, s[36:39], s60 offen offset:2048 lds
  buffer_load_dwordx4 v55, s[36:39], s60 offen offset:3072 lds
  s_lshr_b32 s60, s65, 6
  s_add_u32 s60, s60, s70
  s_add_u32 s60, s60, 128
  s_add_u32 m0, s72, 12288
  s_nop 0
  buffer_load_dwordx4 v52, s[36:39], s60 offen offset:0 lds
  buffer_load_dwordx4 v53, s[36:39], s60 offen offset:1024 lds
  buffer_load_dwordx4 v54, s[36:39], s60 offen offset:2048 lds
  buffer_load_dwordx4 v55, s[36:39], s60 offen offset:3072 lds
  s_mov_b64 exec, 0
  s_cmp_eq_u32 s57, 0
  s_cbranch_scc1 pad_m_0
  s_cmp_eq_u32 s57, 1
  s_cbranch_scc1 pad_m_1
  s_cmp_eq_u32 s57, 2
  s_cbranch_scc1 pad_m_2
  s_branch pad_m_3
warm_0:
  s_mov_b64 exec, -1
  s_nop 3
  s_mov_b64 exec, 0
  s_cmp_eq_u32 s57, 0
  s_cbranch_scc1 pad_m_4
  s_cmp_eq_u32 s57, 1
  s_cbranch_scc1 pad_m_5
  s_cmp_eq_u32 s57, 2
  s_cbranch_scc1 pad_m_6
  s_branch pad_m_7
warm_1:
  s_mov_b64 exec, -1
  s_nop 3
  s_waitcnt vmcnt(14) lgkmcnt(0)
  ds_read_b128 a[160:163], v56 offset:0
  ds_read_b128 a[164:167], v56 offset:2048
  ds_read_b128 a[176:179], v57 offset:0
  ds_read_b128 a[180:183], v57 offset:2048
  s_waitcnt vmcnt(10)
  ds_read_b128 a[168:171], v56 offset:4096
  ds_read_b128 a[172:175], v56 offset:6144
  ds_read_b128 a[184:187], v57 offset:4096
  ds_read_b128 a[188:191], v57 offset:6144
  s_waitcnt lgkmcnt(0)
  s_lshr_b32 s60, s65, 6
  s_add_u32 s60, s60, s69
  s_add_u32 s60, s60, 256
  s_add_u32 m0, s72, 0
  s_nop 0
  buffer_load_dwordx4 v52, s[36:39], s60 offen offset:0 lds
  buffer_load_dwordx4 v53, s[36:39], s60 offen offset:1024 lds
  buffer_load_dwordx4 v54, s[36:39], s60 offen offset:2048 lds
  buffer_load_dwordx4 v55, s[36:39], s60 offen offset:3072 lds
  s_lshr_b32 s60, s65, 6
  s_add_u32 s60, s60, s70
  s_add_u32 s60, s60, 256
  s_add_u32 m0, s72, 4096
  s_nop 0
  buffer_load_dwordx4 v52, s[36:39], s60 offen offset:0 lds
  buffer_load_dwordx4 v53, s[36:39], s60 offen offset:1024 lds
  buffer_load_dwordx4 v54, s[36:39], s60 offen offset:2048 lds
  buffer_load_dwordx4 v55, s[36:39], s60 offen offset:3072 lds
  s_waitcnt vmcnt(12)
  ds_read_b128 a[192:195], v56 offset:8192
  ds_read_b128 a[196:199], v56 offset:10240
  ds_read_b128 a[208:211], v57 offset:8192
  ds_read_b128 a[212:215], v57 offset:10240
  s_waitcnt vmcnt(8)
  ds_read_b128 a[200:203], v56 offset:12288
  ds_read_b128 a[204:207], v56 offset:14336
  ds_read_b128 a[216:219], v57 offset:12288
  ds_read_b128 a[220:223], v57 offset:14336
  s_waitcnt lgkmcnt(0)
  s_barrier
  ds_read_b64_tr_b16 v[224:225], v6 offset:0
  ds_read_b64_tr_b16 v[226:227], v6 offset:1024
  ds_read_b64_tr_b16 v[228:229], v6 offset:8192
  ds_read_b64_tr_b16 v[230:231], v6 offset:9216
  ds_read_b64_tr_b16 v[232:233], v6 offset:16384
  ds_read_b64_tr_b16 v[234:235], v6 offset:17408
  s_branch att_go
spin_l:
  s_mov_b32 s90, 100000
spin_l_loop:
  buffer_load_dword v59, off, s[84:87], s45 sc1
  s_waitcnt vmcnt(0)
  v_readfirstlane_b32 s73, v59
  s_nop 0
  s_cmp_ge_u32 s73, 32
  s_cbranch_scc1 back_l
  s_sleep 6
  s_sub_u32 s90, s90, 1
  s_cmp_lg_u32 s90, 0
  s_cbranch_scc1 spin_l_loop
  s_branch back_l
att_flag:
  ds_write_b32 v55, v56
  s_waitcnt lgkmcnt(0)
  s_branch att_flagged
spin_x:
  s_mov_b32 s90, 100000
spin_x_loop:
  buffer_load_dword v59, off, s[4:7], s58 sc1
  s_waitcnt vmcnt(0)
  v_readfirstlane_b32 s73, v59
  s_nop 0
  s_cmp_ge_u32 s73, 32
  s_cbranch_scc1 back_x
  s_sleep 6
  s_sub_u32 s90, s90, 1
  s_cmp_lg_u32 s90, 0
  s_cbranch_scc1 spin_x_loop
  s_branch back_x
spin_g:
  s_mov_b32 s90, 100000
spin_g_loop:
  buffer_load_dword v59, off, s[84:87], 4 sc1
  s_waitcnt vmcnt(0)
  v_readfirstlane_b32 s73, v59
  s_nop 0
  s_cmp_ge_u32 s73, 256
  s_cbranch_scc1 back_g
  s_sleep 6
  s_sub_u32 s90, s90, 1
  s_cmp_lg_u32 s90, 0
  s_cbranch_scc1 spin_g_loop
  s_branch back_g
spin_a:
  s_mov_b32 s90, 100000
spin_a_loop:
  buffer_load_dword v59, off, s[4:7], s46 sc1
  s_waitcnt vmcnt(0)
  v_readfirstlane_b32 s73, v59
  s_nop 0
  s_and_b32 s73, s73, s9
  s_cmp_ge_u32 s73, s9
  s_cbranch_scc1 back_a
  s_sleep 6
  s_sub_u32 s90, s90, 1
  s_cmp_lg_u32 s90, 0
  s_cbranch_scc1 spin_a_loop
  s_branch back_a
spin_r:
  s_mov_b32 s90, 100000
spin_r_loop:
  buffer_load_dword v59, off, s[84:87], s50 sc1
  s_waitcnt vmcnt(0)
  v_readfirstlane_b32 s73, v59
  s_nop 0
  s_cmp_ge_u32 s73, 1
  s_cbranch_scc1 back_r
  s_sleep 6
  s_sub_u32 s90, s90, 1
  s_cmp_lg_u32 s90, 0
  s_cbranch_scc1 spin_r_loop
  s_branch back_r
spin_k2:
  s_mov_b32 s90, 100000
spin_k2_loop:
  buffer_load_dword v59, off, s[4:7], s46 sc1
  s_waitcnt vmcnt(0)
  v_readfirstlane_b32 s73, v59
  s_nop 0
  s_and_b32 s73, s73, 68
  s_cmp_ge_u32 s73, 68
  s_cbranch_scc1 back_k2
  s_sleep 6
  s_sub_u32 s90, s90, 1
  s_cmp_lg_u32 s90, 0
  s_cbranch_scc1 spin_k2_loop
  s_branch back_k2
spin_k4:
  s_mov_b32 s90, 100000
spin_k4_loop:
  buffer_load_dword v59, off, s[4:7], s46 sc1
  s_waitcnt vmcnt(0)
  v_readfirstlane_b32 s73, v59
  s_nop 0
  s_and_b32 s73, s73, s10
  s_cmp_ge_u32 s73, s10
  s_cbranch_scc1 back_k4
  s_sleep 6
  s_sub_u32 s90, s90, 1
  s_cmp_lg_u32 s90, 0
  s_cbranch_scc1 spin_k4_loop
  s_branch back_k4
spin_k6:
  s_mov_b32 s90, 100000
spin_k6_loop:
  buffer_load_dword v59, off, s[4:7], s46 sc1
  s_waitcnt vmcnt(0)
  v_readfirstlane_b32 s73, v59
  s_nop 0
  s_and_b32 s73, s73, s54
  s_cmp_ge_u32 s73, s54
  s_cbranch_scc1 back_k6
  s_sleep 6
  s_sub_u32 s90, s90, 1
  s_cmp_lg_u32 s90, 0
  s_cbranch_scc1 spin_k6_loop
  s_branch back_k6
spin_k8:
  s_mov_b32 s90, 100000
spin_k8_loop:
  buffer_load_dword v59, off, s[4:7], s70 sc1
  s_waitcnt vmcnt(0)
  v_readfirstlane_b32 s73, v59
  s_nop 0
  s_cmp_ge_u32 s73, 524288
  s_cbranch_scc1 back_k8
  s_sleep 6
  s_sub_u32 s90, s90, 1
  s_cmp_lg_u32 s90, 0
  s_cbranch_scc1 spin_k8_loop
  s_branch back_k8
spin_k9:
  s_mov_b32 s90, 100000
spin_k9_loop:
  buffer_load_dword v59, off, s[4:7], s71 sc1
  s_waitcnt vmcnt(0)
  v_readfirstlane_b32 s73, v59
  s_nop 0
  s_cmp_ge_u32 s73, 524288
  s_cbranch_scc1 back_k9
  s_sleep 6
  s_sub_u32 s90, s90, 1
  s_cmp_lg_u32 s90, 0
  s_cbranch_scc1 spin_k9_loop
  s_branch back_k9
spin_d:
  s_mov_b32 s90, 100000
spin_d_loop:
  buffer_load_dword v59, v56, s[84:87], 0 offen sc1
  s_waitcnt vmcnt(0)
  v_cmp_gt_u32 vcc, 4, v59
  s_mov_b32 s24, 0x80000
  s_mov_b32 s25, 0x800020
  s_andn2_b64 vcc, vcc, s[24:25]
  s_cbranch_scc0 back_d
  s_sleep 6
  s_sub_u32 s90, s90, 1
  s_cmp_lg_u32 s90, 0
  s_cbranch_scc1 spin_d_loop
  s_branch back_d
.p2align 12
att_go:
pad_m_0:
  s_cbranch_execz warm_0
  s_waitcnt lgkmcnt(4)
  v_mfma_f32_16x16x32_bf16 v[64:67], v[224:227], a[160:163], 0
  s_waitcnt lgkmcnt(2)
  s_lshl_b32 s61, s66, 6
  ds_read_b64_tr_b16 a[0:1], v248 offset:0
  ds_read_b64_tr_b16 a[2:3], v248 offset:1024
  v_mfma_f32_16x16x32_bf16 v[64:67], v[228:231], a[176:179], v[64:67]
  s_waitcnt lgkmcnt(2)
  s_add_u32 s61, s61, s80
  ds_read_b64_tr_b16 a[4:5], v248 offset:8192
  ds_read_b64_tr_b16 a[6:7], v248 offset:9216
  v_mfma_f32_16x16x32_bf16 v[64:67], v[232:235], a[192:195], v[64:67]
  s_add_u32 m0, s62, 24576
  ds_read_b64_tr_b16 a[8:9], v248 offset:16384
  ds_read_b64_tr_b16 a[10:11], v248 offset:17408
  v_mfma_f32_16x16x32_bf16 v[72:75], v[232:235], a[196:199], 0
  s_and_b32 s85, s85, 0xffff
  ds_read_b64_tr_b16 a[12:13], v248 offset:8
  ds_read_b64_tr_b16 a[14:15], v248 offset:1032
  v_mfma_f32_16x16x32_bf16 v[72:75], v[228:231], a[180:183], v[72:75]
  s_mov_b32 s86, 256
  ds_read_b64_tr_b16 a[16:17], v248 offset:8200
  ds_read_b64_tr_b16 a[18:19], v248 offset:9224
  v_mfma_f32_16x16x32_bf16 v[72:75], v[224:227], a[164:167], v[72:75]
  s_mov_b32 s87, 0x20000
  ds_read_b64_tr_b16 a[20:21], v248 offset:16392
  ds_read_b64_tr_b16 a[22:23], v248 offset:17416
  v_mfma_f32_16x16x32_bf16 v[80:83], v[224:227], a[168:171], 0
  ds_read_b64_tr_b16 v[236:237], v6 offset:8
  ds_read_b64_tr_b16 v[238:239], v6 offset:1032
  buffer_load_dwordx4 v3, s[8:11], s61 offen offset:0 lds
  v_mfma_f32_16x16x32_bf16 v[80:83], v[228:231], a[184:187], v[80:83]
  s_lshr_b32 s45, s2, 5
  ds_read_b64_tr_b16 v[240:241], v6 offset:8200
  ds_read_b64_tr_b16 v[242:243], v6 offset:9224
  v_mfma_f32_16x16x32_bf16 v[80:83], v[232:235], a[200:203], v[80:83]
  s_mul_i32 s45, s45, 36
  ds_read_b64_tr_b16 v[244:245], v6 offset:16392
  v_xor_b32 v7, 64, v6
  v_mfma_f32_16x16x32_bf16 v[88:91], v[232:235], a[204:207], 0
  s_andn2_b32 s45, s45, 4
  ds_read_b64_tr_b16 v[246:247], v6 offset:17416
  v_xor_b32 v8, 128, v6
  v_mfma_f32_16x16x32_bf16 v[88:91], v[228:231], a[188:191], v[88:91]
  buffer_load_dwordx4 v4, s[8:11], s61 offen offset:1024 lds
  v_mfma_f32_16x16x32_bf16 v[88:91], v[224:227], a[172:175], v[88:91]
  s_waitcnt lgkmcnt(6)
  v_xor_b32 v9, 192, v6
  v_bfe_u32 v201, v0, 4, 1
  v_mfma_f32_16x16x32_bf16 a[24:27], a[0:3], a[32:35], 0
  s_add_u32 s88, s66, 12288
  v_lshlrev_b32 v201, 9, v201
  v_bfe_u32 v255, v0, 1, 2
  v_mfma_f32_16x16x32_bf16 a[24:27], a[4:7], a[32:35], a[24:27]
  buffer_load_dwordx4 v5, s[8:11], s61 offen offset:2048 lds
  v_mfma_f32_16x16x32_bf16 a[24:27], a[8:11], a[32:35], a[24:27]
  s_add_u32 s61, s61, 98304
  v_lshl_add_u32 v201, v255, 7, v201
  v_lshrrev_b32 v254, 5, v0
  v_mfma_f32_16x16x32_bf16 a[28:31], a[12:15], a[32:35], 0
  s_add_u32 m0, s62, 27648
  v_lshrrev_b32 v255, 7, v201
  v_add_f32 v202, v202, v220
  v_mfma_f32_16x16x32_bf16 a[28:31], a[16:19], a[32:35], a[28:31]
  buffer_load_dwordx4 v3, s[8:11], s61 offen offset:0 lds
  v_mfma_f32_16x16x32_bf16 a[28:31], a[20:23], a[32:35], a[28:31]
  s_waitcnt lgkmcnt(0)
  ds_read_b64_tr_b16 v[224:225], v7 offset:0
  ds_read_b64_tr_b16 v[226:227], v7 offset:1024
  v_mfma_f32_16x16x32_bf16 v[92:95], v[236:239], a[172:175], 0
  s_cmp_eq_u32 s88, 73728
  s_cselect_b32 s88, 0, s88
  ds_read_b64_tr_b16 v[228:229], v7 offset:8192
  v_mfma_f32_16x16x32_bf16 v[92:95], v[240:243], a[188:191], v[92:95]
  s_add_u32 s89, s88, 12288
  ds_read_b64_tr_b16 v[230:231], v7 offset:9216
  v_xor_b32 v254, v254, v255
  v_mfma_f32_16x16x32_bf16 v[92:95], v[244:247], a[204:207], v[92:95]
  s_lshl_b32 s74, s56, 19
  ds_read_b64_tr_b16 v[232:233], v7 offset:16384
  v_lshl_add_u32 v201, v254, 4, v201
  v_mfma_f32_16x16x32_bf16 v[84:87], v[244:247], a[200:203], 0
  s_mov_b32 s22, 0x80000
  ds_read_b64_tr_b16 v[234:235], v7 offset:17408
  v_bfe_u32 v255, v0, 3, 1
  v_mfma_f32_16x16x32_bf16 v[84:87], v[240:243], a[184:187], v[84:87]
  buffer_load_dwordx4 v4, s[8:11], s61 offen offset:1024 lds
  v_mfma_f32_16x16x32_bf16 v[84:87], v[236:239], a[168:171], v[84:87]
  s_lshr_b32 s60, s88, 6
  v_lshl_add_u32 v201, v255, 3, v201
  v_add_f32 v203, v203, v220
  v_mfma_f32_16x16x32_bf16 v[76:79], v[236:239], a[164:167], 0
  s_add_u32 s60, s60, s69
  v_and_b32 v254, 1, v0
  v_add_u32 v249, 49152, v248
  v_mfma_f32_16x16x32_bf16 v[76:79], v[240:243], a[180:183], v[76:79]
  buffer_load_dwordx4 v5, s[8:11], s61 offen offset:2048 lds
  v_mfma_f32_16x16x32_bf16 v[76:79], v[244:247], a[196:199], v[76:79]
  s_add_u32 m0, s72, 8192
  v_lshl_add_u32 v201, v254, 2, v201
  v_cvt_pk_bf16_f32 v202, v202, v203
  v_mfma_f32_16x16x32_bf16 v[68:71], v[244:247], a[192:195], 0
  s_mov_b32 s23, 0x20000
  v_add_u32 v10, 49152, v6
  v_add_u32 v11, 49152, v7
  v_mfma_f32_16x16x32_bf16 v[68:71], v[240:243], a[176:179], v[68:71]
  buffer_load_dwordx4 v52, s[36:39], s60 offen offset:0 lds
  v_mfma_f32_16x16x32_bf16 v[68:71], v[236:239], a[160:163], v[68:71]
  s_waitcnt lgkmcnt(0)
  ds_read_b64_tr_b16 v[236:237], v7 offset:8
  ds_read_b64_tr_b16 v[238:239], v7 offset:1032
  v_mfma_f32_16x16x32_bf16 v[96:99], v[224:227], a[160:163], 0
  s_mov_b32 s26, 0x80000
  ds_read_b64_tr_b16 v[240:241], v7 offset:8200
  v_add_u32 v12, 49152, v8
  v_mfma_f32_16x16x32_bf16 v[96:99], v[228:231], a[176:179], v[96:99]
  s_mov_b32 s27, 0x20000
  ds_read_b64_tr_b16 v[242:243], v7 offset:9224
  v_and_b32 v203, 0xffff0000, v202
  v_mfma_f32_16x16x32_bf16 v[96:99], v[232:235], a[192:195], v[96:99]
  s_lshl_b32 s67, s57, 12
  ds_read_b64_tr_b16 v[244:245], v7 offset:16392
  v_add_u32 v13, 49152, v9
  v_mfma_f32_16x16x32_bf16 v[104:107], v[232:235], a[196:199], 0
  s_add_u32 s68, s67, 81920
  ds_read_b64_tr_b16 v[246:247], v7 offset:17416
  v_lshlrev_b32 v202, 16, v202
  v_mfma_f32_16x16x32_bf16 v[104:107], v[228:231], a[180:183], v[104:107]
  buffer_load_dwordx4 v53, s[36:39], s60 offen offset:1024 lds
  v_mfma_f32_16x16x32_bf16 v[104:107], v[224:227], a[164:167], v[104:107]
  s_cmp_eq_u32 s89, 73728
  s_cselect_b32 s89, 0, s89
  v_mul_f32 v202, v202, v221
  v_mfma_f32_16x16x32_bf16 v[112:115], v[224:227], a[168:171], 0
  s_add_u32 s71, s89, 12288
  v_mul_f32 v203, v203, v221
  v_add_f32 v204, v204, v220
  v_mfma_f32_16x16x32_bf16 v[112:115], v[228:231], a[184:187], v[112:115]
  buffer_load_dwordx4 v54, s[36:39], s60 offen offset:2048 lds
  v_mfma_f32_16x16x32_bf16 v[112:115], v[232:235], a[200:203], v[112:115]
  s_cmp_eq_u32 s71, 73728
  s_cselect_b32 s71, 0, s71
  v_cvt_pk_bf16_f32 v192, v202, v203
  v_mfma_f32_16x16x32_bf16 v[120:123], v[232:235], a[204:207], 0
  s_add_u32 s76, s71, 12288
  v_add_f32 v205, v205, v220
  v_lshlrev_b32 v254, 8, v253
  v_mfma_f32_16x16x32_bf16 v[120:123], v[228:231], a[188:191], v[120:123]
  buffer_load_dwordx4 v55, s[36:39], s60 offen offset:3072 lds
  v_mfma_f32_16x16x32_bf16 v[120:123], v[224:227], a[172:175], v[120:123]
  s_waitcnt lgkmcnt(0)
  ds_read_b64_tr_b16 v[224:225], v8 offset:0
  ds_read_b64_tr_b16 v[226:227], v8 offset:1024
  v_mfma_f32_16x16x32_bf16 v[124:127], v[236:239], a[172:175], 0
  s_lshr_b32 s60, s88, 6
  ds_read_b64_tr_b16 v[228:229], v8 offset:8192
  v_cvt_pk_bf16_f32 v204, v204, v205
  v_mfma_f32_16x16x32_bf16 v[124:127], v[240:243], a[188:191], v[124:127]
  s_add_u32 s60, s60, s70
  ds_read_b64_tr_b16 v[230:231], v8 offset:9216
  v_and_b32 v205, 0xffff0000, v204
  v_mfma_f32_16x16x32_bf16 v[124:127], v[244:247], a[204:207], v[124:127]
  s_add_u32 m0, s72, 12288
  ds_read_b64_tr_b16 v[232:233], v8 offset:16384
  v_lshlrev_b32 v204, 16, v204
  v_mfma_f32_16x16x32_bf16 v[116:119], v[244:247], a[200:203], 0
  s_waitcnt vmcnt(14)
  ds_read_b64_tr_b16 v[234:235], v8 offset:17408
  ds_read_b128 a[224:227], v56 offset:0
  v_mfma_f32_16x16x32_bf16 v[116:119], v[240:243], a[184:187], v[116:119]
  ds_read_b128 a[228:231], v56 offset:2048
  buffer_load_dwordx4 v52, s[36:39], s60 offen offset:0 lds
  v_mfma_f32_16x16x32_bf16 v[116:119], v[236:239], a[168:171], v[116:119]
  s_cmp_eq_u32 s76, 73728
  s_cselect_b32 s76, 0, s76
  ds_read_b128 a[240:243], v57 offset:0
  v_mfma_f32_16x16x32_bf16 v[108:111], v[236:239], a[164:167], 0
  s_add_u32 s40, s40, s74
  s_addc_u32 s41, s41, 0
  ds_read_b128 a[244:247], v57 offset:2048
  v_mfma_f32_16x16x32_bf16 v[108:111], v[240:243], a[180:183], v[108:111]
  buffer_load_dwordx4 v53, s[36:39], s60 offen offset:1024 lds
  v_mfma_f32_16x16x32_bf16 v[108:111], v[244:247], a[196:199], v[108:111]
  s_add_u32 s42, s42, s74
  s_addc_u32 s43, s43, 0
  v_mul_f32 v204, v204, v221
  v_mfma_f32_16x16x32_bf16 v[100:103], v[244:247], a[192:195], 0
  s_mov_b32 s20, s40
  v_mul_f32 v205, v205, v221
  v_add_u32 v254, s67, v254
  v_mfma_f32_16x16x32_bf16 v[100:103], v[240:243], a[176:179], v[100:103]
  buffer_load_dwordx4 v54, s[36:39], s60 offen offset:2048 lds
  v_mfma_f32_16x16x32_bf16 v[100:103], v[236:239], a[160:163], v[100:103]
  s_waitcnt lgkmcnt(4)
  ds_read_b64_tr_b16 v[236:237], v8 offset:8
  ds_read_b64_tr_b16 v[238:239], v8 offset:1032
  v_mfma_f32_16x16x32_bf16 v[128:131], v[224:227], a[160:163], 0
  s_waitcnt lgkmcnt(2)
  ds_read_b64_tr_b16 v[240:241], v8 offset:8200
  v_cvt_pk_bf16_f32 v193, v204, v205
  v_mfma_f32_16x16x32_bf16 v[128:131], v[228:231], a[176:179], v[128:131]
  s_and_b32 s21, s41, 0xffff
  ds_read_b64_tr_b16 v[242:243], v8 offset:9224
  v_add_f32 v206, v206, v220
  v_mfma_f32_16x16x32_bf16 v[128:131], v[232:235], a[192:195], v[128:131]
  s_mov_b32 s24, s42
  ds_read_b64_tr_b16 v[244:245], v8 offset:16392
  v_add_u32 v28, 0, v253
  v_mfma_f32_16x16x32_bf16 v[136:139], v[232:235], a[196:199], 0
  s_and_b32 s25, s43, 0xffff
  ds_read_b64_tr_b16 v[246:247], v8 offset:17416
  v_xor_b32 v28, v28, v252
  v_mfma_f32_16x16x32_bf16 v[136:139], v[228:231], a[180:183], v[136:139]
  buffer_load_dwordx4 v55, s[36:39], s60 offen offset:3072 lds
  v_mfma_f32_16x16x32_bf16 v[136:139], v[224:227], a[164:167], v[136:139]
  s_lshl_b32 s61, s88, 6
  v_add_f32 v207, v207, v220
  v_lshlrev_b32 v34, 4, v28
  v_mfma_f32_16x16x32_bf16 v[144:147], v[224:227], a[168:171], 0
  s_add_u32 s61, s61, s80
  v_cvt_pk_bf16_f32 v206, v206, v207
  v_lshl_add_u32 v28, v28, 4, v254
  v_mfma_f32_16x16x32_bf16 v[144:147], v[228:231], a[184:187], v[144:147]
  s_add_u32 m0, s62, 49152
  v_lshl_add_u32 v34, v252, 8, v34
  v_add_u32 v29, 4, v253
  v_mfma_f32_16x16x32_bf16 v[144:147], v[232:235], a[200:203], v[144:147]
  buffer_load_dwordx4 v3, s[8:11], s61 offen offset:0 lds
  v_mfma_f32_16x16x32_bf16 v[152:155], v[232:235], a[204:207], 0
  s_and_b32 s73, s56, 1
  v_and_b32 v207, 0xffff0000, v206
  v_xor_b32 v29, v29, v252
  v_mfma_f32_16x16x32_bf16 v[152:155], v[228:231], a[188:191], v[152:155]
  s_lshl_b32 s73, s73, 11
  v_lshlrev_b32 v206, 16, v206
  v_lshlrev_b32 v35, 4, v29
  v_mfma_f32_16x16x32_bf16 v[152:155], v[224:227], a[172:175], v[152:155]
  s_waitcnt vmcnt(15) lgkmcnt(0)
  ds_read_b64_tr_b16 v[224:225], v9 offset:0
  ds_read_b64_tr_b16 v[226:227], v9 offset:1024
  v_mfma_f32_16x16x32_bf16 v[156:159], v[236:239], a[172:175], 0
  s_xor_b32 s74, s73, 2048
  ds_read_b64_tr_b16 v[228:229], v9 offset:8192
  ds_read_b128 a[232:235], v56 offset:4096
  v_mfma_f32_16x16x32_bf16 v[156:159], v[240:243], a[188:191], v[156:159]
  s_mul_i32 s59, s58, 73728
  ds_read_b64_tr_b16 v[230:231], v9 offset:9216
  ds_read_b128 a[236:239], v56 offset:6144
  v_mfma_f32_16x16x32_bf16 v[156:159], v[244:247], a[204:207], v[156:159]
  s_add_u32 s59, s59, 0
  ds_read_b64_tr_b16 v[232:233], v9 offset:16384
  ds_read_b128 a[248:251], v57 offset:4096
  v_mfma_f32_16x16x32_bf16 v[148:151], v[244:247], a[200:203], 0
  s_mov_b32 s12, s48
  ds_read_b64_tr_b16 v[234:235], v9 offset:17408
  ds_read_b128 a[252:255], v57 offset:6144
  v_mfma_f32_16x16x32_bf16 v[148:151], v[240:243], a[184:187], v[148:151]
  buffer_load_dwordx4 v4, s[8:11], s61 offen offset:1024 lds
  v_mfma_f32_16x16x32_bf16 v[148:151], v[236:239], a[168:171], v[148:151]
  s_and_b32 s13, s49, 0xffff
  v_lshl_add_u32 v29, v29, 4, v254
  v_lshl_add_u32 v35, v252, 8, v35
  v_mfma_f32_16x16x32_bf16 v[140:143], v[236:239], a[164:167], 0
  s_mov_b32 s14, 0x510000
  v_mul_f32 v206, v206, v221
  v_add_u32 v30, 8, v253
  v_mfma_f32_16x16x32_bf16 v[140:143], v[240:243], a[180:183], v[140:143]
  buffer_load_dwordx4 v5, s[8:11], s61 offen offset:2048 lds
  v_mfma_f32_16x16x32_bf16 v[140:143], v[244:247], a[196:199], v[140:143]
  s_waitcnt lgkmcnt(0)
  v_mul_f32 v207, v207, v221
  v_xor_b32 v30, v30, v252
  v_mfma_f32_16x16x32_bf16 v[132:135], v[244:247], a[192:195], 0
  s_add_u32 s61, s61, 98304
  v_lshlrev_b32 v36, 4, v30
  v_add_u32 v31, 12, v253
  v_mfma_f32_16x16x32_bf16 v[132:135], v[240:243], a[176:179], v[132:135]
  s_add_u32 m0, s62, 52224
  v_lshl_add_u32 v30, v30, 4, v254
  v_lshl_add_u32 v36, v252, 8, v36
  v_mfma_f32_16x16x32_bf16 v[132:135], v[236:239], a[160:163], v[132:135]
  ds_read_b64_tr_b16 v[236:237], v9 offset:8
  ds_read_b64_tr_b16 v[238:239], v9 offset:1032
  v_mfma_f32_16x16x32_bf16 v[160:163], v[224:227], a[160:163], 0
  s_mov_b32 s15, 0x20000
  ds_read_b64_tr_b16 v[240:241], v9 offset:8200
  v_cvt_pk_bf16_f32 v194, v206, v207
  v_mfma_f32_16x16x32_bf16 v[160:163], v[228:231], a[176:179], v[160:163]
  ds_read_b64_tr_b16 v[242:243], v9 offset:9224
  buffer_load_dwordx4 v3, s[8:11], s61 offen offset:0 lds
  v_mfma_f32_16x16x32_bf16 v[160:163], v[232:235], a[192:195], v[160:163]
  s_mov_b32 s16, s50
  ds_read_b64_tr_b16 v[244:245], v9 offset:16392
  v_xor_b32 v31, v31, v252
  v_mfma_f32_16x16x32_bf16 v[168:171], v[232:235], a[196:199], 0
  s_and_b32 s17, s51, 0xffff
  ds_read_b64_tr_b16 v[246:247], v9 offset:17416
  v_lshlrev_b32 v37, 4, v31
  v_mfma_f32_16x16x32_bf16 v[168:171], v[228:231], a[180:183], v[168:171]
  buffer_load_dwordx4 v4, s[8:11], s61 offen offset:1024 lds
  v_mfma_f32_16x16x32_bf16 v[168:171], v[224:227], a[164:167], v[168:171]
  s_lshr_b32 s60, s88, 6
  v_add_f32 v208, v208, v220
  v_lshl_add_u32 v31, v31, 4, v254
  v_mfma_f32_16x16x32_bf16 v[176:179], v[224:227], a[168:171], 0
  s_add_u32 s60, s60, s69
  v_lshl_add_u32 v37, v252, 8, v37
  v_add_u32 v32, 0, v253
  v_mfma_f32_16x16x32_bf16 v[176:179], v[228:231], a[184:187], v[176:179]
  buffer_load_dwordx4 v5, s[8:11], s61 offen offset:2048 lds
  v_mfma_f32_16x16x32_bf16 v[176:179], v[232:235], a[200:203], v[176:179]
  s_add_u32 s60, s60, 128
  v_add_f32 v209, v209, v220
  v_lshlrev_b32 v32, 1, v32
  v_mfma_f32_16x16x32_bf16 v[184:187], v[232:235], a[204:207], 0
  s_add_u32 m0, s72, 0
  v_cvt_pk_bf16_f32 v208, v208, v209
  v_xor_b32 v32, v32, v252
  v_mfma_f32_16x16x32_bf16 v[184:187], v[228:231], a[188:191], v[184:187]
  buffer_load_dwordx4 v52, s[36:39], s60 offen offset:0 lds
  v_mfma_f32_16x16x32_bf16 v[184:187], v[224:227], a[172:175], v[184:187]
  s_waitcnt vmcnt(15) lgkmcnt(0)
  s_barrier
  ds_read_b64_tr_b16 v[224:225], v6 offset:24576
  v_mfma_f32_16x16x32_bf16 v[188:191], v[236:239], a[172:175], 0
  s_cmp_eq_u32 s57, 0
  s_cbranch_scc0 sigd_l
  v_mov_b32 v58, 1
  s_mov_b64 exec, 1
  buffer_atomic_add v58, off, s[84:87], s45 sc1
  s_mov_b64 exec, -1
  s_nop 3
sigd_l:
  ds_read_b64_tr_b16 v[226:227], v6 offset:25600
  v_mfma_f32_16x16x32_bf16 v[188:191], v[240:243], a[188:191], v[188:191]
  s_mov_b32 s18, 0x510000
  ds_read_b64_tr_b16 v[228:229], v6 offset:32768
  ds_read_b64_tr_b16 v[230:231], v6 offset:33792
  v_mfma_f32_16x16x32_bf16 v[188:191], v[244:247], a[204:207], v[188:191]
  s_mov_b32 s19, 0x20000
  ds_read_b64_tr_b16 v[232:233], v6 offset:40960
  v_lshl_add_u32 v32, v32, 4, v254
  v_mfma_f32_16x16x32_bf16 v[180:183], v[244:247], a[200:203], 0
  s_mul_i32 s0, s57, 48
  ds_read_b64_tr_b16 v[234:235], v6 offset:41984
  v_add_u32 v33, 4, v253
  v_mfma_f32_16x16x32_bf16 v[180:183], v[240:243], a[184:187], v[180:183]
  ds_read_b64_tr_b16 a[0:1], v248 offset:24576
  buffer_load_dwordx4 v53, s[36:39], s60 offen offset:1024 lds
  v_mfma_f32_16x16x32_bf16 v[180:183], v[236:239], a[168:171], v[180:183]
  s_mul_i32 s64, s57, 3072
  ds_read_b64_tr_b16 a[2:3], v248 offset:25600
  v_lshlrev_b32 v33, 1, v33
  v_mfma_f32_16x16x32_bf16 v[172:175], v[236:239], a[164:167], 0
  s_mov_b32 s31, 0x20000
  ds_read_b64_tr_b16 a[4:5], v248 offset:32768
  v_and_b32 v209, 0xffff0000, v208
  v_mfma_f32_16x16x32_bf16 v[172:175], v[240:243], a[180:183], v[172:175]
  s_mov_b32 s35, 0x20000
  ds_read_b64_tr_b16 a[6:7], v248 offset:33792
  v_xor_b32 v33, v33, v252
  v_mfma_f32_16x16x32_bf16 v[172:175], v[244:247], a[196:199], v[172:175]
  ds_read_b64_tr_b16 a[8:9], v248 offset:40960
  buffer_load_dwordx4 v54, s[36:39], s60 offen offset:2048 lds
  v_mfma_f32_16x16x32_bf16 v[164:167], v[244:247], a[192:195], 0
  s_lshl_b32 s77, s57, 11
  ds_read_b64_tr_b16 a[10:11], v248 offset:41984
  v_lshl_add_u32 v33, v33, 4, v254
  v_mfma_f32_16x16x32_bf16 v[164:167], v[240:243], a[176:179], v[164:167]
  s_add_u32 s77, s77, 147456
  ds_read_b64_tr_b16 a[12:13], v248 offset:24584
  v_lshlrev_b32 v208, 16, v208
  v_mfma_f32_16x16x32_bf16 v[164:167], v[236:239], a[160:163], v[164:167]
  s_waitcnt lgkmcnt(7)
  ds_read_b64_tr_b16 a[14:15], v248 offset:25608
  v_lshlrev_b32 v39, 8, v251
  v_mfma_f32_16x16x32_bf16 v[64:67], v[224:227], a[208:211], v[64:67]
  ds_read_b64_tr_b16 a[16:17], v248 offset:32776
  buffer_load_dwordx4 v55, s[36:39], s60 offen offset:3072 lds
  v_mfma_f32_16x16x32_bf16 v[64:67], v[228:231], a[224:227], v[64:67]
  s_lshr_b32 s60, s88, 6
  ds_read_b64_tr_b16 a[18:19], v248 offset:33800
  v_lshl_add_u32 v39, v250, 3, v39
  v_mfma_f32_16x16x32_bf16 v[64:67], v[232:235], a[240:243], v[64:67]
  s_add_u32 s60, s60, s70
  ds_read_b64_tr_b16 a[20:21], v248 offset:40968
  v_add_u32 v39, 81920, v39
  v_mfma_f32_16x16x32_bf16 v[72:75], v[232:235], a[244:247], v[72:75]
  s_add_u32 s60, s60, 128
  ds_read_b64_tr_b16 a[22:23], v248 offset:41992
  v_mul_f32 v208, v208, v221
  v_mfma_f32_16x16x32_bf16 v[72:75], v[228:231], a[228:231], v[72:75]
  s_add_u32 m0, s72, 4096
  v_mul_f32 v209, v209, v221
  v_and_b32 v38, 7, v251
  v_mfma_f32_16x16x32_bf16 v[72:75], v[224:227], a[212:215], v[72:75]
  ds_read_b64_tr_b16 v[236:237], v6 offset:24584
  ds_read_b64_tr_b16 v[238:239], v6 offset:25608
  buffer_load_dwordx4 v52, s[36:39], s60 offen offset:0 lds
  v_mfma_f32_16x16x32_bf16 v[80:83], v[224:227], a[216:219], v[80:83]
  s_mul_i32 s97, s58, 589824
  ds_read_b64_tr_b16 v[240:241], v6 offset:32776
  v_lshl_add_u32 v38, v38, 5, v39
  v_mfma_f32_16x16x32_bf16 v[80:83], v[228:231], a[232:235], v[80:83]
  s_add_u32 s97, s97, 0x300000
  ds_read_b64_tr_b16 v[242:243], v6 offset:33800
  v_xor_b32 v39, 32, v38
  v_mfma_f32_16x16x32_bf16 v[80:83], v[232:235], a[248:251], v[80:83]
  s_mul_i32 s78, s58, 524288
  ds_read_b64_tr_b16 v[244:245], v6 offset:40968
  v_xor_b32 v40, 64, v38
  v_mfma_f32_16x16x32_bf16 v[88:91], v[232:235], a[252:255], v[88:91]
  ds_read_b64_tr_b16 v[246:247], v6 offset:41992
  buffer_load_dwordx4 v53, s[36:39], s60 offen offset:1024 lds
  v_mfma_f32_16x16x32_bf16 v[88:91], v[228:231], a[236:239], v[88:91]
  s_mov_b32 s79, 0
  v_cvt_pk_bf16_f32 v195, v208, v209
  v_xor_b32 v41, 96, v38
  v_mfma_f32_16x16x32_bf16 v[88:91], v[224:227], a[220:223], v[88:91]
  s_waitcnt lgkmcnt(6)
  v_xor_b32 v42, 128, v38
  v_xor_b32 v43, 160, v38
  v_mfma_f32_16x16x32_bf16 a[24:27], a[0:3], a[32:35], a[24:27]
  buffer_load_dwordx4 v54, s[36:39], s60 offen offset:2048 lds
  v_mfma_f32_16x16x32_bf16 a[24:27], a[4:7], a[32:35], a[24:27]
  s_lshl_b32 s91, s58, 12
  v_add_f32 v210, v210, v220
  v_xor_b32 v44, 192, v38
  v_mfma_f32_16x16x32_bf16 a[24:27], a[8:11], a[32:35], a[24:27]
  s_add_u32 s91, s91, 0x4500000
  v_add_f32 v211, v211, v220
  v_xor_b32 v45, 224, v38
  v_mfma_f32_16x16x32_bf16 a[28:31], a[12:15], a[32:35], a[28:31]
  s_waitcnt vmcnt(17)
  ds_read_b128 a[64:67], v56 offset:8192
  v_cvt_pk_bf16_f32 v210, v210, v211
  v_mfma_f32_16x16x32_bf16 a[28:31], a[16:19], a[32:35], a[28:31]
  s_lshr_b32 s1, s2, 5
  ds_read_b128 a[68:71], v56 offset:10240
  v_add_u32 v1, s73, v50
  v_mfma_f32_16x16x32_bf16 a[28:31], a[20:23], a[32:35], a[28:31]
  s_waitcnt lgkmcnt(2)
  ds_read_b64_tr_b16 v[224:225], v7 offset:24576
  ds_read_b64_tr_b16 v[226:227], v7 offset:25600
  v_mfma_f32_16x16x32_bf16 v[92:95], v[236:239], a[220:223], v[92:95]
  ds_read_b64_tr_b16 v[228:229], v7 offset:32768
  ds_read_b128 a[80:83], v57 offset:8192
  buffer_load_dwordx4 v55, s[36:39], s60 offen offset:3072 lds
  v_mfma_f32_16x16x32_bf16 v[92:95], v[240:243], a[236:239], v[92:95]
  s_lshr_b32 s73, s56, 1
  ds_read_b64_tr_b16 v[230:231], v7 offset:33792
  ds_read_b128 a[84:87], v57 offset:10240
  v_mfma_f32_16x16x32_bf16 v[92:95], v[244:247], a[252:255], v[92:95]
  s_lshl_b32 s81, s73, 6
  ds_read_b64_tr_b16 v[232:233], v7 offset:40960
  v_add_u32 v2, s74, v50
  v_mfma_f32_16x16x32_bf16 v[84:87], v[244:247], a[248:251], v[84:87]
  s_add_u32 s81, s81, 8192
  ds_read_b64_tr_b16 v[234:235], v7 offset:41984
  v_and_b32 v211, 0xffff0000, v210
  v_mfma_f32_16x16x32_bf16 v[84:87], v[240:243], a[232:235], v[84:87]
  s_lshr_b32 s60, s88, 6
  v_lshlrev_b32 v210, 16, v210
  v_mul_f32 v211, v211, v221
  v_mfma_f32_16x16x32_bf16 v[84:87], v[236:239], a[216:219], v[84:87]
  s_add_u32 s60, s60, s69
  v_mul_f32 v210, v210, v221
  v_bfe_u32 v15, v0, 3, 3
  v_mfma_f32_16x16x32_bf16 v[76:79], v[236:239], a[212:215], v[76:79]
  s_waitcnt lgkmcnt(2)
  v_cvt_pk_bf16_f32 v196, v210, v211
  v_add_f32 v212, v212, v220
  v_mfma_f32_16x16x32_bf16 v[76:79], v[240:243], a[228:231], v[76:79]
  s_add_u32 s60, s60, 256
  v_add_u32 v15, s0, v15
  v_lshlrev_b32 v16, 1, v253
  v_mfma_f32_16x16x32_bf16 v[76:79], v[244:247], a[244:247], v[76:79]
  s_add_u32 m0, s72, 8192
  v_add_f32 v213, v213, v220
  v_mul_u32_u24 v15, 9216, v15
  v_mfma_f32_16x16x32_bf16 v[68:71], v[244:247], a[240:243], v[68:71]
  buffer_load_dwordx4 v52, s[36:39], s60 offen offset:0 lds
  v_mfma_f32_16x16x32_bf16 v[68:71], v[240:243], a[224:227], v[68:71]
  s_lshl_b32 s74, s2, 2
  v_cvt_pk_bf16_f32 v212, v212, v213
  v_and_b32 v14, 7, v0
  v_mfma_f32_16x16x32_bf16 v[68:71], v[236:239], a[208:211], v[68:71]
  s_waitcnt lgkmcnt(0)
  ds_read_b64_tr_b16 v[236:237], v7 offset:24584
  ds_read_b64_tr_b16 v[238:239], v7 offset:25608
  v_mfma_f32_16x16x32_bf16 v[96:99], v[224:227], a[208:211], v[96:99]
  s_add_u32 s74, s74, s57
  ds_read_b64_tr_b16 v[240:241], v7 offset:32776
  v_xor_b32 v14, v16, v14
  v_mfma_f32_16x16x32_bf16 v[96:99], v[228:231], a[224:227], v[96:99]
  s_lshr_b32 s73, s56, 3
  ds_read_b64_tr_b16 v[242:243], v7 offset:33800
  v_lshl_add_u32 v14, v14, 4, v15
  v_mfma_f32_16x16x32_bf16 v[96:99], v[232:235], a[240:243], v[96:99]
  s_waitcnt vmcnt(15)
  ds_read_b64_tr_b16 v[244:245], v7 offset:40968
  ds_read_b128 a[72:75], v56 offset:12288
  buffer_load_dwordx4 v53, s[36:39], s60 offen offset:1024 lds
  v_mfma_f32_16x16x32_bf16 v[104:107], v[232:235], a[244:247], v[104:107]
  s_mul_i32 s73, s73, 147456
  ds_read_b64_tr_b16 v[246:247], v7 offset:41992
  ds_read_b128 a[76:79], v56 offset:14336
  v_mfma_f32_16x16x32_bf16 v[104:107], v[228:231], a[228:231], v[104:107]
  s_add_u32 s97, s97, s73
  ds_read_b128 a[88:91], v57 offset:12288
  v_add_u32 v15, 72704, v14
  v_mfma_f32_16x16x32_bf16 v[104:107], v[224:227], a[212:215], v[104:107]
  s_mov_b32 s40, s97
  ds_read_b128 a[92:95], v57 offset:14336
  v_add_u32 v16, 145408, v14
  v_mfma_f32_16x16x32_bf16 v[112:115], v[224:227], a[216:219], v[112:115]
  buffer_load_dwordx4 v54, s[36:39], s60 offen offset:2048 lds
  v_mfma_f32_16x16x32_bf16 v[112:115], v[228:231], a[232:235], v[112:115]
  s_bfe_u32 s73, s56, 0x20001
  v_and_b32 v213, 0xffff0000, v212
  v_lshlrev_b32 v20, 7, v251
  v_mfma_f32_16x16x32_bf16 v[112:115], v[232:235], a[248:251], v[112:115]
  s_add_u32 s73, s73, 32
  v_lshlrev_b32 v212, 16, v212
  v_bfe_u32 v21, v0, 3, 2
  v_mfma_f32_16x16x32_bf16 v[120:123], v[232:235], a[252:255], v[120:123]
  buffer_load_dwordx4 v55, s[36:39], s60 offen offset:3072 lds
  v_mfma_f32_16x16x32_bf16 v[120:123], v[228:231], a[236:239], v[120:123]
  s_lshr_b32 s60, s88, 6
  v_mul_f32 v212, v212, v221
  v_lshl_add_u32 v20, v21, 5, v20
  v_mfma_f32_16x16x32_bf16 v[120:123], v[224:227], a[220:223], v[120:123]
  s_waitcnt lgkmcnt(0)
  ds_read_b64_tr_b16 v[224:225], v8 offset:24576
  ds_read_b64_tr_b16 v[226:227], v8 offset:25600
  v_mfma_f32_16x16x32_bf16 v[124:127], v[236:239], a[220:223], v[124:127]
  s_add_u32 s60, s60, s70
  ds_read_b64_tr_b16 v[228:229], v8 offset:32768
  v_lshl_add_u32 v20, v250, 3, v20
  v_mfma_f32_16x16x32_bf16 v[124:127], v[240:243], a[236:239], v[124:127]
  s_add_u32 s60, s60, 256
  ds_read_b64_tr_b16 v[230:231], v8 offset:33792
  v_xor_b32 v21, 32, v20
  v_mfma_f32_16x16x32_bf16 v[124:127], v[244:247], a[252:255], v[124:127]
  s_add_u32 m0, s72, 12288
  ds_read_b64_tr_b16 v[232:233], v8 offset:40960
  v_xor_b32 v22, 64, v20
  v_mfma_f32_16x16x32_bf16 v[116:119], v[244:247], a[248:251], v[116:119]
  ds_read_b64_tr_b16 v[234:235], v8 offset:41984
  buffer_load_dwordx4 v52, s[36:39], s60 offen offset:0 lds
  v_mfma_f32_16x16x32_bf16 v[116:119], v[240:243], a[232:235], v[116:119]
  s_lshl_b32 s73, s73, 12
  v_mul_f32 v213, v213, v221
  v_xor_b32 v23, 96, v20
  v_mfma_f32_16x16x32_bf16 v[116:119], v[236:239], a[216:219], v[116:119]
  s_add_u32 s98, s97, s73
  v_add_u32 v24, 106496, v20
  v_add_u32 v25, 106496, v21
  v_mfma_f32_16x16x32_bf16 v[108:111], v[236:239], a[212:215], v[108:111]
  buffer_load_dwordx4 v53, s[36:39], s60 offen offset:1024 lds
  v_mfma_f32_16x16x32_bf16 v[108:111], v[240:243], a[228:231], v[108:111]
  s_and_b32 s73, s56, 7
  v_cvt_pk_bf16_f32 v197, v212, v213
  v_add_u32 v26, 106496, v22
  v_mfma_f32_16x16x32_bf16 v[108:111], v[244:247], a[244:247], v[108:111]
  s_lshl_b32 s73, s73, 13
  v_add_u32 v27, 106496, v23
  v_add_u32 v17, s0, v251
  v_mfma_f32_16x16x32_bf16 v[100:103], v[244:247], a[240:243], v[100:103]
  buffer_load_dwordx4 v54, s[36:39], s60 offen offset:2048 lds
  v_mfma_f32_16x16x32_bf16 v[100:103], v[240:243], a[224:227], v[100:103]
  s_sub_u32 s0, s74, 468
  v_add_f32 v214, v214, v220
  v_mul_u32_u24 v17, 9216, v17
  v_mfma_f32_16x16x32_bf16 v[100:103], v[236:239], a[208:211], v[100:103]
  s_waitcnt lgkmcnt(0)
  ds_read_b64_tr_b16 v[236:237], v8 offset:24584
  ds_read_b64_tr_b16 v[238:239], v8 offset:25608
  v_mfma_f32_16x16x32_bf16 v[128:131], v[224:227], a[208:211], v[128:131]
  s_add_u32 s97, s97, s73
  ds_read_b64_tr_b16 v[240:241], v8 offset:32776
  v_and_b32 v49, 1, v253
  v_mfma_f32_16x16x32_bf16 v[128:131], v[228:231], a[224:227], v[128:131]
  s_lshl_b32 s73, s56, 14
  ds_read_b64_tr_b16 v[242:243], v8 offset:33800
  v_add_f32 v215, v215, v220
  v_mfma_f32_16x16x32_bf16 v[128:131], v[232:235], a[240:243], v[128:131]
  s_lshl_b32 s61, s89, 6
  ds_read_b64_tr_b16 v[244:245], v8 offset:40968
  v_lshlrev_b32 v255, 1, v49
  v_mfma_f32_16x16x32_bf16 v[136:139], v[232:235], a[244:247], v[136:139]
  s_add_u32 s61, s61, s80
  ds_read_b64_tr_b16 v[246:247], v8 offset:41992
  v_xor_b32 v255, v255, v250
  v_mfma_f32_16x16x32_bf16 v[136:139], v[228:231], a[228:231], v[136:139]
pad_m_1:
  s_cbranch_execz warm_0
  buffer_load_dwordx4 v55, s[36:39], s60 offen offset:3072 lds
  v_mfma_f32_16x16x32_bf16 v[136:139], v[224:227], a[212:215], v[136:139]
  s_add_u32 m0, s62, 0
  v_cvt_pk_bf16_f32 v214, v214, v215
  v_lshl_add_u32 v17, v255, 4, v17
  v_mfma_f32_16x16x32_bf16 v[144:147], v[224:227], a[216:219], v[144:147]
  s_add_u32 s78, s78, s73
  v_add_u32 v18, 146432, v17
  v_add_u32 v19, 292864, v17
  v_mfma_f32_16x16x32_bf16 v[144:147], v[228:231], a[232:235], v[144:147]
  buffer_load_dwordx4 v3, s[8:11], s61 offen offset:0 lds
  v_mfma_f32_16x16x32_bf16 v[144:147], v[232:235], a[248:251], v[144:147]
  s_add_u32 s78, s78, 0x1600000
  v_and_b32 v215, 0xffff0000, v214
  v_mul_u32_u24 v46, 1152, v251
  v_mfma_f32_16x16x32_bf16 v[152:155], v[232:235], a[252:255], v[152:155]
  s_mul_i32 s73, s58, 18
  v_lshlrev_b32 v214, 16, v214
  v_lshl_add_u32 v46, v255, 4, v46
  v_mfma_f32_16x16x32_bf16 v[152:155], v[228:231], a[236:239], v[152:155]
  buffer_load_dwordx4 v4, s[8:11], s61 offen offset:1024 lds
  v_mfma_f32_16x16x32_bf16 v[152:155], v[224:227], a[220:223], v[152:155]
  s_waitcnt lgkmcnt(0)
  ds_read_b64_tr_b16 v[224:225], v9 offset:24576
  ds_read_b64_tr_b16 v[226:227], v9 offset:25600
  v_mfma_f32_16x16x32_bf16 v[156:159], v[236:239], a[220:223], v[156:159]
  s_lshl_b32 s1, s1, 2
  ds_read_b64_tr_b16 v[228:229], v9 offset:32768
  v_add_u32 v47, 17408, v46
  v_mfma_f32_16x16x32_bf16 v[156:159], v[240:243], a[236:239], v[156:159]
  s_mul_i32 s42, s58, 524288
  ds_read_b64_tr_b16 v[230:231], v9 offset:33792
  v_mul_f32 v214, v214, v221
  v_mfma_f32_16x16x32_bf16 v[156:159], v[244:247], a[252:255], v[156:159]
  s_and_b32 s43, s57, 2
  ds_read_b64_tr_b16 v[232:233], v9 offset:40960
  v_mul_f32 v215, v215, v221
  v_mfma_f32_16x16x32_bf16 v[148:151], v[244:247], a[248:251], v[148:151]
  s_add_u32 s43, s43, 128
  ds_read_b64_tr_b16 v[234:235], v9 offset:41984
  v_cvt_pk_bf16_f32 v198, v214, v215
  v_mfma_f32_16x16x32_bf16 v[148:151], v[240:243], a[232:235], v[148:151]
  buffer_load_dwordx4 v5, s[8:11], s61 offen offset:2048 lds
  v_mfma_f32_16x16x32_bf16 v[148:151], v[236:239], a[216:219], v[148:151]
  s_add_u32 s61, s61, 98304
  v_add_f32 v216, v216, v220
  v_add_f32 v217, v217, v220
  v_mfma_f32_16x16x32_bf16 v[140:143], v[236:239], a[212:215], v[140:143]
  s_add_u32 m0, s62, 3072
  v_cvt_pk_bf16_f32 v216, v216, v217
  v_add_f32 v218, v218, v220
  v_mfma_f32_16x16x32_bf16 v[140:143], v[240:243], a[228:231], v[140:143]
  buffer_load_dwordx4 v3, s[8:11], s61 offen offset:0 lds
  v_mfma_f32_16x16x32_bf16 v[140:143], v[244:247], a[244:247], v[140:143]
  s_cmp_lt_u32 s74, 468
  s_cselect_b32 s28, s46, s52
  s_cselect_b32 s29, s47, s53
  v_mfma_f32_16x16x32_bf16 v[132:135], v[244:247], a[240:243], v[132:135]
  s_waitcnt vmcnt(16)
  ds_read_b128 a[96:99], v56 offset:0
  v_and_b32 v217, 0xffff0000, v216
  v_mfma_f32_16x16x32_bf16 v[132:135], v[240:243], a[224:227], v[132:135]
  s_and_b32 s29, s29, 0xffff
  ds_read_b128 a[100:103], v56 offset:2048
  v_lshlrev_b32 v216, 16, v216
  v_mfma_f32_16x16x32_bf16 v[132:135], v[236:239], a[208:211], v[132:135]
  s_waitcnt lgkmcnt(2)
  ds_read_b64_tr_b16 v[236:237], v9 offset:24584
  ds_read_b64_tr_b16 v[238:239], v9 offset:25608
  v_mfma_f32_16x16x32_bf16 v[160:163], v[224:227], a[208:211], v[160:163]
  s_bfe_u32 s52, s2, 0x20001
  ds_read_b64_tr_b16 v[240:241], v9 offset:32776
  ds_read_b128 a[112:115], v57 offset:0
  v_mfma_f32_16x16x32_bf16 v[160:163], v[228:231], a[224:227], v[160:163]
  s_add_u32 s46, s1, s52
  ds_read_b64_tr_b16 v[242:243], v9 offset:33800
  ds_read_b128 a[116:119], v57 offset:2048
  v_mfma_f32_16x16x32_bf16 v[160:163], v[232:235], a[240:243], v[160:163]
  s_lshl_b32 s46, s46, 8
  ds_read_b64_tr_b16 v[244:245], v9 offset:40968
  v_mul_f32 v216, v216, v221
  v_mfma_f32_16x16x32_bf16 v[168:171], v[232:235], a[244:247], v[168:171]
  ds_read_b64_tr_b16 v[246:247], v9 offset:41992
  buffer_load_dwordx4 v4, s[8:11], s61 offen offset:1024 lds
  v_mfma_f32_16x16x32_bf16 v[168:171], v[228:231], a[228:231], v[168:171]
  s_lshr_b32 s60, s71, 6
  v_mul_f32 v217, v217, v221
  v_add_f32 v219, v219, v220
  v_mfma_f32_16x16x32_bf16 v[168:171], v[224:227], a[212:215], v[168:171]
  s_add_u32 s60, s60, s69
  v_cvt_pk_bf16_f32 v199, v216, v217
  v_cvt_pk_bf16_f32 v218, v218, v219
  v_mfma_f32_16x16x32_bf16 v[176:179], v[224:227], a[216:219], v[176:179]
  s_waitcnt lgkmcnt(2)
  buffer_load_dwordx4 v5, s[8:11], s61 offen offset:2048 lds
  v_mfma_f32_16x16x32_bf16 v[176:179], v[228:231], a[232:235], v[176:179]
  s_add_u32 m0, s72, 0
  v_and_b32 v219, 0xffff0000, v218
  v_lshlrev_b32 v48, 6, v251
  v_mfma_f32_16x16x32_bf16 v[176:179], v[232:235], a[248:251], v[176:179]
  s_cmp_lt_u32 s74, 468
  s_cselect_b32 s30, 0x480000, s14
  s_cselect_b32 s101, 26, 29
  v_mfma_f32_16x16x32_bf16 v[184:187], v[232:235], a[252:255], v[184:187]
  buffer_load_dwordx4 v52, s[36:39], s60 offen offset:0 lds
  v_mfma_f32_16x16x32_bf16 v[184:187], v[228:231], a[236:239], v[184:187]
  s_cmp_lt_u32 s74, 468
  s_cselect_b32 s100, 0, 0x480000
  s_cselect_b32 s74, s74, s0
  v_mfma_f32_16x16x32_bf16 v[184:187], v[224:227], a[220:223], v[184:187]
  s_waitcnt lgkmcnt(0)
  s_barrier
  ds_read_b64_tr_b16 v[224:225], v10 offset:0
  v_mfma_f32_16x16x32_bf16 v[188:191], v[236:239], a[220:223], v[188:191]
  s_waitcnt vmcnt(15)
  ds_read_b64_tr_b16 v[226:227], v10 offset:1024
  ds_read_b64_tr_b16 v[228:229], v10 offset:8192
  v_mfma_f32_16x16x32_bf16 v[188:191], v[240:243], a[236:239], v[188:191]
  s_mul_i32 s101, s101, 36864
  ds_read_b64_tr_b16 v[230:231], v10 offset:9216
  ds_read_b128 a[104:107], v56 offset:4096
  v_mfma_f32_16x16x32_bf16 v[188:191], v[244:247], a[252:255], v[188:191]
  ds_read_b64_tr_b16 v[232:233], v10 offset:16384
  ds_read_b128 a[108:111], v56 offset:6144
  buffer_load_dwordx4 v53, s[36:39], s60 offen offset:1024 lds
  v_mfma_f32_16x16x32_bf16 v[180:183], v[244:247], a[248:251], v[180:183]
  s_add_u32 s100, s100, 0x2680000
  ds_read_b64_tr_b16 v[234:235], v10 offset:17408
  ds_read_b128 a[120:123], v57 offset:4096
  v_mfma_f32_16x16x32_bf16 v[180:183], v[240:243], a[232:235], v[180:183]
  s_mov_b32 s34, s30
  ds_read_b64_tr_b16 a[0:1], v249 offset:0
  ds_read_b128 a[124:127], v57 offset:6144
  v_mfma_f32_16x16x32_bf16 v[180:183], v[236:239], a[216:219], v[180:183]
  s_add_u32 s32, s54, s100
  s_addc_u32 s33, s55, 0
  ds_read_b64_tr_b16 a[2:3], v249 offset:1024
  v_mfma_f32_16x16x32_bf16 v[172:175], v[236:239], a[212:215], v[172:175]
  ds_read_b64_tr_b16 a[4:5], v249 offset:8192
  buffer_load_dwordx4 v54, s[36:39], s60 offen offset:2048 lds
  v_mfma_f32_16x16x32_bf16 v[172:175], v[240:243], a[228:231], v[172:175]
  s_and_b32 s33, s33, 0xffff
  ds_read_b64_tr_b16 a[6:7], v249 offset:9216
  v_lshlrev_b32 v218, 16, v218
  v_mfma_f32_16x16x32_bf16 v[172:175], v[244:247], a[244:247], v[172:175]
  s_cmp_lt_u32 s74, 522
  s_cselect_b32 s74, s74, 4000
  ds_read_b64_tr_b16 a[8:9], v249 offset:16384
  v_mfma_f32_16x16x32_bf16 v[164:167], v[244:247], a[240:243], v[164:167]
  s_waitcnt lgkmcnt(4)
  ds_read_b64_tr_b16 a[10:11], v249 offset:17408
  v_mul_f32 v218, v218, v221
  v_mfma_f32_16x16x32_bf16 v[164:167], v[240:243], a[224:227], v[164:167]
  s_lshl_b32 s100, s74, 11
  ds_read_b64_tr_b16 a[12:13], v249 offset:8
  v_mul_f32 v219, v219, v221
  v_mfma_f32_16x16x32_bf16 v[164:167], v[236:239], a[208:211], v[164:167]
  ds_read_b64_tr_b16 a[14:15], v249 offset:1032
  buffer_load_dwordx4 v55, s[36:39], s60 offen offset:3072 lds
  v_mfma_f32_16x16x32_bf16 v[64:67], v[224:227], a[64:67], v[64:67]
  s_lshr_b32 s60, s71, 6
  ds_read_b64_tr_b16 a[16:17], v249 offset:8200
  v_cvt_pk_bf16_f32 v200, v218, v219
  v_mfma_f32_16x16x32_bf16 v[64:67], v[228:231], a[80:83], v[64:67]
  s_add_u32 s60, s60, s70
  ds_read_b64_tr_b16 a[18:19], v249 offset:9224
  v_lshl_add_u32 v48, v250, 3, v48
  v_mfma_f32_16x16x32_bf16 v[64:67], v[232:235], a[96:99], v[64:67]
  s_add_u32 m0, s72, 4096
  ds_read_b64_tr_b16 a[20:21], v249 offset:16392
  v_lshl_add_u32 v48, v49, 5, v48
  v_mfma_f32_16x16x32_bf16 v[72:75], v[232:235], a[100:103], v[72:75]
  ds_read_b64_tr_b16 a[22:23], v249 offset:17416
  buffer_load_dwordx4 v52, s[36:39], s60 offen offset:0 lds
  v_mfma_f32_16x16x32_bf16 v[72:75], v[228:231], a[84:87], v[72:75]
  s_mul_i32 s0, s74, 3641
  v_add_u32 v48, s77, v48
  v_mov_b32 v254, 155648
  v_mfma_f32_16x16x32_bf16 v[72:75], v[224:227], a[68:71], v[72:75]
  s_lshr_b32 s0, s0, 16
  ds_read_b64_tr_b16 v[236:237], v10 offset:8
  ds_read_b64_tr_b16 v[238:239], v10 offset:1032
  v_mfma_f32_16x16x32_bf16 v[80:83], v[224:227], a[72:75], v[80:83]
  s_mul_i32 s99, s0, 18
  ds_read_b64_tr_b16 v[240:241], v10 offset:8200
  v_xor_b32 v49, 32, v48
  v_mfma_f32_16x16x32_bf16 v[80:83], v[228:231], a[88:91], v[80:83]
  ds_read_b64_tr_b16 v[242:243], v10 offset:9224
  buffer_load_dwordx4 v53, s[36:39], s60 offen offset:1024 lds
  v_mfma_f32_16x16x32_bf16 v[80:83], v[232:235], a[104:107], v[80:83]
  s_sub_u32 s74, s74, s99
  ds_read_b64_tr_b16 v[244:245], v10 offset:16392
  v_mov_b32 v255, 0
  v_mfma_f32_16x16x32_bf16 v[88:91], v[232:235], a[108:111], v[88:91]
  s_lshl_b32 s74, s74, 6
  ds_read_b64_tr_b16 v[246:247], v10 offset:17416
  ds_write_b32 v254, v255
  v_mfma_f32_16x16x32_bf16 v[88:91], v[228:231], a[92:95], v[88:91]
  buffer_load_dwordx4 v54, s[36:39], s60 offen offset:2048 lds
  v_mfma_f32_16x16x32_bf16 v[88:91], v[224:227], a[76:79], v[88:91]
  s_waitcnt lgkmcnt(7)
  v_and_b32 v254, 63, v0
  v_lshlrev_b32 v251, 4, v253
  v_mfma_f32_16x16x32_bf16 a[24:27], a[0:3], a[32:35], a[24:27]
  s_mul_i32 s99, s0, 36864
  v_min_u32 v254, 8, v254
  v_add_u32 v251, 156160, v251
  v_mfma_f32_16x16x32_bf16 a[24:27], a[4:7], a[32:35], a[24:27]
  s_waitcnt vmcnt(17)
  ds_read_b128 a[128:131], v56 offset:8192
  v_mul_u32_u24 v255, 86, v254
  v_mfma_f32_16x16x32_bf16 a[24:27], a[8:11], a[32:35], a[24:27]
  s_lshl_b32 s61, s71, 6
  ds_read_b128 a[132:135], v56 offset:10240
  v_lshrrev_b32 v255, 8, v255
  v_mfma_f32_16x16x32_bf16 a[28:31], a[12:15], a[32:35], a[28:31]
  s_add_u32 s61, s61, s80
  ds_read_b128 a[144:147], v57 offset:8192
  v_mul_u32_u24 v250, 3, v255
  v_mfma_f32_16x16x32_bf16 a[28:31], a[16:19], a[32:35], a[28:31]
  ds_read_b128 a[148:151], v57 offset:10240
  buffer_load_dwordx4 v55, s[36:39], s60 offen offset:3072 lds
  v_mfma_f32_16x16x32_bf16 a[28:31], a[20:23], a[32:35], a[28:31]
  s_waitcnt lgkmcnt(5)
  ds_read_b64_tr_b16 v[224:225], v11 offset:0
  ds_read_b64_tr_b16 v[226:227], v11 offset:1024
  v_mfma_f32_16x16x32_bf16 v[92:95], v[236:239], a[76:79], v[92:95]
  s_add_u32 m0, s62, 24576
  ds_read_b64_tr_b16 v[228:229], v11 offset:8192
  v_sub_u32 v254, v254, v250
  v_mfma_f32_16x16x32_bf16 v[92:95], v[240:243], a[92:95], v[92:95]
  s_add_u32 s99, s99, s74
  ds_read_b64_tr_b16 v[230:231], v11 offset:9216
  v_add_u32 v255, s73, v255
  v_mfma_f32_16x16x32_bf16 v[92:95], v[244:247], a[108:111], v[92:95]
  s_lshr_b32 s73, s2, 3
  ds_read_b64_tr_b16 v[232:233], v11 offset:16384
  v_mul_u32_u24 v255, 9216, v255
  v_mfma_f32_16x16x32_bf16 v[84:87], v[244:247], a[104:107], v[84:87]
  s_mul_i32 s75, s73, 73728
  ds_read_b64_tr_b16 v[234:235], v11 offset:17408
  v_lshlrev_b32 v250, 7, v254
  v_mfma_f32_16x16x32_bf16 v[84:87], v[240:243], a[88:91], v[84:87]
  s_waitcnt lgkmcnt(6)
  buffer_load_dwordx4 v3, s[8:11], s61 offen offset:0 lds
  v_mfma_f32_16x16x32_bf16 v[84:87], v[236:239], a[72:75], v[84:87]
  s_bfe_u32 s73, s2, 0x20001
  v_add_u32 v250, s80, v250
  v_cmp_eq_u32 vcc, 2, v254
  v_mfma_f32_16x16x32_bf16 v[76:79], v[236:239], a[68:71], v[76:79]
  s_lshl_b32 s73, s73, 10
  v_mov_b32 v254, s81
  v_bfe_u32 v253, v0, 3, 2
  v_mfma_f32_16x16x32_bf16 v[76:79], v[240:243], a[84:87], v[76:79]
  buffer_load_dwordx4 v4, s[8:11], s61 offen offset:1024 lds
  v_mfma_f32_16x16x32_bf16 v[76:79], v[244:247], a[100:103], v[76:79]
  s_add_u32 s75, s75, s73
  v_cndmask_b32 v250, v250, v254, vcc
  v_lshlrev_b32 v253, 8, v253
  v_mfma_f32_16x16x32_bf16 v[68:71], v[244:247], a[96:99], v[68:71]
  s_and_b32 s74, s56, 1
  v_add_u32 v63, v255, v250
  v_cmp_eq_u32 vcc, 0, v252
  v_mfma_f32_16x16x32_bf16 v[68:71], v[240:243], a[80:83], v[68:71]
  buffer_load_dwordx4 v5, s[8:11], s61 offen offset:2048 lds
  v_mfma_f32_16x16x32_bf16 v[68:71], v[236:239], a[64:67], v[68:71]
  s_waitcnt lgkmcnt(0)
  ds_read_b64_tr_b16 v[236:237], v11 offset:8
  ds_read_b64_tr_b16 v[238:239], v11 offset:1032
  v_mfma_f32_16x16x32_bf16 v[96:99], v[224:227], a[64:67], v[96:99]
  s_add_u32 s61, s61, 98304
  ds_read_b64_tr_b16 v[240:241], v11 offset:8200
  v_mov_b32 v255, 157184
  v_mfma_f32_16x16x32_bf16 v[96:99], v[228:231], a[80:83], v[96:99]
  s_waitcnt vmcnt(17)
  ds_read_b64_tr_b16 v[242:243], v11 offset:9224
  ds_read_b128 a[136:139], v56 offset:12288
  v_mfma_f32_16x16x32_bf16 v[96:99], v[232:235], a[96:99], v[96:99]
  s_add_u32 m0, s62, 27648
  ds_read_b64_tr_b16 v[244:245], v11 offset:16392
  ds_read_b128 a[140:143], v56 offset:14336
  v_mfma_f32_16x16x32_bf16 v[104:107], v[232:235], a[100:103], v[104:107]
  s_lshl_b32 s74, s74, 11
  ds_read_b64_tr_b16 v[246:247], v11 offset:17416
  ds_read_b128 a[152:155], v57 offset:12288
  v_mfma_f32_16x16x32_bf16 v[104:107], v[228:231], a[84:87], v[104:107]
  s_and_b32 s73, s2, 1
  ds_read_b128 a[156:159], v57 offset:14336
  v_lshlrev_b32 v254, 6, v252
  v_mfma_f32_16x16x32_bf16 v[104:107], v[224:227], a[68:71], v[104:107]
  buffer_load_dwordx4 v3, s[8:11], s61 offen offset:0 lds
  v_mfma_f32_16x16x32_bf16 v[112:115], v[224:227], a[72:75], v[112:115]
  s_lshl_b32 s73, s73, 7
  v_add_u32 v254, s74, v254
  v_mfma_f32_16x16x32_bf16 v[112:115], v[228:231], a[88:91], v[112:115]
  s_add_u32 s75, s75, s73
  v_mfma_f32_16x16x32_bf16 v[112:115], v[232:235], a[104:107], v[112:115]
  buffer_load_dwordx4 v4, s[8:11], s61 offen offset:1024 lds
  v_mfma_f32_16x16x32_bf16 v[120:123], v[232:235], a[108:111], v[120:123]
  s_lshl_b32 s73, s57, 13
  v_mfma_f32_16x16x32_bf16 v[120:123], v[228:231], a[92:95], v[120:123]
  s_waitcnt lgkmcnt(0)
  v_mfma_f32_16x16x32_bf16 v[120:123], v[224:227], a[76:79], v[120:123]
  ds_read_b64_tr_b16 v[224:225], v12 offset:0
  ds_read_b64_tr_b16 v[226:227], v12 offset:1024
  v_mfma_f32_16x16x32_bf16 v[124:127], v[236:239], a[76:79], v[124:127]
  s_lshr_b32 s60, s71, 6
  ds_read_b64_tr_b16 v[228:229], v12 offset:8192
  v_mfma_f32_16x16x32_bf16 v[124:127], v[240:243], a[92:95], v[124:127]
  s_add_u32 s60, s60, s69
  ds_read_b64_tr_b16 v[230:231], v12 offset:9216
  v_mfma_f32_16x16x32_bf16 v[124:127], v[244:247], a[108:111], v[124:127]
  ds_read_b64_tr_b16 v[232:233], v12 offset:16384
  buffer_load_dwordx4 v5, s[8:11], s61 offen offset:2048 lds
  v_mfma_f32_16x16x32_bf16 v[116:119], v[244:247], a[104:107], v[116:119]
  s_add_u32 s60, s60, 128
  s_add_u32 m0, s72, 8192
  ds_read_b64_tr_b16 v[234:235], v12 offset:17408
  v_mfma_f32_16x16x32_bf16 v[116:119], v[240:243], a[88:91], v[116:119]
  buffer_load_dwordx4 v52, s[36:39], s60 offen offset:0 lds
  v_mfma_f32_16x16x32_bf16 v[116:119], v[236:239], a[72:75], v[116:119]
  s_add_u32 s75, s75, s73
  v_mfma_f32_16x16x32_bf16 v[108:111], v[236:239], a[68:71], v[108:111]
  s_add_u32 s75, s75, 0
  v_mfma_f32_16x16x32_bf16 v[108:111], v[240:243], a[84:87], v[108:111]
  buffer_load_dwordx4 v53, s[36:39], s60 offen offset:1024 lds
  v_mfma_f32_16x16x32_bf16 v[108:111], v[244:247], a[100:103], v[108:111]
  s_lshl_b32 s73, s57, 7
  v_mfma_f32_16x16x32_bf16 v[100:103], v[244:247], a[96:99], v[100:103]
  s_bfe_u32 s0, s2, 0x20003
  v_add_u32 v250, s73, v251
  v_mfma_f32_16x16x32_bf16 v[100:103], v[240:243], a[80:83], v[100:103]
  buffer_load_dwordx4 v54, s[36:39], s60 offen offset:2048 lds
  v_mfma_f32_16x16x32_bf16 v[100:103], v[236:239], a[64:67], v[100:103]
  s_waitcnt lgkmcnt(0)
  ds_read_b64_tr_b16 v[236:237], v12 offset:8
  ds_read_b64_tr_b16 v[238:239], v12 offset:1032
  v_mfma_f32_16x16x32_bf16 v[128:131], v[224:227], a[64:67], v[128:131]
  s_lshl_b32 s55, s57, 6
  ds_read_b64_tr_b16 v[240:241], v12 offset:8200
  v_cndmask_b32 v250, v255, v250, vcc
  v_mfma_f32_16x16x32_bf16 v[128:131], v[228:231], a[80:83], v[128:131]
  s_add_u32 s46, s46, 0x4400000
  ds_read_b64_tr_b16 v[242:243], v12 offset:9224
  v_bfe_u32 v255, v0, 5, 1
  v_mfma_f32_16x16x32_bf16 v[128:131], v[232:235], a[96:99], v[128:131]
  s_lshr_b32 s1, s2, 3
  ds_read_b64_tr_b16 v[244:245], v12 offset:16392
  v_lshl_add_u32 v253, v255, 12, v253
  v_mfma_f32_16x16x32_bf16 v[136:139], v[232:235], a[100:103], v[136:139]
  s_lshl_b32 s48, s1, 6
  ds_read_b64_tr_b16 v[246:247], v12 offset:17416
  v_lshrrev_b32 v255, 3, v0
  v_mfma_f32_16x16x32_bf16 v[136:139], v[228:231], a[84:87], v[136:139]
  buffer_load_dwordx4 v55, s[36:39], s60 offen offset:3072 lds
  v_mfma_f32_16x16x32_bf16 v[136:139], v[224:227], a[68:71], v[136:139]
  s_lshr_b32 s60, s71, 6
  v_xor_b32 v255, v255, v0
  v_mfma_f32_16x16x32_bf16 v[144:147], v[224:227], a[72:75], v[144:147]
  s_add_u32 s60, s60, s70
  v_and_b32 v255, 7, v255
  v_mfma_f32_16x16x32_bf16 v[144:147], v[228:231], a[88:91], v[144:147]
  s_add_u32 s60, s60, 128
  v_lshl_add_u32 v253, v255, 4, v253
  v_mfma_f32_16x16x32_bf16 v[144:147], v[232:235], a[104:107], v[144:147]
  s_add_u32 m0, s72, 12288
  v_xor_b32 v255, 2048, v254
  v_mfma_f32_16x16x32_bf16 v[152:155], v[232:235], a[108:111], v[152:155]
  buffer_load_dwordx4 v52, s[36:39], s60 offen offset:0 lds
  v_mfma_f32_16x16x32_bf16 v[152:155], v[228:231], a[92:95], v[152:155]
  s_add_u32 s48, s48, s57
  v_mfma_f32_16x16x32_bf16 v[152:155], v[224:227], a[76:79], v[152:155]
  s_waitcnt lgkmcnt(0)
  ds_read_b64_tr_b16 v[224:225], v13 offset:0
  ds_read_b64_tr_b16 v[226:227], v13 offset:1024
  v_mfma_f32_16x16x32_bf16 v[156:159], v[236:239], a[76:79], v[156:159]
  s_lshl_b32 s48, s48, 5
  ds_read_b64_tr_b16 v[228:229], v13 offset:8192
  v_mfma_f32_16x16x32_bf16 v[156:159], v[240:243], a[92:95], v[156:159]
  ds_read_b64_tr_b16 v[230:231], v13 offset:9216
  buffer_load_dwordx4 v53, s[36:39], s60 offen offset:1024 lds
  v_mfma_f32_16x16x32_bf16 v[156:159], v[244:247], a[108:111], v[156:159]
  s_add_u32 s48, s48, 0x4400080
  ds_read_b64_tr_b16 v[232:233], v13 offset:16384
  v_mfma_f32_16x16x32_bf16 v[148:151], v[244:247], a[104:107], v[148:151]
  s_lshl_b32 s49, s1, 5
  ds_read_b64_tr_b16 v[234:235], v13 offset:17408
  v_mfma_f32_16x16x32_bf16 v[148:151], v[240:243], a[88:91], v[148:151]
  buffer_load_dwordx4 v54, s[36:39], s60 offen offset:2048 lds
  v_mfma_f32_16x16x32_bf16 v[148:151], v[236:239], a[72:75], v[148:151]
  s_add_u32 s49, s49, s57
  v_mfma_f32_16x16x32_bf16 v[140:143], v[236:239], a[68:71], v[140:143]
  s_mul_i32 s49, s49, 18432
  v_mfma_f32_16x16x32_bf16 v[140:143], v[240:243], a[84:87], v[140:143]
  buffer_load_dwordx4 v55, s[36:39], s60 offen offset:3072 lds
  v_mfma_f32_16x16x32_bf16 v[140:143], v[244:247], a[100:103], v[140:143]
  s_waitcnt vmcnt(18)
  ds_read_b128 a[160:163], v56 offset:0
  v_mfma_f32_16x16x32_bf16 v[132:135], v[244:247], a[96:99], v[132:135]
  s_add_u32 s49, s49, 0x3100000
  ds_read_b128 a[164:167], v56 offset:2048
  v_mfma_f32_16x16x32_bf16 v[132:135], v[240:243], a[80:83], v[132:135]
  s_lshl_b32 s3, s52, 17
  ds_read_b128 a[176:179], v57 offset:0
  v_mfma_f32_16x16x32_bf16 v[132:135], v[236:239], a[64:67], v[132:135]
  s_waitcnt lgkmcnt(3)
  ds_read_b64_tr_b16 v[236:237], v13 offset:8
  ds_read_b64_tr_b16 v[238:239], v13 offset:1032
  v_mfma_f32_16x16x32_bf16 v[160:163], v[224:227], a[64:67], v[160:163]
  s_add_u32 s42, s42, s3
  ds_read_b64_tr_b16 v[240:241], v13 offset:8200
  ds_read_b128 a[180:183], v57 offset:2048
  v_mfma_f32_16x16x32_bf16 v[160:163], v[228:231], a[80:83], v[160:163]
  s_add_u32 s42, s42, 0x1600000
  ds_read_b64_tr_b16 v[242:243], v13 offset:9224
  v_mfma_f32_16x16x32_bf16 v[160:163], v[232:235], a[96:99], v[160:163]
  s_lshl_b32 s1, s52, 5
  ds_read_b64_tr_b16 v[244:245], v13 offset:16392
  v_mfma_f32_16x16x32_bf16 v[168:171], v[232:235], a[100:103], v[168:171]
  s_lshr_b32 s60, s71, 6
  ds_read_b64_tr_b16 v[246:247], v13 offset:17416
  v_mfma_f32_16x16x32_bf16 v[168:171], v[228:231], a[84:87], v[168:171]
  s_add_u32 s60, s60, s69
  v_mfma_f32_16x16x32_bf16 v[168:171], v[224:227], a[68:71], v[168:171]
  s_waitcnt lgkmcnt(3)
  v_mfma_f32_16x16x32_bf16 v[176:179], v[224:227], a[72:75], v[176:179]
  s_add_u32 s60, s60, 256
  v_mfma_f32_16x16x32_bf16 v[176:179], v[228:231], a[88:91], v[176:179]
  s_add_u32 m0, s72, 0
  v_mfma_f32_16x16x32_bf16 v[176:179], v[232:235], a[104:107], v[176:179]
  buffer_load_dwordx4 v52, s[36:39], s60 offen offset:0 lds
  v_mfma_f32_16x16x32_bf16 v[184:187], v[232:235], a[108:111], v[184:187]
  s_mov_b32 s69, 0
  v_mfma_f32_16x16x32_bf16 v[184:187], v[228:231], a[92:95], v[184:187]
  s_add_u32 s1, s1, s57
  v_mfma_f32_16x16x32_bf16 v[184:187], v[224:227], a[76:79], v[184:187]
  s_waitcnt lgkmcnt(0)
  s_barrier
  ds_read_b64_tr_b16 v[224:225], v6 offset:0
  v_mfma_f32_16x16x32_bf16 v[188:191], v[236:239], a[76:79], v[188:191]
  s_lshl_b32 s1, s1, 2
  ds_read_b64_tr_b16 v[226:227], v6 offset:1024
  ds_read_b64_tr_b16 v[228:229], v6 offset:8192
  v_mfma_f32_16x16x32_bf16 v[188:191], v[240:243], a[92:95], v[188:191]
  s_waitcnt vmcnt(15)
  ds_read_b64_tr_b16 v[230:231], v6 offset:9216
  ds_read_b128 a[168:171], v56 offset:4096
  buffer_load_dwordx4 v53, s[36:39], s60 offen offset:1024 lds
  v_mfma_f32_16x16x32_bf16 v[188:191], v[244:247], a[108:111], v[188:191]
  s_add_u32 s1, s1, s0
  ds_read_b64_tr_b16 v[232:233], v6 offset:16384
  ds_read_b128 a[172:175], v56 offset:6144
  v_mfma_f32_16x16x32_bf16 v[180:183], v[244:247], a[104:107], v[180:183]
  s_mul_i32 s41, s1, 9216
  ds_read_b64_tr_b16 v[234:235], v6 offset:17408
  ds_read_b128 a[184:187], v57 offset:4096
  v_mfma_f32_16x16x32_bf16 v[180:183], v[240:243], a[88:91], v[180:183]
  s_add_u32 s41, s41, 0x267f000
  ds_read_b64_tr_b16 a[0:1], v248 offset:0
  ds_read_b128 a[188:191], v57 offset:6144
  v_mfma_f32_16x16x32_bf16 v[180:183], v[236:239], a[72:75], v[180:183]
  ds_read_b64_tr_b16 a[2:3], v248 offset:1024
  buffer_load_dwordx4 v54, s[36:39], s60 offen offset:2048 lds
  v_mfma_f32_16x16x32_bf16 v[172:175], v[236:239], a[68:71], v[172:175]
  s_mul_i32 s43, s43, 36864
  ds_read_b64_tr_b16 a[4:5], v248 offset:8192
  v_mfma_f32_16x16x32_bf16 v[172:175], v[240:243], a[84:87], v[172:175]
  s_lshl_b32 s1, s52, 2
  ds_read_b64_tr_b16 a[6:7], v248 offset:9216
  v_mfma_f32_16x16x32_bf16 v[172:175], v[244:247], a[100:103], v[172:175]
  s_add_u32 s1, s1, s57
  ds_read_b64_tr_b16 a[8:9], v248 offset:16384
  v_mfma_f32_16x16x32_bf16 v[164:167], v[244:247], a[96:99], v[164:167]
  ds_read_b64_tr_b16 a[10:11], v248 offset:17408
  buffer_load_dwordx4 v55, s[36:39], s60 offen offset:3072 lds
  v_mfma_f32_16x16x32_bf16 v[164:167], v[240:243], a[80:83], v[164:167]
  s_waitcnt lgkmcnt(5)
  ds_read_b64_tr_b16 a[12:13], v248 offset:8
  v_mfma_f32_16x16x32_bf16 v[164:167], v[236:239], a[64:67], v[164:167]
  s_lshr_b32 s60, s71, 6
  ds_read_b64_tr_b16 a[14:15], v248 offset:1032
  v_mfma_f32_16x16x32_bf16 v[64:67], v[224:227], a[112:115], v[64:67]
  s_add_u32 s60, s60, s70
  ds_read_b64_tr_b16 a[16:17], v248 offset:8200
  v_mfma_f32_16x16x32_bf16 v[64:67], v[228:231], a[128:131], v[64:67]
  s_add_u32 s60, s60, 256
  s_add_u32 m0, s72, 4096
  ds_read_b64_tr_b16 a[18:19], v248 offset:9224
  v_mfma_f32_16x16x32_bf16 v[64:67], v[232:235], a[144:147], v[64:67]
  ds_read_b64_tr_b16 a[20:21], v248 offset:16392
  buffer_load_dwordx4 v52, s[36:39], s60 offen offset:0 lds
  v_mfma_f32_16x16x32_bf16 v[72:75], v[232:235], a[148:151], v[72:75]
  s_add_u32 s1, s1, 256
  ds_read_b64_tr_b16 a[22:23], v248 offset:17416
  v_mfma_f32_16x16x32_bf16 v[72:75], v[228:231], a[132:135], v[72:75]
  s_lshl_b32 s1, s1, 2
  v_mfma_f32_16x16x32_bf16 v[72:75], v[224:227], a[116:119], v[72:75]
  s_add_u32 s1, s1, s0
  ds_read_b64_tr_b16 v[236:237], v6 offset:8
  ds_read_b64_tr_b16 v[238:239], v6 offset:1032
  v_mfma_f32_16x16x32_bf16 v[80:83], v[224:227], a[120:123], v[80:83]
  ds_read_b64_tr_b16 v[240:241], v6 offset:8200
  buffer_load_dwordx4 v53, s[36:39], s60 offen offset:1024 lds
  v_mfma_f32_16x16x32_bf16 v[80:83], v[228:231], a[136:139], v[80:83]
  s_mul_i32 s47, s1, 9216
  ds_read_b64_tr_b16 v[242:243], v6 offset:9224
  v_mfma_f32_16x16x32_bf16 v[80:83], v[232:235], a[152:155], v[80:83]
  s_add_u32 s47, s47, 0x267f000
  ds_read_b64_tr_b16 v[244:245], v6 offset:16392
  v_mfma_f32_16x16x32_bf16 v[88:91], v[232:235], a[156:159], v[88:91]
  s_mul_i32 s44, s57, 9216
  ds_read_b64_tr_b16 v[246:247], v6 offset:17416
  v_mfma_f32_16x16x32_bf16 v[88:91], v[228:231], a[140:143], v[88:91]
  buffer_load_dwordx4 v54, s[36:39], s60 offen offset:2048 lds
  v_mfma_f32_16x16x32_bf16 v[88:91], v[224:227], a[124:127], v[88:91]
  s_waitcnt lgkmcnt(6)
  v_mfma_f32_16x16x32_bf16 a[24:27], a[0:3], a[32:35], a[24:27]
  s_lshl_b32 s53, s58, 2
  v_mfma_f32_16x16x32_bf16 a[24:27], a[4:7], a[32:35], a[24:27]
  buffer_load_dwordx4 v55, s[36:39], s60 offen offset:3072 lds
  v_mfma_f32_16x16x32_bf16 a[24:27], a[8:11], a[32:35], a[24:27]
  s_lshl_b32 s61, s76, 6
  v_mfma_f32_16x16x32_bf16 a[28:31], a[12:15], a[32:35], a[28:31]
  s_add_u32 s61, s61, s80
  v_mfma_f32_16x16x32_bf16 a[28:31], a[16:19], a[32:35], a[28:31]
  s_add_u32 m0, s62, 49152
  v_mfma_f32_16x16x32_bf16 a[28:31], a[20:23], a[32:35], a[28:31]
  s_waitcnt lgkmcnt(0)
  ds_read_b64_tr_b16 v[224:225], v7 offset:0
  ds_read_b64_tr_b16 v[226:227], v7 offset:1024
  v_mfma_f32_16x16x32_bf16 v[92:95], v[236:239], a[124:127], v[92:95]
  s_add_u32 s53, s53, s52
  ds_read_b64_tr_b16 v[228:229], v7 offset:8192
  v_mfma_f32_16x16x32_bf16 v[92:95], v[240:243], a[140:143], v[92:95]
  s_mul_i32 s53, s53, 18432
  ds_read_b64_tr_b16 v[230:231], v7 offset:9216
  v_mfma_f32_16x16x32_bf16 v[92:95], v[244:247], a[156:159], v[92:95]
  s_mul_i32 s1, s0, 288
  ds_read_b64_tr_b16 v[232:233], v7 offset:16384
  v_mfma_f32_16x16x32_bf16 v[84:87], v[244:247], a[152:155], v[84:87]
  ds_read_b64_tr_b16 v[234:235], v7 offset:17408
  buffer_load_dwordx4 v3, s[8:11], s61 offen offset:0 lds
  v_mfma_f32_16x16x32_bf16 v[84:87], v[240:243], a[136:139], v[84:87]
  s_add_u32 s53, s53, s1
  v_mfma_f32_16x16x32_bf16 v[84:87], v[236:239], a[120:123], v[84:87]
  s_mov_b32 s70, 0
  v_mfma_f32_16x16x32_bf16 v[76:79], v[236:239], a[116:119], v[76:79]
  buffer_load_dword v59, off, s[84:87], s45 sc1
  v_mfma_f32_16x16x32_bf16 v[76:79], v[240:243], a[132:135], v[76:79]
  buffer_load_dwordx4 v4, s[8:11], s61 offen offset:1024 lds
  v_mfma_f32_16x16x32_bf16 v[76:79], v[244:247], a[148:151], v[76:79]
  s_mul_i32 s50, s52, 72
  v_mfma_f32_16x16x32_bf16 v[68:71], v[244:247], a[144:147], v[68:71]
  s_add_u32 s50, s50, 36
  v_mfma_f32_16x16x32_bf16 v[68:71], v[240:243], a[128:131], v[68:71]
  buffer_load_dwordx4 v5, s[8:11], s61 offen offset:2048 lds
  v_mfma_f32_16x16x32_bf16 v[68:71], v[236:239], a[112:115], v[68:71]
  s_waitcnt lgkmcnt(0)
  ds_read_b64_tr_b16 v[236:237], v7 offset:8
  ds_read_b64_tr_b16 v[238:239], v7 offset:1032
  v_mfma_f32_16x16x32_bf16 v[96:99], v[224:227], a[112:115], v[96:99]
  s_add_u32 s61, s61, 98304
  ds_read_b64_tr_b16 v[240:241], v7 offset:8200
  v_mfma_f32_16x16x32_bf16 v[96:99], v[228:231], a[128:131], v[96:99]
  s_add_u32 m0, s62, 52224
  ds_read_b64_tr_b16 v[242:243], v7 offset:9224
  v_mfma_f32_16x16x32_bf16 v[96:99], v[232:235], a[144:147], v[96:99]
  s_waitcnt vmcnt(16)
  ds_read_b64_tr_b16 v[244:245], v7 offset:16392
  ds_read_b128 a[192:195], v56 offset:8192
  v_mfma_f32_16x16x32_bf16 v[104:107], v[232:235], a[148:151], v[104:107]
  s_and_b32 s56, s2, 1
  ds_read_b64_tr_b16 v[246:247], v7 offset:17416
  ds_read_b128 a[196:199], v56 offset:10240
  v_mfma_f32_16x16x32_bf16 v[104:107], v[228:231], a[132:135], v[104:107]
  ds_read_b128 a[208:211], v57 offset:8192
  buffer_load_dwordx4 v3, s[8:11], s61 offen offset:0 lds
  v_mfma_f32_16x16x32_bf16 v[104:107], v[224:227], a[116:119], v[104:107]
  s_add_u32 s56, s56, 5
  ds_read_b128 a[212:215], v57 offset:10240
  v_mfma_f32_16x16x32_bf16 v[112:115], v[224:227], a[120:123], v[112:115]
pad_m_2:
  s_cbranch_execz warm_0
  s_lshr_b32 s58, s2, 5
  v_mfma_f32_16x16x32_bf16 v[112:115], v[228:231], a[136:139], v[112:115]
  buffer_load_dwordx4 v4, s[8:11], s61 offen offset:1024 lds
  v_mfma_f32_16x16x32_bf16 v[112:115], v[232:235], a[152:155], v[112:115]
  s_lshl_b32 s58, s58, 13
  v_mfma_f32_16x16x32_bf16 v[120:123], v[232:235], a[156:159], v[120:123]
  s_add_u32 s58, s58, 0x4401f04
  v_mfma_f32_16x16x32_bf16 v[120:123], v[228:231], a[140:143], v[120:123]
  buffer_load_dwordx4 v5, s[8:11], s61 offen offset:2048 lds
  v_mfma_f32_16x16x32_bf16 v[120:123], v[224:227], a[124:127], v[120:123]
  s_waitcnt lgkmcnt(0)
  ds_read_b64_tr_b16 v[224:225], v8 offset:0
  ds_read_b64_tr_b16 v[226:227], v8 offset:1024
  v_mfma_f32_16x16x32_bf16 v[124:127], v[236:239], a[124:127], v[124:127]
  s_add_u32 m0, s67, 0
  ds_read_b64_tr_b16 v[228:229], v8 offset:8192
  v_mfma_f32_16x16x32_bf16 v[124:127], v[240:243], a[140:143], v[124:127]
  ds_read_b64_tr_b16 v[230:231], v8 offset:9216
  v_mfma_f32_16x16x32_bf16 v[124:127], v[244:247], a[156:159], v[124:127]
  ds_read_b64_tr_b16 v[232:233], v8 offset:16384
  v_mfma_f32_16x16x32_bf16 v[116:119], v[244:247], a[152:155], v[116:119]
  ds_read_b64_tr_b16 v[234:235], v8 offset:17408
  v_mfma_f32_16x16x32_bf16 v[116:119], v[240:243], a[136:139], v[116:119]
  buffer_load_dwordx4 v28, s[20:23], s69 offen offset:0 lds
  v_mfma_f32_16x16x32_bf16 v[116:119], v[236:239], a[120:123], v[116:119]
  v_mfma_f32_16x16x32_bf16 v[108:111], v[236:239], a[116:119], v[108:111]
  v_mfma_f32_16x16x32_bf16 v[108:111], v[240:243], a[132:135], v[108:111]
  s_waitcnt vmcnt(16)
  ds_read_b128 a[200:203], v56 offset:12288
  v_mfma_f32_16x16x32_bf16 v[108:111], v[244:247], a[148:151], v[108:111]
  ds_read_b128 a[204:207], v56 offset:14336
  v_mfma_f32_16x16x32_bf16 v[100:103], v[244:247], a[144:147], v[100:103]
  ds_read_b128 a[216:219], v57 offset:12288
  buffer_load_dwordx4 v29, s[20:23], s69 offen offset:1024 lds
  v_mfma_f32_16x16x32_bf16 v[100:103], v[240:243], a[128:131], v[100:103]
  ds_read_b128 a[220:223], v57 offset:14336
  v_mfma_f32_16x16x32_bf16 v[100:103], v[236:239], a[112:115], v[100:103]
  s_waitcnt lgkmcnt(4)
  ds_read_b64_tr_b16 v[236:237], v8 offset:8
  ds_read_b64_tr_b16 v[238:239], v8 offset:1032
  v_mfma_f32_16x16x32_bf16 v[128:131], v[224:227], a[112:115], v[128:131]
  ds_read_b64_tr_b16 v[240:241], v8 offset:8200
  v_mfma_f32_16x16x32_bf16 v[128:131], v[228:231], a[128:131], v[128:131]
  ds_read_b64_tr_b16 v[242:243], v8 offset:9224
  buffer_load_dwordx4 v30, s[20:23], s69 offen offset:2048 lds
  v_mfma_f32_16x16x32_bf16 v[128:131], v[232:235], a[144:147], v[128:131]
  ds_read_b64_tr_b16 v[244:245], v8 offset:16392
  v_mfma_f32_16x16x32_bf16 v[136:139], v[232:235], a[148:151], v[136:139]
  ds_read_b64_tr_b16 v[246:247], v8 offset:17416
  v_mfma_f32_16x16x32_bf16 v[136:139], v[228:231], a[132:135], v[136:139]
  s_waitcnt lgkmcnt(6)
  buffer_load_dwordx4 v31, s[20:23], s69 offen offset:3072 lds
  v_mfma_f32_16x16x32_bf16 v[136:139], v[224:227], a[116:119], v[136:139]
  s_add_u32 s69, s69, 16384
  v_mfma_f32_16x16x32_bf16 v[144:147], v[224:227], a[120:123], v[144:147]
  v_mfma_f32_16x16x32_bf16 v[144:147], v[228:231], a[136:139], v[144:147]
  v_mfma_f32_16x16x32_bf16 v[144:147], v[232:235], a[152:155], v[144:147]
  v_mfma_f32_16x16x32_bf16 v[152:155], v[232:235], a[156:159], v[152:155]
  v_mfma_f32_16x16x32_bf16 v[152:155], v[228:231], a[140:143], v[152:155]
  v_mfma_f32_16x16x32_bf16 v[152:155], v[224:227], a[124:127], v[152:155]
  s_waitcnt lgkmcnt(0)
  ds_read_b64_tr_b16 v[224:225], v9 offset:0
  ds_read_b64_tr_b16 v[226:227], v9 offset:1024
  v_mfma_f32_16x16x32_bf16 v[156:159], v[236:239], a[124:127], v[156:159]
  ds_read_b64_tr_b16 v[228:229], v9 offset:8192
  v_mfma_f32_16x16x32_bf16 v[156:159], v[240:243], a[140:143], v[156:159]
  ds_read_b64_tr_b16 v[230:231], v9 offset:9216
  v_mfma_f32_16x16x32_bf16 v[156:159], v[244:247], a[156:159], v[156:159]
  ds_read_b64_tr_b16 v[232:233], v9 offset:16384
  v_mfma_f32_16x16x32_bf16 v[148:151], v[244:247], a[152:155], v[148:151]
  ds_read_b64_tr_b16 v[234:235], v9 offset:17408
  v_mfma_f32_16x16x32_bf16 v[148:151], v[240:243], a[136:139], v[148:151]
  v_mfma_f32_16x16x32_bf16 v[148:151], v[236:239], a[120:123], v[148:151]
  v_mfma_f32_16x16x32_bf16 v[140:143], v[236:239], a[116:119], v[140:143]
  s_waitcnt vmcnt(15)
  ds_read_b128 a[224:227], v56 offset:0
  v_mfma_f32_16x16x32_bf16 v[140:143], v[240:243], a[132:135], v[140:143]
  ds_read_b128 a[228:231], v56 offset:2048
  v_mfma_f32_16x16x32_bf16 v[140:143], v[244:247], a[148:151], v[140:143]
  ds_read_b128 a[240:243], v57 offset:0
  v_mfma_f32_16x16x32_bf16 v[132:135], v[244:247], a[144:147], v[132:135]
  ds_read_b128 a[244:247], v57 offset:2048
  v_mfma_f32_16x16x32_bf16 v[132:135], v[240:243], a[128:131], v[132:135]
  v_mfma_f32_16x16x32_bf16 v[132:135], v[236:239], a[112:115], v[132:135]
  s_waitcnt lgkmcnt(4)
  ds_read_b64_tr_b16 v[236:237], v9 offset:8
  ds_read_b64_tr_b16 v[238:239], v9 offset:1032
  v_mfma_f32_16x16x32_bf16 v[160:163], v[224:227], a[112:115], v[160:163]
  ds_read_b64_tr_b16 v[240:241], v9 offset:8200
  v_mfma_f32_16x16x32_bf16 v[160:163], v[228:231], a[128:131], v[160:163]
  s_waitcnt vmcnt(9)
  v_readfirstlane_b32 s73, v59
  s_nop 0
  s_cmp_ge_u32 s73, 32
  s_cbranch_scc0 spin_l
back_l:
  v_mfma_f32_16x16x32_bf16 v[160:163], v[232:235], a[144:147], v[160:163]
  ds_read_b64_tr_b16 v[242:243], v9 offset:9224
  ds_read_b64_tr_b16 v[244:245], v9 offset:16392
  v_mfma_f32_16x16x32_bf16 v[168:171], v[232:235], a[148:151], v[168:171]
  s_waitcnt lgkmcnt(5)
  ds_read_b64_tr_b16 v[246:247], v9 offset:17416
  v_mfma_f32_16x16x32_bf16 v[168:171], v[228:231], a[132:135], v[168:171]
  buffer_load_dwordx2 v[216:217], v254, s[4:7], s91 offen offset:0 sc1
  v_mfma_f32_16x16x32_bf16 v[168:171], v[224:227], a[116:119], v[168:171]
  v_mfma_f32_16x16x32_bf16 v[176:179], v[224:227], a[120:123], v[176:179]
  v_mfma_f32_16x16x32_bf16 v[176:179], v[228:231], a[136:139], v[176:179]
  buffer_load_dwordx2 v[218:219], v254, s[4:7], s91 offen offset:1024 sc1
  v_mfma_f32_16x16x32_bf16 v[176:179], v[232:235], a[152:155], v[176:179]
  v_mfma_f32_16x16x32_bf16 v[184:187], v[232:235], a[156:159], v[184:187]
  v_mfma_f32_16x16x32_bf16 v[184:187], v[228:231], a[140:143], v[184:187]
  buffer_load_dwordx2 v[220:221], v255, s[4:7], s91 offen offset:0 sc1
  v_mfma_f32_16x16x32_bf16 v[184:187], v[224:227], a[124:127], v[184:187]
  s_waitcnt lgkmcnt(0)
  s_barrier
  ds_read_b64_tr_b16 v[224:225], v6 offset:24576
  v_mfma_f32_16x16x32_bf16 v[188:191], v[236:239], a[124:127], v[188:191]
  ds_read_b64_tr_b16 v[226:227], v6 offset:25600
  ds_read_b64_tr_b16 v[228:229], v6 offset:32768
  v_mfma_f32_16x16x32_bf16 v[188:191], v[240:243], a[140:143], v[188:191]
  ds_read_b64_tr_b16 v[230:231], v6 offset:33792
  ds_read_b128 a[232:235], v56 offset:4096
  v_mfma_f32_16x16x32_bf16 v[188:191], v[244:247], a[156:159], v[188:191]
  ds_read_b64_tr_b16 v[232:233], v6 offset:40960
  ds_read_b128 a[236:239], v56 offset:6144
  v_mfma_f32_16x16x32_bf16 v[180:183], v[244:247], a[152:155], v[180:183]
  ds_read_b64_tr_b16 v[234:235], v6 offset:41984
  ds_read_b128 a[248:251], v57 offset:4096
  v_mfma_f32_16x16x32_bf16 v[180:183], v[240:243], a[136:139], v[180:183]
  ds_read_b64_tr_b16 a[0:1], v248 offset:24576
  ds_read_b128 a[252:255], v57 offset:6144
  v_mfma_f32_16x16x32_bf16 v[180:183], v[236:239], a[120:123], v[180:183]
  ds_read_b64_tr_b16 a[2:3], v248 offset:25600
  buffer_load_dwordx2 v[222:223], v255, s[4:7], s91 offen offset:1024 sc1
  v_mfma_f32_16x16x32_bf16 v[172:175], v[236:239], a[116:119], v[172:175]
  ds_read_b64_tr_b16 a[4:5], v248 offset:32768
  v_mfma_f32_16x16x32_bf16 v[172:175], v[240:243], a[132:135], v[172:175]
  ds_read_b64_tr_b16 a[6:7], v248 offset:33792
  v_mfma_f32_16x16x32_bf16 v[172:175], v[244:247], a[148:151], v[172:175]
  ds_read_b64_tr_b16 a[8:9], v248 offset:40960
  v_mfma_f32_16x16x32_bf16 v[164:167], v[244:247], a[144:147], v[164:167]
  s_waitcnt lgkmcnt(4)
  ds_read_b64_tr_b16 a[10:11], v248 offset:41984
  v_mfma_f32_16x16x32_bf16 v[164:167], v[240:243], a[128:131], v[164:167]
  ds_read_b64_tr_b16 a[12:13], v248 offset:24584
  v_mfma_f32_16x16x32_bf16 v[164:167], v[236:239], a[112:115], v[164:167]
  ds_read_b64_tr_b16 a[14:15], v248 offset:25608
  v_mfma_f32_16x16x32_bf16 v[64:67], v[224:227], a[160:163], v[64:67]
  ds_read_b64_tr_b16 a[16:17], v248 offset:32776
  v_mfma_f32_16x16x32_bf16 v[64:67], v[228:231], a[176:179], v[64:67]
  ds_read_b64_tr_b16 a[18:19], v248 offset:33800
  v_mfma_f32_16x16x32_bf16 v[64:67], v[232:235], a[192:195], v[64:67]
  ds_read_b64_tr_b16 a[20:21], v248 offset:40968
  v_and_b32 v202, 3, v0
  v_mfma_f32_16x16x32_bf16 v[72:75], v[232:235], a[196:199], v[72:75]
  ds_read_b64_tr_b16 a[22:23], v248 offset:41992
  v_mfma_f32_16x16x32_bf16 v[72:75], v[228:231], a[180:183], v[72:75]
  v_cmp_eq_u32 vcc, 0, v202
  v_mfma_f32_16x16x32_bf16 v[72:75], v[224:227], a[164:167], v[72:75]
  ds_read_b64_tr_b16 v[236:237], v6 offset:24584
  ds_read_b64_tr_b16 v[238:239], v6 offset:25608
  v_mfma_f32_16x16x32_bf16 v[80:83], v[224:227], a[168:171], v[80:83]
  ds_read_b64_tr_b16 v[240:241], v6 offset:32776
  ds_write_b32 v201, v192 offset:32768
  v_mfma_f32_16x16x32_bf16 v[80:83], v[228:231], a[184:187], v[80:83]
  ds_read_b64_tr_b16 v[242:243], v6 offset:33800
  v_mov_b32 v203, 0x3f803f80
  v_mfma_f32_16x16x32_bf16 v[80:83], v[232:235], a[200:203], v[80:83]
  ds_read_b64_tr_b16 v[244:245], v6 offset:40968
  ds_write_b32 v201, v193 offset:33792
  v_mfma_f32_16x16x32_bf16 v[88:91], v[232:235], a[204:207], v[88:91]
  ds_read_b64_tr_b16 v[246:247], v6 offset:41992
  v_cndmask_b32 v202, 0, v203, vcc
  v_mfma_f32_16x16x32_bf16 v[88:91], v[228:231], a[188:191], v[88:91]
  v_accvgpr_write_b32 a144, v202
  v_mfma_f32_16x16x32_bf16 v[88:91], v[224:227], a[172:175], v[88:91]
  s_waitcnt lgkmcnt(8)
  ds_write_b32 v201, v194 offset:34816
  v_mfma_f32_16x16x32_bf16 a[24:27], a[0:3], a[32:35], a[24:27]
  v_accvgpr_write_b32 a145, v202
  v_mfma_f32_16x16x32_bf16 a[24:27], a[4:7], a[32:35], a[24:27]
  v_mfma_f32_16x16x32_bf16 a[24:27], a[8:11], a[32:35], a[24:27]
  ds_write_b32 v201, v195 offset:35840
  v_accvgpr_write_b32 a146, v202
  v_mfma_f32_16x16x32_bf16 a[28:31], a[12:15], a[32:35], a[28:31]
  v_mfma_f32_16x16x32_bf16 a[28:31], a[16:19], a[32:35], a[28:31]
  v_accvgpr_write_b32 a147, v202
  v_mfma_f32_16x16x32_bf16 a[28:31], a[20:23], a[32:35], a[28:31]
  s_waitcnt vmcnt(8) lgkmcnt(0)
  s_barrier
  ds_read_b64_tr_b16 v[224:225], v10 offset:0
  v_mfma_f32_16x16x32_bf16 v[92:95], v[236:239], a[172:175], v[92:95]
  s_add_u32 m0, s68, 49152
  ds_read_b64_tr_b16 v[226:227], v10 offset:1024
  ds_read_b64_tr_b16 v[228:229], v10 offset:8192
  v_mfma_f32_16x16x32_bf16 v[92:95], v[240:243], a[188:191], v[92:95]
  ds_read_b64_tr_b16 v[230:231], v10 offset:9216
  ds_write_b32 v201, v196 offset:36864
  v_mfma_f32_16x16x32_bf16 v[92:95], v[244:247], a[204:207], v[92:95]
  ds_read_b64_tr_b16 v[232:233], v10 offset:16384
  ds_write_b32 v201, v197 offset:37888
  v_mfma_f32_16x16x32_bf16 v[84:87], v[244:247], a[200:203], v[84:87]
  ds_read_b64_tr_b16 v[234:235], v10 offset:17408
  v_mfma_f32_16x16x32_bf16 v[84:87], v[240:243], a[184:187], v[84:87]
  ds_read_b64_tr_b16 a[0:1], v249 offset:0
  v_mfma_f32_16x16x32_bf16 v[84:87], v[236:239], a[168:171], v[84:87]
  ds_read_b64_tr_b16 a[2:3], v249 offset:1024
  ds_write_b32 v201, v198 offset:38912
  v_mfma_f32_16x16x32_bf16 v[76:79], v[236:239], a[164:167], v[76:79]
  ds_read_b64_tr_b16 a[4:5], v249 offset:8192
  v_mfma_f32_16x16x32_bf16 v[76:79], v[240:243], a[180:183], v[76:79]
  ds_read_b64_tr_b16 a[6:7], v249 offset:9216
  v_mfma_f32_16x16x32_bf16 v[76:79], v[244:247], a[196:199], v[76:79]
  ds_read_b64_tr_b16 a[8:9], v249 offset:16384
  buffer_load_dwordx4 v32, s[24:27], s70 offen offset:0 lds
  v_mfma_f32_16x16x32_bf16 v[68:71], v[244:247], a[192:195], v[68:71]
  ds_read_b64_tr_b16 a[10:11], v249 offset:17408
  ds_write_b32 v201, v199 offset:39936
  v_mfma_f32_16x16x32_bf16 v[68:71], v[240:243], a[176:179], v[68:71]
  ds_read_b64_tr_b16 a[12:13], v249 offset:8
  v_mfma_f32_16x16x32_bf16 v[68:71], v[236:239], a[160:163], v[68:71]
  s_waitcnt lgkmcnt(9)
  ds_read_b64_tr_b16 a[14:15], v249 offset:1032
  ds_write_b32 v201, v200 offset:40960
  v_mfma_f32_16x16x32_bf16 v[64:67], v[224:227], a[208:211], v[64:67]
  ds_read_b64_tr_b16 a[16:17], v249 offset:8200
  v_lshlrev_b32 v201, 4, v0
  v_mfma_f32_16x16x32_bf16 v[64:67], v[228:231], a[224:227], v[64:67]
  ds_read_b64_tr_b16 a[18:19], v249 offset:9224
  buffer_load_dwordx4 v33, s[24:27], s70 offen offset:1024 lds
  v_mfma_f32_16x16x32_bf16 v[64:67], v[232:235], a[240:243], v[64:67]
  ds_read_b64_tr_b16 a[20:21], v249 offset:16392
  v_mfma_f32_16x16x32_bf16 v[72:75], v[232:235], a[244:247], v[72:75]
  ds_read_b64_tr_b16 a[22:23], v249 offset:17416
  v_mfma_f32_16x16x32_bf16 v[72:75], v[228:231], a[228:231], v[72:75]
  buffer_load_dwordx4 v32, s[24:27], s70 offen offset:2048 lds
  v_mfma_f32_16x16x32_bf16 v[72:75], v[224:227], a[212:215], v[72:75]
  ds_read_b64_tr_b16 v[236:237], v7 offset:24576
  ds_read_b64_tr_b16 v[238:239], v7 offset:25600
  v_mfma_f32_16x16x32_bf16 v[80:83], v[224:227], a[216:219], v[80:83]
  ds_read_b64_tr_b16 v[240:241], v7 offset:32768
  v_mfma_f32_16x16x32_bf16 v[80:83], v[228:231], a[232:235], v[80:83]
  ds_read_b64_tr_b16 v[242:243], v7 offset:33792
  v_mfma_f32_16x16x32_bf16 v[80:83], v[232:235], a[248:251], v[80:83]
  ds_read_b64_tr_b16 v[244:245], v7 offset:40960
  v_mfma_f32_16x16x32_bf16 v[88:91], v[232:235], a[252:255], v[88:91]
  ds_read_b64_tr_b16 v[246:247], v7 offset:41984
  v_mfma_f32_16x16x32_bf16 v[88:91], v[228:231], a[236:239], v[88:91]
  buffer_load_dwordx4 v33, s[24:27], s70 offen offset:3072 lds
  v_mfma_f32_16x16x32_bf16 v[88:91], v[224:227], a[220:223], v[88:91]
  s_waitcnt lgkmcnt(6)
  v_mfma_f32_16x16x32_bf16 a[24:27], a[0:3], a[32:35], a[24:27]
  s_add_u32 s70, s70, 16384
  v_mfma_f32_16x16x32_bf16 a[24:27], a[4:7], a[32:35], a[24:27]
  v_mfma_f32_16x16x32_bf16 a[24:27], a[8:11], a[32:35], a[24:27]
  v_mfma_f32_16x16x32_bf16 a[28:31], a[12:15], a[32:35], a[28:31]
  v_mfma_f32_16x16x32_bf16 a[28:31], a[16:19], a[32:35], a[28:31]
  v_mfma_f32_16x16x32_bf16 a[28:31], a[20:23], a[32:35], a[28:31]
  s_waitcnt lgkmcnt(0)
  ds_read_b64_tr_b16 v[224:225], v10 offset:8
  ds_read_b64_tr_b16 v[226:227], v10 offset:1032
  v_mfma_f32_16x16x32_bf16 v[120:123], v[236:239], a[172:175], v[120:123]
  ds_read_b64_tr_b16 v[228:229], v10 offset:8200
  v_mfma_f32_16x16x32_bf16 v[120:123], v[240:243], a[188:191], v[120:123]
  ds_read_b64_tr_b16 v[230:231], v10 offset:9224
  s_waitcnt vmcnt(7)
  v_mul_f32 v217, 0x3e0293ee, v217
  v_mfma_f32_16x16x32_bf16 v[120:123], v[244:247], a[204:207], v[120:123]
  ds_read_b64_tr_b16 v[232:233], v10 offset:16392
  ds_write_b128 v250, a[24:27] offset:0
  v_mfma_f32_16x16x32_bf16 v[112:115], v[244:247], a[200:203], v[112:115]
  ds_read_b64_tr_b16 v[234:235], v10 offset:17416
  ds_write_b128 v250, a[28:31] offset:64
  v_mfma_f32_16x16x32_bf16 v[112:115], v[240:243], a[184:187], v[112:115]
  s_waitcnt vmcnt(6)
  v_mul_f32 v219, 0x3e0293ee, v219
  s_waitcnt vmcnt(5)
  v_mul_f32 v221, 0x3e0293ee, v221
  v_mfma_f32_16x16x32_bf16 v[112:115], v[236:239], a[168:171], v[112:115]
  s_waitcnt vmcnt(4)
  v_mul_f32 v223, 0x3e0293ee, v223
  v_mfma_f32_16x16x32_bf16 v[104:107], v[236:239], a[164:167], v[104:107]
  v_mfma_f32_16x16x32_bf16 v[104:107], v[240:243], a[180:183], v[104:107]
  s_waitcnt lgkmcnt(0)
  s_barrier
  ds_read_b128 v[204:207], v251 offset:0
  v_mfma_f32_16x16x32_bf16 v[104:107], v[244:247], a[196:199], v[104:107]
  ds_read_b128 v[208:211], v251 offset:64
  ds_read_b128 v[212:215], v251 offset:128
  v_mfma_f32_16x16x32_bf16 v[96:99], v[244:247], a[192:195], v[96:99]
  s_add_u32 m0, s67, 16384
  ds_read_b128 v[192:195], v251 offset:192
  ds_read_b128 v[196:199], v251 offset:256
  v_mfma_f32_16x16x32_bf16 v[96:99], v[240:243], a[176:179], v[96:99]
  v_mfma_f32_16x16x32_bf16 v[96:99], v[236:239], a[160:163], v[96:99]
  ds_read_b64_tr_b16 v[236:237], v7 offset:24584
  ds_read_b64_tr_b16 v[238:239], v7 offset:25608
  v_mfma_f32_16x16x32_bf16 v[68:71], v[224:227], a[208:211], v[68:71]
  ds_read_b64_tr_b16 v[240:241], v7 offset:32776
  ds_read_b128 a[36:39], v201 offset:32768
  v_mfma_f32_16x16x32_bf16 v[68:71], v[228:231], a[224:227], v[68:71]
  ds_read_b64_tr_b16 v[242:243], v7 offset:33800
  s_waitcnt lgkmcnt(9)
  v_fmac_f32 v64, v216, v204
  v_mfma_f32_16x16x32_bf16 v[68:71], v[232:235], a[240:243], v[68:71]
  ds_read_b64_tr_b16 v[244:245], v7 offset:40968
  v_fmac_f32 v65, v216, v205
  v_mfma_f32_16x16x32_bf16 v[76:79], v[232:235], a[244:247], v[76:79]
  ds_read_b64_tr_b16 v[246:247], v7 offset:41992
  v_fmac_f32 v72, v218, v204
  v_mfma_f32_16x16x32_bf16 v[76:79], v[228:231], a[228:231], v[76:79]
  buffer_load_dwordx4 v28, s[20:23], s69 offen offset:0 lds
  v_mfma_f32_16x16x32_bf16 v[76:79], v[224:227], a[212:215], v[76:79]
  v_fmac_f32 v73, v218, v205
  v_fmac_f32 v80, v220, v204
  v_mfma_f32_16x16x32_bf16 v[84:87], v[224:227], a[216:219], v[84:87]
  v_fmac_f32 v81, v220, v205
  v_fmac_f32 v88, v222, v204
  v_mfma_f32_16x16x32_bf16 v[84:87], v[228:231], a[232:235], v[84:87]
  buffer_load_dwordx4 v29, s[20:23], s69 offen offset:1024 lds
  v_mfma_f32_16x16x32_bf16 v[84:87], v[232:235], a[248:251], v[84:87]
  v_fmac_f32 v66, v216, v206
  v_fmac_f32 v89, v222, v205
  v_mfma_f32_16x16x32_bf16 v[92:95], v[232:235], a[252:255], v[92:95]
  v_fmac_f32 v67, v216, v207
  v_mul_f32 v64, v217, v64
  v_mfma_f32_16x16x32_bf16 v[92:95], v[228:231], a[236:239], v[92:95]
  buffer_load_dwordx4 v30, s[20:23], s69 offen offset:2048 lds
  v_mfma_f32_16x16x32_bf16 v[92:95], v[224:227], a[220:223], v[92:95]
  s_waitcnt lgkmcnt(0)
  ds_read_b64_tr_b16 v[224:225], v11 offset:0
  ds_read_b64_tr_b16 v[226:227], v11 offset:1024
  ds_read_b128 a[40:43], v201 offset:36864
  ds_read_b128 a[44:47], v201 offset:40960
  v_mfma_f32_16x16x32_bf16 v[124:127], v[236:239], a[172:175], v[124:127]
  ds_read_b64_tr_b16 v[228:229], v11 offset:8192
  v_mul_f32 v65, v217, v65
  v_mfma_f32_16x16x32_bf16 v[124:127], v[240:243], a[188:191], v[124:127]
  ds_read_b64_tr_b16 v[230:231], v11 offset:9216
  v_fmac_f32 v74, v218, v206
  v_mfma_f32_16x16x32_bf16 v[124:127], v[244:247], a[204:207], v[124:127]
  ds_read_b64_tr_b16 v[232:233], v11 offset:16384
  v_fmac_f32 v75, v218, v207
  v_mfma_f32_16x16x32_bf16 v[116:119], v[244:247], a[200:203], v[116:119]
  ds_read_b64_tr_b16 v[234:235], v11 offset:17408
  v_mul_f32 v72, v219, v72
  v_mfma_f32_16x16x32_bf16 v[116:119], v[240:243], a[184:187], v[116:119]
  buffer_load_dwordx4 v31, s[20:23], s69 offen offset:3072 lds
  v_mfma_f32_16x16x32_bf16 v[116:119], v[236:239], a[168:171], v[116:119]
  s_add_u32 s69, s69, 16384
  v_mul_f32 v73, v219, v73
  v_fmac_f32 v82, v220, v206
  v_mfma_f32_16x16x32_bf16 v[108:111], v[236:239], a[164:167], v[108:111]
  v_fmac_f32 v83, v220, v207
  v_mul_f32 v80, v221, v80
  v_mfma_f32_16x16x32_bf16 v[108:111], v[240:243], a[180:183], v[108:111]
  v_mul_f32 v81, v221, v81
  v_fmac_f32 v90, v222, v206
  v_mfma_f32_16x16x32_bf16 v[108:111], v[244:247], a[196:199], v[108:111]
  v_fmac_f32 v91, v222, v207
  v_mul_f32 v88, v223, v88
  v_mfma_f32_16x16x32_bf16 v[100:103], v[244:247], a[192:195], v[100:103]
  v_mul_f32 v66, v217, v66
  v_mul_f32 v89, v223, v89
  v_mfma_f32_16x16x32_bf16 v[100:103], v[240:243], a[176:179], v[100:103]
  buffer_store_dwordx4 a[36:39], v253, s[4:7], s75 offen sc1
  v_mfma_f32_16x16x32_bf16 v[100:103], v[236:239], a[160:163], v[100:103]
  s_waitcnt lgkmcnt(0)
  ds_read_b64_tr_b16 v[236:237], v8 offset:24576
  ds_read_b64_tr_b16 v[238:239], v8 offset:25600
  v_mfma_f32_16x16x32_bf16 v[96:99], v[224:227], a[208:211], v[96:99]
  ds_read_b64_tr_b16 v[240:241], v8 offset:32768
  v_mul_f32 v67, v217, v67
  v_mfma_f32_16x16x32_bf16 v[96:99], v[228:231], a[224:227], v[96:99]
  ds_read_b64_tr_b16 v[242:243], v8 offset:33792
  v_cvt_pk_bf16_f32 v64, v64, v65
  v_mfma_f32_16x16x32_bf16 v[96:99], v[232:235], a[240:243], v[96:99]
  ds_read_b64_tr_b16 v[244:245], v8 offset:40960
  v_mul_f32 v74, v219, v74
  v_mfma_f32_16x16x32_bf16 v[104:107], v[232:235], a[244:247], v[104:107]
  s_add_u32 s75, s75, 32768
  ds_read_b64_tr_b16 v[246:247], v8 offset:41984
  v_mul_f32 v75, v219, v75
  v_mfma_f32_16x16x32_bf16 v[104:107], v[228:231], a[228:231], v[104:107]
  v_cvt_pk_bf16_f32 v72, v72, v73
  v_mul_f32 v82, v221, v82
  v_mfma_f32_16x16x32_bf16 v[104:107], v[224:227], a[212:215], v[104:107]
  v_mul_f32 v83, v221, v83
  v_cvt_pk_bf16_f32 v80, v80, v81
  v_mfma_f32_16x16x32_bf16 v[112:115], v[224:227], a[216:219], v[112:115]
  buffer_store_dwordx4 a[40:43], v253, s[4:7], s75 offen sc1
  v_mfma_f32_16x16x32_bf16 v[112:115], v[228:231], a[232:235], v[112:115]
  v_mul_f32 v90, v223, v90
  v_mul_f32 v91, v223, v91
  v_mfma_f32_16x16x32_bf16 v[112:115], v[232:235], a[248:251], v[112:115]
  v_cvt_pk_bf16_f32 v65, v66, v67
  v_cvt_pk_bf16_f32 v88, v88, v89
  v_mfma_f32_16x16x32_bf16 v[120:123], v[232:235], a[252:255], v[120:123]
  v_cvt_pk_bf16_f32 v73, v74, v75
  v_cvt_pk_bf16_f32 v81, v82, v83
  v_mfma_f32_16x16x32_bf16 v[120:123], v[228:231], a[236:239], v[120:123]
  v_cvt_pk_bf16_f32 v89, v90, v91
  v_fmac_f32 v68, v216, v208
  v_mfma_f32_16x16x32_bf16 v[120:123], v[224:227], a[220:223], v[120:123]
  s_waitcnt lgkmcnt(0)
  ds_read_b64_tr_b16 v[224:225], v11 offset:8
  ds_read_b64_tr_b16 v[226:227], v11 offset:1032
  v_mfma_f32_16x16x32_bf16 v[152:155], v[236:239], a[172:175], v[152:155]
  s_lshl_b32 s74, s57, 28
  ds_read_b64_tr_b16 v[228:229], v11 offset:8200
  v_fmac_f32 v69, v216, v209
  v_mfma_f32_16x16x32_bf16 v[152:155], v[240:243], a[188:191], v[152:155]
  s_add_u32 s75, s75, s74
  ds_read_b64_tr_b16 v[230:231], v11 offset:9224
  v_fmac_f32 v70, v216, v210
  v_mfma_f32_16x16x32_bf16 v[152:155], v[244:247], a[204:207], v[152:155]
  s_add_u32 s75, s75, 32768
  ds_read_b64_tr_b16 v[232:233], v11 offset:16392
  v_fmac_f32 v71, v216, v211
  v_mfma_f32_16x16x32_bf16 v[144:147], v[244:247], a[200:203], v[144:147]
  ds_read_b64_tr_b16 v[234:235], v11 offset:17416
  v_mul_f32 v68, v217, v68
  v_mfma_f32_16x16x32_bf16 v[144:147], v[240:243], a[184:187], v[144:147]
  buffer_store_dwordx4 a[44:47], v253, s[4:7], s75 offen sc1
  v_mfma_f32_16x16x32_bf16 v[144:147], v[236:239], a[168:171], v[144:147]
  v_mul_f32 v69, v217, v69
  v_mul_f32 v70, v217, v70
  v_mfma_f32_16x16x32_bf16 v[136:139], v[236:239], a[164:167], v[136:139]
  v_mul_f32 v71, v217, v71
  v_cvt_pk_bf16_f32 v66, v68, v69
  v_mfma_f32_16x16x32_bf16 v[136:139], v[240:243], a[180:183], v[136:139]
  v_cvt_pk_bf16_f32 v67, v70, v71
  v_fmac_f32 v76, v218, v208
  v_mfma_f32_16x16x32_bf16 v[136:139], v[244:247], a[196:199], v[136:139]
  v_fmac_f32 v77, v218, v209
  v_fmac_f32 v78, v218, v210
  v_mfma_f32_16x16x32_bf16 v[128:131], v[244:247], a[192:195], v[128:131]
  v_fmac_f32 v79, v218, v211
  v_mul_f32 v76, v219, v76
  v_mfma_f32_16x16x32_bf16 v[128:131], v[240:243], a[176:179], v[128:131]
  v_mul_f32 v77, v219, v77
  v_mul_f32 v78, v219, v78
  v_mfma_f32_16x16x32_bf16 v[128:131], v[236:239], a[160:163], v[128:131]
  s_waitcnt lgkmcnt(0)
  ds_read_b64_tr_b16 v[236:237], v8 offset:24584
  ds_read_b64_tr_b16 v[238:239], v8 offset:25608
  v_mfma_f32_16x16x32_bf16 v[100:103], v[224:227], a[208:211], v[100:103]
  ds_read_b64_tr_b16 v[240:241], v8 offset:32776
  v_mul_f32 v79, v219, v79
  v_mfma_f32_16x16x32_bf16 v[100:103], v[228:231], a[224:227], v[100:103]
  ds_read_b64_tr_b16 v[242:243], v8 offset:33800
  v_cvt_pk_bf16_f32 v74, v76, v77
  v_mfma_f32_16x16x32_bf16 v[100:103], v[232:235], a[240:243], v[100:103]
  ds_read_b64_tr_b16 v[244:245], v8 offset:40968
  v_cvt_pk_bf16_f32 v75, v78, v79
  v_mfma_f32_16x16x32_bf16 v[108:111], v[232:235], a[244:247], v[108:111]
  ds_read_b64_tr_b16 v[246:247], v8 offset:41992
  v_fmac_f32 v84, v220, v208
  v_mfma_f32_16x16x32_bf16 v[108:111], v[228:231], a[228:231], v[108:111]
  v_fmac_f32 v85, v220, v209
  v_fmac_f32 v86, v220, v210
  v_mfma_f32_16x16x32_bf16 v[108:111], v[224:227], a[212:215], v[108:111]
  v_fmac_f32 v87, v220, v211
  v_mul_f32 v84, v221, v84
  v_mfma_f32_16x16x32_bf16 v[116:119], v[224:227], a[216:219], v[116:119]
  v_mul_f32 v85, v221, v85
  v_mul_f32 v86, v221, v86
  v_mfma_f32_16x16x32_bf16 v[116:119], v[228:231], a[232:235], v[116:119]
  v_mul_f32 v87, v221, v87
  v_cvt_pk_bf16_f32 v82, v84, v85
  v_mfma_f32_16x16x32_bf16 v[116:119], v[232:235], a[248:251], v[116:119]
  v_cvt_pk_bf16_f32 v83, v86, v87
  v_fmac_f32 v92, v222, v208
  v_mfma_f32_16x16x32_bf16 v[124:127], v[232:235], a[252:255], v[124:127]
  v_fmac_f32 v93, v222, v209
  v_fmac_f32 v94, v222, v210
  v_mfma_f32_16x16x32_bf16 v[124:127], v[228:231], a[236:239], v[124:127]
  v_fmac_f32 v95, v222, v211
  v_mul_f32 v92, v223, v92
  v_mfma_f32_16x16x32_bf16 v[124:127], v[224:227], a[220:223], v[124:127]
  s_waitcnt lgkmcnt(0)
  ds_read_b64_tr_b16 v[224:225], v12 offset:0
  ds_read_b64_tr_b16 v[226:227], v12 offset:1024
  v_mfma_f32_16x16x32_bf16 v[156:159], v[236:239], a[172:175], v[156:159]
  ds_read_b64_tr_b16 v[228:229], v12 offset:8192
  v_mul_f32 v93, v223, v93
  v_mfma_f32_16x16x32_bf16 v[156:159], v[240:243], a[188:191], v[156:159]
  ds_read_b64_tr_b16 v[230:231], v12 offset:9216
  v_mul_f32 v94, v223, v94
  v_mfma_f32_16x16x32_bf16 v[156:159], v[244:247], a[204:207], v[156:159]
  ds_read_b64_tr_b16 v[232:233], v12 offset:16384
  v_mul_f32 v95, v223, v95
  v_mfma_f32_16x16x32_bf16 v[148:151], v[244:247], a[200:203], v[148:151]
  ds_read_b64_tr_b16 v[234:235], v12 offset:17408
  v_cvt_pk_bf16_f32 v90, v92, v93
  v_mfma_f32_16x16x32_bf16 v[148:151], v[240:243], a[184:187], v[148:151]
  v_cvt_pk_bf16_f32 v91, v94, v95
  v_fmac_f32 v96, v216, v212
  v_mfma_f32_16x16x32_bf16 v[148:151], v[236:239], a[168:171], v[148:151]
  v_fmac_f32 v97, v216, v213
  v_fmac_f32 v98, v216, v214
  v_mfma_f32_16x16x32_bf16 v[140:143], v[236:239], a[164:167], v[140:143]
  v_fmac_f32 v99, v216, v215
  v_mul_f32 v96, v217, v96
  v_mfma_f32_16x16x32_bf16 v[140:143], v[240:243], a[180:183], v[140:143]
  v_mul_f32 v97, v217, v97
  v_mul_f32 v98, v217, v98
  v_mfma_f32_16x16x32_bf16 v[140:143], v[244:247], a[196:199], v[140:143]
  v_mul_f32 v99, v217, v99
  v_cvt_pk_bf16_f32 v96, v96, v97
  v_mfma_f32_16x16x32_bf16 v[132:135], v[244:247], a[192:195], v[132:135]
  v_cvt_pk_bf16_f32 v97, v98, v99
  v_fmac_f32 v104, v218, v212
  v_mfma_f32_16x16x32_bf16 v[132:135], v[240:243], a[176:179], v[132:135]
  v_fmac_f32 v105, v218, v213
  v_fmac_f32 v106, v218, v214
  v_mfma_f32_16x16x32_bf16 v[132:135], v[236:239], a[160:163], v[132:135]
  s_waitcnt lgkmcnt(0)
  ds_read_b64_tr_b16 v[236:237], v9 offset:24576
  ds_read_b64_tr_b16 v[238:239], v9 offset:25600
  v_mfma_f32_16x16x32_bf16 v[128:131], v[224:227], a[208:211], v[128:131]
  ds_read_b64_tr_b16 v[240:241], v9 offset:32768
  v_fmac_f32 v107, v218, v215
  v_mfma_f32_16x16x32_bf16 v[128:131], v[228:231], a[224:227], v[128:131]
  ds_read_b64_tr_b16 v[242:243], v9 offset:33792
  v_mul_f32 v104, v219, v104
  v_mfma_f32_16x16x32_bf16 v[128:131], v[232:235], a[240:243], v[128:131]
  ds_read_b64_tr_b16 v[244:245], v9 offset:40960
  v_mul_f32 v105, v219, v105
  v_mfma_f32_16x16x32_bf16 v[136:139], v[232:235], a[244:247], v[136:139]
  ds_read_b64_tr_b16 v[246:247], v9 offset:41984
  v_mul_f32 v106, v219, v106
  v_mfma_f32_16x16x32_bf16 v[136:139], v[228:231], a[228:231], v[136:139]
  v_mul_f32 v107, v219, v107
  v_cvt_pk_bf16_f32 v104, v104, v105
  v_mfma_f32_16x16x32_bf16 v[136:139], v[224:227], a[212:215], v[136:139]
  v_cvt_pk_bf16_f32 v105, v106, v107
  v_fmac_f32 v112, v220, v212
  v_mfma_f32_16x16x32_bf16 v[144:147], v[224:227], a[216:219], v[144:147]
  v_fmac_f32 v113, v220, v213
  v_fmac_f32 v114, v220, v214
  v_mfma_f32_16x16x32_bf16 v[144:147], v[228:231], a[232:235], v[144:147]
  v_fmac_f32 v115, v220, v215
  v_mul_f32 v112, v221, v112
  v_mfma_f32_16x16x32_bf16 v[144:147], v[232:235], a[248:251], v[144:147]
  v_mul_f32 v113, v221, v113
  v_mul_f32 v114, v221, v114
  v_mfma_f32_16x16x32_bf16 v[152:155], v[232:235], a[252:255], v[152:155]
  v_mul_f32 v115, v221, v115
  v_cvt_pk_bf16_f32 v112, v112, v113
  v_mfma_f32_16x16x32_bf16 v[152:155], v[228:231], a[236:239], v[152:155]
  v_cvt_pk_bf16_f32 v113, v114, v115
  v_fmac_f32 v120, v222, v212
  v_mfma_f32_16x16x32_bf16 v[152:155], v[224:227], a[220:223], v[152:155]
  s_waitcnt lgkmcnt(0)
  ds_read_b64_tr_b16 v[224:225], v12 offset:8
  ds_read_b64_tr_b16 v[226:227], v12 offset:1032
  v_mfma_f32_16x16x32_bf16 v[184:187], v[236:239], a[172:175], v[184:187]
  ds_read_b64_tr_b16 v[228:229], v12 offset:8200
  v_fmac_f32 v121, v222, v213
  v_mfma_f32_16x16x32_bf16 v[184:187], v[240:243], a[188:191], v[184:187]
  ds_read_b64_tr_b16 v[230:231], v12 offset:9224
  v_fmac_f32 v122, v222, v214
  v_mfma_f32_16x16x32_bf16 v[184:187], v[244:247], a[204:207], v[184:187]
  ds_read_b64_tr_b16 v[232:233], v12 offset:16392
  v_fmac_f32 v123, v222, v215
  v_mfma_f32_16x16x32_bf16 v[176:179], v[244:247], a[200:203], v[176:179]
  ds_read_b64_tr_b16 v[234:235], v12 offset:17416
  v_mul_f32 v120, v223, v120
  v_mfma_f32_16x16x32_bf16 v[176:179], v[240:243], a[184:187], v[176:179]
  v_mul_f32 v121, v223, v121
  v_mul_f32 v122, v223, v122
  v_mfma_f32_16x16x32_bf16 v[176:179], v[236:239], a[168:171], v[176:179]
  v_mul_f32 v123, v223, v123
  v_cvt_pk_bf16_f32 v120, v120, v121
  v_mfma_f32_16x16x32_bf16 v[168:171], v[236:239], a[164:167], v[168:171]
  v_cvt_pk_bf16_f32 v121, v122, v123
  v_fmac_f32 v100, v216, v192
  v_mfma_f32_16x16x32_bf16 v[168:171], v[240:243], a[180:183], v[168:171]
  v_fmac_f32 v101, v216, v193
  v_fmac_f32 v102, v216, v194
  v_mfma_f32_16x16x32_bf16 v[168:171], v[244:247], a[196:199], v[168:171]
  v_fmac_f32 v103, v216, v195
  v_mul_f32 v100, v217, v100
  v_mfma_f32_16x16x32_bf16 v[160:163], v[244:247], a[192:195], v[160:163]
  v_mul_f32 v101, v217, v101
  v_mul_f32 v102, v217, v102
  v_mfma_f32_16x16x32_bf16 v[160:163], v[240:243], a[176:179], v[160:163]
pad_m_3:
  s_cbranch_execz warm_0
  v_mul_f32 v103, v217, v103
  v_cvt_pk_bf16_f32 v98, v100, v101
  v_mfma_f32_16x16x32_bf16 v[160:163], v[236:239], a[160:163], v[160:163]
  s_waitcnt lgkmcnt(0)
  ds_read_b64_tr_b16 v[236:237], v9 offset:24584
  ds_read_b64_tr_b16 v[238:239], v9 offset:25608
  v_mfma_f32_16x16x32_bf16 v[132:135], v[224:227], a[208:211], v[132:135]
  ds_read_b64_tr_b16 v[240:241], v9 offset:32776
  v_cvt_pk_bf16_f32 v99, v102, v103
  v_mfma_f32_16x16x32_bf16 v[132:135], v[228:231], a[224:227], v[132:135]
  ds_read_b64_tr_b16 v[242:243], v9 offset:33800
  v_fmac_f32 v108, v218, v192
  v_mfma_f32_16x16x32_bf16 v[132:135], v[232:235], a[240:243], v[132:135]
  ds_read_b64_tr_b16 v[244:245], v9 offset:40968
  v_fmac_f32 v109, v218, v193
  v_mfma_f32_16x16x32_bf16 v[140:143], v[232:235], a[244:247], v[140:143]
  ds_read_b64_tr_b16 v[246:247], v9 offset:41992
  v_fmac_f32 v110, v218, v194
  v_mfma_f32_16x16x32_bf16 v[140:143], v[228:231], a[228:231], v[140:143]
  v_fmac_f32 v111, v218, v195
  v_mul_f32 v108, v219, v108
  v_mfma_f32_16x16x32_bf16 v[140:143], v[224:227], a[212:215], v[140:143]
  v_mul_f32 v109, v219, v109
  v_mul_f32 v110, v219, v110
  v_mfma_f32_16x16x32_bf16 v[148:151], v[224:227], a[216:219], v[148:151]
  v_mul_f32 v111, v219, v111
  v_cvt_pk_bf16_f32 v106, v108, v109
  v_mfma_f32_16x16x32_bf16 v[148:151], v[228:231], a[232:235], v[148:151]
  v_cvt_pk_bf16_f32 v107, v110, v111
  v_fmac_f32 v116, v220, v192
  v_mfma_f32_16x16x32_bf16 v[148:151], v[232:235], a[248:251], v[148:151]
  v_fmac_f32 v117, v220, v193
  v_fmac_f32 v118, v220, v194
  v_mfma_f32_16x16x32_bf16 v[156:159], v[232:235], a[252:255], v[156:159]
  v_fmac_f32 v119, v220, v195
  v_mul_f32 v116, v221, v116
  v_mfma_f32_16x16x32_bf16 v[156:159], v[228:231], a[236:239], v[156:159]
  v_mul_f32 v117, v221, v117
  v_mul_f32 v118, v221, v118
  v_mfma_f32_16x16x32_bf16 v[156:159], v[224:227], a[220:223], v[156:159]
  s_waitcnt lgkmcnt(0)
  ds_read_b64_tr_b16 v[224:225], v13 offset:0
  ds_read_b64_tr_b16 v[226:227], v13 offset:1024
  v_mfma_f32_16x16x32_bf16 v[188:191], v[236:239], a[172:175], v[188:191]
  ds_read_b64_tr_b16 v[228:229], v13 offset:8192
  v_mul_f32 v119, v221, v119
  v_mfma_f32_16x16x32_bf16 v[188:191], v[240:243], a[188:191], v[188:191]
  ds_read_b64_tr_b16 v[230:231], v13 offset:9216
  v_cvt_pk_bf16_f32 v114, v116, v117
  v_mfma_f32_16x16x32_bf16 v[188:191], v[244:247], a[204:207], v[188:191]
  ds_read_b64_tr_b16 v[232:233], v13 offset:16384
  v_cvt_pk_bf16_f32 v115, v118, v119
  v_mfma_f32_16x16x32_bf16 v[180:183], v[244:247], a[200:203], v[180:183]
  ds_read_b64_tr_b16 v[234:235], v13 offset:17408
  v_fmac_f32 v124, v222, v192
  v_mfma_f32_16x16x32_bf16 v[180:183], v[240:243], a[184:187], v[180:183]
  v_fmac_f32 v125, v222, v193
  v_fmac_f32 v126, v222, v194
  v_mfma_f32_16x16x32_bf16 v[180:183], v[236:239], a[168:171], v[180:183]
  v_fmac_f32 v127, v222, v195
  v_mul_f32 v124, v223, v124
  v_mfma_f32_16x16x32_bf16 v[172:175], v[236:239], a[164:167], v[172:175]
  v_mul_f32 v125, v223, v125
  v_mul_f32 v126, v223, v126
  v_mfma_f32_16x16x32_bf16 v[172:175], v[240:243], a[180:183], v[172:175]
  v_mul_f32 v127, v223, v127
  v_cvt_pk_bf16_f32 v122, v124, v125
  v_mfma_f32_16x16x32_bf16 v[172:175], v[244:247], a[196:199], v[172:175]
  v_cvt_pk_bf16_f32 v123, v126, v127
  v_fmac_f32 v128, v216, v196
  v_mfma_f32_16x16x32_bf16 v[164:167], v[244:247], a[192:195], v[164:167]
  v_fmac_f32 v129, v216, v197
  v_fmac_f32 v130, v216, v198
  v_mfma_f32_16x16x32_bf16 v[164:167], v[240:243], a[176:179], v[164:167]
  v_fmac_f32 v131, v216, v199
  v_mul_f32 v128, v217, v128
  v_mfma_f32_16x16x32_bf16 v[164:167], v[236:239], a[160:163], v[164:167]
  s_waitcnt lgkmcnt(0)
  ds_read_b64_tr_b16 v[236:237], v13 offset:8
  ds_read_b64_tr_b16 v[238:239], v13 offset:1032
  v_mfma_f32_16x16x32_bf16 v[160:163], v[224:227], a[208:211], v[160:163]
  ds_read_b64_tr_b16 v[240:241], v13 offset:8200
  v_mul_f32 v129, v217, v129
  v_mfma_f32_16x16x32_bf16 v[160:163], v[228:231], a[224:227], v[160:163]
  ds_read_b64_tr_b16 v[242:243], v13 offset:9224
  v_mul_f32 v130, v217, v130
  v_mfma_f32_16x16x32_bf16 v[160:163], v[232:235], a[240:243], v[160:163]
  ds_read_b64_tr_b16 v[244:245], v13 offset:16392
  v_mul_f32 v131, v217, v131
  v_mfma_f32_16x16x32_bf16 v[168:171], v[232:235], a[244:247], v[168:171]
  ds_read_b64_tr_b16 v[246:247], v13 offset:17416
  v_cvt_pk_bf16_f32 v128, v128, v129
  v_mfma_f32_16x16x32_bf16 v[168:171], v[228:231], a[228:231], v[168:171]
  v_cvt_pk_bf16_f32 v129, v130, v131
  v_fmac_f32 v136, v218, v196
  v_mfma_f32_16x16x32_bf16 v[168:171], v[224:227], a[212:215], v[168:171]
  v_fmac_f32 v137, v218, v197
  v_fmac_f32 v138, v218, v198
  v_mfma_f32_16x16x32_bf16 v[176:179], v[224:227], a[216:219], v[176:179]
  v_fmac_f32 v139, v218, v199
  v_mul_f32 v136, v219, v136
  v_mfma_f32_16x16x32_bf16 v[176:179], v[228:231], a[232:235], v[176:179]
  v_mul_f32 v137, v219, v137
  v_mul_f32 v138, v219, v138
  v_mfma_f32_16x16x32_bf16 v[176:179], v[232:235], a[248:251], v[176:179]
  v_mul_f32 v139, v219, v139
  v_cvt_pk_bf16_f32 v136, v136, v137
  v_mfma_f32_16x16x32_bf16 v[184:187], v[232:235], a[252:255], v[184:187]
  v_cvt_pk_bf16_f32 v137, v138, v139
  v_fmac_f32 v144, v220, v196
  v_mfma_f32_16x16x32_bf16 v[184:187], v[228:231], a[236:239], v[184:187]
  v_fmac_f32 v145, v220, v197
  v_fmac_f32 v146, v220, v198
  v_mfma_f32_16x16x32_bf16 v[184:187], v[224:227], a[220:223], v[184:187]
  s_waitcnt lgkmcnt(0)
  s_barrier
  v_fmac_f32 v147, v220, v199
  v_mfma_f32_16x16x32_bf16 v[188:191], v[236:239], a[220:223], v[188:191]
  v_mul_f32 v144, v221, v144
  v_mul_f32 v145, v221, v145
  v_mfma_f32_16x16x32_bf16 v[188:191], v[240:243], a[236:239], v[188:191]
  v_mul_f32 v146, v221, v146
  v_mul_f32 v147, v221, v147
  v_mfma_f32_16x16x32_bf16 v[188:191], v[244:247], a[252:255], v[188:191]
  v_cvt_pk_bf16_f32 v144, v144, v145
  v_fmac_f32 v152, v222, v196
  v_mfma_f32_16x16x32_bf16 v[180:183], v[244:247], a[248:251], v[180:183]
  v_cvt_pk_bf16_f32 v145, v146, v147
  v_fmac_f32 v153, v222, v197
  v_mfma_f32_16x16x32_bf16 v[180:183], v[240:243], a[232:235], v[180:183]
  v_fmac_f32 v154, v222, v198
  v_fmac_f32 v155, v222, v199
  v_mfma_f32_16x16x32_bf16 v[180:183], v[236:239], a[216:219], v[180:183]
  v_mul_f32 v152, v223, v152
  v_mul_f32 v153, v223, v153
  v_mfma_f32_16x16x32_bf16 v[172:175], v[236:239], a[212:215], v[172:175]
  v_mul_f32 v154, v223, v154
  v_mul_f32 v155, v223, v155
  v_mfma_f32_16x16x32_bf16 v[172:175], v[240:243], a[228:231], v[172:175]
  ds_read_b128 v[204:207], v251 offset:320
  v_cvt_pk_bf16_f32 v152, v152, v153
  v_mfma_f32_16x16x32_bf16 v[172:175], v[244:247], a[244:247], v[172:175]
  ds_read_b128 v[208:211], v251 offset:384
  v_cvt_pk_bf16_f32 v153, v154, v155
  v_mfma_f32_16x16x32_bf16 v[164:167], v[244:247], a[240:243], v[164:167]
  ds_read_b128 a[160:163], v34 offset:0
  ds_read_b128 v[212:215], v251 offset:448
  v_mfma_f32_16x16x32_bf16 v[164:167], v[240:243], a[224:227], v[164:167]
  ds_read_b128 a[164:167], v35 offset:0
  ds_read_b128 a[168:171], v36 offset:0
  ds_read_b128 a[172:175], v37 offset:0
  v_mfma_f32_16x16x32_bf16 v[164:167], v[236:239], a[208:211], v[164:167]
  s_waitcnt lgkmcnt(6)
  v_pk_fma_f32 v[132:133], v[216:217], v[204:205], v[132:133] op_sel_hi:[0,1,1]
  v_pk_fma_f32 v[134:135], v[216:217], v[206:207], v[134:135] op_sel_hi:[0,1,1]
  v_pk_mul_f32 v[132:133], v[216:217], v[132:133] op_sel:[1,0] op_sel_hi:[1,1]
  v_pk_mul_f32 v[134:135], v[216:217], v[134:135] op_sel:[1,0] op_sel_hi:[1,1]
  v_cvt_pk_bf16_f32 v130, v132, v133
  v_cvt_pk_bf16_f32 v131, v134, v135
  v_pk_fma_f32 v[140:141], v[218:219], v[204:205], v[140:141] op_sel_hi:[0,1,1]
  v_pk_fma_f32 v[142:143], v[218:219], v[206:207], v[142:143] op_sel_hi:[0,1,1]
  v_pk_mul_f32 v[140:141], v[218:219], v[140:141] op_sel:[1,0] op_sel_hi:[1,1]
  v_pk_mul_f32 v[142:143], v[218:219], v[142:143] op_sel:[1,0] op_sel_hi:[1,1]
  v_cvt_pk_bf16_f32 v138, v140, v141
  v_cvt_pk_bf16_f32 v139, v142, v143
  v_pk_fma_f32 v[148:149], v[220:221], v[204:205], v[148:149] op_sel_hi:[0,1,1]
  v_pk_fma_f32 v[150:151], v[220:221], v[206:207], v[150:151] op_sel_hi:[0,1,1]
  v_pk_mul_f32 v[148:149], v[220:221], v[148:149] op_sel:[1,0] op_sel_hi:[1,1]
  v_pk_mul_f32 v[150:151], v[220:221], v[150:151] op_sel:[1,0] op_sel_hi:[1,1]
  v_cvt_pk_bf16_f32 v146, v148, v149
  v_cvt_pk_bf16_f32 v147, v150, v151
  v_pk_fma_f32 v[156:157], v[222:223], v[204:205], v[156:157] op_sel_hi:[0,1,1]
  v_pk_fma_f32 v[158:159], v[222:223], v[206:207], v[158:159] op_sel_hi:[0,1,1]
  v_pk_mul_f32 v[156:157], v[222:223], v[156:157] op_sel:[1,0] op_sel_hi:[1,1]
  v_pk_mul_f32 v[158:159], v[222:223], v[158:159] op_sel:[1,0] op_sel_hi:[1,1]
  v_cvt_pk_bf16_f32 v154, v156, v157
  v_cvt_pk_bf16_f32 v155, v158, v159
  s_waitcnt lgkmcnt(5)
  v_pk_fma_f32 v[160:161], v[216:217], v[208:209], v[160:161] op_sel_hi:[0,1,1]
  v_pk_fma_f32 v[162:163], v[216:217], v[210:211], v[162:163] op_sel_hi:[0,1,1]
  v_pk_mul_f32 v[160:161], v[216:217], v[160:161] op_sel:[1,0] op_sel_hi:[1,1]
  v_pk_mul_f32 v[162:163], v[216:217], v[162:163] op_sel:[1,0] op_sel_hi:[1,1]
  v_cvt_pk_bf16_f32 v160, v160, v161
  v_cvt_pk_bf16_f32 v161, v162, v163
  v_pk_fma_f32 v[168:169], v[218:219], v[208:209], v[168:169] op_sel_hi:[0,1,1]
  v_pk_fma_f32 v[170:171], v[218:219], v[210:211], v[170:171] op_sel_hi:[0,1,1]
  v_pk_mul_f32 v[168:169], v[218:219], v[168:169] op_sel:[1,0] op_sel_hi:[1,1]
  v_pk_mul_f32 v[170:171], v[218:219], v[170:171] op_sel:[1,0] op_sel_hi:[1,1]
  v_cvt_pk_bf16_f32 v168, v168, v169
  v_cvt_pk_bf16_f32 v169, v170, v171
  v_pk_fma_f32 v[176:177], v[220:221], v[208:209], v[176:177] op_sel_hi:[0,1,1]
  v_pk_fma_f32 v[178:179], v[220:221], v[210:211], v[178:179] op_sel_hi:[0,1,1]
  v_pk_mul_f32 v[176:177], v[220:221], v[176:177] op_sel:[1,0] op_sel_hi:[1,1]
  v_pk_mul_f32 v[178:179], v[220:221], v[178:179] op_sel:[1,0] op_sel_hi:[1,1]
  v_cvt_pk_bf16_f32 v176, v176, v177
  v_cvt_pk_bf16_f32 v177, v178, v179
  v_pk_fma_f32 v[184:185], v[222:223], v[208:209], v[184:185] op_sel_hi:[0,1,1]
  v_pk_fma_f32 v[186:187], v[222:223], v[210:211], v[186:187] op_sel_hi:[0,1,1]
  v_pk_mul_f32 v[184:185], v[222:223], v[184:185] op_sel:[1,0] op_sel_hi:[1,1]
  v_pk_mul_f32 v[186:187], v[222:223], v[186:187] op_sel:[1,0] op_sel_hi:[1,1]
  v_cvt_pk_bf16_f32 v184, v184, v185
  v_cvt_pk_bf16_f32 v185, v186, v187
  s_waitcnt lgkmcnt(3)
  v_pk_fma_f32 v[164:165], v[216:217], v[212:213], v[164:165] op_sel_hi:[0,1,1]
  v_pk_fma_f32 v[166:167], v[216:217], v[214:215], v[166:167] op_sel_hi:[0,1,1]
  v_pk_mul_f32 v[164:165], v[216:217], v[164:165] op_sel:[1,0] op_sel_hi:[1,1]
  v_pk_mul_f32 v[166:167], v[216:217], v[166:167] op_sel:[1,0] op_sel_hi:[1,1]
  v_cvt_pk_bf16_f32 v162, v164, v165
  v_cvt_pk_bf16_f32 v163, v166, v167
  v_pk_fma_f32 v[172:173], v[218:219], v[212:213], v[172:173] op_sel_hi:[0,1,1]
  v_pk_fma_f32 v[174:175], v[218:219], v[214:215], v[174:175] op_sel_hi:[0,1,1]
  v_pk_mul_f32 v[172:173], v[218:219], v[172:173] op_sel:[1,0] op_sel_hi:[1,1]
  v_pk_mul_f32 v[174:175], v[218:219], v[174:175] op_sel:[1,0] op_sel_hi:[1,1]
  v_cvt_pk_bf16_f32 v170, v172, v173
  v_cvt_pk_bf16_f32 v171, v174, v175
  v_pk_fma_f32 v[180:181], v[220:221], v[212:213], v[180:181] op_sel_hi:[0,1,1]
  v_pk_fma_f32 v[182:183], v[220:221], v[214:215], v[182:183] op_sel_hi:[0,1,1]
  v_pk_mul_f32 v[180:181], v[220:221], v[180:181] op_sel:[1,0] op_sel_hi:[1,1]
  v_pk_mul_f32 v[182:183], v[220:221], v[182:183] op_sel:[1,0] op_sel_hi:[1,1]
  v_cvt_pk_bf16_f32 v178, v180, v181
  v_cvt_pk_bf16_f32 v179, v182, v183
  v_pk_fma_f32 v[188:189], v[222:223], v[212:213], v[188:189] op_sel_hi:[0,1,1]
  v_pk_fma_f32 v[190:191], v[222:223], v[214:215], v[190:191] op_sel_hi:[0,1,1]
  v_pk_mul_f32 v[188:189], v[222:223], v[188:189] op_sel:[1,0] op_sel_hi:[1,1]
  v_pk_mul_f32 v[190:191], v[222:223], v[190:191] op_sel:[1,0] op_sel_hi:[1,1]
  v_cvt_pk_bf16_f32 v186, v188, v189
  v_cvt_pk_bf16_f32 v187, v190, v191
  v_mfma_f32_16x16x32_bf16 v[68:71], a[160:163], v[64:67], 0
  s_getpc_b64 s[82:83]
att_pc2:
  s_add_u32 s82, s82, att_last-att_pc2
  s_addc_u32 s83, s83, 0
  s_waitcnt lgkmcnt(2)
  v_mfma_f32_16x16x32_bf16 v[68:71], a[164:167], v[96:99], v[68:71]
  s_waitcnt lgkmcnt(1)
  s_bfe_u32 s3, s2, 0x30003
  v_subrev_u32 v3, s77, v48
  v_lshlrev_b32 v60, 2, v0
  v_mfma_f32_16x16x32_bf16 v[68:71], a[168:171], v[128:131], v[68:71]
  s_waitcnt lgkmcnt(0)
  v_subrev_u32 v4, s77, v49
  v_lshl_add_u32 v60, s3, 10, v60
  v_mfma_f32_16x16x32_bf16 v[68:71], a[172:175], v[160:163], v[68:71]
  v_mov_b32 v61, s83
  v_add_co_u32 v60, vcc, s82, v60
  v_mfma_f32_16x16x32_bf16 v[76:79], a[172:175], v[168:171], 0
  v_add_u32 v5, 106496, v3
  v_add_u32 v6, 106496, v4
  v_mfma_f32_16x16x32_bf16 v[76:79], a[168:171], v[136:139], v[76:79]
  v_addc_co_u32 v61, vcc, 0, v61, vcc
  v_mfma_f32_16x16x32_bf16 v[76:79], a[164:167], v[104:107], v[76:79]
  ds_read_b128 a[176:179], v34 offset:4096
  ds_read_b128 a[180:183], v35 offset:4096
  v_mfma_f32_16x16x32_bf16 v[76:79], a[160:163], v[72:75], v[76:79]
  ds_read_b128 a[184:187], v36 offset:4096
  v_max3_f32 v52, v68, v69, v70
  v_mfma_f32_16x16x32_bf16 v[84:87], a[160:163], v[80:83], 0
  ds_read_b128 a[188:191], v37 offset:4096
  v_max_f32 v52, v52, v71
  v_mfma_f32_16x16x32_bf16 v[84:87], a[164:167], v[112:115], v[84:87]
  v_mfma_f32_16x16x32_bf16 v[84:87], a[168:171], v[144:147], v[84:87]
  v_mfma_f32_16x16x32_bf16 v[84:87], a[172:175], v[176:179], v[84:87]
  v_max3_f32 v53, v76, v77, v78
  v_mfma_f32_16x16x32_bf16 v[92:95], a[172:175], v[184:187], 0
  v_max_f32 v53, v53, v79
  v_mfma_f32_16x16x32_bf16 v[92:95], a[168:171], v[152:155], v[92:95]
  v_mfma_f32_16x16x32_bf16 v[92:95], a[164:167], v[120:123], v[92:95]
  v_mfma_f32_16x16x32_bf16 v[92:95], a[160:163], v[88:91], v[92:95]
  s_nop 1
  v_max3_f32 v54, v84, v85, v86
  v_max_f32 v54, v54, v87
  s_nop 3
  v_max3_f32 v55, v92, v93, v94
  v_max_f32 v55, v55, v95
att_restart:
  v_mov_b32 v56, v52
  v_mov_b32 v57, v53
  v_mov_b32 v58, v54
  v_mov_b32 v59, v55
  v_permlane32_swap_b32 v52, v56
  v_permlane32_swap_b32 v53, v57
  v_permlane32_swap_b32 v54, v58
  v_permlane32_swap_b32 v55, v59
  v_max_f32 v52, v52, v56
  v_max_f32 v53, v53, v57
  v_max_f32 v54, v54, v58
  v_max_f32 v55, v55, v59
  v_mov_b32 v56, v52
  v_mov_b32 v57, v53
  v_mov_b32 v58, v54
  v_mov_b32 v59, v55
  v_permlane16_swap_b32 v52, v56
  v_permlane16_swap_b32 v53, v57
  v_permlane16_swap_b32 v54, v58
  v_permlane16_swap_b32 v55, v59
  v_max_f32 v52, v52, v56
  v_max_f32 v53, v53, v57
  v_max_f32 v54, v54, v58
  v_max_f32 v55, v55, v59
  v_mov_b32 v164, 0
  v_mov_b32 v166, 0
  s_mov_b32 s71, 7
  v_sub_f32 v132, 0, v52
  v_sub_f32 v133, 0, v52
  v_sub_f32 v134, 0, v52
  v_sub_f32 v135, 0, v52
  s_waitcnt lgkmcnt(3)
  s_nop 0
  v_mfma_f32_16x16x32_bf16 v[100:103], a[176:179], v[64:67], v[132:135]
  s_waitcnt lgkmcnt(2)
  s_add_u32 m0, s67, 32768
  ds_read_b128 a[160:163], v34 offset:8192
  ds_read_b128 a[164:167], v35 offset:8192
  ds_read_b128 a[168:171], v36 offset:8192
  ds_read_b128 a[172:175], v37 offset:8192
  v_mfma_f32_16x16x32_bf16 v[100:103], a[180:183], v[96:99], v[100:103]
  s_waitcnt lgkmcnt(5)
  v_sub_f32 v68, v68, v52
  v_sub_f32 v69, v69, v52
  v_sub_f32 v70, v70, v52
  v_sub_f32 v71, v71, v52
  v_mfma_f32_16x16x32_bf16 v[100:103], a[184:187], v[128:131], v[100:103]
  s_waitcnt lgkmcnt(4)
  v_sub_f32 v140, 0, v53
  v_sub_f32 v141, 0, v53
  v_sub_f32 v142, 0, v53
  v_sub_f32 v143, 0, v53
  v_exp_f32 v68, v68
  v_exp_f32 v69, v69
  v_mfma_f32_16x16x32_bf16 v[100:103], a[188:191], v[160:163], v[100:103]
  buffer_load_dwordx4 v28, s[20:23], s69 offen offset:0 lds
  v_exp_f32 v70, v70
  v_cvt_pk_bf16_f32 v192, v68, v69
  v_add_f32 v164, v164, v68
  v_mfma_f32_16x16x32_bf16 v[108:111], a[188:191], v[168:171], v[140:143]
  v_sub_f32 v76, v76, v53
  v_exp_f32 v71, v71
  v_add_f32 v164, v164, v69
  v_mfma_f32_16x16x32_bf16 v[108:111], a[184:187], v[136:139], v[108:111]
  v_sub_f32 v77, v77, v53
  v_sub_f32 v78, v78, v53
  v_cvt_pk_bf16_f32 v193, v70, v71
  v_add_f32 v164, v164, v70
  v_mfma_f32_16x16x32_bf16 v[108:111], a[180:183], v[104:107], v[108:111]
  v_sub_f32 v79, v79, v53
  v_sub_f32 v148, 0, v54
  v_sub_f32 v149, 0, v54
  v_sub_f32 v150, 0, v54
  v_sub_f32 v151, 0, v54
  v_exp_f32 v76, v76
  v_add_f32 v164, v164, v71
  v_mfma_f32_16x16x32_bf16 v[108:111], a[176:179], v[72:75], v[108:111]
  v_sub_f32 v84, v84, v54
  v_sub_f32 v85, v85, v54
  v_exp_f32 v77, v77
  v_mfma_f32_16x16x32_bf16 v[116:119], a[176:179], v[80:83], v[148:151]
  buffer_load_dwordx4 v29, s[20:23], s69 offen offset:1024 lds
  v_sub_f32 v86, v86, v54
  v_cvt_pk_bf16_f32 v200, v76, v77
  v_exp_f32 v78, v78
  v_mfma_f32_16x16x32_bf16 v[116:119], a[180:183], v[112:115], v[116:119]
  v_exp_f32 v79, v79
  v_exp_f32 v84, v84
  v_mfma_f32_16x16x32_bf16 v[116:119], a[184:187], v[144:147], v[116:119]
  v_sub_f32 v87, v87, v54
  v_sub_f32 v156, 0, v55
  v_sub_f32 v157, 0, v55
  v_sub_f32 v158, 0, v55
  v_sub_f32 v159, 0, v55
  v_cvt_pk_bf16_f32 v201, v78, v79
  v_exp_f32 v85, v85
  v_mfma_f32_16x16x32_bf16 v[116:119], a[188:191], v[176:179], v[116:119]
  v_cvt_pk_bf16_f32 v208, v84, v85
  v_exp_f32 v86, v86
  v_add_f32 v166, v166, v84
  v_mfma_f32_16x16x32_bf16 v[124:127], a[188:191], v[184:187], v[156:159]
  v_sub_f32 v92, v92, v55
  v_exp_f32 v87, v87
  v_add_f32 v166, v166, v85
  v_mfma_f32_16x16x32_bf16 v[124:127], a[184:187], v[152:155], v[124:127]
  buffer_load_dwordx4 v30, s[20:23], s69 offen offset:2048 lds
  v_sub_f32 v93, v93, v55
  v_sub_f32 v94, v94, v55
  v_cvt_pk_bf16_f32 v209, v86, v87
  v_add_f32 v166, v166, v86
  v_mfma_f32_16x16x32_bf16 v[124:127], a[180:183], v[120:123], v[124:127]
  v_sub_f32 v95, v95, v55
  v_exp_f32 v92, v92
  v_add_f32 v166, v166, v87
  v_mfma_f32_16x16x32_bf16 v[124:127], a[176:179], v[88:91], v[124:127]
  s_waitcnt lgkmcnt(3)
  ds_read_b128 a[176:179], v34 offset:12288
  ds_read_b128 a[180:183], v35 offset:12288
  ds_read_b128 a[184:187], v36 offset:12288
  ds_read_b128 a[188:191], v37 offset:12288
  v_mfma_f32_16x16x32_bf16 v[68:71], a[160:163], v[64:67], v[132:135]
  s_waitcnt lgkmcnt(6)
  v_exp_f32 v93, v93
  v_exp_f32 v94, v94
  v_mfma_f32_16x16x32_bf16 v[68:71], a[164:167], v[96:99], v[68:71]
  s_waitcnt lgkmcnt(5)
  v_cvt_pk_bf16_f32 v216, v92, v93
  v_exp_f32 v95, v95
  v_mfma_f32_16x16x32_bf16 v[68:71], a[168:171], v[128:131], v[68:71]
  s_waitcnt lgkmcnt(4)
  buffer_load_dwordx4 v31, s[20:23], s69 offen offset:3072 lds
  v_cvt_pk_bf16_f32 v217, v94, v95
  v_exp_f32 v100, v100
  v_mfma_f32_16x16x32_bf16 v[68:71], a[172:175], v[160:163], v[68:71]
  s_add_u32 m0, s68, 0
  v_exp_f32 v101, v101
  v_add_f32 v164, v164, v100
  v_mfma_f32_16x16x32_bf16 v[76:79], a[172:175], v[168:171], v[140:143]
  s_add_u32 s69, s69, 16384
  v_cvt_pk_bf16_f32 v194, v100, v101
  v_exp_f32 v102, v102
  v_add_f32 v164, v164, v101
  v_mfma_f32_16x16x32_bf16 v[76:79], a[168:171], v[136:139], v[76:79]
  v_exp_f32 v103, v103
  v_add_f32 v164, v164, v102
  v_mfma_f32_16x16x32_bf16 v[76:79], a[164:167], v[104:107], v[76:79]
  v_cvt_pk_bf16_f32 v195, v102, v103
  v_exp_f32 v108, v108
  v_add_f32 v164, v164, v103
  v_mfma_f32_16x16x32_bf16 v[76:79], a[160:163], v[72:75], v[76:79]
  buffer_load_dwordx4 v32, s[24:27], s70 offen offset:0 lds
  v_exp_f32 v109, v109
  v_exp_f32 v110, v110
  v_mfma_f32_16x16x32_bf16 v[84:87], a[160:163], v[80:83], v[148:151]
  v_cvt_pk_bf16_f32 v202, v108, v109
  v_exp_f32 v111, v111
  v_mfma_f32_16x16x32_bf16 v[84:87], a[164:167], v[112:115], v[84:87]
  v_cvt_pk_bf16_f32 v203, v110, v111
  v_exp_f32 v116, v116
  v_mfma_f32_16x16x32_bf16 v[84:87], a[168:171], v[144:147], v[84:87]
  v_exp_f32 v117, v117
  v_add_f32 v166, v166, v116
  v_mfma_f32_16x16x32_bf16 v[84:87], a[172:175], v[176:179], v[84:87]
  v_cvt_pk_bf16_f32 v210, v116, v117
  v_exp_f32 v118, v118
  v_add_f32 v166, v166, v117
  v_mfma_f32_16x16x32_bf16 v[92:95], a[172:175], v[184:187], v[156:159]
  buffer_load_dwordx4 v33, s[24:27], s70 offen offset:1024 lds
  v_exp_f32 v119, v119
  v_add_f32 v166, v166, v118
  v_mfma_f32_16x16x32_bf16 v[92:95], a[168:171], v[152:155], v[92:95]
  v_cvt_pk_bf16_f32 v211, v118, v119
  v_exp_f32 v124, v124
  v_add_f32 v166, v166, v119
  v_mfma_f32_16x16x32_bf16 v[92:95], a[164:167], v[120:123], v[92:95]
  v_exp_f32 v125, v125
  v_exp_f32 v126, v126
  v_mfma_f32_16x16x32_bf16 v[92:95], a[160:163], v[88:91], v[92:95]
  s_waitcnt lgkmcnt(3)
  v_cvt_pk_bf16_f32 v218, v124, v125
  v_exp_f32 v127, v127
  v_mfma_f32_16x16x32_bf16 v[100:103], a[176:179], v[64:67], v[132:135]
  s_waitcnt lgkmcnt(2)
  v_cvt_pk_bf16_f32 v219, v126, v127
  v_exp_f32 v68, v68
  v_mfma_f32_16x16x32_bf16 v[100:103], a[180:183], v[96:99], v[100:103]
  s_waitcnt lgkmcnt(1)
  buffer_load_dwordx4 v32, s[24:27], s70 offen offset:2048 lds
  v_exp_f32 v69, v69
  v_add_f32 v164, v164, v68
  v_mfma_f32_16x16x32_bf16 v[100:103], a[184:187], v[128:131], v[100:103]
  s_waitcnt lgkmcnt(0)
  v_cvt_pk_bf16_f32 v196, v68, v69
  v_exp_f32 v70, v70
  v_add_f32 v164, v164, v69
  v_mfma_f32_16x16x32_bf16 v[100:103], a[188:191], v[160:163], v[100:103]
  v_exp_f32 v71, v71
  v_add_f32 v164, v164, v70
  v_mfma_f32_16x16x32_bf16 v[108:111], a[188:191], v[168:171], v[140:143]
  v_cvt_pk_bf16_f32 v197, v70, v71
  v_exp_f32 v76, v76
  v_add_f32 v164, v164, v71
  v_mfma_f32_16x16x32_bf16 v[108:111], a[184:187], v[136:139], v[108:111]
  v_exp_f32 v77, v77
  v_exp_f32 v78, v78
  v_mfma_f32_16x16x32_bf16 v[108:111], a[180:183], v[104:107], v[108:111]
  buffer_load_dwordx4 v33, s[24:27], s70 offen offset:3072 lds
  v_cvt_pk_bf16_f32 v204, v76, v77
  v_exp_f32 v79, v79
  v_mfma_f32_16x16x32_bf16 v[108:111], a[176:179], v[72:75], v[108:111]
  s_add_u32 s70, s70, 16384
  v_cvt_pk_bf16_f32 v205, v78, v79
  v_exp_f32 v84, v84
  v_mfma_f32_16x16x32_bf16 v[116:119], a[176:179], v[80:83], v[148:151]
  v_exp_f32 v85, v85
  v_add_f32 v166, v166, v84
  v_mfma_f32_16x16x32_bf16 v[116:119], a[180:183], v[112:115], v[116:119]
  v_cvt_pk_bf16_f32 v212, v84, v85
  v_exp_f32 v86, v86
  v_add_f32 v166, v166, v85
  v_mfma_f32_16x16x32_bf16 v[116:119], a[184:187], v[144:147], v[116:119]
  s_waitcnt vmcnt(8)
  s_barrier
  s_cmp_eq_u32 s55, 0
  s_cbranch_scc0 sigd_x
  v_mov_b32 v58, 1
  s_mov_b64 exec, 1
  buffer_atomic_add v58, off, s[4:7], s58 sc1
  s_mov_b64 exec, -1
  s_nop 3
sigd_x:
  ds_read_b128 a[160:163], v34 offset:16384
  v_mfma_f32_16x16x32_bf16 v[116:119], a[188:191], v[176:179], v[116:119]
  s_add_u32 m0, s67, 49152
  ds_read_b128 a[164:167], v35 offset:16384
  ds_read_b128 a[168:171], v36 offset:16384
  ds_read_b128 a[172:175], v37 offset:16384
  ds_read_b64_tr_b16 a[192:193], v38 offset:49152
  v_mfma_f32_16x16x32_bf16 v[124:127], a[188:191], v[184:187], v[156:159]
  buffer_load_dwordx4 v28, s[20:23], s69 offen offset:0 lds
  ds_read_b64_tr_b16 a[194:195], v38 offset:53248
  ds_read_b64_tr_b16 a[196:197], v38 offset:57344
  v_mfma_f32_16x16x32_bf16 v[124:127], a[184:187], v[152:155], v[124:127]
  ds_read_b64_tr_b16 a[198:199], v38 offset:61440
  ds_read_b64_tr_b16 a[200:201], v39 offset:49152
  v_exp_f32 v87, v87
  v_mfma_f32_16x16x32_bf16 v[124:127], a[180:183], v[120:123], v[124:127]
  v_cvt_pk_bf16_f32 v213, v86, v87
  v_exp_f32 v92, v92
  v_add_f32 v166, v166, v86
  v_mfma_f32_16x16x32_bf16 v[124:127], a[176:179], v[88:91], v[124:127]
  s_waitcnt lgkmcnt(8)
  v_exp_f32 v93, v93
  v_add_f32 v166, v166, v87
  v_exp_f32 v94, v94
  v_cvt_pk_bf16_f32 v220, v92, v93
  v_exp_f32 v95, v95
  s_nop 0
  v_cvt_pk_bf16_f32 v221, v94, v95
  v_exp_f32 v100, v100
  s_nop 0
  v_add_f32 v164, v164, v100
  v_exp_f32 v101, v101
  s_nop 0
  v_cvt_pk_bf16_f32 v198, v100, v101
  v_exp_f32 v102, v102
  v_add_f32 v164, v164, v101
  v_exp_f32 v103, v103
  v_add_f32 v164, v164, v102
  v_cvt_pk_bf16_f32 v199, v102, v103
  v_exp_f32 v108, v108
  v_add_f32 v164, v164, v103
  v_exp_f32 v109, v109
  s_nop 0
  v_cvt_pk_bf16_f32 v206, v108, v109
  v_exp_f32 v110, v110
  v_exp_f32 v111, v111
  v_exp_f32 v116, v116
  v_cvt_pk_bf16_f32 v207, v110, v111
  v_exp_f32 v117, v117
  s_nop 0
  v_cvt_pk_bf16_f32 v214, v116, v117
  v_exp_f32 v118, v118
  v_exp_f32 v119, v119
  s_nop 0
  v_cvt_pk_bf16_f32 v215, v118, v119
  v_exp_f32 v124, v124
  v_mfma_f32_16x16x32_bf16 v[68:71], a[160:163], v[64:67], v[132:135]
  s_waitcnt lgkmcnt(7)
  v_exp_f32 v125, v125
  v_mfma_f32_16x16x32_bf16 v[68:71], a[164:167], v[96:99], v[68:71]
  s_waitcnt lgkmcnt(6)
  buffer_load_dwordx4 v29, s[20:23], s69 offen offset:1024 lds
  v_mfma_f32_16x16x32_bf16 v[68:71], a[168:171], v[128:131], v[68:71]
  s_waitcnt lgkmcnt(5)
  v_exp_f32 v126, v126
  v_mfma_f32_16x16x32_bf16 v[68:71], a[172:175], v[160:163], v[68:71]
  ds_read_b64_tr_b16 a[202:203], v39 offset:53248
  v_cvt_pk_bf16_f32 v222, v124, v125
  v_mfma_f32_16x16x32_bf16 v[76:79], a[172:175], v[168:171], v[140:143]
  v_exp_f32 v127, v127
  v_mfma_f32_16x16x32_bf16 v[76:79], a[168:171], v[136:139], v[76:79]
  ds_read_b64_tr_b16 a[204:205], v39 offset:57344
  v_cvt_pk_bf16_f32 v223, v126, v127
  v_mfma_f32_16x16x32_bf16 v[76:79], a[164:167], v[104:107], v[76:79]
  ds_read_b64_tr_b16 a[206:207], v39 offset:61440
  v_add_f32 v166, v166, v116
  v_mfma_f32_16x16x32_bf16 v[76:79], a[160:163], v[72:75], v[76:79]
  v_exp_f32 v68, v68
  v_mfma_f32_16x16x32_bf16 v[84:87], a[160:163], v[80:83], v[148:151]
  ds_read_b128 a[176:179], v34 offset:20480
  v_add_f32 v166, v166, v117
  v_mfma_f32_16x16x32_bf16 v[84:87], a[164:167], v[112:115], v[84:87]
  v_exp_f32 v69, v69
  v_mfma_f32_16x16x32_bf16 v[84:87], a[168:171], v[144:147], v[84:87]
  v_add_f32 v166, v166, v118
  v_cvt_pk_bf16_f32 v224, v68, v69
  v_mfma_f32_16x16x32_bf16 v[84:87], a[172:175], v[176:179], v[84:87]
  v_exp_f32 v70, v70
  v_mfma_f32_16x16x32_bf16 v[92:95], a[172:175], v[184:187], v[156:159]
  buffer_load_dwordx4 v30, s[20:23], s69 offen offset:2048 lds
  v_mfma_f32_16x16x32_bf16 v[92:95], a[168:171], v[152:155], v[92:95]
  v_exp_f32 v71, v71
  v_mfma_f32_16x16x32_bf16 v[92:95], a[164:167], v[120:123], v[92:95]
  v_add_f32 v166, v166, v119
  v_cvt_pk_bf16_f32 v225, v70, v71
  v_mfma_f32_16x16x32_bf16 v[92:95], a[160:163], v[88:91], v[92:95]
  s_waitcnt lgkmcnt(7)
  v_exp_f32 v76, v76
  v_mfma_f32_16x16x32_bf16 a[0:3], a[192:195], v[192:195], 0
  s_waitcnt lgkmcnt(5)
  ds_read_b128 a[180:183], v35 offset:20480
  ds_read_b128 a[184:187], v36 offset:20480
  v_mfma_f32_16x16x32_bf16 a[0:3], a[196:199], v[196:199], a[0:3]
  v_exp_f32 v77, v77
  v_mfma_f32_16x16x32_bf16 a[4:7], a[196:199], v[204:207], 0
  ds_read_b128 a[188:191], v37 offset:20480
  v_cvt_pk_bf16_f32 v232, v76, v77
  v_mfma_f32_16x16x32_bf16 a[4:7], a[192:195], v[200:203], a[4:7]
  v_exp_f32 v78, v78
  v_mfma_f32_16x16x32_bf16 a[8:11], a[192:195], v[208:211], 0
  ds_read_b64_tr_b16 a[208:209], v40 offset:49152
  v_add_f32 v164, v164, v68
  v_mfma_f32_16x16x32_bf16 a[8:11], a[196:199], v[212:215], a[8:11]
  v_exp_f32 v79, v79
  v_mfma_f32_16x16x32_bf16 a[12:15], a[196:199], v[220:223], 0
  v_add_f32 v164, v164, v69
  v_cvt_pk_bf16_f32 v233, v78, v79
  v_mfma_f32_16x16x32_bf16 a[12:15], a[192:195], v[216:219], a[12:15]
  s_waitcnt lgkmcnt(7)
  v_exp_f32 v84, v84
  v_mfma_f32_16x16x32_bf16 a[28:31], a[200:203], v[216:219], 0
  s_waitcnt lgkmcnt(5)
  buffer_load_dwordx4 v31, s[20:23], s69 offen offset:3072 lds
  v_mfma_f32_16x16x32_bf16 a[28:31], a[204:207], v[220:223], a[28:31]
  s_add_u32 s69, s69, 16384
  v_exp_f32 v85, v85
  v_mfma_f32_16x16x32_bf16 a[24:27], a[204:207], v[212:215], 0
  v_add_f32 v164, v164, v70
  v_cvt_pk_bf16_f32 v240, v84, v85
  v_mfma_f32_16x16x32_bf16 a[24:27], a[200:203], v[208:211], a[24:27]
  v_exp_f32 v86, v86
  v_mfma_f32_16x16x32_bf16 a[20:23], a[200:203], v[200:203], 0
  ds_read_b64_tr_b16 a[210:211], v40 offset:53248
  v_add_f32 v164, v164, v71
  v_mfma_f32_16x16x32_bf16 a[20:23], a[204:207], v[204:207], a[20:23]
  v_exp_f32 v87, v87
  v_mfma_f32_16x16x32_bf16 a[16:19], a[204:207], v[196:199], 0
  ds_read_b64_tr_b16 a[212:213], v40 offset:57344
  v_cvt_pk_bf16_f32 v241, v86, v87
  v_mfma_f32_16x16x32_bf16 a[16:19], a[200:203], v[192:195], a[16:19]
  s_waitcnt lgkmcnt(6)
  v_exp_f32 v92, v92
  v_mfma_f32_16x16x32_bf16 v[100:103], a[176:179], v[64:67], v[132:135]
  s_waitcnt lgkmcnt(5)
  ds_read_b64_tr_b16 a[214:215], v40 offset:61440
  ds_read_b64_tr_b16 a[216:217], v41 offset:49152
  v_mfma_f32_16x16x32_bf16 v[100:103], a[180:183], v[96:99], v[100:103]
  s_waitcnt lgkmcnt(6)
  v_exp_f32 v93, v93
  v_mfma_f32_16x16x32_bf16 v[100:103], a[184:187], v[128:131], v[100:103]
  s_waitcnt lgkmcnt(5)
  ds_read_b64_tr_b16 a[218:219], v41 offset:53248
  v_cvt_pk_bf16_f32 v248, v92, v93
  v_mfma_f32_16x16x32_bf16 v[100:103], a[188:191], v[160:163], v[100:103]
  s_add_u32 m0, s68, 16384
  v_exp_f32 v94, v94
  v_mfma_f32_16x16x32_bf16 v[108:111], a[188:191], v[168:171], v[140:143]
pad_m_4:
  s_cbranch_execz warm_1
  buffer_load_dwordx4 v32, s[24:27], s70 offen offset:0 lds
  v_mfma_f32_16x16x32_bf16 v[108:111], a[184:187], v[136:139], v[108:111]
  v_exp_f32 v95, v95
  v_mfma_f32_16x16x32_bf16 v[108:111], a[180:183], v[104:107], v[108:111]
  ds_read_b64_tr_b16 a[220:221], v41 offset:57344
  v_cvt_pk_bf16_f32 v249, v94, v95
  v_mfma_f32_16x16x32_bf16 v[108:111], a[176:179], v[72:75], v[108:111]
  v_exp_f32 v100, v100
  v_mfma_f32_16x16x32_bf16 v[116:119], a[176:179], v[80:83], v[148:151]
  ds_read_b64_tr_b16 a[222:223], v41 offset:61440
  v_add_f32 v166, v166, v84
  v_mfma_f32_16x16x32_bf16 v[116:119], a[180:183], v[112:115], v[116:119]
  v_exp_f32 v101, v101
  v_mfma_f32_16x16x32_bf16 v[116:119], a[184:187], v[144:147], v[116:119]
  v_add_f32 v166, v166, v85
  v_cvt_pk_bf16_f32 v226, v100, v101
  v_mfma_f32_16x16x32_bf16 v[116:119], a[188:191], v[176:179], v[116:119]
  v_exp_f32 v102, v102
  v_mfma_f32_16x16x32_bf16 v[124:127], a[188:191], v[184:187], v[156:159]
  ds_read_b128 a[160:163], v34 offset:24576
  v_add_f32 v166, v166, v86
  v_mfma_f32_16x16x32_bf16 v[124:127], a[184:187], v[152:155], v[124:127]
  v_exp_f32 v103, v103
  v_mfma_f32_16x16x32_bf16 v[124:127], a[180:183], v[120:123], v[124:127]
  v_add_f32 v166, v166, v87
  v_cvt_pk_bf16_f32 v227, v102, v103
  v_mfma_f32_16x16x32_bf16 v[124:127], a[176:179], v[88:91], v[124:127]
  s_waitcnt lgkmcnt(7)
  v_exp_f32 v108, v108
  v_mfma_f32_16x16x32_bf16 a[32:35], a[208:211], v[192:195], 0
  s_waitcnt lgkmcnt(5)
  buffer_load_dwordx4 v33, s[24:27], s70 offen offset:1024 lds
  v_mfma_f32_16x16x32_bf16 a[32:35], a[212:215], v[196:199], a[32:35]
  v_exp_f32 v109, v109
  v_mfma_f32_16x16x32_bf16 a[36:39], a[212:215], v[204:207], 0
  ds_read_b128 a[164:167], v35 offset:24576
  v_cvt_pk_bf16_f32 v234, v108, v109
  v_mfma_f32_16x16x32_bf16 a[36:39], a[208:211], v[200:203], a[36:39]
  v_exp_f32 v110, v110
  v_mfma_f32_16x16x32_bf16 a[40:43], a[208:211], v[208:211], 0
  ds_read_b128 a[168:171], v36 offset:24576
  ds_read_b128 a[172:175], v37 offset:24576
  v_mfma_f32_16x16x32_bf16 a[40:43], a[212:215], v[212:215], a[40:43]
  v_exp_f32 v111, v111
  v_mfma_f32_16x16x32_bf16 a[44:47], a[212:215], v[220:223], 0
  v_add_f32 v164, v164, v100
  v_cvt_pk_bf16_f32 v235, v110, v111
  v_mfma_f32_16x16x32_bf16 a[44:47], a[208:211], v[216:219], a[44:47]
  s_waitcnt lgkmcnt(6)
  ds_read_b64_tr_b16 a[192:193], v42 offset:49152
  v_add_f32 v164, v164, v101
  v_mfma_f32_16x16x32_bf16 a[60:63], a[216:219], v[216:219], 0
  s_waitcnt lgkmcnt(5)
  v_exp_f32 v116, v116
  v_mfma_f32_16x16x32_bf16 a[60:63], a[220:223], v[220:223], a[60:63]
  ds_read_b64_tr_b16 a[194:195], v42 offset:53248
  v_add_f32 v164, v164, v102
  v_mfma_f32_16x16x32_bf16 a[56:59], a[220:223], v[212:215], 0
  v_exp_f32 v117, v117
  v_mfma_f32_16x16x32_bf16 a[56:59], a[216:219], v[208:211], a[56:59]
  v_add_f32 v164, v164, v103
  v_cvt_pk_bf16_f32 v242, v116, v117
  v_mfma_f32_16x16x32_bf16 a[52:55], a[216:219], v[200:203], 0
  v_exp_f32 v118, v118
  v_mfma_f32_16x16x32_bf16 a[52:55], a[220:223], v[204:207], a[52:55]
  buffer_load_dwordx4 v32, s[24:27], s70 offen offset:2048 lds
  v_mfma_f32_16x16x32_bf16 a[48:51], a[220:223], v[196:199], 0
  v_exp_f32 v119, v119
  v_mfma_f32_16x16x32_bf16 a[48:51], a[216:219], v[192:195], a[48:51]
  ds_read_b64_tr_b16 a[196:197], v42 offset:57344
  v_cvt_pk_bf16_f32 v243, v118, v119
  v_mfma_f32_16x16x32_bf16 a[132:135], a[144:147], v[200:203], 0
  v_exp_f32 v124, v124
  v_mfma_f32_16x16x32_bf16 a[132:135], a[144:147], v[204:207], a[132:135]
  s_waitcnt lgkmcnt(6)
  ds_read_b64_tr_b16 a[198:199], v42 offset:61440
  ds_read_b64_tr_b16 a[200:201], v43 offset:49152
  v_mfma_f32_16x16x32_bf16 v[68:71], a[160:163], v[64:67], v[132:135]
  s_waitcnt lgkmcnt(7)
  v_exp_f32 v125, v125
  v_mfma_f32_16x16x32_bf16 v[68:71], a[164:167], v[96:99], v[68:71]
  s_waitcnt lgkmcnt(6)
  ds_read_b64_tr_b16 a[202:203], v43 offset:53248
  v_cvt_pk_bf16_f32 v250, v124, v125
  v_mfma_f32_16x16x32_bf16 v[68:71], a[168:171], v[128:131], v[68:71]
  s_waitcnt lgkmcnt(6)
  v_exp_f32 v126, v126
  v_mfma_f32_16x16x32_bf16 v[68:71], a[172:175], v[160:163], v[68:71]
  ds_read_b64_tr_b16 a[204:205], v43 offset:57344
  ds_read_b64_tr_b16 a[206:207], v43 offset:61440
  v_mfma_f32_16x16x32_bf16 v[76:79], a[172:175], v[168:171], v[140:143]
  v_exp_f32 v127, v127
  v_mfma_f32_16x16x32_bf16 v[76:79], a[168:171], v[136:139], v[76:79]
  v_add_f32 v166, v166, v116
  v_cvt_pk_bf16_f32 v251, v126, v127
  v_mfma_f32_16x16x32_bf16 v[76:79], a[164:167], v[104:107], v[76:79]
  buffer_load_dwordx4 v33, s[24:27], s70 offen offset:3072 lds
  v_mfma_f32_16x16x32_bf16 v[76:79], a[160:163], v[72:75], v[76:79]
  s_add_u32 s70, s70, 16384
  v_exp_f32 v68, v68
  v_mfma_f32_16x16x32_bf16 v[84:87], a[160:163], v[80:83], v[148:151]
  ds_read_b128 a[176:179], v34 offset:28672
  v_add_f32 v166, v166, v117
  v_mfma_f32_16x16x32_bf16 v[84:87], a[164:167], v[112:115], v[84:87]
  v_exp_f32 v69, v69
  v_mfma_f32_16x16x32_bf16 v[84:87], a[168:171], v[144:147], v[84:87]
  v_add_f32 v166, v166, v118
  v_cvt_pk_bf16_f32 v228, v68, v69
  v_mfma_f32_16x16x32_bf16 v[84:87], a[172:175], v[176:179], v[84:87]
  v_exp_f32 v70, v70
  v_mfma_f32_16x16x32_bf16 v[92:95], a[172:175], v[184:187], v[156:159]
  ds_read_b128 a[180:183], v35 offset:28672
  v_add_f32 v166, v166, v119
  v_mfma_f32_16x16x32_bf16 v[92:95], a[168:171], v[152:155], v[92:95]
  v_exp_f32 v71, v71
  v_mfma_f32_16x16x32_bf16 v[92:95], a[164:167], v[120:123], v[92:95]
  ds_read_b128 a[184:187], v36 offset:28672
  v_cvt_pk_bf16_f32 v229, v70, v71
  v_mfma_f32_16x16x32_bf16 v[92:95], a[160:163], v[88:91], v[92:95]
  s_waitcnt lgkmcnt(9)
  v_exp_f32 v76, v76
  v_mfma_f32_16x16x32_bf16 a[64:67], a[192:195], v[192:195], 0
  s_waitcnt lgkmcnt(7)
  ds_read_b128 a[188:191], v37 offset:28672
  v_add_f32 v164, v164, v68
  v_mfma_f32_16x16x32_bf16 a[64:67], a[196:199], v[196:199], a[64:67]
  v_exp_f32 v77, v77
  v_mfma_f32_16x16x32_bf16 a[68:71], a[196:199], v[204:207], 0
  v_add_f32 v164, v164, v69
  v_cvt_pk_bf16_f32 v236, v76, v77
  v_mfma_f32_16x16x32_bf16 a[68:71], a[192:195], v[200:203], a[68:71]
  s_mov_b32 m0, s77
  v_exp_f32 v78, v78
  v_mfma_f32_16x16x32_bf16 a[72:75], a[192:195], v[208:211], 0
  ds_read_b64_tr_b16 a[208:209], v44 offset:49152
  v_add_f32 v164, v164, v70
  v_mfma_f32_16x16x32_bf16 a[72:75], a[196:199], v[212:215], a[72:75]
  v_exp_f32 v79, v79
  v_mfma_f32_16x16x32_bf16 a[76:79], a[196:199], v[220:223], 0
  buffer_load_dwordx4 v46, s[28:31], s99 offen offset:0 lds
  v_mfma_f32_16x16x32_bf16 a[76:79], a[192:195], v[216:219], a[76:79]
  s_waitcnt lgkmcnt(7)
  v_exp_f32 v84, v84
  v_mfma_f32_16x16x32_bf16 a[92:95], a[200:203], v[216:219], 0
  s_waitcnt lgkmcnt(5)
  ds_read_b64_tr_b16 a[210:211], v44 offset:53248
  v_cvt_pk_bf16_f32 v237, v78, v79
  v_mfma_f32_16x16x32_bf16 a[92:95], a[204:207], v[220:223], a[92:95]
  v_exp_f32 v85, v85
  v_mfma_f32_16x16x32_bf16 a[88:91], a[204:207], v[212:215], 0
  v_add_f32 v164, v164, v71
  v_cvt_pk_bf16_f32 v244, v84, v85
  v_mfma_f32_16x16x32_bf16 a[88:91], a[200:203], v[208:211], a[88:91]
  v_exp_f32 v86, v86
  v_mfma_f32_16x16x32_bf16 a[84:87], a[200:203], v[200:203], 0
  ds_read_b64_tr_b16 a[212:213], v44 offset:57344
  ds_read_b64_tr_b16 a[214:215], v44 offset:61440
  v_mfma_f32_16x16x32_bf16 a[84:87], a[204:207], v[204:207], a[84:87]
  v_exp_f32 v87, v87
  v_mfma_f32_16x16x32_bf16 a[80:83], a[204:207], v[196:199], 0
  ds_read_b64_tr_b16 a[216:217], v45 offset:49152
  v_cvt_pk_bf16_f32 v245, v86, v87
  v_mfma_f32_16x16x32_bf16 a[80:83], a[200:203], v[192:195], a[80:83]
  s_waitcnt lgkmcnt(8)
  v_exp_f32 v92, v92
  v_mfma_f32_16x16x32_bf16 v[100:103], a[176:179], v[64:67], v[132:135]
  s_waitcnt lgkmcnt(7)
  ds_read_b64_tr_b16 a[218:219], v45 offset:53248
  ds_read_b64_tr_b16 a[220:221], v45 offset:57344
  v_mfma_f32_16x16x32_bf16 v[100:103], a[180:183], v[96:99], v[100:103]
  s_waitcnt lgkmcnt(8)
  v_exp_f32 v93, v93
  v_mfma_f32_16x16x32_bf16 v[100:103], a[184:187], v[128:131], v[100:103]
  s_waitcnt lgkmcnt(7)
  buffer_load_dwordx4 v47, s[28:31], s99 offen offset:1024 lds
  v_mfma_f32_16x16x32_bf16 v[100:103], a[188:191], v[160:163], v[100:103]
  s_add_u32 s99, s99, s101
  v_exp_f32 v94, v94
  v_mfma_f32_16x16x32_bf16 v[108:111], a[188:191], v[168:171], v[140:143]
  ds_read_b64_tr_b16 a[222:223], v45 offset:61440
  v_cvt_pk_bf16_f32 v252, v92, v93
  v_mfma_f32_16x16x32_bf16 v[108:111], a[184:187], v[136:139], v[108:111]
  v_exp_f32 v95, v95
  v_mfma_f32_16x16x32_bf16 v[108:111], a[180:183], v[104:107], v[108:111]
  v_add_f32 v166, v166, v84
  v_cvt_pk_bf16_f32 v253, v94, v95
  v_mfma_f32_16x16x32_bf16 v[108:111], a[176:179], v[72:75], v[108:111]
  v_exp_f32 v100, v100
  v_mfma_f32_16x16x32_bf16 v[116:119], a[176:179], v[80:83], v[148:151]
  v_add_f32 v166, v166, v85
  v_add_f32 v164, v164, v100
  v_mfma_f32_16x16x32_bf16 v[116:119], a[180:183], v[112:115], v[116:119]
  v_exp_f32 v101, v101
  v_mfma_f32_16x16x32_bf16 v[116:119], a[184:187], v[144:147], v[116:119]
  v_add_f32 v166, v166, v86
  v_cvt_pk_bf16_f32 v230, v100, v101
  v_mfma_f32_16x16x32_bf16 v[116:119], a[188:191], v[176:179], v[116:119]
  v_exp_f32 v102, v102
  v_mfma_f32_16x16x32_bf16 v[124:127], a[188:191], v[184:187], v[156:159]
  v_add_f32 v166, v166, v87
  v_add_f32 v164, v164, v101
  v_mfma_f32_16x16x32_bf16 v[124:127], a[184:187], v[152:155], v[124:127]
  v_exp_f32 v103, v103
  v_mfma_f32_16x16x32_bf16 v[124:127], a[180:183], v[120:123], v[124:127]
  v_add_f32 v164, v164, v102
  v_cvt_pk_bf16_f32 v231, v102, v103
  v_mfma_f32_16x16x32_bf16 v[124:127], a[176:179], v[88:91], v[124:127]
  s_waitcnt lgkmcnt(6)
  v_exp_f32 v108, v108
  v_mfma_f32_16x16x32_bf16 a[96:99], a[208:211], v[192:195], 0
  s_waitcnt lgkmcnt(4)
  v_add_f32 v164, v164, v103
  v_mfma_f32_16x16x32_bf16 a[96:99], a[212:215], v[196:199], a[96:99]
  v_exp_f32 v109, v109
  v_mfma_f32_16x16x32_bf16 a[100:103], a[212:215], v[204:207], 0
  v_cvt_pk_bf16_f32 v238, v108, v109
  v_mfma_f32_16x16x32_bf16 a[100:103], a[208:211], v[200:203], a[100:103]
  v_exp_f32 v110, v110
  v_mfma_f32_16x16x32_bf16 a[104:107], a[208:211], v[208:211], 0
  s_waitcnt vmcnt(10)
  s_barrier
  ds_read_b128 a[160:163], v34 offset:32768
  v_mfma_f32_16x16x32_bf16 a[104:107], a[212:215], v[212:215], a[104:107]
  s_add_u32 m0, s67, 0
  v_exp_f32 v111, v111
  v_mfma_f32_16x16x32_bf16 a[108:111], a[212:215], v[220:223], 0
  buffer_load_dwordx4 v28, s[20:23], s69 offen offset:0 lds
  v_mfma_f32_16x16x32_bf16 a[108:111], a[208:211], v[216:219], a[108:111]
  s_waitcnt lgkmcnt(3)
  ds_read_b128 a[164:167], v35 offset:32768
  ds_read_b128 a[168:171], v36 offset:32768
  v_mfma_f32_16x16x32_bf16 a[124:127], a[216:219], v[216:219], 0
  s_waitcnt lgkmcnt(3)
  v_exp_f32 v116, v116
  v_mfma_f32_16x16x32_bf16 a[124:127], a[220:223], v[220:223], a[124:127]
  ds_read_b128 a[172:175], v37 offset:32768
  v_cvt_pk_bf16_f32 v239, v110, v111
  v_mfma_f32_16x16x32_bf16 a[120:123], a[220:223], v[212:215], 0
  v_exp_f32 v117, v117
  v_mfma_f32_16x16x32_bf16 a[120:123], a[216:219], v[208:211], a[120:123]
  ds_read_b64_tr_b16 a[192:193], v38 offset:0
  v_cvt_pk_bf16_f32 v246, v116, v117
  v_mfma_f32_16x16x32_bf16 a[116:119], a[216:219], v[200:203], 0
  v_exp_f32 v118, v118
  v_mfma_f32_16x16x32_bf16 a[116:119], a[220:223], v[204:207], a[116:119]
  ds_read_b64_tr_b16 a[194:195], v38 offset:4096
  ds_read_b64_tr_b16 a[196:197], v38 offset:8192
  v_mfma_f32_16x16x32_bf16 a[112:115], a[220:223], v[196:199], 0
  v_exp_f32 v119, v119
  v_mfma_f32_16x16x32_bf16 a[112:115], a[216:219], v[192:195], a[112:115]
  ds_read_b64_tr_b16 a[198:199], v38 offset:12288
  v_cvt_pk_bf16_f32 v247, v118, v119
  v_mfma_f32_16x16x32_bf16 a[140:143], a[144:147], v[216:219], 0
  v_exp_f32 v124, v124
  v_mfma_f32_16x16x32_bf16 a[140:143], a[144:147], v[220:223], a[140:143]
  ds_read_b64_tr_b16 a[200:201], v39 offset:0
  ds_read_b64_tr_b16 a[202:203], v39 offset:4096
  s_branch att_loop_b
.p2align 6
att_loop:
  s_waitcnt lgkmcnt(8)
  v_mfma_f32_16x16x32_bf16 v[68:71], a[160:163], v[64:67], v[132:135]
  s_waitcnt lgkmcnt(7)
  v_exp_f32 v125, v125
  v_mfma_f32_16x16x32_bf16 v[68:71], a[164:167], v[96:99], v[68:71]
  s_waitcnt lgkmcnt(6)
  buffer_load_dwordx4 v29, s[20:23], s69 offen offset:1024 lds
  v_mfma_f32_16x16x32_bf16 v[68:71], a[168:171], v[128:131], v[68:71]
  s_waitcnt lgkmcnt(5)
  v_exp_f32 v126, v126
  v_mfma_f32_16x16x32_bf16 v[68:71], a[172:175], v[160:163], v[68:71]
  ds_read_b64_tr_b16 a[202:203], v39 offset:53248
  v_cvt_pk_bf16_f32 v222, v124, v125
  v_mfma_f32_16x16x32_bf16 v[76:79], a[172:175], v[168:171], v[140:143]
  v_exp_f32 v127, v127
  v_mfma_f32_16x16x32_bf16 v[76:79], a[168:171], v[136:139], v[76:79]
  ds_read_b64_tr_b16 a[204:205], v39 offset:57344
  v_cvt_pk_bf16_f32 v223, v126, v127
  v_mfma_f32_16x16x32_bf16 v[76:79], a[164:167], v[104:107], v[76:79]
  ds_read_b64_tr_b16 a[206:207], v39 offset:61440
  v_add_f32 v166, v166, v116
  v_mfma_f32_16x16x32_bf16 v[76:79], a[160:163], v[72:75], v[76:79]
  v_exp_f32 v68, v68
  v_mfma_f32_16x16x32_bf16 v[84:87], a[160:163], v[80:83], v[148:151]
  ds_read_b128 a[176:179], v34 offset:20480
  v_add_f32 v166, v166, v117
  v_mfma_f32_16x16x32_bf16 v[84:87], a[164:167], v[112:115], v[84:87]
  v_exp_f32 v69, v69
  v_mfma_f32_16x16x32_bf16 v[84:87], a[168:171], v[144:147], v[84:87]
  v_add_f32 v166, v166, v118
  v_cvt_pk_bf16_f32 v224, v68, v69
  v_mfma_f32_16x16x32_bf16 v[84:87], a[172:175], v[176:179], v[84:87]
  v_exp_f32 v70, v70
  v_mfma_f32_16x16x32_bf16 v[92:95], a[172:175], v[184:187], v[156:159]
  buffer_load_dwordx4 v30, s[20:23], s69 offen offset:2048 lds
  v_mfma_f32_16x16x32_bf16 v[92:95], a[168:171], v[152:155], v[92:95]
  v_exp_f32 v71, v71
  v_mfma_f32_16x16x32_bf16 v[92:95], a[164:167], v[120:123], v[92:95]
  v_add_f32 v166, v166, v119
  v_cvt_pk_bf16_f32 v225, v70, v71
  v_mfma_f32_16x16x32_bf16 v[92:95], a[160:163], v[88:91], v[92:95]
  s_waitcnt lgkmcnt(7)
  v_exp_f32 v76, v76
  v_mfma_f32_16x16x32_bf16 a[0:3], a[192:195], v[192:195], a[0:3]
  s_waitcnt lgkmcnt(5)
  ds_read_b128 a[180:183], v35 offset:20480
  ds_read_b128 a[184:187], v36 offset:20480
  v_mfma_f32_16x16x32_bf16 a[0:3], a[196:199], v[196:199], a[0:3]
  v_exp_f32 v77, v77
  v_mfma_f32_16x16x32_bf16 a[4:7], a[196:199], v[204:207], a[4:7]
  ds_read_b128 a[188:191], v37 offset:20480
  v_cvt_pk_bf16_f32 v232, v76, v77
  v_mfma_f32_16x16x32_bf16 a[4:7], a[192:195], v[200:203], a[4:7]
  v_exp_f32 v78, v78
  v_mfma_f32_16x16x32_bf16 a[8:11], a[192:195], v[208:211], a[8:11]
  ds_read_b64_tr_b16 a[208:209], v40 offset:49152
  v_add_f32 v164, v164, v68
  v_mfma_f32_16x16x32_bf16 a[8:11], a[196:199], v[212:215], a[8:11]
  v_exp_f32 v79, v79
  v_mfma_f32_16x16x32_bf16 a[12:15], a[196:199], v[220:223], a[12:15]
  v_add_f32 v164, v164, v69
  v_cvt_pk_bf16_f32 v233, v78, v79
  v_mfma_f32_16x16x32_bf16 a[12:15], a[192:195], v[216:219], a[12:15]
  s_waitcnt lgkmcnt(7)
  v_exp_f32 v84, v84
  v_mfma_f32_16x16x32_bf16 a[28:31], a[200:203], v[216:219], a[28:31]
  s_waitcnt lgkmcnt(5)
  buffer_load_dwordx4 v31, s[20:23], s69 offen offset:3072 lds
  v_mfma_f32_16x16x32_bf16 a[28:31], a[204:207], v[220:223], a[28:31]
  s_add_u32 s69, s69, 16384
  v_exp_f32 v85, v85
  v_mfma_f32_16x16x32_bf16 a[24:27], a[204:207], v[212:215], a[24:27]
  v_add_f32 v164, v164, v70
  v_cvt_pk_bf16_f32 v240, v84, v85
  v_mfma_f32_16x16x32_bf16 a[24:27], a[200:203], v[208:211], a[24:27]
  v_exp_f32 v86, v86
  v_mfma_f32_16x16x32_bf16 a[20:23], a[200:203], v[200:203], a[20:23]
  ds_read_b64_tr_b16 a[210:211], v40 offset:53248
  v_add_f32 v164, v164, v71
  v_mfma_f32_16x16x32_bf16 a[20:23], a[204:207], v[204:207], a[20:23]
  v_exp_f32 v87, v87
  v_mfma_f32_16x16x32_bf16 a[16:19], a[204:207], v[196:199], a[16:19]
  ds_read_b64_tr_b16 a[212:213], v40 offset:57344
  v_cvt_pk_bf16_f32 v241, v86, v87
  v_mfma_f32_16x16x32_bf16 a[16:19], a[200:203], v[192:195], a[16:19]
  s_waitcnt lgkmcnt(6)
  v_exp_f32 v92, v92
  v_mfma_f32_16x16x32_bf16 v[100:103], a[176:179], v[64:67], v[132:135]
  s_waitcnt lgkmcnt(5)
  ds_read_b64_tr_b16 a[214:215], v40 offset:61440
  ds_read_b64_tr_b16 a[216:217], v41 offset:49152
  v_mfma_f32_16x16x32_bf16 v[100:103], a[180:183], v[96:99], v[100:103]
  s_waitcnt lgkmcnt(6)
  v_exp_f32 v93, v93
  v_mfma_f32_16x16x32_bf16 v[100:103], a[184:187], v[128:131], v[100:103]
  s_waitcnt lgkmcnt(5)
  ds_read_b64_tr_b16 a[218:219], v41 offset:53248
  v_cvt_pk_bf16_f32 v248, v92, v93
  v_mfma_f32_16x16x32_bf16 v[100:103], a[188:191], v[160:163], v[100:103]
  s_add_u32 m0, s68, 16384
  v_exp_f32 v94, v94
  v_mfma_f32_16x16x32_bf16 v[108:111], a[188:191], v[168:171], v[140:143]
  buffer_load_dwordx4 v32, s[24:27], s70 offen offset:0 lds
  v_mfma_f32_16x16x32_bf16 v[108:111], a[184:187], v[136:139], v[108:111]
  v_exp_f32 v95, v95
  v_mfma_f32_16x16x32_bf16 v[108:111], a[180:183], v[104:107], v[108:111]
  ds_read_b64_tr_b16 a[220:221], v41 offset:57344
  v_cvt_pk_bf16_f32 v249, v94, v95
  v_mfma_f32_16x16x32_bf16 v[108:111], a[176:179], v[72:75], v[108:111]
  v_exp_f32 v100, v100
  v_mfma_f32_16x16x32_bf16 v[116:119], a[176:179], v[80:83], v[148:151]
  ds_read_b64_tr_b16 a[222:223], v41 offset:61440
  v_add_f32 v166, v166, v84
  v_mfma_f32_16x16x32_bf16 v[116:119], a[180:183], v[112:115], v[116:119]
  v_exp_f32 v101, v101
  v_mfma_f32_16x16x32_bf16 v[116:119], a[184:187], v[144:147], v[116:119]
  v_add_f32 v166, v166, v85
  v_cvt_pk_bf16_f32 v226, v100, v101
  v_mfma_f32_16x16x32_bf16 v[116:119], a[188:191], v[176:179], v[116:119]
  v_exp_f32 v102, v102
  v_mfma_f32_16x16x32_bf16 v[124:127], a[188:191], v[184:187], v[156:159]
  ds_read_b128 a[160:163], v34 offset:24576
  v_add_f32 v166, v166, v86
  v_mfma_f32_16x16x32_bf16 v[124:127], a[184:187], v[152:155], v[124:127]
  v_exp_f32 v103, v103
  v_mfma_f32_16x16x32_bf16 v[124:127], a[180:183], v[120:123], v[124:127]
  v_add_f32 v166, v166, v87
  v_cvt_pk_bf16_f32 v227, v102, v103
  v_mfma_f32_16x16x32_bf16 v[124:127], a[176:179], v[88:91], v[124:127]
  s_waitcnt lgkmcnt(7)
  v_exp_f32 v108, v108
  v_mfma_f32_16x16x32_bf16 a[32:35], a[208:211], v[192:195], a[32:35]
  s_waitcnt lgkmcnt(5)
  buffer_load_dwordx4 v33, s[24:27], s70 offen offset:1024 lds
  v_mfma_f32_16x16x32_bf16 a[32:35], a[212:215], v[196:199], a[32:35]
  v_exp_f32 v109, v109
  v_mfma_f32_16x16x32_bf16 a[36:39], a[212:215], v[204:207], a[36:39]
  ds_read_b128 a[164:167], v35 offset:24576
  v_cvt_pk_bf16_f32 v234, v108, v109
  v_mfma_f32_16x16x32_bf16 a[36:39], a[208:211], v[200:203], a[36:39]
  v_exp_f32 v110, v110
  v_mfma_f32_16x16x32_bf16 a[40:43], a[208:211], v[208:211], a[40:43]
  ds_read_b128 a[168:171], v36 offset:24576
  ds_read_b128 a[172:175], v37 offset:24576
  v_mfma_f32_16x16x32_bf16 a[40:43], a[212:215], v[212:215], a[40:43]
  v_exp_f32 v111, v111
  v_mfma_f32_16x16x32_bf16 a[44:47], a[212:215], v[220:223], a[44:47]
  v_add_f32 v164, v164, v100
  v_cvt_pk_bf16_f32 v235, v110, v111
  v_mfma_f32_16x16x32_bf16 a[44:47], a[208:211], v[216:219], a[44:47]
  s_waitcnt lgkmcnt(6)
  ds_read_b64_tr_b16 a[192:193], v42 offset:49152
  v_add_f32 v164, v164, v101
  v_mfma_f32_16x16x32_bf16 a[60:63], a[216:219], v[216:219], a[60:63]
  s_waitcnt lgkmcnt(5)
  v_exp_f32 v116, v116
  v_mfma_f32_16x16x32_bf16 a[60:63], a[220:223], v[220:223], a[60:63]
  ds_read_b64_tr_b16 a[194:195], v42 offset:53248
  v_add_f32 v164, v164, v102
  v_mfma_f32_16x16x32_bf16 a[56:59], a[220:223], v[212:215], a[56:59]
  v_exp_f32 v117, v117
  v_mfma_f32_16x16x32_bf16 a[56:59], a[216:219], v[208:211], a[56:59]
  v_add_f32 v164, v164, v103
  v_cvt_pk_bf16_f32 v242, v116, v117
  v_mfma_f32_16x16x32_bf16 a[52:55], a[216:219], v[200:203], a[52:55]
  v_exp_f32 v118, v118
  v_mfma_f32_16x16x32_bf16 a[52:55], a[220:223], v[204:207], a[52:55]
  buffer_load_dwordx4 v32, s[24:27], s70 offen offset:2048 lds
  v_mfma_f32_16x16x32_bf16 a[48:51], a[220:223], v[196:199], a[48:51]
  v_exp_f32 v119, v119
  v_mfma_f32_16x16x32_bf16 a[48:51], a[216:219], v[192:195], a[48:51]
  ds_read_b64_tr_b16 a[196:197], v42 offset:57344
  v_cvt_pk_bf16_f32 v243, v118, v119
  v_mfma_f32_16x16x32_bf16 a[132:135], a[144:147], v[200:203], a[132:135]
  v_exp_f32 v124, v124
  v_mfma_f32_16x16x32_bf16 a[132:135], a[144:147], v[204:207], a[132:135]
  s_waitcnt lgkmcnt(6)
  ds_read_b64_tr_b16 a[198:199], v42 offset:61440
  ds_read_b64_tr_b16 a[200:201], v43 offset:49152
  v_mfma_f32_16x16x32_bf16 v[68:71], a[160:163], v[64:67], v[132:135]
  s_waitcnt lgkmcnt(7)
  v_exp_f32 v125, v125
  v_mfma_f32_16x16x32_bf16 v[68:71], a[164:167], v[96:99], v[68:71]
  s_waitcnt lgkmcnt(6)
  ds_read_b64_tr_b16 a[202:203], v43 offset:53248
  v_cvt_pk_bf16_f32 v250, v124, v125
  v_mfma_f32_16x16x32_bf16 v[68:71], a[168:171], v[128:131], v[68:71]
  s_waitcnt lgkmcnt(6)
  v_exp_f32 v126, v126
  v_mfma_f32_16x16x32_bf16 v[68:71], a[172:175], v[160:163], v[68:71]
  ds_read_b64_tr_b16 a[204:205], v43 offset:57344
  ds_read_b64_tr_b16 a[206:207], v43 offset:61440
  v_mfma_f32_16x16x32_bf16 v[76:79], a[172:175], v[168:171], v[140:143]
  v_exp_f32 v127, v127
  v_mfma_f32_16x16x32_bf16 v[76:79], a[168:171], v[136:139], v[76:79]
  v_add_f32 v166, v166, v116
  v_cvt_pk_bf16_f32 v251, v126, v127
  v_mfma_f32_16x16x32_bf16 v[76:79], a[164:167], v[104:107], v[76:79]
  buffer_load_dwordx4 v33, s[24:27], s70 offen offset:3072 lds
  v_mfma_f32_16x16x32_bf16 v[76:79], a[160:163], v[72:75], v[76:79]
  s_add_u32 s70, s70, 16384
  v_exp_f32 v68, v68
  v_mfma_f32_16x16x32_bf16 v[84:87], a[160:163], v[80:83], v[148:151]
  ds_read_b128 a[176:179], v34 offset:28672
  v_add_f32 v166, v166, v117
  v_mfma_f32_16x16x32_bf16 v[84:87], a[164:167], v[112:115], v[84:87]
  v_exp_f32 v69, v69
  v_mfma_f32_16x16x32_bf16 v[84:87], a[168:171], v[144:147], v[84:87]
  v_add_f32 v166, v166, v118
  v_cvt_pk_bf16_f32 v228, v68, v69
  v_mfma_f32_16x16x32_bf16 v[84:87], a[172:175], v[176:179], v[84:87]
  v_exp_f32 v70, v70
  v_mfma_f32_16x16x32_bf16 v[92:95], a[172:175], v[184:187], v[156:159]
  ds_read_b128 a[180:183], v35 offset:28672
  v_add_f32 v166, v166, v119
  v_mfma_f32_16x16x32_bf16 v[92:95], a[168:171], v[152:155], v[92:95]
  v_exp_f32 v71, v71
  v_mfma_f32_16x16x32_bf16 v[92:95], a[164:167], v[120:123], v[92:95]
  ds_read_b128 a[184:187], v36 offset:28672
  v_cvt_pk_bf16_f32 v229, v70, v71
  v_mfma_f32_16x16x32_bf16 v[92:95], a[160:163], v[88:91], v[92:95]
  s_waitcnt lgkmcnt(9)
  v_exp_f32 v76, v76
  v_mfma_f32_16x16x32_bf16 a[64:67], a[192:195], v[192:195], a[64:67]
  s_waitcnt lgkmcnt(7)
  ds_read_b128 a[188:191], v37 offset:28672
  v_add_f32 v164, v164, v68
  v_mfma_f32_16x16x32_bf16 a[64:67], a[196:199], v[196:199], a[64:67]
  v_exp_f32 v77, v77
  v_mfma_f32_16x16x32_bf16 a[68:71], a[196:199], v[204:207], a[68:71]
  v_add_f32 v164, v164, v69
  v_cvt_pk_bf16_f32 v236, v76, v77
  v_mfma_f32_16x16x32_bf16 a[68:71], a[192:195], v[200:203], a[68:71]
  s_mov_b32 m0, s77
  v_exp_f32 v78, v78
  v_mfma_f32_16x16x32_bf16 a[72:75], a[192:195], v[208:211], a[72:75]
  ds_read_b64_tr_b16 a[208:209], v44 offset:49152
  v_add_f32 v164, v164, v70
  v_mfma_f32_16x16x32_bf16 a[72:75], a[196:199], v[212:215], a[72:75]
  v_exp_f32 v79, v79
  v_mfma_f32_16x16x32_bf16 a[76:79], a[196:199], v[220:223], a[76:79]
  buffer_load_dwordx4 v46, s[28:31], s99 offen offset:0 lds
  v_mfma_f32_16x16x32_bf16 a[76:79], a[192:195], v[216:219], a[76:79]
  s_waitcnt lgkmcnt(7)
  v_exp_f32 v84, v84
  v_mfma_f32_16x16x32_bf16 a[92:95], a[200:203], v[216:219], a[92:95]
  s_waitcnt lgkmcnt(5)
  ds_read_b64_tr_b16 a[210:211], v44 offset:53248
  v_cvt_pk_bf16_f32 v237, v78, v79
  v_mfma_f32_16x16x32_bf16 a[92:95], a[204:207], v[220:223], a[92:95]
  v_exp_f32 v85, v85
  v_mfma_f32_16x16x32_bf16 a[88:91], a[204:207], v[212:215], a[88:91]
  v_add_f32 v164, v164, v71
  v_cvt_pk_bf16_f32 v244, v84, v85
  v_mfma_f32_16x16x32_bf16 a[88:91], a[200:203], v[208:211], a[88:91]
  v_exp_f32 v86, v86
  v_mfma_f32_16x16x32_bf16 a[84:87], a[200:203], v[200:203], a[84:87]
  ds_read_b64_tr_b16 a[212:213], v44 offset:57344
  ds_read_b64_tr_b16 a[214:215], v44 offset:61440
  v_mfma_f32_16x16x32_bf16 a[84:87], a[204:207], v[204:207], a[84:87]
  v_exp_f32 v87, v87
  v_mfma_f32_16x16x32_bf16 a[80:83], a[204:207], v[196:199], a[80:83]
  ds_read_b64_tr_b16 a[216:217], v45 offset:49152
  v_cvt_pk_bf16_f32 v245, v86, v87
  v_mfma_f32_16x16x32_bf16 a[80:83], a[200:203], v[192:195], a[80:83]
  s_waitcnt lgkmcnt(8)
  v_exp_f32 v92, v92
  v_mfma_f32_16x16x32_bf16 v[100:103], a[176:179], v[64:67], v[132:135]
  s_waitcnt lgkmcnt(7)
  ds_read_b64_tr_b16 a[218:219], v45 offset:53248
  ds_read_b64_tr_b16 a[220:221], v45 offset:57344
  v_mfma_f32_16x16x32_bf16 v[100:103], a[180:183], v[96:99], v[100:103]
  s_waitcnt lgkmcnt(8)
  v_exp_f32 v93, v93
  v_mfma_f32_16x16x32_bf16 v[100:103], a[184:187], v[128:131], v[100:103]
  s_waitcnt lgkmcnt(7)
  buffer_load_dwordx4 v47, s[28:31], s99 offen offset:1024 lds
  v_mfma_f32_16x16x32_bf16 v[100:103], a[188:191], v[160:163], v[100:103]
  s_add_u32 s99, s99, s101
  v_exp_f32 v94, v94
  v_mfma_f32_16x16x32_bf16 v[108:111], a[188:191], v[168:171], v[140:143]
  ds_read_b64_tr_b16 a[222:223], v45 offset:61440
  v_cvt_pk_bf16_f32 v252, v92, v93
  v_mfma_f32_16x16x32_bf16 v[108:111], a[184:187], v[136:139], v[108:111]
  v_exp_f32 v95, v95
  v_mfma_f32_16x16x32_bf16 v[108:111], a[180:183], v[104:107], v[108:111]
  v_add_f32 v166, v166, v84
  v_cvt_pk_bf16_f32 v253, v94, v95
  v_mfma_f32_16x16x32_bf16 v[108:111], a[176:179], v[72:75], v[108:111]
  v_exp_f32 v100, v100
  v_mfma_f32_16x16x32_bf16 v[116:119], a[176:179], v[80:83], v[148:151]
  v_add_f32 v166, v166, v85
  v_add_f32 v164, v164, v100
  v_mfma_f32_16x16x32_bf16 v[116:119], a[180:183], v[112:115], v[116:119]
  v_exp_f32 v101, v101
  v_mfma_f32_16x16x32_bf16 v[116:119], a[184:187], v[144:147], v[116:119]
  v_add_f32 v166, v166, v86
  v_cvt_pk_bf16_f32 v230, v100, v101
  v_mfma_f32_16x16x32_bf16 v[116:119], a[188:191], v[176:179], v[116:119]
  v_exp_f32 v102, v102
  v_mfma_f32_16x16x32_bf16 v[124:127], a[188:191], v[184:187], v[156:159]
  v_add_f32 v166, v166, v87
  v_add_f32 v164, v164, v101
  v_mfma_f32_16x16x32_bf16 v[124:127], a[184:187], v[152:155], v[124:127]
  v_exp_f32 v103, v103
  v_mfma_f32_16x16x32_bf16 v[124:127], a[180:183], v[120:123], v[124:127]
  v_add_f32 v164, v164, v102
  v_cvt_pk_bf16_f32 v231, v102, v103
  v_mfma_f32_16x16x32_bf16 v[124:127], a[176:179], v[88:91], v[124:127]
  s_waitcnt lgkmcnt(6)
  v_exp_f32 v108, v108
  v_mfma_f32_16x16x32_bf16 a[96:99], a[208:211], v[192:195], a[96:99]
  s_waitcnt lgkmcnt(4)
  v_add_f32 v164, v164, v103
  v_mfma_f32_16x16x32_bf16 a[96:99], a[212:215], v[196:199], a[96:99]
  v_exp_f32 v109, v109
  v_mfma_f32_16x16x32_bf16 a[100:103], a[212:215], v[204:207], a[100:103]
  v_cvt_pk_bf16_f32 v238, v108, v109
  v_mfma_f32_16x16x32_bf16 a[100:103], a[208:211], v[200:203], a[100:103]
  v_exp_f32 v110, v110
  v_mfma_f32_16x16x32_bf16 a[104:107], a[208:211], v[208:211], a[104:107]
  s_waitcnt vmcnt(10)
  s_barrier
  ds_read_b128 a[160:163], v34 offset:32768
  v_mfma_f32_16x16x32_bf16 a[104:107], a[212:215], v[212:215], a[104:107]
  s_add_u32 m0, s67, 0
  v_exp_f32 v111, v111
  v_mfma_f32_16x16x32_bf16 a[108:111], a[212:215], v[220:223], a[108:111]
  buffer_load_dwordx4 v28, s[20:23], s69 offen offset:0 lds
  v_mfma_f32_16x16x32_bf16 a[108:111], a[208:211], v[216:219], a[108:111]
  s_waitcnt lgkmcnt(3)
  ds_read_b128 a[164:167], v35 offset:32768
  ds_read_b128 a[168:171], v36 offset:32768
  v_mfma_f32_16x16x32_bf16 a[124:127], a[216:219], v[216:219], a[124:127]
  s_waitcnt lgkmcnt(3)
  v_exp_f32 v116, v116
  v_mfma_f32_16x16x32_bf16 a[124:127], a[220:223], v[220:223], a[124:127]
  ds_read_b128 a[172:175], v37 offset:32768
  v_cvt_pk_bf16_f32 v239, v110, v111
  v_mfma_f32_16x16x32_bf16 a[120:123], a[220:223], v[212:215], a[120:123]
  v_exp_f32 v117, v117
  v_mfma_f32_16x16x32_bf16 a[120:123], a[216:219], v[208:211], a[120:123]
  ds_read_b64_tr_b16 a[192:193], v38 offset:0
  v_cvt_pk_bf16_f32 v246, v116, v117
  v_mfma_f32_16x16x32_bf16 a[116:119], a[216:219], v[200:203], a[116:119]
  v_exp_f32 v118, v118
  v_mfma_f32_16x16x32_bf16 a[116:119], a[220:223], v[204:207], a[116:119]
  ds_read_b64_tr_b16 a[194:195], v38 offset:4096
  ds_read_b64_tr_b16 a[196:197], v38 offset:8192
  v_mfma_f32_16x16x32_bf16 a[112:115], a[220:223], v[196:199], a[112:115]
  v_exp_f32 v119, v119
  v_mfma_f32_16x16x32_bf16 a[112:115], a[216:219], v[192:195], a[112:115]
  ds_read_b64_tr_b16 a[198:199], v38 offset:12288
  v_cvt_pk_bf16_f32 v247, v118, v119
  v_mfma_f32_16x16x32_bf16 a[140:143], a[144:147], v[216:219], a[140:143]
  v_exp_f32 v124, v124
  v_mfma_f32_16x16x32_bf16 a[140:143], a[144:147], v[220:223], a[140:143]
  ds_read_b64_tr_b16 a[200:201], v39 offset:0
  ds_read_b64_tr_b16 a[202:203], v39 offset:4096
att_loop_b:
  s_waitcnt lgkmcnt(9)
  v_mfma_f32_16x16x32_bf16 v[68:71], a[160:163], v[64:67], v[132:135]
  s_waitcnt lgkmcnt(8)
  v_exp_f32 v125, v125
  v_mfma_f32_16x16x32_bf16 v[68:71], a[164:167], v[96:99], v[68:71]
pad_m_5:
  s_cbranch_execz warm_1
  s_waitcnt lgkmcnt(7)
  ds_read_b64_tr_b16 a[204:205], v39 offset:8192
  v_cvt_pk_bf16_f32 v254, v124, v125
  v_mfma_f32_16x16x32_bf16 v[68:71], a[168:171], v[128:131], v[68:71]
  s_waitcnt lgkmcnt(7)
  s_mul_i32 s73, s71, 27648
  v_exp_f32 v126, v126
  v_mfma_f32_16x16x32_bf16 v[68:71], a[172:175], v[160:163], v[68:71]
  ds_read_b64_tr_b16 a[206:207], v39 offset:12288
  v_add_f32 v166, v166, v116
  v_mfma_f32_16x16x32_bf16 v[76:79], a[172:175], v[168:171], v[140:143]
  v_exp_f32 v127, v127
  v_mfma_f32_16x16x32_bf16 v[76:79], a[168:171], v[136:139], v[76:79]
  buffer_load_dwordx4 v29, s[20:23], s69 offen offset:1024 lds
  v_mfma_f32_16x16x32_bf16 v[76:79], a[164:167], v[104:107], v[76:79]
  v_add_f32 v166, v166, v117
  v_cvt_pk_bf16_f32 v255, v126, v127
  v_mfma_f32_16x16x32_bf16 v[76:79], a[160:163], v[72:75], v[76:79]
  v_exp_f32 v68, v68
  v_mfma_f32_16x16x32_bf16 v[84:87], a[160:163], v[80:83], v[148:151]
  ds_read_b128 a[176:179], v34 offset:36864
  v_add_f32 v166, v166, v118
  v_mfma_f32_16x16x32_bf16 v[84:87], a[164:167], v[112:115], v[84:87]
  v_exp_f32 v69, v69
  v_mfma_f32_16x16x32_bf16 v[84:87], a[168:171], v[144:147], v[84:87]
  global_load_dword v62, v[60:61], off
  v_mfma_f32_16x16x32_bf16 v[84:87], a[172:175], v[176:179], v[84:87]
  v_exp_f32 v70, v70
  v_mfma_f32_16x16x32_bf16 v[92:95], a[172:175], v[184:187], v[156:159]
  v_add_f32 v166, v166, v119
  v_cvt_pk_bf16_f32 v192, v68, v69
  v_mfma_f32_16x16x32_bf16 v[92:95], a[168:171], v[152:155], v[92:95]
  v_exp_f32 v71, v71
  v_mfma_f32_16x16x32_bf16 v[92:95], a[164:167], v[120:123], v[92:95]
  ds_read_b128 a[180:183], v35 offset:36864
  v_cvt_pk_bf16_f32 v193, v70, v71
  v_mfma_f32_16x16x32_bf16 v[92:95], a[160:163], v[88:91], v[92:95]
  s_waitcnt lgkmcnt(8)
  v_exp_f32 v76, v76
  v_mfma_f32_16x16x32_bf16 a[0:3], a[192:195], v[224:227], a[0:3]
  s_waitcnt lgkmcnt(6)
  ds_read_b128 a[184:187], v36 offset:36864
  ds_read_b128 a[188:191], v37 offset:36864
  v_mfma_f32_16x16x32_bf16 a[0:3], a[196:199], v[228:231], a[0:3]
  v_exp_f32 v77, v77
  v_mfma_f32_16x16x32_bf16 a[4:7], a[196:199], v[236:239], a[4:7]
  v_add_f32 v164, v164, v68
  v_cvt_pk_bf16_f32 v200, v76, v77
  v_mfma_f32_16x16x32_bf16 a[4:7], a[192:195], v[232:235], a[4:7]
  v_exp_f32 v78, v78
  v_mfma_f32_16x16x32_bf16 a[8:11], a[192:195], v[240:243], a[8:11]
  buffer_load_dwordx4 v30, s[20:23], s69 offen offset:2048 lds
  v_mfma_f32_16x16x32_bf16 a[8:11], a[196:199], v[244:247], a[8:11]
  v_exp_f32 v79, v79
  v_mfma_f32_16x16x32_bf16 a[12:15], a[196:199], v[252:255], a[12:15]
  v_add_f32 v164, v164, v69
  v_cvt_pk_bf16_f32 v201, v78, v79
  v_mfma_f32_16x16x32_bf16 a[12:15], a[192:195], v[248:251], a[12:15]
  s_waitcnt lgkmcnt(6)
  v_exp_f32 v84, v84
  v_mfma_f32_16x16x32_bf16 a[28:31], a[200:203], v[248:251], a[28:31]
  s_waitcnt lgkmcnt(4)
  ds_read_b64_tr_b16 a[208:209], v40 offset:0
  v_add_f32 v164, v164, v70
  v_mfma_f32_16x16x32_bf16 a[28:31], a[204:207], v[252:255], a[28:31]
  v_exp_f32 v85, v85
  v_mfma_f32_16x16x32_bf16 a[24:27], a[204:207], v[244:247], a[24:27]
  ds_read_b64_tr_b16 a[210:211], v40 offset:4096
  v_cvt_pk_bf16_f32 v208, v84, v85
  v_mfma_f32_16x16x32_bf16 a[24:27], a[200:203], v[240:243], a[24:27]
  v_exp_f32 v86, v86
  v_mfma_f32_16x16x32_bf16 a[20:23], a[200:203], v[232:235], a[20:23]
  ds_read_b64_tr_b16 a[212:213], v40 offset:8192
  v_add_f32 v164, v164, v71
  v_mfma_f32_16x16x32_bf16 a[20:23], a[204:207], v[236:239], a[20:23]
  v_exp_f32 v87, v87
  v_mfma_f32_16x16x32_bf16 a[16:19], a[204:207], v[228:231], a[16:19]
  ds_read_b64_tr_b16 a[214:215], v40 offset:12288
  v_cvt_pk_bf16_f32 v209, v86, v87
  v_mfma_f32_16x16x32_bf16 a[16:19], a[200:203], v[224:227], a[16:19]
  s_waitcnt lgkmcnt(7)
  v_exp_f32 v92, v92
  v_mfma_f32_16x16x32_bf16 v[100:103], a[176:179], v[64:67], v[132:135]
  s_waitcnt lgkmcnt(6)
  ds_read_b64_tr_b16 a[216:217], v41 offset:0
  ds_read_b64_tr_b16 a[218:219], v41 offset:4096
  v_mfma_f32_16x16x32_bf16 v[100:103], a[180:183], v[96:99], v[100:103]
  s_waitcnt lgkmcnt(7)
  v_exp_f32 v93, v93
  v_mfma_f32_16x16x32_bf16 v[100:103], a[184:187], v[128:131], v[100:103]
  s_waitcnt lgkmcnt(6)
  ds_read_b64_tr_b16 a[220:221], v41 offset:8192
  v_cvt_pk_bf16_f32 v216, v92, v93
  v_mfma_f32_16x16x32_bf16 v[100:103], a[188:191], v[160:163], v[100:103]
  v_exp_f32 v94, v94
  v_mfma_f32_16x16x32_bf16 v[108:111], a[188:191], v[168:171], v[140:143]
  buffer_load_dwordx4 v31, s[20:23], s69 offen offset:3072 lds
  v_mfma_f32_16x16x32_bf16 v[108:111], a[184:187], v[136:139], v[108:111]
  s_add_u32 s69, s69, 16384
  v_exp_f32 v95, v95
  v_mfma_f32_16x16x32_bf16 v[108:111], a[180:183], v[104:107], v[108:111]
  ds_read_b64_tr_b16 a[222:223], v41 offset:12288
  v_cvt_pk_bf16_f32 v217, v94, v95
  v_mfma_f32_16x16x32_bf16 v[108:111], a[176:179], v[72:75], v[108:111]
  v_exp_f32 v100, v100
  v_mfma_f32_16x16x32_bf16 v[116:119], a[176:179], v[80:83], v[148:151]
  ds_read_b128 a[160:163], v34 offset:40960
  v_add_f32 v166, v166, v84
  v_mfma_f32_16x16x32_bf16 v[116:119], a[180:183], v[112:115], v[116:119]
  v_exp_f32 v101, v101
  v_mfma_f32_16x16x32_bf16 v[116:119], a[184:187], v[144:147], v[116:119]
  v_add_f32 v166, v166, v85
  v_cvt_pk_bf16_f32 v194, v100, v101
  v_mfma_f32_16x16x32_bf16 v[116:119], a[188:191], v[176:179], v[116:119]
  v_exp_f32 v102, v102
  v_mfma_f32_16x16x32_bf16 v[124:127], a[188:191], v[184:187], v[156:159]
  buffer_load_dword v62, v63, s[12:15], s73 offen
  v_mfma_f32_16x16x32_bf16 v[124:127], a[184:187], v[152:155], v[124:127]
  v_exp_f32 v103, v103
  v_mfma_f32_16x16x32_bf16 v[124:127], a[180:183], v[120:123], v[124:127]
  v_add_f32 v166, v166, v86
  v_cvt_pk_bf16_f32 v195, v102, v103
  v_mfma_f32_16x16x32_bf16 v[124:127], a[176:179], v[88:91], v[124:127]
  s_waitcnt lgkmcnt(7)
  v_exp_f32 v108, v108
  v_mfma_f32_16x16x32_bf16 a[32:35], a[208:211], v[224:227], a[32:35]
  s_waitcnt lgkmcnt(5)
  ds_read_b128 a[164:167], v35 offset:40960
  v_add_f32 v166, v166, v87
  v_mfma_f32_16x16x32_bf16 a[32:35], a[212:215], v[228:231], a[32:35]
  v_exp_f32 v109, v109
  v_mfma_f32_16x16x32_bf16 a[36:39], a[212:215], v[236:239], a[36:39]
  ds_read_b128 a[168:171], v36 offset:40960
  v_cvt_pk_bf16_f32 v202, v108, v109
  v_mfma_f32_16x16x32_bf16 a[36:39], a[208:211], v[232:235], a[36:39]
  s_add_u32 m0, s68, 32768
  v_exp_f32 v110, v110
  v_mfma_f32_16x16x32_bf16 a[40:43], a[208:211], v[240:243], a[40:43]
  buffer_load_dwordx4 v32, s[24:27], s70 offen offset:0 lds
  v_mfma_f32_16x16x32_bf16 a[40:43], a[212:215], v[244:247], a[40:43]
  v_exp_f32 v111, v111
  v_mfma_f32_16x16x32_bf16 a[44:47], a[212:215], v[252:255], a[44:47]
  ds_read_b128 a[172:175], v37 offset:40960
  v_cvt_pk_bf16_f32 v203, v110, v111
  v_mfma_f32_16x16x32_bf16 a[44:47], a[208:211], v[248:251], a[44:47]
  s_waitcnt lgkmcnt(6)
  ds_read_b64_tr_b16 a[192:193], v42 offset:0
  v_add_f32 v164, v164, v100
  v_mfma_f32_16x16x32_bf16 a[60:63], a[216:219], v[248:251], a[60:63]
  s_waitcnt lgkmcnt(5)
  v_exp_f32 v116, v116
  v_mfma_f32_16x16x32_bf16 a[60:63], a[220:223], v[252:255], a[60:63]
  ds_read_b64_tr_b16 a[194:195], v42 offset:4096
  v_add_f32 v164, v164, v101
  v_mfma_f32_16x16x32_bf16 a[56:59], a[220:223], v[244:247], a[56:59]
  v_exp_f32 v117, v117
  v_mfma_f32_16x16x32_bf16 a[56:59], a[216:219], v[240:243], a[56:59]
  v_add_f32 v164, v164, v102
  v_cvt_pk_bf16_f32 v210, v116, v117
  v_mfma_f32_16x16x32_bf16 a[52:55], a[216:219], v[232:235], a[52:55]
  v_exp_f32 v118, v118
  v_mfma_f32_16x16x32_bf16 a[52:55], a[220:223], v[236:239], a[52:55]
  ds_read_b64_tr_b16 a[196:197], v42 offset:8192
  v_add_f32 v164, v164, v103
  v_mfma_f32_16x16x32_bf16 a[48:51], a[220:223], v[228:231], a[48:51]
  v_exp_f32 v119, v119
  v_mfma_f32_16x16x32_bf16 a[48:51], a[216:219], v[224:227], a[48:51]
  ds_read_b64_tr_b16 a[198:199], v42 offset:12288
  v_cvt_pk_bf16_f32 v211, v118, v119
  v_mfma_f32_16x16x32_bf16 a[132:135], a[144:147], v[232:235], a[132:135]
  v_exp_f32 v124, v124
  v_mfma_f32_16x16x32_bf16 a[132:135], a[144:147], v[236:239], a[132:135]
  s_waitcnt lgkmcnt(7)
  ds_read_b64_tr_b16 a[200:201], v43 offset:0
  ds_read_b64_tr_b16 a[202:203], v43 offset:4096
  v_mfma_f32_16x16x32_bf16 v[68:71], a[160:163], v[64:67], v[132:135]
  s_waitcnt lgkmcnt(8)
  v_exp_f32 v125, v125
  v_mfma_f32_16x16x32_bf16 v[68:71], a[164:167], v[96:99], v[68:71]
  s_waitcnt lgkmcnt(7)
  ds_read_b64_tr_b16 a[204:205], v43 offset:8192
  v_cvt_pk_bf16_f32 v218, v124, v125
  v_mfma_f32_16x16x32_bf16 v[68:71], a[168:171], v[128:131], v[68:71]
  s_waitcnt lgkmcnt(7)
  v_exp_f32 v126, v126
  v_mfma_f32_16x16x32_bf16 v[68:71], a[172:175], v[160:163], v[68:71]
  buffer_load_dwordx4 v33, s[24:27], s70 offen offset:1024 lds
  v_mfma_f32_16x16x32_bf16 v[76:79], a[172:175], v[168:171], v[140:143]
  v_exp_f32 v127, v127
  v_mfma_f32_16x16x32_bf16 v[76:79], a[168:171], v[136:139], v[76:79]
  ds_read_b64_tr_b16 a[206:207], v43 offset:12288
  v_cvt_pk_bf16_f32 v219, v126, v127
  v_mfma_f32_16x16x32_bf16 v[76:79], a[164:167], v[104:107], v[76:79]
  ds_read_b128 a[176:179], v34 offset:45056
  v_add_f32 v166, v166, v116
  v_mfma_f32_16x16x32_bf16 v[76:79], a[160:163], v[72:75], v[76:79]
  v_exp_f32 v68, v68
  v_mfma_f32_16x16x32_bf16 v[84:87], a[160:163], v[80:83], v[148:151]
  ds_read_b128 a[180:183], v35 offset:45056
  v_add_f32 v166, v166, v117
  v_mfma_f32_16x16x32_bf16 v[84:87], a[164:167], v[112:115], v[84:87]
  v_exp_f32 v69, v69
  v_mfma_f32_16x16x32_bf16 v[84:87], a[168:171], v[144:147], v[84:87]
  v_add_f32 v166, v166, v118
  v_cvt_pk_bf16_f32 v196, v68, v69
  v_mfma_f32_16x16x32_bf16 v[84:87], a[172:175], v[176:179], v[84:87]
  v_exp_f32 v70, v70
  v_mfma_f32_16x16x32_bf16 v[92:95], a[172:175], v[184:187], v[156:159]
  buffer_load_dword v62, v63, s[16:19], s73 offen
  v_mfma_f32_16x16x32_bf16 v[92:95], a[168:171], v[152:155], v[92:95]
  v_exp_f32 v71, v71
  v_mfma_f32_16x16x32_bf16 v[92:95], a[164:167], v[120:123], v[92:95]
  v_add_f32 v166, v166, v119
  v_cvt_pk_bf16_f32 v197, v70, v71
  v_mfma_f32_16x16x32_bf16 v[92:95], a[160:163], v[88:91], v[92:95]
  s_waitcnt lgkmcnt(8)
  v_exp_f32 v76, v76
  v_mfma_f32_16x16x32_bf16 a[64:67], a[192:195], v[224:227], a[64:67]
  s_waitcnt lgkmcnt(6)
  ds_read_b128 a[184:187], v36 offset:45056
  ds_read_b128 a[188:191], v37 offset:45056
  v_mfma_f32_16x16x32_bf16 a[64:67], a[196:199], v[228:231], a[64:67]
  v_exp_f32 v77, v77
  v_mfma_f32_16x16x32_bf16 a[68:71], a[196:199], v[236:239], a[68:71]
  buffer_load_dwordx4 v32, s[24:27], s70 offen offset:2048 lds
  v_mfma_f32_16x16x32_bf16 a[68:71], a[192:195], v[232:235], a[68:71]
  v_exp_f32 v78, v78
  v_mfma_f32_16x16x32_bf16 a[72:75], a[192:195], v[240:243], a[72:75]
  v_add_f32 v164, v164, v68
  v_cvt_pk_bf16_f32 v204, v76, v77
  v_mfma_f32_16x16x32_bf16 a[72:75], a[196:199], v[244:247], a[72:75]
  v_exp_f32 v79, v79
  v_mfma_f32_16x16x32_bf16 a[76:79], a[196:199], v[252:255], a[76:79]
  v_add_f32 v164, v164, v69
  v_cvt_pk_bf16_f32 v205, v78, v79
  v_mfma_f32_16x16x32_bf16 a[76:79], a[192:195], v[248:251], a[76:79]
  s_waitcnt lgkmcnt(6)
  v_exp_f32 v84, v84
  v_mfma_f32_16x16x32_bf16 a[92:95], a[200:203], v[248:251], a[92:95]
  s_waitcnt lgkmcnt(4)
  ds_read_b64_tr_b16 a[208:209], v44 offset:0
  v_add_f32 v164, v164, v70
  v_mfma_f32_16x16x32_bf16 a[92:95], a[204:207], v[252:255], a[92:95]
  v_exp_f32 v85, v85
  v_mfma_f32_16x16x32_bf16 a[88:91], a[204:207], v[244:247], a[88:91]
  ds_read_b64_tr_b16 a[210:211], v44 offset:4096
  v_cvt_pk_bf16_f32 v212, v84, v85
  v_mfma_f32_16x16x32_bf16 a[88:91], a[200:203], v[240:243], a[88:91]
  v_exp_f32 v86, v86
  v_mfma_f32_16x16x32_bf16 a[84:87], a[200:203], v[232:235], a[84:87]
  ds_read_b64_tr_b16 a[212:213], v44 offset:8192
  v_add_f32 v164, v164, v71
  v_mfma_f32_16x16x32_bf16 a[84:87], a[204:207], v[236:239], a[84:87]
  v_exp_f32 v87, v87
  v_mfma_f32_16x16x32_bf16 a[80:83], a[204:207], v[228:231], a[80:83]
  ds_read_b64_tr_b16 a[214:215], v44 offset:12288
  v_cvt_pk_bf16_f32 v213, v86, v87
  v_mfma_f32_16x16x32_bf16 a[80:83], a[200:203], v[224:227], a[80:83]
  s_waitcnt lgkmcnt(7)
  v_exp_f32 v92, v92
  v_mfma_f32_16x16x32_bf16 v[100:103], a[176:179], v[64:67], v[132:135]
  s_waitcnt lgkmcnt(6)
  ds_read_b64_tr_b16 a[216:217], v45 offset:0
  ds_read_b64_tr_b16 a[218:219], v45 offset:4096
  v_mfma_f32_16x16x32_bf16 v[100:103], a[180:183], v[96:99], v[100:103]
  s_waitcnt lgkmcnt(7)
  v_exp_f32 v93, v93
  v_mfma_f32_16x16x32_bf16 v[100:103], a[184:187], v[128:131], v[100:103]
  s_waitcnt lgkmcnt(6)
  buffer_load_dwordx4 v33, s[24:27], s70 offen offset:3072 lds
  v_mfma_f32_16x16x32_bf16 v[100:103], a[188:191], v[160:163], v[100:103]
  s_add_u32 s70, s70, 16384
  v_exp_f32 v94, v94
  v_mfma_f32_16x16x32_bf16 v[108:111], a[188:191], v[168:171], v[140:143]
  ds_read_b64_tr_b16 a[220:221], v45 offset:8192
  v_cvt_pk_bf16_f32 v220, v92, v93
  v_mfma_f32_16x16x32_bf16 v[108:111], a[184:187], v[136:139], v[108:111]
  v_exp_f32 v95, v95
  v_mfma_f32_16x16x32_bf16 v[108:111], a[180:183], v[104:107], v[108:111]
  ds_read_b64_tr_b16 a[222:223], v45 offset:12288
  v_cvt_pk_bf16_f32 v221, v94, v95
  v_mfma_f32_16x16x32_bf16 v[108:111], a[176:179], v[72:75], v[108:111]
  v_exp_f32 v100, v100
  v_mfma_f32_16x16x32_bf16 v[116:119], a[176:179], v[80:83], v[148:151]
  v_add_f32 v166, v166, v84
  v_add_f32 v164, v164, v100
  v_mfma_f32_16x16x32_bf16 v[116:119], a[180:183], v[112:115], v[116:119]
  v_exp_f32 v101, v101
  v_mfma_f32_16x16x32_bf16 v[116:119], a[184:187], v[144:147], v[116:119]
  v_add_f32 v166, v166, v85
  v_cvt_pk_bf16_f32 v198, v100, v101
  v_mfma_f32_16x16x32_bf16 v[116:119], a[188:191], v[176:179], v[116:119]
  v_exp_f32 v102, v102
  v_mfma_f32_16x16x32_bf16 v[124:127], a[188:191], v[184:187], v[156:159]
  v_add_f32 v166, v166, v86
  v_add_f32 v164, v164, v101
  v_mfma_f32_16x16x32_bf16 v[124:127], a[184:187], v[152:155], v[124:127]
  v_exp_f32 v103, v103
  v_mfma_f32_16x16x32_bf16 v[124:127], a[180:183], v[120:123], v[124:127]
  v_add_f32 v166, v166, v87
  v_cvt_pk_bf16_f32 v199, v102, v103
  v_mfma_f32_16x16x32_bf16 v[124:127], a[176:179], v[88:91], v[124:127]
  s_waitcnt lgkmcnt(6)
  v_exp_f32 v108, v108
  v_mfma_f32_16x16x32_bf16 a[96:99], a[208:211], v[224:227], a[96:99]
  s_waitcnt lgkmcnt(4)
  v_add_f32 v164, v164, v102
  v_mfma_f32_16x16x32_bf16 a[96:99], a[212:215], v[228:231], a[96:99]
  v_exp_f32 v109, v109
  v_mfma_f32_16x16x32_bf16 a[100:103], a[212:215], v[236:239], a[100:103]
  v_add_f32 v164, v164, v103
  v_cvt_pk_bf16_f32 v206, v108, v109
  v_mfma_f32_16x16x32_bf16 a[100:103], a[208:211], v[232:235], a[100:103]
  v_exp_f32 v110, v110
  v_mfma_f32_16x16x32_bf16 a[104:107], a[208:211], v[240:243], a[104:107]
  s_waitcnt vmcnt(13)
  s_barrier
  ds_read_b128 a[160:163], v34 offset:49152
  v_mfma_f32_16x16x32_bf16 a[104:107], a[212:215], v[244:247], a[104:107]
  s_add_u32 m0, s67, 16384
  v_exp_f32 v111, v111
  v_mfma_f32_16x16x32_bf16 a[108:111], a[212:215], v[252:255], a[108:111]
  buffer_load_dwordx4 v28, s[20:23], s69 offen offset:0 lds
  v_mfma_f32_16x16x32_bf16 a[108:111], a[208:211], v[248:251], a[108:111]
  s_waitcnt lgkmcnt(3)
  ds_read_b128 a[164:167], v35 offset:49152
  ds_read_b128 a[168:171], v36 offset:49152
  v_mfma_f32_16x16x32_bf16 a[124:127], a[216:219], v[248:251], a[124:127]
  s_waitcnt lgkmcnt(3)
  v_exp_f32 v116, v116
  v_mfma_f32_16x16x32_bf16 a[124:127], a[220:223], v[252:255], a[124:127]
  ds_read_b128 a[172:175], v37 offset:49152
  v_cvt_pk_bf16_f32 v207, v110, v111
  v_mfma_f32_16x16x32_bf16 a[120:123], a[220:223], v[244:247], a[120:123]
  v_exp_f32 v117, v117
  v_mfma_f32_16x16x32_bf16 a[120:123], a[216:219], v[240:243], a[120:123]
  ds_read_b64_tr_b16 a[192:193], v38 offset:16384
  v_cvt_pk_bf16_f32 v214, v116, v117
  v_mfma_f32_16x16x32_bf16 a[116:119], a[216:219], v[232:235], a[116:119]
  v_exp_f32 v118, v118
  v_mfma_f32_16x16x32_bf16 a[116:119], a[220:223], v[236:239], a[116:119]
  ds_read_b64_tr_b16 a[194:195], v38 offset:20480
  ds_read_b64_tr_b16 a[196:197], v38 offset:24576
  v_mfma_f32_16x16x32_bf16 a[112:115], a[220:223], v[228:231], a[112:115]
  v_exp_f32 v119, v119
  v_mfma_f32_16x16x32_bf16 a[112:115], a[216:219], v[224:227], a[112:115]
  ds_read_b64_tr_b16 a[198:199], v38 offset:28672
  v_cvt_pk_bf16_f32 v215, v118, v119
  v_mfma_f32_16x16x32_bf16 a[140:143], a[144:147], v[248:251], a[140:143]
  v_exp_f32 v124, v124
  v_mfma_f32_16x16x32_bf16 a[140:143], a[144:147], v[252:255], a[140:143]
  s_waitcnt lgkmcnt(7)
  ds_read_b64_tr_b16 a[200:201], v39 offset:16384
  ds_read_b64_tr_b16 a[202:203], v39 offset:20480
  v_mfma_f32_16x16x32_bf16 v[68:71], a[160:163], v[64:67], v[132:135]
  s_waitcnt lgkmcnt(8)
  v_exp_f32 v125, v125
  v_mfma_f32_16x16x32_bf16 v[68:71], a[164:167], v[96:99], v[68:71]
  s_waitcnt lgkmcnt(7)
  ds_read_b64_tr_b16 a[204:205], v39 offset:24576
  v_cvt_pk_bf16_f32 v222, v124, v125
  v_mfma_f32_16x16x32_bf16 v[68:71], a[168:171], v[128:131], v[68:71]
  s_waitcnt lgkmcnt(7)
  v_exp_f32 v126, v126
  v_mfma_f32_16x16x32_bf16 v[68:71], a[172:175], v[160:163], v[68:71]
  ds_read_b64_tr_b16 a[206:207], v39 offset:28672
  v_add_f32 v166, v166, v116
  v_mfma_f32_16x16x32_bf16 v[76:79], a[172:175], v[168:171], v[140:143]
  v_exp_f32 v127, v127
  v_mfma_f32_16x16x32_bf16 v[76:79], a[168:171], v[136:139], v[76:79]
  buffer_load_dwordx4 v29, s[20:23], s69 offen offset:1024 lds
  v_mfma_f32_16x16x32_bf16 v[76:79], a[164:167], v[104:107], v[76:79]
  v_add_f32 v166, v166, v117
  v_cvt_pk_bf16_f32 v223, v126, v127
  v_mfma_f32_16x16x32_bf16 v[76:79], a[160:163], v[72:75], v[76:79]
  v_exp_f32 v68, v68
  v_mfma_f32_16x16x32_bf16 v[84:87], a[160:163], v[80:83], v[148:151]
  ds_read_b128 a[176:179], v34 offset:53248
  v_add_f32 v166, v166, v118
  v_mfma_f32_16x16x32_bf16 v[84:87], a[164:167], v[112:115], v[84:87]
  v_exp_f32 v69, v69
  v_mfma_f32_16x16x32_bf16 v[84:87], a[168:171], v[144:147], v[84:87]
  v_add_f32 v166, v166, v119
  v_cvt_pk_bf16_f32 v224, v68, v69
  v_mfma_f32_16x16x32_bf16 v[84:87], a[172:175], v[176:179], v[84:87]
  v_exp_f32 v70, v70
  v_mfma_f32_16x16x32_bf16 v[92:95], a[172:175], v[184:187], v[156:159]
  ds_read_b128 a[180:183], v35 offset:53248
  ds_read_b128 a[184:187], v36 offset:53248
  v_mfma_f32_16x16x32_bf16 v[92:95], a[168:171], v[152:155], v[92:95]
  v_exp_f32 v71, v71
  v_mfma_f32_16x16x32_bf16 v[92:95], a[164:167], v[120:123], v[92:95]
  ds_read_b128 a[188:191], v37 offset:53248
  v_cvt_pk_bf16_f32 v225, v70, v71
  v_mfma_f32_16x16x32_bf16 v[92:95], a[160:163], v[88:91], v[92:95]
  s_waitcnt lgkmcnt(10)
  v_exp_f32 v76, v76
  v_mfma_f32_16x16x32_bf16 a[0:3], a[192:195], v[192:195], a[0:3]
  s_waitcnt lgkmcnt(8)
  ds_read_b64_tr_b16 a[208:209], v40 offset:16384
  v_add_f32 v164, v164, v68
  v_mfma_f32_16x16x32_bf16 a[0:3], a[196:199], v[196:199], a[0:3]
  v_exp_f32 v77, v77
  v_mfma_f32_16x16x32_bf16 a[4:7], a[196:199], v[204:207], a[4:7]
  v_add_f32 v164, v164, v69
  v_cvt_pk_bf16_f32 v232, v76, v77
  v_mfma_f32_16x16x32_bf16 a[4:7], a[192:195], v[200:203], a[4:7]
  v_exp_f32 v78, v78
  v_mfma_f32_16x16x32_bf16 a[8:11], a[192:195], v[208:211], a[8:11]
  buffer_load_dwordx4 v30, s[20:23], s69 offen offset:2048 lds
  v_mfma_f32_16x16x32_bf16 a[8:11], a[196:199], v[212:215], a[8:11]
  v_exp_f32 v79, v79
  v_mfma_f32_16x16x32_bf16 a[12:15], a[196:199], v[220:223], a[12:15]
  v_add_f32 v164, v164, v70
  v_cvt_pk_bf16_f32 v233, v78, v79
  v_mfma_f32_16x16x32_bf16 a[12:15], a[192:195], v[216:219], a[12:15]
  s_waitcnt lgkmcnt(7)
  v_exp_f32 v84, v84
  v_mfma_f32_16x16x32_bf16 a[28:31], a[200:203], v[216:219], a[28:31]
  s_waitcnt lgkmcnt(5)
  ds_read_b64_tr_b16 a[210:211], v40 offset:20480
  v_add_f32 v164, v164, v71
  v_mfma_f32_16x16x32_bf16 a[28:31], a[204:207], v[220:223], a[28:31]
  v_exp_f32 v85, v85
  v_mfma_f32_16x16x32_bf16 a[24:27], a[204:207], v[212:215], a[24:27]
  ds_read_b64_tr_b16 a[212:213], v40 offset:24576
  v_cvt_pk_bf16_f32 v240, v84, v85
  v_mfma_f32_16x16x32_bf16 a[24:27], a[200:203], v[208:211], a[24:27]
  v_exp_f32 v86, v86
  v_mfma_f32_16x16x32_bf16 a[20:23], a[200:203], v[200:203], a[20:23]
  ds_read_b64_tr_b16 a[214:215], v40 offset:28672
  ds_read_b64_tr_b16 a[216:217], v41 offset:16384
  v_mfma_f32_16x16x32_bf16 a[20:23], a[204:207], v[204:207], a[20:23]
  v_exp_f32 v87, v87
  v_mfma_f32_16x16x32_bf16 a[16:19], a[204:207], v[196:199], a[16:19]
  ds_read_b64_tr_b16 a[218:219], v41 offset:20480
  v_cvt_pk_bf16_f32 v241, v86, v87
  v_mfma_f32_16x16x32_bf16 a[16:19], a[200:203], v[192:195], a[16:19]
  s_waitcnt lgkmcnt(9)
  v_exp_f32 v92, v92
  v_mfma_f32_16x16x32_bf16 v[100:103], a[176:179], v[64:67], v[132:135]
  s_waitcnt lgkmcnt(8)
  ds_read_b64_tr_b16 a[220:221], v41 offset:24576
  ds_read_b64_tr_b16 a[222:223], v41 offset:28672
  v_mfma_f32_16x16x32_bf16 v[100:103], a[180:183], v[96:99], v[100:103]
  s_waitcnt lgkmcnt(9)
  v_exp_f32 v93, v93
  v_mfma_f32_16x16x32_bf16 v[100:103], a[184:187], v[128:131], v[100:103]
  s_waitcnt lgkmcnt(8)
  v_add_f32 v166, v166, v84
  v_cvt_pk_bf16_f32 v248, v92, v93
  v_mfma_f32_16x16x32_bf16 v[100:103], a[188:191], v[160:163], v[100:103]
  v_exp_f32 v94, v94
  v_mfma_f32_16x16x32_bf16 v[108:111], a[188:191], v[168:171], v[140:143]
  buffer_load_dwordx4 v31, s[20:23], s69 offen offset:3072 lds
  v_mfma_f32_16x16x32_bf16 v[108:111], a[184:187], v[136:139], v[108:111]
  s_add_u32 s69, s69, 16384
  v_exp_f32 v95, v95
  v_mfma_f32_16x16x32_bf16 v[108:111], a[180:183], v[104:107], v[108:111]
  v_add_f32 v166, v166, v85
  v_cvt_pk_bf16_f32 v249, v94, v95
  v_mfma_f32_16x16x32_bf16 v[108:111], a[176:179], v[72:75], v[108:111]
  v_exp_f32 v100, v100
  v_mfma_f32_16x16x32_bf16 v[116:119], a[176:179], v[80:83], v[148:151]
  s_waitcnt vmcnt(15)
  ds_read_b64_tr_b16 a[224:225], v48 offset:0
  v_add_f32 v166, v166, v86
  v_mfma_f32_16x16x32_bf16 v[116:119], a[180:183], v[112:115], v[116:119]
  v_exp_f32 v101, v101
  v_mfma_f32_16x16x32_bf16 v[116:119], a[184:187], v[144:147], v[116:119]
  v_add_f32 v166, v166, v87
  v_cvt_pk_bf16_f32 v226, v100, v101
  v_mfma_f32_16x16x32_bf16 v[116:119], a[188:191], v[176:179], v[116:119]
  v_exp_f32 v102, v102
  v_mfma_f32_16x16x32_bf16 v[124:127], a[188:191], v[184:187], v[156:159]
  ds_read_b64_tr_b16 a[226:227], v48 offset:1024
  ds_read_b128 a[160:163], v34 offset:57344
  v_mfma_f32_16x16x32_bf16 v[124:127], a[184:187], v[152:155], v[124:127]
  v_exp_f32 v103, v103
  v_mfma_f32_16x16x32_bf16 v[124:127], a[180:183], v[120:123], v[124:127]
  ds_read_b128 a[164:167], v35 offset:57344
  v_cvt_pk_bf16_f32 v227, v102, v103
  v_mfma_f32_16x16x32_bf16 v[124:127], a[176:179], v[88:91], v[124:127]
  s_waitcnt lgkmcnt(10)
  v_exp_f32 v108, v108
  v_mfma_f32_16x16x32_bf16 a[32:35], a[208:211], v[192:195], a[32:35]
  s_waitcnt lgkmcnt(8)
  ds_read_b64_tr_b16 a[228:229], v49 offset:0
  ds_read_b128 a[168:171], v36 offset:57344
  v_mfma_f32_16x16x32_bf16 a[32:35], a[212:215], v[196:199], a[32:35]
  v_exp_f32 v109, v109
  v_mfma_f32_16x16x32_bf16 a[36:39], a[212:215], v[204:207], a[36:39]
  ds_read_b128 a[172:175], v37 offset:57344
  v_cvt_pk_bf16_f32 v234, v108, v109
  v_mfma_f32_16x16x32_bf16 a[36:39], a[208:211], v[200:203], a[36:39]
  s_add_u32 m0, s68, 49152
  v_exp_f32 v110, v110
  v_mfma_f32_16x16x32_bf16 a[40:43], a[208:211], v[208:211], a[40:43]
  ds_read_b64_tr_b16 a[230:231], v49 offset:1024
  v_add_f32 v164, v164, v100
  v_mfma_f32_16x16x32_bf16 a[40:43], a[212:215], v[212:215], a[40:43]
  v_exp_f32 v111, v111
  v_mfma_f32_16x16x32_bf16 a[44:47], a[212:215], v[220:223], a[44:47]
  buffer_load_dwordx4 v32, s[24:27], s70 offen offset:0 lds
  v_mfma_f32_16x16x32_bf16 a[44:47], a[208:211], v[216:219], a[44:47]
  s_waitcnt lgkmcnt(10)
  v_add_f32 v164, v164, v101
  v_cvt_pk_bf16_f32 v235, v110, v111
  v_mfma_f32_16x16x32_bf16 a[60:63], a[216:219], v[216:219], a[60:63]
  s_waitcnt lgkmcnt(8)
  v_exp_f32 v116, v116
  v_mfma_f32_16x16x32_bf16 a[60:63], a[220:223], v[220:223], a[60:63]
  ds_read_b64_tr_b16 a[192:193], v42 offset:16384
  v_add_f32 v164, v164, v102
  v_mfma_f32_16x16x32_bf16 a[56:59], a[220:223], v[212:215], a[56:59]
  v_exp_f32 v117, v117
  v_mfma_f32_16x16x32_bf16 a[56:59], a[216:219], v[208:211], a[56:59]
  v_add_f32 v164, v164, v103
  v_cvt_pk_bf16_f32 v242, v116, v117
  v_mfma_f32_16x16x32_bf16 a[52:55], a[216:219], v[200:203], a[52:55]
  v_exp_f32 v118, v118
  v_mfma_f32_16x16x32_bf16 a[52:55], a[220:223], v[204:207], a[52:55]
  ds_read_b64_tr_b16 a[194:195], v42 offset:20480
  ds_read_b64_tr_b16 a[196:197], v42 offset:24576
  v_mfma_f32_16x16x32_bf16 a[48:51], a[220:223], v[196:199], a[48:51]
  v_exp_f32 v119, v119
  v_mfma_f32_16x16x32_bf16 a[48:51], a[216:219], v[192:195], a[48:51]
  ds_read_b64_tr_b16 a[198:199], v42 offset:28672
  v_cvt_pk_bf16_f32 v243, v118, v119
  v_mfma_f32_16x16x32_bf16 a[132:135], a[144:147], v[200:203], a[132:135]
  v_exp_f32 v124, v124
  v_mfma_f32_16x16x32_bf16 a[132:135], a[144:147], v[204:207], a[132:135]
  s_waitcnt lgkmcnt(9)
  ds_read_b64_tr_b16 a[200:201], v43 offset:16384
  ds_read_b64_tr_b16 a[202:203], v43 offset:20480
  v_mfma_f32_16x16x32_bf16 v[68:71], a[160:163], v[64:67], v[132:135]
  s_waitcnt lgkmcnt(10)
  v_exp_f32 v125, v125
  v_mfma_f32_16x16x32_bf16 v[68:71], a[164:167], v[96:99], v[68:71]
  s_waitcnt lgkmcnt(8)
  ds_read_b64_tr_b16 a[204:205], v43 offset:24576
  v_cvt_pk_bf16_f32 v250, v124, v125
  v_mfma_f32_16x16x32_bf16 v[68:71], a[168:171], v[128:131], v[68:71]
  s_waitcnt lgkmcnt(8)
  v_exp_f32 v126, v126
  v_mfma_f32_16x16x32_bf16 v[68:71], a[172:175], v[160:163], v[68:71]
  buffer_load_dwordx4 v33, s[24:27], s70 offen offset:1024 lds
  v_mfma_f32_16x16x32_bf16 v[76:79], a[172:175], v[168:171], v[140:143]
  v_exp_f32 v127, v127
  v_mfma_f32_16x16x32_bf16 v[76:79], a[168:171], v[136:139], v[76:79]
  ds_read_b64_tr_b16 a[206:207], v43 offset:28672
  v_cvt_pk_bf16_f32 v251, v126, v127
  v_mfma_f32_16x16x32_bf16 v[76:79], a[164:167], v[104:107], v[76:79]
  ds_read_b128 a[176:179], v34 offset:61440
  v_add_f32 v166, v166, v116
  v_mfma_f32_16x16x32_bf16 v[76:79], a[160:163], v[72:75], v[76:79]
  v_exp_f32 v68, v68
  v_mfma_f32_16x16x32_bf16 v[84:87], a[160:163], v[80:83], v[148:151]
  ds_read_b128 a[180:183], v35 offset:61440
  v_add_f32 v166, v166, v117
  v_mfma_f32_16x16x32_bf16 v[84:87], a[164:167], v[112:115], v[84:87]
  v_exp_f32 v69, v69
  v_mfma_f32_16x16x32_bf16 v[84:87], a[168:171], v[144:147], v[84:87]
  v_add_f32 v166, v166, v118
  v_cvt_pk_bf16_f32 v228, v68, v69
  v_mfma_f32_16x16x32_bf16 v[84:87], a[172:175], v[176:179], v[84:87]
  v_exp_f32 v70, v70
  v_mfma_f32_16x16x32_bf16 v[92:95], a[172:175], v[184:187], v[156:159]
  ds_read_b128 a[184:187], v36 offset:61440
  v_add_f32 v166, v166, v119
  v_mfma_f32_16x16x32_bf16 v[92:95], a[168:171], v[152:155], v[92:95]
  v_exp_f32 v71, v71
  v_mfma_f32_16x16x32_bf16 v[92:95], a[164:167], v[120:123], v[92:95]
  ds_read_b128 a[188:191], v37 offset:61440
  v_cvt_pk_bf16_f32 v229, v70, v71
  v_mfma_f32_16x16x32_bf16 v[92:95], a[160:163], v[88:91], v[92:95]
  s_waitcnt lgkmcnt(10)
  v_exp_f32 v76, v76
  v_mfma_f32_16x16x32_bf16 a[64:67], a[192:195], v[192:195], a[64:67]
  s_waitcnt lgkmcnt(8)
  ds_read_b64_tr_b16 a[208:209], v44 offset:16384
  v_add_f32 v164, v164, v68
  v_mfma_f32_16x16x32_bf16 a[64:67], a[196:199], v[196:199], a[64:67]
  v_exp_f32 v77, v77
  v_mfma_f32_16x16x32_bf16 a[68:71], a[196:199], v[204:207], a[68:71]
  buffer_load_dwordx4 v32, s[24:27], s70 offen offset:2048 lds
  v_mfma_f32_16x16x32_bf16 a[68:71], a[192:195], v[200:203], a[68:71]
  v_exp_f32 v78, v78
  v_mfma_f32_16x16x32_bf16 a[72:75], a[192:195], v[208:211], a[72:75]
  v_add_f32 v164, v164, v69
  v_cvt_pk_bf16_f32 v236, v76, v77
  v_mfma_f32_16x16x32_bf16 a[72:75], a[196:199], v[212:215], a[72:75]
  v_exp_f32 v79, v79
  v_mfma_f32_16x16x32_bf16 a[76:79], a[196:199], v[220:223], a[76:79]
  v_add_f32 v164, v164, v70
  v_cvt_pk_bf16_f32 v237, v78, v79
  v_mfma_f32_16x16x32_bf16 a[76:79], a[192:195], v[216:219], a[76:79]
  s_waitcnt lgkmcnt(7)
  v_exp_f32 v84, v84
  v_mfma_f32_16x16x32_bf16 a[92:95], a[200:203], v[216:219], a[92:95]
  s_waitcnt lgkmcnt(5)
  ds_read_b64_tr_b16 a[210:211], v44 offset:20480
  v_add_f32 v164, v164, v71
  v_mfma_f32_16x16x32_bf16 a[92:95], a[204:207], v[220:223], a[92:95]
  v_exp_f32 v85, v85
  v_mfma_f32_16x16x32_bf16 a[88:91], a[204:207], v[212:215], a[88:91]
  ds_read_b64_tr_b16 a[212:213], v44 offset:24576
  v_cvt_pk_bf16_f32 v244, v84, v85
  v_mfma_f32_16x16x32_bf16 a[88:91], a[200:203], v[208:211], a[88:91]
  v_exp_f32 v86, v86
  v_mfma_f32_16x16x32_bf16 a[84:87], a[200:203], v[200:203], a[84:87]
  ds_read_b64_tr_b16 a[214:215], v44 offset:28672
  ds_read_b64_tr_b16 a[216:217], v45 offset:16384
  v_mfma_f32_16x16x32_bf16 a[84:87], a[204:207], v[204:207], a[84:87]
  v_exp_f32 v87, v87
  v_mfma_f32_16x16x32_bf16 a[80:83], a[204:207], v[196:199], a[80:83]
  ds_read_b64_tr_b16 a[218:219], v45 offset:20480
  v_cvt_pk_bf16_f32 v245, v86, v87
  v_mfma_f32_16x16x32_bf16 a[80:83], a[200:203], v[192:195], a[80:83]
  s_waitcnt lgkmcnt(9)
  v_exp_f32 v92, v92
  v_mfma_f32_16x16x32_bf16 v[100:103], a[176:179], v[64:67], v[132:135]
  s_waitcnt lgkmcnt(8)
  ds_read_b64_tr_b16 a[220:221], v45 offset:24576
  ds_read_b64_tr_b16 a[222:223], v45 offset:28672
  v_mfma_f32_16x16x32_bf16 v[100:103], a[180:183], v[96:99], v[100:103]
pad_m_6:
  s_cbranch_execz warm_1
  s_waitcnt lgkmcnt(9)
  v_exp_f32 v93, v93
  v_mfma_f32_16x16x32_bf16 v[100:103], a[184:187], v[128:131], v[100:103]
  s_waitcnt lgkmcnt(8)
  buffer_load_dwordx4 v33, s[24:27], s70 offen offset:3072 lds
  v_mfma_f32_16x16x32_bf16 v[100:103], a[188:191], v[160:163], v[100:103]
  s_add_u32 s70, s70, 16384
  v_exp_f32 v94, v94
  v_mfma_f32_16x16x32_bf16 v[108:111], a[188:191], v[168:171], v[140:143]
  v_add_f32 v166, v166, v84
  v_cvt_pk_bf16_f32 v252, v92, v93
  v_mfma_f32_16x16x32_bf16 v[108:111], a[184:187], v[136:139], v[108:111]
  v_exp_f32 v95, v95
  v_mfma_f32_16x16x32_bf16 v[108:111], a[180:183], v[104:107], v[108:111]
  v_add_f32 v166, v166, v85
  v_cvt_pk_bf16_f32 v253, v94, v95
  v_mfma_f32_16x16x32_bf16 v[108:111], a[176:179], v[72:75], v[108:111]
  v_exp_f32 v100, v100
  v_mfma_f32_16x16x32_bf16 v[116:119], a[176:179], v[80:83], v[148:151]
  v_add_f32 v166, v166, v86
  v_add_f32 v164, v164, v100
  v_mfma_f32_16x16x32_bf16 v[116:119], a[180:183], v[112:115], v[116:119]
  v_exp_f32 v101, v101
  v_mfma_f32_16x16x32_bf16 v[116:119], a[184:187], v[144:147], v[116:119]
  v_add_f32 v166, v166, v87
  v_cvt_pk_bf16_f32 v230, v100, v101
  v_mfma_f32_16x16x32_bf16 v[116:119], a[188:191], v[176:179], v[116:119]
  v_exp_f32 v102, v102
  v_mfma_f32_16x16x32_bf16 v[124:127], a[188:191], v[184:187], v[156:159]
  v_add_f32 v164, v164, v101
  v_mfma_f32_16x16x32_bf16 v[124:127], a[184:187], v[152:155], v[124:127]
  v_exp_f32 v103, v103
  v_mfma_f32_16x16x32_bf16 v[124:127], a[180:183], v[120:123], v[124:127]
  v_add_f32 v164, v164, v102
  v_cvt_pk_bf16_f32 v231, v102, v103
  v_mfma_f32_16x16x32_bf16 v[124:127], a[176:179], v[88:91], v[124:127]
  s_waitcnt lgkmcnt(6)
  v_exp_f32 v108, v108
  v_mfma_f32_16x16x32_bf16 a[96:99], a[208:211], v[192:195], a[96:99]
  s_waitcnt lgkmcnt(4)
  v_add_f32 v164, v164, v103
  v_mfma_f32_16x16x32_bf16 a[96:99], a[212:215], v[196:199], a[96:99]
  v_exp_f32 v109, v109
  v_mfma_f32_16x16x32_bf16 a[100:103], a[212:215], v[204:207], a[100:103]
  v_cvt_pk_bf16_f32 v238, v108, v109
  v_mfma_f32_16x16x32_bf16 a[100:103], a[208:211], v[200:203], a[100:103]
  v_exp_f32 v110, v110
  v_mfma_f32_16x16x32_bf16 a[104:107], a[208:211], v[208:211], a[104:107]
  s_waitcnt vmcnt(8)
  s_barrier
  ds_read_b128 a[160:163], v34 offset:0
  v_mfma_f32_16x16x32_bf16 a[104:107], a[212:215], v[212:215], a[104:107]
  s_add_u32 m0, s67, 32768
  v_exp_f32 v111, v111
  v_mfma_f32_16x16x32_bf16 a[108:111], a[212:215], v[220:223], a[108:111]
  buffer_load_dwordx4 v28, s[20:23], s69 offen offset:0 lds
  v_mfma_f32_16x16x32_bf16 a[108:111], a[208:211], v[216:219], a[108:111]
  s_waitcnt lgkmcnt(3)
  ds_read_b128 a[164:167], v35 offset:0
  ds_read_b128 a[168:171], v36 offset:0
  v_mfma_f32_16x16x32_bf16 a[124:127], a[216:219], v[216:219], a[124:127]
  s_waitcnt lgkmcnt(3)
  v_exp_f32 v116, v116
  v_mfma_f32_16x16x32_bf16 a[124:127], a[220:223], v[220:223], a[124:127]
  ds_read_b128 a[172:175], v37 offset:0
  v_cvt_pk_bf16_f32 v239, v110, v111
  v_mfma_f32_16x16x32_bf16 a[120:123], a[220:223], v[212:215], a[120:123]
  v_exp_f32 v117, v117
  v_mfma_f32_16x16x32_bf16 a[120:123], a[216:219], v[208:211], a[120:123]
  ds_read_b64_tr_b16 a[192:193], v38 offset:32768
  v_cvt_pk_bf16_f32 v246, v116, v117
  v_mfma_f32_16x16x32_bf16 a[116:119], a[216:219], v[200:203], a[116:119]
  v_exp_f32 v118, v118
  v_mfma_f32_16x16x32_bf16 a[116:119], a[220:223], v[204:207], a[116:119]
  ds_read_b64_tr_b16 a[194:195], v38 offset:36864
  ds_read_b64_tr_b16 a[196:197], v38 offset:40960
  v_mfma_f32_16x16x32_bf16 a[112:115], a[220:223], v[196:199], a[112:115]
  v_exp_f32 v119, v119
  v_mfma_f32_16x16x32_bf16 a[112:115], a[216:219], v[192:195], a[112:115]
  ds_read_b64_tr_b16 a[198:199], v38 offset:45056
  v_cvt_pk_bf16_f32 v247, v118, v119
  v_mfma_f32_16x16x32_bf16 a[140:143], a[144:147], v[216:219], a[140:143]
  v_exp_f32 v124, v124
  v_mfma_f32_16x16x32_bf16 a[140:143], a[144:147], v[220:223], a[140:143]
  s_sub_u32 s71, s71, 1
  ds_read_b64_tr_b16 a[200:201], v39 offset:32768
  ds_read_b64_tr_b16 a[202:203], v39 offset:36864
  s_waitcnt lgkmcnt(9)
  v_mfma_f32_16x16x32_bf16 v[68:71], a[160:163], v[64:67], v[132:135]
  s_waitcnt lgkmcnt(8)
  v_exp_f32 v125, v125
  v_mfma_f32_16x16x32_bf16 v[68:71], a[164:167], v[96:99], v[68:71]
  s_waitcnt lgkmcnt(7)
  ds_read_b64_tr_b16 a[204:205], v39 offset:40960
  v_cvt_pk_bf16_f32 v254, v124, v125
  v_mfma_f32_16x16x32_bf16 v[68:71], a[168:171], v[128:131], v[68:71]
  s_waitcnt lgkmcnt(7)
  v_exp_f32 v126, v126
  v_mfma_f32_16x16x32_bf16 v[68:71], a[172:175], v[160:163], v[68:71]
  ds_read_b64_tr_b16 a[206:207], v39 offset:45056
  v_add_f32 v166, v166, v116
  v_mfma_f32_16x16x32_bf16 v[76:79], a[172:175], v[168:171], v[140:143]
  v_exp_f32 v127, v127
  v_mfma_f32_16x16x32_bf16 v[76:79], a[168:171], v[136:139], v[76:79]
  buffer_load_dwordx4 v29, s[20:23], s69 offen offset:1024 lds
  v_mfma_f32_16x16x32_bf16 v[76:79], a[164:167], v[104:107], v[76:79]
  v_add_f32 v166, v166, v117
  v_cvt_pk_bf16_f32 v255, v126, v127
  v_mfma_f32_16x16x32_bf16 v[76:79], a[160:163], v[72:75], v[76:79]
  v_exp_f32 v68, v68
  v_mfma_f32_16x16x32_bf16 v[84:87], a[160:163], v[80:83], v[148:151]
  ds_read_b128 a[176:179], v34 offset:4096
  v_add_f32 v166, v166, v118
  v_mfma_f32_16x16x32_bf16 v[84:87], a[164:167], v[112:115], v[84:87]
  v_exp_f32 v69, v69
  v_mfma_f32_16x16x32_bf16 v[84:87], a[168:171], v[144:147], v[84:87]
  buffer_store_dwordx4 a[224:227], v50, s[32:35], s100 offen offset:0 sc1
  v_mfma_f32_16x16x32_bf16 v[84:87], a[172:175], v[176:179], v[84:87]
  v_exp_f32 v70, v70
  v_mfma_f32_16x16x32_bf16 v[92:95], a[172:175], v[184:187], v[156:159]
  v_add_f32 v166, v166, v119
  v_cvt_pk_bf16_f32 v192, v68, v69
  v_mfma_f32_16x16x32_bf16 v[92:95], a[168:171], v[152:155], v[92:95]
  v_exp_f32 v71, v71
  v_mfma_f32_16x16x32_bf16 v[92:95], a[164:167], v[120:123], v[92:95]
  ds_read_b128 a[180:183], v35 offset:4096
  v_cvt_pk_bf16_f32 v193, v70, v71
  v_mfma_f32_16x16x32_bf16 v[92:95], a[160:163], v[88:91], v[92:95]
  s_waitcnt lgkmcnt(8)
  v_exp_f32 v76, v76
  v_mfma_f32_16x16x32_bf16 a[0:3], a[192:195], v[224:227], a[0:3]
  s_waitcnt lgkmcnt(6)
  ds_read_b128 a[184:187], v36 offset:4096
  ds_read_b128 a[188:191], v37 offset:4096
  v_mfma_f32_16x16x32_bf16 a[0:3], a[196:199], v[228:231], a[0:3]
  v_exp_f32 v77, v77
  v_mfma_f32_16x16x32_bf16 a[4:7], a[196:199], v[236:239], a[4:7]
  v_add_f32 v164, v164, v68
  v_cvt_pk_bf16_f32 v200, v76, v77
  v_mfma_f32_16x16x32_bf16 a[4:7], a[192:195], v[232:235], a[4:7]
  v_exp_f32 v78, v78
  v_mfma_f32_16x16x32_bf16 a[8:11], a[192:195], v[240:243], a[8:11]
  buffer_load_dwordx4 v30, s[20:23], s69 offen offset:2048 lds
  v_mfma_f32_16x16x32_bf16 a[8:11], a[196:199], v[244:247], a[8:11]
  v_exp_f32 v79, v79
  v_mfma_f32_16x16x32_bf16 a[12:15], a[196:199], v[252:255], a[12:15]
  v_add_f32 v164, v164, v69
  v_cvt_pk_bf16_f32 v201, v78, v79
  v_mfma_f32_16x16x32_bf16 a[12:15], a[192:195], v[248:251], a[12:15]
  s_waitcnt lgkmcnt(6)
  v_exp_f32 v84, v84
  v_mfma_f32_16x16x32_bf16 a[28:31], a[200:203], v[248:251], a[28:31]
  s_waitcnt lgkmcnt(4)
  ds_read_b64_tr_b16 a[208:209], v40 offset:32768
  v_add_f32 v164, v164, v70
  v_mfma_f32_16x16x32_bf16 a[28:31], a[204:207], v[252:255], a[28:31]
  v_exp_f32 v85, v85
  v_mfma_f32_16x16x32_bf16 a[24:27], a[204:207], v[244:247], a[24:27]
  ds_read_b64_tr_b16 a[210:211], v40 offset:36864
  v_cvt_pk_bf16_f32 v208, v84, v85
  v_mfma_f32_16x16x32_bf16 a[24:27], a[200:203], v[240:243], a[24:27]
  v_exp_f32 v86, v86
  v_mfma_f32_16x16x32_bf16 a[20:23], a[200:203], v[232:235], a[20:23]
  ds_read_b64_tr_b16 a[212:213], v40 offset:40960
  v_add_f32 v164, v164, v71
  v_mfma_f32_16x16x32_bf16 a[20:23], a[204:207], v[236:239], a[20:23]
  v_exp_f32 v87, v87
  v_mfma_f32_16x16x32_bf16 a[16:19], a[204:207], v[228:231], a[16:19]
  ds_read_b64_tr_b16 a[214:215], v40 offset:45056
  v_cvt_pk_bf16_f32 v209, v86, v87
  v_mfma_f32_16x16x32_bf16 a[16:19], a[200:203], v[224:227], a[16:19]
  s_waitcnt lgkmcnt(7)
  v_exp_f32 v92, v92
  v_mfma_f32_16x16x32_bf16 v[100:103], a[176:179], v[64:67], v[132:135]
  s_waitcnt lgkmcnt(6)
  ds_read_b64_tr_b16 a[216:217], v41 offset:32768
  ds_read_b64_tr_b16 a[218:219], v41 offset:36864
  v_mfma_f32_16x16x32_bf16 v[100:103], a[180:183], v[96:99], v[100:103]
  s_waitcnt lgkmcnt(7)
  v_exp_f32 v93, v93
  v_mfma_f32_16x16x32_bf16 v[100:103], a[184:187], v[128:131], v[100:103]
  s_waitcnt lgkmcnt(6)
  ds_read_b64_tr_b16 a[220:221], v41 offset:40960
  v_cvt_pk_bf16_f32 v216, v92, v93
  v_mfma_f32_16x16x32_bf16 v[100:103], a[188:191], v[160:163], v[100:103]
  v_exp_f32 v94, v94
  v_mfma_f32_16x16x32_bf16 v[108:111], a[188:191], v[168:171], v[140:143]
  buffer_load_dwordx4 v31, s[20:23], s69 offen offset:3072 lds
  v_mfma_f32_16x16x32_bf16 v[108:111], a[184:187], v[136:139], v[108:111]
  s_add_u32 s69, s69, 16384
  v_exp_f32 v95, v95
  v_mfma_f32_16x16x32_bf16 v[108:111], a[180:183], v[104:107], v[108:111]
  ds_read_b64_tr_b16 a[222:223], v41 offset:45056
  v_cvt_pk_bf16_f32 v217, v94, v95
  v_mfma_f32_16x16x32_bf16 v[108:111], a[176:179], v[72:75], v[108:111]
  v_exp_f32 v100, v100
  v_mfma_f32_16x16x32_bf16 v[116:119], a[176:179], v[80:83], v[148:151]
  ds_read_b128 a[160:163], v34 offset:8192
  v_add_f32 v166, v166, v84
  v_mfma_f32_16x16x32_bf16 v[116:119], a[180:183], v[112:115], v[116:119]
  v_exp_f32 v101, v101
  v_mfma_f32_16x16x32_bf16 v[116:119], a[184:187], v[144:147], v[116:119]
  v_add_f32 v166, v166, v85
  v_cvt_pk_bf16_f32 v194, v100, v101
  v_mfma_f32_16x16x32_bf16 v[116:119], a[188:191], v[176:179], v[116:119]
  v_exp_f32 v102, v102
  v_mfma_f32_16x16x32_bf16 v[124:127], a[188:191], v[184:187], v[156:159]
  ds_read_b128 a[164:167], v35 offset:8192
  v_add_f32 v166, v166, v86
  v_mfma_f32_16x16x32_bf16 v[124:127], a[184:187], v[152:155], v[124:127]
  v_exp_f32 v103, v103
  v_mfma_f32_16x16x32_bf16 v[124:127], a[180:183], v[120:123], v[124:127]
  v_add_f32 v166, v166, v87
  v_cvt_pk_bf16_f32 v195, v102, v103
  v_mfma_f32_16x16x32_bf16 v[124:127], a[176:179], v[88:91], v[124:127]
  s_waitcnt lgkmcnt(8)
  v_exp_f32 v108, v108
  v_mfma_f32_16x16x32_bf16 a[32:35], a[208:211], v[224:227], a[32:35]
  s_waitcnt lgkmcnt(6)
  ds_read_b128 a[168:171], v36 offset:8192
  ds_read_b128 a[172:175], v37 offset:8192
  v_mfma_f32_16x16x32_bf16 a[32:35], a[212:215], v[228:231], a[32:35]
  v_exp_f32 v109, v109
  v_mfma_f32_16x16x32_bf16 a[36:39], a[212:215], v[236:239], a[36:39]
  v_add_f32 v164, v164, v100
  v_cvt_pk_bf16_f32 v202, v108, v109
  v_mfma_f32_16x16x32_bf16 a[36:39], a[208:211], v[232:235], a[36:39]
  s_add_u32 m0, s68, 0
  v_exp_f32 v110, v110
  v_mfma_f32_16x16x32_bf16 a[40:43], a[208:211], v[240:243], a[40:43]
  buffer_load_dwordx4 v32, s[24:27], s70 offen offset:0 lds
  v_mfma_f32_16x16x32_bf16 a[40:43], a[212:215], v[244:247], a[40:43]
  v_exp_f32 v111, v111
  v_mfma_f32_16x16x32_bf16 a[44:47], a[212:215], v[252:255], a[44:47]
  v_add_f32 v164, v164, v101
  v_cvt_pk_bf16_f32 v203, v110, v111
  v_mfma_f32_16x16x32_bf16 a[44:47], a[208:211], v[248:251], a[44:47]
  s_waitcnt lgkmcnt(6)
  ds_read_b64_tr_b16 a[192:193], v42 offset:32768
  v_add_f32 v164, v164, v102
  v_mfma_f32_16x16x32_bf16 a[60:63], a[216:219], v[248:251], a[60:63]
  s_waitcnt lgkmcnt(5)
  v_exp_f32 v116, v116
  v_mfma_f32_16x16x32_bf16 a[60:63], a[220:223], v[252:255], a[60:63]
  ds_read_b64_tr_b16 a[194:195], v42 offset:36864
  v_add_f32 v164, v164, v103
  v_mfma_f32_16x16x32_bf16 a[56:59], a[220:223], v[244:247], a[56:59]
  v_exp_f32 v117, v117
  v_mfma_f32_16x16x32_bf16 a[56:59], a[216:219], v[240:243], a[56:59]
  ds_read_b64_tr_b16 a[196:197], v42 offset:40960
  v_cvt_pk_bf16_f32 v210, v116, v117
  v_mfma_f32_16x16x32_bf16 a[52:55], a[216:219], v[232:235], a[52:55]
  v_exp_f32 v118, v118
  v_mfma_f32_16x16x32_bf16 a[52:55], a[220:223], v[236:239], a[52:55]
  buffer_store_dwordx4 a[228:231], v50, s[32:35], s100 offen offset:1024 sc1
  v_mfma_f32_16x16x32_bf16 a[48:51], a[220:223], v[228:231], a[48:51]
  s_add_u32 s100, s100, s101
  v_exp_f32 v119, v119
  v_mfma_f32_16x16x32_bf16 a[48:51], a[216:219], v[224:227], a[48:51]
  ds_read_b64_tr_b16 a[198:199], v42 offset:45056
  v_cvt_pk_bf16_f32 v211, v118, v119
  v_mfma_f32_16x16x32_bf16 a[132:135], a[144:147], v[232:235], a[132:135]
  v_exp_f32 v124, v124
  v_mfma_f32_16x16x32_bf16 a[132:135], a[144:147], v[236:239], a[132:135]
  s_waitcnt lgkmcnt(7)
  ds_read_b64_tr_b16 a[200:201], v43 offset:32768
  ds_read_b64_tr_b16 a[202:203], v43 offset:36864
  v_mfma_f32_16x16x32_bf16 v[68:71], a[160:163], v[64:67], v[132:135]
  s_waitcnt lgkmcnt(8)
  v_exp_f32 v125, v125
  v_mfma_f32_16x16x32_bf16 v[68:71], a[164:167], v[96:99], v[68:71]
  s_waitcnt lgkmcnt(7)
  ds_read_b64_tr_b16 a[204:205], v43 offset:40960
  v_cvt_pk_bf16_f32 v218, v124, v125
  v_mfma_f32_16x16x32_bf16 v[68:71], a[168:171], v[128:131], v[68:71]
  s_waitcnt lgkmcnt(7)
  v_exp_f32 v126, v126
  v_mfma_f32_16x16x32_bf16 v[68:71], a[172:175], v[160:163], v[68:71]
  buffer_load_dwordx4 v33, s[24:27], s70 offen offset:1024 lds
  v_mfma_f32_16x16x32_bf16 v[76:79], a[172:175], v[168:171], v[140:143]
  v_exp_f32 v127, v127
  v_mfma_f32_16x16x32_bf16 v[76:79], a[168:171], v[136:139], v[76:79]
  ds_read_b64_tr_b16 a[206:207], v43 offset:45056
  v_cvt_pk_bf16_f32 v219, v126, v127
  v_mfma_f32_16x16x32_bf16 v[76:79], a[164:167], v[104:107], v[76:79]
  ds_read_b128 a[176:179], v34 offset:12288
  v_add_f32 v166, v166, v116
  v_mfma_f32_16x16x32_bf16 v[76:79], a[160:163], v[72:75], v[76:79]
  v_exp_f32 v68, v68
  v_mfma_f32_16x16x32_bf16 v[84:87], a[160:163], v[80:83], v[148:151]
  ds_read_b128 a[180:183], v35 offset:12288
  v_add_f32 v166, v166, v117
  v_mfma_f32_16x16x32_bf16 v[84:87], a[164:167], v[112:115], v[84:87]
  v_exp_f32 v69, v69
  v_mfma_f32_16x16x32_bf16 v[84:87], a[168:171], v[144:147], v[84:87]
  v_add_f32 v166, v166, v118
  v_cvt_pk_bf16_f32 v196, v68, v69
  v_mfma_f32_16x16x32_bf16 v[84:87], a[172:175], v[176:179], v[84:87]
  v_exp_f32 v70, v70
  v_mfma_f32_16x16x32_bf16 v[92:95], a[172:175], v[184:187], v[156:159]
  ds_read_b128 a[184:187], v36 offset:12288
  v_add_f32 v166, v166, v119
  v_mfma_f32_16x16x32_bf16 v[92:95], a[168:171], v[152:155], v[92:95]
  v_exp_f32 v71, v71
  v_mfma_f32_16x16x32_bf16 v[92:95], a[164:167], v[120:123], v[92:95]
  ds_read_b128 a[188:191], v37 offset:12288
  v_cvt_pk_bf16_f32 v197, v70, v71
  v_mfma_f32_16x16x32_bf16 v[92:95], a[160:163], v[88:91], v[92:95]
  s_waitcnt lgkmcnt(10)
  v_exp_f32 v76, v76
  v_mfma_f32_16x16x32_bf16 a[64:67], a[192:195], v[224:227], a[64:67]
  s_waitcnt lgkmcnt(8)
  ds_read_b64_tr_b16 a[208:209], v44 offset:32768
  v_add_f32 v164, v164, v68
  v_mfma_f32_16x16x32_bf16 a[64:67], a[196:199], v[228:231], a[64:67]
  v_exp_f32 v77, v77
  v_mfma_f32_16x16x32_bf16 a[68:71], a[196:199], v[236:239], a[68:71]
  buffer_load_dwordx4 v32, s[24:27], s70 offen offset:2048 lds
  v_mfma_f32_16x16x32_bf16 a[68:71], a[192:195], v[232:235], a[68:71]
  v_exp_f32 v78, v78
  v_mfma_f32_16x16x32_bf16 a[72:75], a[192:195], v[240:243], a[72:75]
  v_add_f32 v164, v164, v69
  v_cvt_pk_bf16_f32 v204, v76, v77
  v_mfma_f32_16x16x32_bf16 a[72:75], a[196:199], v[244:247], a[72:75]
  v_exp_f32 v79, v79
  v_mfma_f32_16x16x32_bf16 a[76:79], a[196:199], v[252:255], a[76:79]
  v_add_f32 v164, v164, v70
  v_cvt_pk_bf16_f32 v205, v78, v79
  v_mfma_f32_16x16x32_bf16 a[76:79], a[192:195], v[248:251], a[76:79]
  s_waitcnt lgkmcnt(7)
  v_exp_f32 v84, v84
  v_mfma_f32_16x16x32_bf16 a[92:95], a[200:203], v[248:251], a[92:95]
  s_waitcnt lgkmcnt(5)
  ds_read_b64_tr_b16 a[210:211], v44 offset:36864
  v_add_f32 v164, v164, v71
  v_mfma_f32_16x16x32_bf16 a[92:95], a[204:207], v[252:255], a[92:95]
  v_exp_f32 v85, v85
  v_mfma_f32_16x16x32_bf16 a[88:91], a[204:207], v[244:247], a[88:91]
  ds_read_b64_tr_b16 a[212:213], v44 offset:40960
  v_cvt_pk_bf16_f32 v212, v84, v85
  v_mfma_f32_16x16x32_bf16 a[88:91], a[200:203], v[240:243], a[88:91]
  v_exp_f32 v86, v86
  v_mfma_f32_16x16x32_bf16 a[84:87], a[200:203], v[232:235], a[84:87]
  ds_read_b64_tr_b16 a[214:215], v44 offset:45056
  ds_read_b64_tr_b16 a[216:217], v45 offset:32768
  v_mfma_f32_16x16x32_bf16 a[84:87], a[204:207], v[236:239], a[84:87]
  v_exp_f32 v87, v87
  v_mfma_f32_16x16x32_bf16 a[80:83], a[204:207], v[228:231], a[80:83]
  ds_read_b64_tr_b16 a[218:219], v45 offset:36864
  v_cvt_pk_bf16_f32 v213, v86, v87
  v_mfma_f32_16x16x32_bf16 a[80:83], a[200:203], v[224:227], a[80:83]
  s_waitcnt lgkmcnt(9)
  v_exp_f32 v92, v92
  v_mfma_f32_16x16x32_bf16 v[100:103], a[176:179], v[64:67], v[132:135]
  s_waitcnt lgkmcnt(8)
  ds_read_b64_tr_b16 a[220:221], v45 offset:40960
  ds_read_b64_tr_b16 a[222:223], v45 offset:45056
  v_mfma_f32_16x16x32_bf16 v[100:103], a[180:183], v[96:99], v[100:103]
  s_waitcnt lgkmcnt(9)
  v_exp_f32 v93, v93
  v_mfma_f32_16x16x32_bf16 v[100:103], a[184:187], v[128:131], v[100:103]
  s_waitcnt lgkmcnt(8)
  buffer_load_dwordx4 v33, s[24:27], s70 offen offset:3072 lds
  v_mfma_f32_16x16x32_bf16 v[100:103], a[188:191], v[160:163], v[100:103]
  s_add_u32 s70, s70, 16384
  v_exp_f32 v94, v94
  v_mfma_f32_16x16x32_bf16 v[108:111], a[188:191], v[168:171], v[140:143]
  v_add_f32 v166, v166, v84
  v_cvt_pk_bf16_f32 v220, v92, v93
  v_mfma_f32_16x16x32_bf16 v[108:111], a[184:187], v[136:139], v[108:111]
  v_exp_f32 v95, v95
  v_mfma_f32_16x16x32_bf16 v[108:111], a[180:183], v[104:107], v[108:111]
  v_add_f32 v166, v166, v85
  v_cvt_pk_bf16_f32 v221, v94, v95
  v_mfma_f32_16x16x32_bf16 v[108:111], a[176:179], v[72:75], v[108:111]
  v_exp_f32 v100, v100
  v_mfma_f32_16x16x32_bf16 v[116:119], a[176:179], v[80:83], v[148:151]
  v_add_f32 v166, v166, v86
  v_add_f32 v164, v164, v100
  v_mfma_f32_16x16x32_bf16 v[116:119], a[180:183], v[112:115], v[116:119]
  v_exp_f32 v101, v101
  v_mfma_f32_16x16x32_bf16 v[116:119], a[184:187], v[144:147], v[116:119]
  v_add_f32 v166, v166, v87
  v_cvt_pk_bf16_f32 v198, v100, v101
  v_mfma_f32_16x16x32_bf16 v[116:119], a[188:191], v[176:179], v[116:119]
  v_exp_f32 v102, v102
  v_mfma_f32_16x16x32_bf16 v[124:127], a[188:191], v[184:187], v[156:159]
  v_add_f32 v164, v164, v101
  v_mfma_f32_16x16x32_bf16 v[124:127], a[184:187], v[152:155], v[124:127]
  v_exp_f32 v103, v103
  v_mfma_f32_16x16x32_bf16 v[124:127], a[180:183], v[120:123], v[124:127]
  v_add_f32 v164, v164, v102
  v_cvt_pk_bf16_f32 v199, v102, v103
  v_mfma_f32_16x16x32_bf16 v[124:127], a[176:179], v[88:91], v[124:127]
  s_waitcnt lgkmcnt(6)
  v_exp_f32 v108, v108
  v_mfma_f32_16x16x32_bf16 a[96:99], a[208:211], v[224:227], a[96:99]
  s_waitcnt lgkmcnt(4)
  v_add_f32 v164, v164, v103
  v_mfma_f32_16x16x32_bf16 a[96:99], a[212:215], v[228:231], a[96:99]
  v_exp_f32 v109, v109
  v_mfma_f32_16x16x32_bf16 a[100:103], a[212:215], v[236:239], a[100:103]
  v_cvt_pk_bf16_f32 v206, v108, v109
  v_mfma_f32_16x16x32_bf16 a[100:103], a[208:211], v[232:235], a[100:103]
  v_exp_f32 v110, v110
  v_mfma_f32_16x16x32_bf16 a[104:107], a[208:211], v[240:243], a[104:107]
  s_waitcnt vmcnt(10)
  s_barrier
  ds_read_b128 a[160:163], v34 offset:16384
  v_mfma_f32_16x16x32_bf16 a[104:107], a[212:215], v[244:247], a[104:107]
  s_add_u32 m0, s67, 49152
  v_exp_f32 v111, v111
  v_mfma_f32_16x16x32_bf16 a[108:111], a[212:215], v[252:255], a[108:111]
  buffer_load_dwordx4 v28, s[20:23], s69 offen offset:0 lds
  v_mfma_f32_16x16x32_bf16 a[108:111], a[208:211], v[248:251], a[108:111]
  s_waitcnt lgkmcnt(3)
  ds_read_b128 a[164:167], v35 offset:16384
  ds_read_b128 a[168:171], v36 offset:16384
  v_mfma_f32_16x16x32_bf16 a[124:127], a[216:219], v[248:251], a[124:127]
  s_waitcnt lgkmcnt(3)
  v_exp_f32 v116, v116
  v_mfma_f32_16x16x32_bf16 a[124:127], a[220:223], v[252:255], a[124:127]
  ds_read_b128 a[172:175], v37 offset:16384
  v_cvt_pk_bf16_f32 v207, v110, v111
  v_mfma_f32_16x16x32_bf16 a[120:123], a[220:223], v[244:247], a[120:123]
  v_exp_f32 v117, v117
  v_mfma_f32_16x16x32_bf16 a[120:123], a[216:219], v[240:243], a[120:123]
  ds_read_b64_tr_b16 a[192:193], v38 offset:49152
  v_cvt_pk_bf16_f32 v214, v116, v117
  v_mfma_f32_16x16x32_bf16 a[116:119], a[216:219], v[232:235], a[116:119]
  v_exp_f32 v118, v118
  v_mfma_f32_16x16x32_bf16 a[116:119], a[220:223], v[236:239], a[116:119]
  ds_read_b64_tr_b16 a[194:195], v38 offset:53248
  ds_read_b64_tr_b16 a[196:197], v38 offset:57344
  v_mfma_f32_16x16x32_bf16 a[112:115], a[220:223], v[228:231], a[112:115]
  v_exp_f32 v119, v119
  v_mfma_f32_16x16x32_bf16 a[112:115], a[216:219], v[224:227], a[112:115]
  ds_read_b64_tr_b16 a[198:199], v38 offset:61440
  v_cvt_pk_bf16_f32 v215, v118, v119
  v_mfma_f32_16x16x32_bf16 a[140:143], a[144:147], v[248:251], a[140:143]
  v_exp_f32 v124, v124
  v_mfma_f32_16x16x32_bf16 a[140:143], a[144:147], v[252:255], a[140:143]
  s_cmp_lg_u32 s71, 0
  ds_read_b64_tr_b16 a[200:201], v39 offset:49152
  s_cbranch_scc1 att_loop
att_last:
  s_waitcnt lgkmcnt(8)
  v_mfma_f32_16x16x32_bf16 v[68:71], a[160:163], v[64:67], v[132:135]
  s_waitcnt lgkmcnt(7)
  v_exp_f32 v125, v125
  v_mfma_f32_16x16x32_bf16 v[68:71], a[164:167], v[96:99], v[68:71]
  s_waitcnt lgkmcnt(6)
  buffer_load_dword v59, off, s[4:7], s58 sc1
  v_mfma_f32_16x16x32_bf16 v[68:71], a[168:171], v[128:131], v[68:71]
  s_waitcnt lgkmcnt(5)
  v_exp_f32 v126, v126
  v_mfma_f32_16x16x32_bf16 v[68:71], a[172:175], v[160:163], v[68:71]
  ds_read_b64_tr_b16 a[202:203], v39 offset:53248
  v_cvt_pk_bf16_f32 v222, v124, v125
  v_mfma_f32_16x16x32_bf16 v[76:79], a[172:175], v[168:171], v[140:143]
  v_exp_f32 v127, v127
  v_mfma_f32_16x16x32_bf16 v[76:79], a[168:171], v[136:139], v[76:79]
  buffer_load_dwordx4 v29, s[20:23], s69 offen offset:1024 lds
  v_mfma_f32_16x16x32_bf16 v[76:79], a[164:167], v[104:107], v[76:79]
  ds_read_b64_tr_b16 a[204:205], v39 offset:57344
  v_cvt_pk_bf16_f32 v223, v126, v127
  v_mfma_f32_16x16x32_bf16 v[76:79], a[160:163], v[72:75], v[76:79]
  v_exp_f32 v68, v68
  v_mfma_f32_16x16x32_bf16 v[84:87], a[160:163], v[80:83], v[148:151]
  ds_read_b64_tr_b16 a[206:207], v39 offset:61440
  v_add_f32 v166, v166, v116
  v_mfma_f32_16x16x32_bf16 v[84:87], a[164:167], v[112:115], v[84:87]
  v_exp_f32 v69, v69
  v_mfma_f32_16x16x32_bf16 v[84:87], a[168:171], v[144:147], v[84:87]
  v_add_f32 v166, v166, v117
  v_cvt_pk_bf16_f32 v224, v68, v69
  v_mfma_f32_16x16x32_bf16 v[84:87], a[172:175], v[176:179], v[84:87]
  v_exp_f32 v70, v70
  v_mfma_f32_16x16x32_bf16 v[92:95], a[172:175], v[184:187], v[156:159]
  buffer_load_dwordx4 v30, s[20:23], s69 offen offset:2048 lds
  v_mfma_f32_16x16x32_bf16 v[92:95], a[168:171], v[152:155], v[92:95]
  v_exp_f32 v71, v71
  v_mfma_f32_16x16x32_bf16 v[92:95], a[164:167], v[120:123], v[92:95]
  v_add_f32 v166, v166, v118
  v_cvt_pk_bf16_f32 v225, v70, v71
  v_mfma_f32_16x16x32_bf16 v[92:95], a[160:163], v[88:91], v[92:95]
  s_waitcnt lgkmcnt(6)
  v_exp_f32 v76, v76
  v_mfma_f32_16x16x32_bf16 a[0:3], a[192:195], v[192:195], a[0:3]
  s_waitcnt lgkmcnt(4)
  ds_read_b128 a[176:179], v34 offset:20480
  v_add_f32 v166, v166, v119
  v_mfma_f32_16x16x32_bf16 a[0:3], a[196:199], v[196:199], a[0:3]
  v_exp_f32 v77, v77
  v_mfma_f32_16x16x32_bf16 a[4:7], a[196:199], v[204:207], a[4:7]
  ds_read_b128 a[180:183], v35 offset:20480
  v_cvt_pk_bf16_f32 v232, v76, v77
  v_mfma_f32_16x16x32_bf16 a[4:7], a[192:195], v[200:203], a[4:7]
  v_exp_f32 v78, v78
  v_mfma_f32_16x16x32_bf16 a[8:11], a[192:195], v[208:211], a[8:11]
  ds_read_b128 a[184:187], v36 offset:20480
  ds_read_b128 a[188:191], v37 offset:20480
  v_mfma_f32_16x16x32_bf16 a[8:11], a[196:199], v[212:215], a[8:11]
  v_exp_f32 v79, v79
  v_mfma_f32_16x16x32_bf16 a[12:15], a[196:199], v[220:223], a[12:15]
  v_add_f32 v164, v164, v68
  v_cvt_pk_bf16_f32 v233, v78, v79
  v_mfma_f32_16x16x32_bf16 a[12:15], a[192:195], v[216:219], a[12:15]
  s_waitcnt lgkmcnt(6)
  v_exp_f32 v84, v84
  v_mfma_f32_16x16x32_bf16 a[28:31], a[200:203], v[216:219], a[28:31]
  s_waitcnt lgkmcnt(4)
  buffer_load_dwordx4 v31, s[20:23], s69 offen offset:3072 lds
  v_mfma_f32_16x16x32_bf16 a[28:31], a[204:207], v[220:223], a[28:31]
  s_add_u32 s69, s69, 16384
  v_exp_f32 v85, v85
  v_mfma_f32_16x16x32_bf16 a[24:27], a[204:207], v[212:215], a[24:27]
  v_add_f32 v164, v164, v69
  v_cvt_pk_bf16_f32 v240, v84, v85
  v_mfma_f32_16x16x32_bf16 a[24:27], a[200:203], v[208:211], a[24:27]
  v_exp_f32 v86, v86
  v_mfma_f32_16x16x32_bf16 a[20:23], a[200:203], v[200:203], a[20:23]
  ds_read_b64_tr_b16 a[208:209], v40 offset:49152
  v_add_f32 v164, v164, v70
  v_mfma_f32_16x16x32_bf16 a[20:23], a[204:207], v[204:207], a[20:23]
  v_exp_f32 v87, v87
  v_mfma_f32_16x16x32_bf16 a[16:19], a[204:207], v[196:199], a[16:19]
  ds_read_b64_tr_b16 a[210:211], v40 offset:53248
  v_cvt_pk_bf16_f32 v241, v86, v87
  v_mfma_f32_16x16x32_bf16 a[16:19], a[200:203], v[192:195], a[16:19]
  s_waitcnt lgkmcnt(5)
  v_exp_f32 v92, v92
  v_mfma_f32_16x16x32_bf16 v[100:103], a[176:179], v[64:67], v[132:135]
  s_waitcnt lgkmcnt(4)
  ds_read_b64_tr_b16 a[212:213], v40 offset:57344
  v_add_f32 v164, v164, v71
  v_mfma_f32_16x16x32_bf16 v[100:103], a[180:183], v[96:99], v[100:103]
  s_waitcnt lgkmcnt(4)
  v_exp_f32 v93, v93
  v_mfma_f32_16x16x32_bf16 v[100:103], a[184:187], v[128:131], v[100:103]
  s_lshr_b32 s73, s2, 4
  s_or_b32 s73, s73, s55
  s_cmp_eq_u32 s73, 0
  s_cbranch_scc0 sigd_e28
  s_and_b32 s73, s2, 7
  s_lshl_b32 s74, s73, 2
  v_lshl_add_u32 v54, v0, 5, s74
  v_mov_b32 v55, 4
  v_mov_b32 v52, s56
  v_mov_b32 v53, 0
  s_and_b32 s73, s73, 6
  s_lshl_b32 s73, 3, s73
  s_mov_b64 exec, 0xff
  s_andn2_b32 exec_lo, 0xff, s73
  buffer_atomic_or v55, v54, s[84:87], 0 offen sc1
  s_mov_b64 exec, 1
  buffer_atomic_cmpswap v[52:53], off, s[84:87], s50 sc1
  s_mov_b64 exec, -1
  s_nop 3
sigd_e28:
  s_waitcnt lgkmcnt(3)
  v_mfma_f32_16x16x32_bf16 v[100:103], a[188:191], v[160:163], v[100:103]
  s_add_u32 m0, s68, 16384
  v_exp_f32 v94, v94
  v_mfma_f32_16x16x32_bf16 v[108:111], a[188:191], v[168:171], v[140:143]
  buffer_load_dwordx4 v32, s[24:27], s70 offen offset:0 lds
  v_mfma_f32_16x16x32_bf16 v[108:111], a[184:187], v[136:139], v[108:111]
  v_exp_f32 v95, v95
  v_mfma_f32_16x16x32_bf16 v[108:111], a[180:183], v[104:107], v[108:111]
  ds_read_b64_tr_b16 a[214:215], v40 offset:61440
  v_cvt_pk_bf16_f32 v248, v92, v93
  v_mfma_f32_16x16x32_bf16 v[108:111], a[176:179], v[72:75], v[108:111]
  v_exp_f32 v100, v100
  v_mfma_f32_16x16x32_bf16 v[116:119], a[176:179], v[80:83], v[148:151]
  ds_read_b64_tr_b16 a[216:217], v41 offset:49152
  v_cvt_pk_bf16_f32 v249, v94, v95
  v_mfma_f32_16x16x32_bf16 v[116:119], a[180:183], v[112:115], v[116:119]
  v_exp_f32 v101, v101
  v_mfma_f32_16x16x32_bf16 v[116:119], a[184:187], v[144:147], v[116:119]
  ds_read_b64_tr_b16 a[218:219], v41 offset:53248
  v_add_co_u32 v60, vcc, (att_retry-att_last-8192)/36*4, v60
  v_mfma_f32_16x16x32_bf16 v[116:119], a[188:191], v[176:179], v[116:119]
  v_exp_f32 v102, v102
  v_mfma_f32_16x16x32_bf16 v[124:127], a[188:191], v[184:187], v[156:159]
  v_cvt_pk_bf16_f32 v226, v100, v101
  v_addc_co_u32 v61, vcc, 0, v61, vcc
  v_mfma_f32_16x16x32_bf16 v[124:127], a[184:187], v[152:155], v[124:127]
  v_exp_f32 v103, v103
  v_mfma_f32_16x16x32_bf16 v[124:127], a[180:183], v[120:123], v[124:127]
  ds_read_b64_tr_b16 a[220:221], v41 offset:57344
  ds_read_b64_tr_b16 a[222:223], v41 offset:61440
  v_mfma_f32_16x16x32_bf16 v[124:127], a[176:179], v[88:91], v[124:127]
  s_waitcnt lgkmcnt(6)
  v_exp_f32 v108, v108
  v_mfma_f32_16x16x32_bf16 a[32:35], a[208:211], v[192:195], a[32:35]
  s_waitcnt lgkmcnt(4)
  buffer_load_dwordx4 v33, s[24:27], s70 offen offset:1024 lds
  v_mfma_f32_16x16x32_bf16 a[32:35], a[212:215], v[196:199], a[32:35]
  v_exp_f32 v109, v109
  v_mfma_f32_16x16x32_bf16 a[36:39], a[212:215], v[204:207], a[36:39]
  v_add_f32 v166, v166, v84
  v_cvt_pk_bf16_f32 v227, v102, v103
  v_mfma_f32_16x16x32_bf16 a[36:39], a[208:211], v[200:203], a[36:39]
  v_exp_f32 v110, v110
  v_mfma_f32_16x16x32_bf16 a[40:43], a[208:211], v[208:211], a[40:43]
  v_add_f32 v166, v166, v85
  v_cvt_pk_bf16_f32 v234, v108, v109
  v_mfma_f32_16x16x32_bf16 a[40:43], a[212:215], v[212:215], a[40:43]
  v_exp_f32 v111, v111
  v_mfma_f32_16x16x32_bf16 a[44:47], a[212:215], v[220:223], a[44:47]
  global_load_dword v62, v[60:61], off
  v_mfma_f32_16x16x32_bf16 a[44:47], a[208:211], v[216:219], a[44:47]
  s_waitcnt lgkmcnt(2)
  ds_read_b128 a[160:163], v34 offset:24576
  v_add_f32 v166, v166, v86
  v_mfma_f32_16x16x32_bf16 a[60:63], a[216:219], v[216:219], a[60:63]
  s_waitcnt lgkmcnt(1)
  v_exp_f32 v116, v116
  v_mfma_f32_16x16x32_bf16 a[60:63], a[220:223], v[220:223], a[60:63]
  ds_read_b128 a[164:167], v35 offset:24576
  v_add_f32 v166, v166, v87
  v_mfma_f32_16x16x32_bf16 a[56:59], a[220:223], v[212:215], a[56:59]
  v_exp_f32 v117, v117
  v_mfma_f32_16x16x32_bf16 a[56:59], a[216:219], v[208:211], a[56:59]
  ds_read_b128 a[168:171], v36 offset:24576
  v_cvt_pk_bf16_f32 v235, v110, v111
  v_mfma_f32_16x16x32_bf16 a[52:55], a[216:219], v[200:203], a[52:55]
  v_exp_f32 v118, v118
  v_mfma_f32_16x16x32_bf16 a[52:55], a[220:223], v[204:207], a[52:55]
  ds_read_b128 a[172:175], v37 offset:24576
  v_cvt_pk_bf16_f32 v242, v116, v117
  v_mfma_f32_16x16x32_bf16 a[48:51], a[220:223], v[196:199], a[48:51]
pad_m_7:
  s_cbranch_execz warm_1
  v_exp_f32 v119, v119
  v_mfma_f32_16x16x32_bf16 a[48:51], a[216:219], v[192:195], a[48:51]
  buffer_load_dwordx4 v32, s[24:27], s70 offen offset:2048 lds
  v_mfma_f32_16x16x32_bf16 a[132:135], a[144:147], v[200:203], a[132:135]
  v_exp_f32 v124, v124
  v_mfma_f32_16x16x32_bf16 a[132:135], a[144:147], v[204:207], a[132:135]
  s_waitcnt lgkmcnt(3)
  v_add_f32 v164, v164, v100
  v_cvt_pk_bf16_f32 v243, v118, v119
  v_mfma_f32_16x16x32_bf16 v[68:71], a[160:163], v[64:67], v[132:135]
  s_waitcnt lgkmcnt(2)
  v_exp_f32 v125, v125
  v_mfma_f32_16x16x32_bf16 v[68:71], a[164:167], v[96:99], v[68:71]
  s_waitcnt vmcnt(7)
  v_readfirstlane_b32 s73, v59
  s_nop 0
  s_cmp_ge_u32 s73, 32
  s_cbranch_scc0 spin_x
back_x:
  s_waitcnt lgkmcnt(1)
  v_mfma_f32_16x16x32_bf16 v[68:71], a[168:171], v[128:131], v[68:71]
  s_waitcnt lgkmcnt(0)
  v_exp_f32 v126, v126
  v_add_co_u32 v60, vcc, (att_retry-att_last-8192)/36*4, v60
  v_mfma_f32_16x16x32_bf16 v[68:71], a[172:175], v[160:163], v[68:71]
  s_add_u32 s76, s59, 0
  v_add_f32 v164, v164, v101
  v_addc_co_u32 v61, vcc, 0, v61, vcc
  v_mfma_f32_16x16x32_bf16 v[76:79], a[172:175], v[168:171], v[140:143]
  v_exp_f32 v127, v127
  v_mfma_f32_16x16x32_bf16 v[76:79], a[168:171], v[136:139], v[76:79]
  buffer_load_dwordx4 a[224:227], v2, s[4:7], s76 offen offset:0 sc1
  v_add_f32 v164, v164, v102
  v_mfma_f32_16x16x32_bf16 v[76:79], a[164:167], v[104:107], v[76:79]
  v_add_f32 v164, v164, v103
  v_cvt_pk_bf16_f32 v250, v124, v125
  v_mfma_f32_16x16x32_bf16 v[76:79], a[160:163], v[72:75], v[76:79]
  v_exp_f32 v68, v68
  v_mfma_f32_16x16x32_bf16 v[84:87], a[160:163], v[80:83], v[148:151]
  ds_read_b64_tr_b16 a[192:193], v42 offset:49152
  ds_read_b64_tr_b16 a[194:195], v42 offset:53248
  v_mfma_f32_16x16x32_bf16 v[84:87], a[164:167], v[112:115], v[84:87]
  ds_read_b64_tr_b16 a[196:197], v42 offset:57344
  ds_read_b64_tr_b16 a[198:199], v42 offset:61440
  v_exp_f32 v69, v69
  v_mfma_f32_16x16x32_bf16 v[84:87], a[168:171], v[144:147], v[84:87]
  global_load_dword v62, v[60:61], off
  v_mfma_f32_16x16x32_bf16 v[84:87], a[172:175], v[176:179], v[84:87]
  buffer_load_dword v62, v63, s[12:15], 0 offen
  v_exp_f32 v70, v70
  v_mfma_f32_16x16x32_bf16 v[92:95], a[172:175], v[184:187], v[156:159]
  buffer_load_dword v62, v63, s[16:19], 0 offen
  v_cvt_pk_bf16_f32 v251, v126, v127
  v_mfma_f32_16x16x32_bf16 v[92:95], a[168:171], v[152:155], v[92:95]
  v_exp_f32 v71, v71
  v_mfma_f32_16x16x32_bf16 v[92:95], a[164:167], v[120:123], v[92:95]
  ds_read_b64_tr_b16 a[200:201], v43 offset:49152
  ds_read_b64_tr_b16 a[202:203], v43 offset:53248
  v_mfma_f32_16x16x32_bf16 v[92:95], a[160:163], v[88:91], v[92:95]
  s_waitcnt lgkmcnt(4)
  v_exp_f32 v76, v76
  v_mfma_f32_16x16x32_bf16 a[64:67], a[192:195], v[192:195], a[64:67]
  s_waitcnt lgkmcnt(2)
  buffer_load_dwordx4 v33, s[24:27], s70 offen offset:3072 lds
  v_mfma_f32_16x16x32_bf16 a[64:67], a[196:199], v[196:199], a[64:67]
  s_add_u32 s70, s70, 16384
  ds_read_b64_tr_b16 a[204:205], v43 offset:57344
  ds_read_b64_tr_b16 a[206:207], v43 offset:61440
  v_cvt_pk_bf16_f32 v228, v68, v69
  v_exp_f32 v77, v77
  v_mfma_f32_16x16x32_bf16 a[68:71], a[196:199], v[204:207], a[68:71]
  v_add_f32 v166, v166, v116
  v_cvt_pk_bf16_f32 v229, v70, v71
  v_mfma_f32_16x16x32_bf16 a[68:71], a[192:195], v[200:203], a[68:71]
  v_exp_f32 v78, v78
  v_mfma_f32_16x16x32_bf16 a[72:75], a[192:195], v[208:211], a[72:75]
  ds_read_b128 a[176:179], v34 offset:28672
  v_add_f32 v166, v166, v117
  v_mfma_f32_16x16x32_bf16 a[72:75], a[196:199], v[212:215], a[72:75]
  v_exp_f32 v79, v79
  v_mfma_f32_16x16x32_bf16 a[76:79], a[196:199], v[220:223], a[76:79]
  buffer_load_dwordx4 a[228:231], v2, s[4:7], s76 offen offset:1024 sc1
  v_add_f32 v166, v166, v118
  v_mfma_f32_16x16x32_bf16 a[76:79], a[192:195], v[216:219], a[76:79]
  s_waitcnt lgkmcnt(3)
  v_exp_f32 v84, v84
  v_mfma_f32_16x16x32_bf16 a[92:95], a[200:203], v[216:219], a[92:95]
  s_waitcnt lgkmcnt(1)
  v_add_f32 v166, v166, v119
  v_cvt_pk_bf16_f32 v236, v76, v77
  v_mfma_f32_16x16x32_bf16 a[92:95], a[204:207], v[220:223], a[92:95]
  ds_read_b128 a[180:183], v35 offset:28672
  v_exp_f32 v85, v85
  v_mfma_f32_16x16x32_bf16 a[88:91], a[204:207], v[212:215], a[88:91]
  s_add_u32 s76, s59, 4096
  ds_read_b128 a[184:187], v36 offset:28672
  ds_read_b128 a[188:191], v37 offset:28672
  v_mfma_f32_16x16x32_bf16 a[88:91], a[200:203], v[208:211], a[88:91]
  v_exp_f32 v86, v86
  v_mfma_f32_16x16x32_bf16 a[84:87], a[200:203], v[200:203], a[84:87]
  v_cvt_pk_bf16_f32 v237, v78, v79
  v_cvt_pk_bf16_f32 v244, v84, v85
  v_mfma_f32_16x16x32_bf16 a[84:87], a[204:207], v[204:207], a[84:87]
  v_exp_f32 v87, v87
  v_mfma_f32_16x16x32_bf16 a[80:83], a[204:207], v[196:199], a[80:83]
  buffer_load_dwordx4 a[232:235], v2, s[4:7], s76 offen offset:0 sc1
  v_mfma_f32_16x16x32_bf16 a[80:83], a[200:203], v[192:195], a[80:83]
  s_waitcnt lgkmcnt(3)
  v_exp_f32 v92, v92
  v_mfma_f32_16x16x32_bf16 v[100:103], a[176:179], v[64:67], v[132:135]
  s_waitcnt lgkmcnt(2)
  v_add_f32 v164, v164, v68
  v_cvt_pk_bf16_f32 v245, v86, v87
  v_mfma_f32_16x16x32_bf16 v[100:103], a[180:183], v[96:99], v[100:103]
  s_waitcnt lgkmcnt(1)
  v_exp_f32 v93, v93
  v_mfma_f32_16x16x32_bf16 v[100:103], a[184:187], v[128:131], v[100:103]
  s_waitcnt lgkmcnt(0)
  ds_read_b64_tr_b16 a[208:209], v44 offset:49152
  v_add_f32 v164, v164, v69
  v_mfma_f32_16x16x32_bf16 v[100:103], a[188:191], v[160:163], v[100:103]
  v_exp_f32 v94, v94
  v_mfma_f32_16x16x32_bf16 v[108:111], a[188:191], v[168:171], v[140:143]
  ds_read_b64_tr_b16 a[210:211], v44 offset:53248
  v_add_f32 v164, v164, v70
  v_mfma_f32_16x16x32_bf16 v[108:111], a[184:187], v[136:139], v[108:111]
  v_exp_f32 v95, v95
  v_mfma_f32_16x16x32_bf16 v[108:111], a[180:183], v[104:107], v[108:111]
  v_add_f32 v164, v164, v71
  v_cvt_pk_bf16_f32 v252, v92, v93
  v_mfma_f32_16x16x32_bf16 v[108:111], a[176:179], v[72:75], v[108:111]
  v_exp_f32 v100, v100
  v_mfma_f32_16x16x32_bf16 v[116:119], a[176:179], v[80:83], v[148:151]
  ds_read_b64_tr_b16 a[212:213], v44 offset:57344
  ds_read_b64_tr_b16 a[214:215], v44 offset:61440
  v_mfma_f32_16x16x32_bf16 v[116:119], a[180:183], v[112:115], v[116:119]
  v_exp_f32 v101, v101
  v_mfma_f32_16x16x32_bf16 v[116:119], a[184:187], v[144:147], v[116:119]
  buffer_load_dwordx4 a[236:239], v2, s[4:7], s76 offen offset:1024 sc1
  v_mfma_f32_16x16x32_bf16 v[116:119], a[188:191], v[176:179], v[116:119]
  v_exp_f32 v102, v102
  v_mfma_f32_16x16x32_bf16 v[124:127], a[188:191], v[184:187], v[156:159]
  ds_read_b64_tr_b16 a[216:217], v45 offset:49152
  v_cvt_pk_bf16_f32 v253, v94, v95
  v_mfma_f32_16x16x32_bf16 v[124:127], a[184:187], v[152:155], v[124:127]
  v_exp_f32 v103, v103
  v_mfma_f32_16x16x32_bf16 v[124:127], a[180:183], v[120:123], v[124:127]
  ds_read_b64_tr_b16 a[218:219], v45 offset:53248
  v_cvt_pk_bf16_f32 v230, v100, v101
  v_mfma_f32_16x16x32_bf16 v[124:127], a[176:179], v[88:91], v[124:127]
  s_waitcnt lgkmcnt(4)
  v_exp_f32 v108, v108
  v_mfma_f32_16x16x32_bf16 a[96:99], a[208:211], v[192:195], a[96:99]
  s_waitcnt lgkmcnt(2)
  ds_read_b64_tr_b16 a[220:221], v45 offset:57344
  ds_read_b64_tr_b16 a[222:223], v45 offset:61440
  v_mfma_f32_16x16x32_bf16 a[96:99], a[212:215], v[196:199], a[96:99]
  v_exp_f32 v109, v109
  v_mfma_f32_16x16x32_bf16 a[100:103], a[212:215], v[204:207], a[100:103]
  v_add_f32 v166, v166, v84
  v_cvt_pk_bf16_f32 v231, v102, v103
  v_mfma_f32_16x16x32_bf16 a[100:103], a[208:211], v[200:203], a[100:103]
  v_exp_f32 v110, v110
  v_mfma_f32_16x16x32_bf16 a[104:107], a[208:211], v[208:211], a[104:107]
  s_waitcnt lgkmcnt(0)
  s_barrier
  v_add_f32 v166, v166, v85
  v_mfma_f32_16x16x32_bf16 a[104:107], a[212:215], v[212:215], a[104:107]
  s_add_u32 m0, s68, 32768
  v_exp_f32 v111, v111
  v_mfma_f32_16x16x32_bf16 a[108:111], a[212:215], v[220:223], a[108:111]
  v_add_f32 v166, v166, v86
  v_cvt_pk_bf16_f32 v238, v108, v109
  v_mfma_f32_16x16x32_bf16 a[108:111], a[208:211], v[216:219], a[108:111]
  ds_read_b128 a[160:163], v34 offset:32768
  v_add_f32 v166, v166, v87
  v_mfma_f32_16x16x32_bf16 a[124:127], a[216:219], v[216:219], a[124:127]
  v_exp_f32 v116, v116
  v_mfma_f32_16x16x32_bf16 a[124:127], a[220:223], v[220:223], a[124:127]
  buffer_load_dwordx4 v32, s[24:27], s70 offen offset:0 lds
  v_mfma_f32_16x16x32_bf16 a[120:123], a[220:223], v[212:215], a[120:123]
  v_exp_f32 v117, v117
  v_mfma_f32_16x16x32_bf16 a[120:123], a[216:219], v[208:211], a[120:123]
  ds_read_b128 a[164:167], v35 offset:32768
  ds_read_b128 a[168:171], v36 offset:32768
  v_mfma_f32_16x16x32_bf16 a[116:119], a[216:219], v[200:203], a[116:119]
  v_exp_f32 v118, v118
  v_mfma_f32_16x16x32_bf16 a[116:119], a[220:223], v[204:207], a[116:119]
  ds_read_b128 a[172:175], v37 offset:32768
  v_cvt_pk_bf16_f32 v239, v110, v111
  v_mfma_f32_16x16x32_bf16 a[112:115], a[220:223], v[196:199], a[112:115]
  v_exp_f32 v119, v119
  v_mfma_f32_16x16x32_bf16 a[112:115], a[216:219], v[192:195], a[112:115]
  v_add_f32 v164, v164, v100
  v_cvt_pk_bf16_f32 v246, v116, v117
  v_mfma_f32_16x16x32_bf16 a[140:143], a[144:147], v[216:219], a[140:143]
  v_exp_f32 v124, v124
  v_mfma_f32_16x16x32_bf16 a[140:143], a[144:147], v[220:223], a[140:143]
  s_lshr_b32 s73, s2, 4
  s_or_b32 s73, s73, s55
  s_cmp_eq_u32 s73, 0
  s_cbranch_scc0 sigd_e29
  s_waitcnt vmcnt(13)
  s_and_b32 s73, s2, 7
  s_lshl_b32 s74, s73, 5
  v_lshl_add_u32 v54, v0, 2, s74
  v_mov_b32 v52, 1
  v_mov_b32 v53, 0
  s_and_b32 s73, s73, 6
  s_lshl_b32 s73, 3, s73
  s_mov_b64 exec, 0xff
  s_andn2_b32 exec_lo, 0xff, s73
  buffer_atomic_cmpswap v[52:53], v54, s[84:87], 0 offen sc1
  s_mov_b64 exec, -1
  s_nop 3
sigd_e29:
  s_waitcnt lgkmcnt(3)
  v_mfma_f32_16x16x32_bf16 v[68:71], a[160:163], v[64:67], v[132:135]
  s_waitcnt lgkmcnt(2)
  v_exp_f32 v125, v125
  v_mfma_f32_16x16x32_bf16 v[68:71], a[164:167], v[96:99], v[68:71]
  s_waitcnt lgkmcnt(1)
  buffer_load_dwordx4 v33, s[24:27], s70 offen offset:1024 lds
  v_mfma_f32_16x16x32_bf16 v[68:71], a[168:171], v[128:131], v[68:71]
  s_waitcnt lgkmcnt(0)
  v_exp_f32 v126, v126
  v_mfma_f32_16x16x32_bf16 v[68:71], a[172:175], v[160:163], v[68:71]
  v_add_f32 v164, v164, v101
  v_cvt_pk_bf16_f32 v247, v118, v119
  v_mfma_f32_16x16x32_bf16 v[76:79], a[172:175], v[168:171], v[140:143]
  v_exp_f32 v127, v127
  v_mfma_f32_16x16x32_bf16 v[76:79], a[168:171], v[136:139], v[76:79]
  v_add_f32 v164, v164, v102
  v_cvt_pk_bf16_f32 v254, v124, v125
  v_mfma_f32_16x16x32_bf16 v[76:79], a[164:167], v[104:107], v[76:79]
  ds_read_b64_tr_b16 a[192:193], v38 offset:0
  v_add_f32 v164, v164, v103
  v_mfma_f32_16x16x32_bf16 v[76:79], a[160:163], v[72:75], v[76:79]
  v_exp_f32 v68, v68
  v_mfma_f32_16x16x32_bf16 v[84:87], a[160:163], v[80:83], v[148:151]
  ds_read_b64_tr_b16 a[194:195], v38 offset:4096
  ds_read_b64_tr_b16 a[196:197], v38 offset:8192
  v_mfma_f32_16x16x32_bf16 v[84:87], a[164:167], v[112:115], v[84:87]
  ds_read_b64_tr_b16 a[198:199], v38 offset:12288
  v_exp_f32 v69, v69
  v_mfma_f32_16x16x32_bf16 v[84:87], a[168:171], v[144:147], v[84:87]
  buffer_load_dwordx4 v32, s[24:27], s70 offen offset:2048 lds
  v_mfma_f32_16x16x32_bf16 v[84:87], a[172:175], v[176:179], v[84:87]
  v_exp_f32 v70, v70
  v_mfma_f32_16x16x32_bf16 v[92:95], a[172:175], v[184:187], v[156:159]
  ds_read_b64_tr_b16 a[200:201], v39 offset:0
  v_cvt_pk_bf16_f32 v255, v126, v127
  v_mfma_f32_16x16x32_bf16 v[92:95], a[168:171], v[152:155], v[92:95]
  v_exp_f32 v71, v71
  v_mfma_f32_16x16x32_bf16 v[92:95], a[164:167], v[120:123], v[92:95]
  ds_read_b64_tr_b16 a[202:203], v39 offset:4096
  v_cvt_pk_bf16_f32 v192, v68, v69
  v_mfma_f32_16x16x32_bf16 v[92:95], a[160:163], v[88:91], v[92:95]
  s_waitcnt lgkmcnt(4)
  v_exp_f32 v76, v76
  v_mfma_f32_16x16x32_bf16 a[0:3], a[192:195], v[224:227], a[0:3]
  s_waitcnt lgkmcnt(2)
  ds_read_b64_tr_b16 a[204:205], v39 offset:8192
  ds_read_b64_tr_b16 a[206:207], v39 offset:12288
  v_mfma_f32_16x16x32_bf16 a[0:3], a[196:199], v[228:231], a[0:3]
  v_exp_f32 v77, v77
  v_mfma_f32_16x16x32_bf16 a[4:7], a[196:199], v[236:239], a[4:7]
  v_add_f32 v166, v166, v116
  v_cvt_pk_bf16_f32 v193, v70, v71
  v_mfma_f32_16x16x32_bf16 a[4:7], a[192:195], v[232:235], a[4:7]
  v_exp_f32 v78, v78
  v_mfma_f32_16x16x32_bf16 a[8:11], a[192:195], v[240:243], a[8:11]
  buffer_load_dwordx4 v33, s[24:27], s70 offen offset:3072 lds
  v_add_f32 v166, v166, v117
  v_mfma_f32_16x16x32_bf16 a[8:11], a[196:199], v[244:247], a[8:11]
  v_exp_f32 v79, v79
  v_mfma_f32_16x16x32_bf16 a[12:15], a[196:199], v[252:255], a[12:15]
  ds_read_b128 a[176:179], v34 offset:36864
  v_add_f32 v166, v166, v118
  v_mfma_f32_16x16x32_bf16 a[12:15], a[192:195], v[248:251], a[12:15]
  s_waitcnt lgkmcnt(3)
  v_exp_f32 v84, v84
  v_mfma_f32_16x16x32_bf16 a[28:31], a[200:203], v[248:251], a[28:31]
  s_waitcnt lgkmcnt(1)
  v_add_f32 v166, v166, v119
  v_cvt_pk_bf16_f32 v200, v76, v77
  v_mfma_f32_16x16x32_bf16 a[28:31], a[204:207], v[252:255], a[28:31]
  ds_read_b128 a[180:183], v35 offset:36864
  v_exp_f32 v85, v85
  v_mfma_f32_16x16x32_bf16 a[24:27], a[204:207], v[244:247], a[24:27]
  ds_read_b128 a[184:187], v36 offset:36864
  ds_read_b128 a[188:191], v37 offset:36864
  v_mfma_f32_16x16x32_bf16 a[24:27], a[200:203], v[240:243], a[24:27]
  s_add_u32 s61, s80, 0
  v_exp_f32 v86, v86
  v_mfma_f32_16x16x32_bf16 a[20:23], a[200:203], v[232:235], a[20:23]
  s_add_u32 m0, s63, 0
  v_cvt_pk_bf16_f32 v201, v78, v79
  v_cvt_pk_bf16_f32 v208, v84, v85
  v_mfma_f32_16x16x32_bf16 a[20:23], a[204:207], v[236:239], a[20:23]
  s_add_u32 s70, s70, 16384
  v_exp_f32 v87, v87
  v_mfma_f32_16x16x32_bf16 a[16:19], a[204:207], v[228:231], a[16:19]
  buffer_load_dwordx4 v14, s[12:15], s61 offen offset:0 lds
  v_mfma_f32_16x16x32_bf16 a[16:19], a[200:203], v[224:227], a[16:19]
  s_waitcnt lgkmcnt(3)
  v_exp_f32 v92, v92
  v_mfma_f32_16x16x32_bf16 v[100:103], a[176:179], v[64:67], v[132:135]
  s_waitcnt lgkmcnt(2)
  v_add_f32 v164, v164, v68
  v_cvt_pk_bf16_f32 v209, v86, v87
  v_mfma_f32_16x16x32_bf16 v[100:103], a[180:183], v[96:99], v[100:103]
  s_waitcnt lgkmcnt(1)
  v_exp_f32 v93, v93
  v_mfma_f32_16x16x32_bf16 v[100:103], a[184:187], v[128:131], v[100:103]
  s_waitcnt lgkmcnt(0)
  ds_read_b64_tr_b16 a[208:209], v40 offset:0
  v_add_f32 v164, v164, v69
  v_mfma_f32_16x16x32_bf16 v[100:103], a[188:191], v[160:163], v[100:103]
  v_exp_f32 v94, v94
  v_mfma_f32_16x16x32_bf16 v[108:111], a[188:191], v[168:171], v[140:143]
  ds_read_b64_tr_b16 a[210:211], v40 offset:4096
  v_add_f32 v164, v164, v70
  v_mfma_f32_16x16x32_bf16 v[108:111], a[184:187], v[136:139], v[108:111]
  v_exp_f32 v95, v95
  v_mfma_f32_16x16x32_bf16 v[108:111], a[180:183], v[104:107], v[108:111]
  v_add_f32 v164, v164, v71
  v_cvt_pk_bf16_f32 v216, v92, v93
  v_mfma_f32_16x16x32_bf16 v[108:111], a[176:179], v[72:75], v[108:111]
  v_exp_f32 v100, v100
  v_mfma_f32_16x16x32_bf16 v[116:119], a[176:179], v[80:83], v[148:151]
  buffer_load_dwordx4 v15, s[12:15], s61 offen offset:1024 lds
  v_mfma_f32_16x16x32_bf16 v[116:119], a[180:183], v[112:115], v[116:119]
  ds_read_b64_tr_b16 a[212:213], v40 offset:8192
  ds_read_b64_tr_b16 a[214:215], v40 offset:12288
  v_exp_f32 v101, v101
  v_mfma_f32_16x16x32_bf16 v[116:119], a[184:187], v[144:147], v[116:119]
  ds_read_b64_tr_b16 a[216:217], v41 offset:0
  v_cvt_pk_bf16_f32 v217, v94, v95
  v_mfma_f32_16x16x32_bf16 v[116:119], a[188:191], v[176:179], v[116:119]
  v_exp_f32 v102, v102
  v_mfma_f32_16x16x32_bf16 v[124:127], a[188:191], v[184:187], v[156:159]
  ds_read_b64_tr_b16 a[218:219], v41 offset:4096
  v_cvt_pk_bf16_f32 v194, v100, v101
  v_mfma_f32_16x16x32_bf16 v[124:127], a[184:187], v[152:155], v[124:127]
  v_exp_f32 v103, v103
  v_mfma_f32_16x16x32_bf16 v[124:127], a[180:183], v[120:123], v[124:127]
  ds_read_b64_tr_b16 a[220:221], v41 offset:8192
  ds_read_b64_tr_b16 a[222:223], v41 offset:12288
  v_mfma_f32_16x16x32_bf16 v[124:127], a[176:179], v[88:91], v[124:127]
  s_waitcnt lgkmcnt(6)
  v_exp_f32 v108, v108
  v_mfma_f32_16x16x32_bf16 a[32:35], a[208:211], v[224:227], a[32:35]
  s_waitcnt lgkmcnt(4)
  v_add_f32 v166, v166, v84
  v_cvt_pk_bf16_f32 v195, v102, v103
  v_mfma_f32_16x16x32_bf16 a[32:35], a[212:215], v[228:231], a[32:35]
  v_exp_f32 v109, v109
  v_mfma_f32_16x16x32_bf16 a[36:39], a[212:215], v[236:239], a[36:39]
  buffer_load_dwordx4 v16, s[12:15], s61 offen offset:2048 lds
  v_mfma_f32_16x16x32_bf16 a[36:39], a[208:211], v[232:235], a[36:39]
  v_exp_f32 v110, v110
  v_mfma_f32_16x16x32_bf16 a[40:43], a[208:211], v[240:243], a[40:43]
  v_add_f32 v166, v166, v85
  v_cvt_pk_bf16_f32 v202, v108, v109
  v_mfma_f32_16x16x32_bf16 a[40:43], a[212:215], v[244:247], a[40:43]
  v_exp_f32 v111, v111
  v_mfma_f32_16x16x32_bf16 a[44:47], a[212:215], v[252:255], a[44:47]
  ds_read_b128 a[160:163], v34 offset:40960
  v_add_f32 v166, v166, v86
  v_mfma_f32_16x16x32_bf16 a[44:47], a[208:211], v[248:251], a[44:47]
  s_waitcnt lgkmcnt(3)
  ds_read_b128 a[164:167], v35 offset:40960
  v_add_f32 v166, v166, v87
  v_mfma_f32_16x16x32_bf16 a[60:63], a[216:219], v[248:251], a[60:63]
  s_waitcnt lgkmcnt(2)
  v_exp_f32 v116, v116
  v_mfma_f32_16x16x32_bf16 a[60:63], a[220:223], v[252:255], a[60:63]
  s_add_u32 s61, s80, 221184
  ds_read_b128 a[168:171], v36 offset:40960
  v_cvt_pk_bf16_f32 v203, v110, v111
  v_mfma_f32_16x16x32_bf16 a[56:59], a[220:223], v[244:247], a[56:59]
  s_add_u32 m0, s63, 3072
  v_exp_f32 v117, v117
  v_mfma_f32_16x16x32_bf16 a[56:59], a[216:219], v[240:243], a[56:59]
  ds_read_b128 a[172:175], v37 offset:40960
  v_cvt_pk_bf16_f32 v210, v116, v117
  v_mfma_f32_16x16x32_bf16 a[52:55], a[216:219], v[232:235], a[52:55]
  v_exp_f32 v118, v118
  v_mfma_f32_16x16x32_bf16 a[52:55], a[220:223], v[236:239], a[52:55]
  s_mov_b64 exec, 0
  s_cmp_eq_u32 s57, 0
  s_cbranch_scc1 pad_m_8
  s_cmp_eq_u32 s57, 1
  s_cbranch_scc1 pad_m_9
  s_cmp_eq_u32 s57, 2
  s_cbranch_scc1 pad_m_10
  s_branch pad_m_11
warm_2:
  s_mov_b64 exec, -1
  s_nop 3
  buffer_load_dwordx4 v14, s[12:15], s61 offen offset:0 lds
  v_mfma_f32_16x16x32_bf16 a[48:51], a[220:223], v[228:231], a[48:51]
  v_exp_f32 v119, v119
  v_mfma_f32_16x16x32_bf16 a[48:51], a[216:219], v[224:227], a[48:51]
  v_add_f32 v164, v164, v100
  v_cvt_pk_bf16_f32 v211, v118, v119
  v_mfma_f32_16x16x32_bf16 a[132:135], a[144:147], v[232:235], a[132:135]
  v_exp_f32 v124, v124
  v_mfma_f32_16x16x32_bf16 a[132:135], a[144:147], v[236:239], a[132:135]
  s_waitcnt lgkmcnt(3)
  ds_read_b64_tr_b16 a[192:193], v42 offset:0
  v_add_f32 v164, v164, v101
  v_mfma_f32_16x16x32_bf16 v[68:71], a[160:163], v[64:67], v[132:135]
  s_waitcnt lgkmcnt(3)
  v_exp_f32 v125, v125
  v_mfma_f32_16x16x32_bf16 v[68:71], a[164:167], v[96:99], v[68:71]
  s_waitcnt lgkmcnt(2)
  v_add_f32 v164, v164, v102
  v_cvt_pk_bf16_f32 v218, v124, v125
  v_mfma_f32_16x16x32_bf16 v[68:71], a[168:171], v[128:131], v[68:71]
  s_waitcnt lgkmcnt(1)
  v_exp_f32 v126, v126
  v_mfma_f32_16x16x32_bf16 v[68:71], a[172:175], v[160:163], v[68:71]
  ds_read_b64_tr_b16 a[194:195], v42 offset:4096
  v_add_f32 v164, v164, v103
  v_mfma_f32_16x16x32_bf16 v[76:79], a[172:175], v[168:171], v[140:143]
  v_exp_f32 v127, v127
  v_mfma_f32_16x16x32_bf16 v[76:79], a[168:171], v[136:139], v[76:79]
  buffer_load_dwordx4 v15, s[12:15], s61 offen offset:1024 lds
  v_mfma_f32_16x16x32_bf16 v[76:79], a[164:167], v[104:107], v[76:79]
  ds_read_b64_tr_b16 a[196:197], v42 offset:8192
  ds_read_b64_tr_b16 a[198:199], v42 offset:12288
  v_mfma_f32_16x16x32_bf16 v[76:79], a[160:163], v[72:75], v[76:79]
  v_exp_f32 v68, v68
  v_mfma_f32_16x16x32_bf16 v[84:87], a[160:163], v[80:83], v[148:151]
  ds_read_b64_tr_b16 a[200:201], v43 offset:0
  v_cvt_pk_bf16_f32 v219, v126, v127
  v_mfma_f32_16x16x32_bf16 v[84:87], a[164:167], v[112:115], v[84:87]
  v_exp_f32 v69, v69
  v_mfma_f32_16x16x32_bf16 v[84:87], a[168:171], v[144:147], v[84:87]
  ds_read_b64_tr_b16 a[202:203], v43 offset:4096
  v_cvt_pk_bf16_f32 v196, v68, v69
  v_mfma_f32_16x16x32_bf16 v[84:87], a[172:175], v[176:179], v[84:87]
  v_exp_f32 v70, v70
  v_mfma_f32_16x16x32_bf16 v[92:95], a[172:175], v[184:187], v[156:159]
  ds_read_b64_tr_b16 a[204:205], v43 offset:8192
  ds_read_b64_tr_b16 a[206:207], v43 offset:12288
  v_mfma_f32_16x16x32_bf16 v[92:95], a[168:171], v[152:155], v[92:95]
  v_exp_f32 v71, v71
  v_mfma_f32_16x16x32_bf16 v[92:95], a[164:167], v[120:123], v[92:95]
  buffer_load_dwordx4 v16, s[12:15], s61 offen offset:2048 lds
  v_mfma_f32_16x16x32_bf16 v[92:95], a[160:163], v[88:91], v[92:95]
  s_waitcnt lgkmcnt(6)
  v_exp_f32 v76, v76
  v_mfma_f32_16x16x32_bf16 a[64:67], a[192:195], v[224:227], a[64:67]
  s_waitcnt lgkmcnt(4)
  v_add_f32 v166, v166, v116
  v_cvt_pk_bf16_f32 v197, v70, v71
  v_mfma_f32_16x16x32_bf16 a[64:67], a[196:199], v[228:231], a[64:67]
  v_exp_f32 v77, v77
  v_mfma_f32_16x16x32_bf16 a[68:71], a[196:199], v[236:239], a[68:71]
  ds_read_b128 a[176:179], v34 offset:45056
  v_add_f32 v166, v166, v117
  v_mfma_f32_16x16x32_bf16 a[68:71], a[192:195], v[232:235], a[68:71]
  v_exp_f32 v78, v78
  v_mfma_f32_16x16x32_bf16 a[72:75], a[192:195], v[240:243], a[72:75]
  v_add_f32 v166, v166, v118
  v_cvt_pk_bf16_f32 v204, v76, v77
  v_mfma_f32_16x16x32_bf16 a[72:75], a[196:199], v[244:247], a[72:75]
  s_add_u32 s61, s80, 3538944
  v_exp_f32 v79, v79
  v_mfma_f32_16x16x32_bf16 a[76:79], a[196:199], v[252:255], a[76:79]
  s_add_u32 m0, s63, 131072
  ds_read_b128 a[180:183], v35 offset:45056
  v_add_f32 v166, v166, v119
  v_mfma_f32_16x16x32_bf16 a[76:79], a[192:195], v[248:251], a[76:79]
  s_waitcnt lgkmcnt(4)
  v_exp_f32 v84, v84
  v_mfma_f32_16x16x32_bf16 a[92:95], a[200:203], v[248:251], a[92:95]
  s_waitcnt lgkmcnt(2)
  buffer_load_dwordx4 v14, s[12:15], s61 offen offset:0 lds
  v_mfma_f32_16x16x32_bf16 a[92:95], a[204:207], v[252:255], a[92:95]
  v_exp_f32 v85, v85
  v_mfma_f32_16x16x32_bf16 a[88:91], a[204:207], v[244:247], a[88:91]
  s_lshr_b32 s73, s2, 4
  s_or_b32 s73, s73, s55
  s_cmp_eq_u32 s73, 0
  s_cbranch_scc0 sigd_e30
  s_waitcnt vmcnt(10)
  s_and_b32 s73, s2, 7
  s_lshl_b32 s74, s73, 5
  v_lshl_add_u32 v54, v0, 2, s74
  v_mov_b32 v52, 3
  v_mov_b32 v53, 1
  s_and_b32 s73, s73, 6
  s_lshl_b32 s73, 3, s73
  s_mov_b64 exec, 0xff
  s_andn2_b32 exec_lo, 0xff, s73
  buffer_atomic_cmpswap v[52:53], v54, s[84:87], 0 offen sc1
  s_mov_b64 exec, -1
  s_nop 3
sigd_e30:
  ds_read_b128 a[184:187], v36 offset:45056
  v_mfma_f32_16x16x32_bf16 a[88:91], a[200:203], v[240:243], a[88:91]
  ds_read_b128 a[188:191], v37 offset:45056
  v_exp_f32 v86, v86
  v_mfma_f32_16x16x32_bf16 a[84:87], a[200:203], v[232:235], a[84:87]
  v_cvt_pk_bf16_f32 v205, v78, v79
  v_cvt_pk_bf16_f32 v212, v84, v85
  v_mfma_f32_16x16x32_bf16 a[84:87], a[204:207], v[236:239], a[84:87]
  v_exp_f32 v87, v87
  v_mfma_f32_16x16x32_bf16 a[80:83], a[204:207], v[228:231], a[80:83]
  v_add_f32 v164, v164, v68
  v_cvt_pk_bf16_f32 v213, v86, v87
  v_mfma_f32_16x16x32_bf16 a[80:83], a[200:203], v[224:227], a[80:83]
  s_waitcnt lgkmcnt(3)
  v_exp_f32 v92, v92
  v_mfma_f32_16x16x32_bf16 v[100:103], a[176:179], v[64:67], v[132:135]
  s_waitcnt lgkmcnt(2)
  ds_read_b64_tr_b16 a[208:209], v44 offset:0
  v_add_f32 v164, v164, v69
  v_mfma_f32_16x16x32_bf16 v[100:103], a[180:183], v[96:99], v[100:103]
  s_waitcnt lgkmcnt(2)
  v_exp_f32 v93, v93
  v_mfma_f32_16x16x32_bf16 v[100:103], a[184:187], v[128:131], v[100:103]
  s_waitcnt lgkmcnt(1)
  buffer_load_dwordx4 v15, s[12:15], s61 offen offset:1024 lds
  v_mfma_f32_16x16x32_bf16 v[100:103], a[188:191], v[160:163], v[100:103]
  v_exp_f32 v94, v94
  v_mfma_f32_16x16x32_bf16 v[108:111], a[188:191], v[168:171], v[140:143]
  ds_read_b64_tr_b16 a[210:211], v44 offset:4096
  v_add_f32 v164, v164, v70
  v_mfma_f32_16x16x32_bf16 v[108:111], a[184:187], v[136:139], v[108:111]
  v_exp_f32 v95, v95
  v_mfma_f32_16x16x32_bf16 v[108:111], a[180:183], v[104:107], v[108:111]
  v_add_f32 v164, v164, v71
  v_cvt_pk_bf16_f32 v220, v92, v93
  v_mfma_f32_16x16x32_bf16 v[108:111], a[176:179], v[72:75], v[108:111]
  v_exp_f32 v100, v100
  v_mfma_f32_16x16x32_bf16 v[116:119], a[176:179], v[80:83], v[148:151]
  ds_read_b64_tr_b16 a[212:213], v44 offset:8192
  ds_read_b64_tr_b16 a[214:215], v44 offset:12288
  v_mfma_f32_16x16x32_bf16 v[116:119], a[180:183], v[112:115], v[116:119]
  v_exp_f32 v101, v101
  v_mfma_f32_16x16x32_bf16 v[116:119], a[184:187], v[144:147], v[116:119]
  ds_read_b64_tr_b16 a[216:217], v45 offset:0
  v_cvt_pk_bf16_f32 v221, v94, v95
  v_mfma_f32_16x16x32_bf16 v[116:119], a[188:191], v[176:179], v[116:119]
  v_exp_f32 v102, v102
  v_mfma_f32_16x16x32_bf16 v[124:127], a[188:191], v[184:187], v[156:159]
  buffer_load_dwordx4 v16, s[12:15], s61 offen offset:2048 lds
  v_mfma_f32_16x16x32_bf16 v[124:127], a[184:187], v[152:155], v[124:127]
  v_exp_f32 v103, v103
  v_mfma_f32_16x16x32_bf16 v[124:127], a[180:183], v[120:123], v[124:127]
  ds_read_b64_tr_b16 a[218:219], v45 offset:4096
  v_cvt_pk_bf16_f32 v198, v100, v101
  v_mfma_f32_16x16x32_bf16 v[124:127], a[176:179], v[88:91], v[124:127]
  s_waitcnt lgkmcnt(4)
  v_exp_f32 v108, v108
  v_mfma_f32_16x16x32_bf16 a[96:99], a[208:211], v[224:227], a[96:99]
  s_waitcnt lgkmcnt(2)
  ds_read_b64_tr_b16 a[220:221], v45 offset:8192
  ds_read_b64_tr_b16 a[222:223], v45 offset:12288
  v_mfma_f32_16x16x32_bf16 a[96:99], a[212:215], v[228:231], a[96:99]
  v_exp_f32 v109, v109
  v_mfma_f32_16x16x32_bf16 a[100:103], a[212:215], v[236:239], a[100:103]
  v_add_f32 v166, v166, v84
  v_cvt_pk_bf16_f32 v199, v102, v103
  v_mfma_f32_16x16x32_bf16 a[100:103], a[208:211], v[232:235], a[100:103]
  s_add_u32 s61, s80, 3760128
  v_exp_f32 v110, v110
  v_mfma_f32_16x16x32_bf16 a[104:107], a[208:211], v[240:243], a[104:107]
  s_waitcnt vmcnt(16)
  s_barrier
  v_add_f32 v166, v166, v85
  v_mfma_f32_16x16x32_bf16 a[104:107], a[212:215], v[244:247], a[104:107]
  s_add_u32 m0, s63, 134144
  v_exp_f32 v111, v111
  v_mfma_f32_16x16x32_bf16 a[108:111], a[212:215], v[252:255], a[108:111]
  buffer_load_dwordx4 v14, s[12:15], s61 offen offset:0 lds
  v_mfma_f32_16x16x32_bf16 a[108:111], a[208:211], v[248:251], a[108:111]
  s_waitcnt lgkmcnt(2)
  v_add_f32 v166, v166, v86
  v_cvt_pk_bf16_f32 v206, v108, v109
  v_mfma_f32_16x16x32_bf16 a[124:127], a[216:219], v[248:251], a[124:127]
  s_waitcnt lgkmcnt(0)
  v_exp_f32 v116, v116
  v_mfma_f32_16x16x32_bf16 a[124:127], a[220:223], v[252:255], a[124:127]
  ds_read_b128 a[160:163], v34 offset:49152
  v_add_f32 v166, v166, v87
  v_mfma_f32_16x16x32_bf16 a[120:123], a[220:223], v[244:247], a[120:123]
  v_exp_f32 v117, v117
  v_mfma_f32_16x16x32_bf16 a[120:123], a[216:219], v[240:243], a[120:123]
  ds_read_b128 a[164:167], v35 offset:49152
  ds_read_b128 a[168:171], v36 offset:49152
  v_mfma_f32_16x16x32_bf16 a[116:119], a[216:219], v[232:235], a[116:119]
  v_exp_f32 v118, v118
  v_mfma_f32_16x16x32_bf16 a[116:119], a[220:223], v[236:239], a[116:119]
  ds_read_b128 a[172:175], v37 offset:49152
  v_cvt_pk_bf16_f32 v207, v110, v111
  v_mfma_f32_16x16x32_bf16 a[112:115], a[220:223], v[228:231], a[112:115]
  v_exp_f32 v119, v119
  v_mfma_f32_16x16x32_bf16 a[112:115], a[216:219], v[224:227], a[112:115]
  v_add_f32 v164, v164, v100
  v_cvt_pk_bf16_f32 v214, v116, v117
  v_mfma_f32_16x16x32_bf16 a[140:143], a[144:147], v[248:251], a[140:143]
  v_exp_f32 v124, v124
  v_mfma_f32_16x16x32_bf16 a[140:143], a[144:147], v[252:255], a[140:143]
  s_waitcnt lgkmcnt(3)
  buffer_load_dwordx4 v15, s[12:15], s61 offen offset:1024 lds
  v_mfma_f32_16x16x32_bf16 v[68:71], a[160:163], v[64:67], v[132:135]
  s_waitcnt lgkmcnt(2)
  v_exp_f32 v125, v125
  v_mfma_f32_16x16x32_bf16 v[68:71], a[164:167], v[96:99], v[68:71]
  s_waitcnt lgkmcnt(1)
  v_add_f32 v164, v164, v101
  v_cvt_pk_bf16_f32 v215, v118, v119
  v_mfma_f32_16x16x32_bf16 v[68:71], a[168:171], v[128:131], v[68:71]
  s_waitcnt lgkmcnt(0)
  v_exp_f32 v126, v126
  v_mfma_f32_16x16x32_bf16 v[68:71], a[172:175], v[160:163], v[68:71]
  v_add_f32 v164, v164, v102
  v_cvt_pk_bf16_f32 v222, v124, v125
  v_mfma_f32_16x16x32_bf16 v[76:79], a[172:175], v[168:171], v[140:143]
  v_exp_f32 v127, v127
  v_mfma_f32_16x16x32_bf16 v[76:79], a[168:171], v[136:139], v[76:79]
  ds_read_b64_tr_b16 a[192:193], v38 offset:16384
  v_add_f32 v164, v164, v103
  v_mfma_f32_16x16x32_bf16 v[76:79], a[164:167], v[104:107], v[76:79]
  ds_read_b64_tr_b16 a[194:195], v38 offset:20480
  ds_read_b64_tr_b16 a[196:197], v38 offset:24576
  v_mfma_f32_16x16x32_bf16 v[76:79], a[160:163], v[72:75], v[76:79]
  v_exp_f32 v68, v68
  v_mfma_f32_16x16x32_bf16 v[84:87], a[160:163], v[80:83], v[148:151]
  buffer_load_dwordx4 v16, s[12:15], s61 offen offset:2048 lds
  v_mfma_f32_16x16x32_bf16 v[84:87], a[164:167], v[112:115], v[84:87]
  ds_read_b64_tr_b16 a[198:199], v38 offset:28672
  v_exp_f32 v69, v69
  v_mfma_f32_16x16x32_bf16 v[84:87], a[168:171], v[144:147], v[84:87]
  ds_read_b64_tr_b16 a[200:201], v39 offset:16384
  v_cvt_pk_bf16_f32 v223, v126, v127
  v_mfma_f32_16x16x32_bf16 v[84:87], a[172:175], v[176:179], v[84:87]
pad_m_8:
  s_cbranch_execz warm_2
  v_exp_f32 v70, v70
  v_mfma_f32_16x16x32_bf16 v[92:95], a[172:175], v[184:187], v[156:159]
  ds_read_b64_tr_b16 a[202:203], v39 offset:20480
  v_cvt_pk_bf16_f32 v224, v68, v69
  v_mfma_f32_16x16x32_bf16 v[92:95], a[168:171], v[152:155], v[92:95]
  v_exp_f32 v71, v71
  v_mfma_f32_16x16x32_bf16 v[92:95], a[164:167], v[120:123], v[92:95]
  ds_read_b64_tr_b16 a[204:205], v39 offset:24576
  ds_read_b64_tr_b16 a[206:207], v39 offset:28672
  v_mfma_f32_16x16x32_bf16 v[92:95], a[160:163], v[88:91], v[92:95]
  s_waitcnt lgkmcnt(6)
  s_add_u32 s61, s80, 1769472
  v_exp_f32 v76, v76
  v_mfma_f32_16x16x32_bf16 a[0:3], a[192:195], v[192:195], a[0:3]
  s_waitcnt lgkmcnt(4)
  s_add_u32 m0, s63, 24576
  v_add_f32 v166, v166, v116
  v_cvt_pk_bf16_f32 v225, v70, v71
  v_mfma_f32_16x16x32_bf16 a[0:3], a[196:199], v[196:199], a[0:3]
  v_exp_f32 v77, v77
  v_mfma_f32_16x16x32_bf16 a[4:7], a[196:199], v[204:207], a[4:7]
  buffer_load_dwordx4 v14, s[12:15], s61 offen offset:0 lds
  v_mfma_f32_16x16x32_bf16 a[4:7], a[192:195], v[200:203], a[4:7]
  v_exp_f32 v78, v78
  v_mfma_f32_16x16x32_bf16 a[8:11], a[192:195], v[208:211], a[8:11]
  s_cmp_eq_u32 s55, 0
  s_cbranch_scc0 sigd_g
  v_mov_b32 v58, 1
  s_mov_b64 exec, 1
  buffer_atomic_add v58, off, s[84:87], 4 sc1
  s_mov_b64 exec, -1
  s_nop 3
sigd_g:
  v_add_f32 v166, v166, v117
  v_mfma_f32_16x16x32_bf16 a[8:11], a[196:199], v[212:215], a[8:11]
  v_exp_f32 v79, v79
  v_mfma_f32_16x16x32_bf16 a[12:15], a[196:199], v[220:223], a[12:15]
  ds_read_b128 a[176:179], v34 offset:53248
  v_add_f32 v166, v166, v118
  v_mfma_f32_16x16x32_bf16 a[12:15], a[192:195], v[216:219], a[12:15]
  s_waitcnt lgkmcnt(3)
  v_exp_f32 v84, v84
  v_mfma_f32_16x16x32_bf16 a[28:31], a[200:203], v[216:219], a[28:31]
  s_waitcnt lgkmcnt(1)
  v_add_f32 v166, v166, v119
  v_cvt_pk_bf16_f32 v232, v76, v77
  v_mfma_f32_16x16x32_bf16 a[28:31], a[204:207], v[220:223], a[28:31]
  ds_read_b128 a[180:183], v35 offset:53248
  v_exp_f32 v85, v85
  v_mfma_f32_16x16x32_bf16 a[24:27], a[204:207], v[212:215], a[24:27]
  ds_read_b128 a[184:187], v36 offset:53248
  ds_read_b128 a[188:191], v37 offset:53248
  v_mfma_f32_16x16x32_bf16 a[24:27], a[200:203], v[208:211], a[24:27]
  v_exp_f32 v86, v86
  v_mfma_f32_16x16x32_bf16 a[20:23], a[200:203], v[200:203], a[20:23]
  buffer_load_dwordx4 v15, s[12:15], s61 offen offset:1024 lds
  v_mfma_f32_16x16x32_bf16 a[20:23], a[204:207], v[204:207], a[20:23]
  v_cvt_pk_bf16_f32 v233, v78, v79
  v_exp_f32 v87, v87
  v_mfma_f32_16x16x32_bf16 a[16:19], a[204:207], v[196:199], a[16:19]
  v_add_f32 v164, v164, v68
  v_cvt_pk_bf16_f32 v240, v84, v85
  v_mfma_f32_16x16x32_bf16 a[16:19], a[200:203], v[192:195], a[16:19]
  s_waitcnt lgkmcnt(3)
  v_exp_f32 v92, v92
  v_mfma_f32_16x16x32_bf16 v[100:103], a[176:179], v[64:67], v[132:135]
  s_waitcnt lgkmcnt(2)
  v_add_f32 v164, v164, v69
  v_cvt_pk_bf16_f32 v241, v86, v87
  v_mfma_f32_16x16x32_bf16 v[100:103], a[180:183], v[96:99], v[100:103]
  s_waitcnt lgkmcnt(1)
  v_exp_f32 v93, v93
  v_mfma_f32_16x16x32_bf16 v[100:103], a[184:187], v[128:131], v[100:103]
  s_waitcnt lgkmcnt(0)
  ds_read_b64_tr_b16 a[208:209], v40 offset:16384
  v_add_f32 v164, v164, v70
  v_mfma_f32_16x16x32_bf16 v[100:103], a[188:191], v[160:163], v[100:103]
  v_exp_f32 v94, v94
  v_mfma_f32_16x16x32_bf16 v[108:111], a[188:191], v[168:171], v[140:143]
  ds_read_b64_tr_b16 a[210:211], v40 offset:20480
  v_add_f32 v164, v164, v71
  v_mfma_f32_16x16x32_bf16 v[108:111], a[184:187], v[136:139], v[108:111]
  v_exp_f32 v95, v95
  v_mfma_f32_16x16x32_bf16 v[108:111], a[180:183], v[104:107], v[108:111]
  buffer_load_dwordx4 v16, s[12:15], s61 offen offset:2048 lds
  v_mfma_f32_16x16x32_bf16 v[108:111], a[176:179], v[72:75], v[108:111]
  v_exp_f32 v100, v100
  v_mfma_f32_16x16x32_bf16 v[116:119], a[176:179], v[80:83], v[148:151]
  ds_read_b64_tr_b16 a[212:213], v40 offset:24576
  v_cvt_pk_bf16_f32 v248, v92, v93
  v_mfma_f32_16x16x32_bf16 v[116:119], a[180:183], v[112:115], v[116:119]
  ds_read_b64_tr_b16 a[214:215], v40 offset:28672
  v_exp_f32 v101, v101
  v_mfma_f32_16x16x32_bf16 v[116:119], a[184:187], v[144:147], v[116:119]
  ds_read_b64_tr_b16 a[216:217], v41 offset:16384
  v_cvt_pk_bf16_f32 v249, v94, v95
  v_mfma_f32_16x16x32_bf16 v[116:119], a[188:191], v[176:179], v[116:119]
  v_exp_f32 v102, v102
  v_mfma_f32_16x16x32_bf16 v[124:127], a[188:191], v[184:187], v[156:159]
  ds_read_b64_tr_b16 a[218:219], v41 offset:20480
  v_cvt_pk_bf16_f32 v226, v100, v101
  v_mfma_f32_16x16x32_bf16 v[124:127], a[184:187], v[152:155], v[124:127]
  s_add_u32 s61, s80, 1990656
  v_exp_f32 v103, v103
  v_mfma_f32_16x16x32_bf16 v[124:127], a[180:183], v[120:123], v[124:127]
  s_add_u32 m0, s63, 27648
  ds_read_b64_tr_b16 a[220:221], v41 offset:24576
  ds_read_b64_tr_b16 a[222:223], v41 offset:28672
  v_mfma_f32_16x16x32_bf16 v[124:127], a[176:179], v[88:91], v[124:127]
  s_waitcnt lgkmcnt(6)
  v_exp_f32 v108, v108
  v_mfma_f32_16x16x32_bf16 a[32:35], a[208:211], v[192:195], a[32:35]
  s_waitcnt lgkmcnt(4)
  buffer_load_dwordx4 v14, s[12:15], s61 offen offset:0 lds
  v_mfma_f32_16x16x32_bf16 a[32:35], a[212:215], v[196:199], a[32:35]
  v_exp_f32 v109, v109
  v_mfma_f32_16x16x32_bf16 a[36:39], a[212:215], v[204:207], a[36:39]
  v_add_f32 v166, v166, v84
  v_cvt_pk_bf16_f32 v227, v102, v103
  v_mfma_f32_16x16x32_bf16 a[36:39], a[208:211], v[200:203], a[36:39]
  v_exp_f32 v110, v110
  v_mfma_f32_16x16x32_bf16 a[40:43], a[208:211], v[208:211], a[40:43]
  v_add_f32 v166, v166, v85
  v_cvt_pk_bf16_f32 v234, v108, v109
  v_mfma_f32_16x16x32_bf16 a[40:43], a[212:215], v[212:215], a[40:43]
  v_exp_f32 v111, v111
  v_mfma_f32_16x16x32_bf16 a[44:47], a[212:215], v[220:223], a[44:47]
  ds_read_b128 a[160:163], v34 offset:57344
  v_add_f32 v166, v166, v86
  v_mfma_f32_16x16x32_bf16 a[44:47], a[208:211], v[216:219], a[44:47]
  s_waitcnt lgkmcnt(3)
  ds_read_b128 a[164:167], v35 offset:57344
  v_add_f32 v166, v166, v87
  v_mfma_f32_16x16x32_bf16 a[60:63], a[216:219], v[216:219], a[60:63]
  s_waitcnt lgkmcnt(2)
  v_exp_f32 v116, v116
  v_mfma_f32_16x16x32_bf16 a[60:63], a[220:223], v[220:223], a[60:63]
  ds_read_b128 a[168:171], v36 offset:57344
  v_cvt_pk_bf16_f32 v235, v110, v111
  v_mfma_f32_16x16x32_bf16 a[56:59], a[220:223], v[212:215], a[56:59]
  v_exp_f32 v117, v117
  v_mfma_f32_16x16x32_bf16 a[56:59], a[216:219], v[208:211], a[56:59]
  buffer_load_dwordx4 v15, s[12:15], s61 offen offset:1024 lds
  v_mfma_f32_16x16x32_bf16 a[52:55], a[216:219], v[200:203], a[52:55]
  v_exp_f32 v118, v118
  v_mfma_f32_16x16x32_bf16 a[52:55], a[220:223], v[204:207], a[52:55]
  ds_read_b128 a[172:175], v37 offset:57344
  v_cvt_pk_bf16_f32 v242, v116, v117
  v_mfma_f32_16x16x32_bf16 a[48:51], a[220:223], v[196:199], a[48:51]
  v_exp_f32 v119, v119
  v_mfma_f32_16x16x32_bf16 a[48:51], a[216:219], v[192:195], a[48:51]
  v_add_f32 v164, v164, v100
  v_cvt_pk_bf16_f32 v243, v118, v119
  v_mfma_f32_16x16x32_bf16 a[132:135], a[144:147], v[200:203], a[132:135]
  v_exp_f32 v124, v124
  v_mfma_f32_16x16x32_bf16 a[132:135], a[144:147], v[204:207], a[132:135]
  s_waitcnt lgkmcnt(3)
  ds_read_b64_tr_b16 a[192:193], v42 offset:16384
  v_add_f32 v164, v164, v101
  v_mfma_f32_16x16x32_bf16 v[68:71], a[160:163], v[64:67], v[132:135]
  s_waitcnt lgkmcnt(3)
  v_exp_f32 v125, v125
  v_mfma_f32_16x16x32_bf16 v[68:71], a[164:167], v[96:99], v[68:71]
  s_waitcnt lgkmcnt(2)
  v_add_f32 v164, v164, v102
  v_cvt_pk_bf16_f32 v250, v124, v125
  v_mfma_f32_16x16x32_bf16 v[68:71], a[168:171], v[128:131], v[68:71]
  s_waitcnt lgkmcnt(1)
  v_exp_f32 v126, v126
  v_mfma_f32_16x16x32_bf16 v[68:71], a[172:175], v[160:163], v[68:71]
  buffer_load_dwordx4 v16, s[12:15], s61 offen offset:2048 lds
  v_mfma_f32_16x16x32_bf16 v[76:79], a[172:175], v[168:171], v[140:143]
  v_exp_f32 v127, v127
  v_mfma_f32_16x16x32_bf16 v[76:79], a[168:171], v[136:139], v[76:79]
  ds_read_b64_tr_b16 a[194:195], v42 offset:20480
  v_add_f32 v164, v164, v103
  v_mfma_f32_16x16x32_bf16 v[76:79], a[164:167], v[104:107], v[76:79]
  ds_read_b64_tr_b16 a[196:197], v42 offset:24576
  ds_read_b64_tr_b16 a[198:199], v42 offset:28672
  v_mfma_f32_16x16x32_bf16 v[76:79], a[160:163], v[72:75], v[76:79]
  v_exp_f32 v68, v68
  v_mfma_f32_16x16x32_bf16 v[84:87], a[160:163], v[80:83], v[148:151]
  ds_read_b64_tr_b16 a[200:201], v43 offset:16384
  v_cvt_pk_bf16_f32 v251, v126, v127
  v_mfma_f32_16x16x32_bf16 v[84:87], a[164:167], v[112:115], v[84:87]
  s_add_u32 s76, s59, 8192
  v_exp_f32 v69, v69
  v_mfma_f32_16x16x32_bf16 v[84:87], a[168:171], v[144:147], v[84:87]
  ds_read_b64_tr_b16 a[202:203], v43 offset:20480
  v_cvt_pk_bf16_f32 v228, v68, v69
  v_mfma_f32_16x16x32_bf16 v[84:87], a[172:175], v[176:179], v[84:87]
  v_exp_f32 v70, v70
  v_mfma_f32_16x16x32_bf16 v[92:95], a[172:175], v[184:187], v[156:159]
  buffer_load_dwordx4 a[240:243], v2, s[4:7], s76 offen offset:0 sc1
  v_mfma_f32_16x16x32_bf16 v[92:95], a[168:171], v[152:155], v[92:95]
  v_exp_f32 v71, v71
  v_mfma_f32_16x16x32_bf16 v[92:95], a[164:167], v[120:123], v[92:95]
  ds_read_b64_tr_b16 a[204:205], v43 offset:24576
  ds_read_b64_tr_b16 a[206:207], v43 offset:28672
  v_mfma_f32_16x16x32_bf16 v[92:95], a[160:163], v[88:91], v[92:95]
  s_waitcnt lgkmcnt(6)
  v_exp_f32 v76, v76
  v_mfma_f32_16x16x32_bf16 a[64:67], a[192:195], v[192:195], a[64:67]
  s_waitcnt lgkmcnt(4)
  v_add_f32 v166, v166, v116
  v_cvt_pk_bf16_f32 v229, v70, v71
  v_mfma_f32_16x16x32_bf16 a[64:67], a[196:199], v[196:199], a[64:67]
  v_exp_f32 v77, v77
  v_mfma_f32_16x16x32_bf16 a[68:71], a[196:199], v[204:207], a[68:71]
  ds_read_b128 a[176:179], v34 offset:61440
  v_add_f32 v166, v166, v117
  v_mfma_f32_16x16x32_bf16 a[68:71], a[192:195], v[200:203], a[68:71]
  v_exp_f32 v78, v78
  v_mfma_f32_16x16x32_bf16 a[72:75], a[192:195], v[208:211], a[72:75]
  v_add_f32 v166, v166, v118
  v_cvt_pk_bf16_f32 v236, v76, v77
  v_mfma_f32_16x16x32_bf16 a[72:75], a[196:199], v[212:215], a[72:75]
  v_exp_f32 v79, v79
  v_mfma_f32_16x16x32_bf16 a[76:79], a[196:199], v[220:223], a[76:79]
  buffer_load_dwordx4 a[244:247], v2, s[4:7], s76 offen offset:1024 sc1
  v_mfma_f32_16x16x32_bf16 a[76:79], a[192:195], v[216:219], a[76:79]
  s_waitcnt lgkmcnt(3)
  v_exp_f32 v84, v84
  v_mfma_f32_16x16x32_bf16 a[92:95], a[200:203], v[216:219], a[92:95]
  s_waitcnt lgkmcnt(1)
  ds_read_b128 a[180:183], v35 offset:61440
  v_add_f32 v166, v166, v119
  v_mfma_f32_16x16x32_bf16 a[92:95], a[204:207], v[220:223], a[92:95]
  v_exp_f32 v85, v85
  v_mfma_f32_16x16x32_bf16 a[88:91], a[204:207], v[212:215], a[88:91]
  ds_read_b128 a[184:187], v36 offset:61440
  ds_read_b128 a[188:191], v37 offset:61440
  v_mfma_f32_16x16x32_bf16 a[88:91], a[200:203], v[208:211], a[88:91]
  s_add_u32 s76, s59, 12288
  v_exp_f32 v86, v86
  v_mfma_f32_16x16x32_bf16 a[84:87], a[200:203], v[200:203], a[84:87]
  v_cvt_pk_bf16_f32 v237, v78, v79
  v_cvt_pk_bf16_f32 v244, v84, v85
  v_mfma_f32_16x16x32_bf16 a[84:87], a[204:207], v[204:207], a[84:87]
  v_exp_f32 v87, v87
  v_mfma_f32_16x16x32_bf16 a[80:83], a[204:207], v[196:199], a[80:83]
  buffer_load_dwordx4 a[248:251], v2, s[4:7], s76 offen offset:0 sc1
  v_mfma_f32_16x16x32_bf16 a[80:83], a[200:203], v[192:195], a[80:83]
  s_waitcnt lgkmcnt(3)
  v_exp_f32 v92, v92
  v_mfma_f32_16x16x32_bf16 v[100:103], a[176:179], v[64:67], v[132:135]
  s_waitcnt lgkmcnt(2)
  v_add_f32 v164, v164, v68
  v_cvt_pk_bf16_f32 v245, v86, v87
  v_mfma_f32_16x16x32_bf16 v[100:103], a[180:183], v[96:99], v[100:103]
  s_waitcnt lgkmcnt(1)
  v_exp_f32 v93, v93
  v_mfma_f32_16x16x32_bf16 v[100:103], a[184:187], v[128:131], v[100:103]
  s_waitcnt lgkmcnt(0)
  ds_read_b64_tr_b16 a[208:209], v44 offset:16384
  v_add_f32 v164, v164, v69
  v_mfma_f32_16x16x32_bf16 v[100:103], a[188:191], v[160:163], v[100:103]
  v_exp_f32 v94, v94
  v_mfma_f32_16x16x32_bf16 v[108:111], a[188:191], v[168:171], v[140:143]
  ds_read_b64_tr_b16 a[210:211], v44 offset:20480
  v_add_f32 v164, v164, v70
  v_mfma_f32_16x16x32_bf16 v[108:111], a[184:187], v[136:139], v[108:111]
  v_exp_f32 v95, v95
  v_mfma_f32_16x16x32_bf16 v[108:111], a[180:183], v[104:107], v[108:111]
  v_add_f32 v164, v164, v71
  v_cvt_pk_bf16_f32 v252, v92, v93
  v_mfma_f32_16x16x32_bf16 v[108:111], a[176:179], v[72:75], v[108:111]
  v_exp_f32 v100, v100
  v_mfma_f32_16x16x32_bf16 v[116:119], a[176:179], v[80:83], v[148:151]
  buffer_load_dwordx4 a[252:255], v2, s[4:7], s76 offen offset:1024 sc1
  v_mfma_f32_16x16x32_bf16 v[116:119], a[180:183], v[112:115], v[116:119]
  ds_read_b64_tr_b16 a[212:213], v44 offset:24576
  ds_read_b64_tr_b16 a[214:215], v44 offset:28672
  v_exp_f32 v101, v101
  v_mfma_f32_16x16x32_bf16 v[116:119], a[184:187], v[144:147], v[116:119]
  ds_read_b64_tr_b16 a[216:217], v45 offset:16384
  v_cvt_pk_bf16_f32 v253, v94, v95
  v_mfma_f32_16x16x32_bf16 v[116:119], a[188:191], v[176:179], v[116:119]
  v_exp_f32 v102, v102
  v_mfma_f32_16x16x32_bf16 v[124:127], a[188:191], v[184:187], v[156:159]
  ds_read_b64_tr_b16 a[218:219], v45 offset:20480
  v_cvt_pk_bf16_f32 v230, v100, v101
  v_mfma_f32_16x16x32_bf16 v[124:127], a[184:187], v[152:155], v[124:127]
  s_add_u32 s76, s59, 16384
  v_exp_f32 v103, v103
  v_mfma_f32_16x16x32_bf16 v[124:127], a[180:183], v[120:123], v[124:127]
  ds_read_b64_tr_b16 a[220:221], v45 offset:24576
  ds_read_b64_tr_b16 a[222:223], v45 offset:28672
  v_mfma_f32_16x16x32_bf16 v[124:127], a[176:179], v[88:91], v[124:127]
  s_waitcnt lgkmcnt(6)
  v_exp_f32 v108, v108
  v_mfma_f32_16x16x32_bf16 a[96:99], a[208:211], v[192:195], a[96:99]
  s_waitcnt lgkmcnt(4)
  buffer_load_dwordx4 a[148:151], v2, s[4:7], s76 offen offset:0 sc1
  v_mfma_f32_16x16x32_bf16 a[96:99], a[212:215], v[196:199], a[96:99]
  v_exp_f32 v109, v109
  v_mfma_f32_16x16x32_bf16 a[100:103], a[212:215], v[204:207], a[100:103]
  v_add_f32 v166, v166, v84
  v_cvt_pk_bf16_f32 v231, v102, v103
  v_mfma_f32_16x16x32_bf16 a[100:103], a[208:211], v[200:203], a[100:103]
  v_exp_f32 v110, v110
  v_mfma_f32_16x16x32_bf16 a[104:107], a[208:211], v[208:211], a[104:107]
  s_waitcnt vmcnt(23)
  s_barrier
  v_add_f32 v166, v166, v85
  v_mfma_f32_16x16x32_bf16 a[104:107], a[212:215], v[212:215], a[104:107]
  v_exp_f32 v111, v111
  v_mfma_f32_16x16x32_bf16 a[108:111], a[212:215], v[220:223], a[108:111]
  v_add_f32 v166, v166, v86
  v_cvt_pk_bf16_f32 v238, v108, v109
  v_mfma_f32_16x16x32_bf16 a[108:111], a[208:211], v[216:219], a[108:111]
  s_waitcnt lgkmcnt(2)
  ds_read_b64_tr_b16 a[192:193], v38 offset:32768
  v_add_f32 v166, v166, v87
  v_mfma_f32_16x16x32_bf16 a[124:127], a[216:219], v[216:219], a[124:127]
  s_waitcnt lgkmcnt(1)
  v_exp_f32 v116, v116
  v_mfma_f32_16x16x32_bf16 a[124:127], a[220:223], v[220:223], a[124:127]
  buffer_load_dwordx4 a[152:155], v2, s[4:7], s76 offen offset:1024 sc1
  v_mfma_f32_16x16x32_bf16 a[120:123], a[220:223], v[212:215], a[120:123]
  ds_read_b64_tr_b16 a[194:195], v38 offset:36864
  ds_read_b64_tr_b16 a[196:197], v38 offset:40960
  ds_read_b64_tr_b16 a[198:199], v38 offset:45056
  v_exp_f32 v117, v117
  v_mfma_f32_16x16x32_bf16 a[120:123], a[216:219], v[208:211], a[120:123]
  v_exp_f32 v118, v118
  v_mfma_f32_16x16x32_bf16 a[116:119], a[216:219], v[200:203], a[116:119]
  v_exp_f32 v119, v119
  v_mfma_f32_16x16x32_bf16 a[116:119], a[220:223], v[204:207], a[116:119]
  v_cvt_pk_bf16_f32 v239, v110, v111
  v_exp_f32 v124, v124
  v_mfma_f32_16x16x32_bf16 a[112:115], a[220:223], v[196:199], a[112:115]
  v_exp_f32 v125, v125
  v_mfma_f32_16x16x32_bf16 a[112:115], a[216:219], v[192:195], a[112:115]
  v_exp_f32 v126, v126
  v_mfma_f32_16x16x32_bf16 a[140:143], a[144:147], v[216:219], a[140:143]
  v_exp_f32 v127, v127
  v_mfma_f32_16x16x32_bf16 a[140:143], a[144:147], v[220:223], a[140:143]
  s_waitcnt lgkmcnt(2)
  ds_read_b64_tr_b16 a[200:201], v39 offset:32768
  ds_read_b64_tr_b16 a[202:203], v39 offset:36864
  v_mfma_f32_16x16x32_bf16 a[0:3], a[192:195], v[224:227], a[0:3]
  s_waitcnt lgkmcnt(2)
  ds_read_b64_tr_b16 a[204:205], v39 offset:40960
  ds_read_b64_tr_b16 a[206:207], v39 offset:45056
  v_mfma_f32_16x16x32_bf16 a[0:3], a[196:199], v[228:231], a[0:3]
  s_add_u32 s60, s59, 0
  v_add_f32 v164, v164, v100
  v_cvt_pk_bf16_f32 v246, v116, v117
  v_mfma_f32_16x16x32_bf16 a[4:7], a[196:199], v[236:239], a[4:7]
  v_add_f32 v164, v164, v101
  v_cvt_pk_bf16_f32 v247, v118, v119
  v_mfma_f32_16x16x32_bf16 a[4:7], a[192:195], v[232:235], a[4:7]
  v_cvt_pk_bf16_f32 v254, v124, v125
  v_cvt_pk_bf16_f32 v255, v126, v127
  v_mfma_f32_16x16x32_bf16 a[8:11], a[192:195], v[240:243], a[8:11]
  buffer_load_dwordx4 v[192:195], v1, s[4:7], s60 offen offset:0 sc1
  v_mfma_f32_16x16x32_bf16 a[8:11], a[196:199], v[244:247], a[8:11]
  v_add_f32 v164, v164, v102
  v_add_f32 v166, v166, v116
  v_mfma_f32_16x16x32_bf16 a[12:15], a[196:199], v[252:255], a[12:15]
  v_add_f32 v164, v164, v103
  v_add_f32 v166, v166, v117
  v_mfma_f32_16x16x32_bf16 a[12:15], a[192:195], v[248:251], a[12:15]
  s_waitcnt lgkmcnt(2)
  buffer_load_dwordx4 v[196:199], v1, s[4:7], s60 offen offset:1024 sc1
  v_mfma_f32_16x16x32_bf16 a[28:31], a[200:203], v[248:251], a[28:31]
  s_waitcnt lgkmcnt(0)
  s_add_u32 s60, s59, 4096
  ds_read_b64_tr_b16 a[208:209], v40 offset:32768
  v_add_f32 v166, v166, v118
  v_mfma_f32_16x16x32_bf16 a[28:31], a[204:207], v[252:255], a[28:31]
  ds_read_b64_tr_b16 a[210:211], v40 offset:36864
  v_add_f32 v166, v166, v119
  v_mfma_f32_16x16x32_bf16 a[24:27], a[204:207], v[244:247], a[24:27]
  ds_read_b64_tr_b16 a[212:213], v40 offset:40960
  ds_read_b64_tr_b16 a[214:215], v40 offset:45056
  v_mfma_f32_16x16x32_bf16 a[24:27], a[200:203], v[240:243], a[24:27]
  buffer_load_dwordx4 v[200:203], v1, s[4:7], s60 offen offset:0 sc1
  v_mfma_f32_16x16x32_bf16 a[20:23], a[200:203], v[232:235], a[20:23]
  ds_read_b64_tr_b16 a[216:217], v41 offset:32768
  ds_read_b64_tr_b16 a[218:219], v41 offset:36864
  v_mfma_f32_16x16x32_bf16 a[20:23], a[204:207], v[236:239], a[20:23]
  ds_read_b64_tr_b16 a[220:221], v41 offset:40960
  ds_read_b64_tr_b16 a[222:223], v41 offset:45056
  v_mfma_f32_16x16x32_bf16 a[16:19], a[204:207], v[228:231], a[16:19]
  ds_read_b64_tr_b16 a[192:193], v42 offset:32768
  ds_read_b64_tr_b16 a[194:195], v42 offset:36864
  v_mfma_f32_16x16x32_bf16 a[16:19], a[200:203], v[224:227], a[16:19]
  buffer_load_dwordx4 v[204:207], v1, s[4:7], s60 offen offset:1024 sc1
  v_mfma_f32_16x16x32_bf16 a[132:135], a[144:147], v[232:235], a[132:135]
  s_add_u32 s60, s59, 8192
  ds_read_b64_tr_b16 a[196:197], v42 offset:40960
  ds_read_b64_tr_b16 a[198:199], v42 offset:45056
  v_mfma_f32_16x16x32_bf16 a[132:135], a[144:147], v[236:239], a[132:135]
  ds_read_b64_tr_b16 a[200:201], v43 offset:32768
  ds_read_b64_tr_b16 a[202:203], v43 offset:36864
  v_mfma_f32_16x16x32_bf16 a[140:143], a[144:147], v[248:251], a[140:143]
  ds_read_b64_tr_b16 a[204:205], v43 offset:40960
  ds_read_b64_tr_b16 a[206:207], v43 offset:45056
  v_mfma_f32_16x16x32_bf16 a[140:143], a[144:147], v[252:255], a[140:143]
  s_waitcnt lgkmcnt(14)
  buffer_load_dwordx4 v[208:211], v1, s[4:7], s60 offen offset:0 sc1
  v_mfma_f32_16x16x32_bf16 a[32:35], a[208:211], v[224:227], a[32:35]
  s_waitcnt lgkmcnt(12)
  v_mfma_f32_16x16x32_bf16 a[32:35], a[212:215], v[228:231], a[32:35]
  v_mfma_f32_16x16x32_bf16 a[36:39], a[212:215], v[236:239], a[36:39]
  v_mfma_f32_16x16x32_bf16 a[36:39], a[208:211], v[232:235], a[36:39]
  buffer_load_dwordx4 v[212:215], v1, s[4:7], s60 offen offset:1024 sc1
  v_mfma_f32_16x16x32_bf16 a[40:43], a[208:211], v[240:243], a[40:43]
  s_add_u32 s60, s59, 12288
  v_mfma_f32_16x16x32_bf16 a[40:43], a[212:215], v[244:247], a[40:43]
  v_mfma_f32_16x16x32_bf16 a[44:47], a[212:215], v[252:255], a[44:47]
  v_mov_b32 v52, v164
  v_mov_b32 v54, v166
  v_mfma_f32_16x16x32_bf16 a[44:47], a[208:211], v[248:251], a[44:47]
  s_waitcnt lgkmcnt(10)
  buffer_load_dwordx4 v[216:219], v1, s[4:7], s60 offen offset:0 sc1
  v_mfma_f32_16x16x32_bf16 a[60:63], a[216:219], v[248:251], a[60:63]
  s_waitcnt lgkmcnt(8)
  v_permlane32_swap_b32 v164, v52
  v_permlane32_swap_b32 v166, v54
  v_mfma_f32_16x16x32_bf16 a[60:63], a[220:223], v[252:255], a[60:63]
  ds_read_b64_tr_b16 a[208:209], v44 offset:32768
  ds_read_b64_tr_b16 a[210:211], v44 offset:36864
  v_mfma_f32_16x16x32_bf16 a[56:59], a[220:223], v[244:247], a[56:59]
  ds_read_b64_tr_b16 a[212:213], v44 offset:40960
  ds_read_b64_tr_b16 a[214:215], v44 offset:45056
  v_mfma_f32_16x16x32_bf16 a[56:59], a[216:219], v[240:243], a[56:59]
  buffer_load_dwordx4 v[220:223], v1, s[4:7], s60 offen offset:1024 sc1
  v_mfma_f32_16x16x32_bf16 a[52:55], a[216:219], v[232:235], a[52:55]
  s_add_u32 s60, s59, 16384
  v_add_f32 v164, v164, v52
  v_add_f32 v166, v166, v54
  v_mfma_f32_16x16x32_bf16 a[52:55], a[220:223], v[236:239], a[52:55]
  v_mov_b32 v52, v164
  v_mov_b32 v54, v166
  v_mfma_f32_16x16x32_bf16 a[48:51], a[220:223], v[228:231], a[48:51]
  v_permlane16_swap_b32 v164, v52
  v_permlane16_swap_b32 v166, v54
  v_mfma_f32_16x16x32_bf16 a[48:51], a[216:219], v[224:227], a[48:51]
  s_waitcnt lgkmcnt(10)
  buffer_load_dwordx4 a[168:171], v1, s[4:7], s60 offen offset:0 sc1
  v_mfma_f32_16x16x32_bf16 a[64:67], a[192:195], v[224:227], a[64:67]
  s_waitcnt lgkmcnt(8)
  v_accvgpr_read_b32 v165, a132
  v_accvgpr_read_b32 v167, a140
  v_mfma_f32_16x16x32_bf16 a[64:67], a[196:199], v[228:231], a[64:67]
  v_add_f32 v164, v164, v52
  v_add_f32 v166, v166, v54
  v_mfma_f32_16x16x32_bf16 a[68:71], a[196:199], v[236:239], a[68:71]
  buffer_load_dwordx4 a[172:175], v1, s[4:7], s60 offen offset:1024 sc1
  v_mfma_f32_16x16x32_bf16 a[68:71], a[192:195], v[232:235], a[68:71]
  s_add_u32 s60, s59, 20480
  v_add_f32 v53, v164, v165
  v_add_f32 v54, v166, v167
  v_mfma_f32_16x16x32_bf16 a[72:75], a[192:195], v[240:243], a[72:75]
  v_add_f32 v53, v53, v54
  v_mov_b32 v55, 155648
  v_mfma_f32_16x16x32_bf16 a[72:75], a[196:199], v[244:247], a[72:75]
  v_mov_b32 v54, 0x53800000
  v_mov_b32 v56, 1
  v_mfma_f32_16x16x32_bf16 a[76:79], a[196:199], v[252:255], a[76:79]
  buffer_load_dwordx4 a[176:179], v1, s[4:7], s60 offen offset:0 sc1
  v_mfma_f32_16x16x32_bf16 a[76:79], a[192:195], v[248:251], a[76:79]
  s_waitcnt lgkmcnt(6)
  ds_read_b64_tr_b16 a[216:217], v45 offset:32768
  v_cmp_nge_f32 vcc, v54, v53
  v_mfma_f32_16x16x32_bf16 a[92:95], a[200:203], v[248:251], a[92:95]
  s_waitcnt lgkmcnt(5)
  ds_read_b64_tr_b16 a[218:219], v45 offset:36864
  ds_read_b64_tr_b16 a[220:221], v45 offset:40960
  v_mfma_f32_16x16x32_bf16 a[92:95], a[204:207], v[252:255], a[92:95]
  ds_read_b64_tr_b16 a[222:223], v45 offset:45056
  v_mfma_f32_16x16x32_bf16 a[88:91], a[204:207], v[244:247], a[88:91]
  buffer_load_dwordx4 a[180:183], v1, s[4:7], s60 offen offset:1024 sc1
  v_mfma_f32_16x16x32_bf16 a[88:91], a[200:203], v[240:243], a[88:91]
  s_add_u32 s76, s59, 20480
  v_mfma_f32_16x16x32_bf16 a[84:87], a[200:203], v[232:235], a[84:87]
  v_mfma_f32_16x16x32_bf16 a[84:87], a[204:207], v[236:239], a[84:87]
  v_mfma_f32_16x16x32_bf16 a[80:83], a[204:207], v[228:231], a[80:83]
  buffer_load_dwordx4 a[156:159], v2, s[4:7], s76 offen offset:0 sc1
  v_mfma_f32_16x16x32_bf16 a[80:83], a[200:203], v[224:227], a[80:83]
  s_waitcnt lgkmcnt(6)
  v_mfma_f32_16x16x32_bf16 a[96:99], a[208:211], v[224:227], a[96:99]
  s_waitcnt lgkmcnt(4)
  v_mfma_f32_16x16x32_bf16 a[96:99], a[212:215], v[228:231], a[96:99]
  v_mfma_f32_16x16x32_bf16 a[100:103], a[212:215], v[236:239], a[100:103]
  s_cbranch_vccnz att_flag
att_flagged:
  s_waitcnt vmcnt(31)
  s_barrier
  ds_read_b32 v56, v55
  v_mfma_f32_16x16x32_bf16 a[100:103], a[208:211], v[232:235], a[100:103]
  buffer_load_dwordx4 a[160:163], v2, s[4:7], s76 offen offset:1024 sc1
  v_mfma_f32_16x16x32_bf16 a[104:107], a[208:211], v[240:243], a[104:107]
  s_add_u32 s60, s59, 24576
  v_mfma_f32_16x16x32_bf16 a[104:107], a[212:215], v[244:247], a[104:107]
  v_mfma_f32_16x16x32_bf16 a[108:111], a[212:215], v[252:255], a[108:111]
  buffer_load_dwordx4 a[184:187], v1, s[4:7], s60 offen offset:0 sc1
  v_mfma_f32_16x16x32_bf16 a[108:111], a[208:211], v[248:251], a[108:111]
  s_waitcnt lgkmcnt(3)
  v_mfma_f32_16x16x32_bf16 a[124:127], a[216:219], v[248:251], a[124:127]
  s_waitcnt lgkmcnt(1)
  v_mfma_f32_16x16x32_bf16 a[124:127], a[220:223], v[252:255], a[124:127]
  v_mfma_f32_16x16x32_bf16 a[120:123], a[220:223], v[244:247], a[120:123]
  buffer_load_dwordx4 a[188:191], v1, s[4:7], s60 offen offset:1024 sc1
  v_mfma_f32_16x16x32_bf16 a[120:123], a[216:219], v[240:243], a[120:123]
  v_mfma_f32_16x16x32_bf16 a[116:119], a[216:219], v[232:235], a[116:119]
  v_mfma_f32_16x16x32_bf16 a[116:119], a[220:223], v[236:239], a[116:119]
  v_mfma_f32_16x16x32_bf16 a[112:115], a[220:223], v[228:231], a[112:115]
  v_mfma_f32_16x16x32_bf16 a[112:115], a[216:219], v[224:227], a[112:115]
  s_waitcnt lgkmcnt(0)
  v_readfirstlane_b32 s73, v56
  s_nop 0
  s_cmp_gt_u32 s73, s79
  s_cbranch_scc1 att_retry
att_final:
  s_mov_b32 s72, 0xbfb8aa3b
  ds_read_b64_tr_b16 v[224:225], v20 offset:0
  ds_read_b64_tr_b16 v[226:227], v20 offset:2048
  ds_read_b64_tr_b16 v[228:229], v20 offset:4096
  ds_read_b64_tr_b16 v[230:231], v20 offset:6144
  ds_read_b64_tr_b16 v[232:233], v20 offset:8192
  ds_read_b64_tr_b16 v[234:235], v20 offset:10240
  v_rcp_f32 v48, v164
  v_rcp_f32 v49, v165
  v_rcp_f32 v56, v166
  v_rcp_f32 v57, v167
  s_add_u32 s76, s59, 24576
  buffer_load_dwordx4 a[164:167], v2, s[4:7], s76 offen offset:0 sc1
  v_accvgpr_read_b32 v80, a0
  v_accvgpr_read_b32 v81, a1
  v_accvgpr_read_b32 v82, a2
  v_accvgpr_read_b32 v83, a3
  v_accvgpr_read_b32 v84, a16
  v_accvgpr_read_b32 v85, a17
  v_accvgpr_read_b32 v86, a18
  v_accvgpr_read_b32 v87, a19
  v_pk_mul_f32 v[80:81], v[80:81], v[48:49] op_sel:[0,0] op_sel_hi:[1,0]
  v_pk_mul_f32 v[82:83], v[82:83], v[48:49] op_sel:[0,0] op_sel_hi:[1,0]
  v_pk_mul_f32 v[84:85], v[84:85], v[48:49] op_sel:[0,0] op_sel_hi:[1,0]
  v_pk_mul_f32 v[86:87], v[86:87], v[48:49] op_sel:[0,0] op_sel_hi:[1,0]
  v_cvt_pk_bf16_f32 v136, v80, v81
  v_cvt_pk_bf16_f32 v137, v82, v83
  v_cvt_pk_bf16_f32 v138, v84, v85
  v_cvt_pk_bf16_f32 v139, v86, v87
  buffer_load_dwordx4 a[192:195], v2, s[4:7], s76 offen offset:1024 sc1
  v_accvgpr_read_b32 v88, a4
  v_accvgpr_read_b32 v89, a5
  v_accvgpr_read_b32 v90, a6
  v_accvgpr_read_b32 v91, a7
  v_accvgpr_read_b32 v92, a20
  v_accvgpr_read_b32 v93, a21
  v_accvgpr_read_b32 v94, a22
  v_accvgpr_read_b32 v95, a23
  v_pk_mul_f32 v[88:89], v[88:89], v[48:49] op_sel:[0,1] op_sel_hi:[1,1]
  v_pk_mul_f32 v[90:91], v[90:91], v[48:49] op_sel:[0,1] op_sel_hi:[1,1]
  v_pk_mul_f32 v[92:93], v[92:93], v[48:49] op_sel:[0,1] op_sel_hi:[1,1]
  v_pk_mul_f32 v[94:95], v[94:95], v[48:49] op_sel:[0,1] op_sel_hi:[1,1]
  v_cvt_pk_bf16_f32 v152, v88, v89
  v_cvt_pk_bf16_f32 v153, v90, v91
  v_cvt_pk_bf16_f32 v154, v92, v93
  v_cvt_pk_bf16_f32 v155, v94, v95
  s_add_u32 s60, s59, 28672
  buffer_load_dwordx4 a[196:199], v1, s[4:7], s60 offen offset:0 sc1
  v_accvgpr_read_b32 v80, a8
  v_accvgpr_read_b32 v81, a9
  v_accvgpr_read_b32 v82, a10
  v_accvgpr_read_b32 v83, a11
  v_accvgpr_read_b32 v84, a24
  v_accvgpr_read_b32 v85, a25
  v_accvgpr_read_b32 v86, a26
  v_accvgpr_read_b32 v87, a27
  v_pk_mul_f32 v[80:81], v[80:81], v[56:57] op_sel:[0,0] op_sel_hi:[1,0]
  v_pk_mul_f32 v[82:83], v[82:83], v[56:57] op_sel:[0,0] op_sel_hi:[1,0]
  v_pk_mul_f32 v[84:85], v[84:85], v[56:57] op_sel:[0,0] op_sel_hi:[1,0]
  v_pk_mul_f32 v[86:87], v[86:87], v[56:57] op_sel:[0,0] op_sel_hi:[1,0]
  v_cvt_pk_bf16_f32 v168, v80, v81
  v_cvt_pk_bf16_f32 v169, v82, v83
  v_cvt_pk_bf16_f32 v170, v84, v85
  v_cvt_pk_bf16_f32 v171, v86, v87
  buffer_load_dwordx4 a[204:207], v1, s[4:7], s60 offen offset:1024 sc1
  v_accvgpr_read_b32 v88, a12
  v_accvgpr_read_b32 v89, a13
  v_accvgpr_read_b32 v90, a14
  v_accvgpr_read_b32 v91, a15
  v_accvgpr_read_b32 v92, a28
  v_accvgpr_read_b32 v93, a29
  v_accvgpr_read_b32 v94, a30
  v_accvgpr_read_b32 v95, a31
  v_pk_mul_f32 v[88:89], v[88:89], v[56:57] op_sel:[0,1] op_sel_hi:[1,1]
  v_pk_mul_f32 v[90:91], v[90:91], v[56:57] op_sel:[0,1] op_sel_hi:[1,1]
  v_pk_mul_f32 v[92:93], v[92:93], v[56:57] op_sel:[0,1] op_sel_hi:[1,1]
  v_pk_mul_f32 v[94:95], v[94:95], v[56:57] op_sel:[0,1] op_sel_hi:[1,1]
  v_cvt_pk_bf16_f32 v184, v88, v89
  v_cvt_pk_bf16_f32 v185, v90, v91
  v_cvt_pk_bf16_f32 v186, v92, v93
  v_cvt_pk_bf16_f32 v187, v94, v95
  s_add_u32 s76, s59, 28672
  buffer_load_dwordx4 a[200:203], v2, s[4:7], s76 offen offset:0 sc1
  v_accvgpr_read_b32 v80, a32
  v_accvgpr_read_b32 v81, a33
  v_accvgpr_read_b32 v82, a34
  v_accvgpr_read_b32 v83, a35
  v_accvgpr_read_b32 v84, a48
  v_accvgpr_read_b32 v85, a49
  v_accvgpr_read_b32 v86, a50
pad_m_9:
  s_cbranch_execz warm_2
  v_accvgpr_read_b32 v87, a51
  v_pk_mul_f32 v[80:81], v[80:81], v[48:49] op_sel:[0,0] op_sel_hi:[1,0]
  v_pk_mul_f32 v[82:83], v[82:83], v[48:49] op_sel:[0,0] op_sel_hi:[1,0]
  v_pk_mul_f32 v[84:85], v[84:85], v[48:49] op_sel:[0,0] op_sel_hi:[1,0]
  v_pk_mul_f32 v[86:87], v[86:87], v[48:49] op_sel:[0,0] op_sel_hi:[1,0]
  v_cvt_pk_bf16_f32 v140, v80, v81
  v_cvt_pk_bf16_f32 v141, v82, v83
  v_cvt_pk_bf16_f32 v142, v84, v85
  v_cvt_pk_bf16_f32 v143, v86, v87
  buffer_load_dwordx4 a[208:211], v2, s[4:7], s76 offen offset:1024 sc1
  v_accvgpr_read_b32 v88, a36
  v_accvgpr_read_b32 v89, a37
  v_accvgpr_read_b32 v90, a38
  v_accvgpr_read_b32 v91, a39
  v_accvgpr_read_b32 v92, a52
  v_accvgpr_read_b32 v93, a53
  v_accvgpr_read_b32 v94, a54
  v_accvgpr_read_b32 v95, a55
  v_pk_mul_f32 v[88:89], v[88:89], v[48:49] op_sel:[0,1] op_sel_hi:[1,1]
  v_pk_mul_f32 v[90:91], v[90:91], v[48:49] op_sel:[0,1] op_sel_hi:[1,1]
  v_pk_mul_f32 v[92:93], v[92:93], v[48:49] op_sel:[0,1] op_sel_hi:[1,1]
  v_pk_mul_f32 v[94:95], v[94:95], v[48:49] op_sel:[0,1] op_sel_hi:[1,1]
  v_cvt_pk_bf16_f32 v156, v88, v89
  v_cvt_pk_bf16_f32 v157, v90, v91
  v_cvt_pk_bf16_f32 v158, v92, v93
  v_cvt_pk_bf16_f32 v159, v94, v95
  s_waitcnt vmcnt(21) lgkmcnt(4)
  v_mfma_f32_16x16x32_bf16 v[64:67], v[224:227], v[192:195], 0
  s_waitcnt vmcnt(19) lgkmcnt(2)
  s_add_u32 s60, s59, 32768
  ds_read_b64_tr_b16 v[236:237], v21 offset:0
  ds_read_b64_tr_b16 v[238:239], v21 offset:2048
  v_mfma_f32_16x16x32_bf16 v[64:67], v[228:231], v[200:203], v[64:67]
  s_waitcnt vmcnt(17) lgkmcnt(2)
  ds_read_b64_tr_b16 v[240:241], v21 offset:4096
  ds_read_b64_tr_b16 v[242:243], v21 offset:6144
  v_mfma_f32_16x16x32_bf16 v[64:67], v[232:235], v[208:211], v[64:67]
  s_waitcnt vmcnt(16)
  ds_read_b64_tr_b16 v[244:245], v21 offset:8192
  v_accvgpr_read_b32 v160, a40
  v_mfma_f32_16x16x32_bf16 v[80:83], v[232:235], v[212:215], 0
  ds_read_b64_tr_b16 v[246:247], v21 offset:10240
  v_accvgpr_read_b32 v161, a41
  v_mfma_f32_16x16x32_bf16 v[80:83], v[228:231], v[204:207], v[80:83]
  buffer_load_dwordx4 a[212:215], v1, s[4:7], s60 offen offset:0 sc1
  v_mfma_f32_16x16x32_bf16 v[80:83], v[224:227], v[196:199], v[80:83]
  v_accvgpr_read_b32 v162, a42
  v_accvgpr_read_b32 v163, a43
  v_mfma_f32_16x16x32_bf16 v[96:99], v[224:227], a[224:227], 0
  s_add_u32 s76, s59, 32768
  v_accvgpr_read_b32 v164, a56
  v_accvgpr_read_b32 v165, a57
  v_mfma_f32_16x16x32_bf16 v[96:99], v[228:231], a[232:235], v[96:99]
  buffer_load_dwordx4 a[220:223], v1, s[4:7], s60 offen offset:1024 sc1
  v_mfma_f32_16x16x32_bf16 v[96:99], v[232:235], a[240:243], v[96:99]
  v_accvgpr_read_b32 v166, a58
  v_accvgpr_read_b32 v167, a59
  v_mfma_f32_16x16x32_bf16 v[112:115], v[232:235], a[244:247], 0
  v_mul_f32 v160, v160, v56
  v_mul_f32 v161, v161, v56
  v_mfma_f32_16x16x32_bf16 v[112:115], v[228:231], a[236:239], v[112:115]
  buffer_load_dwordx4 a[216:219], v2, s[4:7], s76 offen offset:0 sc1
  v_mfma_f32_16x16x32_bf16 v[112:115], v[224:227], a[228:231], v[112:115]
  s_waitcnt lgkmcnt(0)
  ds_read_b64_tr_b16 v[224:225], v22 offset:0
  ds_read_b64_tr_b16 v[226:227], v22 offset:2048
  v_mfma_f32_16x16x32_bf16 v[116:119], v[236:239], a[228:231], 0
  ds_read_b64_tr_b16 v[228:229], v22 offset:4096
  v_mul_f32 v162, v162, v56
  v_mfma_f32_16x16x32_bf16 v[116:119], v[240:243], a[236:239], v[116:119]
  ds_read_b64_tr_b16 v[230:231], v22 offset:6144
  v_mul_f32 v163, v163, v56
  v_mfma_f32_16x16x32_bf16 v[116:119], v[244:247], a[244:247], v[116:119]
  s_add_u32 s60, s59, 36864
  ds_read_b64_tr_b16 v[232:233], v22 offset:8192
  v_mul_f32 v164, v164, v56
  v_mfma_f32_16x16x32_bf16 v[100:103], v[244:247], a[240:243], 0
  ds_read_b64_tr_b16 v[234:235], v22 offset:10240
  v_mul_f32 v165, v165, v56
  v_mfma_f32_16x16x32_bf16 v[100:103], v[240:243], a[232:235], v[100:103]
  buffer_load_dwordx4 a[144:147], v2, s[4:7], s76 offen offset:1024 sc1
  v_mfma_f32_16x16x32_bf16 v[100:103], v[236:239], a[224:227], v[100:103]
  v_mul_f32 v166, v166, v56
  v_mul_f32 v167, v167, v56
  v_mfma_f32_16x16x32_bf16 v[84:87], v[236:239], v[196:199], 0
  v_cvt_pk_bf16_f32 v172, v160, v161
  v_accvgpr_read_b32 v176, a44
  v_mfma_f32_16x16x32_bf16 v[84:87], v[240:243], v[204:207], v[84:87]
  buffer_load_dwordx4 a[128:131], v1, s[4:7], s60 offen offset:0 sc1
  v_mfma_f32_16x16x32_bf16 v[84:87], v[244:247], v[212:215], v[84:87]
  v_cvt_pk_bf16_f32 v173, v162, v163
  v_accvgpr_read_b32 v177, a45
  v_mfma_f32_16x16x32_bf16 v[68:71], v[244:247], v[208:211], 0
  v_cvt_pk_bf16_f32 v174, v164, v165
  v_accvgpr_read_b32 v178, a46
  v_mfma_f32_16x16x32_bf16 v[68:71], v[240:243], v[200:203], v[68:71]
  buffer_load_dwordx4 a[136:139], v1, s[4:7], s60 offen offset:1024 sc1
  v_mfma_f32_16x16x32_bf16 v[68:71], v[236:239], v[192:195], v[68:71]
  s_waitcnt lgkmcnt(0)
  ds_read_b64_tr_b16 v[236:237], v23 offset:0
  ds_read_b64_tr_b16 v[238:239], v23 offset:2048
  v_mfma_f32_16x16x32_bf16 v[72:75], v[224:227], v[192:195], 0
  s_add_u32 s76, s59, 36864
  ds_read_b64_tr_b16 v[240:241], v23 offset:4096
  v_cvt_pk_bf16_f32 v175, v166, v167
  v_mfma_f32_16x16x32_bf16 v[72:75], v[228:231], v[200:203], v[72:75]
  ds_read_b64_tr_b16 v[242:243], v23 offset:6144
  v_accvgpr_read_b32 v179, a47
  v_mfma_f32_16x16x32_bf16 v[72:75], v[232:235], v[208:211], v[72:75]
  ds_read_b64_tr_b16 v[244:245], v23 offset:8192
  v_accvgpr_read_b32 v180, a60
  v_mfma_f32_16x16x32_bf16 v[88:91], v[232:235], v[212:215], 0
  ds_read_b64_tr_b16 v[246:247], v23 offset:10240
  v_accvgpr_read_b32 v181, a61
  v_mfma_f32_16x16x32_bf16 v[88:91], v[228:231], v[204:207], v[88:91]
  buffer_load_dwordx4 a[132:135], v2, s[4:7], s76 offen offset:0 sc1
  v_mfma_f32_16x16x32_bf16 v[88:91], v[224:227], v[196:199], v[88:91]
  v_accvgpr_read_b32 v182, a62
  v_accvgpr_read_b32 v183, a63
  v_mfma_f32_16x16x32_bf16 v[104:107], v[224:227], a[224:227], 0
  v_mul_f32 v176, v176, v57
  v_mul_f32 v177, v177, v57
  v_mfma_f32_16x16x32_bf16 v[104:107], v[228:231], a[232:235], v[104:107]
  buffer_load_dwordx4 a[140:143], v2, s[4:7], s76 offen offset:1024 sc1
  v_mfma_f32_16x16x32_bf16 v[104:107], v[232:235], a[240:243], v[104:107]
  s_add_u32 s60, s59, 40960
  v_mul_f32 v178, v178, v57
  v_mul_f32 v179, v179, v57
  v_mfma_f32_16x16x32_bf16 v[120:123], v[232:235], a[244:247], 0
  v_mul_f32 v180, v180, v57
  v_mul_f32 v181, v181, v57
  v_mfma_f32_16x16x32_bf16 v[120:123], v[228:231], a[236:239], v[120:123]
  buffer_load_dwordx4 a[0:3], v1, s[4:7], s60 offen offset:0 sc1
  v_mfma_f32_16x16x32_bf16 v[120:123], v[224:227], a[228:231], v[120:123]
  s_waitcnt lgkmcnt(0)
  ds_read_b64_tr_b16 v[224:225], v20 offset:12288
  ds_read_b64_tr_b16 v[226:227], v20 offset:14336
  v_mfma_f32_16x16x32_bf16 v[124:127], v[236:239], a[228:231], 0
  ds_read_b64_tr_b16 v[228:229], v20 offset:16384
  v_mul_f32 v182, v182, v57
  v_mfma_f32_16x16x32_bf16 v[124:127], v[240:243], a[236:239], v[124:127]
  ds_read_b64_tr_b16 v[230:231], v20 offset:18432
  v_mul_f32 v183, v183, v57
  v_mfma_f32_16x16x32_bf16 v[124:127], v[244:247], a[244:247], v[124:127]
  ds_read_b64_tr_b16 v[232:233], v20 offset:20480
  v_cvt_pk_bf16_f32 v188, v176, v177
  v_mfma_f32_16x16x32_bf16 v[108:111], v[244:247], a[240:243], 0
  ds_read_b64_tr_b16 v[234:235], v20 offset:22528
  v_accvgpr_read_b32 v128, a64
  v_mfma_f32_16x16x32_bf16 v[108:111], v[240:243], a[232:235], v[108:111]
  buffer_load_dwordx4 a[4:7], v1, s[4:7], s60 offen offset:1024 sc1
  v_mfma_f32_16x16x32_bf16 v[108:111], v[236:239], a[224:227], v[108:111]
  s_add_u32 s76, s59, 40960
  v_cvt_pk_bf16_f32 v189, v178, v179
  v_accvgpr_read_b32 v129, a65
  v_mfma_f32_16x16x32_bf16 v[92:95], v[236:239], v[196:199], 0
  v_cvt_pk_bf16_f32 v190, v180, v181
  v_accvgpr_read_b32 v130, a66
  v_mfma_f32_16x16x32_bf16 v[92:95], v[240:243], v[204:207], v[92:95]
  buffer_load_dwordx4 a[16:19], v2, s[4:7], s76 offen offset:0 sc1
  v_mfma_f32_16x16x32_bf16 v[92:95], v[244:247], v[212:215], v[92:95]
  v_cvt_pk_bf16_f32 v191, v182, v183
  v_accvgpr_read_b32 v131, a67
  v_mfma_f32_16x16x32_bf16 v[76:79], v[244:247], v[208:211], 0
  v_accvgpr_read_b32 v132, a80
  v_accvgpr_read_b32 v133, a81
  v_mfma_f32_16x16x32_bf16 v[76:79], v[240:243], v[200:203], v[76:79]
  v_accvgpr_read_b32 v134, a82
  v_accvgpr_read_b32 v135, a83
  v_mfma_f32_16x16x32_bf16 v[76:79], v[236:239], v[192:195], v[76:79]
  s_waitcnt vmcnt(26) lgkmcnt(0)
  ds_read_b64_tr_b16 v[236:237], v21 offset:12288
  ds_read_b64_tr_b16 v[238:239], v21 offset:14336
  v_mfma_f32_16x16x32_bf16 v[64:67], v[224:227], v[216:219], v[64:67]
  s_waitcnt vmcnt(24)
  s_add_u32 s60, s59, 45056
  ds_read_b64_tr_b16 v[240:241], v21 offset:16384
  v_mul_f32 v128, v128, v48
  v_mfma_f32_16x16x32_bf16 v[64:67], v[228:231], a[168:171], v[64:67]
  s_waitcnt vmcnt(22)
  ds_read_b64_tr_b16 v[242:243], v21 offset:18432
  v_mul_f32 v129, v129, v48
  v_mfma_f32_16x16x32_bf16 v[64:67], v[232:235], a[176:179], v[64:67]
  s_waitcnt vmcnt(21)
  ds_read_b64_tr_b16 v[244:245], v21 offset:20480
  v_mul_f32 v130, v130, v48
  v_mfma_f32_16x16x32_bf16 v[80:83], v[232:235], a[180:183], v[80:83]
  ds_read_b64_tr_b16 v[246:247], v21 offset:22528
  v_mul_f32 v131, v131, v48
  v_mfma_f32_16x16x32_bf16 v[80:83], v[228:231], a[172:175], v[80:83]
  buffer_load_dwordx4 a[20:23], v2, s[4:7], s76 offen offset:1024 sc1
  v_mfma_f32_16x16x32_bf16 v[80:83], v[224:227], v[220:223], v[80:83]
  v_mul_f32 v132, v132, v48
  v_mul_f32 v133, v133, v48
  v_mfma_f32_16x16x32_bf16 v[96:99], v[224:227], a[248:251], v[96:99]
  v_mul_f32 v134, v134, v48
  v_mul_f32 v135, v135, v48
  v_mfma_f32_16x16x32_bf16 v[96:99], v[228:231], a[148:151], v[96:99]
  s_waitcnt vmcnt(21)
  buffer_load_dwordx4 a[8:11], v1, s[4:7], s60 offen offset:0 sc1
  v_mfma_f32_16x16x32_bf16 v[96:99], v[232:235], a[156:159], v[96:99]
  s_waitcnt vmcnt(21)
  s_add_u32 s76, s59, 45056
  v_cvt_pk_bf16_f32 v28, v128, v129
  v_accvgpr_read_b32 v144, a68
  v_mfma_f32_16x16x32_bf16 v[112:115], v[232:235], a[160:163], v[112:115]
  v_cvt_pk_bf16_f32 v29, v130, v131
  v_accvgpr_read_b32 v145, a69
  v_mfma_f32_16x16x32_bf16 v[112:115], v[228:231], a[152:155], v[112:115]
  buffer_load_dwordx4 a[12:15], v1, s[4:7], s60 offen offset:1024 sc1
  v_mfma_f32_16x16x32_bf16 v[112:115], v[224:227], a[252:255], v[112:115]
  s_waitcnt lgkmcnt(0)
  ds_read_b64_tr_b16 v[224:225], v22 offset:12288
  ds_read_b64_tr_b16 v[226:227], v22 offset:14336
  v_mfma_f32_16x16x32_bf16 v[116:119], v[236:239], a[252:255], v[116:119]
  ds_read_b64_tr_b16 v[228:229], v22 offset:16384
  v_cvt_pk_bf16_f32 v30, v132, v133
  v_mfma_f32_16x16x32_bf16 v[116:119], v[240:243], a[152:155], v[116:119]
  ds_read_b64_tr_b16 v[230:231], v22 offset:18432
  v_accvgpr_read_b32 v146, a70
  v_mfma_f32_16x16x32_bf16 v[116:119], v[244:247], a[160:163], v[116:119]
  ds_read_b64_tr_b16 v[232:233], v22 offset:20480
  v_cvt_pk_bf16_f32 v31, v134, v135
  v_mfma_f32_16x16x32_bf16 v[100:103], v[244:247], a[156:159], v[100:103]
  ds_read_b64_tr_b16 v[234:235], v22 offset:22528
  v_accvgpr_read_b32 v147, a71
  v_mfma_f32_16x16x32_bf16 v[100:103], v[240:243], a[148:151], v[100:103]
  buffer_load_dwordx4 a[24:27], v2, s[4:7], s76 offen offset:0 sc1
  v_mfma_f32_16x16x32_bf16 v[100:103], v[236:239], a[248:251], v[100:103]
  s_add_u32 s60, s59, 49152
  v_accvgpr_read_b32 v148, a84
  v_accvgpr_read_b32 v149, a85
  v_mfma_f32_16x16x32_bf16 v[84:87], v[236:239], v[220:223], v[84:87]
  v_accvgpr_read_b32 v150, a86
  v_accvgpr_read_b32 v151, a87
  v_mfma_f32_16x16x32_bf16 v[84:87], v[240:243], a[172:175], v[84:87]
  buffer_load_dwordx4 a[28:31], v2, s[4:7], s76 offen offset:1024 sc1
  v_mfma_f32_16x16x32_bf16 v[84:87], v[244:247], a[180:183], v[84:87]
  v_mul_f32 v144, v144, v49
  v_mul_f32 v145, v145, v49
  v_mfma_f32_16x16x32_bf16 v[68:71], v[244:247], a[176:179], v[68:71]
  v_mul_f32 v146, v146, v49
  v_mul_f32 v147, v147, v49
  v_mfma_f32_16x16x32_bf16 v[68:71], v[240:243], a[168:171], v[68:71]
  buffer_load_dwordx4 a[32:35], v1, s[4:7], s60 offen offset:0 sc1
  v_mfma_f32_16x16x32_bf16 v[68:71], v[236:239], v[216:219], v[68:71]
  s_waitcnt lgkmcnt(0)
  ds_read_b64_tr_b16 v[236:237], v23 offset:12288
  ds_read_b64_tr_b16 v[238:239], v23 offset:14336
  v_mfma_f32_16x16x32_bf16 v[72:75], v[224:227], v[216:219], v[72:75]
  ds_read_b64_tr_b16 v[240:241], v23 offset:16384
  v_mul_f32 v148, v148, v49
  v_mfma_f32_16x16x32_bf16 v[72:75], v[228:231], a[168:171], v[72:75]
  s_add_u32 s76, s59, 49152
  ds_read_b64_tr_b16 v[242:243], v23 offset:18432
  v_mul_f32 v149, v149, v49
  v_mfma_f32_16x16x32_bf16 v[72:75], v[232:235], a[176:179], v[72:75]
  ds_read_b64_tr_b16 v[244:245], v23 offset:20480
  v_mul_f32 v150, v150, v49
  v_mfma_f32_16x16x32_bf16 v[88:91], v[232:235], a[180:183], v[88:91]
  ds_read_b64_tr_b16 v[246:247], v23 offset:22528
  v_mul_f32 v151, v151, v49
  v_mfma_f32_16x16x32_bf16 v[88:91], v[228:231], a[172:175], v[88:91]
  buffer_load_dwordx4 a[36:39], v1, s[4:7], s60 offen offset:1024 sc1
  v_mfma_f32_16x16x32_bf16 v[88:91], v[224:227], v[220:223], v[88:91]
  v_cvt_pk_bf16_f32 v32, v144, v145
  v_accvgpr_read_b32 v160, a72
  v_mfma_f32_16x16x32_bf16 v[104:107], v[224:227], a[248:251], v[104:107]
  v_cvt_pk_bf16_f32 v33, v146, v147
  v_accvgpr_read_b32 v161, a73
  v_mfma_f32_16x16x32_bf16 v[104:107], v[228:231], a[148:151], v[104:107]
  buffer_load_dwordx4 a[48:51], v2, s[4:7], s76 offen offset:0 sc1
  v_mfma_f32_16x16x32_bf16 v[104:107], v[232:235], a[156:159], v[104:107]
  v_cvt_pk_bf16_f32 v34, v148, v149
  v_accvgpr_read_b32 v162, a74
  v_mfma_f32_16x16x32_bf16 v[120:123], v[232:235], a[160:163], v[120:123]
  v_cvt_pk_bf16_f32 v35, v150, v151
  v_accvgpr_read_b32 v163, a75
  v_mfma_f32_16x16x32_bf16 v[120:123], v[228:231], a[152:155], v[120:123]
  buffer_load_dwordx4 a[52:55], v2, s[4:7], s76 offen offset:1024 sc1
  v_mfma_f32_16x16x32_bf16 v[120:123], v[224:227], a[252:255], v[120:123]
  s_waitcnt lgkmcnt(0)
  s_barrier
  ds_read_b64_tr_b16 v[224:225], v20 offset:24576
  v_mfma_f32_16x16x32_bf16 v[124:127], v[236:239], a[252:255], v[124:127]
  s_add_u32 s60, s59, 53248
  ds_read_b64_tr_b16 v[226:227], v20 offset:26624
  ds_read_b64_tr_b16 v[228:229], v20 offset:28672
  v_mfma_f32_16x16x32_bf16 v[124:127], v[240:243], a[152:155], v[124:127]
  ds_read_b64_tr_b16 v[230:231], v20 offset:30720
  v_accvgpr_read_b32 v164, a88
  v_mfma_f32_16x16x32_bf16 v[124:127], v[244:247], a[160:163], v[124:127]
  ds_read_b64_tr_b16 v[232:233], v20 offset:32768
  v_accvgpr_read_b32 v165, a89
  v_mfma_f32_16x16x32_bf16 v[108:111], v[244:247], a[156:159], v[108:111]
  ds_read_b64_tr_b16 v[234:235], v20 offset:34816
  v_accvgpr_read_b32 v166, a90
  v_mfma_f32_16x16x32_bf16 v[108:111], v[240:243], a[148:151], v[108:111]
  buffer_load_dwordx4 a[40:43], v1, s[4:7], s60 offen offset:0 sc1
  v_mfma_f32_16x16x32_bf16 v[108:111], v[236:239], a[248:251], v[108:111]
  v_accvgpr_read_b32 v167, a91
  v_mul_f32 v160, v160, v56
  v_mfma_f32_16x16x32_bf16 v[92:95], v[236:239], v[220:223], v[92:95]
  s_add_u32 s76, s59, 53248
  v_mul_f32 v161, v161, v56
  v_mul_f32 v162, v162, v56
  v_mfma_f32_16x16x32_bf16 v[92:95], v[240:243], a[172:175], v[92:95]
  buffer_load_dwordx4 a[44:47], v1, s[4:7], s60 offen offset:1024 sc1
  v_mfma_f32_16x16x32_bf16 v[92:95], v[244:247], a[180:183], v[92:95]
  v_mul_f32 v163, v163, v56
  v_mul_f32 v164, v164, v56
  v_mfma_f32_16x16x32_bf16 v[76:79], v[244:247], a[176:179], v[76:79]
  v_mul_f32 v165, v165, v56
  v_mul_f32 v166, v166, v56
  v_mfma_f32_16x16x32_bf16 v[76:79], v[240:243], a[168:171], v[76:79]
  buffer_load_dwordx4 a[56:59], v2, s[4:7], s76 offen offset:0 sc1
  v_mfma_f32_16x16x32_bf16 v[76:79], v[236:239], v[216:219], v[76:79]
  s_waitcnt vmcnt(30) lgkmcnt(0)
  ds_read_b64_tr_b16 v[236:237], v21 offset:24576
  ds_read_b64_tr_b16 v[238:239], v21 offset:26624
  v_mfma_f32_16x16x32_bf16 v[64:67], v[224:227], a[184:187], v[64:67]
  s_waitcnt vmcnt(26)
  ds_read_b64_tr_b16 v[240:241], v21 offset:28672
  v_mul_f32 v167, v167, v56
  v_mfma_f32_16x16x32_bf16 v[64:67], v[228:231], a[196:199], v[64:67]
  s_waitcnt vmcnt(22)
  ds_read_b64_tr_b16 v[242:243], v21 offset:30720
  v_cvt_pk_bf16_f32 v36, v160, v161
  v_mfma_f32_16x16x32_bf16 v[64:67], v[232:235], a[212:215], v[64:67]
  s_waitcnt vmcnt(21)
  s_add_u32 s60, s59, 57344
  ds_read_b64_tr_b16 v[244:245], v21 offset:32768
  v_accvgpr_read_b32 v176, a76
  v_mfma_f32_16x16x32_bf16 v[80:83], v[232:235], a[220:223], v[80:83]
  ds_read_b64_tr_b16 v[246:247], v21 offset:34816
  v_cvt_pk_bf16_f32 v37, v162, v163
  v_mfma_f32_16x16x32_bf16 v[80:83], v[228:231], a[204:207], v[80:83]
  buffer_load_dwordx4 a[60:63], v2, s[4:7], s76 offen offset:1024 sc1
  v_mfma_f32_16x16x32_bf16 v[80:83], v[224:227], a[188:191], v[80:83]
  v_cvt_pk_bf16_f32 v38, v164, v165
  v_accvgpr_read_b32 v177, a77
  v_mfma_f32_16x16x32_bf16 v[96:99], v[224:227], a[164:167], v[96:99]
  v_cvt_pk_bf16_f32 v39, v166, v167
  v_accvgpr_read_b32 v178, a78
  v_mfma_f32_16x16x32_bf16 v[96:99], v[228:231], a[200:203], v[96:99]
  s_waitcnt vmcnt(21)
  buffer_load_dwordx4 a[64:67], v1, s[4:7], s60 offen offset:0 sc1
  v_mfma_f32_16x16x32_bf16 v[96:99], v[232:235], a[216:219], v[96:99]
  s_waitcnt vmcnt(21)
  v_accvgpr_read_b32 v179, a79
  v_accvgpr_read_b32 v180, a92
  v_mfma_f32_16x16x32_bf16 v[112:115], v[232:235], a[144:147], v[112:115]
  v_accvgpr_read_b32 v181, a93
  v_accvgpr_read_b32 v182, a94
  v_mfma_f32_16x16x32_bf16 v[112:115], v[228:231], a[208:211], v[112:115]
  buffer_load_dwordx4 a[68:71], v1, s[4:7], s60 offen offset:1024 sc1
  v_mfma_f32_16x16x32_bf16 v[112:115], v[224:227], a[192:195], v[112:115]
  s_waitcnt lgkmcnt(0)
  ds_read_b64_tr_b16 v[224:225], v22 offset:24576
  ds_read_b64_tr_b16 v[226:227], v22 offset:26624
  v_mfma_f32_16x16x32_bf16 v[116:119], v[236:239], a[192:195], v[116:119]
  s_add_u32 s76, s59, 57344
  ds_read_b64_tr_b16 v[228:229], v22 offset:28672
  v_accvgpr_read_b32 v183, a95
  v_mfma_f32_16x16x32_bf16 v[116:119], v[240:243], a[208:211], v[116:119]
  ds_read_b64_tr_b16 v[230:231], v22 offset:30720
  v_mul_f32 v176, v176, v57
  v_mfma_f32_16x16x32_bf16 v[116:119], v[244:247], a[144:147], v[116:119]
  ds_read_b64_tr_b16 v[232:233], v22 offset:32768
  v_mul_f32 v177, v177, v57
  v_mfma_f32_16x16x32_bf16 v[100:103], v[244:247], a[216:219], v[100:103]
  ds_read_b64_tr_b16 v[234:235], v22 offset:34816
  v_mul_f32 v178, v178, v57
  v_mfma_f32_16x16x32_bf16 v[100:103], v[240:243], a[200:203], v[100:103]
  buffer_load_dwordx4 a[80:83], v2, s[4:7], s76 offen offset:0 sc1
  v_mfma_f32_16x16x32_bf16 v[100:103], v[236:239], a[164:167], v[100:103]
  v_mul_f32 v179, v179, v57
  v_add_co_u32 v60, vcc, (att_retry-att_last-8192)/36*4, v60
  v_mfma_f32_16x16x32_bf16 v[84:87], v[236:239], a[188:191], v[84:87]
  v_mul_f32 v180, v180, v57
  v_addc_co_u32 v61, vcc, 0, v61, vcc
  v_mfma_f32_16x16x32_bf16 v[84:87], v[240:243], a[204:207], v[84:87]
  buffer_load_dwordx4 a[84:87], v2, s[4:7], s76 offen offset:1024 sc1
  v_mfma_f32_16x16x32_bf16 v[84:87], v[244:247], a[220:223], v[84:87]
  s_add_u32 s60, s59, 61440
  v_mul_f32 v181, v181, v57
  v_mul_f32 v182, v182, v57
  v_mfma_f32_16x16x32_bf16 v[68:71], v[244:247], a[212:215], v[68:71]
  v_mul_f32 v183, v183, v57
  v_cvt_pk_bf16_f32 v40, v176, v177
  v_mfma_f32_16x16x32_bf16 v[68:71], v[240:243], a[196:199], v[68:71]
  buffer_load_dwordx4 a[72:75], v1, s[4:7], s60 offen offset:0 sc1
  v_mfma_f32_16x16x32_bf16 v[68:71], v[236:239], a[184:187], v[68:71]
  s_waitcnt lgkmcnt(0)
  ds_read_b64_tr_b16 v[236:237], v23 offset:24576
  ds_read_b64_tr_b16 v[238:239], v23 offset:26624
  v_mfma_f32_16x16x32_bf16 v[72:75], v[224:227], a[184:187], v[72:75]
  ds_read_b64_tr_b16 v[240:241], v23 offset:28672
  v_accvgpr_read_b32 v128, a96
  v_mfma_f32_16x16x32_bf16 v[72:75], v[228:231], a[196:199], v[72:75]
  ds_read_b64_tr_b16 v[242:243], v23 offset:30720
  v_cvt_pk_bf16_f32 v41, v178, v179
  v_mfma_f32_16x16x32_bf16 v[72:75], v[232:235], a[212:215], v[72:75]
  ds_read_b64_tr_b16 v[244:245], v23 offset:32768
  v_accvgpr_read_b32 v129, a97
  v_mfma_f32_16x16x32_bf16 v[88:91], v[232:235], a[220:223], v[88:91]
  ds_read_b64_tr_b16 v[246:247], v23 offset:34816
  v_cvt_pk_bf16_f32 v42, v180, v181
  v_mfma_f32_16x16x32_bf16 v[88:91], v[228:231], a[204:207], v[88:91]
  global_load_dword v62, v[60:61], off
  v_mfma_f32_16x16x32_bf16 v[88:91], v[224:227], a[188:191], v[88:91]
  s_add_u32 s76, s59, 61440
  v_cvt_pk_bf16_f32 v43, v182, v183
  v_accvgpr_read_b32 v130, a98
  v_mfma_f32_16x16x32_bf16 v[104:107], v[224:227], a[164:167], v[104:107]
  v_accvgpr_read_b32 v131, a99
  v_accvgpr_read_b32 v132, a112
  v_mfma_f32_16x16x32_bf16 v[104:107], v[228:231], a[200:203], v[104:107]
  buffer_load_dwordx4 a[76:79], v1, s[4:7], s60 offen offset:1024 sc1
  v_mfma_f32_16x16x32_bf16 v[104:107], v[232:235], a[216:219], v[104:107]
  v_accvgpr_read_b32 v133, a113
  v_accvgpr_read_b32 v134, a114
  v_mfma_f32_16x16x32_bf16 v[120:123], v[232:235], a[144:147], v[120:123]
  v_accvgpr_read_b32 v135, a115
  v_mul_f32 v128, v128, v48
  v_mfma_f32_16x16x32_bf16 v[120:123], v[228:231], a[208:211], v[120:123]
  buffer_load_dwordx4 a[88:91], v2, s[4:7], s76 offen offset:0 sc1
  v_mfma_f32_16x16x32_bf16 v[120:123], v[224:227], a[192:195], v[120:123]
  s_waitcnt lgkmcnt(0)
  ds_read_b64_tr_b16 v[224:225], v20 offset:36864
  ds_read_b64_tr_b16 v[226:227], v20 offset:38912
  v_mfma_f32_16x16x32_bf16 v[124:127], v[236:239], a[192:195], v[124:127]
  s_add_u32 s60, s59, 65536
  ds_read_b64_tr_b16 v[228:229], v20 offset:40960
  v_mul_f32 v129, v129, v48
  v_mfma_f32_16x16x32_bf16 v[124:127], v[240:243], a[208:211], v[124:127]
  ds_read_b64_tr_b16 v[230:231], v20 offset:43008
  v_mul_f32 v130, v130, v48
  v_mfma_f32_16x16x32_bf16 v[124:127], v[244:247], a[144:147], v[124:127]
  ds_read_b64_tr_b16 v[232:233], v20 offset:45056
  v_mul_f32 v131, v131, v48
  v_mfma_f32_16x16x32_bf16 v[108:111], v[244:247], a[216:219], v[108:111]
  ds_read_b64_tr_b16 v[234:235], v20 offset:47104
  v_mul_f32 v132, v132, v48
  v_mfma_f32_16x16x32_bf16 v[108:111], v[240:243], a[200:203], v[108:111]
  buffer_load_dwordx4 a[92:95], v2, s[4:7], s76 offen offset:1024 sc1
  v_mfma_f32_16x16x32_bf16 v[108:111], v[236:239], a[164:167], v[108:111]
  v_mul_f32 v133, v133, v48
  v_mul_f32 v134, v134, v48
  v_mfma_f32_16x16x32_bf16 v[92:95], v[236:239], a[188:191], v[92:95]
  v_mul_f32 v135, v135, v48
  v_cvt_pk_bf16_f32 v44, v128, v129
  v_mfma_f32_16x16x32_bf16 v[92:95], v[240:243], a[204:207], v[92:95]
  buffer_load_dwordx4 a[96:99], v1, s[4:7], s60 offen offset:0 sc1
  v_mfma_f32_16x16x32_bf16 v[92:95], v[244:247], a[220:223], v[92:95]
  s_add_u32 s76, s59, 65536
  v_cvt_pk_bf16_f32 v45, v130, v131
  v_accvgpr_read_b32 v144, a100
  v_mfma_f32_16x16x32_bf16 v[76:79], v[244:247], a[212:215], v[76:79]
  v_cvt_pk_bf16_f32 v46, v132, v133
  v_accvgpr_read_b32 v145, a101
  v_mfma_f32_16x16x32_bf16 v[76:79], v[240:243], a[196:199], v[76:79]
  v_cvt_pk_bf16_f32 v47, v134, v135
  v_accvgpr_read_b32 v146, a102
  v_mfma_f32_16x16x32_bf16 v[76:79], v[236:239], a[184:187], v[76:79]
  s_waitcnt vmcnt(29) lgkmcnt(0)
  ds_read_b64_tr_b16 v[236:237], v21 offset:36864
  ds_read_b64_tr_b16 v[238:239], v21 offset:38912
  v_accvgpr_read_b32 v147, a103
  v_mfma_f32_16x16x32_bf16 v[64:67], v[224:227], a[128:131], v[64:67]
  s_waitcnt vmcnt(25)
  ds_read_b64_tr_b16 v[240:241], v21 offset:40960
  buffer_load_dwordx4 a[100:103], v1, s[4:7], s60 offen offset:1024 sc1
  v_mfma_f32_16x16x32_bf16 v[64:67], v[228:231], a[0:3], v[64:67]
  s_waitcnt vmcnt(22)
  ds_read_b64_tr_b16 v[242:243], v21 offset:43008
  v_accvgpr_read_b32 v148, a116
  v_mfma_f32_16x16x32_bf16 v[64:67], v[232:235], a[8:11], v[64:67]
  s_waitcnt vmcnt(21)
  ds_read_b64_tr_b16 v[244:245], v21 offset:45056
  v_accvgpr_read_b32 v149, a117
  v_mfma_f32_16x16x32_bf16 v[80:83], v[232:235], a[12:15], v[80:83]
  ds_read_b64_tr_b16 v[246:247], v21 offset:47104
  v_accvgpr_read_b32 v150, a118
  v_mfma_f32_16x16x32_bf16 v[80:83], v[228:231], a[4:7], v[80:83]
  buffer_load_dwordx4 a[112:115], v2, s[4:7], s76 offen offset:0 sc1
  v_mfma_f32_16x16x32_bf16 v[80:83], v[224:227], a[136:139], v[80:83]
  s_add_u32 s60, s59, 69632
  v_accvgpr_read_b32 v151, a119
  v_mul_f32 v144, v144, v49
  v_mfma_f32_16x16x32_bf16 v[96:99], v[224:227], a[132:135], v[96:99]
  v_mul_f32 v145, v145, v49
  v_mul_f32 v146, v146, v49
  v_mfma_f32_16x16x32_bf16 v[96:99], v[228:231], a[16:19], v[96:99]
  s_waitcnt vmcnt(21)
  buffer_load_dwordx4 a[116:119], v2, s[4:7], s76 offen offset:1024 sc1
  v_mfma_f32_16x16x32_bf16 v[96:99], v[232:235], a[24:27], v[96:99]
  s_waitcnt vmcnt(21)
  v_mul_f32 v147, v147, v49
  v_mul_f32 v148, v148, v49
  v_mfma_f32_16x16x32_bf16 v[112:115], v[232:235], a[28:31], v[112:115]
  v_mul_f32 v149, v149, v49
  v_mul_f32 v150, v150, v49
  v_mfma_f32_16x16x32_bf16 v[112:115], v[228:231], a[20:23], v[112:115]
  v_mul_f32 v151, v151, v49
  v_cvt_pk_bf16_f32 v52, v144, v145
  v_mfma_f32_16x16x32_bf16 v[112:115], v[224:227], a[140:143], v[112:115]
  s_waitcnt lgkmcnt(0)
  ds_read_b64_tr_b16 v[224:225], v22 offset:36864
  ds_read_b64_tr_b16 v[226:227], v22 offset:38912
  v_mfma_f32_16x16x32_bf16 v[116:119], v[236:239], a[140:143], v[116:119]
  ds_read_b64_tr_b16 v[228:229], v22 offset:40960
  v_accvgpr_read_b32 v160, a104
  v_accvgpr_read_b32 v161, a105
  v_accvgpr_read_b32 v162, a106
  v_accvgpr_read_b32 v163, a107
  v_mfma_f32_16x16x32_bf16 v[116:119], v[240:243], a[20:23], v[116:119]
  ds_read_b64_tr_b16 v[230:231], v22 offset:43008
  buffer_load_dwordx4 a[104:107], v1, s[4:7], s60 offen offset:0 sc1
  v_mfma_f32_16x16x32_bf16 v[116:119], v[244:247], a[28:31], v[116:119]
  s_add_u32 s76, s59, 69632
  ds_read_b64_tr_b16 v[232:233], v22 offset:45056
  v_cvt_pk_bf16_f32 v53, v146, v147
  v_mfma_f32_16x16x32_bf16 v[100:103], v[244:247], a[24:27], v[100:103]
  ds_read_b64_tr_b16 v[234:235], v22 offset:47104
  v_cvt_pk_bf16_f32 v54, v148, v149
  v_mfma_f32_16x16x32_bf16 v[100:103], v[240:243], a[16:19], v[100:103]
  v_cvt_pk_bf16_f32 v55, v150, v151
  v_accvgpr_read_b32 v164, a120
  v_accvgpr_read_b32 v176, a108
  v_accvgpr_read_b32 v177, a109
  v_accvgpr_read_b32 v178, a110
  v_accvgpr_read_b32 v179, a111
  v_mfma_f32_16x16x32_bf16 v[100:103], v[236:239], a[132:135], v[100:103]
  buffer_load_dwordx4 a[108:111], v1, s[4:7], s60 offen offset:1024 sc1
  v_mfma_f32_16x16x32_bf16 v[84:87], v[236:239], a[136:139], v[84:87]
  v_accvgpr_read_b32 v165, a121
  v_accvgpr_read_b32 v166, a122
  v_mfma_f32_16x16x32_bf16 v[84:87], v[240:243], a[4:7], v[84:87]
  v_accvgpr_read_b32 v167, a123
  v_mul_f32 v160, v160, v56
  v_mfma_f32_16x16x32_bf16 v[84:87], v[244:247], a[12:15], v[84:87]
  buffer_load_dwordx4 a[120:123], v2, s[4:7], s76 offen offset:0 sc1
  v_mfma_f32_16x16x32_bf16 v[68:71], v[244:247], a[8:11], v[68:71]
  s_add_u32 s61, s80, 0
  v_mul_f32 v161, v161, v56
  v_mul_f32 v162, v162, v56
  v_mfma_f32_16x16x32_bf16 v[68:71], v[240:243], a[0:3], v[68:71]
  s_add_u32 m0, s63, 106496
  v_mul_f32 v163, v163, v56
  v_mul_f32 v164, v164, v56
  v_mfma_f32_16x16x32_bf16 v[68:71], v[236:239], a[128:131], v[68:71]
  s_waitcnt lgkmcnt(0)
  ds_read_b64_tr_b16 v[236:237], v23 offset:36864
  ds_read_b64_tr_b16 v[238:239], v23 offset:38912
  v_mfma_f32_16x16x32_bf16 v[72:75], v[224:227], a[128:131], v[72:75]
  ds_read_b64_tr_b16 v[240:241], v23 offset:40960
  v_mul_f32 v165, v165, v56
  v_accvgpr_read_b32 v180, a124
  v_accvgpr_read_b32 v181, a125
  v_accvgpr_read_b32 v182, a126
  v_accvgpr_read_b32 v183, a127
  v_mfma_f32_16x16x32_bf16 v[72:75], v[228:231], a[0:3], v[72:75]
pad_m_10:
  s_cbranch_execz warm_2
  ds_read_b64_tr_b16 v[242:243], v23 offset:43008
  buffer_load_dwordx4 a[124:127], v2, s[4:7], s76 offen offset:1024 sc1
  v_mfma_f32_16x16x32_bf16 v[72:75], v[232:235], a[8:11], v[72:75]
  ds_read_b64_tr_b16 v[244:245], v23 offset:45056
  v_mul_f32 v166, v166, v56
  v_mfma_f32_16x16x32_bf16 v[88:91], v[232:235], a[12:15], v[88:91]
  ds_read_b64_tr_b16 v[246:247], v23 offset:47104
  v_mul_f32 v167, v167, v56
  v_mfma_f32_16x16x32_bf16 v[88:91], v[228:231], a[4:7], v[88:91]
  buffer_load_dwordx4 v14, s[16:19], s61 offen offset:0 lds
  v_mfma_f32_16x16x32_bf16 v[88:91], v[224:227], a[136:139], v[88:91]
  v_cvt_pk_bf16_f32 v248, v160, v161
  v_cvt_pk_bf16_f32 v249, v162, v163
  v_mfma_f32_16x16x32_bf16 v[104:107], v[224:227], a[132:135], v[104:107]
  v_cvt_pk_bf16_f32 v250, v164, v165
  v_cvt_pk_bf16_f32 v251, v166, v167
  v_mfma_f32_16x16x32_bf16 v[104:107], v[228:231], a[16:19], v[104:107]
  v_mul_f32 v176, v176, v57
  v_mul_f32 v177, v177, v57
  v_mfma_f32_16x16x32_bf16 v[104:107], v[232:235], a[24:27], v[104:107]
  v_mul_f32 v178, v178, v57
  v_mul_f32 v179, v179, v57
  v_mfma_f32_16x16x32_bf16 v[120:123], v[232:235], a[28:31], v[120:123]
  v_mul_f32 v180, v180, v57
  v_mul_f32 v181, v181, v57
  v_mfma_f32_16x16x32_bf16 v[120:123], v[228:231], a[20:23], v[120:123]
  v_mul_f32 v182, v182, v57
  v_mul_f32 v183, v183, v57
  v_mfma_f32_16x16x32_bf16 v[120:123], v[224:227], a[140:143], v[120:123]
  s_waitcnt lgkmcnt(0)
  s_barrier
  ds_read_b64_tr_b16 v[224:225], v24 offset:24576
  v_mfma_f32_16x16x32_bf16 v[124:127], v[236:239], a[140:143], v[124:127]
  s_add_u32 s74, s78, 0
  ds_read_b64_tr_b16 v[226:227], v24 offset:26624
  ds_read_b64_tr_b16 v[228:229], v24 offset:28672
  v_mfma_f32_16x16x32_bf16 v[124:127], v[240:243], a[20:23], v[124:127]
  ds_read_b64_tr_b16 v[230:231], v24 offset:30720
  v_cvt_pk_bf16_f32 v252, v176, v177
  v_mfma_f32_16x16x32_bf16 v[124:127], v[244:247], a[28:31], v[124:127]
  ds_read_b64_tr_b16 v[232:233], v24 offset:32768
  v_cvt_pk_bf16_f32 v253, v178, v179
  v_mfma_f32_16x16x32_bf16 v[108:111], v[244:247], a[24:27], v[108:111]
  ds_read_b64_tr_b16 v[234:235], v24 offset:34816
  v_cvt_pk_bf16_f32 v254, v180, v181
  v_mfma_f32_16x16x32_bf16 v[108:111], v[240:243], a[16:19], v[108:111]
  buffer_load_dwordx4 v15, s[16:19], s61 offen offset:1024 lds
  v_mfma_f32_16x16x32_bf16 v[108:111], v[236:239], a[132:135], v[108:111]
  v_cvt_pk_bf16_f32 v255, v182, v183
  v_mfma_f32_16x16x32_bf16 v[92:95], v[236:239], a[136:139], v[92:95]
  v_mfma_f32_16x16x32_bf16 v[92:95], v[240:243], a[4:7], v[92:95]
  v_mfma_f32_16x16x32_bf16 v[92:95], v[244:247], a[12:15], v[92:95]
  buffer_store_dwordx4 v[136:139], v1, s[4:7], s74 offen offset:0 sc1
  v_mfma_f32_16x16x32_bf16 v[76:79], v[244:247], a[8:11], v[76:79]
  v_mfma_f32_16x16x32_bf16 v[76:79], v[240:243], a[0:3], v[76:79]
  v_mfma_f32_16x16x32_bf16 v[76:79], v[236:239], a[128:131], v[76:79]
  s_waitcnt vmcnt(27) lgkmcnt(0)
  ds_read_b64_tr_b16 v[236:237], v25 offset:24576
  ds_read_b64_tr_b16 v[238:239], v25 offset:26624
  v_mfma_f32_16x16x32_bf16 v[64:67], v[224:227], a[32:35], v[64:67]
  s_waitcnt vmcnt(23)
  ds_read_b64_tr_b16 v[240:241], v25 offset:28672
  v_mfma_f32_16x16x32_bf16 v[64:67], v[228:231], a[40:43], v[64:67]
  s_waitcnt vmcnt(19)
  ds_read_b64_tr_b16 v[242:243], v25 offset:30720
  v_mfma_f32_16x16x32_bf16 v[64:67], v[232:235], a[64:67], v[64:67]
  s_waitcnt vmcnt(18)
  ds_read_b64_tr_b16 v[244:245], v25 offset:32768
  v_mfma_f32_16x16x32_bf16 v[80:83], v[232:235], a[68:71], v[80:83]
  ds_read_b64_tr_b16 v[246:247], v25 offset:34816
  v_mfma_f32_16x16x32_bf16 v[80:83], v[228:231], a[44:47], v[80:83]
  buffer_load_dwordx4 v16, s[16:19], s61 offen offset:2048 lds
  v_mfma_f32_16x16x32_bf16 v[80:83], v[224:227], a[36:39], v[80:83]
  v_mfma_f32_16x16x32_bf16 v[96:99], v[224:227], a[48:51], v[96:99]
  v_mfma_f32_16x16x32_bf16 v[96:99], v[228:231], a[56:59], v[96:99]
  s_waitcnt vmcnt(18)
  v_mfma_f32_16x16x32_bf16 v[96:99], v[232:235], a[80:83], v[96:99]
  s_waitcnt vmcnt(17)
  buffer_store_dwordx4 v[152:155], v1, s[4:7], s74 offen offset:1024 sc1
  v_mfma_f32_16x16x32_bf16 v[112:115], v[232:235], a[84:87], v[112:115]
  s_add_u32 s61, s80, 221184
  v_mfma_f32_16x16x32_bf16 v[112:115], v[228:231], a[60:63], v[112:115]
  s_add_u32 m0, s63, 109568
  v_mfma_f32_16x16x32_bf16 v[112:115], v[224:227], a[52:55], v[112:115]
  s_waitcnt lgkmcnt(0)
  ds_read_b64_tr_b16 v[224:225], v26 offset:24576
  ds_read_b64_tr_b16 v[226:227], v26 offset:26624
  v_mfma_f32_16x16x32_bf16 v[116:119], v[236:239], a[52:55], v[116:119]
  ds_read_b64_tr_b16 v[228:229], v26 offset:28672
  v_mfma_f32_16x16x32_bf16 v[116:119], v[240:243], a[60:63], v[116:119]
  ds_read_b64_tr_b16 v[230:231], v26 offset:30720
  v_mfma_f32_16x16x32_bf16 v[116:119], v[244:247], a[84:87], v[116:119]
  ds_read_b64_tr_b16 v[232:233], v26 offset:32768
  v_mfma_f32_16x16x32_bf16 v[100:103], v[244:247], a[80:83], v[100:103]
  ds_read_b64_tr_b16 v[234:235], v26 offset:34816
  v_mfma_f32_16x16x32_bf16 v[100:103], v[240:243], a[56:59], v[100:103]
  buffer_load_dwordx4 v14, s[16:19], s61 offen offset:0 lds
  v_mfma_f32_16x16x32_bf16 v[100:103], v[236:239], a[48:51], v[100:103]
  v_mfma_f32_16x16x32_bf16 v[84:87], v[236:239], a[36:39], v[84:87]
  v_mfma_f32_16x16x32_bf16 v[84:87], v[240:243], a[44:47], v[84:87]
  v_mfma_f32_16x16x32_bf16 v[84:87], v[244:247], a[68:71], v[84:87]
  v_mfma_f32_16x16x32_bf16 v[68:71], v[244:247], a[64:67], v[68:71]
  v_mfma_f32_16x16x32_bf16 v[68:71], v[240:243], a[40:43], v[68:71]
  buffer_store_dwordx4 v[168:171], v2, s[4:7], s74 offen offset:0 sc1
  v_mfma_f32_16x16x32_bf16 v[68:71], v[236:239], a[32:35], v[68:71]
  s_waitcnt lgkmcnt(0)
  ds_read_b64_tr_b16 v[236:237], v27 offset:24576
  ds_read_b64_tr_b16 v[238:239], v27 offset:26624
  v_mfma_f32_16x16x32_bf16 v[72:75], v[224:227], a[32:35], v[72:75]
  ds_read_b64_tr_b16 v[240:241], v27 offset:28672
  v_mfma_f32_16x16x32_bf16 v[72:75], v[228:231], a[40:43], v[72:75]
  ds_read_b64_tr_b16 v[242:243], v27 offset:30720
  v_mfma_f32_16x16x32_bf16 v[72:75], v[232:235], a[64:67], v[72:75]
  ds_read_b64_tr_b16 v[244:245], v27 offset:32768
  v_mfma_f32_16x16x32_bf16 v[88:91], v[232:235], a[68:71], v[88:91]
  ds_read_b64_tr_b16 v[246:247], v27 offset:34816
  v_mfma_f32_16x16x32_bf16 v[88:91], v[228:231], a[44:47], v[88:91]
  buffer_load_dwordx4 v15, s[16:19], s61 offen offset:1024 lds
  v_mfma_f32_16x16x32_bf16 v[88:91], v[224:227], a[36:39], v[88:91]
  v_mfma_f32_16x16x32_bf16 v[104:107], v[224:227], a[48:51], v[104:107]
  v_add_co_u32 v60, vcc, (att_retry-att_last-8192)/36*4, v60
  v_mfma_f32_16x16x32_bf16 v[104:107], v[228:231], a[56:59], v[104:107]
  s_nop 0
  v_addc_co_u32 v61, vcc, 0, v61, vcc
  v_mfma_f32_16x16x32_bf16 v[104:107], v[232:235], a[80:83], v[104:107]
  v_mfma_f32_16x16x32_bf16 v[120:123], v[232:235], a[84:87], v[120:123]
  v_mfma_f32_16x16x32_bf16 v[120:123], v[228:231], a[60:63], v[120:123]
  v_mfma_f32_16x16x32_bf16 v[120:123], v[224:227], a[52:55], v[120:123]
  s_waitcnt lgkmcnt(0)
  ds_read_b64_tr_b16 v[224:225], v24 offset:36864
  ds_read_b64_tr_b16 v[226:227], v24 offset:38912
  v_mfma_f32_16x16x32_bf16 v[124:127], v[236:239], a[52:55], v[124:127]
  ds_read_b64_tr_b16 v[228:229], v24 offset:40960
  v_mfma_f32_16x16x32_bf16 v[124:127], v[240:243], a[60:63], v[124:127]
  ds_read_b64_tr_b16 v[230:231], v24 offset:43008
  v_mfma_f32_16x16x32_bf16 v[124:127], v[244:247], a[84:87], v[124:127]
  ds_read_b64_tr_b16 v[232:233], v24 offset:45056
  v_mfma_f32_16x16x32_bf16 v[108:111], v[244:247], a[80:83], v[108:111]
  ds_read_b64_tr_b16 v[234:235], v24 offset:47104
  v_mfma_f32_16x16x32_bf16 v[108:111], v[240:243], a[56:59], v[108:111]
  buffer_load_dwordx4 v16, s[16:19], s61 offen offset:2048 lds
  v_mfma_f32_16x16x32_bf16 v[108:111], v[236:239], a[48:51], v[108:111]
  v_mfma_f32_16x16x32_bf16 v[92:95], v[236:239], a[36:39], v[92:95]
  buffer_store_dwordx4 v[184:187], v2, s[4:7], s74 offen offset:1024 sc1
  v_mfma_f32_16x16x32_bf16 v[92:95], v[240:243], a[44:47], v[92:95]
  global_load_dword v62, v[60:61], off
  v_mfma_f32_16x16x32_bf16 v[92:95], v[244:247], a[68:71], v[92:95]
  v_mfma_f32_16x16x32_bf16 v[76:79], v[244:247], a[64:67], v[76:79]
  s_add_u32 s61, s80, 1769472
  v_mfma_f32_16x16x32_bf16 v[76:79], v[240:243], a[40:43], v[76:79]
  s_add_u32 m0, s63, 0
  v_mfma_f32_16x16x32_bf16 v[76:79], v[236:239], a[32:35], v[76:79]
  s_waitcnt vmcnt(23) lgkmcnt(0)
  ds_read_b64_tr_b16 v[236:237], v25 offset:36864
  ds_read_b64_tr_b16 v[238:239], v25 offset:38912
  v_mfma_f32_16x16x32_bf16 v[64:67], v[224:227], a[72:75], v[64:67]
  s_waitcnt vmcnt(18)
  ds_read_b64_tr_b16 v[240:241], v25 offset:40960
  v_mfma_f32_16x16x32_bf16 v[64:67], v[228:231], a[96:99], v[64:67]
  s_waitcnt vmcnt(14)
  ds_read_b64_tr_b16 v[242:243], v25 offset:43008
  v_mfma_f32_16x16x32_bf16 v[64:67], v[232:235], a[104:107], v[64:67]
  s_waitcnt vmcnt(13)
  s_add_u32 s74, s78, 4096
  ds_read_b64_tr_b16 v[244:245], v25 offset:45056
  v_mfma_f32_16x16x32_bf16 v[80:83], v[232:235], a[108:111], v[80:83]
  ds_read_b64_tr_b16 v[246:247], v25 offset:47104
  v_mfma_f32_16x16x32_bf16 v[80:83], v[228:231], a[100:103], v[80:83]
  buffer_load_dwordx4 v14, s[16:19], s61 offen offset:0 lds
  v_mfma_f32_16x16x32_bf16 v[80:83], v[224:227], a[76:79], v[80:83]
  v_mfma_f32_16x16x32_bf16 v[96:99], v[224:227], a[88:91], v[96:99]
  v_mfma_f32_16x16x32_bf16 v[96:99], v[228:231], a[112:115], v[96:99]
  s_waitcnt vmcnt(13)
  v_mfma_f32_16x16x32_bf16 v[96:99], v[232:235], a[120:123], v[96:99]
  s_waitcnt vmcnt(12)
  buffer_store_dwordx4 v[140:143], v1, s[4:7], s74 offen offset:0 sc1
  v_mfma_f32_16x16x32_bf16 v[112:115], v[232:235], a[124:127], v[112:115]
  v_mfma_f32_16x16x32_bf16 v[112:115], v[228:231], a[116:119], v[112:115]
  v_mul_f32 v64, s72, v64
  v_mul_f32 v65, s72, v65
  v_mfma_f32_16x16x32_bf16 v[112:115], v[224:227], a[92:95], v[112:115]
  s_waitcnt lgkmcnt(0)
  ds_read_b64_tr_b16 v[224:225], v26 offset:36864
  ds_read_b64_tr_b16 v[226:227], v26 offset:38912
  v_mfma_f32_16x16x32_bf16 v[116:119], v[236:239], a[92:95], v[116:119]
  ds_read_b64_tr_b16 v[228:229], v26 offset:40960
  v_mul_f32 v66, s72, v66
  v_mfma_f32_16x16x32_bf16 v[116:119], v[240:243], a[116:119], v[116:119]
  ds_read_b64_tr_b16 v[230:231], v26 offset:43008
  v_mul_f32 v67, s72, v67
  v_mfma_f32_16x16x32_bf16 v[116:119], v[244:247], a[124:127], v[116:119]
  ds_read_b64_tr_b16 v[232:233], v26 offset:45056
  v_mul_f32 v80, s72, v80
  v_mfma_f32_16x16x32_bf16 v[100:103], v[244:247], a[120:123], v[100:103]
  ds_read_b64_tr_b16 v[234:235], v26 offset:47104
  v_mul_f32 v81, s72, v81
  v_mfma_f32_16x16x32_bf16 v[100:103], v[240:243], a[112:115], v[100:103]
  buffer_load_dwordx4 v15, s[16:19], s61 offen offset:1024 lds
  v_mfma_f32_16x16x32_bf16 v[100:103], v[236:239], a[88:91], v[100:103]
  v_mul_f32 v82, s72, v82
  v_mul_f32 v83, s72, v83
  v_mfma_f32_16x16x32_bf16 v[84:87], v[236:239], a[76:79], v[84:87]
  v_exp_f32 v64, v64
  v_mfma_f32_16x16x32_bf16 v[84:87], v[240:243], a[100:103], v[84:87]
  v_exp_f32 v65, v65
  v_mfma_f32_16x16x32_bf16 v[84:87], v[244:247], a[108:111], v[84:87]
  buffer_store_dwordx4 v[156:159], v1, s[4:7], s74 offen offset:1024 sc1
  v_mfma_f32_16x16x32_bf16 v[68:71], v[244:247], a[104:107], v[68:71]
  v_exp_f32 v66, v66
  v_mfma_f32_16x16x32_bf16 v[68:71], v[240:243], a[96:99], v[68:71]
  v_exp_f32 v67, v67
  v_mfma_f32_16x16x32_bf16 v[68:71], v[236:239], a[72:75], v[68:71]
  s_waitcnt lgkmcnt(0)
  ds_read_b64_tr_b16 v[236:237], v27 offset:36864
  ds_read_b64_tr_b16 v[238:239], v27 offset:38912
  v_mfma_f32_16x16x32_bf16 v[72:75], v[224:227], a[72:75], v[72:75]
  ds_read_b64_tr_b16 v[240:241], v27 offset:40960
  v_add_f32 v64, 1.0, v64
  v_mfma_f32_16x16x32_bf16 v[72:75], v[228:231], a[96:99], v[72:75]
  ds_read_b64_tr_b16 v[242:243], v27 offset:43008
  v_add_f32 v65, 1.0, v65
  v_mfma_f32_16x16x32_bf16 v[72:75], v[232:235], a[104:107], v[72:75]
  ds_read_b64_tr_b16 v[244:245], v27 offset:45056
  v_add_f32 v66, 1.0, v66
  v_mfma_f32_16x16x32_bf16 v[88:91], v[232:235], a[108:111], v[88:91]
  ds_read_b64_tr_b16 v[246:247], v27 offset:47104
  v_add_f32 v67, 1.0, v67
  v_mfma_f32_16x16x32_bf16 v[88:91], v[228:231], a[100:103], v[88:91]
  buffer_load_dwordx4 v16, s[16:19], s61 offen offset:2048 lds
  v_mfma_f32_16x16x32_bf16 v[88:91], v[224:227], a[76:79], v[88:91]
  v_exp_f32 v80, v80
  v_mfma_f32_16x16x32_bf16 v[104:107], v[224:227], a[88:91], v[104:107]
  v_exp_f32 v81, v81
  v_mfma_f32_16x16x32_bf16 v[104:107], v[228:231], a[112:115], v[104:107]
  v_exp_f32 v82, v82
  v_mfma_f32_16x16x32_bf16 v[104:107], v[232:235], a[120:123], v[104:107]
  v_exp_f32 v83, v83
  v_mfma_f32_16x16x32_bf16 v[120:123], v[232:235], a[124:127], v[120:123]
  s_add_u32 s61, s80, 1990656
  v_add_f32 v80, 1.0, v80
  v_add_f32 v81, 1.0, v81
  v_mfma_f32_16x16x32_bf16 v[120:123], v[228:231], a[116:119], v[120:123]
  s_add_u32 m0, s63, 3072
  v_add_f32 v82, 1.0, v82
  v_add_f32 v83, 1.0, v83
  v_mfma_f32_16x16x32_bf16 v[120:123], v[224:227], a[92:95], v[120:123]
  s_waitcnt vmcnt(7) lgkmcnt(0)
  s_barrier
  ds_read_b64_tr_b16 v[224:225], v24 offset:0
  v_mfma_f32_16x16x32_bf16 v[124:127], v[236:239], a[92:95], v[124:127]
  ds_read_b64_tr_b16 v[226:227], v24 offset:2048
  ds_read_b64_tr_b16 v[228:229], v24 offset:4096
  v_mfma_f32_16x16x32_bf16 v[124:127], v[240:243], a[116:119], v[124:127]
  ds_read_b64_tr_b16 v[230:231], v24 offset:6144
  v_mul_f32 v96, s72, v96
  v_mfma_f32_16x16x32_bf16 v[124:127], v[244:247], a[124:127], v[124:127]
  ds_read_b64_tr_b16 v[232:233], v24 offset:8192
  v_mul_f32 v97, s72, v97
  v_mfma_f32_16x16x32_bf16 v[108:111], v[244:247], a[120:123], v[108:111]
  ds_read_b64_tr_b16 v[234:235], v24 offset:10240
  v_mul_f32 v98, s72, v98
  v_mfma_f32_16x16x32_bf16 v[108:111], v[240:243], a[112:115], v[108:111]
  buffer_load_dwordx4 v14, s[16:19], s61 offen offset:0 lds
  v_mfma_f32_16x16x32_bf16 v[108:111], v[236:239], a[88:91], v[108:111]
  buffer_store_dwordx4 v[172:175], v2, s[4:7], s74 offen offset:0 sc1
  v_mfma_f32_16x16x32_bf16 v[92:95], v[236:239], a[76:79], v[92:95]
  v_rcp_f32 v64, v64
  v_mfma_f32_16x16x32_bf16 v[92:95], v[240:243], a[100:103], v[92:95]
  v_rcp_f32 v65, v65
  v_mfma_f32_16x16x32_bf16 v[92:95], v[244:247], a[108:111], v[92:95]
  buffer_load_dword v59, off, s[84:87], s50 sc1
  v_mfma_f32_16x16x32_bf16 v[76:79], v[244:247], a[104:107], v[76:79]
  v_rcp_f32 v66, v66
  v_mfma_f32_16x16x32_bf16 v[76:79], v[240:243], a[96:99], v[76:79]
  v_rcp_f32 v67, v67
  v_mfma_f32_16x16x32_bf16 v[76:79], v[236:239], a[72:75], v[76:79]
  s_waitcnt lgkmcnt(0)
  ds_read_b64_tr_b16 v[236:237], v25 offset:0
  ds_read_b64_tr_b16 v[238:239], v25 offset:2048
  v_mfma_f32_16x16x32_bf16 v[128:131], v[224:227], v[192:195], 0
  ds_read_b64_tr_b16 v[240:241], v25 offset:4096
  v_mul_f32 v99, s72, v99
  v_mfma_f32_16x16x32_bf16 v[128:131], v[228:231], v[200:203], v[128:131]
  ds_read_b64_tr_b16 v[242:243], v25 offset:6144
  v_mul_f32 v112, s72, v112
  v_mfma_f32_16x16x32_bf16 v[128:131], v[232:235], v[208:211], v[128:131]
  ds_read_b64_tr_b16 v[244:245], v25 offset:8192
  v_mul_f32 v113, s72, v113
  v_mfma_f32_16x16x32_bf16 v[144:147], v[232:235], v[212:215], 0
  ds_read_b64_tr_b16 v[246:247], v25 offset:10240
  v_mul_f32 v114, s72, v114
  v_mfma_f32_16x16x32_bf16 v[144:147], v[228:231], v[204:207], v[144:147]
  buffer_load_dwordx4 v15, s[16:19], s61 offen offset:1024 lds
  v_mfma_f32_16x16x32_bf16 v[144:147], v[224:227], v[196:199], v[144:147]
  v_rcp_f32 v80, v80
  v_mfma_f32_16x16x32_bf16 v[160:163], v[224:227], a[224:227], 0
  v_rcp_f32 v81, v81
  v_mfma_f32_16x16x32_bf16 v[160:163], v[228:231], a[232:235], v[160:163]
  v_rcp_f32 v82, v82
  v_mfma_f32_16x16x32_bf16 v[160:163], v[232:235], a[240:243], v[160:163]
  buffer_store_dwordx4 v[188:191], v2, s[4:7], s74 offen offset:1024 sc1
  v_mfma_f32_16x16x32_bf16 v[176:179], v[232:235], a[244:247], 0
  v_rcp_f32 v83, v83
  v_mfma_f32_16x16x32_bf16 v[176:179], v[228:231], a[236:239], v[176:179]
  v_mul_f32 v115, s72, v115
  v_mul_f32 v68, s72, v68
  v_mfma_f32_16x16x32_bf16 v[176:179], v[224:227], a[228:231], v[176:179]
  s_waitcnt lgkmcnt(0)
  ds_read_b64_tr_b16 v[224:225], v26 offset:0
  ds_read_b64_tr_b16 v[226:227], v26 offset:2048
  v_mfma_f32_16x16x32_bf16 v[180:183], v[236:239], a[228:231], 0
  ds_read_b64_tr_b16 v[228:229], v26 offset:4096
  v_mul_f32 v69, s72, v69
  v_mfma_f32_16x16x32_bf16 v[180:183], v[240:243], a[236:239], v[180:183]
  ds_read_b64_tr_b16 v[230:231], v26 offset:6144
  v_mul_f32 v70, s72, v70
  v_mfma_f32_16x16x32_bf16 v[180:183], v[244:247], a[244:247], v[180:183]
  ds_read_b64_tr_b16 v[232:233], v26 offset:8192
  v_mul_f32 v71, s72, v71
  v_mfma_f32_16x16x32_bf16 v[164:167], v[244:247], a[240:243], 0
  ds_read_b64_tr_b16 v[234:235], v26 offset:10240
  v_mul_f32 v84, s72, v84
  v_mfma_f32_16x16x32_bf16 v[164:167], v[240:243], a[232:235], v[164:167]
  buffer_load_dwordx4 v16, s[16:19], s61 offen offset:2048 lds
  v_mfma_f32_16x16x32_bf16 v[164:167], v[236:239], a[224:227], v[164:167]
  v_exp_f32 v96, v96
  v_mfma_f32_16x16x32_bf16 v[148:151], v[236:239], v[196:199], 0
  v_exp_f32 v97, v97
  v_mfma_f32_16x16x32_bf16 v[148:151], v[240:243], v[204:207], v[148:151]
  v_exp_f32 v98, v98
  v_mfma_f32_16x16x32_bf16 v[148:151], v[244:247], v[212:215], v[148:151]
  v_exp_f32 v99, v99
  v_mfma_f32_16x16x32_bf16 v[132:135], v[244:247], v[208:211], 0
  s_add_u32 s61, s80, 3538944
  v_exp_f32 v112, v112
  v_mfma_f32_16x16x32_bf16 v[132:135], v[240:243], v[200:203], v[132:135]
  s_add_u32 m0, s63, 24576
  v_exp_f32 v113, v113
  v_mfma_f32_16x16x32_bf16 v[132:135], v[236:239], v[192:195], v[132:135]
  s_waitcnt lgkmcnt(0)
  ds_read_b64_tr_b16 v[236:237], v27 offset:0
  ds_read_b64_tr_b16 v[238:239], v27 offset:2048
  v_mfma_f32_16x16x32_bf16 v[136:139], v[224:227], v[192:195], 0
  ds_read_b64_tr_b16 v[240:241], v27 offset:4096
  v_add_f32 v96, 1.0, v96
  v_mfma_f32_16x16x32_bf16 v[136:139], v[228:231], v[200:203], v[136:139]
  ds_read_b64_tr_b16 v[242:243], v27 offset:6144
  v_add_f32 v97, 1.0, v97
  v_mfma_f32_16x16x32_bf16 v[136:139], v[232:235], v[208:211], v[136:139]
  ds_read_b64_tr_b16 v[244:245], v27 offset:8192
  v_add_f32 v98, 1.0, v98
  v_mfma_f32_16x16x32_bf16 v[152:155], v[232:235], v[212:215], 0
  s_add_u32 s74, s78, 8192
  ds_read_b64_tr_b16 v[246:247], v27 offset:10240
  v_add_f32 v99, 1.0, v99
  v_mfma_f32_16x16x32_bf16 v[152:155], v[228:231], v[204:207], v[152:155]
  buffer_load_dwordx4 v14, s[16:19], s61 offen offset:0 lds
  v_mfma_f32_16x16x32_bf16 v[152:155], v[224:227], v[196:199], v[152:155]
  v_exp_f32 v114, v114
  v_mfma_f32_16x16x32_bf16 v[168:171], v[224:227], a[224:227], 0
  v_exp_f32 v115, v115
  v_mfma_f32_16x16x32_bf16 v[168:171], v[228:231], a[232:235], v[168:171]
  v_add_f32 v112, 1.0, v112
  v_add_f32 v113, 1.0, v113
  v_mfma_f32_16x16x32_bf16 v[168:171], v[232:235], a[240:243], v[168:171]
  buffer_store_dwordx4 v[28:31], v1, s[4:7], s74 offen offset:0 sc1
  v_mfma_f32_16x16x32_bf16 v[184:187], v[232:235], a[244:247], 0
  v_add_f32 v114, 1.0, v114
  v_add_f32 v115, 1.0, v115
  v_mfma_f32_16x16x32_bf16 v[184:187], v[228:231], a[236:239], v[184:187]
  v_rcp_f32 v96, v96
  v_mfma_f32_16x16x32_bf16 v[184:187], v[224:227], a[228:231], v[184:187]
  s_waitcnt lgkmcnt(0)
  ds_read_b64_tr_b16 v[224:225], v24 offset:12288
  ds_read_b64_tr_b16 v[226:227], v24 offset:14336
  v_mfma_f32_16x16x32_bf16 v[188:191], v[236:239], a[228:231], 0
  ds_read_b64_tr_b16 v[228:229], v24 offset:16384
  v_mul_f32 v85, s72, v85
  v_mfma_f32_16x16x32_bf16 v[188:191], v[240:243], a[236:239], v[188:191]
  ds_read_b64_tr_b16 v[230:231], v24 offset:18432
  v_mul_f32 v86, s72, v86
  v_mfma_f32_16x16x32_bf16 v[188:191], v[244:247], a[244:247], v[188:191]
  ds_read_b64_tr_b16 v[232:233], v24 offset:20480
  v_mul_f32 v87, s72, v87
  v_mfma_f32_16x16x32_bf16 v[172:175], v[244:247], a[240:243], 0
  ds_read_b64_tr_b16 v[234:235], v24 offset:22528
  v_mul_f32 v100, s72, v100
  v_mfma_f32_16x16x32_bf16 v[172:175], v[240:243], a[232:235], v[172:175]
  buffer_load_dwordx4 v15, s[16:19], s61 offen offset:1024 lds
  v_mfma_f32_16x16x32_bf16 v[172:175], v[236:239], a[224:227], v[172:175]
  v_rcp_f32 v97, v97
  v_mfma_f32_16x16x32_bf16 v[156:159], v[236:239], v[196:199], 0
  v_rcp_f32 v98, v98
  v_mfma_f32_16x16x32_bf16 v[156:159], v[240:243], v[204:207], v[156:159]
  v_rcp_f32 v99, v99
  v_mfma_f32_16x16x32_bf16 v[156:159], v[244:247], v[212:215], v[156:159]
  v_add_co_u32 v60, vcc, (att_retry-att_last-8192)/36*4, v60
  v_mul_f32 v101, s72, v101
  v_mfma_f32_16x16x32_bf16 v[140:143], v[244:247], v[208:211], 0
  v_addc_co_u32 v61, vcc, 0, v61, vcc
  v_mul_f32 v102, s72, v102
  v_mfma_f32_16x16x32_bf16 v[140:143], v[240:243], v[200:203], v[140:143]
  v_rcp_f32 v112, v112
  v_mfma_f32_16x16x32_bf16 v[140:143], v[236:239], v[192:195], v[140:143]
  s_waitcnt lgkmcnt(0)
  ds_read_b64_tr_b16 v[236:237], v25 offset:12288
  ds_read_b64_tr_b16 v[238:239], v25 offset:14336
  v_mfma_f32_16x16x32_bf16 v[128:131], v[224:227], v[216:219], v[128:131]
  ds_read_b64_tr_b16 v[240:241], v25 offset:16384
  v_mul_f32 v103, s72, v103
  v_mfma_f32_16x16x32_bf16 v[128:131], v[228:231], a[168:171], v[128:131]
  ds_read_b64_tr_b16 v[242:243], v25 offset:18432
  v_mul_f32 v116, s72, v116
  v_mfma_f32_16x16x32_bf16 v[128:131], v[232:235], a[176:179], v[128:131]
  ds_read_b64_tr_b16 v[244:245], v25 offset:20480
  v_mul_f32 v117, s72, v117
  v_mfma_f32_16x16x32_bf16 v[144:147], v[232:235], a[180:183], v[144:147]
  ds_read_b64_tr_b16 v[246:247], v25 offset:22528
  v_mul_f32 v118, s72, v118
  v_mfma_f32_16x16x32_bf16 v[144:147], v[228:231], a[172:175], v[144:147]
  buffer_load_dwordx4 v16, s[16:19], s61 offen offset:2048 lds
  v_mfma_f32_16x16x32_bf16 v[144:147], v[224:227], v[220:223], v[144:147]
  v_rcp_f32 v113, v113
  v_mfma_f32_16x16x32_bf16 v[160:163], v[224:227], a[248:251], v[160:163]
  v_rcp_f32 v114, v114
  v_mfma_f32_16x16x32_bf16 v[160:163], v[228:231], a[148:151], v[160:163]
  v_rcp_f32 v115, v115
  v_mfma_f32_16x16x32_bf16 v[160:163], v[232:235], a[156:159], v[160:163]
  global_load_dword v62, v[60:61], off
  v_mfma_f32_16x16x32_bf16 v[176:179], v[232:235], a[160:163], v[176:179]
  s_add_u32 s61, s80, 3760128
  v_exp_f32 v68, v68
  v_mfma_f32_16x16x32_bf16 v[176:179], v[228:231], a[152:155], v[176:179]
  s_add_u32 m0, s63, 27648
  v_exp_f32 v69, v69
  v_mfma_f32_16x16x32_bf16 v[176:179], v[224:227], a[252:255], v[176:179]
  s_waitcnt lgkmcnt(0)
  ds_read_b64_tr_b16 v[224:225], v26 offset:12288
  ds_read_b64_tr_b16 v[226:227], v26 offset:14336
  v_mfma_f32_16x16x32_bf16 v[180:183], v[236:239], a[252:255], v[180:183]
  ds_read_b64_tr_b16 v[228:229], v26 offset:16384
  v_add_f32 v68, 1.0, v68
  v_mfma_f32_16x16x32_bf16 v[180:183], v[240:243], a[152:155], v[180:183]
  ds_read_b64_tr_b16 v[230:231], v26 offset:18432
  v_add_f32 v69, 1.0, v69
  v_mfma_f32_16x16x32_bf16 v[180:183], v[244:247], a[160:163], v[180:183]
  ds_read_b64_tr_b16 v[232:233], v26 offset:20480
  v_mul_f32 v119, s72, v119
  v_mfma_f32_16x16x32_bf16 v[164:167], v[244:247], a[156:159], v[164:167]
  ds_read_b64_tr_b16 v[234:235], v26 offset:22528
  v_mul_f32 v72, s72, v72
  v_mfma_f32_16x16x32_bf16 v[164:167], v[240:243], a[148:151], v[164:167]
  buffer_load_dwordx4 v14, s[16:19], s61 offen offset:0 lds
  v_mfma_f32_16x16x32_bf16 v[164:167], v[236:239], a[248:251], v[164:167]
  buffer_store_dwordx4 v[32:35], v1, s[4:7], s74 offen offset:1024 sc1
  v_mfma_f32_16x16x32_bf16 v[148:151], v[236:239], v[220:223], v[148:151]
  v_exp_f32 v70, v70
  v_mfma_f32_16x16x32_bf16 v[148:151], v[240:243], a[172:175], v[148:151]
  v_exp_f32 v71, v71
  v_mfma_f32_16x16x32_bf16 v[148:151], v[244:247], a[180:183], v[148:151]
  v_exp_f32 v84, v84
  v_mfma_f32_16x16x32_bf16 v[132:135], v[244:247], a[176:179], v[132:135]
  v_exp_f32 v85, v85
  v_mfma_f32_16x16x32_bf16 v[132:135], v[240:243], a[168:171], v[132:135]
  v_exp_f32 v86, v86
  v_mfma_f32_16x16x32_bf16 v[132:135], v[236:239], v[216:219], v[132:135]
  s_waitcnt lgkmcnt(0)
  ds_read_b64_tr_b16 v[236:237], v27 offset:12288
  ds_read_b64_tr_b16 v[238:239], v27 offset:14336
  v_mfma_f32_16x16x32_bf16 v[136:139], v[224:227], v[216:219], v[136:139]
  ds_read_b64_tr_b16 v[240:241], v27 offset:16384
  v_add_f32 v70, 1.0, v70
  v_mfma_f32_16x16x32_bf16 v[136:139], v[228:231], a[168:171], v[136:139]
  ds_read_b64_tr_b16 v[242:243], v27 offset:18432
  v_add_f32 v71, 1.0, v71
  v_mfma_f32_16x16x32_bf16 v[136:139], v[232:235], a[176:179], v[136:139]
  ds_read_b64_tr_b16 v[244:245], v27 offset:20480
  v_add_f32 v84, 1.0, v84
  v_mfma_f32_16x16x32_bf16 v[152:155], v[232:235], a[180:183], v[152:155]
  ds_read_b64_tr_b16 v[246:247], v27 offset:22528
  v_add_f32 v85, 1.0, v85
  v_mfma_f32_16x16x32_bf16 v[152:155], v[228:231], a[172:175], v[152:155]
  buffer_load_dwordx4 v15, s[16:19], s61 offen offset:1024 lds
  v_mfma_f32_16x16x32_bf16 v[152:155], v[224:227], v[220:223], v[152:155]
  v_exp_f32 v87, v87
  v_mfma_f32_16x16x32_bf16 v[168:171], v[224:227], a[248:251], v[168:171]
  v_add_f32 v86, 1.0, v86
  v_add_f32 v87, 1.0, v87
  v_mfma_f32_16x16x32_bf16 v[168:171], v[228:231], a[148:151], v[168:171]
  v_rcp_f32 v68, v68
  v_mfma_f32_16x16x32_bf16 v[168:171], v[232:235], a[156:159], v[168:171]
  v_rcp_f32 v69, v69
  v_mfma_f32_16x16x32_bf16 v[184:187], v[232:235], a[160:163], v[184:187]
  v_rcp_f32 v70, v70
  v_mfma_f32_16x16x32_bf16 v[184:187], v[228:231], a[152:155], v[184:187]
  v_rcp_f32 v71, v71
  v_mfma_f32_16x16x32_bf16 v[184:187], v[224:227], a[252:255], v[184:187]
  s_waitcnt vmcnt(8) lgkmcnt(0)
  s_barrier
  ds_read_b64_tr_b16 v[224:225], v20 offset:0
  v_mfma_f32_16x16x32_bf16 v[188:191], v[236:239], a[252:255], v[188:191]
  ds_read_b64_tr_b16 v[226:227], v20 offset:2048
  ds_read_b64_tr_b16 v[228:229], v20 offset:4096
  v_mfma_f32_16x16x32_bf16 v[188:191], v[240:243], a[152:155], v[188:191]
  ds_read_b64_tr_b16 v[230:231], v20 offset:6144
  v_mul_f32 v73, s72, v73
  v_mfma_f32_16x16x32_bf16 v[188:191], v[244:247], a[160:163], v[188:191]
  ds_read_b64_tr_b16 v[232:233], v20 offset:8192
  v_mul_f32 v74, s72, v74
  v_mfma_f32_16x16x32_bf16 v[172:175], v[244:247], a[156:159], v[172:175]
  ds_read_b64_tr_b16 v[234:235], v20 offset:10240
  v_mul_f32 v75, s72, v75
  v_mfma_f32_16x16x32_bf16 v[172:175], v[240:243], a[148:151], v[172:175]
  buffer_load_dwordx4 v16, s[16:19], s61 offen offset:2048 lds
  v_mfma_f32_16x16x32_bf16 v[172:175], v[236:239], a[248:251], v[172:175]
  v_rcp_f32 v84, v84
  v_mfma_f32_16x16x32_bf16 v[156:159], v[236:239], v[220:223], v[156:159]
  v_rcp_f32 v85, v85
  v_mfma_f32_16x16x32_bf16 v[156:159], v[240:243], a[172:175], v[156:159]
  v_rcp_f32 v86, v86
  v_mfma_f32_16x16x32_bf16 v[156:159], v[244:247], a[180:183], v[156:159]
  buffer_store_dwordx4 v[36:39], v2, s[4:7], s74 offen offset:0 sc1
  v_mfma_f32_16x16x32_bf16 v[140:143], v[244:247], a[176:179], v[140:143]
  s_add_u32 s61, s80, 128
  v_rcp_f32 v87, v87
  v_mfma_f32_16x16x32_bf16 v[140:143], v[240:243], a[168:171], v[140:143]
  s_add_u32 m0, s63, 131072
  v_exp_f32 v100, v100
  v_mfma_f32_16x16x32_bf16 v[140:143], v[236:239], v[216:219], v[140:143]
  s_waitcnt lgkmcnt(0)
  ds_read_b64_tr_b16 v[236:237], v21 offset:0
  ds_read_b64_tr_b16 v[238:239], v21 offset:2048
  v_mfma_f32_16x16x32_bf16 v[128:131], v[224:227], a[184:187], v[128:131]
  ds_read_b64_tr_b16 v[240:241], v21 offset:4096
  v_add_f32 v100, 1.0, v100
  v_mfma_f32_16x16x32_bf16 v[128:131], v[228:231], a[196:199], v[128:131]
  ds_read_b64_tr_b16 v[242:243], v21 offset:6144
  v_mul_f32 v88, s72, v88
  v_mfma_f32_16x16x32_bf16 v[128:131], v[232:235], a[212:215], v[128:131]
  ds_read_b64_tr_b16 v[244:245], v21 offset:8192
  v_mul_f32 v89, s72, v89
  v_mfma_f32_16x16x32_bf16 v[144:147], v[232:235], a[220:223], v[144:147]
  ds_read_b64_tr_b16 v[246:247], v21 offset:10240
  v_mul_f32 v90, s72, v90
  v_mfma_f32_16x16x32_bf16 v[144:147], v[228:231], a[204:207], v[144:147]
  buffer_load_dwordx4 v14, s[12:15], s61 offen offset:0 lds
  v_mfma_f32_16x16x32_bf16 v[144:147], v[224:227], a[188:191], v[144:147]
  v_exp_f32 v101, v101
  v_mfma_f32_16x16x32_bf16 v[160:163], v[224:227], a[164:167], v[160:163]
  v_exp_f32 v102, v102
  v_mfma_f32_16x16x32_bf16 v[160:163], v[228:231], a[200:203], v[160:163]
  v_exp_f32 v103, v103
  v_mfma_f32_16x16x32_bf16 v[160:163], v[232:235], a[216:219], v[160:163]
  buffer_load_dwordx4 v15, s[12:15], s61 offen offset:1024 lds
  v_mfma_f32_16x16x32_bf16 v[176:179], v[232:235], a[144:147], v[176:179]
  v_exp_f32 v116, v116
  v_mfma_f32_16x16x32_bf16 v[176:179], v[228:231], a[208:211], v[176:179]
  v_exp_f32 v117, v117
  v_mfma_f32_16x16x32_bf16 v[176:179], v[224:227], a[192:195], v[176:179]
  s_waitcnt lgkmcnt(0)
  ds_read_b64_tr_b16 v[224:225], v22 offset:0
  ds_read_b64_tr_b16 v[226:227], v22 offset:2048
  v_mfma_f32_16x16x32_bf16 v[180:183], v[236:239], a[192:195], v[180:183]
  ds_read_b64_tr_b16 v[228:229], v22 offset:4096
  v_add_f32 v101, 1.0, v101
  v_mfma_f32_16x16x32_bf16 v[180:183], v[240:243], a[208:211], v[180:183]
  ds_read_b64_tr_b16 v[230:231], v22 offset:6144
  v_add_f32 v102, 1.0, v102
  v_mfma_f32_16x16x32_bf16 v[180:183], v[244:247], a[144:147], v[180:183]
  ds_read_b64_tr_b16 v[232:233], v22 offset:8192
  v_add_f32 v103, 1.0, v103
  v_mfma_f32_16x16x32_bf16 v[164:167], v[244:247], a[216:219], v[164:167]
  ds_read_b64_tr_b16 v[234:235], v22 offset:10240
  v_add_f32 v116, 1.0, v116
  v_mfma_f32_16x16x32_bf16 v[164:167], v[240:243], a[200:203], v[164:167]
  buffer_load_dwordx4 v16, s[12:15], s61 offen offset:2048 lds
  v_mfma_f32_16x16x32_bf16 v[164:167], v[236:239], a[164:167], v[164:167]
  v_exp_f32 v118, v118
  v_mfma_f32_16x16x32_bf16 v[148:151], v[236:239], a[188:191], v[148:151]
  v_exp_f32 v119, v119
  v_mfma_f32_16x16x32_bf16 v[148:151], v[240:243], a[204:207], v[148:151]
  v_add_f32 v117, 1.0, v117
  v_add_f32 v118, 1.0, v118
  v_mfma_f32_16x16x32_bf16 v[148:151], v[244:247], a[220:223], v[148:151]
  v_add_f32 v119, 1.0, v119
  v_mul_f32 v91, s72, v91
  v_mfma_f32_16x16x32_bf16 v[132:135], v[244:247], a[212:215], v[132:135]
  s_add_u32 s61, s80, 221312
  v_rcp_f32 v100, v100
  v_mfma_f32_16x16x32_bf16 v[132:135], v[240:243], a[196:199], v[132:135]
  s_add_u32 m0, s63, 134144
  v_rcp_f32 v101, v101
  v_mfma_f32_16x16x32_bf16 v[132:135], v[236:239], a[184:187], v[132:135]
  s_waitcnt lgkmcnt(0)
  ds_read_b64_tr_b16 v[236:237], v23 offset:0
  ds_read_b64_tr_b16 v[238:239], v23 offset:2048
  v_mfma_f32_16x16x32_bf16 v[136:139], v[224:227], a[184:187], v[136:139]
  ds_read_b64_tr_b16 v[240:241], v23 offset:4096
  v_mul_f32 v104, s72, v104
  v_mfma_f32_16x16x32_bf16 v[136:139], v[228:231], a[196:199], v[136:139]
pad_m_11:
  s_cbranch_execz warm_2
  ds_read_b64_tr_b16 v[242:243], v23 offset:6144
  v_mul_f32 v105, s72, v105
  v_mfma_f32_16x16x32_bf16 v[136:139], v[232:235], a[212:215], v[136:139]
  ds_read_b64_tr_b16 v[244:245], v23 offset:8192
  v_mul_f32 v106, s72, v106
  v_mfma_f32_16x16x32_bf16 v[152:155], v[232:235], a[220:223], v[152:155]
  ds_read_b64_tr_b16 v[246:247], v23 offset:10240
  v_mul_f32 v107, s72, v107
  v_mfma_f32_16x16x32_bf16 v[152:155], v[228:231], a[204:207], v[152:155]
  buffer_load_dwordx4 v14, s[12:15], s61 offen offset:0 lds
  v_mfma_f32_16x16x32_bf16 v[152:155], v[224:227], a[188:191], v[152:155]
  buffer_store_dwordx4 v[40:43], v2, s[4:7], s74 offen offset:1024 sc1
  v_mfma_f32_16x16x32_bf16 v[168:171], v[224:227], a[164:167], v[168:171]
  v_rcp_f32 v102, v102
  v_mfma_f32_16x16x32_bf16 v[168:171], v[228:231], a[200:203], v[168:171]
  v_rcp_f32 v103, v103
  v_mfma_f32_16x16x32_bf16 v[168:171], v[232:235], a[216:219], v[168:171]
  buffer_load_dwordx4 v15, s[12:15], s61 offen offset:1024 lds
  v_mfma_f32_16x16x32_bf16 v[184:187], v[232:235], a[144:147], v[184:187]
  v_rcp_f32 v116, v116
  v_mfma_f32_16x16x32_bf16 v[184:187], v[228:231], a[208:211], v[184:187]
  v_rcp_f32 v117, v117
  v_mfma_f32_16x16x32_bf16 v[184:187], v[224:227], a[192:195], v[184:187]
  s_waitcnt lgkmcnt(0)
  ds_read_b64_tr_b16 v[224:225], v20 offset:12288
  ds_read_b64_tr_b16 v[226:227], v20 offset:14336
  v_mfma_f32_16x16x32_bf16 v[188:191], v[236:239], a[192:195], v[188:191]
  ds_read_b64_tr_b16 v[228:229], v20 offset:16384
  v_mul_f32 v120, s72, v120
  v_mfma_f32_16x16x32_bf16 v[188:191], v[240:243], a[208:211], v[188:191]
  ds_read_b64_tr_b16 v[230:231], v20 offset:18432
  v_mul_f32 v121, s72, v121
  v_mfma_f32_16x16x32_bf16 v[188:191], v[244:247], a[144:147], v[188:191]
  ds_read_b64_tr_b16 v[232:233], v20 offset:20480
  v_mul_f32 v122, s72, v122
  v_mfma_f32_16x16x32_bf16 v[172:175], v[244:247], a[216:219], v[172:175]
  ds_read_b64_tr_b16 v[234:235], v20 offset:22528
  v_mul_f32 v123, s72, v123
  v_mfma_f32_16x16x32_bf16 v[172:175], v[240:243], a[200:203], v[172:175]
  buffer_load_dwordx4 v16, s[12:15], s61 offen offset:2048 lds
  v_mfma_f32_16x16x32_bf16 v[172:175], v[236:239], a[164:167], v[172:175]
  v_rcp_f32 v118, v118
  v_mfma_f32_16x16x32_bf16 v[156:159], v[236:239], a[188:191], v[156:159]
  v_rcp_f32 v119, v119
  v_mfma_f32_16x16x32_bf16 v[156:159], v[240:243], a[204:207], v[156:159]
  v_exp_f32 v72, v72
  v_mfma_f32_16x16x32_bf16 v[156:159], v[244:247], a[220:223], v[156:159]
  v_exp_f32 v73, v73
  v_mfma_f32_16x16x32_bf16 v[140:143], v[244:247], a[212:215], v[140:143]
  s_add_u32 s61, s80, 1769600
  v_exp_f32 v74, v74
  v_mfma_f32_16x16x32_bf16 v[140:143], v[240:243], a[196:199], v[140:143]
  s_add_u32 m0, s63, 106496
  v_exp_f32 v75, v75
  v_mfma_f32_16x16x32_bf16 v[140:143], v[236:239], a[184:187], v[140:143]
  s_waitcnt lgkmcnt(0)
  ds_read_b64_tr_b16 v[236:237], v21 offset:12288
  ds_read_b64_tr_b16 v[238:239], v21 offset:14336
  v_mfma_f32_16x16x32_bf16 v[128:131], v[224:227], a[128:131], v[128:131]
  ds_read_b64_tr_b16 v[240:241], v21 offset:16384
  v_add_f32 v72, 1.0, v72
  v_mfma_f32_16x16x32_bf16 v[128:131], v[228:231], a[0:3], v[128:131]
  ds_read_b64_tr_b16 v[242:243], v21 offset:18432
  v_add_f32 v73, 1.0, v73
  v_mfma_f32_16x16x32_bf16 v[128:131], v[232:235], a[8:11], v[128:131]
  ds_read_b64_tr_b16 v[244:245], v21 offset:20480
  v_add_f32 v74, 1.0, v74
  v_mfma_f32_16x16x32_bf16 v[144:147], v[232:235], a[12:15], v[144:147]
  ds_read_b64_tr_b16 v[246:247], v21 offset:22528
  v_add_f32 v75, 1.0, v75
  v_mfma_f32_16x16x32_bf16 v[144:147], v[228:231], a[4:7], v[144:147]
  buffer_load_dwordx4 v14, s[12:15], s61 offen offset:0 lds
  v_mfma_f32_16x16x32_bf16 v[144:147], v[224:227], a[136:139], v[144:147]
  s_add_u32 s74, s78, 12288
  v_exp_f32 v88, v88
  v_mfma_f32_16x16x32_bf16 v[160:163], v[224:227], a[132:135], v[160:163]
  v_exp_f32 v89, v89
  v_mfma_f32_16x16x32_bf16 v[160:163], v[228:231], a[16:19], v[160:163]
  v_exp_f32 v90, v90
  v_mfma_f32_16x16x32_bf16 v[160:163], v[232:235], a[24:27], v[160:163]
  buffer_store_dwordx4 v[44:47], v1, s[4:7], s74 offen offset:0 sc1
  v_mfma_f32_16x16x32_bf16 v[176:179], v[232:235], a[28:31], v[176:179]
  v_exp_f32 v91, v91
  v_mfma_f32_16x16x32_bf16 v[176:179], v[228:231], a[20:23], v[176:179]
  v_add_f32 v88, 1.0, v88
  v_add_f32 v89, 1.0, v89
  v_mfma_f32_16x16x32_bf16 v[176:179], v[224:227], a[140:143], v[176:179]
  s_waitcnt lgkmcnt(0)
  ds_read_b64_tr_b16 v[224:225], v22 offset:12288
  ds_read_b64_tr_b16 v[226:227], v22 offset:14336
  v_mfma_f32_16x16x32_bf16 v[180:183], v[236:239], a[140:143], v[180:183]
  ds_read_b64_tr_b16 v[228:229], v22 offset:16384
  v_add_f32 v90, 1.0, v90
  v_mfma_f32_16x16x32_bf16 v[180:183], v[240:243], a[20:23], v[180:183]
  ds_read_b64_tr_b16 v[230:231], v22 offset:18432
  buffer_load_dwordx4 v15, s[12:15], s61 offen offset:1024 lds
  v_mfma_f32_16x16x32_bf16 v[180:183], v[244:247], a[28:31], v[180:183]
  ds_read_b64_tr_b16 v[232:233], v22 offset:20480
  v_add_f32 v91, 1.0, v91
  v_mfma_f32_16x16x32_bf16 v[164:167], v[244:247], a[24:27], v[164:167]
  ds_read_b64_tr_b16 v[234:235], v22 offset:22528
  v_mul_f32 v76, s72, v76
  v_mfma_f32_16x16x32_bf16 v[164:167], v[240:243], a[16:19], v[164:167]
  v_rcp_f32 v72, v72
  v_mfma_f32_16x16x32_bf16 v[164:167], v[236:239], a[132:135], v[164:167]
  buffer_load_dwordx4 v16, s[12:15], s61 offen offset:2048 lds
  v_mfma_f32_16x16x32_bf16 v[148:151], v[236:239], a[136:139], v[148:151]
  v_rcp_f32 v73, v73
  v_mfma_f32_16x16x32_bf16 v[148:151], v[240:243], a[4:7], v[148:151]
  v_rcp_f32 v74, v74
  v_mfma_f32_16x16x32_bf16 v[148:151], v[244:247], a[12:15], v[148:151]
  v_rcp_f32 v75, v75
  v_mfma_f32_16x16x32_bf16 v[132:135], v[244:247], a[8:11], v[132:135]
  s_add_u32 s61, s80, 1990784
  v_rcp_f32 v88, v88
  v_mfma_f32_16x16x32_bf16 v[132:135], v[240:243], a[0:3], v[132:135]
  s_add_u32 m0, s63, 109568
  v_rcp_f32 v89, v89
  v_mfma_f32_16x16x32_bf16 v[132:135], v[236:239], a[128:131], v[132:135]
  s_waitcnt lgkmcnt(0)
  ds_read_b64_tr_b16 v[236:237], v23 offset:12288
  ds_read_b64_tr_b16 v[238:239], v23 offset:14336
  v_mfma_f32_16x16x32_bf16 v[136:139], v[224:227], a[128:131], v[136:139]
  ds_read_b64_tr_b16 v[240:241], v23 offset:16384
  v_mul_f32 v77, s72, v77
  v_mfma_f32_16x16x32_bf16 v[136:139], v[228:231], a[0:3], v[136:139]
  ds_read_b64_tr_b16 v[242:243], v23 offset:18432
  v_mul_f32 v78, s72, v78
  v_mfma_f32_16x16x32_bf16 v[136:139], v[232:235], a[8:11], v[136:139]
  ds_read_b64_tr_b16 v[244:245], v23 offset:20480
  v_mul_f32 v79, s72, v79
  v_mfma_f32_16x16x32_bf16 v[152:155], v[232:235], a[12:15], v[152:155]
  ds_read_b64_tr_b16 v[246:247], v23 offset:22528
  v_mul_f32 v92, s72, v92
  v_mfma_f32_16x16x32_bf16 v[152:155], v[228:231], a[4:7], v[152:155]
  buffer_load_dwordx4 v14, s[12:15], s61 offen offset:0 lds
  v_mfma_f32_16x16x32_bf16 v[152:155], v[224:227], a[136:139], v[152:155]
  v_rcp_f32 v90, v90
  v_mfma_f32_16x16x32_bf16 v[168:171], v[224:227], a[132:135], v[168:171]
  v_rcp_f32 v91, v91
  v_mfma_f32_16x16x32_bf16 v[168:171], v[228:231], a[16:19], v[168:171]
  v_exp_f32 v104, v104
  v_mfma_f32_16x16x32_bf16 v[168:171], v[232:235], a[24:27], v[168:171]
  buffer_load_dwordx4 v15, s[12:15], s61 offen offset:1024 lds
  v_mfma_f32_16x16x32_bf16 v[184:187], v[232:235], a[28:31], v[184:187]
  v_exp_f32 v105, v105
  v_mfma_f32_16x16x32_bf16 v[184:187], v[228:231], a[20:23], v[184:187]
  s_mov_b64 exec, 0
  s_cmp_eq_u32 s57, 0
  s_cbranch_scc1 pad_m_12
  s_cmp_eq_u32 s57, 1
  s_cbranch_scc1 pad_m_13
  s_cmp_eq_u32 s57, 2
  s_cbranch_scc1 pad_m_14
  s_branch pad_m_15
warm_3:
  s_mov_b64 exec, -1
  s_nop 3
  v_exp_f32 v106, v106
  v_mfma_f32_16x16x32_bf16 v[184:187], v[224:227], a[140:143], v[184:187]
  s_waitcnt vmcnt(14) lgkmcnt(0)
  s_barrier
  ds_read_b64_tr_b16 v[224:225], v20 offset:24576
  v_mfma_f32_16x16x32_bf16 v[188:191], v[236:239], a[140:143], v[188:191]
  ds_read_b64_tr_b16 v[226:227], v20 offset:26624
  ds_read_b64_tr_b16 v[228:229], v20 offset:28672
  v_mfma_f32_16x16x32_bf16 v[188:191], v[240:243], a[20:23], v[188:191]
  ds_read_b64_tr_b16 v[230:231], v20 offset:30720
  v_add_f32 v104, 1.0, v104
  v_mfma_f32_16x16x32_bf16 v[188:191], v[244:247], a[28:31], v[188:191]
  ds_read_b64_tr_b16 v[232:233], v20 offset:32768
  v_add_f32 v105, 1.0, v105
  v_mfma_f32_16x16x32_bf16 v[172:175], v[244:247], a[24:27], v[172:175]
  ds_read_b64_tr_b16 v[234:235], v20 offset:34816
  v_add_f32 v106, 1.0, v106
  v_mfma_f32_16x16x32_bf16 v[172:175], v[240:243], a[16:19], v[172:175]
  buffer_store_dwordx4 v[52:55], v1, s[4:7], s74 offen offset:1024 sc1
  v_mfma_f32_16x16x32_bf16 v[172:175], v[236:239], a[132:135], v[172:175]
  v_exp_f32 v107, v107
  v_mfma_f32_16x16x32_bf16 v[156:159], v[236:239], a[136:139], v[156:159]
  v_exp_f32 v120, v120
  v_mfma_f32_16x16x32_bf16 v[156:159], v[240:243], a[4:7], v[156:159]
  v_readfirstlane_b32 s73, v59
  s_nop 0
  s_cmp_ge_u32 s73, 1
  s_cbranch_scc0 spin_r
back_r:
  v_mfma_f32_16x16x32_bf16 v[156:159], v[244:247], a[12:15], v[156:159]
  buffer_load_dwordx4 v16, s[12:15], s61 offen offset:2048 lds
  v_mfma_f32_16x16x32_bf16 v[140:143], v[244:247], a[8:11], v[140:143]
  s_add_u32 s61, s80, 3539072
  v_exp_f32 v121, v121
  v_mfma_f32_16x16x32_bf16 v[140:143], v[240:243], a[0:3], v[140:143]
  s_add_u32 m0, s63, 0
  v_exp_f32 v122, v122
  v_mfma_f32_16x16x32_bf16 v[140:143], v[236:239], a[128:131], v[140:143]
  s_waitcnt lgkmcnt(0)
  ds_read_b64_tr_b16 v[236:237], v21 offset:24576
  ds_read_b64_tr_b16 v[238:239], v21 offset:26624
  v_mfma_f32_16x16x32_bf16 v[128:131], v[224:227], a[32:35], v[128:131]
  ds_read_b64_tr_b16 v[240:241], v21 offset:28672
  v_add_f32 v107, 1.0, v107
  v_mfma_f32_16x16x32_bf16 v[128:131], v[228:231], a[40:43], v[128:131]
  ds_read_b64_tr_b16 v[242:243], v21 offset:30720
  v_add_f32 v120, 1.0, v120
  v_mfma_f32_16x16x32_bf16 v[128:131], v[232:235], a[64:67], v[128:131]
  s_and_b32 s1, s2, 1
  ds_read_b64_tr_b16 v[244:245], v21 offset:32768
  v_add_f32 v121, 1.0, v121
  v_mfma_f32_16x16x32_bf16 v[144:147], v[232:235], a[68:71], v[144:147]
  s_lshl_b32 s35, s1, 2
  ds_read_b64_tr_b16 v[246:247], v21 offset:34816
  v_add_f32 v122, 1.0, v122
  v_mfma_f32_16x16x32_bf16 v[144:147], v[228:231], a[44:47], v[144:147]
  buffer_load_dwordx4 v14, s[12:15], s61 offen offset:0 lds
  v_mfma_f32_16x16x32_bf16 v[144:147], v[224:227], a[36:39], v[144:147]
  s_lshl_b32 s35, 1, s35
  v_exp_f32 v123, v123
  v_mfma_f32_16x16x32_bf16 v[160:163], v[224:227], a[48:51], v[160:163]
  s_lshl_b32 s8, s35, 8
  v_add_f32 v123, 1.0, v123
  v_mul_f32 v93, s72, v93
  v_mfma_f32_16x16x32_bf16 v[160:163], v[228:231], a[56:59], v[160:163]
  s_lshl_b32 s9, s35, 2
  v_rcp_f32 v104, v104
  v_mfma_f32_16x16x32_bf16 v[160:163], v[232:235], a[80:83], v[160:163]
  buffer_load_dwordx4 v15, s[12:15], s61 offen offset:1024 lds
  v_mfma_f32_16x16x32_bf16 v[176:179], v[232:235], a[84:87], v[176:179]
  s_lshl_b32 s10, s35, 10
  v_rcp_f32 v105, v105
  v_mfma_f32_16x16x32_bf16 v[176:179], v[228:231], a[60:63], v[176:179]
  v_rcp_f32 v106, v106
  v_mfma_f32_16x16x32_bf16 v[176:179], v[224:227], a[52:55], v[176:179]
  s_waitcnt lgkmcnt(0)
  ds_read_b64_tr_b16 v[224:225], v22 offset:24576
  ds_read_b64_tr_b16 v[226:227], v22 offset:26624
  v_mfma_f32_16x16x32_bf16 v[180:183], v[236:239], a[52:55], v[180:183]
  ds_read_b64_tr_b16 v[228:229], v22 offset:28672
  v_mul_f32 v94, s72, v94
  v_mfma_f32_16x16x32_bf16 v[180:183], v[240:243], a[60:63], v[180:183]
  ds_read_b64_tr_b16 v[230:231], v22 offset:30720
  v_mul_f32 v95, s72, v95
  v_mfma_f32_16x16x32_bf16 v[180:183], v[244:247], a[84:87], v[180:183]
  ds_read_b64_tr_b16 v[232:233], v22 offset:32768
  v_mul_f32 v108, s72, v108
  v_mfma_f32_16x16x32_bf16 v[164:167], v[244:247], a[80:83], v[164:167]
  ds_read_b64_tr_b16 v[234:235], v22 offset:34816
  v_mul_f32 v109, s72, v109
  v_mfma_f32_16x16x32_bf16 v[164:167], v[240:243], a[56:59], v[164:167]
  buffer_load_dwordx4 v16, s[12:15], s61 offen offset:2048 lds
  v_mfma_f32_16x16x32_bf16 v[164:167], v[236:239], a[48:51], v[164:167]
  v_rcp_f32 v107, v107
  v_mfma_f32_16x16x32_bf16 v[148:151], v[236:239], a[36:39], v[148:151]
  v_rcp_f32 v120, v120
  v_mfma_f32_16x16x32_bf16 v[148:151], v[240:243], a[44:47], v[148:151]
  v_rcp_f32 v121, v121
  v_mfma_f32_16x16x32_bf16 v[148:151], v[244:247], a[68:71], v[148:151]
  buffer_store_dwordx4 v[248:251], v2, s[4:7], s74 offen offset:0 sc1
  v_mfma_f32_16x16x32_bf16 v[132:135], v[244:247], a[64:67], v[132:135]
  s_add_u32 s61, s80, 3760256
  v_rcp_f32 v122, v122
  v_mfma_f32_16x16x32_bf16 v[132:135], v[240:243], a[40:43], v[132:135]
  s_add_u32 m0, s63, 3072
  v_rcp_f32 v123, v123
  v_mfma_f32_16x16x32_bf16 v[132:135], v[236:239], a[32:35], v[132:135]
  s_waitcnt lgkmcnt(0)
  ds_read_b64_tr_b16 v[236:237], v23 offset:24576
  ds_read_b64_tr_b16 v[238:239], v23 offset:26624
  v_mfma_f32_16x16x32_bf16 v[136:139], v[224:227], a[32:35], v[136:139]
  ds_read_b64_tr_b16 v[240:241], v23 offset:28672
  v_mul_f32 v110, s72, v110
  v_mfma_f32_16x16x32_bf16 v[136:139], v[228:231], a[40:43], v[136:139]
  ds_read_b64_tr_b16 v[242:243], v23 offset:30720
  v_mul_f32 v111, s72, v111
  v_mfma_f32_16x16x32_bf16 v[136:139], v[232:235], a[64:67], v[136:139]
  ds_read_b64_tr_b16 v[244:245], v23 offset:32768
  v_mul_f32 v124, s72, v124
  v_mfma_f32_16x16x32_bf16 v[152:155], v[232:235], a[68:71], v[152:155]
  ds_read_b64_tr_b16 v[246:247], v23 offset:34816
  v_mul_f32 v125, s72, v125
  v_mfma_f32_16x16x32_bf16 v[152:155], v[228:231], a[44:47], v[152:155]
  buffer_load_dwordx4 v14, s[12:15], s61 offen offset:0 lds
  v_mfma_f32_16x16x32_bf16 v[152:155], v[224:227], a[36:39], v[152:155]
  v_exp_f32 v76, v76
  v_mfma_f32_16x16x32_bf16 v[168:171], v[224:227], a[48:51], v[168:171]
  v_exp_f32 v77, v77
  v_mfma_f32_16x16x32_bf16 v[168:171], v[228:231], a[56:59], v[168:171]
  v_exp_f32 v78, v78
  v_mfma_f32_16x16x32_bf16 v[168:171], v[232:235], a[80:83], v[168:171]
  v_exp_f32 v79, v79
  v_mfma_f32_16x16x32_bf16 v[184:187], v[232:235], a[84:87], v[184:187]
  buffer_load_dwordx4 v15, s[12:15], s61 offen offset:1024 lds
  v_mfma_f32_16x16x32_bf16 v[184:187], v[228:231], a[60:63], v[184:187]
  v_exp_f32 v92, v92
  v_mfma_f32_16x16x32_bf16 v[184:187], v[224:227], a[52:55], v[184:187]
  s_waitcnt lgkmcnt(0)
  ds_read_b64_tr_b16 v[224:225], v20 offset:36864
  ds_read_b64_tr_b16 v[226:227], v20 offset:38912
  v_mfma_f32_16x16x32_bf16 v[188:191], v[236:239], a[52:55], v[188:191]
  ds_read_b64_tr_b16 v[228:229], v20 offset:40960
  v_add_f32 v76, 1.0, v76
  v_mfma_f32_16x16x32_bf16 v[188:191], v[240:243], a[60:63], v[188:191]
  ds_read_b64_tr_b16 v[230:231], v20 offset:43008
  v_add_f32 v77, 1.0, v77
  v_mfma_f32_16x16x32_bf16 v[188:191], v[244:247], a[84:87], v[188:191]
  ds_read_b64_tr_b16 v[232:233], v20 offset:45056
  v_add_f32 v78, 1.0, v78
  v_mfma_f32_16x16x32_bf16 v[172:175], v[244:247], a[80:83], v[172:175]
  ds_read_b64_tr_b16 v[234:235], v20 offset:47104
  v_add_f32 v79, 1.0, v79
  v_mfma_f32_16x16x32_bf16 v[172:175], v[240:243], a[56:59], v[172:175]
  v_exp_f32 v93, v93
  v_mfma_f32_16x16x32_bf16 v[172:175], v[236:239], a[48:51], v[172:175]
  buffer_load_dwordx4 v16, s[12:15], s61 offen offset:2048 lds
  v_mfma_f32_16x16x32_bf16 v[156:159], v[236:239], a[36:39], v[156:159]
  v_exp_f32 v94, v94
  v_mfma_f32_16x16x32_bf16 v[156:159], v[240:243], a[44:47], v[156:159]
  v_exp_f32 v95, v95
  v_mfma_f32_16x16x32_bf16 v[156:159], v[244:247], a[68:71], v[156:159]
  v_add_f32 v92, 1.0, v92
  v_add_f32 v93, 1.0, v93
  v_mfma_f32_16x16x32_bf16 v[140:143], v[244:247], a[64:67], v[140:143]
  v_add_f32 v94, 1.0, v94
  v_add_f32 v95, 1.0, v95
  v_mfma_f32_16x16x32_bf16 v[140:143], v[240:243], a[40:43], v[140:143]
  v_rcp_f32 v76, v76
  v_mfma_f32_16x16x32_bf16 v[140:143], v[236:239], a[32:35], v[140:143]
  s_waitcnt lgkmcnt(0)
  ds_read_b64_tr_b16 v[236:237], v21 offset:36864
  ds_read_b64_tr_b16 v[238:239], v21 offset:38912
  v_mfma_f32_16x16x32_bf16 v[128:131], v[224:227], a[72:75], v[128:131]
  ds_read_b64_tr_b16 v[240:241], v21 offset:40960
  v_mul_f32 v126, s72, v126
  v_mfma_f32_16x16x32_bf16 v[128:131], v[228:231], a[96:99], v[128:131]
  ds_read_b64_tr_b16 v[242:243], v21 offset:43008
  v_mul_f32 v127, s72, v127
  v_mfma_f32_16x16x32_bf16 v[128:131], v[232:235], a[104:107], v[128:131]
  ds_read_b64_tr_b16 v[244:245], v21 offset:45056
  v_readfirstlane_b32 s51, v59
  v_mfma_f32_16x16x32_bf16 v[144:147], v[232:235], a[108:111], v[144:147]
  s_cmp_eq_u32 s51, s56
  s_cselect_b32 s51, 0, 1
  ds_read_b64_tr_b16 v[246:247], v21 offset:47104
  v_mfma_f32_16x16x32_bf16 v[144:147], v[228:231], a[100:103], v[144:147]
  buffer_store_dwordx4 v[252:255], v2, s[4:7], s74 offen offset:1024 sc1
  v_mfma_f32_16x16x32_bf16 v[144:147], v[224:227], a[76:79], v[144:147]
  s_andn2_b32 s1, s1, s51
  v_rcp_f32 v77, v77
  v_mfma_f32_16x16x32_bf16 v[160:163], v[224:227], a[88:91], v[160:163]
  s_mul_i32 s1, s1, 1
  v_rcp_f32 v78, v78
  v_mfma_f32_16x16x32_bf16 v[160:163], v[228:231], a[112:115], v[160:163]
  s_lshl_b32 s0, s1, 5
  v_rcp_f32 v79, v79
  v_mfma_f32_16x16x32_bf16 v[160:163], v[232:235], a[120:123], v[160:163]
  s_lshl_b32 s56, s52, 1
  v_rcp_f32 v92, v92
  v_mfma_f32_16x16x32_bf16 v[176:179], v[232:235], a[124:127], v[176:179]
  s_add_u32 s56, s56, s51
  v_rcp_f32 v93, v93
  v_mfma_f32_16x16x32_bf16 v[176:179], v[228:231], a[116:119], v[176:179]
  s_mul_i32 s50, s56, 73728
  v_rcp_f32 v94, v94
  v_mfma_f32_16x16x32_bf16 v[176:179], v[224:227], a[92:95], v[176:179]
  s_waitcnt lgkmcnt(0)
  ds_read_b64_tr_b16 v[224:225], v22 offset:36864
  ds_read_b64_tr_b16 v[226:227], v22 offset:38912
  v_mfma_f32_16x16x32_bf16 v[180:183], v[236:239], a[92:95], v[180:183]
  s_cmp_eq_u32 s51, 0
  s_cselect_b32 s43, s43, 0
  ds_read_b64_tr_b16 v[228:229], v22 offset:40960
  v_mfma_f32_16x16x32_bf16 v[180:183], v[240:243], a[116:119], v[180:183]
  s_add_u32 s41, s41, s43
  ds_read_b64_tr_b16 v[230:231], v22 offset:43008
  v_mul_f32 v128, v64, v128
  v_mfma_f32_16x16x32_bf16 v[180:183], v[244:247], a[124:127], v[180:183]
  s_add_u32 s50, s50, s49
  ds_read_b64_tr_b16 v[232:233], v22 offset:45056
  v_mul_f32 v129, v65, v129
  v_mfma_f32_16x16x32_bf16 v[164:167], v[244:247], a[120:123], v[164:167]
  ds_read_b64_tr_b16 v[234:235], v22 offset:47104
  v_mul_f32 v130, v66, v130
  v_mfma_f32_16x16x32_bf16 v[164:167], v[240:243], a[112:115], v[164:167]
  v_rcp_f32 v95, v95
  v_mfma_f32_16x16x32_bf16 v[164:167], v[236:239], a[88:91], v[164:167]
  v_exp_f32 v108, v108
  v_mfma_f32_16x16x32_bf16 v[148:151], v[236:239], a[76:79], v[148:151]
  v_exp_f32 v109, v109
  v_mfma_f32_16x16x32_bf16 v[148:151], v[240:243], a[100:103], v[148:151]
  v_exp_f32 v110, v110
  v_mfma_f32_16x16x32_bf16 v[148:151], v[244:247], a[108:111], v[148:151]
  v_exp_f32 v111, v111
  v_mfma_f32_16x16x32_bf16 v[132:135], v[244:247], a[104:107], v[132:135]
  v_exp_f32 v124, v124
  v_mfma_f32_16x16x32_bf16 v[132:135], v[240:243], a[96:99], v[132:135]
  v_exp_f32 v125, v125
  v_mfma_f32_16x16x32_bf16 v[132:135], v[236:239], a[72:75], v[132:135]
  s_waitcnt lgkmcnt(0)
  ds_read_b64_tr_b16 v[236:237], v23 offset:36864
  ds_read_b64_tr_b16 v[238:239], v23 offset:38912
  v_mfma_f32_16x16x32_bf16 v[136:139], v[224:227], a[72:75], v[136:139]
  ds_read_b64_tr_b16 v[240:241], v23 offset:40960
  v_add_f32 v108, 1.0, v108
  v_mfma_f32_16x16x32_bf16 v[136:139], v[228:231], a[96:99], v[136:139]
  ds_read_b64_tr_b16 v[242:243], v23 offset:43008
  v_add_f32 v109, 1.0, v109
  v_mfma_f32_16x16x32_bf16 v[136:139], v[232:235], a[104:107], v[136:139]
  ds_read_b64_tr_b16 v[244:245], v23 offset:45056
  v_add_f32 v110, 1.0, v110
  v_mfma_f32_16x16x32_bf16 v[152:155], v[232:235], a[108:111], v[152:155]
  ds_read_b64_tr_b16 v[246:247], v23 offset:47104
  v_add_f32 v111, 1.0, v111
  v_mfma_f32_16x16x32_bf16 v[152:155], v[228:231], a[100:103], v[152:155]
  v_exp_f32 v126, v126
  v_mfma_f32_16x16x32_bf16 v[152:155], v[224:227], a[76:79], v[152:155]
  v_exp_f32 v127, v127
  v_mfma_f32_16x16x32_bf16 v[168:171], v[224:227], a[88:91], v[168:171]
  v_add_f32 v124, 1.0, v124
  v_add_f32 v125, 1.0, v125
  v_mfma_f32_16x16x32_bf16 v[168:171], v[228:231], a[112:115], v[168:171]
  v_add_f32 v126, 1.0, v126
  v_add_f32 v127, 1.0, v127
  v_mfma_f32_16x16x32_bf16 v[168:171], v[232:235], a[120:123], v[168:171]
  v_rcp_f32 v108, v108
  v_mfma_f32_16x16x32_bf16 v[184:187], v[232:235], a[124:127], v[184:187]
  v_rcp_f32 v109, v109
  v_mfma_f32_16x16x32_bf16 v[184:187], v[228:231], a[116:119], v[184:187]
  v_rcp_f32 v110, v110
  v_mfma_f32_16x16x32_bf16 v[184:187], v[224:227], a[92:95], v[184:187]
  s_waitcnt vmcnt(16) lgkmcnt(0)
  s_barrier
  ds_read_b64_tr_b16 v[224:225], v24 offset:24576
  v_mfma_f32_16x16x32_bf16 v[188:191], v[236:239], a[92:95], v[188:191]
  s_add_u32 s61, s80, 128
  ds_read_b64_tr_b16 v[226:227], v24 offset:26624
  ds_read_b64_tr_b16 v[228:229], v24 offset:28672
  v_mfma_f32_16x16x32_bf16 v[188:191], v[240:243], a[116:119], v[188:191]
  s_add_u32 m0, s63, 24576
  s_cmp_eq_u32 s51, 0
  s_cselect_b32 s40, s40, s42
  s_cselect_b32 s54, 0x4400, 0
  ds_read_b64_tr_b16 v[230:231], v24 offset:30720
  v_mfma_f32_16x16x32_bf16 v[188:191], v[244:247], a[124:127], v[188:191]
  ds_read_b64_tr_b16 v[232:233], v24 offset:32768
  v_mul_f32 v131, v67, v131
  v_mfma_f32_16x16x32_bf16 v[172:175], v[244:247], a[120:123], v[172:175]
  ds_read_b64_tr_b16 v[234:235], v24 offset:34816
  v_mul_f32 v144, v80, v144
  v_mfma_f32_16x16x32_bf16 v[172:175], v[240:243], a[112:115], v[172:175]
  s_cmp_eq_u32 s51, 0
  s_cselect_b32 s42, 8, 4
  s_cselect_b32 s43, -22, 4
  buffer_load_dwordx4 v14, s[16:19], s61 offen offset:0 lds
  v_mfma_f32_16x16x32_bf16 v[172:175], v[236:239], a[88:91], v[172:175]
  s_add_u32 s43, s43, s0
  v_rcp_f32 v111, v111
  v_mfma_f32_16x16x32_bf16 v[156:159], v[236:239], a[76:79], v[156:159]
  s_sub_u32 s79, s42, s0
  v_rcp_f32 v124, v124
  v_mfma_f32_16x16x32_bf16 v[156:159], v[240:243], a[100:103], v[156:159]
  s_mul_i32 s79, s79, 36864
  v_rcp_f32 v125, v125
  v_mfma_f32_16x16x32_bf16 v[156:159], v[244:247], a[108:111], v[156:159]
  s_mul_i32 s0, s1, 589824
  v_rcp_f32 v126, v126
  v_mfma_f32_16x16x32_bf16 v[140:143], v[244:247], a[104:107], v[140:143]
  s_add_u32 s41, s41, s0
  v_rcp_f32 v127, v127
  v_mfma_f32_16x16x32_bf16 v[140:143], v[240:243], a[96:99], v[140:143]
  s_cmp_eq_u32 s51, 0
  s_cselect_b32 s9, s9, 0x44
  s_cselect_b32 s10, s10, 0
  v_mfma_f32_16x16x32_bf16 v[140:143], v[236:239], a[72:75], v[140:143]
  s_waitcnt lgkmcnt(0)
  ds_read_b64_tr_b16 v[236:237], v25 offset:24576
  ds_read_b64_tr_b16 v[238:239], v25 offset:26624
  v_mfma_f32_16x16x32_bf16 v[64:67], v[224:227], v[192:195], 0
  s_lshl_b32 s0, s1, 16
  ds_read_b64_tr_b16 v[240:241], v25 offset:28672
  v_mul_f32 v145, v81, v145
  v_mfma_f32_16x16x32_bf16 v[64:67], v[228:231], v[200:203], v[64:67]
  ds_read_b64_tr_b16 v[242:243], v25 offset:30720
  v_mul_f32 v146, v82, v146
  v_mul_f32 v147, v83, v147
  v_mfma_f32_16x16x32_bf16 v[64:67], v[232:235], v[208:211], v[64:67]
  s_sub_u32 s11, 4096, s0
  ds_read_b64_tr_b16 v[244:245], v25 offset:32768
  v_mul_f32 v160, v96, v160
  v_mfma_f32_16x16x32_bf16 v[80:83], v[232:235], v[212:215], 0
  s_add_u32 s91, 4096, s0
  ds_read_b64_tr_b16 v[246:247], v25 offset:34816
  v_mul_f32 v161, v97, v161
  v_mfma_f32_16x16x32_bf16 v[80:83], v[228:231], v[204:207], v[80:83]
  buffer_load_dwordx4 v15, s[16:19], s61 offen offset:1024 lds
  v_mul_f32 v162, v98, v162
  v_mul_f32 v163, v99, v163
  v_mfma_f32_16x16x32_bf16 v[80:83], v[224:227], v[196:199], v[80:83]
  s_lshl_b32 s0, s1, 15
  v_mul_f32 v176, v112, v176
  v_mul_f32 v177, v113, v177
  v_mfma_f32_16x16x32_bf16 v[96:99], v[224:227], a[224:227], 0
  s_add_u32 s0, s0, s40
  v_mul_f32 v178, v114, v178
  v_mul_f32 v179, v115, v179
  v_mfma_f32_16x16x32_bf16 v[96:99], v[228:231], a[232:235], v[96:99]
  s_mul_i32 s42, s42, 36864
  v_mul_f32 v180, v116, v180
  v_mul_f32 v181, v117, v181
  v_mfma_f32_16x16x32_bf16 v[96:99], v[232:235], a[240:243], v[96:99]
  buffer_load_dwordx4 v16, s[16:19], s61 offen offset:2048 lds
  v_mfma_f32_16x16x32_bf16 v[112:115], v[232:235], a[244:247], 0
  s_mul_i32 s43, s43, 36864
  v_mul_f32 v182, v118, v182
  v_mul_f32 v183, v119, v183
  v_mfma_f32_16x16x32_bf16 v[112:115], v[228:231], a[236:239], v[112:115]
  s_add_u32 s65, s97, 0
  v_mul_f32 v164, v100, v164
  v_mul_f32 v165, v101, v165
  v_mfma_f32_16x16x32_bf16 v[112:115], v[224:227], a[228:231], v[112:115]
  s_waitcnt lgkmcnt(0)
  ds_read_b64_tr_b16 v[224:225], v26 offset:24576
  ds_read_b64_tr_b16 v[226:227], v26 offset:26624
  v_mfma_f32_16x16x32_bf16 v[116:119], v[236:239], a[228:231], 0
  s_add_u32 s61, s80, 221312
  ds_read_b64_tr_b16 v[228:229], v26 offset:28672
  v_mul_f32 v166, v102, v166
  v_mfma_f32_16x16x32_bf16 v[116:119], v[240:243], a[236:239], v[116:119]
  s_add_u32 m0, s63, 27648
  ds_read_b64_tr_b16 v[230:231], v26 offset:30720
  v_mul_f32 v167, v103, v167
  v_mfma_f32_16x16x32_bf16 v[116:119], v[244:247], a[244:247], v[116:119]
  s_add_u32 s66, s97, 4096
  ds_read_b64_tr_b16 v[232:233], v26 offset:32768
  v_mul_f32 v148, v84, v148
  v_mfma_f32_16x16x32_bf16 v[100:103], v[244:247], a[240:243], 0
  ds_read_b64_tr_b16 v[234:235], v26 offset:34816
  v_mul_f32 v149, v85, v149
  v_mfma_f32_16x16x32_bf16 v[100:103], v[240:243], a[232:235], v[100:103]
  buffer_load_dwordx4 v14, s[16:19], s61 offen offset:0 lds
  v_mul_f32 v150, v86, v150
  v_mul_f32 v151, v87, v151
  v_mfma_f32_16x16x32_bf16 v[100:103], v[236:239], a[224:227], v[100:103]
  v_mul_f32 v132, v68, v132
  v_mul_f32 v133, v69, v133
  v_mfma_f32_16x16x32_bf16 v[84:87], v[236:239], v[196:199], 0
  v_mul_f32 v134, v70, v134
  v_mul_f32 v135, v71, v135
  v_mfma_f32_16x16x32_bf16 v[84:87], v[240:243], v[204:207], v[84:87]
  v_mul_f32 v136, v72, v136
  v_mul_f32 v137, v73, v137
  v_mfma_f32_16x16x32_bf16 v[84:87], v[244:247], v[212:215], v[84:87]
  v_mul_f32 v138, v74, v138
  v_mul_f32 v139, v75, v139
  v_mfma_f32_16x16x32_bf16 v[68:71], v[244:247], v[208:211], 0
  v_mul_f32 v152, v88, v152
  v_mul_f32 v153, v89, v153
  v_mfma_f32_16x16x32_bf16 v[68:71], v[240:243], v[200:203], v[68:71]
  v_mul_f32 v154, v90, v154
  v_mul_f32 v155, v91, v155
  v_mfma_f32_16x16x32_bf16 v[68:71], v[236:239], v[192:195], v[68:71]
  s_waitcnt lgkmcnt(0)
  ds_read_b64_tr_b16 v[236:237], v27 offset:24576
  ds_read_b64_tr_b16 v[238:239], v27 offset:26624
  v_mfma_f32_16x16x32_bf16 v[72:75], v[224:227], v[192:195], 0
  ds_read_b64_tr_b16 v[240:241], v27 offset:28672
  v_cvt_pk_bf16_f32 v128, v128, v129
  v_mfma_f32_16x16x32_bf16 v[72:75], v[228:231], v[200:203], v[72:75]
  ds_read_b64_tr_b16 v[242:243], v27 offset:30720
  v_mul_f32 v168, v104, v168
  v_mfma_f32_16x16x32_bf16 v[72:75], v[232:235], v[208:211], v[72:75]
  ds_read_b64_tr_b16 v[244:245], v27 offset:32768
  v_mul_f32 v169, v105, v169
  v_mfma_f32_16x16x32_bf16 v[88:91], v[232:235], v[212:215], 0
  ds_read_b64_tr_b16 v[246:247], v27 offset:34816
  v_mul_f32 v170, v106, v170
  v_mfma_f32_16x16x32_bf16 v[88:91], v[228:231], v[204:207], v[88:91]
  buffer_load_dwordx4 v15, s[16:19], s61 offen offset:1024 lds
  v_mul_f32 v171, v107, v171
  v_mfma_f32_16x16x32_bf16 v[88:91], v[224:227], v[196:199], v[88:91]
  v_mul_f32 v184, v120, v184
  v_cvt_pk_bf16_f32 v129, v130, v131
  v_mfma_f32_16x16x32_bf16 v[104:107], v[224:227], a[224:227], 0
  v_mul_f32 v185, v121, v185
  v_mul_f32 v186, v122, v186
  v_mfma_f32_16x16x32_bf16 v[104:107], v[228:231], a[232:235], v[104:107]
  v_mul_f32 v187, v123, v187
  v_cvt_pk_bf16_f32 v130, v132, v133
  v_mfma_f32_16x16x32_bf16 v[104:107], v[232:235], a[240:243], v[104:107]
  buffer_load_dwordx4 v16, s[16:19], s61 offen offset:2048 lds
  v_mfma_f32_16x16x32_bf16 v[120:123], v[232:235], a[244:247], 0
  v_mul_f32 v188, v124, v188
  v_mul_f32 v189, v125, v189
  v_mfma_f32_16x16x32_bf16 v[120:123], v[228:231], a[236:239], v[120:123]
  v_mul_f32 v190, v126, v190
  v_mul_f32 v191, v127, v191
  v_mfma_f32_16x16x32_bf16 v[120:123], v[224:227], a[228:231], v[120:123]
  s_waitcnt lgkmcnt(0)
  ds_read_b64_tr_b16 v[224:225], v24 offset:36864
  ds_read_b64_tr_b16 v[226:227], v24 offset:38912
  v_mfma_f32_16x16x32_bf16 v[124:127], v[236:239], a[228:231], 0
  ds_read_b64_tr_b16 v[228:229], v24 offset:40960
  v_cvt_pk_bf16_f32 v131, v134, v135
  v_mfma_f32_16x16x32_bf16 v[124:127], v[240:243], a[236:239], v[124:127]
  ds_read_b64_tr_b16 v[230:231], v24 offset:43008
  v_mul_f32 v172, v108, v172
  v_mul_f32 v173, v109, v173
  v_mul_f32 v174, v110, v174
  v_mul_f32 v175, v111, v175
  v_mfma_f32_16x16x32_bf16 v[124:127], v[244:247], a[244:247], v[124:127]
  ds_read_b64_tr_b16 v[232:233], v24 offset:45056
  v_cvt_pk_bf16_f32 v132, v136, v137
  v_mfma_f32_16x16x32_bf16 v[108:111], v[244:247], a[240:243], 0
  ds_read_b64_tr_b16 v[234:235], v24 offset:47104
  v_mul_f32 v156, v92, v156
  v_mfma_f32_16x16x32_bf16 v[108:111], v[240:243], a[232:235], v[108:111]
  v_mul_f32 v157, v93, v157
  v_mul_f32 v158, v94, v158
  v_mul_f32 v159, v95, v159
  v_mfma_f32_16x16x32_bf16 v[108:111], v[236:239], a[224:227], v[108:111]
  v_mul_f32 v140, v76, v140
  v_cvt_pk_bf16_f32 v133, v138, v139
  v_mfma_f32_16x16x32_bf16 v[92:95], v[236:239], v[196:199], 0
  buffer_store_dwordx4 v[128:131], v1, s[4:7], s65 offen offset:0 sc1
  v_mfma_f32_16x16x32_bf16 v[92:95], v[240:243], v[204:207], v[92:95]
  v_mul_f32 v141, v77, v141
  v_mul_f32 v142, v78, v142
  v_mul_f32 v143, v79, v143
  v_mfma_f32_16x16x32_bf16 v[92:95], v[244:247], v[212:215], v[92:95]
  v_cvt_pk_bf16_f32 v134, v140, v141
  v_cvt_pk_bf16_f32 v135, v142, v143
  v_mfma_f32_16x16x32_bf16 v[76:79], v[244:247], v[208:211], 0
  v_lshl_add_u32 v28, s52, 10, v50
  v_cvt_pk_bf16_f32 v144, v144, v145
  v_mfma_f32_16x16x32_bf16 v[76:79], v[240:243], v[200:203], v[76:79]
  v_xor_b32 v29, 1024, v28
  v_cvt_pk_bf16_f32 v145, v146, v147
  v_mfma_f32_16x16x32_bf16 v[76:79], v[236:239], v[192:195], v[76:79]
  s_waitcnt lgkmcnt(0)
  ds_read_b64_tr_b16 v[236:237], v25 offset:36864
  ds_read_b64_tr_b16 v[238:239], v25 offset:38912
  v_mfma_f32_16x16x32_bf16 v[64:67], v[224:227], v[216:219], v[64:67]
pad_m_12:
  s_cbranch_execz warm_3
  ds_read_b64_tr_b16 v[240:241], v25 offset:40960
  v_xor_b32 v30, 2048, v28
  v_mfma_f32_16x16x32_bf16 v[64:67], v[228:231], a[168:171], v[64:67]
  ds_read_b64_tr_b16 v[242:243], v25 offset:43008
  v_xor_b32 v31, 3072, v28
  v_mfma_f32_16x16x32_bf16 v[64:67], v[232:235], a[176:179], v[64:67]
  ds_read_b64_tr_b16 v[244:245], v25 offset:45056
  v_cvt_pk_bf16_f32 v146, v148, v149
  v_mfma_f32_16x16x32_bf16 v[80:83], v[232:235], a[180:183], v[80:83]
  ds_read_b64_tr_b16 v[246:247], v25 offset:47104
  v_cvt_pk_bf16_f32 v147, v150, v151
  v_mfma_f32_16x16x32_bf16 v[80:83], v[228:231], a[172:175], v[80:83]
  v_mov_b32 v54, s51
  v_cvt_pk_bf16_f32 v148, v152, v153
  v_mfma_f32_16x16x32_bf16 v[80:83], v[224:227], v[220:223], v[80:83]
  v_mul_i32_i24 v55, 8192, v54
  v_cvt_pk_bf16_f32 v149, v154, v155
  v_mfma_f32_16x16x32_bf16 v[96:99], v[224:227], a[248:251], v[96:99]
  v_add_u32 v55, 4096, v55
  v_cvt_pk_bf16_f32 v150, v156, v157
  v_mfma_f32_16x16x32_bf16 v[96:99], v[228:231], a[148:151], v[96:99]
  v_add_u32 v36, v55, v50
  v_cvt_pk_bf16_f32 v151, v158, v159
  v_mfma_f32_16x16x32_bf16 v[96:99], v[232:235], a[156:159], v[96:99]
  v_mul_i32_i24 v55, 6144, v54
  v_cvt_pk_bf16_f32 v160, v160, v161
  v_mfma_f32_16x16x32_bf16 v[112:115], v[232:235], a[160:163], v[112:115]
  v_add_u32 v55, 4096, v55
  v_cvt_pk_bf16_f32 v161, v162, v163
  v_mfma_f32_16x16x32_bf16 v[112:115], v[228:231], a[152:155], v[112:115]
  v_add_u32 v37, v55, v50
  v_cvt_pk_bf16_f32 v162, v164, v165
  v_mfma_f32_16x16x32_bf16 v[112:115], v[224:227], a[252:255], v[112:115]
  s_waitcnt lgkmcnt(0)
  ds_read_b64_tr_b16 v[224:225], v26 offset:36864
  ds_read_b64_tr_b16 v[226:227], v26 offset:38912
  v_mfma_f32_16x16x32_bf16 v[116:119], v[236:239], a[252:255], v[116:119]
  ds_read_b64_tr_b16 v[228:229], v26 offset:40960
  v_mul_i32_i24 v55, 4096, v54
  v_mfma_f32_16x16x32_bf16 v[116:119], v[240:243], a[152:155], v[116:119]
  ds_read_b64_tr_b16 v[230:231], v26 offset:43008
  v_cvt_pk_bf16_f32 v163, v166, v167
  v_mfma_f32_16x16x32_bf16 v[116:119], v[244:247], a[160:163], v[116:119]
  ds_read_b64_tr_b16 v[232:233], v26 offset:45056
  v_add_u32 v55, 4096, v55
  v_mfma_f32_16x16x32_bf16 v[100:103], v[244:247], a[156:159], v[100:103]
  ds_read_b64_tr_b16 v[234:235], v26 offset:47104
  v_cvt_pk_bf16_f32 v164, v168, v169
  v_mfma_f32_16x16x32_bf16 v[100:103], v[240:243], a[148:151], v[100:103]
  buffer_store_dwordx4 v[132:135], v1, s[4:7], s66 offen offset:0 sc1
  v_mfma_f32_16x16x32_bf16 v[100:103], v[236:239], a[248:251], v[100:103]
  v_add_u32 v38, v55, v50
  v_cvt_pk_bf16_f32 v165, v170, v171
  v_mfma_f32_16x16x32_bf16 v[84:87], v[236:239], v[220:223], v[84:87]
  v_mul_i32_i24 v55, 2048, v54
  v_cvt_pk_bf16_f32 v166, v172, v173
  v_mfma_f32_16x16x32_bf16 v[84:87], v[240:243], a[172:175], v[84:87]
  v_add_u32 v55, 4096, v55
  v_cvt_pk_bf16_f32 v167, v174, v175
  v_mfma_f32_16x16x32_bf16 v[84:87], v[244:247], a[180:183], v[84:87]
  v_add_u32 v39, v55, v50
  v_cvt_pk_bf16_f32 v176, v176, v177
  v_mfma_f32_16x16x32_bf16 v[68:71], v[244:247], a[176:179], v[68:71]
  v_mul_i32_i24 v55, 0, v54
  v_cvt_pk_bf16_f32 v177, v178, v179
  v_mfma_f32_16x16x32_bf16 v[68:71], v[240:243], a[168:171], v[68:71]
  v_add_u32 v55, 8192, v55
  v_cvt_pk_bf16_f32 v178, v180, v181
  v_mfma_f32_16x16x32_bf16 v[68:71], v[236:239], v[216:219], v[68:71]
  s_waitcnt lgkmcnt(0)
  ds_read_b64_tr_b16 v[236:237], v27 offset:36864
  ds_read_b64_tr_b16 v[238:239], v27 offset:38912
  v_mfma_f32_16x16x32_bf16 v[72:75], v[224:227], v[216:219], v[72:75]
  ds_read_b64_tr_b16 v[240:241], v27 offset:40960
  v_add_u32 v40, v55, v50
  v_mfma_f32_16x16x32_bf16 v[72:75], v[228:231], a[168:171], v[72:75]
  ds_read_b64_tr_b16 v[242:243], v27 offset:43008
  v_cvt_pk_bf16_f32 v179, v182, v183
  v_mfma_f32_16x16x32_bf16 v[72:75], v[232:235], a[176:179], v[72:75]
  ds_read_b64_tr_b16 v[244:245], v27 offset:45056
  v_mul_i32_i24 v55, -2048, v54
  v_mfma_f32_16x16x32_bf16 v[88:91], v[232:235], a[180:183], v[88:91]
  ds_read_b64_tr_b16 v[246:247], v27 offset:47104
  v_cvt_pk_bf16_f32 v180, v184, v185
  v_mfma_f32_16x16x32_bf16 v[88:91], v[228:231], a[172:175], v[88:91]
  v_add_u32 v55, 8192, v55
  v_cvt_pk_bf16_f32 v181, v186, v187
  v_mfma_f32_16x16x32_bf16 v[88:91], v[224:227], v[220:223], v[88:91]
  v_add_u32 v41, v55, v50
  v_cvt_pk_bf16_f32 v182, v188, v189
  v_mfma_f32_16x16x32_bf16 v[104:107], v[224:227], a[248:251], v[104:107]
  v_mul_i32_i24 v55, -4096, v54
  v_cvt_pk_bf16_f32 v183, v190, v191
  v_mfma_f32_16x16x32_bf16 v[104:107], v[228:231], a[148:151], v[104:107]
  buffer_store_dwordx4 v[144:147], v1, s[4:7], s65 offen offset:1024 sc1
  v_mfma_f32_16x16x32_bf16 v[104:107], v[232:235], a[156:159], v[104:107]
  v_add_u32 v55, 8192, v55
  v_add_u32 v45, 49152, v50
  v_mfma_f32_16x16x32_bf16 v[120:123], v[232:235], a[160:163], v[120:123]
  v_add_u32 v42, v55, v50
  v_add_u32 v46, 86016, v50
  v_mfma_f32_16x16x32_bf16 v[120:123], v[228:231], a[152:155], v[120:123]
  v_mul_i32_i24 v55, -6144, v54
  v_add_u32 v47, 0, v50
  v_mfma_f32_16x16x32_bf16 v[120:123], v[224:227], a[252:255], v[120:123]
  s_waitcnt vmcnt(17) lgkmcnt(0)
  s_barrier
  ds_read_b64_tr_b16 v[224:225], v24 offset:0
  v_mfma_f32_16x16x32_bf16 v[124:127], v[236:239], a[252:255], v[124:127]
  s_add_u32 s61, s80, 1769600
  ds_read_b64_tr_b16 v[226:227], v24 offset:2048
  ds_read_b64_tr_b16 v[228:229], v24 offset:4096
  v_mfma_f32_16x16x32_bf16 v[124:127], v[240:243], a[152:155], v[124:127]
  s_add_u32 m0, s63, 131072
  ds_read_b64_tr_b16 v[230:231], v24 offset:6144
  v_add_u32 v55, 8192, v55
  v_mfma_f32_16x16x32_bf16 v[124:127], v[244:247], a[160:163], v[124:127]
  ds_read_b64_tr_b16 v[232:233], v24 offset:8192
  v_add_u32 v43, v55, v50
  v_mfma_f32_16x16x32_bf16 v[108:111], v[244:247], a[156:159], v[108:111]
  ds_read_b64_tr_b16 v[234:235], v24 offset:10240
  v_mul_i32_i24 v55, -8192, v54
  v_mfma_f32_16x16x32_bf16 v[108:111], v[240:243], a[148:151], v[108:111]
  buffer_load_dwordx4 v14, s[16:19], s61 offen offset:0 lds
  v_mfma_f32_16x16x32_bf16 v[108:111], v[236:239], a[248:251], v[108:111]
  v_add_u32 v55, 12288, v55
  v_lshrrev_b32 v32, 1, v50
  v_mfma_f32_16x16x32_bf16 v[92:95], v[236:239], v[220:223], v[92:95]
  v_add_u32 v44, v55, v50
  v_lshl_add_u32 v32, v54, 30, v32
  v_mfma_f32_16x16x32_bf16 v[92:95], v[240:243], a[172:175], v[92:95]
  v_and_b32 v55, 7, v0
  v_xor_b32 v33, 2.0, v32
  v_mfma_f32_16x16x32_bf16 v[92:95], v[244:247], a[180:183], v[92:95]
  v_xor_b32 v12, s56, v55
  v_and_b32 v56, 15, v0
  v_mfma_f32_16x16x32_bf16 v[76:79], v[244:247], a[176:179], v[76:79]
  v_lshlrev_b32 v55, 2, v55
  v_mul_u32_u24 v56, 1152, v56
  v_mfma_f32_16x16x32_bf16 v[76:79], v[240:243], a[168:171], v[76:79]
  v_lshl_add_u32 v12, v12, 8, v55
  v_lshl_add_u32 v13, s56, 8, v55
  v_mfma_f32_16x16x32_bf16 v[76:79], v[236:239], v[216:219], v[76:79]
  s_waitcnt lgkmcnt(0)
  ds_read_b64_tr_b16 v[236:237], v25 offset:0
  ds_read_b64_tr_b16 v[238:239], v25 offset:2048
  v_mfma_f32_16x16x32_bf16 v[64:67], v[224:227], a[184:187], v[64:67]
  ds_read_b64_tr_b16 v[240:241], v25 offset:4096
  v_bfe_u32 v57, v0, 4, 2
  v_mfma_f32_16x16x32_bf16 v[64:67], v[228:231], a[196:199], v[64:67]
  ds_read_b64_tr_b16 v[242:243], v25 offset:6144
  v_lshl_add_u32 v56, v57, 3, v56
  v_mfma_f32_16x16x32_bf16 v[64:67], v[232:235], a[212:215], v[64:67]
  ds_read_b64_tr_b16 v[244:245], v25 offset:8192
  v_mul_u32_u24 v57, 256, v54
  v_mfma_f32_16x16x32_bf16 v[80:83], v[232:235], a[220:223], v[80:83]
  ds_read_b64_tr_b16 v[246:247], v25 offset:10240
  v_add_u32 v57, 0, v57
  v_mfma_f32_16x16x32_bf16 v[80:83], v[228:231], a[204:207], v[80:83]
  buffer_load_dwordx4 v15, s[16:19], s61 offen offset:1024 lds
  v_mfma_f32_16x16x32_bf16 v[80:83], v[224:227], a[188:191], v[80:83]
  v_add_u32 v7, v57, v56
  v_mfma_f32_16x16x32_bf16 v[96:99], v[224:227], a[164:167], v[96:99]
  v_mul_u32_u24 v57, 192, v54
  v_mfma_f32_16x16x32_bf16 v[96:99], v[228:231], a[200:203], v[96:99]
  v_add_u32 v57, 32, v57
  v_mfma_f32_16x16x32_bf16 v[96:99], v[232:235], a[216:219], v[96:99]
  buffer_load_dwordx4 v16, s[16:19], s61 offen offset:2048 lds
  v_mfma_f32_16x16x32_bf16 v[112:115], v[232:235], a[144:147], v[112:115]
  v_add_u32 v8, v57, v56
  v_mfma_f32_16x16x32_bf16 v[112:115], v[228:231], a[208:211], v[112:115]
  v_mul_u32_u24 v57, 128, v54
  v_mfma_f32_16x16x32_bf16 v[112:115], v[224:227], a[192:195], v[112:115]
  s_waitcnt lgkmcnt(0)
  ds_read_b64_tr_b16 v[224:225], v26 offset:0
  ds_read_b64_tr_b16 v[226:227], v26 offset:2048
  v_mfma_f32_16x16x32_bf16 v[116:119], v[236:239], a[192:195], v[116:119]
  s_add_u32 s61, s80, 1990784
  ds_read_b64_tr_b16 v[228:229], v26 offset:4096
  v_add_u32 v57, 64, v57
  v_mfma_f32_16x16x32_bf16 v[116:119], v[240:243], a[208:211], v[116:119]
  s_add_u32 m0, s63, 134144
  ds_read_b64_tr_b16 v[230:231], v26 offset:6144
  v_add_u32 v9, v57, v56
  v_mfma_f32_16x16x32_bf16 v[116:119], v[244:247], a[144:147], v[116:119]
  ds_read_b64_tr_b16 v[232:233], v26 offset:8192
  v_mul_u32_u24 v57, 64, v54
  v_mfma_f32_16x16x32_bf16 v[100:103], v[244:247], a[216:219], v[100:103]
  ds_read_b64_tr_b16 v[234:235], v26 offset:10240
  v_add_u32 v57, 96, v57
  v_mfma_f32_16x16x32_bf16 v[100:103], v[240:243], a[200:203], v[100:103]
  buffer_load_dwordx4 v14, s[16:19], s61 offen offset:0 lds
  v_mfma_f32_16x16x32_bf16 v[100:103], v[236:239], a[164:167], v[100:103]
  v_add_u32 v10, v57, v56
  v_mfma_f32_16x16x32_bf16 v[84:87], v[236:239], a[188:191], v[84:87]
  v_mul_u32_u24 v57, 4194304, v54
  v_mfma_f32_16x16x32_bf16 v[84:87], v[240:243], a[204:207], v[84:87]
  v_add_u32 v57, 128, v57
  v_mfma_f32_16x16x32_bf16 v[84:87], v[244:247], a[220:223], v[84:87]
  buffer_store_dwordx4 v[148:151], v1, s[4:7], s66 offen offset:1024 sc1
  v_mfma_f32_16x16x32_bf16 v[68:71], v[244:247], a[212:215], v[68:71]
  v_add_u32 v11, v57, v56
  v_mfma_f32_16x16x32_bf16 v[68:71], v[240:243], a[196:199], v[68:71]
  v_mfma_f32_16x16x32_bf16 v[68:71], v[236:239], a[184:187], v[68:71]
  s_waitcnt lgkmcnt(0)
  ds_read_b64_tr_b16 v[236:237], v27 offset:0
  ds_read_b64_tr_b16 v[238:239], v27 offset:2048
  v_mfma_f32_16x16x32_bf16 v[72:75], v[224:227], a[184:187], v[72:75]
  ds_read_b64_tr_b16 v[240:241], v27 offset:4096
  v_mfma_f32_16x16x32_bf16 v[72:75], v[228:231], a[196:199], v[72:75]
  ds_read_b64_tr_b16 v[242:243], v27 offset:6144
  v_mfma_f32_16x16x32_bf16 v[72:75], v[232:235], a[212:215], v[72:75]
  ds_read_b64_tr_b16 v[244:245], v27 offset:8192
  v_mfma_f32_16x16x32_bf16 v[88:91], v[232:235], a[220:223], v[88:91]
  ds_read_b64_tr_b16 v[246:247], v27 offset:10240
  v_mfma_f32_16x16x32_bf16 v[88:91], v[228:231], a[204:207], v[88:91]
  buffer_load_dwordx4 v15, s[16:19], s61 offen offset:1024 lds
  v_mfma_f32_16x16x32_bf16 v[88:91], v[224:227], a[188:191], v[88:91]
  v_mfma_f32_16x16x32_bf16 v[104:107], v[224:227], a[164:167], v[104:107]
  v_mfma_f32_16x16x32_bf16 v[104:107], v[228:231], a[200:203], v[104:107]
  v_mfma_f32_16x16x32_bf16 v[104:107], v[232:235], a[216:219], v[104:107]
  buffer_load_dwordx4 v16, s[16:19], s61 offen offset:2048 lds
  v_mfma_f32_16x16x32_bf16 v[120:123], v[232:235], a[144:147], v[120:123]
  v_mfma_f32_16x16x32_bf16 v[120:123], v[228:231], a[208:211], v[120:123]
  v_mfma_f32_16x16x32_bf16 v[120:123], v[224:227], a[192:195], v[120:123]
  s_waitcnt lgkmcnt(0)
  ds_read_b64_tr_b16 v[224:225], v24 offset:12288
  ds_read_b64_tr_b16 v[226:227], v24 offset:14336
  v_mfma_f32_16x16x32_bf16 v[124:127], v[236:239], a[192:195], v[124:127]
  ds_read_b64_tr_b16 v[228:229], v24 offset:16384
  v_mfma_f32_16x16x32_bf16 v[124:127], v[240:243], a[208:211], v[124:127]
  ds_read_b64_tr_b16 v[230:231], v24 offset:18432
  v_mfma_f32_16x16x32_bf16 v[124:127], v[244:247], a[144:147], v[124:127]
  ds_read_b64_tr_b16 v[232:233], v24 offset:20480
  v_mfma_f32_16x16x32_bf16 v[108:111], v[244:247], a[216:219], v[108:111]
  ds_read_b64_tr_b16 v[234:235], v24 offset:22528
  v_mfma_f32_16x16x32_bf16 v[108:111], v[240:243], a[200:203], v[108:111]
  buffer_store_dwordx4 v[160:163], v2, s[4:7], s65 offen offset:0 sc1
  v_mfma_f32_16x16x32_bf16 v[108:111], v[236:239], a[164:167], v[108:111]
  v_mfma_f32_16x16x32_bf16 v[92:95], v[236:239], a[188:191], v[92:95]
  v_mfma_f32_16x16x32_bf16 v[92:95], v[240:243], a[204:207], v[92:95]
  buffer_load_dword v59, off, s[84:87], 4 sc1
  v_mfma_f32_16x16x32_bf16 v[92:95], v[244:247], a[220:223], v[92:95]
  v_mfma_f32_16x16x32_bf16 v[76:79], v[244:247], a[212:215], v[76:79]
  v_mfma_f32_16x16x32_bf16 v[76:79], v[240:243], a[196:199], v[76:79]
  buffer_store_dwordx4 v[164:167], v2, s[4:7], s66 offen offset:0 sc1
  v_mfma_f32_16x16x32_bf16 v[76:79], v[236:239], a[184:187], v[76:79]
  s_waitcnt lgkmcnt(0)
  ds_read_b64_tr_b16 v[236:237], v25 offset:12288
  ds_read_b64_tr_b16 v[238:239], v25 offset:14336
  v_mfma_f32_16x16x32_bf16 v[64:67], v[224:227], a[128:131], v[64:67]
  ds_read_b64_tr_b16 v[240:241], v25 offset:16384
  v_mfma_f32_16x16x32_bf16 v[64:67], v[228:231], a[0:3], v[64:67]
  ds_read_b64_tr_b16 v[242:243], v25 offset:18432
  v_mfma_f32_16x16x32_bf16 v[64:67], v[232:235], a[8:11], v[64:67]
  ds_read_b64_tr_b16 v[244:245], v25 offset:20480
  v_mfma_f32_16x16x32_bf16 v[80:83], v[232:235], a[12:15], v[80:83]
  ds_read_b64_tr_b16 v[246:247], v25 offset:22528
  v_mfma_f32_16x16x32_bf16 v[80:83], v[228:231], a[4:7], v[80:83]
  v_mfma_f32_16x16x32_bf16 v[80:83], v[224:227], a[136:139], v[80:83]
  v_mfma_f32_16x16x32_bf16 v[96:99], v[224:227], a[132:135], v[96:99]
  v_mfma_f32_16x16x32_bf16 v[96:99], v[228:231], a[16:19], v[96:99]
  v_mfma_f32_16x16x32_bf16 v[96:99], v[232:235], a[24:27], v[96:99]
  v_mfma_f32_16x16x32_bf16 v[112:115], v[232:235], a[28:31], v[112:115]
  v_mfma_f32_16x16x32_bf16 v[112:115], v[228:231], a[20:23], v[112:115]
  v_mfma_f32_16x16x32_bf16 v[112:115], v[224:227], a[140:143], v[112:115]
  s_waitcnt lgkmcnt(0)
  ds_read_b64_tr_b16 v[224:225], v26 offset:12288
  ds_read_b64_tr_b16 v[226:227], v26 offset:14336
  v_mfma_f32_16x16x32_bf16 v[116:119], v[236:239], a[140:143], v[116:119]
  ds_read_b64_tr_b16 v[228:229], v26 offset:16384
  v_mfma_f32_16x16x32_bf16 v[116:119], v[240:243], a[20:23], v[116:119]
  ds_read_b64_tr_b16 v[230:231], v26 offset:18432
  v_mfma_f32_16x16x32_bf16 v[116:119], v[244:247], a[28:31], v[116:119]
  ds_read_b64_tr_b16 v[232:233], v26 offset:20480
  v_mfma_f32_16x16x32_bf16 v[100:103], v[244:247], a[24:27], v[100:103]
  ds_read_b64_tr_b16 v[234:235], v26 offset:22528
  v_mfma_f32_16x16x32_bf16 v[100:103], v[240:243], a[16:19], v[100:103]
  buffer_store_dwordx4 v[176:179], v2, s[4:7], s65 offen offset:1024 sc1
  v_mfma_f32_16x16x32_bf16 v[100:103], v[236:239], a[132:135], v[100:103]
  v_mfma_f32_16x16x32_bf16 v[84:87], v[236:239], a[136:139], v[84:87]
  v_mfma_f32_16x16x32_bf16 v[84:87], v[240:243], a[4:7], v[84:87]
  v_mfma_f32_16x16x32_bf16 v[84:87], v[244:247], a[12:15], v[84:87]
  v_mfma_f32_16x16x32_bf16 v[68:71], v[244:247], a[8:11], v[68:71]
  v_mfma_f32_16x16x32_bf16 v[68:71], v[240:243], a[0:3], v[68:71]
  v_mfma_f32_16x16x32_bf16 v[68:71], v[236:239], a[128:131], v[68:71]
  s_waitcnt lgkmcnt(0)
  ds_read_b64_tr_b16 v[236:237], v27 offset:12288
  ds_read_b64_tr_b16 v[238:239], v27 offset:14336
  v_mfma_f32_16x16x32_bf16 v[72:75], v[224:227], a[128:131], v[72:75]
  ds_read_b64_tr_b16 v[240:241], v27 offset:16384
  v_mfma_f32_16x16x32_bf16 v[72:75], v[228:231], a[0:3], v[72:75]
  ds_read_b64_tr_b16 v[242:243], v27 offset:18432
  v_mfma_f32_16x16x32_bf16 v[72:75], v[232:235], a[8:11], v[72:75]
  ds_read_b64_tr_b16 v[244:245], v27 offset:20480
  v_mfma_f32_16x16x32_bf16 v[88:91], v[232:235], a[12:15], v[88:91]
  ds_read_b64_tr_b16 v[246:247], v27 offset:22528
  v_mfma_f32_16x16x32_bf16 v[88:91], v[228:231], a[4:7], v[88:91]
  v_mfma_f32_16x16x32_bf16 v[88:91], v[224:227], a[136:139], v[88:91]
  v_mfma_f32_16x16x32_bf16 v[104:107], v[224:227], a[132:135], v[104:107]
  v_mfma_f32_16x16x32_bf16 v[104:107], v[228:231], a[16:19], v[104:107]
  v_mfma_f32_16x16x32_bf16 v[104:107], v[232:235], a[24:27], v[104:107]
  v_mfma_f32_16x16x32_bf16 v[120:123], v[232:235], a[28:31], v[120:123]
  v_mfma_f32_16x16x32_bf16 v[120:123], v[228:231], a[20:23], v[120:123]
  buffer_store_dwordx4 v[180:183], v2, s[4:7], s66 offen offset:1024 sc1
  v_mfma_f32_16x16x32_bf16 v[120:123], v[224:227], a[140:143], v[120:123]
  s_waitcnt vmcnt(22) lgkmcnt(0)
  s_barrier
  ds_read_b64_tr_b16 v[224:225], v20 offset:0
  v_mfma_f32_16x16x32_bf16 v[124:127], v[236:239], a[140:143], v[124:127]
  s_add_u32 s61, s80, 3539072
  ds_read_b64_tr_b16 v[226:227], v20 offset:2048
  ds_read_b64_tr_b16 v[228:229], v20 offset:4096
  v_mfma_f32_16x16x32_bf16 v[124:127], v[240:243], a[20:23], v[124:127]
  s_add_u32 m0, s63, 106496
  ds_read_b64_tr_b16 v[230:231], v20 offset:6144
  v_mfma_f32_16x16x32_bf16 v[124:127], v[244:247], a[28:31], v[124:127]
  ds_read_b64_tr_b16 v[232:233], v20 offset:8192
  v_mfma_f32_16x16x32_bf16 v[108:111], v[244:247], a[24:27], v[108:111]
  ds_read_b64_tr_b16 v[234:235], v20 offset:10240
  v_mfma_f32_16x16x32_bf16 v[108:111], v[240:243], a[16:19], v[108:111]
  buffer_load_dwordx4 v14, s[16:19], s61 offen offset:0 lds
  v_mfma_f32_16x16x32_bf16 v[108:111], v[236:239], a[132:135], v[108:111]
  v_mfma_f32_16x16x32_bf16 v[92:95], v[236:239], a[136:139], v[92:95]
  v_mfma_f32_16x16x32_bf16 v[92:95], v[240:243], a[4:7], v[92:95]
  v_mfma_f32_16x16x32_bf16 v[92:95], v[244:247], a[12:15], v[92:95]
  v_mfma_f32_16x16x32_bf16 v[76:79], v[244:247], a[8:11], v[76:79]
  v_mfma_f32_16x16x32_bf16 v[76:79], v[240:243], a[0:3], v[76:79]
  v_mfma_f32_16x16x32_bf16 v[76:79], v[236:239], a[128:131], v[76:79]
  s_waitcnt lgkmcnt(0)
  ds_read_b64_tr_b16 v[236:237], v21 offset:0
  ds_read_b64_tr_b16 v[238:239], v21 offset:2048
  v_mfma_f32_16x16x32_bf16 v[64:67], v[224:227], a[32:35], v[64:67]
  ds_read_b64_tr_b16 v[240:241], v21 offset:4096
  v_mfma_f32_16x16x32_bf16 v[64:67], v[228:231], a[40:43], v[64:67]
  ds_read_b64_tr_b16 v[242:243], v21 offset:6144
  v_mfma_f32_16x16x32_bf16 v[64:67], v[232:235], a[64:67], v[64:67]
  ds_read_b64_tr_b16 v[244:245], v21 offset:8192
  v_mfma_f32_16x16x32_bf16 v[80:83], v[232:235], a[68:71], v[80:83]
  ds_read_b64_tr_b16 v[246:247], v21 offset:10240
  v_mfma_f32_16x16x32_bf16 v[80:83], v[228:231], a[44:47], v[80:83]
  buffer_load_dwordx4 v15, s[16:19], s61 offen offset:1024 lds
  v_mfma_f32_16x16x32_bf16 v[80:83], v[224:227], a[36:39], v[80:83]
  v_mfma_f32_16x16x32_bf16 v[96:99], v[224:227], a[48:51], v[96:99]
  v_mfma_f32_16x16x32_bf16 v[96:99], v[228:231], a[56:59], v[96:99]
  v_mfma_f32_16x16x32_bf16 v[96:99], v[232:235], a[80:83], v[96:99]
  buffer_load_dwordx4 v16, s[16:19], s61 offen offset:2048 lds
  v_mfma_f32_16x16x32_bf16 v[112:115], v[232:235], a[84:87], v[112:115]
  v_mfma_f32_16x16x32_bf16 v[112:115], v[228:231], a[60:63], v[112:115]
  v_mfma_f32_16x16x32_bf16 v[112:115], v[224:227], a[52:55], v[112:115]
  s_waitcnt lgkmcnt(0)
  ds_read_b64_tr_b16 v[224:225], v22 offset:0
  ds_read_b64_tr_b16 v[226:227], v22 offset:2048
  v_mfma_f32_16x16x32_bf16 v[116:119], v[236:239], a[52:55], v[116:119]
  s_add_u32 s61, s80, 3760256
  ds_read_b64_tr_b16 v[228:229], v22 offset:4096
  v_mfma_f32_16x16x32_bf16 v[116:119], v[240:243], a[60:63], v[116:119]
  s_add_u32 m0, s63, 109568
  ds_read_b64_tr_b16 v[230:231], v22 offset:6144
  v_mfma_f32_16x16x32_bf16 v[116:119], v[244:247], a[84:87], v[116:119]
  ds_read_b64_tr_b16 v[232:233], v22 offset:8192
  v_mfma_f32_16x16x32_bf16 v[100:103], v[244:247], a[80:83], v[100:103]
  ds_read_b64_tr_b16 v[234:235], v22 offset:10240
  v_mfma_f32_16x16x32_bf16 v[100:103], v[240:243], a[56:59], v[100:103]
  buffer_load_dwordx4 v14, s[16:19], s61 offen offset:0 lds
  v_mfma_f32_16x16x32_bf16 v[100:103], v[236:239], a[48:51], v[100:103]
  s_waitcnt vmcnt(7)
  v_readfirstlane_b32 s73, v59
  s_nop 0
  s_cmp_ge_u32 s73, 256
  s_cbranch_scc0 spin_g
back_g:
  v_mfma_f32_16x16x32_bf16 v[84:87], v[236:239], a[36:39], v[84:87]
  v_mfma_f32_16x16x32_bf16 v[84:87], v[240:243], a[44:47], v[84:87]
  v_mfma_f32_16x16x32_bf16 v[84:87], v[244:247], a[68:71], v[84:87]
  v_mfma_f32_16x16x32_bf16 v[68:71], v[244:247], a[64:67], v[68:71]
  v_mfma_f32_16x16x32_bf16 v[68:71], v[240:243], a[40:43], v[68:71]
  v_mfma_f32_16x16x32_bf16 v[68:71], v[236:239], a[32:35], v[68:71]
  s_waitcnt lgkmcnt(0)
  ds_read_b64_tr_b16 v[236:237], v23 offset:0
  ds_read_b64_tr_b16 v[238:239], v23 offset:2048
  v_mfma_f32_16x16x32_bf16 v[72:75], v[224:227], a[32:35], v[72:75]
  ds_read_b64_tr_b16 v[240:241], v23 offset:4096
  v_add_co_u32 v60, vcc, (att_retry-att_last-8192)/36*4, v60
  v_mfma_f32_16x16x32_bf16 v[72:75], v[228:231], a[40:43], v[72:75]
  ds_read_b64_tr_b16 v[242:243], v23 offset:6144
  v_addc_co_u32 v61, vcc, 0, v61, vcc
  v_mfma_f32_16x16x32_bf16 v[72:75], v[232:235], a[64:67], v[72:75]
  ds_read_b64_tr_b16 v[244:245], v23 offset:8192
  v_mfma_f32_16x16x32_bf16 v[88:91], v[232:235], a[68:71], v[88:91]
  ds_read_b64_tr_b16 v[246:247], v23 offset:10240
  v_mfma_f32_16x16x32_bf16 v[88:91], v[228:231], a[44:47], v[88:91]
  buffer_load_dwordx4 v15, s[16:19], s61 offen offset:1024 lds
  v_mfma_f32_16x16x32_bf16 v[88:91], v[224:227], a[36:39], v[88:91]
  v_mfma_f32_16x16x32_bf16 v[104:107], v[224:227], a[48:51], v[104:107]
  v_mfma_f32_16x16x32_bf16 v[104:107], v[228:231], a[56:59], v[104:107]
  v_mfma_f32_16x16x32_bf16 v[104:107], v[232:235], a[80:83], v[104:107]
  buffer_load_dwordx4 v16, s[16:19], s61 offen offset:2048 lds
  v_mfma_f32_16x16x32_bf16 v[120:123], v[232:235], a[84:87], v[120:123]
  v_mfma_f32_16x16x32_bf16 v[120:123], v[228:231], a[60:63], v[120:123]
  v_mfma_f32_16x16x32_bf16 v[120:123], v[224:227], a[52:55], v[120:123]
  s_waitcnt lgkmcnt(0)
  ds_read_b64_tr_b16 v[224:225], v20 offset:12288
  ds_read_b64_tr_b16 v[226:227], v20 offset:14336
  v_mfma_f32_16x16x32_bf16 v[124:127], v[236:239], a[52:55], v[124:127]
  ds_read_b64_tr_b16 v[228:229], v20 offset:16384
  v_mfma_f32_16x16x32_bf16 v[124:127], v[240:243], a[60:63], v[124:127]
  ds_read_b64_tr_b16 v[230:231], v20 offset:18432
  global_load_dword v62, v[60:61], off
  v_mfma_f32_16x16x32_bf16 v[124:127], v[244:247], a[84:87], v[124:127]
  s_mov_b32 s89, s41
  ds_read_b64_tr_b16 v[232:233], v20 offset:20480
  v_mfma_f32_16x16x32_bf16 v[108:111], v[244:247], a[80:83], v[108:111]
  s_add_u32 m0, s44, 49152
  ds_read_b64_tr_b16 v[234:235], v20 offset:22528
  v_mfma_f32_16x16x32_bf16 v[108:111], v[240:243], a[56:59], v[108:111]
  v_mfma_f32_16x16x32_bf16 v[108:111], v[236:239], a[48:51], v[108:111]
  buffer_load_dwordx4 v36, s[4:7], s89 offen offset:0 sc1 lds
  v_mfma_f32_16x16x32_bf16 v[92:95], v[236:239], a[36:39], v[92:95]
  v_mfma_f32_16x16x32_bf16 v[92:95], v[240:243], a[44:47], v[92:95]
  v_mfma_f32_16x16x32_bf16 v[92:95], v[244:247], a[68:71], v[92:95]
  v_mfma_f32_16x16x32_bf16 v[76:79], v[244:247], a[64:67], v[76:79]
  buffer_load_dwordx4 v37, s[4:7], s89 offen offset:1024 sc1 lds
  v_mfma_f32_16x16x32_bf16 v[76:79], v[240:243], a[40:43], v[76:79]
  v_mfma_f32_16x16x32_bf16 v[76:79], v[236:239], a[32:35], v[76:79]
  s_waitcnt lgkmcnt(0)
  ds_read_b64_tr_b16 v[236:237], v21 offset:12288
  ds_read_b64_tr_b16 v[238:239], v21 offset:14336
  v_mfma_f32_16x16x32_bf16 v[64:67], v[224:227], a[72:75], v[64:67]
  ds_read_b64_tr_b16 v[240:241], v21 offset:16384
  v_mfma_f32_16x16x32_bf16 v[64:67], v[228:231], a[96:99], v[64:67]
  ds_read_b64_tr_b16 v[242:243], v21 offset:18432
  v_mfma_f32_16x16x32_bf16 v[64:67], v[232:235], a[104:107], v[64:67]
  ds_read_b64_tr_b16 v[244:245], v21 offset:20480
  v_mfma_f32_16x16x32_bf16 v[80:83], v[232:235], a[108:111], v[80:83]
  ds_read_b64_tr_b16 v[246:247], v21 offset:22528
  v_mfma_f32_16x16x32_bf16 v[80:83], v[228:231], a[100:103], v[80:83]
  buffer_load_dwordx4 v38, s[4:7], s89 offen offset:2048 sc1 lds
  v_mfma_f32_16x16x32_bf16 v[80:83], v[224:227], a[76:79], v[80:83]
  v_mfma_f32_16x16x32_bf16 v[96:99], v[224:227], a[88:91], v[96:99]
  v_mfma_f32_16x16x32_bf16 v[96:99], v[228:231], a[112:115], v[96:99]
  buffer_load_dwordx4 v39, s[4:7], s89 offen offset:3072 sc1 lds
  v_mfma_f32_16x16x32_bf16 v[96:99], v[232:235], a[120:123], v[96:99]
  s_add_u32 m0, s44, 53248
  v_mfma_f32_16x16x32_bf16 v[112:115], v[232:235], a[124:127], v[112:115]
  v_mfma_f32_16x16x32_bf16 v[112:115], v[228:231], a[116:119], v[112:115]
  v_mul_f32 v64, s72, v64
  v_mul_f32 v65, s72, v65
  v_mfma_f32_16x16x32_bf16 v[112:115], v[224:227], a[92:95], v[112:115]
  s_waitcnt lgkmcnt(0)
  ds_read_b64_tr_b16 v[224:225], v22 offset:12288
  ds_read_b64_tr_b16 v[226:227], v22 offset:14336
  v_mfma_f32_16x16x32_bf16 v[116:119], v[236:239], a[92:95], v[116:119]
  ds_read_b64_tr_b16 v[228:229], v22 offset:16384
  v_mul_f32 v66, s72, v66
  v_mfma_f32_16x16x32_bf16 v[116:119], v[240:243], a[116:119], v[116:119]
  ds_read_b64_tr_b16 v[230:231], v22 offset:18432
  v_mul_f32 v67, s72, v67
  v_mfma_f32_16x16x32_bf16 v[116:119], v[244:247], a[124:127], v[116:119]
  ds_read_b64_tr_b16 v[232:233], v22 offset:20480
  v_mul_f32 v80, s72, v80
  v_mfma_f32_16x16x32_bf16 v[100:103], v[244:247], a[120:123], v[100:103]
  ds_read_b64_tr_b16 v[234:235], v22 offset:22528
  v_mul_f32 v81, s72, v81
  v_mfma_f32_16x16x32_bf16 v[100:103], v[240:243], a[112:115], v[100:103]
  buffer_load_dwordx4 v40, s[4:7], s89 offen offset:0 sc1 lds
  v_mfma_f32_16x16x32_bf16 v[100:103], v[236:239], a[88:91], v[100:103]
  v_mul_f32 v82, s72, v82
  v_mul_f32 v83, s72, v83
  v_mfma_f32_16x16x32_bf16 v[84:87], v[236:239], a[76:79], v[84:87]
  v_exp_f32 v64, v64
  v_mfma_f32_16x16x32_bf16 v[84:87], v[240:243], a[100:103], v[84:87]
  buffer_load_dwordx4 v41, s[4:7], s89 offen offset:1024 sc1 lds
  v_mfma_f32_16x16x32_bf16 v[84:87], v[244:247], a[108:111], v[84:87]
  v_exp_f32 v65, v65
  v_mfma_f32_16x16x32_bf16 v[68:71], v[244:247], a[104:107], v[68:71]
  v_exp_f32 v66, v66
  v_mfma_f32_16x16x32_bf16 v[68:71], v[240:243], a[96:99], v[68:71]
  buffer_load_dwordx4 v42, s[4:7], s89 offen offset:2048 sc1 lds
  v_mfma_f32_16x16x32_bf16 v[68:71], v[236:239], a[72:75], v[68:71]
  s_waitcnt lgkmcnt(0)
  ds_read_b64_tr_b16 v[236:237], v23 offset:12288
  ds_read_b64_tr_b16 v[238:239], v23 offset:14336
  v_mfma_f32_16x16x32_bf16 v[72:75], v[224:227], a[72:75], v[72:75]
  ds_read_b64_tr_b16 v[240:241], v23 offset:16384
  v_add_f32 v64, 1.0, v64
  v_mfma_f32_16x16x32_bf16 v[72:75], v[228:231], a[96:99], v[72:75]
  ds_read_b64_tr_b16 v[242:243], v23 offset:18432
  v_add_f32 v65, 1.0, v65
  v_mfma_f32_16x16x32_bf16 v[72:75], v[232:235], a[104:107], v[72:75]
  ds_read_b64_tr_b16 v[244:245], v23 offset:20480
  v_add_f32 v66, 1.0, v66
  v_mfma_f32_16x16x32_bf16 v[88:91], v[232:235], a[108:111], v[88:91]
  ds_read_b64_tr_b16 v[246:247], v23 offset:22528
  v_mul_f32 v96, s72, v96
  v_mfma_f32_16x16x32_bf16 v[88:91], v[228:231], a[100:103], v[88:91]
  buffer_load_dwordx4 v43, s[4:7], s89 offen offset:3072 sc1 lds
  v_mfma_f32_16x16x32_bf16 v[88:91], v[224:227], a[76:79], v[88:91]
  s_add_u32 m0, s44, 57344
  v_exp_f32 v67, v67
  v_mfma_f32_16x16x32_bf16 v[104:107], v[224:227], a[88:91], v[104:107]
  v_exp_f32 v80, v80
  v_mfma_f32_16x16x32_bf16 v[104:107], v[228:231], a[112:115], v[104:107]
  buffer_load_dwordx4 v44, s[4:7], s89 offen offset:0 sc1 lds
  v_mfma_f32_16x16x32_bf16 v[104:107], v[232:235], a[120:123], v[104:107]
  v_exp_f32 v81, v81
  v_mfma_f32_16x16x32_bf16 v[120:123], v[232:235], a[124:127], v[120:123]
  v_exp_f32 v82, v82
  v_mfma_f32_16x16x32_bf16 v[120:123], v[228:231], a[116:119], v[120:123]
  v_exp_f32 v83, v83
  v_mfma_f32_16x16x32_bf16 v[120:123], v[224:227], a[92:95], v[120:123]
  s_waitcnt vmcnt(16) lgkmcnt(0)
  s_barrier
  ds_read_b64_tr_b16 v[224:225], v20 offset:24576
  v_mfma_f32_16x16x32_bf16 v[124:127], v[236:239], a[92:95], v[124:127]
  s_cmp_eq_u32 s57, 0
  s_cbranch_scc0 sigd_a
  v_mov_b32 v58, s35
  s_mov_b64 exec, 1
  buffer_atomic_add v58, off, s[4:7], s46 sc1
  s_mov_b64 exec, -1
  s_nop 3
sigd_a:
  ds_read_b64_tr_b16 v[226:227], v20 offset:26624
  v_mfma_f32_16x16x32_bf16 v[124:127], v[240:243], a[116:119], v[124:127]
  s_add_u32 s61, s81, 0
  ds_read_b64_tr_b16 v[228:229], v20 offset:28672
  ds_read_b64_tr_b16 v[230:231], v20 offset:30720
  v_mfma_f32_16x16x32_bf16 v[124:127], v[244:247], a[124:127], v[124:127]
  s_add_u32 m0, s64, 0
  ds_read_b64_tr_b16 v[232:233], v20 offset:32768
  v_add_f32 v67, 1.0, v67
  v_mfma_f32_16x16x32_bf16 v[108:111], v[244:247], a[120:123], v[108:111]
  ds_read_b64_tr_b16 v[234:235], v20 offset:34816
  v_add_f32 v80, 1.0, v80
  v_mfma_f32_16x16x32_bf16 v[108:111], v[240:243], a[112:115], v[108:111]
  buffer_load_dwordx4 v17, s[12:15], s61 offen offset:0 lds
  v_mfma_f32_16x16x32_bf16 v[108:111], v[236:239], a[88:91], v[108:111]
  v_add_f32 v81, 1.0, v81
  v_add_f32 v82, 1.0, v82
  v_mfma_f32_16x16x32_bf16 v[92:95], v[236:239], a[76:79], v[92:95]
  v_add_f32 v83, 1.0, v83
  v_mul_f32 v97, s72, v97
  v_mfma_f32_16x16x32_bf16 v[92:95], v[240:243], a[100:103], v[92:95]
  v_rcp_f32 v64, v64
  v_mfma_f32_16x16x32_bf16 v[92:95], v[244:247], a[108:111], v[92:95]
  v_rcp_f32 v65, v65
  v_mfma_f32_16x16x32_bf16 v[76:79], v[244:247], a[104:107], v[76:79]
  v_rcp_f32 v66, v66
  v_mfma_f32_16x16x32_bf16 v[76:79], v[240:243], a[96:99], v[76:79]
  v_rcp_f32 v67, v67
  v_mfma_f32_16x16x32_bf16 v[76:79], v[236:239], a[72:75], v[76:79]
  s_waitcnt lgkmcnt(0)
  ds_read_b64_tr_b16 v[236:237], v21 offset:24576
  ds_read_b64_tr_b16 v[238:239], v21 offset:26624
  v_mfma_f32_16x16x32_bf16 v[128:131], v[224:227], v[192:195], 0
  ds_read_b64_tr_b16 v[240:241], v21 offset:28672
  v_lshrrev_b32 v56, 2, v50
  v_mfma_f32_16x16x32_bf16 v[128:131], v[228:231], v[200:203], v[128:131]
  ds_read_b64_tr_b16 v[242:243], v21 offset:30720
  v_mul_f32 v98, s72, v98
  v_mfma_f32_16x16x32_bf16 v[128:131], v[232:235], v[208:211], v[128:131]
pad_m_13:
  s_cbranch_execz warm_3
  ds_read_b64_tr_b16 v[244:245], v21 offset:32768
  v_mul_f32 v99, s72, v99
  v_mfma_f32_16x16x32_bf16 v[144:147], v[232:235], v[212:215], 0
  ds_read_b64_tr_b16 v[246:247], v21 offset:34816
  v_mul_f32 v112, s72, v112
  v_mfma_f32_16x16x32_bf16 v[144:147], v[228:231], v[204:207], v[144:147]
  buffer_load_dwordx4 v18, s[12:15], s61 offen offset:1024 lds
  v_mfma_f32_16x16x32_bf16 v[144:147], v[224:227], v[196:199], v[144:147]
  v_rcp_f32 v80, v80
  v_mfma_f32_16x16x32_bf16 v[160:163], v[224:227], a[224:227], 0
  v_rcp_f32 v81, v81
  v_mfma_f32_16x16x32_bf16 v[160:163], v[228:231], a[232:235], v[160:163]
  v_rcp_f32 v82, v82
  v_mfma_f32_16x16x32_bf16 v[160:163], v[232:235], a[240:243], v[160:163]
  v_rcp_f32 v83, v83
  v_mfma_f32_16x16x32_bf16 v[176:179], v[232:235], a[244:247], 0
  v_mul_f32 v113, s72, v113
  v_mul_f32 v114, s72, v114
  v_mfma_f32_16x16x32_bf16 v[176:179], v[228:231], a[236:239], v[176:179]
  v_mul_f32 v115, s72, v115
  v_mul_f32 v68, s72, v68
  v_mfma_f32_16x16x32_bf16 v[176:179], v[224:227], a[228:231], v[176:179]
  s_waitcnt lgkmcnt(0)
  ds_read_b64_tr_b16 v[224:225], v22 offset:24576
  ds_read_b64_tr_b16 v[226:227], v22 offset:26624
  v_mfma_f32_16x16x32_bf16 v[180:183], v[236:239], a[228:231], 0
  ds_read_b64_tr_b16 v[228:229], v22 offset:28672
  v_mul_f32 v69, s72, v69
  v_mfma_f32_16x16x32_bf16 v[180:183], v[240:243], a[236:239], v[180:183]
  ds_read_b64_tr_b16 v[230:231], v22 offset:30720
  v_mul_f32 v70, s72, v70
  v_mfma_f32_16x16x32_bf16 v[180:183], v[244:247], a[244:247], v[180:183]
  ds_read_b64_tr_b16 v[232:233], v22 offset:32768
  v_mul_f32 v71, s72, v71
  v_mfma_f32_16x16x32_bf16 v[164:167], v[244:247], a[240:243], 0
  ds_read_b64_tr_b16 v[234:235], v22 offset:34816
  v_mul_f32 v84, s72, v84
  v_mfma_f32_16x16x32_bf16 v[164:167], v[240:243], a[232:235], v[164:167]
  buffer_load_dwordx4 v19, s[12:15], s61 offen offset:2048 lds
  v_mfma_f32_16x16x32_bf16 v[164:167], v[236:239], a[224:227], v[164:167]
  v_exp_f32 v96, v96
  v_mfma_f32_16x16x32_bf16 v[148:151], v[236:239], v[196:199], 0
  v_exp_f32 v97, v97
  v_mfma_f32_16x16x32_bf16 v[148:151], v[240:243], v[204:207], v[148:151]
  v_exp_f32 v98, v98
  v_mfma_f32_16x16x32_bf16 v[148:151], v[244:247], v[212:215], v[148:151]
  v_exp_f32 v99, v99
  v_mfma_f32_16x16x32_bf16 v[132:135], v[244:247], v[208:211], 0
  s_add_u32 m0, s64, 12288
  v_exp_f32 v112, v112
  v_mfma_f32_16x16x32_bf16 v[132:135], v[240:243], v[200:203], v[132:135]
  v_exp_f32 v113, v113
  v_mfma_f32_16x16x32_bf16 v[132:135], v[236:239], v[192:195], v[132:135]
  s_waitcnt lgkmcnt(0)
  ds_read_b64_tr_b16 v[236:237], v23 offset:24576
  ds_read_b64_tr_b16 v[238:239], v23 offset:26624
  v_mfma_f32_16x16x32_bf16 v[136:139], v[224:227], v[192:195], 0
  ds_read_b64_tr_b16 v[240:241], v23 offset:28672
  v_add_f32 v96, 1.0, v96
  v_mfma_f32_16x16x32_bf16 v[136:139], v[228:231], v[200:203], v[136:139]
  ds_read_b64_tr_b16 v[242:243], v23 offset:30720
  v_add_f32 v97, 1.0, v97
  v_mfma_f32_16x16x32_bf16 v[136:139], v[232:235], v[208:211], v[136:139]
  ds_read_b64_tr_b16 v[244:245], v23 offset:32768
  v_add_f32 v98, 1.0, v98
  v_mfma_f32_16x16x32_bf16 v[152:155], v[232:235], v[212:215], 0
  ds_read_b64_tr_b16 v[246:247], v23 offset:34816
  v_add_f32 v99, 1.0, v99
  v_mfma_f32_16x16x32_bf16 v[152:155], v[228:231], v[204:207], v[152:155]
  buffer_load_dwordx4 v17, s[16:19], s61 offen offset:0 lds
  v_mfma_f32_16x16x32_bf16 v[152:155], v[224:227], v[196:199], v[152:155]
  v_exp_f32 v114, v114
  v_mfma_f32_16x16x32_bf16 v[168:171], v[224:227], a[224:227], 0
  v_exp_f32 v115, v115
  v_mfma_f32_16x16x32_bf16 v[168:171], v[228:231], a[232:235], v[168:171]
  v_add_f32 v112, 1.0, v112
  v_add_f32 v113, 1.0, v113
  v_mfma_f32_16x16x32_bf16 v[168:171], v[232:235], a[240:243], v[168:171]
  buffer_load_dword v59, v56, s[84:87], 0 offen sc1
  v_mfma_f32_16x16x32_bf16 v[184:187], v[232:235], a[244:247], 0
  v_add_f32 v114, 1.0, v114
  v_add_f32 v115, 1.0, v115
  v_mfma_f32_16x16x32_bf16 v[184:187], v[228:231], a[236:239], v[184:187]
  v_rcp_f32 v96, v96
  v_mfma_f32_16x16x32_bf16 v[184:187], v[224:227], a[228:231], v[184:187]
  s_waitcnt lgkmcnt(0)
  ds_read_b64_tr_b16 v[224:225], v20 offset:36864
  ds_read_b64_tr_b16 v[226:227], v20 offset:38912
  v_mfma_f32_16x16x32_bf16 v[188:191], v[236:239], a[228:231], 0
  ds_read_b64_tr_b16 v[228:229], v20 offset:40960
  v_mul_f32 v85, s72, v85
  v_mfma_f32_16x16x32_bf16 v[188:191], v[240:243], a[236:239], v[188:191]
  ds_read_b64_tr_b16 v[230:231], v20 offset:43008
  v_mul_f32 v86, s72, v86
  v_mfma_f32_16x16x32_bf16 v[188:191], v[244:247], a[244:247], v[188:191]
  ds_read_b64_tr_b16 v[232:233], v20 offset:45056
  v_mul_f32 v87, s72, v87
  v_mfma_f32_16x16x32_bf16 v[172:175], v[244:247], a[240:243], 0
  ds_read_b64_tr_b16 v[234:235], v20 offset:47104
  v_mul_f32 v100, s72, v100
  v_mfma_f32_16x16x32_bf16 v[172:175], v[240:243], a[232:235], v[172:175]
  buffer_load_dwordx4 v18, s[16:19], s61 offen offset:1024 lds
  v_mfma_f32_16x16x32_bf16 v[172:175], v[236:239], a[224:227], v[172:175]
  v_rcp_f32 v97, v97
  v_mfma_f32_16x16x32_bf16 v[156:159], v[236:239], v[196:199], 0
  v_rcp_f32 v98, v98
  v_mfma_f32_16x16x32_bf16 v[156:159], v[240:243], v[204:207], v[156:159]
  v_rcp_f32 v99, v99
  v_mfma_f32_16x16x32_bf16 v[156:159], v[244:247], v[212:215], v[156:159]
  v_rcp_f32 v112, v112
  v_mfma_f32_16x16x32_bf16 v[140:143], v[244:247], v[208:211], 0
  v_rcp_f32 v113, v113
  v_mfma_f32_16x16x32_bf16 v[140:143], v[240:243], v[200:203], v[140:143]
  buffer_load_dwordx4 v19, s[16:19], s61 offen offset:2048 lds
  v_mfma_f32_16x16x32_bf16 v[140:143], v[236:239], v[192:195], v[140:143]
  s_waitcnt lgkmcnt(0)
  ds_read_b64_tr_b16 v[236:237], v21 offset:36864
  ds_read_b64_tr_b16 v[238:239], v21 offset:38912
  v_mfma_f32_16x16x32_bf16 v[128:131], v[224:227], v[216:219], v[128:131]
  ds_read_b64_tr_b16 v[240:241], v21 offset:40960
  v_mul_f32 v101, s72, v101
  v_mfma_f32_16x16x32_bf16 v[128:131], v[228:231], a[168:171], v[128:131]
  ds_read_b64_tr_b16 v[242:243], v21 offset:43008
  v_mul_f32 v102, s72, v102
  v_mfma_f32_16x16x32_bf16 v[128:131], v[232:235], a[176:179], v[128:131]
  ds_read_b64_tr_b16 v[244:245], v21 offset:45056
  v_mul_f32 v103, s72, v103
  v_mfma_f32_16x16x32_bf16 v[144:147], v[232:235], a[180:183], v[144:147]
  ds_read_b64_tr_b16 v[246:247], v21 offset:47104
  v_mul_f32 v116, s72, v116
  v_mfma_f32_16x16x32_bf16 v[144:147], v[228:231], a[172:175], v[144:147]
  v_rcp_f32 v114, v114
  v_mfma_f32_16x16x32_bf16 v[144:147], v[224:227], v[220:223], v[144:147]
  v_rcp_f32 v115, v115
  v_mfma_f32_16x16x32_bf16 v[160:163], v[224:227], a[248:251], v[160:163]
  v_exp_f32 v68, v68
  v_mfma_f32_16x16x32_bf16 v[160:163], v[228:231], a[148:151], v[160:163]
  v_exp_f32 v69, v69
  v_mfma_f32_16x16x32_bf16 v[160:163], v[232:235], a[156:159], v[160:163]
  v_exp_f32 v70, v70
  v_mfma_f32_16x16x32_bf16 v[176:179], v[232:235], a[160:163], v[176:179]
  v_exp_f32 v71, v71
  v_mfma_f32_16x16x32_bf16 v[176:179], v[228:231], a[152:155], v[176:179]
  v_exp_f32 v84, v84
  v_mfma_f32_16x16x32_bf16 v[176:179], v[224:227], a[252:255], v[176:179]
  s_waitcnt lgkmcnt(0)
  ds_read_b64_tr_b16 v[224:225], v22 offset:36864
  ds_read_b64_tr_b16 v[226:227], v22 offset:38912
  v_mfma_f32_16x16x32_bf16 v[180:183], v[236:239], a[252:255], v[180:183]
  ds_read_b64_tr_b16 v[228:229], v22 offset:40960
  v_add_f32 v68, 1.0, v68
  v_mfma_f32_16x16x32_bf16 v[180:183], v[240:243], a[152:155], v[180:183]
  ds_read_b64_tr_b16 v[230:231], v22 offset:43008
  v_add_f32 v69, 1.0, v69
  v_mfma_f32_16x16x32_bf16 v[180:183], v[244:247], a[160:163], v[180:183]
  ds_read_b64_tr_b16 v[232:233], v22 offset:45056
  v_add_f32 v70, 1.0, v70
  v_mfma_f32_16x16x32_bf16 v[164:167], v[244:247], a[156:159], v[164:167]
  ds_read_b64_tr_b16 v[234:235], v22 offset:47104
  v_add_f32 v71, 1.0, v71
  v_mfma_f32_16x16x32_bf16 v[164:167], v[240:243], a[148:151], v[164:167]
  v_exp_f32 v85, v85
  v_mfma_f32_16x16x32_bf16 v[164:167], v[236:239], a[248:251], v[164:167]
  v_exp_f32 v86, v86
  v_mfma_f32_16x16x32_bf16 v[148:151], v[236:239], v[220:223], v[148:151]
  v_exp_f32 v87, v87
  v_mfma_f32_16x16x32_bf16 v[148:151], v[240:243], a[172:175], v[148:151]
  v_add_f32 v84, 1.0, v84
  v_add_f32 v85, 1.0, v85
  v_mfma_f32_16x16x32_bf16 v[148:151], v[244:247], a[180:183], v[148:151]
  v_add_f32 v86, 1.0, v86
  v_add_f32 v87, 1.0, v87
  v_mfma_f32_16x16x32_bf16 v[132:135], v[244:247], a[176:179], v[132:135]
  v_rcp_f32 v68, v68
  v_mfma_f32_16x16x32_bf16 v[132:135], v[240:243], a[168:171], v[132:135]
  v_rcp_f32 v69, v69
  v_mfma_f32_16x16x32_bf16 v[132:135], v[236:239], v[216:219], v[132:135]
  s_waitcnt lgkmcnt(0)
  ds_read_b64_tr_b16 v[236:237], v23 offset:36864
  ds_read_b64_tr_b16 v[238:239], v23 offset:38912
  v_mfma_f32_16x16x32_bf16 v[136:139], v[224:227], v[216:219], v[136:139]
  ds_read_b64_tr_b16 v[240:241], v23 offset:40960
  v_mul_f32 v117, s72, v117
  v_mfma_f32_16x16x32_bf16 v[136:139], v[228:231], a[168:171], v[136:139]
  ds_read_b64_tr_b16 v[242:243], v23 offset:43008
  v_mul_f32 v118, s72, v118
  v_mfma_f32_16x16x32_bf16 v[136:139], v[232:235], a[176:179], v[136:139]
  ds_read_b64_tr_b16 v[244:245], v23 offset:45056
  v_mul_f32 v119, s72, v119
  v_mfma_f32_16x16x32_bf16 v[152:155], v[232:235], a[180:183], v[152:155]
  ds_read_b64_tr_b16 v[246:247], v23 offset:47104
  v_mul_f32 v72, s72, v72
  v_mfma_f32_16x16x32_bf16 v[152:155], v[228:231], a[172:175], v[152:155]
  v_rcp_f32 v70, v70
  v_mfma_f32_16x16x32_bf16 v[152:155], v[224:227], v[220:223], v[152:155]
  v_rcp_f32 v71, v71
  v_mfma_f32_16x16x32_bf16 v[168:171], v[224:227], a[248:251], v[168:171]
  v_rcp_f32 v84, v84
  v_mfma_f32_16x16x32_bf16 v[168:171], v[228:231], a[148:151], v[168:171]
  v_rcp_f32 v85, v85
  v_mfma_f32_16x16x32_bf16 v[168:171], v[232:235], a[156:159], v[168:171]
  v_rcp_f32 v86, v86
  v_mfma_f32_16x16x32_bf16 v[184:187], v[232:235], a[160:163], v[184:187]
  v_rcp_f32 v87, v87
  v_mfma_f32_16x16x32_bf16 v[184:187], v[228:231], a[152:155], v[184:187]
  v_exp_f32 v100, v100
  v_mfma_f32_16x16x32_bf16 v[184:187], v[224:227], a[252:255], v[184:187]
  s_waitcnt lgkmcnt(0)
  s_barrier
  ds_read_b64_tr_b16 v[224:225], v24 offset:24576
  v_mfma_f32_16x16x32_bf16 v[188:191], v[236:239], a[252:255], v[188:191]
  s_add_u32 s61, s81, 1769472
  ds_read_b64_tr_b16 v[226:227], v24 offset:26624
  ds_read_b64_tr_b16 v[228:229], v24 offset:28672
  v_mfma_f32_16x16x32_bf16 v[188:191], v[240:243], a[152:155], v[188:191]
  s_add_u32 m0, s64, 24576
  ds_read_b64_tr_b16 v[230:231], v24 offset:30720
  v_add_f32 v100, 1.0, v100
  v_mfma_f32_16x16x32_bf16 v[188:191], v[244:247], a[160:163], v[188:191]
  ds_read_b64_tr_b16 v[232:233], v24 offset:32768
  v_mul_f32 v73, s72, v73
  v_mfma_f32_16x16x32_bf16 v[172:175], v[244:247], a[156:159], v[172:175]
  ds_read_b64_tr_b16 v[234:235], v24 offset:34816
  v_mul_f32 v74, s72, v74
  v_mfma_f32_16x16x32_bf16 v[172:175], v[240:243], a[148:151], v[172:175]
  buffer_load_dwordx4 v17, s[12:15], s61 offen offset:0 lds
  v_mfma_f32_16x16x32_bf16 v[172:175], v[236:239], a[248:251], v[172:175]
  v_exp_f32 v101, v101
  v_mfma_f32_16x16x32_bf16 v[156:159], v[236:239], v[220:223], v[156:159]
  v_exp_f32 v102, v102
  v_mfma_f32_16x16x32_bf16 v[156:159], v[240:243], a[172:175], v[156:159]
  s_waitcnt vmcnt(3)
  v_cmp_gt_u32 vcc, 4, v59
  s_mov_b32 s24, 0x80000
  s_mov_b32 s25, 0x800020
  s_andn2_b64 vcc, vcc, s[24:25]
  s_cbranch_scc1 spin_d
back_d:
  v_mfma_f32_16x16x32_bf16 v[156:159], v[244:247], a[180:183], v[156:159]
  v_exp_f32 v103, v103
  v_mfma_f32_16x16x32_bf16 v[140:143], v[244:247], a[176:179], v[140:143]
  s_mov_b32 s26, 0x01010101
  v_cmp_eq_u32 s[22:23], 7, v59
  v_and_b32 v56, 1, v59
  v_mfma_f32_16x16x32_bf16 v[140:143], v[240:243], a[168:171], v[140:143]
  s_mov_b32 s27, 0x01010101
  v_exp_f32 v116, v116
  v_mfma_f32_16x16x32_bf16 v[140:143], v[236:239], v[216:219], v[140:143]
  s_waitcnt lgkmcnt(0)
  ds_read_b64_tr_b16 v[236:237], v25 offset:24576
  ds_read_b64_tr_b16 v[238:239], v25 offset:26624
  v_mfma_f32_16x16x32_bf16 v[128:131], v[224:227], a[184:187], v[128:131]
  s_xor_b32 s100, s51, 1
  ds_read_b64_tr_b16 v[240:241], v25 offset:28672
  v_cmp_eq_u32 s[24:25], 1, v56
  v_mfma_f32_16x16x32_bf16 v[128:131], v[228:231], a[196:199], v[128:131]
  s_and_b32 s101, s2, 7
  ds_read_b64_tr_b16 v[242:243], v25 offset:30720
  v_add_f32 v101, 1.0, v101
  v_mfma_f32_16x16x32_bf16 v[128:131], v[232:235], a[212:215], v[128:131]
  s_lshr_b64 s[28:29], s[24:25], 9
  ds_read_b64_tr_b16 v[244:245], v25 offset:32768
  v_add_f32 v102, 1.0, v102
  v_mfma_f32_16x16x32_bf16 v[144:147], v[232:235], a[220:223], v[144:147]
  s_and_b32 s30, s28, 1
  ds_read_b64_tr_b16 v[246:247], v25 offset:34816
  v_add_f32 v103, 1.0, v103
  v_mfma_f32_16x16x32_bf16 v[144:147], v[228:231], a[204:207], v[144:147]
  buffer_load_dwordx4 v18, s[12:15], s61 offen offset:1024 lds
  v_mfma_f32_16x16x32_bf16 v[144:147], v[224:227], a[188:191], v[144:147]
  s_xor_b32 s30, s30, s100
  v_exp_f32 v117, v117
  v_mfma_f32_16x16x32_bf16 v[160:163], v[224:227], a[164:167], v[160:163]
  s_add_u32 s30, s30, 0
  v_exp_f32 v118, v118
  v_mfma_f32_16x16x32_bf16 v[160:163], v[228:231], a[200:203], v[160:163]
  s_lshr_b64 s[28:29], s[24:25], 27
  v_exp_f32 v119, v119
  v_mfma_f32_16x16x32_bf16 v[160:163], v[232:235], a[216:219], v[160:163]
  s_and_b32 s31, s28, 1
  v_add_f32 v116, 1.0, v116
  v_add_f32 v117, 1.0, v117
  v_mfma_f32_16x16x32_bf16 v[176:179], v[232:235], a[144:147], v[176:179]
  s_xor_b32 s31, s31, s100
  v_add_f32 v118, 1.0, v118
  v_add_f32 v119, 1.0, v119
  v_mfma_f32_16x16x32_bf16 v[176:179], v[228:231], a[208:211], v[176:179]
  s_add_u32 s31, s31, 2
  v_rcp_f32 v100, v100
  v_mfma_f32_16x16x32_bf16 v[176:179], v[224:227], a[192:195], v[176:179]
  s_waitcnt lgkmcnt(0)
  ds_read_b64_tr_b16 v[224:225], v26 offset:24576
  ds_read_b64_tr_b16 v[226:227], v26 offset:26624
  v_mfma_f32_16x16x32_bf16 v[180:183], v[236:239], a[192:195], v[180:183]
  s_lshr_b64 s[28:29], s[24:25], 45
  ds_read_b64_tr_b16 v[228:229], v26 offset:28672
  v_mul_f32 v75, s72, v75
  v_mfma_f32_16x16x32_bf16 v[180:183], v[240:243], a[208:211], v[180:183]
  s_and_b32 s32, s28, 1
  ds_read_b64_tr_b16 v[230:231], v26 offset:30720
  v_mul_f32 v88, s72, v88
  v_mfma_f32_16x16x32_bf16 v[180:183], v[244:247], a[144:147], v[180:183]
  s_xor_b32 s32, s32, s100
  ds_read_b64_tr_b16 v[232:233], v26 offset:32768
  v_mul_f32 v89, s72, v89
  v_mfma_f32_16x16x32_bf16 v[164:167], v[244:247], a[216:219], v[164:167]
  s_add_u32 s32, s32, 4
  ds_read_b64_tr_b16 v[234:235], v26 offset:34816
  v_mul_f32 v90, s72, v90
  v_mfma_f32_16x16x32_bf16 v[164:167], v[240:243], a[200:203], v[164:167]
  buffer_load_dwordx4 v19, s[12:15], s61 offen offset:2048 lds
  v_mfma_f32_16x16x32_bf16 v[164:167], v[236:239], a[164:167], v[164:167]
  s_lshr_b64 s[28:29], s[24:25], 63
  v_rcp_f32 v101, v101
  v_mfma_f32_16x16x32_bf16 v[148:151], v[236:239], a[188:191], v[148:151]
  s_and_b32 s33, s28, 1
  v_rcp_f32 v102, v102
  v_mfma_f32_16x16x32_bf16 v[148:151], v[240:243], a[204:207], v[148:151]
  s_xor_b32 s33, s33, s100
  v_rcp_f32 v103, v103
  v_mfma_f32_16x16x32_bf16 v[148:151], v[244:247], a[220:223], v[148:151]
  s_add_u32 s33, s33, 6
  v_rcp_f32 v116, v116
  v_mfma_f32_16x16x32_bf16 v[132:135], v[244:247], a[212:215], v[132:135]
  s_add_u32 m0, s64, 36864
  v_rcp_f32 v117, v117
  v_mfma_f32_16x16x32_bf16 v[132:135], v[240:243], a[196:199], v[132:135]
  s_mov_b32 s34, 16
  v_rcp_f32 v118, v118
  v_mfma_f32_16x16x32_bf16 v[132:135], v[236:239], a[184:187], v[132:135]
  s_waitcnt lgkmcnt(0)
  ds_read_b64_tr_b16 v[236:237], v27 offset:24576
  ds_read_b64_tr_b16 v[238:239], v27 offset:26624
  v_mfma_f32_16x16x32_bf16 v[136:139], v[224:227], a[184:187], v[136:139]
  s_lshl_b32 s99, s30, 3
  ds_read_b64_tr_b16 v[240:241], v27 offset:28672
  v_mul_f32 v91, s72, v91
  v_mfma_f32_16x16x32_bf16 v[136:139], v[228:231], a[196:199], v[136:139]
  s_lshr_b64 s[28:29], s[24:25], s99
  ds_read_b64_tr_b16 v[242:243], v27 offset:30720
  v_mul_f32 v104, s72, v104
  v_mfma_f32_16x16x32_bf16 v[136:139], v[232:235], a[212:215], v[136:139]
  s_and_b32 s100, s28, 0xff
  ds_read_b64_tr_b16 v[244:245], v27 offset:32768
  v_mul_f32 v105, s72, v105
  v_mfma_f32_16x16x32_bf16 v[152:155], v[232:235], a[220:223], v[152:155]
  s_bcnt1_i32_b32 s100, s100
  ds_read_b64_tr_b16 v[246:247], v27 offset:34816
  v_mul_f32 v106, s72, v106
  v_mfma_f32_16x16x32_bf16 v[152:155], v[228:231], a[204:207], v[152:155]
  buffer_load_dwordx4 v17, s[16:19], s61 offen offset:0 lds
  v_mfma_f32_16x16x32_bf16 v[152:155], v[224:227], a[188:191], v[152:155]
  s_sub_u32 s34, s34, s100
  v_rcp_f32 v119, v119
  v_mfma_f32_16x16x32_bf16 v[168:171], v[224:227], a[164:167], v[168:171]
  s_lshr_b64 s[28:29], s[24:25], s30
  v_exp_f32 v72, v72
  v_mfma_f32_16x16x32_bf16 v[168:171], v[228:231], a[200:203], v[168:171]
  s_and_b64 s[28:29], s[28:29], s[26:27]
  v_exp_f32 v73, v73
  v_mfma_f32_16x16x32_bf16 v[168:171], v[232:235], a[216:219], v[168:171]
  s_bcnt1_i32_b64 s100, s[28:29]
  v_exp_f32 v74, v74
  v_mfma_f32_16x16x32_bf16 v[184:187], v[232:235], a[144:147], v[184:187]
  s_add_u32 s34, s34, s100
  v_exp_f32 v75, v75
  v_mfma_f32_16x16x32_bf16 v[184:187], v[228:231], a[208:211], v[184:187]
  s_lshr_b64 s[28:29], s[22:23], s99
  v_exp_f32 v88, v88
  v_mfma_f32_16x16x32_bf16 v[184:187], v[224:227], a[192:195], v[184:187]
  s_waitcnt lgkmcnt(0)
  ds_read_b64_tr_b16 v[224:225], v24 offset:36864
  ds_read_b64_tr_b16 v[226:227], v24 offset:38912
  v_mfma_f32_16x16x32_bf16 v[188:191], v[236:239], a[192:195], v[188:191]
  s_and_b32 s100, s28, 0xff
  ds_read_b64_tr_b16 v[228:229], v24 offset:40960
  v_add_f32 v72, 1.0, v72
  v_mfma_f32_16x16x32_bf16 v[188:191], v[240:243], a[208:211], v[188:191]
  s_bcnt1_i32_b32 s100, s100
  ds_read_b64_tr_b16 v[230:231], v24 offset:43008
  v_add_f32 v73, 1.0, v73
  v_mfma_f32_16x16x32_bf16 v[188:191], v[244:247], a[144:147], v[188:191]
  s_sub_u32 s34, s34, s100
  ds_read_b64_tr_b16 v[232:233], v24 offset:45056
  v_add_f32 v74, 1.0, v74
  v_mfma_f32_16x16x32_bf16 v[172:175], v[244:247], a[216:219], v[172:175]
  s_lshr_b64 s[28:29], s[22:23], s30
  ds_read_b64_tr_b16 v[234:235], v24 offset:47104
  v_add_f32 v75, 1.0, v75
  v_mfma_f32_16x16x32_bf16 v[172:175], v[240:243], a[200:203], v[172:175]
  buffer_load_dwordx4 v18, s[16:19], s61 offen offset:1024 lds
  v_mfma_f32_16x16x32_bf16 v[172:175], v[236:239], a[164:167], v[172:175]
  s_and_b64 s[28:29], s[28:29], s[26:27]
  v_exp_f32 v89, v89
  v_mfma_f32_16x16x32_bf16 v[156:159], v[236:239], a[188:191], v[156:159]
  s_bcnt1_i32_b64 s100, s[28:29]
  v_exp_f32 v90, v90
  v_mfma_f32_16x16x32_bf16 v[156:159], v[240:243], a[204:207], v[156:159]
  s_add_u32 s34, s34, s100
  v_exp_f32 v91, v91
  v_mfma_f32_16x16x32_bf16 v[156:159], v[244:247], a[220:223], v[156:159]
  s_lshl_b32 s34, s34, 3
  v_add_f32 v88, 1.0, v88
  v_add_f32 v89, 1.0, v89
  v_mfma_f32_16x16x32_bf16 v[140:143], v[244:247], a[212:215], v[140:143]
  s_or_b32 s30, s30, s34
  v_add_f32 v90, 1.0, v90
  v_add_f32 v91, 1.0, v91
  v_mfma_f32_16x16x32_bf16 v[140:143], v[240:243], a[196:199], v[140:143]
  buffer_load_dwordx4 v19, s[16:19], s61 offen offset:2048 lds
  v_mfma_f32_16x16x32_bf16 v[140:143], v[236:239], a[184:187], v[140:143]
  s_waitcnt lgkmcnt(0)
  ds_read_b64_tr_b16 v[236:237], v25 offset:36864
  ds_read_b64_tr_b16 v[238:239], v25 offset:38912
  v_mfma_f32_16x16x32_bf16 v[128:131], v[224:227], a[128:131], v[128:131]
  s_mov_b32 s34, 16
  ds_read_b64_tr_b16 v[240:241], v25 offset:40960
  v_mul_f32 v107, s72, v107
  v_mfma_f32_16x16x32_bf16 v[128:131], v[228:231], a[0:3], v[128:131]
  s_lshl_b32 s99, s31, 3
  ds_read_b64_tr_b16 v[242:243], v25 offset:43008
  v_mul_f32 v120, s72, v120
  v_mfma_f32_16x16x32_bf16 v[128:131], v[232:235], a[8:11], v[128:131]
  s_lshr_b64 s[28:29], s[24:25], s99
  ds_read_b64_tr_b16 v[244:245], v25 offset:45056
  v_mul_f32 v121, s72, v121
  v_mfma_f32_16x16x32_bf16 v[144:147], v[232:235], a[12:15], v[144:147]
  s_and_b32 s100, s28, 0xff
  ds_read_b64_tr_b16 v[246:247], v25 offset:47104
  v_mul_f32 v122, s72, v122
  v_mfma_f32_16x16x32_bf16 v[144:147], v[228:231], a[4:7], v[144:147]
  s_bcnt1_i32_b32 s100, s100
  v_rcp_f32 v72, v72
  v_mfma_f32_16x16x32_bf16 v[144:147], v[224:227], a[136:139], v[144:147]
  s_sub_u32 s34, s34, s100
  v_rcp_f32 v73, v73
  v_mfma_f32_16x16x32_bf16 v[160:163], v[224:227], a[132:135], v[160:163]
  s_lshr_b64 s[28:29], s[24:25], s31
  v_rcp_f32 v74, v74
  v_mfma_f32_16x16x32_bf16 v[160:163], v[228:231], a[16:19], v[160:163]
  s_and_b64 s[28:29], s[28:29], s[26:27]
  v_rcp_f32 v75, v75
  v_mfma_f32_16x16x32_bf16 v[160:163], v[232:235], a[24:27], v[160:163]
  s_bcnt1_i32_b64 s100, s[28:29]
  v_rcp_f32 v88, v88
  v_mfma_f32_16x16x32_bf16 v[176:179], v[232:235], a[28:31], v[176:179]
  s_add_u32 s34, s34, s100
  v_rcp_f32 v89, v89
  v_mfma_f32_16x16x32_bf16 v[176:179], v[228:231], a[20:23], v[176:179]
  s_lshr_b64 s[28:29], s[22:23], s99
  v_rcp_f32 v90, v90
  v_mfma_f32_16x16x32_bf16 v[176:179], v[224:227], a[140:143], v[176:179]
  s_waitcnt lgkmcnt(0)
  ds_read_b64_tr_b16 v[224:225], v26 offset:36864
  ds_read_b64_tr_b16 v[226:227], v26 offset:38912
  v_mfma_f32_16x16x32_bf16 v[180:183], v[236:239], a[140:143], v[180:183]
  s_and_b32 s100, s28, 0xff
  ds_read_b64_tr_b16 v[228:229], v26 offset:40960
  v_mul_f32 v123, s72, v123
  v_mfma_f32_16x16x32_bf16 v[180:183], v[240:243], a[20:23], v[180:183]
  s_bcnt1_i32_b32 s100, s100
  ds_read_b64_tr_b16 v[230:231], v26 offset:43008
  v_mul_f32 v76, s72, v76
  v_mfma_f32_16x16x32_bf16 v[180:183], v[244:247], a[28:31], v[180:183]
  s_sub_u32 s34, s34, s100
  ds_read_b64_tr_b16 v[232:233], v26 offset:45056
  v_mul_f32 v77, s72, v77
  v_mfma_f32_16x16x32_bf16 v[164:167], v[244:247], a[24:27], v[164:167]
  s_lshr_b64 s[28:29], s[22:23], s31
  ds_read_b64_tr_b16 v[234:235], v26 offset:47104
  v_mul_f32 v78, s72, v78
  v_mfma_f32_16x16x32_bf16 v[164:167], v[240:243], a[16:19], v[164:167]
  buffer_load_dword v59, off, s[4:7], s46 sc1
  v_mfma_f32_16x16x32_bf16 v[164:167], v[236:239], a[132:135], v[164:167]
  s_and_b64 s[28:29], s[28:29], s[26:27]
  v_rcp_f32 v91, v91
  v_mfma_f32_16x16x32_bf16 v[148:151], v[236:239], a[136:139], v[148:151]
  s_bcnt1_i32_b64 s100, s[28:29]
  v_exp_f32 v104, v104
  v_mfma_f32_16x16x32_bf16 v[148:151], v[240:243], a[4:7], v[148:151]
  s_add_u32 s34, s34, s100
  v_exp_f32 v105, v105
  v_mfma_f32_16x16x32_bf16 v[148:151], v[244:247], a[12:15], v[148:151]
  s_lshl_b32 s34, s34, 3
  v_exp_f32 v106, v106
  v_mfma_f32_16x16x32_bf16 v[132:135], v[244:247], a[8:11], v[132:135]
  s_or_b32 s31, s31, s34
  v_exp_f32 v107, v107
  v_mfma_f32_16x16x32_bf16 v[132:135], v[240:243], a[0:3], v[132:135]
  s_mov_b32 s34, 16
  v_exp_f32 v120, v120
  v_mfma_f32_16x16x32_bf16 v[132:135], v[236:239], a[128:131], v[132:135]
  s_waitcnt lgkmcnt(0)
  ds_read_b64_tr_b16 v[236:237], v27 offset:36864
  ds_read_b64_tr_b16 v[238:239], v27 offset:38912
  v_mfma_f32_16x16x32_bf16 v[136:139], v[224:227], a[128:131], v[136:139]
  s_lshl_b32 s99, s32, 3
  ds_read_b64_tr_b16 v[240:241], v27 offset:40960
  v_add_f32 v104, 1.0, v104
  v_mfma_f32_16x16x32_bf16 v[136:139], v[228:231], a[0:3], v[136:139]
  s_lshr_b64 s[28:29], s[24:25], s99
  ds_read_b64_tr_b16 v[242:243], v27 offset:43008
  v_add_f32 v105, 1.0, v105
  v_mfma_f32_16x16x32_bf16 v[136:139], v[232:235], a[8:11], v[136:139]
  s_and_b32 s100, s28, 0xff
  ds_read_b64_tr_b16 v[244:245], v27 offset:45056
  v_add_f32 v106, 1.0, v106
  v_mfma_f32_16x16x32_bf16 v[152:155], v[232:235], a[12:15], v[152:155]
  s_bcnt1_i32_b32 s100, s100
  ds_read_b64_tr_b16 v[246:247], v27 offset:47104
  v_add_f32 v107, 1.0, v107
  v_mfma_f32_16x16x32_bf16 v[152:155], v[228:231], a[4:7], v[152:155]
  s_sub_u32 s34, s34, s100
  v_exp_f32 v121, v121
  v_mfma_f32_16x16x32_bf16 v[152:155], v[224:227], a[136:139], v[152:155]
  s_lshr_b64 s[28:29], s[24:25], s32
  v_exp_f32 v122, v122
  v_mfma_f32_16x16x32_bf16 v[168:171], v[224:227], a[132:135], v[168:171]
  s_and_b64 s[28:29], s[28:29], s[26:27]
  v_exp_f32 v123, v123
  v_mfma_f32_16x16x32_bf16 v[168:171], v[228:231], a[16:19], v[168:171]
  s_bcnt1_i32_b64 s100, s[28:29]
  v_add_f32 v120, 1.0, v120
  v_add_f32 v121, 1.0, v121
  v_mfma_f32_16x16x32_bf16 v[168:171], v[232:235], a[24:27], v[168:171]
  s_add_u32 s34, s34, s100
  v_add_f32 v122, 1.0, v122
  v_add_f32 v123, 1.0, v123
  v_mfma_f32_16x16x32_bf16 v[184:187], v[232:235], a[28:31], v[184:187]
  s_lshr_b64 s[28:29], s[22:23], s99
  v_rcp_f32 v104, v104
  v_mfma_f32_16x16x32_bf16 v[184:187], v[228:231], a[20:23], v[184:187]
  s_and_b32 s100, s28, 0xff
  v_rcp_f32 v105, v105
  v_mfma_f32_16x16x32_bf16 v[184:187], v[224:227], a[140:143], v[184:187]
  s_waitcnt lgkmcnt(0)
  s_barrier
  ds_read_b64_tr_b16 v[224:225], v24 offset:0
  v_mfma_f32_16x16x32_bf16 v[188:191], v[236:239], a[140:143], v[188:191]
  s_add_u32 s61, s81, 3538944
  ds_read_b64_tr_b16 v[226:227], v24 offset:2048
  ds_read_b64_tr_b16 v[228:229], v24 offset:4096
  v_mfma_f32_16x16x32_bf16 v[188:191], v[240:243], a[20:23], v[188:191]
  s_add_u32 m0, s64, 131072
  ds_read_b64_tr_b16 v[230:231], v24 offset:6144
  v_mul_f32 v79, s72, v79
  v_mfma_f32_16x16x32_bf16 v[188:191], v[244:247], a[28:31], v[188:191]
  s_bcnt1_i32_b32 s100, s100
  ds_read_b64_tr_b16 v[232:233], v24 offset:8192
  v_mul_f32 v92, s72, v92
  v_mfma_f32_16x16x32_bf16 v[172:175], v[244:247], a[24:27], v[172:175]
  s_sub_u32 s34, s34, s100
  ds_read_b64_tr_b16 v[234:235], v24 offset:10240
  v_mul_f32 v93, s72, v93
  v_mfma_f32_16x16x32_bf16 v[172:175], v[240:243], a[16:19], v[172:175]
  buffer_load_dwordx4 v17, s[12:15], s61 offen offset:0 lds
  v_mfma_f32_16x16x32_bf16 v[172:175], v[236:239], a[132:135], v[172:175]
  s_lshr_b64 s[28:29], s[22:23], s32
  v_rcp_f32 v106, v106
  v_mfma_f32_16x16x32_bf16 v[156:159], v[236:239], a[136:139], v[156:159]
  s_and_b64 s[28:29], s[28:29], s[26:27]
  v_rcp_f32 v107, v107
  v_mfma_f32_16x16x32_bf16 v[156:159], v[240:243], a[4:7], v[156:159]
  s_bcnt1_i32_b64 s100, s[28:29]
  v_rcp_f32 v120, v120
  v_mfma_f32_16x16x32_bf16 v[156:159], v[244:247], a[12:15], v[156:159]
  s_add_u32 s34, s34, s100
  v_rcp_f32 v121, v121
  v_mfma_f32_16x16x32_bf16 v[140:143], v[244:247], a[8:11], v[140:143]
  s_lshl_b32 s34, s34, 3
  v_rcp_f32 v122, v122
  v_mfma_f32_16x16x32_bf16 v[140:143], v[240:243], a[0:3], v[140:143]
  s_or_b32 s32, s32, s34
  v_rcp_f32 v123, v123
  v_mfma_f32_16x16x32_bf16 v[140:143], v[236:239], a[128:131], v[140:143]
  s_waitcnt lgkmcnt(0)
  ds_read_b64_tr_b16 v[236:237], v25 offset:0
  ds_read_b64_tr_b16 v[238:239], v25 offset:2048
  v_mfma_f32_16x16x32_bf16 v[128:131], v[224:227], a[32:35], v[128:131]
  s_mov_b32 s34, 16
  ds_read_b64_tr_b16 v[240:241], v25 offset:4096
  v_mul_f32 v94, s72, v94
  v_mfma_f32_16x16x32_bf16 v[128:131], v[228:231], a[40:43], v[128:131]
  s_lshl_b32 s99, s33, 3
  ds_read_b64_tr_b16 v[242:243], v25 offset:6144
  v_mul_f32 v95, s72, v95
  v_mfma_f32_16x16x32_bf16 v[128:131], v[232:235], a[64:67], v[128:131]
  s_lshr_b64 s[28:29], s[24:25], s99
  ds_read_b64_tr_b16 v[244:245], v25 offset:8192
  v_mul_f32 v108, s72, v108
  v_mfma_f32_16x16x32_bf16 v[144:147], v[232:235], a[68:71], v[144:147]
  s_and_b32 s100, s28, 0xff
  ds_read_b64_tr_b16 v[246:247], v25 offset:10240
  v_mul_f32 v109, s72, v109
  v_mfma_f32_16x16x32_bf16 v[144:147], v[228:231], a[44:47], v[144:147]
  buffer_load_dwordx4 v18, s[12:15], s61 offen offset:1024 lds
  v_mfma_f32_16x16x32_bf16 v[144:147], v[224:227], a[36:39], v[144:147]
  s_bcnt1_i32_b32 s100, s100
  v_exp_f32 v76, v76
  v_mfma_f32_16x16x32_bf16 v[160:163], v[224:227], a[48:51], v[160:163]
  s_sub_u32 s34, s34, s100
  v_exp_f32 v77, v77
  v_mfma_f32_16x16x32_bf16 v[160:163], v[228:231], a[56:59], v[160:163]
  s_lshr_b64 s[28:29], s[24:25], s33
  v_exp_f32 v78, v78
  v_mfma_f32_16x16x32_bf16 v[160:163], v[232:235], a[80:83], v[160:163]
  s_and_b64 s[28:29], s[28:29], s[26:27]
  v_exp_f32 v79, v79
  v_mfma_f32_16x16x32_bf16 v[176:179], v[232:235], a[84:87], v[176:179]
  s_bcnt1_i32_b64 s100, s[28:29]
  v_exp_f32 v92, v92
  v_mfma_f32_16x16x32_bf16 v[176:179], v[228:231], a[60:63], v[176:179]
  s_add_u32 s34, s34, s100
  v_exp_f32 v93, v93
  v_mfma_f32_16x16x32_bf16 v[176:179], v[224:227], a[52:55], v[176:179]
  s_waitcnt lgkmcnt(0)
  ds_read_b64_tr_b16 v[224:225], v26 offset:0
  ds_read_b64_tr_b16 v[226:227], v26 offset:2048
  v_mfma_f32_16x16x32_bf16 v[180:183], v[236:239], a[52:55], v[180:183]
  s_lshr_b64 s[28:29], s[22:23], s99
  ds_read_b64_tr_b16 v[228:229], v26 offset:4096
  v_add_f32 v76, 1.0, v76
  v_mfma_f32_16x16x32_bf16 v[180:183], v[240:243], a[60:63], v[180:183]
  s_and_b32 s100, s28, 0xff
  ds_read_b64_tr_b16 v[230:231], v26 offset:6144
  v_add_f32 v77, 1.0, v77
  v_mfma_f32_16x16x32_bf16 v[180:183], v[244:247], a[84:87], v[180:183]
  s_bcnt1_i32_b32 s100, s100
  ds_read_b64_tr_b16 v[232:233], v26 offset:8192
  v_add_f32 v78, 1.0, v78
  v_mfma_f32_16x16x32_bf16 v[164:167], v[244:247], a[80:83], v[164:167]
  s_sub_u32 s34, s34, s100
  ds_read_b64_tr_b16 v[234:235], v26 offset:10240
  v_add_f32 v79, 1.0, v79
  v_mfma_f32_16x16x32_bf16 v[164:167], v[240:243], a[56:59], v[164:167]
  buffer_load_dwordx4 v19, s[12:15], s61 offen offset:2048 lds
  v_mfma_f32_16x16x32_bf16 v[164:167], v[236:239], a[48:51], v[164:167]
  s_lshr_b64 s[28:29], s[22:23], s33
  v_exp_f32 v94, v94
  v_mfma_f32_16x16x32_bf16 v[148:151], v[236:239], a[36:39], v[148:151]
  s_and_b64 s[28:29], s[28:29], s[26:27]
  v_exp_f32 v95, v95
  v_mfma_f32_16x16x32_bf16 v[148:151], v[240:243], a[44:47], v[148:151]
  s_bcnt1_i32_b64 s100, s[28:29]
  v_add_f32 v92, 1.0, v92
  v_add_f32 v93, 1.0, v93
  v_mfma_f32_16x16x32_bf16 v[148:151], v[244:247], a[68:71], v[148:151]
  s_add_u32 s34, s34, s100
  v_add_f32 v94, 1.0, v94
  v_add_f32 v95, 1.0, v95
  v_mfma_f32_16x16x32_bf16 v[132:135], v[244:247], a[64:67], v[132:135]
  s_add_u32 m0, s64, 143360
  v_rcp_f32 v76, v76
  v_mfma_f32_16x16x32_bf16 v[132:135], v[240:243], a[40:43], v[132:135]
  s_lshl_b32 s34, s34, 3
  v_rcp_f32 v77, v77
  v_mfma_f32_16x16x32_bf16 v[132:135], v[236:239], a[32:35], v[132:135]
  s_waitcnt lgkmcnt(0)
  ds_read_b64_tr_b16 v[236:237], v27 offset:0
  ds_read_b64_tr_b16 v[238:239], v27 offset:2048
  v_mfma_f32_16x16x32_bf16 v[136:139], v[224:227], a[32:35], v[136:139]
  s_or_b32 s33, s33, s34
  ds_read_b64_tr_b16 v[240:241], v27 offset:4096
  v_mul_f32 v110, s72, v110
  v_mfma_f32_16x16x32_bf16 v[136:139], v[228:231], a[40:43], v[136:139]
pad_m_14:
  s_cbranch_execz warm_3
  s_min_u32 s99, s30, s31
  ds_read_b64_tr_b16 v[242:243], v27 offset:6144
  v_mul_f32 v111, s72, v111
  v_mfma_f32_16x16x32_bf16 v[136:139], v[232:235], a[64:67], v[136:139]
  s_max_u32 s31, s30, s31
  ds_read_b64_tr_b16 v[244:245], v27 offset:8192
  v_mul_f32 v124, s72, v124
  v_mfma_f32_16x16x32_bf16 v[152:155], v[232:235], a[68:71], v[152:155]
  s_mov_b32 s30, s99
  ds_read_b64_tr_b16 v[246:247], v27 offset:10240
  v_mul_f32 v125, s72, v125
  v_mfma_f32_16x16x32_bf16 v[152:155], v[228:231], a[44:47], v[152:155]
  s_waitcnt vmcnt(3)
  v_readfirstlane_b32 s73, v59
  s_nop 0
  s_and_b32 s73, s73, s9
  s_cmp_ge_u32 s73, s9
  s_cbranch_scc0 spin_a
back_a:
  v_mfma_f32_16x16x32_bf16 v[152:155], v[224:227], a[36:39], v[152:155]
  buffer_load_dwordx4 v17, s[16:19], s61 offen offset:0 lds
  v_mfma_f32_16x16x32_bf16 v[168:171], v[224:227], a[48:51], v[168:171]
  s_mov_b32 s88, s0
  v_rcp_f32 v78, v78
  v_mfma_f32_16x16x32_bf16 v[168:171], v[228:231], a[56:59], v[168:171]
  s_min_u32 s99, s32, s33
  v_rcp_f32 v79, v79
  v_mfma_f32_16x16x32_bf16 v[168:171], v[232:235], a[80:83], v[168:171]
  s_max_u32 s33, s32, s33
  v_rcp_f32 v92, v92
  v_mfma_f32_16x16x32_bf16 v[184:187], v[232:235], a[84:87], v[184:187]
  buffer_load_dwordx4 a[224:227], v28, s[4:7], s88 offen sc1
  v_mfma_f32_16x16x32_bf16 v[184:187], v[228:231], a[60:63], v[184:187]
  s_mov_b32 s32, s99
  v_rcp_f32 v93, v93
  v_mfma_f32_16x16x32_bf16 v[184:187], v[224:227], a[52:55], v[184:187]
  s_waitcnt lgkmcnt(0)
  ds_read_b64_tr_b16 v[224:225], v24 offset:12288
  ds_read_b64_tr_b16 v[226:227], v24 offset:14336
  v_mfma_f32_16x16x32_bf16 v[188:191], v[236:239], a[52:55], v[188:191]
  s_min_u32 s99, s30, s32
  ds_read_b64_tr_b16 v[228:229], v24 offset:16384
  v_add_co_u32 v60, vcc, (att_retry-att_last-8192)/36*4, v60
  v_mfma_f32_16x16x32_bf16 v[188:191], v[240:243], a[60:63], v[188:191]
  s_max_u32 s32, s30, s32
  ds_read_b64_tr_b16 v[230:231], v24 offset:18432
  v_addc_co_u32 v61, vcc, 0, v61, vcc
  v_mfma_f32_16x16x32_bf16 v[188:191], v[244:247], a[84:87], v[188:191]
  s_mov_b32 s30, s99
  ds_read_b64_tr_b16 v[232:233], v24 offset:20480
  v_mul_f32 v126, s72, v126
  v_mfma_f32_16x16x32_bf16 v[172:175], v[244:247], a[80:83], v[172:175]
  s_min_u32 s99, s31, s33
  ds_read_b64_tr_b16 v[234:235], v24 offset:22528
  v_mul_f32 v127, s72, v127
  v_mfma_f32_16x16x32_bf16 v[172:175], v[240:243], a[56:59], v[172:175]
  buffer_load_dwordx4 v18, s[16:19], s61 offen offset:1024 lds
  v_mfma_f32_16x16x32_bf16 v[172:175], v[236:239], a[48:51], v[172:175]
  s_max_u32 s33, s31, s33
  v_rcp_f32 v94, v94
  v_mfma_f32_16x16x32_bf16 v[156:159], v[236:239], a[36:39], v[156:159]
  s_mov_b32 s31, s99
  v_rcp_f32 v95, v95
  v_mfma_f32_16x16x32_bf16 v[156:159], v[240:243], a[44:47], v[156:159]
  buffer_load_dwordx4 a[228:231], v29, s[4:7], s88 offen sc1
  v_mfma_f32_16x16x32_bf16 v[156:159], v[244:247], a[68:71], v[156:159]
  s_min_u32 s99, s31, s32
  v_exp_f32 v108, v108
  v_mfma_f32_16x16x32_bf16 v[140:143], v[244:247], a[64:67], v[140:143]
  s_max_u32 s32, s31, s32
  v_exp_f32 v109, v109
  v_mfma_f32_16x16x32_bf16 v[140:143], v[240:243], a[40:43], v[140:143]
  global_load_dword v62, v[60:61], off
  v_mfma_f32_16x16x32_bf16 v[140:143], v[236:239], a[32:35], v[140:143]
  s_waitcnt lgkmcnt(0)
  ds_read_b64_tr_b16 v[236:237], v25 offset:12288
  ds_read_b64_tr_b16 v[238:239], v25 offset:14336
  v_mfma_f32_16x16x32_bf16 v[128:131], v[224:227], a[72:75], v[128:131]
  s_mov_b32 s31, s99
  ds_read_b64_tr_b16 v[240:241], v25 offset:16384
  v_add_f32 v108, 1.0, v108
  v_mfma_f32_16x16x32_bf16 v[128:131], v[228:231], a[96:99], v[128:131]
  ds_read_b64_tr_b16 v[242:243], v25 offset:18432
  buffer_load_dwordx4 a[232:235], v30, s[4:7], s88 offen sc1
  v_mfma_f32_16x16x32_bf16 v[128:131], v[232:235], a[104:107], v[128:131]
  s_and_b32 s30, s30, 7
  ds_read_b64_tr_b16 v[244:245], v25 offset:20480
  v_add_f32 v109, 1.0, v109
  v_mfma_f32_16x16x32_bf16 v[144:147], v[232:235], a[108:111], v[144:147]
  ds_read_b64_tr_b16 v[246:247], v25 offset:22528
  buffer_load_dwordx4 v19, s[16:19], s61 offen offset:2048 lds
  v_mfma_f32_16x16x32_bf16 v[144:147], v[228:231], a[100:103], v[144:147]
  s_and_b32 s31, s31, 7
  v_exp_f32 v110, v110
  v_mfma_f32_16x16x32_bf16 v[144:147], v[224:227], a[76:79], v[144:147]
  s_and_b32 s32, s32, 7
  v_exp_f32 v111, v111
  v_mfma_f32_16x16x32_bf16 v[160:163], v[224:227], a[88:91], v[160:163]
  s_and_b32 s33, s33, 7
  v_exp_f32 v124, v124
  v_mfma_f32_16x16x32_bf16 v[160:163], v[228:231], a[112:115], v[160:163]
  buffer_load_dwordx4 a[236:239], v31, s[4:7], s88 offen sc1
  v_mfma_f32_16x16x32_bf16 v[160:163], v[232:235], a[120:123], v[160:163]
  s_add_u32 s88, s88, 4096
  v_exp_f32 v125, v125
  v_mfma_f32_16x16x32_bf16 v[176:179], v[232:235], a[124:127], v[176:179]
  s_mov_b32 s34, 1
  v_exp_f32 v126, v126
  v_mfma_f32_16x16x32_bf16 v[176:179], v[228:231], a[116:119], v[176:179]
  buffer_load_dwordx4 a[240:243], v28, s[4:7], s88 offen sc1
  v_mfma_f32_16x16x32_bf16 v[176:179], v[224:227], a[92:95], v[176:179]
  s_waitcnt lgkmcnt(0)
  ds_read_b64_tr_b16 v[224:225], v26 offset:12288
  ds_read_b64_tr_b16 v[226:227], v26 offset:14336
  v_mfma_f32_16x16x32_bf16 v[180:183], v[236:239], a[92:95], v[180:183]
  s_lshl_b32 s99, s30, 3
  ds_read_b64_tr_b16 v[228:229], v26 offset:16384
  v_add_f32 v110, 1.0, v110
  v_mfma_f32_16x16x32_bf16 v[180:183], v[240:243], a[116:119], v[180:183]
  s_add_u32 s99, s99, s33
  ds_read_b64_tr_b16 v[230:231], v26 offset:18432
  v_add_f32 v111, 1.0, v111
  v_mfma_f32_16x16x32_bf16 v[180:183], v[244:247], a[124:127], v[180:183]
  s_lshr_b64 s[28:29], s[22:23], s99
  ds_read_b64_tr_b16 v[232:233], v26 offset:20480
  v_add_f32 v124, 1.0, v124
  v_mfma_f32_16x16x32_bf16 v[164:167], v[244:247], a[120:123], v[164:167]
  s_and_b32 s34, s34, s28
  ds_read_b64_tr_b16 v[234:235], v26 offset:22528
  v_add_f32 v125, 1.0, v125
  v_mfma_f32_16x16x32_bf16 v[164:167], v[240:243], a[112:115], v[164:167]
  buffer_load_dwordx4 a[244:247], v29, s[4:7], s88 offen sc1
  v_mfma_f32_16x16x32_bf16 v[164:167], v[236:239], a[88:91], v[164:167]
  s_lshl_b32 s99, s31, 3
  v_exp_f32 v127, v127
  v_mfma_f32_16x16x32_bf16 v[148:151], v[236:239], a[76:79], v[148:151]
  s_add_u32 s99, s99, s33
  v_add_f32 v126, 1.0, v126
  v_add_f32 v127, 1.0, v127
  v_mfma_f32_16x16x32_bf16 v[148:151], v[240:243], a[100:103], v[148:151]
  s_lshr_b64 s[28:29], s[22:23], s99
  v_rcp_f32 v108, v108
  v_mfma_f32_16x16x32_bf16 v[148:151], v[244:247], a[108:111], v[148:151]
  buffer_load_dwordx4 a[248:251], v30, s[4:7], s88 offen sc1
  v_mfma_f32_16x16x32_bf16 v[132:135], v[244:247], a[104:107], v[132:135]
  s_and_b32 s34, s34, s28
  v_rcp_f32 v109, v109
  v_mfma_f32_16x16x32_bf16 v[132:135], v[240:243], a[96:99], v[132:135]
  s_lshl_b32 s99, s32, 3
  v_rcp_f32 v110, v110
  v_mfma_f32_16x16x32_bf16 v[132:135], v[236:239], a[72:75], v[132:135]
  s_waitcnt lgkmcnt(0)
  ds_read_b64_tr_b16 v[236:237], v27 offset:12288
  ds_read_b64_tr_b16 v[238:239], v27 offset:14336
  v_mfma_f32_16x16x32_bf16 v[136:139], v[224:227], a[72:75], v[136:139]
  s_add_u32 s99, s99, s33
  ds_read_b64_tr_b16 v[240:241], v27 offset:16384
  v_mul_f32 v128, v64, v128
  v_mfma_f32_16x16x32_bf16 v[136:139], v[228:231], a[96:99], v[136:139]
  s_lshr_b64 s[28:29], s[24:25], s99
  ds_read_b64_tr_b16 v[242:243], v27 offset:18432
  v_mul_f32 v129, v65, v129
  v_mfma_f32_16x16x32_bf16 v[136:139], v[232:235], a[104:107], v[136:139]
  s_and_b32 s34, s34, s28
  ds_read_b64_tr_b16 v[244:245], v27 offset:20480
  v_mul_f32 v130, v66, v130
  v_mfma_f32_16x16x32_bf16 v[152:155], v[232:235], a[108:111], v[152:155]
  s_mov_b32 s100, s30
  ds_read_b64_tr_b16 v[246:247], v27 offset:22528
  v_mul_f32 v131, v67, v131
  v_mfma_f32_16x16x32_bf16 v[152:155], v[228:231], a[100:103], v[152:155]
  buffer_load_dwordx4 a[252:255], v31, s[4:7], s88 offen sc1
  v_mfma_f32_16x16x32_bf16 v[152:155], v[224:227], a[76:79], v[152:155]
  s_add_u32 s88, s88, 4096
  v_rcp_f32 v111, v111
  v_mfma_f32_16x16x32_bf16 v[168:171], v[224:227], a[88:91], v[168:171]
  s_sub_u32 s77, 9, s51
  v_rcp_f32 v124, v124
  v_mfma_f32_16x16x32_bf16 v[168:171], v[228:231], a[112:115], v[168:171]
  s_lshl_b32 s99, s101, 3
  v_rcp_f32 v125, v125
  v_mfma_f32_16x16x32_bf16 v[168:171], v[232:235], a[120:123], v[168:171]
  buffer_load_dwordx4 a[148:151], v28, s[4:7], s88 offen sc1
  v_mfma_f32_16x16x32_bf16 v[184:187], v[232:235], a[124:127], v[184:187]
  v_rcp_f32 v126, v126
  v_mfma_f32_16x16x32_bf16 v[184:187], v[228:231], a[116:119], v[184:187]
  v_rcp_f32 v127, v127
  v_mfma_f32_16x16x32_bf16 v[184:187], v[224:227], a[92:95], v[184:187]
  s_waitcnt lgkmcnt(0)
  s_barrier
  ds_read_b64_tr_b16 v[224:225], v3 offset:0
  v_mfma_f32_16x16x32_bf16 v[188:191], v[236:239], a[92:95], v[188:191]
  ds_read_b64_tr_b16 v[226:227], v3 offset:1024
  ds_read_b64_tr_b16 v[228:229], v3 offset:2048
  v_mfma_f32_16x16x32_bf16 v[188:191], v[240:243], a[116:119], v[188:191]
  ds_read_b64_tr_b16 v[230:231], v3 offset:3072
  v_mul_f32 v144, v80, v144
  v_mfma_f32_16x16x32_bf16 v[188:191], v[244:247], a[124:127], v[188:191]
  ds_read_b64_tr_b16 v[232:233], v3 offset:4096
  v_mul_f32 v145, v81, v145
  v_mfma_f32_16x16x32_bf16 v[172:175], v[244:247], a[120:123], v[172:175]
  ds_read_b64_tr_b16 v[234:235], v3 offset:5120
  v_mul_f32 v146, v82, v146
  v_mfma_f32_16x16x32_bf16 v[172:175], v[240:243], a[112:115], v[172:175]
  buffer_load_dwordx4 a[152:155], v29, s[4:7], s88 offen sc1
  v_mfma_f32_16x16x32_bf16 v[172:175], v[236:239], a[88:91], v[172:175]
  v_mul_f32 v147, v83, v147
  v_mul_f32 v148, v84, v148
  v_mfma_f32_16x16x32_bf16 v[156:159], v[236:239], a[76:79], v[156:159]
  v_mul_f32 v149, v85, v149
  v_mul_f32 v150, v86, v150
  v_mfma_f32_16x16x32_bf16 v[156:159], v[240:243], a[100:103], v[156:159]
  v_mul_f32 v132, v68, v132
  v_mul_f32 v151, v87, v151
  v_mfma_f32_16x16x32_bf16 v[156:159], v[244:247], a[108:111], v[156:159]
  buffer_load_dwordx4 a[156:159], v30, s[4:7], s88 offen sc1
  v_mfma_f32_16x16x32_bf16 v[140:143], v[244:247], a[104:107], v[140:143]
  v_mul_f32 v133, v69, v133
  v_mul_f32 v134, v70, v134
  v_mfma_f32_16x16x32_bf16 v[140:143], v[240:243], a[96:99], v[140:143]
  v_mul_f32 v135, v71, v135
  v_mul_f32 v136, v72, v136
  v_mfma_f32_16x16x32_bf16 v[140:143], v[236:239], a[72:75], v[140:143]
  s_waitcnt lgkmcnt(0)
  ds_read_b64_tr_b16 v[236:237], v4 offset:0
  ds_read_b64_tr_b16 v[238:239], v4 offset:1024
  v_mfma_f32_16x16x32_bf16 v[64:67], v[224:227], v[192:195], 0
  ds_read_b64_tr_b16 v[240:241], v4 offset:2048
  ds_read_b64_tr_b16 v[242:243], v4 offset:3072
  v_mfma_f32_16x16x32_bf16 v[64:67], v[228:231], v[200:203], v[64:67]
  ds_read_b64_tr_b16 v[244:245], v4 offset:4096
  ds_read_b64_tr_b16 v[246:247], v4 offset:5120
  v_mfma_f32_16x16x32_bf16 v[64:67], v[232:235], v[208:211], v[64:67]
  buffer_load_dwordx4 a[160:163], v31, s[4:7], s88 offen sc1
  v_mfma_f32_16x16x32_bf16 v[80:83], v[232:235], v[212:215], 0
  v_mul_f32 v137, v73, v137
  v_mul_f32 v138, v74, v138
  v_mfma_f32_16x16x32_bf16 v[80:83], v[228:231], v[204:207], v[80:83]
  v_mul_f32 v139, v75, v139
  v_mul_f32 v152, v88, v152
  v_mfma_f32_16x16x32_bf16 v[80:83], v[224:227], v[196:199], v[80:83]
  s_waitcnt lgkmcnt(4)
  s_add_u32 s88, s88, 4096
  ds_read_b64_tr_b16 v[224:225], v3 offset:12288
  ds_read_b64_tr_b16 v[226:227], v3 offset:13312
  v_mfma_f32_16x16x32_bf16 v[84:87], v[236:239], v[196:199], 0
  s_waitcnt lgkmcnt(4)
  s_add_u32 s65, s97, 65536
  ds_read_b64_tr_b16 v[228:229], v3 offset:14336
  ds_read_b64_tr_b16 v[230:231], v3 offset:15360
  v_mfma_f32_16x16x32_bf16 v[84:87], v[240:243], v[204:207], v[84:87]
  s_waitcnt lgkmcnt(4)
  s_add_u32 s66, s97, 69632
  ds_read_b64_tr_b16 v[232:233], v3 offset:16384
  ds_read_b64_tr_b16 v[234:235], v3 offset:17408
  v_mfma_f32_16x16x32_bf16 v[84:87], v[244:247], v[212:215], v[84:87]
  buffer_load_dwordx4 a[164:167], v28, s[4:7], s88 offen sc1
  v_mfma_f32_16x16x32_bf16 v[68:71], v[244:247], v[208:211], 0
  v_mul_f32 v153, v89, v153
  v_mul_f32 v154, v90, v154
  v_mfma_f32_16x16x32_bf16 v[68:71], v[240:243], v[200:203], v[68:71]
  v_mul_f32 v155, v91, v155
  v_mul_f32 v156, v92, v156
  v_mfma_f32_16x16x32_bf16 v[68:71], v[236:239], v[192:195], v[68:71]
  s_waitcnt lgkmcnt(4)
  ds_read_b64_tr_b16 v[236:237], v4 offset:12288
  ds_read_b64_tr_b16 v[238:239], v4 offset:13312
  v_mfma_f32_16x16x32_bf16 v[72:75], v[224:227], v[192:195], 0
  s_waitcnt lgkmcnt(4)
  ds_read_b64_tr_b16 v[240:241], v4 offset:14336
  ds_read_b64_tr_b16 v[242:243], v4 offset:15360
  v_mfma_f32_16x16x32_bf16 v[72:75], v[228:231], v[200:203], v[72:75]
  s_waitcnt lgkmcnt(4)
  ds_read_b64_tr_b16 v[244:245], v4 offset:16384
  ds_read_b64_tr_b16 v[246:247], v4 offset:17408
  v_mfma_f32_16x16x32_bf16 v[72:75], v[232:235], v[208:211], v[72:75]
  buffer_load_dwordx4 a[192:195], v29, s[4:7], s88 offen sc1
  v_mfma_f32_16x16x32_bf16 v[88:91], v[232:235], v[212:215], 0
  v_mul_f32 v157, v93, v157
  v_mul_f32 v158, v94, v158
  v_mfma_f32_16x16x32_bf16 v[88:91], v[228:231], v[204:207], v[88:91]
  v_mul_f32 v140, v76, v140
  v_mul_f32 v159, v95, v159
  v_mfma_f32_16x16x32_bf16 v[88:91], v[224:227], v[196:199], v[88:91]
  s_waitcnt lgkmcnt(4)
  ds_read_b64_tr_b16 v[224:225], v3 offset:6144
  ds_read_b64_tr_b16 v[226:227], v3 offset:7168
  v_mfma_f32_16x16x32_bf16 v[92:95], v[236:239], v[196:199], 0
  s_waitcnt lgkmcnt(4)
  ds_read_b64_tr_b16 v[228:229], v3 offset:8192
  ds_read_b64_tr_b16 v[230:231], v3 offset:9216
  v_mfma_f32_16x16x32_bf16 v[92:95], v[240:243], v[204:207], v[92:95]
  s_waitcnt lgkmcnt(4)
  ds_read_b64_tr_b16 v[232:233], v3 offset:10240
  ds_read_b64_tr_b16 v[234:235], v3 offset:11264
  v_mul_f32 v141, v77, v141
  v_mul_f32 v142, v78, v142
  v_mul_f32 v143, v79, v143
  v_mfma_f32_16x16x32_bf16 v[92:95], v[244:247], v[212:215], v[92:95]
  buffer_load_dwordx4 a[200:203], v30, s[4:7], s88 offen sc1
  v_mfma_f32_16x16x32_bf16 v[76:79], v[244:247], v[208:211], 0
  v_mul_f32 v184, v120, v184
  v_mul_f32 v185, v121, v185
  v_mfma_f32_16x16x32_bf16 v[76:79], v[240:243], v[200:203], v[76:79]
  v_cvt_pk_bf16_f32 v120, v128, v129
  v_cvt_pk_bf16_f32 v121, v130, v131
  v_mfma_f32_16x16x32_bf16 v[76:79], v[236:239], v[192:195], v[76:79]
  s_waitcnt lgkmcnt(4)
  ds_read_b64_tr_b16 v[236:237], v4 offset:6144
  ds_read_b64_tr_b16 v[238:239], v4 offset:7168
  v_mfma_f32_16x16x32_bf16 v[64:67], v[224:227], v[216:219], v[64:67]
  s_waitcnt lgkmcnt(4)
  ds_read_b64_tr_b16 v[240:241], v4 offset:8192
  ds_read_b64_tr_b16 v[242:243], v4 offset:9216
  v_mfma_f32_16x16x32_bf16 v[64:67], v[228:231], a[168:171], v[64:67]
  s_waitcnt lgkmcnt(4)
  ds_read_b64_tr_b16 v[244:245], v4 offset:10240
  ds_read_b64_tr_b16 v[246:247], v4 offset:11264
  v_mfma_f32_16x16x32_bf16 v[64:67], v[232:235], a[176:179], v[64:67]
  buffer_load_dwordx4 a[208:211], v31, s[4:7], s88 offen sc1
  v_mfma_f32_16x16x32_bf16 v[80:83], v[232:235], a[180:183], v[80:83]
  v_mul_f32 v186, v122, v186
  v_mul_f32 v187, v123, v187
  v_mfma_f32_16x16x32_bf16 v[80:83], v[228:231], a[172:175], v[80:83]
  v_cvt_pk_bf16_f32 v122, v132, v133
  v_cvt_pk_bf16_f32 v123, v134, v135
  v_mfma_f32_16x16x32_bf16 v[80:83], v[224:227], v[220:223], v[80:83]
  s_waitcnt lgkmcnt(4)
  ds_read_b64_tr_b16 v[224:225], v3 offset:18432
  ds_read_b64_tr_b16 v[226:227], v3 offset:19456
  v_mfma_f32_16x16x32_bf16 v[84:87], v[236:239], v[220:223], v[84:87]
  s_waitcnt lgkmcnt(4)
  ds_read_b64_tr_b16 v[228:229], v3 offset:20480
  ds_read_b64_tr_b16 v[230:231], v3 offset:21504
  v_mfma_f32_16x16x32_bf16 v[84:87], v[240:243], a[172:175], v[84:87]
  s_waitcnt lgkmcnt(4)
  ds_read_b64_tr_b16 v[232:233], v3 offset:22528
  ds_read_b64_tr_b16 v[234:235], v3 offset:23552
  v_mfma_f32_16x16x32_bf16 v[84:87], v[244:247], a[180:183], v[84:87]
  v_mul_f32 v188, v124, v188
  v_mul_f32 v189, v125, v189
  v_mfma_f32_16x16x32_bf16 v[68:71], v[244:247], a[176:179], v[68:71]
  v_cvt_pk_bf16_f32 v124, v136, v137
  v_cvt_pk_bf16_f32 v125, v138, v139
  v_mfma_f32_16x16x32_bf16 v[68:71], v[240:243], a[168:171], v[68:71]
  v_mul_f32 v190, v126, v190
  v_mul_f32 v191, v127, v191
  v_mfma_f32_16x16x32_bf16 v[68:71], v[236:239], v[216:219], v[68:71]
  s_waitcnt lgkmcnt(4)
  ds_read_b64_tr_b16 v[236:237], v4 offset:18432
  ds_read_b64_tr_b16 v[238:239], v4 offset:19456
  v_mfma_f32_16x16x32_bf16 v[72:75], v[224:227], v[216:219], v[72:75]
  s_waitcnt lgkmcnt(4)
  ds_read_b64_tr_b16 v[240:241], v4 offset:20480
  ds_read_b64_tr_b16 v[242:243], v4 offset:21504
  v_mfma_f32_16x16x32_bf16 v[72:75], v[228:231], a[168:171], v[72:75]
  s_waitcnt lgkmcnt(4)
  ds_read_b64_tr_b16 v[244:245], v4 offset:22528
  ds_read_b64_tr_b16 v[246:247], v4 offset:23552
  v_mfma_f32_16x16x32_bf16 v[72:75], v[232:235], a[176:179], v[72:75]
  v_cvt_pk_bf16_f32 v126, v140, v141
  v_cvt_pk_bf16_f32 v127, v142, v143
  v_mfma_f32_16x16x32_bf16 v[88:91], v[232:235], a[180:183], v[88:91]
  v_mul_f32 v176, v112, v176
  v_mul_f32 v177, v113, v177
  v_mfma_f32_16x16x32_bf16 v[88:91], v[228:231], a[172:175], v[88:91]
  v_cvt_pk_bf16_f32 v112, v144, v145
  v_cvt_pk_bf16_f32 v113, v146, v147
  v_mfma_f32_16x16x32_bf16 v[88:91], v[224:227], v[220:223], v[88:91]
  s_waitcnt lgkmcnt(0)
  s_barrier
  ds_read_b64_tr_b16 v[224:225], v3 offset:24576
  v_mfma_f32_16x16x32_bf16 v[92:95], v[236:239], v[220:223], v[92:95]
  ds_read_b64_tr_b16 v[226:227], v3 offset:25600
  ds_read_b64_tr_b16 v[228:229], v3 offset:26624
  v_mfma_f32_16x16x32_bf16 v[92:95], v[240:243], a[172:175], v[92:95]
  ds_read_b64_tr_b16 v[230:231], v3 offset:27648
  ds_read_b64_tr_b16 v[232:233], v3 offset:28672
  v_mfma_f32_16x16x32_bf16 v[92:95], v[244:247], a[180:183], v[92:95]
  ds_read_b64_tr_b16 v[234:235], v3 offset:29696
  v_mul_f32 v178, v114, v178
  v_mfma_f32_16x16x32_bf16 v[76:79], v[244:247], a[176:179], v[76:79]
  v_mul_f32 v179, v115, v179
  v_cvt_pk_bf16_f32 v114, v148, v149
  v_mfma_f32_16x16x32_bf16 v[76:79], v[240:243], a[168:171], v[76:79]
  v_mul_f32 v180, v116, v180
  v_cvt_pk_bf16_f32 v115, v150, v151
  v_mfma_f32_16x16x32_bf16 v[76:79], v[236:239], v[216:219], v[76:79]
  s_waitcnt lgkmcnt(4)
  ds_read_b64_tr_b16 v[236:237], v4 offset:24576
  ds_read_b64_tr_b16 v[238:239], v4 offset:25600
  v_mfma_f32_16x16x32_bf16 v[64:67], v[224:227], a[184:187], v[64:67]
  s_waitcnt lgkmcnt(4)
  ds_read_b64_tr_b16 v[240:241], v4 offset:26624
  ds_read_b64_tr_b16 v[242:243], v4 offset:27648
  v_mfma_f32_16x16x32_bf16 v[64:67], v[228:231], a[196:199], v[64:67]
  s_waitcnt lgkmcnt(4)
  ds_read_b64_tr_b16 v[244:245], v4 offset:28672
  ds_read_b64_tr_b16 v[246:247], v4 offset:29696
  v_mfma_f32_16x16x32_bf16 v[64:67], v[232:235], a[212:215], v[64:67]
  v_mul_f32 v181, v117, v181
  v_cvt_pk_bf16_f32 v116, v152, v153
  v_mfma_f32_16x16x32_bf16 v[80:83], v[232:235], a[220:223], v[80:83]
  v_mul_f32 v182, v118, v182
  v_cvt_pk_bf16_f32 v117, v154, v155
  v_mfma_f32_16x16x32_bf16 v[80:83], v[228:231], a[204:207], v[80:83]
  v_mul_f32 v183, v119, v183
  v_cvt_pk_bf16_f32 v118, v156, v157
  v_mfma_f32_16x16x32_bf16 v[80:83], v[224:227], a[188:191], v[80:83]
  s_waitcnt lgkmcnt(4)
  ds_read_b64_tr_b16 v[224:225], v3 offset:36864
  ds_read_b64_tr_b16 v[226:227], v3 offset:37888
  v_mfma_f32_16x16x32_bf16 v[84:87], v[236:239], a[188:191], v[84:87]
  s_waitcnt lgkmcnt(4)
  ds_read_b64_tr_b16 v[228:229], v3 offset:38912
  ds_read_b64_tr_b16 v[230:231], v3 offset:39936
  v_mfma_f32_16x16x32_bf16 v[84:87], v[240:243], a[204:207], v[84:87]
  s_waitcnt lgkmcnt(4)
  ds_read_b64_tr_b16 v[232:233], v3 offset:40960
  ds_read_b64_tr_b16 v[234:235], v3 offset:41984
  v_mfma_f32_16x16x32_bf16 v[84:87], v[244:247], a[220:223], v[84:87]
  v_mul_f32 v160, v96, v160
  v_cvt_pk_bf16_f32 v119, v158, v159
  v_mfma_f32_16x16x32_bf16 v[68:71], v[244:247], a[212:215], v[68:71]
  v_mul_f32 v161, v97, v161
  v_mul_f32 v168, v104, v168
  v_mfma_f32_16x16x32_bf16 v[68:71], v[240:243], a[196:199], v[68:71]
  v_mul_f32 v162, v98, v162
  v_cvt_pk_bf16_f32 v104, v160, v161
  v_mfma_f32_16x16x32_bf16 v[68:71], v[236:239], a[184:187], v[68:71]
  s_waitcnt lgkmcnt(4)
  ds_read_b64_tr_b16 v[236:237], v4 offset:36864
  ds_read_b64_tr_b16 v[238:239], v4 offset:37888
  v_mfma_f32_16x16x32_bf16 v[72:75], v[224:227], a[184:187], v[72:75]
  s_waitcnt lgkmcnt(4)
  ds_read_b64_tr_b16 v[240:241], v4 offset:38912
  ds_read_b64_tr_b16 v[242:243], v4 offset:39936
  v_mfma_f32_16x16x32_bf16 v[72:75], v[228:231], a[196:199], v[72:75]
  s_waitcnt lgkmcnt(4)
  s_add_u32 s89, s89, s42
  ds_read_b64_tr_b16 v[244:245], v4 offset:40960
  ds_read_b64_tr_b16 v[246:247], v4 offset:41984
  v_mfma_f32_16x16x32_bf16 v[72:75], v[232:235], a[212:215], v[72:75]
  s_add_u32 m0, s44, 86016
  v_mul_f32 v163, v99, v163
  v_mul_f32 v169, v105, v169
  v_mfma_f32_16x16x32_bf16 v[88:91], v[232:235], a[220:223], v[88:91]
  buffer_store_dwordx4 v[120:123], v1, s[4:7], s65 offen offset:0 sc1
  v_mfma_f32_16x16x32_bf16 v[88:91], v[228:231], a[204:207], v[88:91]
  v_mul_f32 v164, v100, v164
  v_cvt_pk_bf16_f32 v105, v162, v163
  v_mfma_f32_16x16x32_bf16 v[88:91], v[224:227], a[188:191], v[88:91]
  s_waitcnt lgkmcnt(4)
  ds_read_b64_tr_b16 v[224:225], v3 offset:30720
  ds_read_b64_tr_b16 v[226:227], v3 offset:31744
  v_mfma_f32_16x16x32_bf16 v[92:95], v[236:239], a[188:191], v[92:95]
  s_waitcnt lgkmcnt(4)
  ds_read_b64_tr_b16 v[228:229], v3 offset:32768
  ds_read_b64_tr_b16 v[230:231], v3 offset:33792
  v_mfma_f32_16x16x32_bf16 v[92:95], v[240:243], a[204:207], v[92:95]
  s_waitcnt lgkmcnt(4)
  ds_read_b64_tr_b16 v[232:233], v3 offset:34816
  ds_read_b64_tr_b16 v[234:235], v3 offset:35840
  buffer_load_dwordx4 v36, s[4:7], s89 offen offset:0 sc1 lds
  v_mfma_f32_16x16x32_bf16 v[92:95], v[244:247], a[220:223], v[92:95]
  v_mul_f32 v165, v101, v165
  v_mul_f32 v170, v106, v170
  v_mfma_f32_16x16x32_bf16 v[76:79], v[244:247], a[212:215], v[76:79]
  buffer_load_dwordx4 v37, s[4:7], s89 offen offset:1024 sc1 lds
  v_mfma_f32_16x16x32_bf16 v[76:79], v[240:243], a[196:199], v[76:79]
  v_mul_f32 v166, v102, v166
  v_cvt_pk_bf16_f32 v106, v164, v165
  v_mfma_f32_16x16x32_bf16 v[76:79], v[236:239], a[184:187], v[76:79]
  s_waitcnt lgkmcnt(4)
  ds_read_b64_tr_b16 v[236:237], v4 offset:30720
  ds_read_b64_tr_b16 v[238:239], v4 offset:31744
  v_mfma_f32_16x16x32_bf16 v[64:67], v[224:227], a[128:131], v[64:67]
  s_waitcnt lgkmcnt(4)
  ds_read_b64_tr_b16 v[240:241], v4 offset:32768
  ds_read_b64_tr_b16 v[242:243], v4 offset:33792
  v_mfma_f32_16x16x32_bf16 v[64:67], v[228:231], a[0:3], v[64:67]
  s_waitcnt lgkmcnt(4)
  ds_read_b64_tr_b16 v[244:245], v4 offset:34816
  ds_read_b64_tr_b16 v[246:247], v4 offset:35840
  v_mfma_f32_16x16x32_bf16 v[64:67], v[232:235], a[8:11], v[64:67]
  buffer_load_dwordx4 v38, s[4:7], s89 offen offset:2048 sc1 lds
  v_mfma_f32_16x16x32_bf16 v[80:83], v[232:235], a[12:15], v[80:83]
  v_mul_f32 v167, v103, v167
  v_mul_f32 v171, v107, v171
  v_mfma_f32_16x16x32_bf16 v[80:83], v[228:231], a[4:7], v[80:83]
  v_mul_f32 v172, v108, v172
  v_mul_f32 v173, v109, v173
  v_mfma_f32_16x16x32_bf16 v[80:83], v[224:227], a[136:139], v[80:83]
  s_waitcnt lgkmcnt(4)
  ds_read_b64_tr_b16 v[224:225], v3 offset:43008
  ds_read_b64_tr_b16 v[226:227], v3 offset:44032
  v_mfma_f32_16x16x32_bf16 v[84:87], v[236:239], a[136:139], v[84:87]
  s_waitcnt lgkmcnt(4)
  ds_read_b64_tr_b16 v[228:229], v3 offset:45056
  ds_read_b64_tr_b16 v[230:231], v3 offset:46080
  v_mfma_f32_16x16x32_bf16 v[84:87], v[240:243], a[4:7], v[84:87]
  s_waitcnt lgkmcnt(4)
  ds_read_b64_tr_b16 v[232:233], v3 offset:47104
  ds_read_b64_tr_b16 v[234:235], v3 offset:48128
  v_mfma_f32_16x16x32_bf16 v[84:87], v[244:247], a[12:15], v[84:87]
  buffer_load_dwordx4 v39, s[4:7], s89 offen offset:3072 sc1 lds
  v_mfma_f32_16x16x32_bf16 v[68:71], v[244:247], a[8:11], v[68:71]
  v_mul_f32 v174, v110, v174
  v_mul_f32 v175, v111, v175
  v_mfma_f32_16x16x32_bf16 v[68:71], v[240:243], a[0:3], v[68:71]
  s_add_u32 m0, s44, 90112
  v_cvt_pk_bf16_f32 v107, v166, v167
  v_cvt_pk_bf16_f32 v108, v168, v169
  v_mfma_f32_16x16x32_bf16 v[68:71], v[236:239], a[128:131], v[68:71]
  s_waitcnt lgkmcnt(4)
  ds_read_b64_tr_b16 v[236:237], v4 offset:43008
  ds_read_b64_tr_b16 v[238:239], v4 offset:44032
  v_mfma_f32_16x16x32_bf16 v[72:75], v[224:227], a[128:131], v[72:75]
  s_waitcnt lgkmcnt(4)
  ds_read_b64_tr_b16 v[240:241], v4 offset:45056
  ds_read_b64_tr_b16 v[242:243], v4 offset:46080
  v_mfma_f32_16x16x32_bf16 v[72:75], v[228:231], a[0:3], v[72:75]
  s_waitcnt lgkmcnt(4)
  ds_read_b64_tr_b16 v[244:245], v4 offset:47104
  ds_read_b64_tr_b16 v[246:247], v4 offset:48128
  v_mfma_f32_16x16x32_bf16 v[72:75], v[232:235], a[8:11], v[72:75]
  buffer_load_dwordx4 v40, s[4:7], s89 offen offset:0 sc1 lds
  v_mfma_f32_16x16x32_bf16 v[88:91], v[232:235], a[12:15], v[88:91]
  v_cvt_pk_bf16_f32 v109, v170, v171
  v_cvt_pk_bf16_f32 v110, v172, v173
  v_mfma_f32_16x16x32_bf16 v[88:91], v[228:231], a[4:7], v[88:91]
  buffer_store_dwordx4 v[124:127], v1, s[4:7], s66 offen offset:0 sc1
  v_mfma_f32_16x16x32_bf16 v[88:91], v[224:227], a[136:139], v[88:91]
  s_waitcnt vmcnt(20) lgkmcnt(0)
  s_barrier
  ds_read_b64_tr_b16 v[224:225], v5 offset:24576
  v_mfma_f32_16x16x32_bf16 v[92:95], v[236:239], a[136:139], v[92:95]
  ds_read_b64_tr_b16 v[226:227], v5 offset:25600
  ds_read_b64_tr_b16 v[228:229], v5 offset:26624
  v_mfma_f32_16x16x32_bf16 v[92:95], v[240:243], a[4:7], v[92:95]
  ds_read_b64_tr_b16 v[230:231], v5 offset:27648
  ds_read_b64_tr_b16 v[232:233], v5 offset:28672
  v_mfma_f32_16x16x32_bf16 v[92:95], v[244:247], a[12:15], v[92:95]
  ds_read_b64_tr_b16 v[234:235], v5 offset:29696
  v_cvt_pk_bf16_f32 v111, v174, v175
  v_mfma_f32_16x16x32_bf16 v[76:79], v[244:247], a[8:11], v[76:79]
  buffer_load_dwordx4 v41, s[4:7], s89 offen offset:1024 sc1 lds
  v_mfma_f32_16x16x32_bf16 v[76:79], v[240:243], a[0:3], v[76:79]
  v_cvt_pk_bf16_f32 v96, v176, v177
  v_cvt_pk_bf16_f32 v97, v178, v179
  v_mfma_f32_16x16x32_bf16 v[76:79], v[236:239], a[128:131], v[76:79]
  s_waitcnt lgkmcnt(4)
  ds_read_b64_tr_b16 v[236:237], v6 offset:24576
  ds_read_b64_tr_b16 v[238:239], v6 offset:25600
  v_mfma_f32_16x16x32_bf16 v[64:67], v[224:227], a[32:35], v[64:67]
  s_waitcnt lgkmcnt(4)
  ds_read_b64_tr_b16 v[240:241], v6 offset:26624
  ds_read_b64_tr_b16 v[242:243], v6 offset:27648
  v_mfma_f32_16x16x32_bf16 v[64:67], v[228:231], a[40:43], v[64:67]
  s_waitcnt lgkmcnt(4)
  ds_read_b64_tr_b16 v[244:245], v6 offset:28672
  ds_read_b64_tr_b16 v[246:247], v6 offset:29696
  v_mfma_f32_16x16x32_bf16 v[64:67], v[232:235], a[64:67], v[64:67]
  buffer_load_dwordx4 v42, s[4:7], s89 offen offset:2048 sc1 lds
  v_mfma_f32_16x16x32_bf16 v[80:83], v[232:235], a[68:71], v[80:83]
  v_cvt_pk_bf16_f32 v98, v180, v181
  v_cvt_pk_bf16_f32 v99, v182, v183
  v_mfma_f32_16x16x32_bf16 v[80:83], v[228:231], a[44:47], v[80:83]
  v_cvt_pk_bf16_f32 v100, v184, v185
  v_cvt_pk_bf16_f32 v101, v186, v187
  v_mfma_f32_16x16x32_bf16 v[80:83], v[224:227], a[36:39], v[80:83]
  s_waitcnt lgkmcnt(4)
  ds_read_b64_tr_b16 v[224:225], v5 offset:36864
  ds_read_b64_tr_b16 v[226:227], v5 offset:37888
  v_mfma_f32_16x16x32_bf16 v[84:87], v[236:239], a[36:39], v[84:87]
  s_waitcnt lgkmcnt(4)
  ds_read_b64_tr_b16 v[228:229], v5 offset:38912
  ds_read_b64_tr_b16 v[230:231], v5 offset:39936
  v_mfma_f32_16x16x32_bf16 v[84:87], v[240:243], a[44:47], v[84:87]
  s_waitcnt lgkmcnt(4)
  ds_read_b64_tr_b16 v[232:233], v5 offset:40960
  ds_read_b64_tr_b16 v[234:235], v5 offset:41984
  v_mfma_f32_16x16x32_bf16 v[84:87], v[244:247], a[68:71], v[84:87]
  buffer_load_dwordx4 v43, s[4:7], s89 offen offset:3072 sc1 lds
  v_mfma_f32_16x16x32_bf16 v[68:71], v[244:247], a[64:67], v[68:71]
  s_add_u32 m0, s44, 94208
  v_cvt_pk_bf16_f32 v102, v188, v189
  v_cvt_pk_bf16_f32 v103, v190, v191
  v_mfma_f32_16x16x32_bf16 v[68:71], v[240:243], a[40:43], v[68:71]
  buffer_load_dwordx4 v44, s[4:7], s89 offen offset:0 sc1 lds
  v_mfma_f32_16x16x32_bf16 v[68:71], v[236:239], a[32:35], v[68:71]
  s_waitcnt lgkmcnt(4)
  ds_read_b64_tr_b16 v[236:237], v6 offset:36864
  ds_read_b64_tr_b16 v[238:239], v6 offset:37888
  v_mfma_f32_16x16x32_bf16 v[72:75], v[224:227], a[32:35], v[72:75]
  s_waitcnt lgkmcnt(4)
  ds_read_b64_tr_b16 v[240:241], v6 offset:38912
  ds_read_b64_tr_b16 v[242:243], v6 offset:39936
  v_mfma_f32_16x16x32_bf16 v[72:75], v[228:231], a[40:43], v[72:75]
  s_waitcnt lgkmcnt(4)
  s_add_u32 s88, s88, 4096
  ds_read_b64_tr_b16 v[244:245], v6 offset:40960
  ds_read_b64_tr_b16 v[246:247], v6 offset:41984
  v_mfma_f32_16x16x32_bf16 v[72:75], v[232:235], a[64:67], v[72:75]
  buffer_store_dwordx4 v[112:115], v1, s[4:7], s65 offen offset:1024 sc1
  v_mfma_f32_16x16x32_bf16 v[88:91], v[232:235], a[68:71], v[88:91]
  s_cmp_eq_u32 s34, 1
  s_cselect_b32 s26, s33, s32
  s_cselect_b32 s27, s32, s31
  v_mfma_f32_16x16x32_bf16 v[88:91], v[228:231], a[44:47], v[88:91]
  s_cmp_eq_u32 s30, s101
  s_cselect_b32 s100, s33, s100
  v_mfma_f32_16x16x32_bf16 v[88:91], v[224:227], a[36:39], v[88:91]
  s_waitcnt lgkmcnt(4)
  ds_read_b64_tr_b16 v[224:225], v5 offset:30720
  ds_read_b64_tr_b16 v[226:227], v5 offset:31744
  v_mfma_f32_16x16x32_bf16 v[92:95], v[236:239], a[36:39], v[92:95]
pad_m_15:
  s_cbranch_execz warm_3
  s_waitcnt lgkmcnt(4)
  ds_read_b64_tr_b16 v[228:229], v5 offset:32768
  ds_read_b64_tr_b16 v[230:231], v5 offset:33792
  v_mfma_f32_16x16x32_bf16 v[92:95], v[240:243], a[44:47], v[92:95]
  s_waitcnt lgkmcnt(4)
  ds_read_b64_tr_b16 v[232:233], v5 offset:34816
  ds_read_b64_tr_b16 v[234:235], v5 offset:35840
  buffer_load_dwordx4 a[216:219], v28, s[4:7], s88 offen sc1
  v_mfma_f32_16x16x32_bf16 v[92:95], v[244:247], a[68:71], v[92:95]
  s_cmp_eq_u32 s31, s101
  s_cselect_b32 s100, s26, s100
  v_mfma_f32_16x16x32_bf16 v[76:79], v[244:247], a[64:67], v[76:79]
  buffer_load_dwordx4 a[144:147], v29, s[4:7], s88 offen sc1
  v_mfma_f32_16x16x32_bf16 v[76:79], v[240:243], a[40:43], v[76:79]
  s_cmp_eq_u32 s32, s101
  s_cselect_b32 s100, s27, s100
  v_mfma_f32_16x16x32_bf16 v[76:79], v[236:239], a[32:35], v[76:79]
  s_waitcnt lgkmcnt(4)
  s_add_u32 s99, s99, s100
  ds_read_b64_tr_b16 v[236:237], v6 offset:30720
  ds_read_b64_tr_b16 v[238:239], v6 offset:31744
  v_mfma_f32_16x16x32_bf16 v[64:67], v[224:227], a[72:75], v[64:67]
  s_waitcnt lgkmcnt(4)
  s_lshr_b64 s[28:29], s[24:25], s99
  ds_read_b64_tr_b16 v[240:241], v6 offset:32768
  ds_read_b64_tr_b16 v[242:243], v6 offset:33792
  v_mfma_f32_16x16x32_bf16 v[64:67], v[228:231], a[96:99], v[64:67]
  s_waitcnt lgkmcnt(4)
  s_and_b32 s99, s28, 1
  ds_read_b64_tr_b16 v[244:245], v6 offset:34816
  ds_read_b64_tr_b16 v[246:247], v6 offset:35840
  v_mfma_f32_16x16x32_bf16 v[64:67], v[232:235], a[104:107], v[64:67]
  buffer_load_dwordx4 a[132:135], v30, s[4:7], s88 offen sc1
  v_mfma_f32_16x16x32_bf16 v[80:83], v[232:235], a[108:111], v[80:83]
  s_cmp_eq_u32 s31, s101
  s_cselect_b32 s62, s34, 0
  v_mfma_f32_16x16x32_bf16 v[80:83], v[228:231], a[100:103], v[80:83]
  s_cmp_eq_u32 s33, s101
  s_cselect_b32 s34, s34, 0
  v_mfma_f32_16x16x32_bf16 v[80:83], v[224:227], a[76:79], v[80:83]
  s_waitcnt lgkmcnt(4)
  s_sub_u32 s77, s77, s34
  ds_read_b64_tr_b16 v[224:225], v5 offset:43008
  ds_read_b64_tr_b16 v[226:227], v5 offset:44032
  v_mfma_f32_16x16x32_bf16 v[84:87], v[236:239], a[76:79], v[84:87]
  s_waitcnt lgkmcnt(4)
  s_add_u32 s77, s77, s99
  ds_read_b64_tr_b16 v[228:229], v5 offset:45056
  ds_read_b64_tr_b16 v[230:231], v5 offset:46080
  v_mfma_f32_16x16x32_bf16 v[84:87], v[240:243], a[100:103], v[84:87]
  s_waitcnt lgkmcnt(4)
  s_lshl_b32 s99, s100, 3
  ds_read_b64_tr_b16 v[232:233], v5 offset:47104
  ds_read_b64_tr_b16 v[234:235], v5 offset:48128
  v_mfma_f32_16x16x32_bf16 v[84:87], v[244:247], a[108:111], v[84:87]
  s_add_u32 s99, s99, s101
  ds_read_b128 a[112:115], v45 offset:8192
  ds_read_b128 a[116:119], v45 offset:17408
  v_mfma_f32_16x16x32_bf16 v[68:71], v[244:247], a[104:107], v[68:71]
  s_lshr_b64 s[28:29], s[24:25], s99
  ds_read_b128 a[120:123], v45 offset:26624
  ds_read_b128 a[124:127], v45 offset:35840
  v_mfma_f32_16x16x32_bf16 v[68:71], v[240:243], a[96:99], v[68:71]
  buffer_load_dwordx4 a[140:143], v31, s[4:7], s88 offen sc1
  v_mfma_f32_16x16x32_bf16 v[68:71], v[236:239], a[72:75], v[68:71]
  s_waitcnt lgkmcnt(8)
  s_add_u32 s88, s88, 4096
  ds_read_b64_tr_b16 v[236:237], v6 offset:43008
  ds_read_b64_tr_b16 v[238:239], v6 offset:44032
  v_mfma_f32_16x16x32_bf16 v[72:75], v[224:227], a[72:75], v[72:75]
  s_waitcnt lgkmcnt(8)
  s_and_b32 s99, s28, 1
  ds_read_b64_tr_b16 v[240:241], v6 offset:45056
  ds_read_b64_tr_b16 v[242:243], v6 offset:46080
  v_mfma_f32_16x16x32_bf16 v[72:75], v[228:231], a[96:99], v[72:75]
  s_waitcnt lgkmcnt(8)
  s_sub_u32 s77, s77, s99
  ds_read_b64_tr_b16 v[244:245], v6 offset:47104
  ds_read_b64_tr_b16 v[246:247], v6 offset:48128
  v_mfma_f32_16x16x32_bf16 v[72:75], v[232:235], a[104:107], v[72:75]
  buffer_load_dwordx4 a[16:19], v28, s[4:7], s88 offen sc1
  v_mfma_f32_16x16x32_bf16 v[88:91], v[232:235], a[108:111], v[88:91]
  s_lshr_b32 s99, s100, 1
  v_mfma_f32_16x16x32_bf16 v[88:91], v[228:231], a[100:103], v[88:91]
  buffer_store_dwordx4 v[116:119], v1, s[4:7], s66 offen offset:1024 sc1
  v_mfma_f32_16x16x32_bf16 v[88:91], v[224:227], a[76:79], v[88:91]
  s_waitcnt lgkmcnt(4)
  s_sub_u32 s99, s99, s52
  v_mfma_f32_16x16x32_bf16 v[92:95], v[236:239], a[76:79], v[92:95]
  s_waitcnt lgkmcnt(2)
  s_lshl_b32 s71, s99, 8
  v_mfma_f32_16x16x32_bf16 v[92:95], v[240:243], a[100:103], v[92:95]
  s_waitcnt lgkmcnt(0)
  buffer_load_dwordx4 a[20:23], v29, s[4:7], s88 offen sc1
  v_mfma_f32_16x16x32_bf16 v[92:95], v[244:247], a[108:111], v[92:95]
  s_add_u32 s71, s71, s46
  v_mfma_f32_16x16x32_bf16 v[76:79], v[244:247], a[104:107], v[76:79]
  s_cmp_eq_u32 s51, 0
  s_cselect_b32 s70, s46, s71
  v_mfma_f32_16x16x32_bf16 v[76:79], v[240:243], a[96:99], v[76:79]
  s_mul_i32 s69, s99, 147456
  v_mfma_f32_16x16x32_bf16 v[76:79], v[236:239], a[72:75], v[76:79]
  ds_read_b128 a[168:171], v45 offset:7168
  ds_read_b128 a[172:175], v45 offset:16384
  v_mfma_f32_16x16x32_bf16 v[240:243], a[112:115], a[224:227], 0
  s_waitcnt vmcnt(30)
  s_add_u32 s69, s69, s47
  ds_read_b128 a[176:179], v45 offset:25600
  ds_read_b128 a[180:183], v45 offset:34816
  v_mfma_f32_16x16x32_bf16 v[240:243], a[116:119], a[240:243], v[240:243]
  s_waitcnt vmcnt(26)
  buffer_load_dwordx4 a[24:27], v30, s[4:7], s88 offen sc1
  v_mfma_f32_16x16x32_bf16 v[240:243], a[120:123], a[148:151], v[240:243]
  s_waitcnt vmcnt(23)
  s_and_b32 s100, s100, 1
  v_mfma_f32_16x16x32_bf16 v[240:243], a[124:127], a[164:167], v[240:243]
  s_waitcnt vmcnt(22)
  s_and_b32 s101, s2, 1
  v_mfma_f32_16x16x32_bf16 v[244:247], a[124:127], a[192:195], 0
  s_add_u32 s101, s101, s100
  v_mul_f32 v64, s72, v64
  v_mul_f32 v65, s72, v65
  v_mfma_f32_16x16x32_bf16 v[244:247], a[120:123], a[152:155], v[244:247]
  buffer_load_dwordx4 a[28:31], v31, s[4:7], s88 offen sc1
  v_mfma_f32_16x16x32_bf16 v[244:247], a[116:119], a[244:247], v[244:247]
  s_lshl_b32 s101, s101, 4
  v_mul_f32 v66, s72, v66
  v_mul_f32 v67, s72, v67
  v_mfma_f32_16x16x32_bf16 v[244:247], a[112:115], a[228:231], v[244:247]
  s_add_u32 s88, s88, 4096
  v_mul_f32 v68, s72, v68
  v_mul_f32 v69, s72, v69
  v_mfma_f32_16x16x32_bf16 v[248:251], a[112:115], a[232:235], 0
  s_lshl_b32 s68, s99, 5
  v_mul_f32 v70, s72, v70
  v_mul_f32 v71, s72, v71
  v_mfma_f32_16x16x32_bf16 v[248:251], a[116:119], a[248:251], v[248:251]
  s_add_u32 s68, s68, 26
  v_exp_f32 v64, v64
  v_mfma_f32_16x16x32_bf16 v[248:251], a[120:123], a[156:159], v[248:251]
  s_waitcnt vmcnt(22)
  buffer_load_dwordx4 a[48:51], v28, s[4:7], s88 offen sc1
  v_mfma_f32_16x16x32_bf16 v[248:251], a[124:127], a[200:203], v[248:251]
  s_waitcnt vmcnt(22)
  s_sub_u32 s101, s68, s101
  v_exp_f32 v65, v65
  v_mfma_f32_16x16x32_bf16 v[252:255], a[124:127], a[208:211], 0
  s_mul_i32 s101, s101, 36864
  v_exp_f32 v66, v66
  v_mfma_f32_16x16x32_bf16 v[252:255], a[120:123], a[160:163], v[252:255]
  buffer_store_dwordx4 v[104:107], v2, s[4:7], s65 offen offset:0 sc1
  v_mfma_f32_16x16x32_bf16 v[252:255], a[116:119], a[252:255], v[252:255]
  s_add_u32 s101, s101, s41
  v_exp_f32 v67, v67
  v_mfma_f32_16x16x32_bf16 v[252:255], a[112:115], a[236:239], v[252:255]
  s_waitcnt lgkmcnt(0)
  ds_read_b128 a[184:187], v45 offset:0
  ds_read_b128 a[188:191], v45 offset:9216
  v_mfma_f32_16x16x32_bf16 v[236:239], a[168:171], a[236:239], 0
  s_lshl_b32 s100, s100, 3
  ds_read_b128 a[196:199], v45 offset:18432
  ds_read_b128 a[204:207], v45 offset:27648
  v_mfma_f32_16x16x32_bf16 v[236:239], a[172:175], a[252:255], v[236:239]
  buffer_load_dwordx4 a[52:55], v29, s[4:7], s88 offen sc1
  v_mfma_f32_16x16x32_bf16 v[236:239], a[176:179], a[160:163], v[236:239]
  s_sub_u32 s100, 28, s100
  v_exp_f32 v68, v68
  v_mfma_f32_16x16x32_bf16 v[236:239], a[180:183], a[208:211], v[236:239]
  s_mul_i32 s68, s99, 36
  v_exp_f32 v69, v69
  v_mfma_f32_16x16x32_bf16 v[232:235], a[180:183], a[200:203], 0
  v_exp_f32 v70, v70
  v_mfma_f32_16x16x32_bf16 v[232:235], a[176:179], a[156:159], v[232:235]
  buffer_load_dwordx4 a[56:59], v30, s[4:7], s88 offen sc1
  v_mfma_f32_16x16x32_bf16 v[232:235], a[172:175], a[248:251], v[232:235]
  v_exp_f32 v71, v71
  v_mfma_f32_16x16x32_bf16 v[232:235], a[168:171], a[232:235], v[232:235]
  v_add_f32 v64, 1.0, v64
  v_add_f32 v65, 1.0, v65
  v_mfma_f32_16x16x32_bf16 v[228:231], a[168:171], a[228:231], 0
  v_add_f32 v66, 1.0, v66
  v_add_f32 v67, 1.0, v67
  v_mfma_f32_16x16x32_bf16 v[228:231], a[172:175], a[244:247], v[228:231]
  v_add_f32 v68, 1.0, v68
  v_add_f32 v69, 1.0, v69
  v_mfma_f32_16x16x32_bf16 v[228:231], a[176:179], a[152:155], v[228:231]
  buffer_load_dwordx4 a[60:63], v31, s[4:7], s88 offen sc1
  v_mfma_f32_16x16x32_bf16 v[228:231], a[180:183], a[192:195], v[228:231]
  v_add_f32 v70, 1.0, v70
  v_add_f32 v71, 1.0, v71
  v_mfma_f32_16x16x32_bf16 v[224:227], a[180:183], a[164:167], 0
  v_rcp_f32 v64, v64
  v_mfma_f32_16x16x32_bf16 v[224:227], a[176:179], a[148:151], v[224:227]
  s_add_u32 s88, s88, 4096
  v_rcp_f32 v65, v65
  v_mfma_f32_16x16x32_bf16 v[224:227], a[172:175], a[240:243], v[224:227]
  v_rcp_f32 v66, v66
  v_mfma_f32_16x16x32_bf16 v[224:227], a[168:171], a[224:227], v[224:227]
  s_waitcnt lgkmcnt(0)
  ds_read_b128 a[212:215], v45 offset:1024
  ds_read_b128 a[220:223], v45 offset:10240
  v_mfma_f32_16x16x32_bf16 v[208:211], a[184:187], a[224:227], 0
  ds_read_b128 a[128:131], v45 offset:19456
  ds_read_b128 a[136:139], v45 offset:28672
  v_mfma_f32_16x16x32_bf16 v[208:211], a[188:191], a[240:243], v[208:211]
  buffer_load_dwordx4 a[80:83], v28, s[4:7], s88 offen sc1
  v_mfma_f32_16x16x32_bf16 v[208:211], a[196:199], a[148:151], v[208:211]
  v_rcp_f32 v67, v67
  v_mfma_f32_16x16x32_bf16 v[208:211], a[204:207], a[164:167], v[208:211]
  v_rcp_f32 v68, v68
  v_mfma_f32_16x16x32_bf16 v[212:215], a[204:207], a[192:195], 0
  v_rcp_f32 v69, v69
  v_mfma_f32_16x16x32_bf16 v[212:215], a[196:199], a[152:155], v[212:215]
  buffer_load_dwordx4 a[84:87], v29, s[4:7], s88 offen sc1
  v_mfma_f32_16x16x32_bf16 v[212:215], a[188:191], a[244:247], v[212:215]
  v_rcp_f32 v70, v70
  v_mfma_f32_16x16x32_bf16 v[212:215], a[184:187], a[228:231], v[212:215]
  buffer_load_dword v59, off, s[4:7], s46 sc1
  v_mfma_f32_16x16x32_bf16 v[216:219], a[184:187], a[232:235], 0
  v_rcp_f32 v71, v71
  v_mfma_f32_16x16x32_bf16 v[216:219], a[188:191], a[248:251], v[216:219]
  buffer_store_dwordx4 v[108:111], v2, s[4:7], s66 offen offset:0 sc1
  v_mfma_f32_16x16x32_bf16 v[216:219], a[196:199], a[156:159], v[216:219]
  v_mul_f32 v64, v64, v72
  v_mul_f32 v65, v65, v73
  v_mfma_f32_16x16x32_bf16 v[216:219], a[204:207], a[200:203], v[216:219]
  v_mul_f32 v66, v66, v74
  v_mul_f32 v67, v67, v75
  v_mfma_f32_16x16x32_bf16 v[220:223], a[204:207], a[208:211], 0
  buffer_load_dwordx4 a[88:91], v30, s[4:7], s88 offen sc1
  v_mfma_f32_16x16x32_bf16 v[220:223], a[196:199], a[160:163], v[220:223]
  v_mul_f32 v68, v68, v76
  v_mul_f32 v69, v69, v77
  v_mfma_f32_16x16x32_bf16 v[220:223], a[188:191], a[252:255], v[220:223]
  v_mul_f32 v70, v70, v78
  v_mul_f32 v71, v71, v79
  v_mfma_f32_16x16x32_bf16 v[220:223], a[184:187], a[236:239], v[220:223]
  s_waitcnt lgkmcnt(0)
  ds_read_b128 a[112:115], v45 offset:4096
  ds_read_b128 a[116:119], v45 offset:13312
  v_mfma_f32_16x16x32_bf16 v[204:207], a[212:215], a[236:239], 0
  ds_read_b128 a[120:123], v45 offset:22528
  ds_read_b128 a[124:127], v45 offset:31744
  v_mfma_f32_16x16x32_bf16 v[204:207], a[220:223], a[252:255], v[204:207]
  buffer_load_dwordx4 a[92:95], v31, s[4:7], s88 offen sc1
  v_mfma_f32_16x16x32_bf16 v[204:207], a[128:131], a[160:163], v[204:207]
  s_add_u32 s89, s89, s79
  v_cvt_pk_bf16_f32 v64, v64, v65
  v_mul_f32 v80, s72, v80
  v_mfma_f32_16x16x32_bf16 v[204:207], a[136:139], a[208:211], v[204:207]
  s_add_u32 m0, s44, 0
  v_cvt_pk_bf16_f32 v65, v66, v67
  v_mul_f32 v81, s72, v81
  v_mfma_f32_16x16x32_bf16 v[200:203], a[136:139], a[200:203], 0
  v_cvt_pk_bf16_f32 v66, v68, v69
  v_cvt_pk_bf16_f32 v67, v70, v71
  v_mfma_f32_16x16x32_bf16 v[200:203], a[128:131], a[156:159], v[200:203]
  buffer_load_dwordx4 v36, s[4:7], s89 offen offset:0 sc1 lds
  v_mfma_f32_16x16x32_bf16 v[200:203], a[220:223], a[248:251], v[200:203]
  v_mul_f32 v82, s72, v82
  v_mul_f32 v83, s72, v83
  v_mfma_f32_16x16x32_bf16 v[200:203], a[212:215], a[232:235], v[200:203]
  v_mul_f32 v84, s72, v84
  v_mul_f32 v85, s72, v85
  v_mfma_f32_16x16x32_bf16 v[196:199], a[212:215], a[228:231], 0
  v_mul_f32 v86, s72, v86
  v_mul_f32 v87, s72, v87
  v_mfma_f32_16x16x32_bf16 v[196:199], a[220:223], a[244:247], v[196:199]
  v_exp_f32 v80, v80
  v_mfma_f32_16x16x32_bf16 v[196:199], a[128:131], a[152:155], v[196:199]
  v_exp_f32 v81, v81
  v_mfma_f32_16x16x32_bf16 v[196:199], a[136:139], a[192:195], v[196:199]
  buffer_load_dwordx4 v37, s[4:7], s89 offen offset:1024 sc1 lds
  v_mfma_f32_16x16x32_bf16 v[192:195], a[136:139], a[164:167], 0
  v_exp_f32 v82, v82
  v_mfma_f32_16x16x32_bf16 v[192:195], a[128:131], a[148:151], v[192:195]
  buffer_store_dwordx4 v[96:99], v2, s[4:7], s65 offen offset:1024 sc1
  v_mfma_f32_16x16x32_bf16 v[192:195], a[220:223], a[240:243], v[192:195]
  v_exp_f32 v83, v83
  v_mfma_f32_16x16x32_bf16 v[192:195], a[212:215], a[224:227], v[192:195]
  s_waitcnt lgkmcnt(0)
  ds_read_b128 a[168:171], v45 offset:6144
  ds_read_b128 a[172:175], v45 offset:15360
  v_mfma_f32_16x16x32_bf16 v[176:179], a[112:115], a[224:227], 0
  ds_read_b128 a[176:179], v45 offset:24576
  ds_read_b128 a[180:183], v45 offset:33792
  v_mfma_f32_16x16x32_bf16 v[176:179], a[116:119], a[240:243], v[176:179]
  buffer_load_dwordx4 v38, s[4:7], s89 offen offset:2048 sc1 lds
  v_mfma_f32_16x16x32_bf16 v[176:179], a[120:123], a[148:151], v[176:179]
  v_exp_f32 v84, v84
  v_mfma_f32_16x16x32_bf16 v[176:179], a[124:127], a[164:167], v[176:179]
  v_exp_f32 v85, v85
  v_mfma_f32_16x16x32_bf16 v[180:183], a[124:127], a[192:195], 0
  v_exp_f32 v86, v86
  v_mfma_f32_16x16x32_bf16 v[180:183], a[120:123], a[152:155], v[180:183]
  buffer_load_dwordx4 v39, s[4:7], s89 offen offset:3072 sc1 lds
  v_mfma_f32_16x16x32_bf16 v[180:183], a[116:119], a[244:247], v[180:183]
  v_exp_f32 v87, v87
  v_mfma_f32_16x16x32_bf16 v[180:183], a[112:115], a[228:231], v[180:183]
  v_add_f32 v80, 1.0, v80
  v_add_f32 v81, 1.0, v81
  v_mfma_f32_16x16x32_bf16 v[184:187], a[112:115], a[232:235], 0
  s_add_u32 m0, s44, 4096
  v_add_f32 v82, 1.0, v82
  v_add_f32 v83, 1.0, v83
  v_mfma_f32_16x16x32_bf16 v[184:187], a[116:119], a[248:251], v[184:187]
  v_add_f32 v84, 1.0, v84
  v_add_f32 v85, 1.0, v85
  v_mfma_f32_16x16x32_bf16 v[184:187], a[120:123], a[156:159], v[184:187]
  v_add_f32 v86, 1.0, v86
  v_add_f32 v87, 1.0, v87
  v_mfma_f32_16x16x32_bf16 v[184:187], a[124:127], a[200:203], v[184:187]
  buffer_load_dwordx4 v40, s[4:7], s89 offen offset:0 sc1 lds
  v_mfma_f32_16x16x32_bf16 v[188:191], a[124:127], a[208:211], 0
  v_rcp_f32 v80, v80
  v_mfma_f32_16x16x32_bf16 v[188:191], a[120:123], a[160:163], v[188:191]
  v_rcp_f32 v81, v81
  v_mfma_f32_16x16x32_bf16 v[188:191], a[116:119], a[252:255], v[188:191]
  v_rcp_f32 v82, v82
  v_mfma_f32_16x16x32_bf16 v[188:191], a[112:115], a[236:239], v[188:191]
  s_waitcnt lgkmcnt(0)
  ds_read_b128 a[184:187], v45 offset:5120
  ds_read_b128 a[188:191], v45 offset:14336
  v_mfma_f32_16x16x32_bf16 v[172:175], a[168:171], a[236:239], 0
  ds_read_b128 a[196:199], v45 offset:23552
  ds_read_b128 a[204:207], v45 offset:32768
  v_mfma_f32_16x16x32_bf16 v[172:175], a[172:175], a[252:255], v[172:175]
  buffer_load_dwordx4 v41, s[4:7], s89 offen offset:1024 sc1 lds
  v_mfma_f32_16x16x32_bf16 v[172:175], a[176:179], a[160:163], v[172:175]
  v_rcp_f32 v83, v83
  v_mfma_f32_16x16x32_bf16 v[172:175], a[180:183], a[208:211], v[172:175]
  v_rcp_f32 v84, v84
  v_mfma_f32_16x16x32_bf16 v[168:171], a[180:183], a[200:203], 0
  v_rcp_f32 v85, v85
  v_mfma_f32_16x16x32_bf16 v[168:171], a[176:179], a[156:159], v[168:171]
  buffer_load_dwordx4 v42, s[4:7], s89 offen offset:2048 sc1 lds
  v_mfma_f32_16x16x32_bf16 v[168:171], a[172:175], a[248:251], v[168:171]
  v_rcp_f32 v86, v86
  v_mfma_f32_16x16x32_bf16 v[168:171], a[168:171], a[232:235], v[168:171]
  buffer_store_dwordx4 v[100:103], v2, s[4:7], s66 offen offset:1024 sc1
  v_mfma_f32_16x16x32_bf16 v[164:167], a[168:171], a[228:231], 0
  v_rcp_f32 v87, v87
  v_mfma_f32_16x16x32_bf16 v[164:167], a[172:175], a[244:247], v[164:167]
  v_mul_f32 v80, v80, v88
  v_mul_f32 v81, v81, v89
  v_mfma_f32_16x16x32_bf16 v[164:167], a[176:179], a[152:155], v[164:167]
  v_mul_f32 v82, v82, v90
  v_mul_f32 v83, v83, v91
  v_mfma_f32_16x16x32_bf16 v[164:167], a[180:183], a[192:195], v[164:167]
  buffer_load_dwordx4 v43, s[4:7], s89 offen offset:3072 sc1 lds
  v_mfma_f32_16x16x32_bf16 v[160:163], a[180:183], a[164:167], 0
  v_mul_f32 v84, v84, v92
  v_mul_f32 v85, v85, v93
  v_mfma_f32_16x16x32_bf16 v[160:163], a[176:179], a[148:151], v[160:163]
  s_add_u32 m0, s44, 8192
  v_mul_f32 v86, v86, v94
  v_mul_f32 v87, v87, v95
  v_mfma_f32_16x16x32_bf16 v[160:163], a[172:175], a[240:243], v[160:163]
  v_cvt_pk_bf16_f32 v80, v80, v81
  v_mfma_f32_16x16x32_bf16 v[160:163], a[168:171], a[224:227], v[160:163]
  s_waitcnt lgkmcnt(0)
  ds_read_b128 a[212:215], v45 offset:2048
  ds_read_b128 a[220:223], v45 offset:11264
  v_mfma_f32_16x16x32_bf16 v[144:147], a[184:187], a[224:227], 0
  ds_read_b128 a[128:131], v45 offset:20480
  ds_read_b128 a[136:139], v45 offset:29696
  v_mfma_f32_16x16x32_bf16 v[144:147], a[188:191], a[240:243], v[144:147]
  s_waitcnt vmcnt(13)
  v_readfirstlane_b32 s73, v59
  s_nop 0
  s_and_b32 s73, s73, 68
  s_cmp_ge_u32 s73, 68
  s_cbranch_scc0 spin_k2
back_k2:
  v_mfma_f32_16x16x32_bf16 v[144:147], a[196:199], a[148:151], v[144:147]
  buffer_load_dwordx4 v44, s[4:7], s89 offen offset:0 sc1 lds
  v_mfma_f32_16x16x32_bf16 v[144:147], a[204:207], a[164:167], v[144:147]
  s_add_u32 s88, s88, s11
  v_cvt_pk_bf16_f32 v81, v82, v83
  v_mfma_f32_16x16x32_bf16 v[148:151], a[204:207], a[192:195], 0
  v_cvt_pk_bf16_f32 v82, v84, v85
  v_cvt_pk_bf16_f32 v83, v86, v87
  v_mfma_f32_16x16x32_bf16 v[148:151], a[196:199], a[152:155], v[148:151]
  buffer_load_dwordx4 a[0:3], v28, s[4:7], s88 offen sc1
  v_mfma_f32_16x16x32_bf16 v[148:151], a[188:191], a[244:247], v[148:151]
  s_cmp_eq_u32 s62, 1
  s_cselect_b32 s69, s101, s69
  s_cselect_b32 s100, s100, 32
  v_mfma_f32_16x16x32_bf16 v[148:151], a[184:187], a[228:231], v[148:151]
  s_add_u32 s68, s68, s100
  v_mfma_f32_16x16x32_bf16 v[152:155], a[184:187], a[232:235], 0
  s_lshl_b32 s68, s68, 12
  v_mfma_f32_16x16x32_bf16 v[152:155], a[188:191], a[248:251], v[152:155]
  s_add_u32 s68, s68, s40
  v_mfma_f32_16x16x32_bf16 v[152:155], a[196:199], a[156:159], v[152:155]
  s_lshl_b32 s62, s62, 2
  v_mfma_f32_16x16x32_bf16 v[152:155], a[204:207], a[200:203], v[152:155]
  buffer_load_dwordx4 a[4:7], v29, s[4:7], s88 offen sc1
  v_mfma_f32_16x16x32_bf16 v[156:159], a[204:207], a[208:211], 0
  s_mul_i32 s100, s99, 32
  v_mfma_f32_16x16x32_bf16 v[156:159], a[196:199], a[160:163], v[156:159]
  s_add_u32 s100, s100, 28
  v_mfma_f32_16x16x32_bf16 v[156:159], a[188:191], a[252:255], v[156:159]
  s_sub_u32 s100, s100, s62
  v_mfma_f32_16x16x32_bf16 v[156:159], a[184:187], a[236:239], v[156:159]
  s_waitcnt lgkmcnt(0)
  ds_read_b128 a[112:115], v45 offset:3072
  ds_read_b128 a[116:119], v45 offset:12288
  v_mfma_f32_16x16x32_bf16 v[140:143], a[212:215], a[236:239], 0
  s_mul_i32 s101, s100, 36864
  ds_read_b128 a[120:123], v45 offset:21504
  ds_read_b128 a[124:127], v45 offset:30720
  v_mfma_f32_16x16x32_bf16 v[140:143], a[220:223], a[252:255], v[140:143]
  buffer_load_dwordx4 a[8:11], v30, s[4:7], s88 offen sc1
  v_mfma_f32_16x16x32_bf16 v[140:143], a[128:131], a[160:163], v[140:143]
  s_add_u32 s101, s101, s41
  v_mfma_f32_16x16x32_bf16 v[140:143], a[136:139], a[208:211], v[140:143]
  s_cmp_eq_u32 s51, 0
  s_cselect_b32 s47, s47, s101
  s_cselect_b32 s100, 32, s100
  v_mfma_f32_16x16x32_bf16 v[136:139], a[136:139], a[200:203], 0
  s_lshl_b32 s100, s100, 12
  v_mfma_f32_16x16x32_bf16 v[136:139], a[128:131], a[156:159], v[136:139]
  buffer_load_dwordx4 a[12:15], v31, s[4:7], s88 offen sc1
  v_mfma_f32_16x16x32_bf16 v[136:139], a[220:223], a[248:251], v[136:139]
  s_add_u32 s67, s40, s100
  v_mfma_f32_16x16x32_bf16 v[136:139], a[212:215], a[232:235], v[136:139]
  v_mfma_f32_16x16x32_bf16 v[132:135], a[212:215], a[228:231], 0
  s_add_u32 s88, s88, 4096
  v_mfma_f32_16x16x32_bf16 v[132:135], a[220:223], a[244:247], v[132:135]
  v_mfma_f32_16x16x32_bf16 v[132:135], a[128:131], a[152:155], v[132:135]
  v_mfma_f32_16x16x32_bf16 v[132:135], a[136:139], a[192:195], v[132:135]
  buffer_load_dwordx4 a[32:35], v28, s[4:7], s88 offen sc1
  v_mfma_f32_16x16x32_bf16 v[128:131], a[136:139], a[164:167], 0
  s_mov_b64 exec, 0
  s_cmp_eq_u32 s57, 0
  s_cbranch_scc1 pad_m_16
  s_cmp_eq_u32 s57, 1
  s_cbranch_scc1 pad_m_17
  s_cmp_eq_u32 s57, 2
  s_cbranch_scc1 pad_m_18
  s_branch pad_m_19
warm_4:
  s_mov_b64 exec, -1
  s_nop 3
  v_mfma_f32_16x16x32_bf16 v[128:131], a[128:131], a[148:151], v[128:131]
  s_waitcnt lgkmcnt(0)
  s_barrier
  v_mfma_f32_16x16x32_bf16 v[128:131], a[220:223], a[240:243], v[128:131]
  v_mfma_f32_16x16x32_bf16 v[128:131], a[212:215], a[224:227], v[128:131]
  ds_read_b128 a[168:171], v46 offset:8192
  ds_read_b128 a[172:175], v46 offset:17408
  v_mfma_f32_16x16x32_bf16 v[112:115], a[112:115], a[224:227], 0
  ds_read_b128 a[176:179], v46 offset:26624
  ds_read_b128 a[180:183], v46 offset:35840
  v_mfma_f32_16x16x32_bf16 v[112:115], a[116:119], a[240:243], v[112:115]
  buffer_load_dwordx4 a[36:39], v29, s[4:7], s88 offen sc1
  v_mfma_f32_16x16x32_bf16 v[112:115], a[120:123], a[148:151], v[112:115]
  v_mfma_f32_16x16x32_bf16 v[112:115], a[124:127], a[164:167], v[112:115]
  v_mfma_f32_16x16x32_bf16 v[116:119], a[124:127], a[192:195], 0
  v_mfma_f32_16x16x32_bf16 v[116:119], a[120:123], a[152:155], v[116:119]
  buffer_load_dwordx4 a[40:43], v30, s[4:7], s88 offen sc1
  v_mfma_f32_16x16x32_bf16 v[116:119], a[116:119], a[244:247], v[116:119]
  v_mfma_f32_16x16x32_bf16 v[116:119], a[112:115], a[228:231], v[116:119]
  v_mfma_f32_16x16x32_bf16 v[120:123], a[112:115], a[232:235], 0
  v_mfma_f32_16x16x32_bf16 v[120:123], a[116:119], a[248:251], v[120:123]
  v_mfma_f32_16x16x32_bf16 v[120:123], a[120:123], a[156:159], v[120:123]
  v_mfma_f32_16x16x32_bf16 v[120:123], a[124:127], a[200:203], v[120:123]
  buffer_load_dwordx4 a[44:47], v31, s[4:7], s88 offen sc1
  v_mfma_f32_16x16x32_bf16 v[124:127], a[124:127], a[208:211], 0
  v_mfma_f32_16x16x32_bf16 v[124:127], a[120:123], a[160:163], v[124:127]
  s_add_u32 s88, s88, 4096
  v_mfma_f32_16x16x32_bf16 v[124:127], a[116:119], a[252:255], v[124:127]
  v_mfma_f32_16x16x32_bf16 v[124:127], a[112:115], a[236:239], v[124:127]
  s_waitcnt lgkmcnt(0)
  ds_read_b128 a[184:187], v46 offset:7168
  ds_read_b128 a[188:191], v46 offset:16384
  v_mfma_f32_16x16x32_bf16 v[252:255], a[168:171], a[140:143], v[252:255]
  ds_read_b128 a[196:199], v46 offset:25600
  ds_read_b128 a[204:207], v46 offset:34816
  v_mfma_f32_16x16x32_bf16 v[252:255], a[172:175], a[28:31], v[252:255]
  buffer_load_dwordx4 a[64:67], v28, s[4:7], s88 offen sc1
  v_mfma_f32_16x16x32_bf16 v[252:255], a[176:179], a[60:63], v[252:255]
  s_waitcnt vmcnt(20)
  v_mfma_f32_16x16x32_bf16 v[252:255], a[180:183], a[92:95], v[252:255]
  v_mfma_f32_16x16x32_bf16 v[248:251], a[180:183], a[88:91], v[248:251]
  v_mfma_f32_16x16x32_bf16 v[248:251], a[176:179], a[56:59], v[248:251]
  v_mfma_f32_16x16x32_bf16 v[248:251], a[172:175], a[24:27], v[248:251]
  buffer_load_dwordx4 a[68:71], v29, s[4:7], s88 offen sc1
  v_mfma_f32_16x16x32_bf16 v[248:251], a[168:171], a[132:135], v[248:251]
  v_mfma_f32_16x16x32_bf16 v[244:247], a[168:171], a[144:147], v[244:247]
  v_mfma_f32_16x16x32_bf16 v[244:247], a[172:175], a[20:23], v[244:247]
  v_mfma_f32_16x16x32_bf16 v[244:247], a[176:179], a[52:55], v[244:247]
  v_mfma_f32_16x16x32_bf16 v[244:247], a[180:183], a[84:87], v[244:247]
  buffer_load_dwordx4 a[72:75], v30, s[4:7], s88 offen sc1
  v_mfma_f32_16x16x32_bf16 v[240:243], a[180:183], a[80:83], v[240:243]
  v_mfma_f32_16x16x32_bf16 v[240:243], a[176:179], a[48:51], v[240:243]
  v_mfma_f32_16x16x32_bf16 v[240:243], a[172:175], a[16:19], v[240:243]
  v_mfma_f32_16x16x32_bf16 v[240:243], a[168:171], a[216:219], v[240:243]
  s_waitcnt lgkmcnt(0)
  ds_read_b128 a[212:215], v46 offset:0
  ds_read_b128 a[220:223], v46 offset:9216
  v_mfma_f32_16x16x32_bf16 v[224:227], a[184:187], a[216:219], v[224:227]
  ds_read_b128 a[128:131], v46 offset:18432
  ds_read_b128 a[136:139], v46 offset:27648
  v_mfma_f32_16x16x32_bf16 v[224:227], a[188:191], a[16:19], v[224:227]
  buffer_load_dwordx4 a[76:79], v31, s[4:7], s88 offen sc1
  v_mfma_f32_16x16x32_bf16 v[224:227], a[196:199], a[48:51], v[224:227]
  v_mfma_f32_16x16x32_bf16 v[224:227], a[204:207], a[80:83], v[224:227]
  s_add_u32 s88, s88, 4096
  v_mfma_f32_16x16x32_bf16 v[228:231], a[204:207], a[84:87], v[228:231]
  v_mfma_f32_16x16x32_bf16 v[228:231], a[196:199], a[52:55], v[228:231]
  v_mfma_f32_16x16x32_bf16 v[228:231], a[188:191], a[20:23], v[228:231]
  buffer_load_dwordx4 a[96:99], v28, s[4:7], s88 offen sc1
  v_mfma_f32_16x16x32_bf16 v[228:231], a[184:187], a[144:147], v[228:231]
  v_mfma_f32_16x16x32_bf16 v[232:235], a[184:187], a[132:135], v[232:235]
  v_mfma_f32_16x16x32_bf16 v[232:235], a[188:191], a[24:27], v[232:235]
  v_mfma_f32_16x16x32_bf16 v[232:235], a[196:199], a[56:59], v[232:235]
  v_mfma_f32_16x16x32_bf16 v[232:235], a[204:207], a[88:91], v[232:235]
  buffer_load_dwordx4 a[100:103], v29, s[4:7], s88 offen sc1
  v_mfma_f32_16x16x32_bf16 v[236:239], a[204:207], a[92:95], v[236:239]
  v_mfma_f32_16x16x32_bf16 v[236:239], a[196:199], a[60:63], v[236:239]
  v_mfma_f32_16x16x32_bf16 v[236:239], a[188:191], a[28:31], v[236:239]
  v_mfma_f32_16x16x32_bf16 v[236:239], a[184:187], a[140:143], v[236:239]
  s_waitcnt lgkmcnt(0)
  ds_read_b128 a[112:115], v46 offset:1024
  ds_read_b128 a[116:119], v46 offset:10240
  v_mfma_f32_16x16x32_bf16 v[220:223], a[212:215], a[140:143], v[220:223]
  ds_read_b128 a[120:123], v46 offset:19456
  ds_read_b128 a[124:127], v46 offset:28672
  v_mfma_f32_16x16x32_bf16 v[220:223], a[220:223], a[28:31], v[220:223]
  buffer_load_dwordx4 a[104:107], v30, s[4:7], s88 offen sc1
  v_mfma_f32_16x16x32_bf16 v[220:223], a[128:131], a[60:63], v[220:223]
  v_mfma_f32_16x16x32_bf16 v[220:223], a[136:139], a[92:95], v[220:223]
  v_mfma_f32_16x16x32_bf16 v[216:219], a[136:139], a[88:91], v[216:219]
  s_waitcnt vmcnt(17)
  s_barrier
  v_mfma_f32_16x16x32_bf16 v[216:219], a[128:131], a[56:59], v[216:219]
  s_cmp_eq_u32 s57, 0
  s_cbranch_scc0 sigd_h1
  v_mov_b32 v58, s8
  s_mov_b64 exec, 1
  buffer_atomic_add v58, off, s[4:7], s46 sc1
  s_mov_b64 exec, -1
  s_nop 3
sigd_h1:
  v_mfma_f32_16x16x32_bf16 v[216:219], a[220:223], a[24:27], v[216:219]
  buffer_load_dwordx4 a[108:111], v31, s[4:7], s88 offen sc1
  v_mfma_f32_16x16x32_bf16 v[216:219], a[212:215], a[132:135], v[216:219]
  v_mfma_f32_16x16x32_bf16 v[212:215], a[212:215], a[144:147], v[212:215]
  s_add_u32 s89, s89, s42
  v_mfma_f32_16x16x32_bf16 v[212:215], a[220:223], a[20:23], v[212:215]
  s_add_u32 m0, s44, 49152
  v_mfma_f32_16x16x32_bf16 v[212:215], a[128:131], a[52:55], v[212:215]
  v_mfma_f32_16x16x32_bf16 v[212:215], a[136:139], a[84:87], v[212:215]
  buffer_load_dwordx4 v36, s[4:7], s89 offen offset:0 sc1 lds
  v_mfma_f32_16x16x32_bf16 v[208:211], a[136:139], a[80:83], v[208:211]
  v_mfma_f32_16x16x32_bf16 v[208:211], a[128:131], a[48:51], v[208:211]
  v_mfma_f32_16x16x32_bf16 v[208:211], a[220:223], a[16:19], v[208:211]
  v_mfma_f32_16x16x32_bf16 v[208:211], a[212:215], a[216:219], v[208:211]
  s_waitcnt lgkmcnt(0)
  ds_read_b128 a[168:171], v46 offset:4096
  ds_read_b128 a[172:175], v46 offset:13312
  v_mfma_f32_16x16x32_bf16 v[192:195], a[112:115], a[216:219], v[192:195]
  ds_read_b128 a[176:179], v46 offset:22528
  ds_read_b128 a[180:183], v46 offset:31744
  v_mfma_f32_16x16x32_bf16 v[192:195], a[116:119], a[16:19], v[192:195]
  buffer_load_dwordx4 v37, s[4:7], s89 offen offset:1024 sc1 lds
  v_mfma_f32_16x16x32_bf16 v[192:195], a[120:123], a[48:51], v[192:195]
  v_mfma_f32_16x16x32_bf16 v[192:195], a[124:127], a[80:83], v[192:195]
  v_mfma_f32_16x16x32_bf16 v[196:199], a[124:127], a[84:87], v[196:199]
  v_mfma_f32_16x16x32_bf16 v[196:199], a[120:123], a[52:55], v[196:199]
  v_mfma_f32_16x16x32_bf16 v[196:199], a[116:119], a[20:23], v[196:199]
  buffer_load_dwordx4 v38, s[4:7], s89 offen offset:2048 sc1 lds
  v_mfma_f32_16x16x32_bf16 v[196:199], a[112:115], a[144:147], v[196:199]
  v_mfma_f32_16x16x32_bf16 v[200:203], a[112:115], a[132:135], v[200:203]
  v_mfma_f32_16x16x32_bf16 v[200:203], a[116:119], a[24:27], v[200:203]
  v_mfma_f32_16x16x32_bf16 v[200:203], a[120:123], a[56:59], v[200:203]
  v_mfma_f32_16x16x32_bf16 v[200:203], a[124:127], a[88:91], v[200:203]
  buffer_load_dwordx4 v39, s[4:7], s89 offen offset:3072 sc1 lds
  v_mfma_f32_16x16x32_bf16 v[204:207], a[124:127], a[92:95], v[204:207]
  v_mfma_f32_16x16x32_bf16 v[204:207], a[120:123], a[60:63], v[204:207]
  s_add_u32 m0, s44, 53248
  v_mfma_f32_16x16x32_bf16 v[204:207], a[116:119], a[28:31], v[204:207]
  v_mfma_f32_16x16x32_bf16 v[204:207], a[112:115], a[140:143], v[204:207]
  s_waitcnt lgkmcnt(0)
  ds_read_b128 a[184:187], v46 offset:6144
  ds_read_b128 a[188:191], v46 offset:15360
  v_mfma_f32_16x16x32_bf16 v[188:191], a[168:171], a[140:143], v[188:191]
  ds_read_b128 a[196:199], v46 offset:24576
  ds_read_b128 a[204:207], v46 offset:33792
  v_mfma_f32_16x16x32_bf16 v[188:191], a[172:175], a[28:31], v[188:191]
  buffer_load_dwordx4 v40, s[4:7], s89 offen offset:0 sc1 lds
  v_mfma_f32_16x16x32_bf16 v[188:191], a[176:179], a[60:63], v[188:191]
  v_mfma_f32_16x16x32_bf16 v[188:191], a[180:183], a[92:95], v[188:191]
  buffer_store_dwordx4 v[64:67], v1, s[4:7], s98 offen offset:0 sc1
  v_mfma_f32_16x16x32_bf16 v[184:187], a[180:183], a[88:91], v[184:187]
  v_mfma_f32_16x16x32_bf16 v[184:187], a[176:179], a[56:59], v[184:187]
  v_mfma_f32_16x16x32_bf16 v[184:187], a[172:175], a[24:27], v[184:187]
  buffer_load_dwordx4 v41, s[4:7], s89 offen offset:1024 sc1 lds
  v_mfma_f32_16x16x32_bf16 v[184:187], a[168:171], a[132:135], v[184:187]
  v_mfma_f32_16x16x32_bf16 v[180:183], a[168:171], a[144:147], v[180:183]
  v_mfma_f32_16x16x32_bf16 v[180:183], a[172:175], a[20:23], v[180:183]
  v_mfma_f32_16x16x32_bf16 v[180:183], a[176:179], a[52:55], v[180:183]
  v_mfma_f32_16x16x32_bf16 v[180:183], a[180:183], a[84:87], v[180:183]
  buffer_load_dwordx4 v42, s[4:7], s89 offen offset:2048 sc1 lds
  v_mfma_f32_16x16x32_bf16 v[176:179], a[180:183], a[80:83], v[176:179]
  v_mfma_f32_16x16x32_bf16 v[176:179], a[176:179], a[48:51], v[176:179]
  v_mfma_f32_16x16x32_bf16 v[176:179], a[172:175], a[16:19], v[176:179]
pad_m_16:
  s_cbranch_execz warm_4
  v_add_co_u32 v60, vcc, (att_retry-att_last-8192)/36*4, v60
  v_mfma_f32_16x16x32_bf16 v[176:179], a[168:171], a[216:219], v[176:179]
  s_waitcnt lgkmcnt(0)
  ds_read_b128 a[212:215], v46 offset:5120
  ds_read_b128 a[220:223], v46 offset:14336
  v_mfma_f32_16x16x32_bf16 v[160:163], a[184:187], a[216:219], v[160:163]
  ds_read_b128 a[128:131], v46 offset:23552
  ds_read_b128 a[136:139], v46 offset:32768
  v_mfma_f32_16x16x32_bf16 v[160:163], a[188:191], a[16:19], v[160:163]
  buffer_load_dwordx4 v43, s[4:7], s89 offen offset:3072 sc1 lds
  v_mfma_f32_16x16x32_bf16 v[160:163], a[196:199], a[48:51], v[160:163]
  v_addc_co_u32 v61, vcc, 0, v61, vcc
  v_mfma_f32_16x16x32_bf16 v[160:163], a[204:207], a[80:83], v[160:163]
  s_add_u32 m0, s44, 57344
  v_mfma_f32_16x16x32_bf16 v[164:167], a[204:207], a[84:87], v[164:167]
  v_mfma_f32_16x16x32_bf16 v[164:167], a[196:199], a[52:55], v[164:167]
  v_mfma_f32_16x16x32_bf16 v[164:167], a[188:191], a[20:23], v[164:167]
  global_load_dword v62, v[60:61], off
  v_mfma_f32_16x16x32_bf16 v[164:167], a[184:187], a[144:147], v[164:167]
  v_mfma_f32_16x16x32_bf16 v[168:171], a[184:187], a[132:135], v[168:171]
  s_add_u32 s88, s88, 4096
  v_mfma_f32_16x16x32_bf16 v[168:171], a[188:191], a[24:27], v[168:171]
  buffer_load_dwordx4 v44, s[4:7], s89 offen offset:0 sc1 lds
  v_mfma_f32_16x16x32_bf16 v[168:171], a[196:199], a[56:59], v[168:171]
  v_mfma_f32_16x16x32_bf16 v[168:171], a[204:207], a[88:91], v[168:171]
  buffer_load_dwordx4 a[224:227], v28, s[4:7], s88 offen sc1
  v_mfma_f32_16x16x32_bf16 v[172:175], a[204:207], a[92:95], v[172:175]
  v_mfma_f32_16x16x32_bf16 v[172:175], a[196:199], a[60:63], v[172:175]
  v_mfma_f32_16x16x32_bf16 v[172:175], a[188:191], a[28:31], v[172:175]
  v_mfma_f32_16x16x32_bf16 v[172:175], a[184:187], a[140:143], v[172:175]
  s_waitcnt lgkmcnt(0)
  ds_read_b128 a[112:115], v46 offset:2048
  ds_read_b128 a[116:119], v46 offset:11264
  v_mfma_f32_16x16x32_bf16 v[156:159], a[212:215], a[140:143], v[156:159]
  ds_read_b128 a[120:123], v46 offset:20480
  ds_read_b128 a[124:127], v46 offset:29696
  v_mfma_f32_16x16x32_bf16 v[156:159], a[220:223], a[28:31], v[156:159]
  buffer_load_dwordx4 a[228:231], v29, s[4:7], s88 offen sc1
  v_mfma_f32_16x16x32_bf16 v[156:159], a[128:131], a[60:63], v[156:159]
  v_mfma_f32_16x16x32_bf16 v[156:159], a[136:139], a[92:95], v[156:159]
  buffer_store_dwordx4 v[80:83], v1, s[4:7], s98 offen offset:1024 sc1
  v_mfma_f32_16x16x32_bf16 v[152:155], a[136:139], a[88:91], v[152:155]
  v_mfma_f32_16x16x32_bf16 v[152:155], a[128:131], a[56:59], v[152:155]
  v_mfma_f32_16x16x32_bf16 v[152:155], a[220:223], a[24:27], v[152:155]
  buffer_load_dwordx4 a[232:235], v30, s[4:7], s88 offen sc1
  v_mfma_f32_16x16x32_bf16 v[152:155], a[212:215], a[132:135], v[152:155]
  v_mfma_f32_16x16x32_bf16 v[148:151], a[212:215], a[144:147], v[148:151]
  v_mfma_f32_16x16x32_bf16 v[148:151], a[220:223], a[20:23], v[148:151]
  v_mfma_f32_16x16x32_bf16 v[148:151], a[128:131], a[52:55], v[148:151]
  v_mfma_f32_16x16x32_bf16 v[148:151], a[136:139], a[84:87], v[148:151]
  buffer_load_dwordx4 a[236:239], v31, s[4:7], s88 offen sc1
  v_mfma_f32_16x16x32_bf16 v[144:147], a[136:139], a[80:83], v[144:147]
  v_mfma_f32_16x16x32_bf16 v[144:147], a[128:131], a[48:51], v[144:147]
  v_mfma_f32_16x16x32_bf16 v[144:147], a[220:223], a[16:19], v[144:147]
  s_add_u32 s88, s88, 4096
  v_mfma_f32_16x16x32_bf16 v[144:147], a[212:215], a[216:219], v[144:147]
  s_waitcnt lgkmcnt(0)
  ds_read_b128 a[168:171], v46 offset:3072
  ds_read_b128 a[172:175], v46 offset:12288
  v_mfma_f32_16x16x32_bf16 v[128:131], a[112:115], a[216:219], v[128:131]
  ds_read_b128 a[176:179], v46 offset:21504
  ds_read_b128 a[180:183], v46 offset:30720
  v_mfma_f32_16x16x32_bf16 v[128:131], a[116:119], a[16:19], v[128:131]
  buffer_load_dwordx4 a[240:243], v28, s[4:7], s88 offen sc1
  v_mfma_f32_16x16x32_bf16 v[128:131], a[120:123], a[48:51], v[128:131]
  v_mfma_f32_16x16x32_bf16 v[128:131], a[124:127], a[80:83], v[128:131]
  v_mfma_f32_16x16x32_bf16 v[132:135], a[124:127], a[84:87], v[132:135]
  v_mfma_f32_16x16x32_bf16 v[132:135], a[120:123], a[52:55], v[132:135]
  v_mfma_f32_16x16x32_bf16 v[132:135], a[116:119], a[20:23], v[132:135]
  buffer_load_dwordx4 a[244:247], v29, s[4:7], s88 offen sc1
  v_mfma_f32_16x16x32_bf16 v[132:135], a[112:115], a[144:147], v[132:135]
  v_mfma_f32_16x16x32_bf16 v[136:139], a[112:115], a[132:135], v[136:139]
  v_mfma_f32_16x16x32_bf16 v[136:139], a[116:119], a[24:27], v[136:139]
  v_mfma_f32_16x16x32_bf16 v[136:139], a[120:123], a[56:59], v[136:139]
  v_mfma_f32_16x16x32_bf16 v[136:139], a[124:127], a[88:91], v[136:139]
  buffer_load_dwordx4 a[248:251], v30, s[4:7], s88 offen sc1
  v_mfma_f32_16x16x32_bf16 v[140:143], a[124:127], a[92:95], v[140:143]
  v_mfma_f32_16x16x32_bf16 v[140:143], a[120:123], a[60:63], v[140:143]
  s_waitcnt vmcnt(35) lgkmcnt(0)
  s_barrier
  v_mfma_f32_16x16x32_bf16 v[140:143], a[116:119], a[28:31], v[140:143]
  v_mfma_f32_16x16x32_bf16 v[140:143], a[112:115], a[140:143], v[140:143]
  ds_read_b128 a[184:187], v47 offset:8192
  ds_read_b128 a[188:191], v47 offset:17408
  v_mfma_f32_16x16x32_bf16 v[124:127], a[168:171], a[140:143], v[124:127]
  ds_read_b128 a[196:199], v47 offset:26624
  ds_read_b128 a[204:207], v47 offset:35840
  v_mfma_f32_16x16x32_bf16 v[124:127], a[172:175], a[28:31], v[124:127]
  buffer_load_dwordx4 a[252:255], v31, s[4:7], s88 offen sc1
  v_mfma_f32_16x16x32_bf16 v[124:127], a[176:179], a[60:63], v[124:127]
  v_mfma_f32_16x16x32_bf16 v[124:127], a[180:183], a[92:95], v[124:127]
  s_add_u32 s88, s88, 4096
  v_mfma_f32_16x16x32_bf16 v[120:123], a[180:183], a[88:91], v[120:123]
  v_mfma_f32_16x16x32_bf16 v[120:123], a[176:179], a[56:59], v[120:123]
  v_mfma_f32_16x16x32_bf16 v[120:123], a[172:175], a[24:27], v[120:123]
  buffer_load_dwordx4 a[148:151], v28, s[4:7], s88 offen sc1
  v_mfma_f32_16x16x32_bf16 v[120:123], a[168:171], a[132:135], v[120:123]
  v_mfma_f32_16x16x32_bf16 v[116:119], a[168:171], a[144:147], v[116:119]
  v_mfma_f32_16x16x32_bf16 v[116:119], a[172:175], a[20:23], v[116:119]
  v_mfma_f32_16x16x32_bf16 v[116:119], a[176:179], a[52:55], v[116:119]
  v_mfma_f32_16x16x32_bf16 v[116:119], a[180:183], a[84:87], v[116:119]
  buffer_load_dwordx4 a[152:155], v29, s[4:7], s88 offen sc1
  v_mfma_f32_16x16x32_bf16 v[112:115], a[180:183], a[80:83], v[112:115]
  v_mfma_f32_16x16x32_bf16 v[112:115], a[176:179], a[48:51], v[112:115]
  v_mfma_f32_16x16x32_bf16 v[112:115], a[172:175], a[16:19], v[112:115]
  v_mfma_f32_16x16x32_bf16 v[112:115], a[168:171], a[216:219], v[112:115]
  s_waitcnt vmcnt(37) lgkmcnt(0)
  ds_read_b128 a[212:215], v47 offset:7168
  ds_read_b128 a[220:223], v47 offset:16384
  v_mfma_f32_16x16x32_bf16 v[240:243], a[184:187], a[0:3], v[240:243]
  s_waitcnt vmcnt(33)
  ds_read_b128 a[128:131], v47 offset:25600
  ds_read_b128 a[136:139], v47 offset:34816
  v_mfma_f32_16x16x32_bf16 v[240:243], a[188:191], a[32:35], v[240:243]
  s_waitcnt vmcnt(29)
  buffer_load_dwordx4 a[156:159], v30, s[4:7], s88 offen sc1
  v_mfma_f32_16x16x32_bf16 v[240:243], a[196:199], a[64:67], v[240:243]
  s_waitcnt vmcnt(26)
  v_mfma_f32_16x16x32_bf16 v[240:243], a[204:207], a[96:99], v[240:243]
  s_waitcnt vmcnt(25)
  v_mfma_f32_16x16x32_bf16 v[244:247], a[204:207], a[100:103], v[244:247]
  v_mfma_f32_16x16x32_bf16 v[244:247], a[196:199], a[68:71], v[244:247]
  v_mfma_f32_16x16x32_bf16 v[244:247], a[188:191], a[36:39], v[244:247]
  buffer_load_dwordx4 a[160:163], v31, s[4:7], s88 offen sc1
  v_mfma_f32_16x16x32_bf16 v[244:247], a[184:187], a[4:7], v[244:247]
  v_mfma_f32_16x16x32_bf16 v[248:251], a[184:187], a[8:11], v[248:251]
  s_add_u32 s88, s88, 4096
  v_mfma_f32_16x16x32_bf16 v[248:251], a[188:191], a[40:43], v[248:251]
  v_mfma_f32_16x16x32_bf16 v[248:251], a[196:199], a[72:75], v[248:251]
  s_waitcnt vmcnt(25)
  v_mfma_f32_16x16x32_bf16 v[248:251], a[204:207], a[104:107], v[248:251]
  s_waitcnt vmcnt(24)
  buffer_load_dwordx4 a[164:167], v28, s[4:7], s88 offen sc1
  v_mfma_f32_16x16x32_bf16 v[252:255], a[204:207], a[108:111], v[252:255]
  v_mfma_f32_16x16x32_bf16 v[252:255], a[196:199], a[76:79], v[252:255]
  v_mfma_f32_16x16x32_bf16 v[252:255], a[188:191], a[44:47], v[252:255]
  v_mfma_f32_16x16x32_bf16 v[252:255], a[184:187], a[12:15], v[252:255]
  s_waitcnt lgkmcnt(0)
  ds_read_b128 a[112:115], v47 offset:0
  ds_read_b128 a[116:119], v47 offset:9216
  v_mfma_f32_16x16x32_bf16 v[236:239], a[212:215], a[12:15], v[236:239]
  ds_read_b128 a[120:123], v47 offset:18432
  ds_read_b128 a[124:127], v47 offset:27648
  v_mfma_f32_16x16x32_bf16 v[236:239], a[220:223], a[44:47], v[236:239]
  buffer_load_dwordx4 a[192:195], v29, s[4:7], s88 offen sc1
  v_mfma_f32_16x16x32_bf16 v[236:239], a[128:131], a[76:79], v[236:239]
  v_mfma_f32_16x16x32_bf16 v[236:239], a[136:139], a[108:111], v[236:239]
  buffer_load_dword v59, off, s[4:7], s46 sc1
  v_mfma_f32_16x16x32_bf16 v[232:235], a[136:139], a[104:107], v[232:235]
  v_mfma_f32_16x16x32_bf16 v[232:235], a[128:131], a[72:75], v[232:235]
  v_mfma_f32_16x16x32_bf16 v[232:235], a[220:223], a[40:43], v[232:235]
  buffer_load_dwordx4 a[200:203], v30, s[4:7], s88 offen sc1
  v_mfma_f32_16x16x32_bf16 v[232:235], a[212:215], a[8:11], v[232:235]
  v_mfma_f32_16x16x32_bf16 v[228:231], a[212:215], a[4:7], v[228:231]
  v_mfma_f32_16x16x32_bf16 v[228:231], a[220:223], a[36:39], v[228:231]
  v_mfma_f32_16x16x32_bf16 v[228:231], a[128:131], a[68:71], v[228:231]
  v_mfma_f32_16x16x32_bf16 v[228:231], a[136:139], a[100:103], v[228:231]
  buffer_load_dwordx4 a[208:211], v31, s[4:7], s88 offen sc1
  v_mfma_f32_16x16x32_bf16 v[224:227], a[136:139], a[96:99], v[224:227]
  v_mfma_f32_16x16x32_bf16 v[224:227], a[128:131], a[64:67], v[224:227]
  v_mfma_f32_16x16x32_bf16 v[224:227], a[220:223], a[32:35], v[224:227]
  s_add_u32 s89, s89, s43
  v_mfma_f32_16x16x32_bf16 v[224:227], a[212:215], a[0:3], v[224:227]
  s_waitcnt lgkmcnt(0)
  ds_read_b128 a[168:171], v47 offset:1024
  ds_read_b128 a[172:175], v47 offset:10240
  v_mfma_f32_16x16x32_bf16 v[208:211], a[112:115], a[0:3], v[208:211]
  s_add_u32 m0, s44, 86016
  ds_read_b128 a[176:179], v47 offset:19456
  ds_read_b128 a[180:183], v47 offset:28672
  v_mfma_f32_16x16x32_bf16 v[208:211], a[116:119], a[32:35], v[208:211]
  buffer_load_dwordx4 v36, s[4:7], s89 offen offset:0 sc1 lds
  v_mfma_f32_16x16x32_bf16 v[208:211], a[120:123], a[64:67], v[208:211]
  v_mfma_f32_16x16x32_bf16 v[208:211], a[124:127], a[96:99], v[208:211]
  v_mfma_f32_16x16x32_bf16 v[212:215], a[124:127], a[100:103], v[212:215]
  v_mfma_f32_16x16x32_bf16 v[212:215], a[120:123], a[68:71], v[212:215]
  v_mfma_f32_16x16x32_bf16 v[212:215], a[116:119], a[36:39], v[212:215]
  buffer_load_dwordx4 v37, s[4:7], s89 offen offset:1024 sc1 lds
  v_mfma_f32_16x16x32_bf16 v[212:215], a[112:115], a[4:7], v[212:215]
  v_mfma_f32_16x16x32_bf16 v[216:219], a[112:115], a[8:11], v[216:219]
  v_mfma_f32_16x16x32_bf16 v[216:219], a[116:119], a[40:43], v[216:219]
  v_mfma_f32_16x16x32_bf16 v[216:219], a[120:123], a[72:75], v[216:219]
  v_mfma_f32_16x16x32_bf16 v[216:219], a[124:127], a[104:107], v[216:219]
  buffer_load_dwordx4 v38, s[4:7], s89 offen offset:2048 sc1 lds
  v_mfma_f32_16x16x32_bf16 v[220:223], a[124:127], a[108:111], v[220:223]
  v_mfma_f32_16x16x32_bf16 v[220:223], a[120:123], a[76:79], v[220:223]
  v_mfma_f32_16x16x32_bf16 v[220:223], a[116:119], a[44:47], v[220:223]
  v_mfma_f32_16x16x32_bf16 v[220:223], a[112:115], a[12:15], v[220:223]
  s_waitcnt lgkmcnt(0)
  ds_read_b128 a[184:187], v47 offset:4096
  ds_read_b128 a[188:191], v47 offset:13312
  v_mfma_f32_16x16x32_bf16 v[204:207], a[168:171], a[12:15], v[204:207]
  ds_read_b128 a[196:199], v47 offset:22528
  ds_read_b128 a[204:207], v47 offset:31744
  v_mfma_f32_16x16x32_bf16 v[204:207], a[172:175], a[44:47], v[204:207]
  buffer_load_dwordx4 v39, s[4:7], s89 offen offset:3072 sc1 lds
  v_mfma_f32_16x16x32_bf16 v[204:207], a[176:179], a[76:79], v[204:207]
  v_mfma_f32_16x16x32_bf16 v[204:207], a[180:183], a[108:111], v[204:207]
  s_add_u32 m0, s44, 90112
  v_mfma_f32_16x16x32_bf16 v[200:203], a[180:183], a[104:107], v[200:203]
  v_mfma_f32_16x16x32_bf16 v[200:203], a[176:179], a[72:75], v[200:203]
  v_mfma_f32_16x16x32_bf16 v[200:203], a[172:175], a[40:43], v[200:203]
  buffer_load_dwordx4 v40, s[4:7], s89 offen offset:0 sc1 lds
  v_mfma_f32_16x16x32_bf16 v[200:203], a[168:171], a[8:11], v[200:203]
  v_mfma_f32_16x16x32_bf16 v[196:199], a[168:171], a[4:7], v[196:199]
  v_mfma_f32_16x16x32_bf16 v[196:199], a[172:175], a[36:39], v[196:199]
  v_mfma_f32_16x16x32_bf16 v[196:199], a[176:179], a[68:71], v[196:199]
  v_mfma_f32_16x16x32_bf16 v[196:199], a[180:183], a[100:103], v[196:199]
  buffer_load_dwordx4 v41, s[4:7], s89 offen offset:1024 sc1 lds
  v_mfma_f32_16x16x32_bf16 v[192:195], a[180:183], a[96:99], v[192:195]
  v_mfma_f32_16x16x32_bf16 v[192:195], a[176:179], a[64:67], v[192:195]
  v_mfma_f32_16x16x32_bf16 v[192:195], a[172:175], a[32:35], v[192:195]
  v_mfma_f32_16x16x32_bf16 v[192:195], a[168:171], a[0:3], v[192:195]
  s_waitcnt lgkmcnt(0)
  ds_read_b128 a[212:215], v47 offset:6144
  ds_read_b128 a[220:223], v47 offset:15360
  v_mfma_f32_16x16x32_bf16 v[176:179], a[184:187], a[0:3], v[176:179]
  ds_read_b128 a[128:131], v47 offset:24576
  ds_read_b128 a[136:139], v47 offset:33792
  v_mfma_f32_16x16x32_bf16 v[176:179], a[188:191], a[32:35], v[176:179]
  buffer_load_dwordx4 v42, s[4:7], s89 offen offset:2048 sc1 lds
  v_mfma_f32_16x16x32_bf16 v[176:179], a[196:199], a[64:67], v[176:179]
  v_mfma_f32_16x16x32_bf16 v[176:179], a[204:207], a[96:99], v[176:179]
  v_mfma_f32_16x16x32_bf16 v[180:183], a[204:207], a[100:103], v[180:183]
  v_mfma_f32_16x16x32_bf16 v[180:183], a[196:199], a[68:71], v[180:183]
  v_mfma_f32_16x16x32_bf16 v[180:183], a[188:191], a[36:39], v[180:183]
  buffer_load_dwordx4 v43, s[4:7], s89 offen offset:3072 sc1 lds
  v_mfma_f32_16x16x32_bf16 v[180:183], a[184:187], a[4:7], v[180:183]
  v_mfma_f32_16x16x32_bf16 v[184:187], a[184:187], a[8:11], v[184:187]
  v_mfma_f32_16x16x32_bf16 v[184:187], a[188:191], a[40:43], v[184:187]
  s_add_u32 m0, s44, 94208
  v_mfma_f32_16x16x32_bf16 v[184:187], a[196:199], a[72:75], v[184:187]
  v_mfma_f32_16x16x32_bf16 v[184:187], a[204:207], a[104:107], v[184:187]
  v_mfma_f32_16x16x32_bf16 v[188:191], a[204:207], a[108:111], v[188:191]
  buffer_load_dwordx4 v44, s[4:7], s89 offen offset:0 sc1 lds
  v_mfma_f32_16x16x32_bf16 v[188:191], a[196:199], a[76:79], v[188:191]
  s_waitcnt vmcnt(11)
  v_readfirstlane_b32 s73, v59
  s_nop 0
  s_and_b32 s73, s73, s10
  s_cmp_ge_u32 s73, s10
  s_cbranch_scc0 spin_k4
back_k4:
  v_mfma_f32_16x16x32_bf16 v[188:191], a[188:191], a[44:47], v[188:191]
  s_add_u32 s88, s88, s91
  v_mfma_f32_16x16x32_bf16 v[188:191], a[184:187], a[12:15], v[188:191]
  s_waitcnt lgkmcnt(0)
  ds_read_b128 a[112:115], v47 offset:5120
  ds_read_b128 a[116:119], v47 offset:14336
  v_mfma_f32_16x16x32_bf16 v[172:175], a[212:215], a[12:15], v[172:175]
  ds_read_b128 a[120:123], v47 offset:23552
  ds_read_b128 a[124:127], v47 offset:32768
  v_mfma_f32_16x16x32_bf16 v[172:175], a[220:223], a[44:47], v[172:175]
  buffer_load_dwordx4 a[216:219], v28, s[4:7], s88 offen sc1
  v_mfma_f32_16x16x32_bf16 v[172:175], a[128:131], a[76:79], v[172:175]
  v_mfma_f32_16x16x32_bf16 v[172:175], a[136:139], a[108:111], v[172:175]
  v_mfma_f32_16x16x32_bf16 v[168:171], a[136:139], a[104:107], v[168:171]
  v_add_co_u32 v60, vcc, (att_retry-att_last-8192)/36*4, v60
  v_mfma_f32_16x16x32_bf16 v[168:171], a[128:131], a[72:75], v[168:171]
  s_nop 0
  v_addc_co_u32 v61, vcc, 0, v61, vcc
  v_mfma_f32_16x16x32_bf16 v[168:171], a[220:223], a[40:43], v[168:171]
  buffer_load_dwordx4 a[144:147], v29, s[4:7], s88 offen sc1
  v_mfma_f32_16x16x32_bf16 v[168:171], a[212:215], a[8:11], v[168:171]
  v_mfma_f32_16x16x32_bf16 v[164:167], a[212:215], a[4:7], v[164:167]
  v_mfma_f32_16x16x32_bf16 v[164:167], a[220:223], a[36:39], v[164:167]
  v_mfma_f32_16x16x32_bf16 v[164:167], a[128:131], a[68:71], v[164:167]
  v_mfma_f32_16x16x32_bf16 v[164:167], a[136:139], a[100:103], v[164:167]
  v_mfma_f32_16x16x32_bf16 v[160:163], a[136:139], a[96:99], v[160:163]
  global_load_dword v62, v[60:61], off
  v_mfma_f32_16x16x32_bf16 v[160:163], a[128:131], a[64:67], v[160:163]
  v_mfma_f32_16x16x32_bf16 v[160:163], a[220:223], a[32:35], v[160:163]
  v_mfma_f32_16x16x32_bf16 v[160:163], a[212:215], a[0:3], v[160:163]
  s_waitcnt lgkmcnt(0)
  buffer_load_dwordx4 a[132:135], v30, s[4:7], s88 offen sc1
  ds_read_b128 a[168:171], v47 offset:2048
  ds_read_b128 a[172:175], v47 offset:11264
  v_mfma_f32_16x16x32_bf16 v[144:147], a[112:115], a[0:3], v[144:147]
  ds_read_b128 a[176:179], v47 offset:20480
  ds_read_b128 a[180:183], v47 offset:29696
  v_mfma_f32_16x16x32_bf16 v[144:147], a[116:119], a[32:35], v[144:147]
  buffer_load_dwordx4 a[140:143], v31, s[4:7], s88 offen sc1
  v_mfma_f32_16x16x32_bf16 v[144:147], a[120:123], a[64:67], v[144:147]
  v_mfma_f32_16x16x32_bf16 v[144:147], a[124:127], a[96:99], v[144:147]
  s_add_u32 s88, s88, 4096
  v_mfma_f32_16x16x32_bf16 v[148:151], a[124:127], a[100:103], v[148:151]
  v_mfma_f32_16x16x32_bf16 v[148:151], a[120:123], a[68:71], v[148:151]
  v_mfma_f32_16x16x32_bf16 v[148:151], a[116:119], a[36:39], v[148:151]
  buffer_load_dwordx4 a[16:19], v28, s[4:7], s88 offen sc1
  v_mfma_f32_16x16x32_bf16 v[148:151], a[112:115], a[4:7], v[148:151]
  v_mfma_f32_16x16x32_bf16 v[152:155], a[112:115], a[8:11], v[152:155]
  v_mfma_f32_16x16x32_bf16 v[152:155], a[116:119], a[40:43], v[152:155]
  v_mfma_f32_16x16x32_bf16 v[152:155], a[120:123], a[72:75], v[152:155]
  v_mfma_f32_16x16x32_bf16 v[152:155], a[124:127], a[104:107], v[152:155]
  v_mfma_f32_16x16x32_bf16 v[156:159], a[124:127], a[108:111], v[156:159]
  buffer_load_dwordx4 a[20:23], v29, s[4:7], s88 offen sc1
  v_mfma_f32_16x16x32_bf16 v[156:159], a[120:123], a[76:79], v[156:159]
  v_mfma_f32_16x16x32_bf16 v[156:159], a[116:119], a[44:47], v[156:159]
  v_mfma_f32_16x16x32_bf16 v[156:159], a[112:115], a[12:15], v[156:159]
  s_waitcnt lgkmcnt(0)
  ds_read_b128 a[184:187], v47 offset:3072
  ds_read_b128 a[188:191], v47 offset:12288
  v_mfma_f32_16x16x32_bf16 v[140:143], a[168:171], a[12:15], v[140:143]
  ds_read_b128 a[196:199], v47 offset:21504
  ds_read_b128 a[204:207], v47 offset:30720
  v_mfma_f32_16x16x32_bf16 v[140:143], a[172:175], a[44:47], v[140:143]
  buffer_load_dwordx4 a[24:27], v30, s[4:7], s88 offen sc1
  v_mfma_f32_16x16x32_bf16 v[140:143], a[176:179], a[76:79], v[140:143]
  v_mfma_f32_16x16x32_bf16 v[140:143], a[180:183], a[108:111], v[140:143]
  v_mfma_f32_16x16x32_bf16 v[136:139], a[180:183], a[104:107], v[136:139]
  v_mfma_f32_16x16x32_bf16 v[136:139], a[176:179], a[72:75], v[136:139]
  v_mfma_f32_16x16x32_bf16 v[136:139], a[172:175], a[40:43], v[136:139]
  buffer_load_dwordx4 a[28:31], v31, s[4:7], s88 offen sc1
  v_mfma_f32_16x16x32_bf16 v[136:139], a[168:171], a[8:11], v[136:139]
  v_mfma_f32_16x16x32_bf16 v[132:135], a[168:171], a[4:7], v[132:135]
  v_mfma_f32_16x16x32_bf16 v[132:135], a[172:175], a[36:39], v[132:135]
  s_add_u32 s88, s88, 4096
  v_mfma_f32_16x16x32_bf16 v[132:135], a[176:179], a[68:71], v[132:135]
  v_mfma_f32_16x16x32_bf16 v[132:135], a[180:183], a[100:103], v[132:135]
  v_mfma_f32_16x16x32_bf16 v[128:131], a[180:183], a[96:99], v[128:131]
  buffer_load_dwordx4 a[48:51], v28, s[4:7], s88 offen sc1
  v_mfma_f32_16x16x32_bf16 v[128:131], a[176:179], a[64:67], v[128:131]
  s_waitcnt lgkmcnt(0)
  s_barrier
  v_mfma_f32_16x16x32_bf16 v[128:131], a[172:175], a[32:35], v[128:131]
  s_cmp_eq_u32 s57, 0
  s_cbranch_scc0 sigd_h2
  v_mov_b32 v58, 65536
  s_mov_b64 exec, 1
  buffer_atomic_add v58, off, s[4:7], s46 sc1
  s_mov_b64 exec, -1
  s_nop 3
sigd_h2:
  v_mfma_f32_16x16x32_bf16 v[128:131], a[168:171], a[0:3], v[128:131]
  ds_read_b128 a[212:215], v45 offset:8192
  ds_read_b128 a[220:223], v45 offset:17408
  v_mfma_f32_16x16x32_bf16 v[112:115], a[184:187], a[0:3], v[112:115]
  s_xor_b32 s94, s56, 1
  ds_read_b128 a[128:131], v45 offset:26624
  ds_read_b128 a[136:139], v45 offset:35840
  v_mfma_f32_16x16x32_bf16 v[112:115], a[188:191], a[32:35], v[112:115]
  buffer_load_dwordx4 a[52:55], v29, s[4:7], s88 offen sc1
  v_mfma_f32_16x16x32_bf16 v[112:115], a[196:199], a[64:67], v[112:115]
  s_xor_b32 s95, s56, 2
  v_mfma_f32_16x16x32_bf16 v[112:115], a[204:207], a[96:99], v[112:115]
  s_xor_b32 s96, s56, 3
  v_mfma_f32_16x16x32_bf16 v[116:119], a[204:207], a[100:103], v[116:119]
  s_xor_b32 s65, s56, 4
  v_mfma_f32_16x16x32_bf16 v[116:119], a[196:199], a[68:71], v[116:119]
  s_mul_i32 s94, s94, 73728
  v_mfma_f32_16x16x32_bf16 v[116:119], a[188:191], a[36:39], v[116:119]
  buffer_load_dwordx4 a[56:59], v30, s[4:7], s88 offen sc1
  v_mfma_f32_16x16x32_bf16 v[116:119], a[184:187], a[4:7], v[116:119]
  s_xor_b32 s66, s56, 5
  v_mfma_f32_16x16x32_bf16 v[120:123], a[184:187], a[8:11], v[120:123]
  s_xor_b32 s97, s56, 6
  v_mfma_f32_16x16x32_bf16 v[120:123], a[188:191], a[40:43], v[120:123]
  s_mul_i32 s95, s95, 73728
  v_mfma_f32_16x16x32_bf16 v[120:123], a[196:199], a[72:75], v[120:123]
  s_xor_b32 s98, s56, 7
  v_mfma_f32_16x16x32_bf16 v[120:123], a[204:207], a[104:107], v[120:123]
  s_mul_i32 s96, s96, 73728
  v_mfma_f32_16x16x32_bf16 v[124:127], a[204:207], a[108:111], v[124:127]
  buffer_load_dwordx4 a[60:63], v31, s[4:7], s88 offen sc1
  v_mfma_f32_16x16x32_bf16 v[124:127], a[196:199], a[76:79], v[124:127]
  s_mul_i32 s65, s65, 73728
  v_mov_b32 v78, 0
  v_mov_b32 v79, 0
  v_mfma_f32_16x16x32_bf16 v[124:127], a[188:191], a[44:47], v[124:127]
  s_add_u32 s88, s88, 4096
  v_mov_b32 v80, 0
  v_mov_b32 v81, 0
  v_mfma_f32_16x16x32_bf16 v[124:127], a[184:187], a[12:15], v[124:127]
  s_waitcnt lgkmcnt(0)
  ds_read_b128 a[112:115], v45 offset:7168
  ds_read_b128 a[116:119], v45 offset:16384
  v_mfma_f32_16x16x32_bf16 v[252:255], a[212:215], a[236:239], v[252:255]
  s_mul_i32 s66, s66, 73728
  ds_read_b128 a[120:123], v45 offset:25600
  ds_read_b128 a[124:127], v45 offset:34816
  v_mfma_f32_16x16x32_bf16 v[252:255], a[220:223], a[252:255], v[252:255]
  buffer_load_dwordx4 a[80:83], v28, s[4:7], s88 offen sc1
  v_mfma_f32_16x16x32_bf16 v[252:255], a[128:131], a[160:163], v[252:255]
  s_waitcnt vmcnt(23)
  s_mul_i32 s97, s97, 73728
  v_mov_b32 v82, 0
  v_mov_b32 v83, 0
  v_mfma_f32_16x16x32_bf16 v[252:255], a[136:139], a[208:211], v[252:255]
  s_mul_i32 s98, s98, 73728
  v_mov_b32 v84, 0
  v_mov_b32 v85, 0
  v_mfma_f32_16x16x32_bf16 v[248:251], a[136:139], a[200:203], v[248:251]
  s_add_u32 s94, s94, s49
  v_mov_b32 v86, 0
  v_mov_b32 v87, 0
  v_mfma_f32_16x16x32_bf16 v[248:251], a[128:131], a[156:159], v[248:251]
  s_add_u32 s95, s95, s49
  v_mov_b32 v88, 0
  v_mov_b32 v89, 0
  v_mfma_f32_16x16x32_bf16 v[248:251], a[220:223], a[248:251], v[248:251]
  buffer_load_dwordx4 a[84:87], v29, s[4:7], s88 offen sc1
  v_mfma_f32_16x16x32_bf16 v[248:251], a[212:215], a[232:235], v[248:251]
  s_mul_i32 s3, s57, 3072
  v_mov_b32 v90, 0
  v_and_b32 v14, 15, v0
  v_mfma_f32_16x16x32_bf16 v[244:247], a[212:215], a[228:231], v[244:247]
  s_add_u32 s3, s3, 126976
  v_mul_u32_u24 v14, 176, v14
  v_bfe_u32 v15, v0, 4, 2
  v_mfma_f32_16x16x32_bf16 v[244:247], a[220:223], a[244:247], v[244:247]
  s_mul_i32 s1, s51, 6
  v_mov_b32 v91, 0
  v_lshl_add_u32 v14, v15, 3, v14
  v_mfma_f32_16x16x32_bf16 v[244:247], a[128:131], a[152:155], v[244:247]
  s_add_u32 s96, s96, s49
  v_mov_b32 v92, 0
  v_and_or_b32 v27, v0, 63, 0
  v_mfma_f32_16x16x32_bf16 v[244:247], a[136:139], a[192:195], v[244:247]
  s_add_u32 s65, s65, s49
  v_mov_b32 v93, 0
  v_mul_u32_u24 v15, 205, v27
  v_mfma_f32_16x16x32_bf16 v[240:243], a[136:139], a[164:167], v[240:243]
  buffer_load_dwordx4 a[88:91], v30, s[4:7], s88 offen sc1
  v_mfma_f32_16x16x32_bf16 v[240:243], a[128:131], a[148:151], v[240:243]
  s_add_u32 s66, s66, s49
  v_mov_b32 v94, 0
  v_lshrrev_b32 v15, 11, v15
  v_mfma_f32_16x16x32_bf16 v[240:243], a[220:223], a[240:243], v[240:243]
  s_add_u32 s97, s97, s49
  v_mov_b32 v95, 0
  v_mul_u32_u24 v52, 10, v15
  v_mfma_f32_16x16x32_bf16 v[240:243], a[212:215], a[224:227], v[240:243]
  s_waitcnt lgkmcnt(0)
  ds_read_b128 a[168:171], v45 offset:0
  ds_read_b128 a[172:175], v45 offset:9216
  v_mfma_f32_16x16x32_bf16 v[224:227], a[112:115], a[224:227], v[224:227]
  s_add_u32 s98, s98, s49
  ds_read_b128 a[176:179], v45 offset:18432
  ds_read_b128 a[180:183], v45 offset:27648
  v_mfma_f32_16x16x32_bf16 v[224:227], a[116:119], a[240:243], v[224:227]
  buffer_load_dwordx4 a[92:95], v31, s[4:7], s88 offen sc1
  v_mfma_f32_16x16x32_bf16 v[224:227], a[120:123], a[148:151], v[224:227]
  s_mov_b32 s20, s92
  v_mov_b32 v96, 0
  v_sub_u32 v27, v27, v52
  v_mfma_f32_16x16x32_bf16 v[224:227], a[124:127], a[164:167], v[224:227]
  s_add_u32 s89, s89, s42
  v_xor_b32 v24, s1, v27
  v_mul_u32_u24 v52, 176, v15
  v_mfma_f32_16x16x32_bf16 v[228:231], a[124:127], a[192:195], v[228:231]
  s_add_u32 m0, s44, 0
  v_mov_b32 v97, 0
  v_lshlrev_b32 v24, 4, v24
  v_mfma_f32_16x16x32_bf16 v[228:231], a[120:123], a[152:155], v[228:231]
  s_and_b32 s21, s93, 0xffff
  v_add_u32 v14, s3, v14
  v_add3_u32 v24, v24, v52, s3
  v_mfma_f32_16x16x32_bf16 v[228:231], a[116:119], a[244:247], v[228:231]
  buffer_load_dwordx4 v36, s[4:7], s89 offen offset:0 sc1 lds
  v_mfma_f32_16x16x32_bf16 v[228:231], a[112:115], a[228:231], v[228:231]
  s_mov_b32 s22, 0x240000
  v_mul_u32_u24 v52, 1152, v15
  v_mfma_f32_16x16x32_bf16 v[232:235], a[112:115], a[232:235], v[232:235]
  s_mov_b32 s23, 0x20000
  v_lshl_add_u32 v52, v27, 4, v52
  v_lshrrev_b32 v15, 4, v15
  v_mfma_f32_16x16x32_bf16 v[232:235], a[116:119], a[248:251], v[232:235]
  s_add_u32 s94, s94, 0
  v_lshrrev_b32 v27, 3, v27
  v_mfma_f32_16x16x32_bf16 v[232:235], a[120:123], a[156:159], v[232:235]
  s_add_u32 s95, s95, 2560
  v_and_b32 v27, s51, v27
  v_mfma_f32_16x16x32_bf16 v[232:235], a[124:127], a[200:203], v[232:235]
  s_add_u32 s96, s96, 5120
  v_or_b32 v27, v27, v15
  v_mfma_f32_16x16x32_bf16 v[236:239], a[124:127], a[208:211], v[236:239]
  buffer_load_dwordx4 v37, s[4:7], s89 offen offset:1024 sc1 lds
  v_mfma_f32_16x16x32_bf16 v[236:239], a[120:123], a[160:163], v[236:239]
  s_add_u32 s65, s65, 7680
  v_lshl_add_u32 v52, v27, 22, v52
  v_mfma_f32_16x16x32_bf16 v[236:239], a[116:119], a[252:255], v[236:239]
  s_add_u32 s66, s66, 10240
  v_and_or_b32 v27, v0, 63, 64
  v_mfma_f32_16x16x32_bf16 v[236:239], a[112:115], a[236:239], v[236:239]
  s_waitcnt lgkmcnt(0)
  ds_read_b128 a[184:187], v45 offset:1024
  ds_read_b128 a[188:191], v45 offset:10240
  v_mfma_f32_16x16x32_bf16 v[220:223], a[168:171], a[236:239], v[220:223]
  s_add_u32 s97, s97, 12800
  ds_read_b128 a[196:199], v45 offset:19456
  ds_read_b128 a[204:207], v45 offset:28672
  v_mfma_f32_16x16x32_bf16 v[220:223], a[172:175], a[252:255], v[220:223]
  buffer_load_dwordx4 v38, s[4:7], s89 offen offset:2048 sc1 lds
  v_mfma_f32_16x16x32_bf16 v[220:223], a[176:179], a[160:163], v[220:223]
  s_add_u32 s98, s98, 15360
  v_mul_u32_u24 v15, 205, v27
  v_mfma_f32_16x16x32_bf16 v[220:223], a[180:183], a[208:211], v[220:223]
  v_lshrrev_b32 v15, 11, v15
  v_mfma_f32_16x16x32_bf16 v[216:219], a[180:183], a[200:203], v[216:219]
  v_mul_u32_u24 v53, 10, v15
  v_mfma_f32_16x16x32_bf16 v[216:219], a[176:179], a[156:159], v[216:219]
  v_sub_u32 v27, v27, v53
  v_mfma_f32_16x16x32_bf16 v[216:219], a[172:175], a[248:251], v[216:219]
  v_xor_b32 v25, s1, v27
  v_mul_u32_u24 v53, 176, v15
  v_mfma_f32_16x16x32_bf16 v[216:219], a[168:171], a[232:235], v[216:219]
  buffer_load_dwordx4 v39, s[4:7], s89 offen offset:3072 sc1 lds
  v_mfma_f32_16x16x32_bf16 v[212:215], a[168:171], a[228:231], v[212:215]
  v_lshlrev_b32 v25, 4, v25
  v_mfma_f32_16x16x32_bf16 v[212:215], a[172:175], a[244:247], v[212:215]
  s_add_u32 m0, s44, 4096
  v_add3_u32 v25, v25, v53, s3
  v_mfma_f32_16x16x32_bf16 v[212:215], a[176:179], a[152:155], v[212:215]
  v_mul_u32_u24 v53, 1152, v15
  v_mfma_f32_16x16x32_bf16 v[212:215], a[180:183], a[192:195], v[212:215]
  v_lshl_add_u32 v53, v27, 4, v53
  v_lshrrev_b32 v15, 4, v15
  v_mfma_f32_16x16x32_bf16 v[208:211], a[180:183], a[164:167], v[208:211]
  buffer_load_dwordx4 v40, s[4:7], s89 offen offset:0 sc1 lds
  v_mfma_f32_16x16x32_bf16 v[208:211], a[176:179], a[148:151], v[208:211]
  v_lshrrev_b32 v27, 3, v27
  v_mfma_f32_16x16x32_bf16 v[208:211], a[172:175], a[240:243], v[208:211]
  v_and_b32 v27, s51, v27
  v_mfma_f32_16x16x32_bf16 v[208:211], a[168:171], a[224:227], v[208:211]
  s_waitcnt lgkmcnt(0)
  ds_read_b128 a[212:215], v45 offset:4096
  ds_read_b128 a[220:223], v45 offset:13312
  v_mfma_f32_16x16x32_bf16 v[192:195], a[184:187], a[224:227], v[192:195]
  ds_read_b128 a[128:131], v45 offset:22528
  ds_read_b128 a[136:139], v45 offset:31744
  v_mfma_f32_16x16x32_bf16 v[192:195], a[188:191], a[240:243], v[192:195]
  buffer_load_dwordx4 v41, s[4:7], s89 offen offset:1024 sc1 lds
  v_mfma_f32_16x16x32_bf16 v[192:195], a[196:199], a[148:151], v[192:195]
  v_or_b32 v27, v27, v15
  v_mfma_f32_16x16x32_bf16 v[192:195], a[204:207], a[164:167], v[192:195]
  v_lshl_add_u32 v53, v27, 22, v53
  v_mfma_f32_16x16x32_bf16 v[196:199], a[204:207], a[192:195], v[196:199]
  v_and_or_b32 v27, v0, 63, 0
  v_mfma_f32_16x16x32_bf16 v[196:199], a[196:199], a[152:155], v[196:199]
  v_add_u32 v27, 128, v27
  v_mfma_f32_16x16x32_bf16 v[196:199], a[188:191], a[244:247], v[196:199]
  v_mul_u32_u24 v15, 205, v27
  v_mfma_f32_16x16x32_bf16 v[196:199], a[184:187], a[228:231], v[196:199]
  buffer_load_dwordx4 v42, s[4:7], s89 offen offset:2048 sc1 lds
  v_mfma_f32_16x16x32_bf16 v[200:203], a[184:187], a[232:235], v[200:203]
  v_lshrrev_b32 v15, 11, v15
  v_mfma_f32_16x16x32_bf16 v[200:203], a[188:191], a[248:251], v[200:203]
  v_mul_u32_u24 v54, 10, v15
  v_mfma_f32_16x16x32_bf16 v[200:203], a[196:199], a[156:159], v[200:203]
  v_sub_u32 v27, v27, v54
  v_mfma_f32_16x16x32_bf16 v[200:203], a[204:207], a[200:203], v[200:203]
  v_xor_b32 v26, s1, v27
  v_mul_u32_u24 v54, 176, v15
  v_mfma_f32_16x16x32_bf16 v[204:207], a[204:207], a[208:211], v[204:207]
  buffer_load_dwordx4 v43, s[4:7], s89 offen offset:3072 sc1 lds
  v_mfma_f32_16x16x32_bf16 v[204:207], a[196:199], a[160:163], v[204:207]
  s_mul_i32 s1, s51, 160
  v_lshlrev_b32 v26, 4, v26
  v_mfma_f32_16x16x32_bf16 v[204:207], a[188:191], a[252:255], v[204:207]
  s_add_u32 m0, s44, 8192
  v_add3_u32 v26, v26, v54, s3
  v_mfma_f32_16x16x32_bf16 v[204:207], a[184:187], a[236:239], v[204:207]
  s_waitcnt lgkmcnt(0)
  ds_read_b128 a[112:115], v45 offset:6144
  ds_read_b128 a[116:119], v45 offset:15360
  v_mfma_f32_16x16x32_bf16 v[188:191], a[212:215], a[236:239], v[188:191]
  s_add_u32 s1, s1, s53
  ds_read_b128 a[120:123], v45 offset:24576
  ds_read_b128 a[124:127], v45 offset:33792
  v_mfma_f32_16x16x32_bf16 v[188:191], a[220:223], a[252:255], v[188:191]
pad_m_17:
  s_cbranch_execz warm_4
  buffer_load_dwordx4 v44, s[4:7], s89 offen offset:0 sc1 lds
  v_mfma_f32_16x16x32_bf16 v[188:191], a[128:131], a[160:163], v[188:191]
  v_mul_u32_u24 v54, 1152, v15
  v_mfma_f32_16x16x32_bf16 v[188:191], a[136:139], a[208:211], v[188:191]
  v_lshl_add_u32 v54, v27, 4, v54
  v_lshrrev_b32 v15, 4, v15
  v_mfma_f32_16x16x32_bf16 v[184:187], a[136:139], a[200:203], v[184:187]
  s_add_u32 s88, s88, 4096
  v_lshrrev_b32 v27, 3, v27
  v_mfma_f32_16x16x32_bf16 v[184:187], a[128:131], a[156:159], v[184:187]
  v_and_b32 v27, s51, v27
  v_mfma_f32_16x16x32_bf16 v[184:187], a[220:223], a[248:251], v[184:187]
  v_or_b32 v27, v27, v15
  v_mfma_f32_16x16x32_bf16 v[184:187], a[212:215], a[232:235], v[184:187]
  buffer_load_dwordx4 a[0:3], v28, s[4:7], s88 offen sc1
  v_mfma_f32_16x16x32_bf16 v[180:183], a[212:215], a[228:231], v[180:183]
  v_lshl_add_u32 v54, v27, 22, v54
  v_mfma_f32_16x16x32_bf16 v[180:183], a[220:223], a[244:247], v[180:183]
  v_mfma_f32_16x16x32_bf16 v[180:183], a[128:131], a[152:155], v[180:183]
  v_mfma_f32_16x16x32_bf16 v[180:183], a[136:139], a[192:195], v[180:183]
  v_mfma_f32_16x16x32_bf16 v[176:179], a[136:139], a[164:167], v[176:179]
  buffer_load_dwordx4 a[4:7], v29, s[4:7], s88 offen sc1
  v_mfma_f32_16x16x32_bf16 v[176:179], a[128:131], a[148:151], v[176:179]
  v_mfma_f32_16x16x32_bf16 v[176:179], a[220:223], a[240:243], v[176:179]
  v_mfma_f32_16x16x32_bf16 v[176:179], a[212:215], a[224:227], v[176:179]
  s_waitcnt lgkmcnt(0)
  ds_read_b128 a[168:171], v45 offset:5120
  ds_read_b128 a[172:175], v45 offset:14336
  v_mfma_f32_16x16x32_bf16 v[160:163], a[112:115], a[224:227], v[160:163]
  ds_read_b128 a[176:179], v45 offset:23552
  ds_read_b128 a[180:183], v45 offset:32768
  v_mfma_f32_16x16x32_bf16 v[160:163], a[116:119], a[240:243], v[160:163]
  buffer_load_dwordx4 a[8:11], v30, s[4:7], s88 offen sc1
  v_mfma_f32_16x16x32_bf16 v[160:163], a[120:123], a[148:151], v[160:163]
  v_mfma_f32_16x16x32_bf16 v[160:163], a[124:127], a[164:167], v[160:163]
  v_mfma_f32_16x16x32_bf16 v[164:167], a[124:127], a[192:195], v[164:167]
  v_mfma_f32_16x16x32_bf16 v[164:167], a[120:123], a[152:155], v[164:167]
  v_mfma_f32_16x16x32_bf16 v[164:167], a[116:119], a[244:247], v[164:167]
  v_mfma_f32_16x16x32_bf16 v[164:167], a[112:115], a[228:231], v[164:167]
  buffer_load_dwordx4 a[12:15], v31, s[4:7], s88 offen sc1
  v_mfma_f32_16x16x32_bf16 v[168:171], a[112:115], a[232:235], v[168:171]
  v_mfma_f32_16x16x32_bf16 v[168:171], a[116:119], a[248:251], v[168:171]
  s_add_u32 s88, s88, 4096
  v_mfma_f32_16x16x32_bf16 v[168:171], a[120:123], a[156:159], v[168:171]
  v_mfma_f32_16x16x32_bf16 v[168:171], a[124:127], a[200:203], v[168:171]
  v_mfma_f32_16x16x32_bf16 v[172:175], a[124:127], a[208:211], v[172:175]
  buffer_load_dwordx4 a[32:35], v28, s[4:7], s88 offen sc1
  v_mfma_f32_16x16x32_bf16 v[172:175], a[120:123], a[160:163], v[172:175]
  v_mfma_f32_16x16x32_bf16 v[172:175], a[116:119], a[252:255], v[172:175]
  v_mfma_f32_16x16x32_bf16 v[172:175], a[112:115], a[236:239], v[172:175]
  s_waitcnt lgkmcnt(0)
  ds_read_b128 a[184:187], v45 offset:2048
  ds_read_b128 a[188:191], v45 offset:11264
  v_mfma_f32_16x16x32_bf16 v[156:159], a[168:171], a[236:239], v[156:159]
  ds_read_b128 a[196:199], v45 offset:20480
  ds_read_b128 a[204:207], v45 offset:29696
  v_mfma_f32_16x16x32_bf16 v[156:159], a[172:175], a[252:255], v[156:159]
  buffer_load_dwordx4 a[36:39], v29, s[4:7], s88 offen sc1
  v_mfma_f32_16x16x32_bf16 v[156:159], a[176:179], a[160:163], v[156:159]
  v_mfma_f32_16x16x32_bf16 v[156:159], a[180:183], a[208:211], v[156:159]
  v_mfma_f32_16x16x32_bf16 v[152:155], a[180:183], a[200:203], v[152:155]
  v_mfma_f32_16x16x32_bf16 v[152:155], a[176:179], a[156:159], v[152:155]
  v_mfma_f32_16x16x32_bf16 v[152:155], a[172:175], a[248:251], v[152:155]
  v_mfma_f32_16x16x32_bf16 v[152:155], a[168:171], a[232:235], v[152:155]
  buffer_load_dwordx4 a[40:43], v30, s[4:7], s88 offen sc1
  v_mfma_f32_16x16x32_bf16 v[148:151], a[168:171], a[228:231], v[148:151]
  v_mfma_f32_16x16x32_bf16 v[148:151], a[172:175], a[244:247], v[148:151]
  buffer_load_dword v59, off, s[4:7], s46 sc1
  v_mfma_f32_16x16x32_bf16 v[148:151], a[176:179], a[152:155], v[148:151]
  v_mfma_f32_16x16x32_bf16 v[148:151], a[180:183], a[192:195], v[148:151]
  v_mfma_f32_16x16x32_bf16 v[144:147], a[180:183], a[164:167], v[144:147]
  buffer_load_dwordx4 a[44:47], v31, s[4:7], s88 offen sc1
  v_mfma_f32_16x16x32_bf16 v[144:147], a[176:179], a[148:151], v[144:147]
  v_mfma_f32_16x16x32_bf16 v[144:147], a[172:175], a[240:243], v[144:147]
  s_add_u32 s88, s88, 4096
  v_mfma_f32_16x16x32_bf16 v[144:147], a[168:171], a[224:227], v[144:147]
  s_waitcnt lgkmcnt(0)
  ds_read_b128 a[212:215], v45 offset:3072
  ds_read_b128 a[220:223], v45 offset:12288
  v_mfma_f32_16x16x32_bf16 v[128:131], a[184:187], a[224:227], v[128:131]
  ds_read_b128 a[128:131], v45 offset:21504
  ds_read_b128 a[136:139], v45 offset:30720
  v_mfma_f32_16x16x32_bf16 v[128:131], a[188:191], a[240:243], v[128:131]
  buffer_load_dwordx4 a[64:67], v28, s[4:7], s88 offen sc1
  v_mfma_f32_16x16x32_bf16 v[128:131], a[196:199], a[148:151], v[128:131]
  v_mfma_f32_16x16x32_bf16 v[128:131], a[204:207], a[164:167], v[128:131]
  v_mfma_f32_16x16x32_bf16 v[132:135], a[204:207], a[192:195], v[132:135]
  v_mfma_f32_16x16x32_bf16 v[132:135], a[196:199], a[152:155], v[132:135]
  v_mfma_f32_16x16x32_bf16 v[132:135], a[188:191], a[244:247], v[132:135]
  v_mfma_f32_16x16x32_bf16 v[132:135], a[184:187], a[228:231], v[132:135]
  buffer_load_dwordx4 a[68:71], v29, s[4:7], s88 offen sc1
  v_mfma_f32_16x16x32_bf16 v[136:139], a[184:187], a[232:235], v[136:139]
  v_mfma_f32_16x16x32_bf16 v[136:139], a[188:191], a[248:251], v[136:139]
  v_mfma_f32_16x16x32_bf16 v[136:139], a[196:199], a[156:159], v[136:139]
  v_mfma_f32_16x16x32_bf16 v[136:139], a[204:207], a[200:203], v[136:139]
  v_mfma_f32_16x16x32_bf16 v[140:143], a[204:207], a[208:211], v[140:143]
  s_mov_b64 exec, 0
warm_P_0:
  s_cmp_lg_u32 s77, 10
  s_cbranch_scc1 warm_P_1
  s_cmp_eq_u32 s57, 0
  s_cbranch_scc1 pad_p3_end10_1
  s_cmp_eq_u32 s57, 1
  s_cbranch_scc1 pad_p3_tail_0
  s_cmp_eq_u32 s57, 2
  s_cbranch_scc1 pad_p3_tail_1
  s_branch pad_p3_tail_2
warm_P_1:
  s_cmp_lg_u32 s77, 6
  s_cbranch_scc1 warm_P_2
  s_cmp_eq_u32 s57, 0
  s_cbranch_scc1 pad_p3_end6_0
  s_cmp_eq_u32 s57, 1
  s_cbranch_scc1 pad_p3_end6_1
  s_cmp_eq_u32 s57, 2
  s_cbranch_scc1 pad_p3_tail_0
  s_branch pad_p3_tail_1
warm_P_2:
  s_cmp_lg_u32 s77, 7
  s_cbranch_scc1 warm_P_3
  s_cmp_eq_u32 s57, 0
  s_cbranch_scc1 pad_p3_end7_0
  s_cmp_eq_u32 s57, 1
  s_cbranch_scc1 pad_p3_end7_1
  s_cmp_eq_u32 s57, 2
  s_cbranch_scc1 pad_p3_tail_0
  s_branch pad_p3_tail_1
warm_P_3:
  s_cmp_lg_u32 s77, 8
  s_cbranch_scc1 warm_P_4
  s_cmp_eq_u32 s57, 0
  s_cbranch_scc1 pad_p3_end8_0
  s_cmp_eq_u32 s57, 1
  s_cbranch_scc1 pad_p3_end8_1
  s_cmp_eq_u32 s57, 2
  s_cbranch_scc1 pad_p3_tail_0
  s_branch pad_p3_tail_1
warm_P_4:
  s_cmp_eq_u32 s57, 0
  s_cbranch_scc1 pad_p3_end9_0
  s_cmp_eq_u32 s57, 1
  s_cbranch_scc1 pad_p3_end9_1
  s_cmp_eq_u32 s57, 2
  s_cbranch_scc1 pad_p3_tail_0
  s_branch pad_p3_tail_1
warm_P:
  s_mov_b64 exec, -1
  s_nop 3
  buffer_load_dwordx4 a[72:75], v30, s[4:7], s88 offen sc1
  v_mfma_f32_16x16x32_bf16 v[140:143], a[196:199], a[160:163], v[140:143]
  s_waitcnt vmcnt(38) lgkmcnt(0)
  s_barrier
  v_mfma_f32_16x16x32_bf16 v[140:143], a[188:191], a[252:255], v[140:143]
  v_mfma_f32_16x16x32_bf16 v[140:143], a[184:187], a[236:239], v[140:143]
  ds_read_b128 a[112:115], v46 offset:8192
  ds_read_b128 a[116:119], v46 offset:17408
  v_mfma_f32_16x16x32_bf16 v[124:127], a[212:215], a[236:239], v[124:127]
  ds_read_b128 a[120:123], v46 offset:26624
  ds_read_b128 a[124:127], v46 offset:35840
  v_mfma_f32_16x16x32_bf16 v[124:127], a[220:223], a[252:255], v[124:127]
  buffer_load_dwordx4 a[76:79], v31, s[4:7], s88 offen sc1
  v_mfma_f32_16x16x32_bf16 v[124:127], a[128:131], a[160:163], v[124:127]
  v_mfma_f32_16x16x32_bf16 v[124:127], a[136:139], a[208:211], v[124:127]
  v_mfma_f32_16x16x32_bf16 v[120:123], a[136:139], a[200:203], v[120:123]
  s_add_u32 s88, s88, 4096
  v_mfma_f32_16x16x32_bf16 v[120:123], a[128:131], a[156:159], v[120:123]
  v_mfma_f32_16x16x32_bf16 v[120:123], a[220:223], a[248:251], v[120:123]
  v_mfma_f32_16x16x32_bf16 v[120:123], a[212:215], a[232:235], v[120:123]
  buffer_load_dwordx4 a[96:99], v28, s[4:7], s88 offen sc1
  v_mfma_f32_16x16x32_bf16 v[116:119], a[212:215], a[228:231], v[116:119]
  v_mfma_f32_16x16x32_bf16 v[116:119], a[220:223], a[244:247], v[116:119]
  v_mfma_f32_16x16x32_bf16 v[116:119], a[128:131], a[152:155], v[116:119]
  v_mfma_f32_16x16x32_bf16 v[116:119], a[136:139], a[192:195], v[116:119]
  v_mfma_f32_16x16x32_bf16 v[112:115], a[136:139], a[164:167], v[112:115]
  buffer_load_dwordx4 a[100:103], v29, s[4:7], s88 offen sc1
  v_mfma_f32_16x16x32_bf16 v[112:115], a[128:131], a[148:151], v[112:115]
  v_mfma_f32_16x16x32_bf16 v[112:115], a[220:223], a[240:243], v[112:115]
  v_mfma_f32_16x16x32_bf16 v[112:115], a[212:215], a[224:227], v[112:115]
  s_waitcnt lgkmcnt(0)
  ds_read_b128 a[168:171], v46 offset:7168
  ds_read_b128 a[172:175], v46 offset:16384
  s_cmp_eq_u32 s77, 6
  s_cbranch_scc1 p3_end6
  s_waitcnt vmcnt(40)
  v_mfma_f32_16x16x32_bf16 v[240:243], a[112:115], a[216:219], v[240:243]
  s_waitcnt vmcnt(35)
  ds_read_b128 a[176:179], v46 offset:25600
  ds_read_b128 a[180:183], v46 offset:34816
  v_mfma_f32_16x16x32_bf16 v[240:243], a[116:119], a[16:19], v[240:243]
  s_waitcnt vmcnt(31)
  v_mfma_f32_16x16x32_bf16 v[240:243], a[120:123], a[48:51], v[240:243]
  s_waitcnt vmcnt(27)
  buffer_load_dwordx4 a[104:107], v30, s[4:7], s88 offen sc1
  v_mfma_f32_16x16x32_bf16 v[240:243], a[124:127], a[80:83], v[240:243]
  s_waitcnt vmcnt(27)
  v_mfma_f32_16x16x32_bf16 v[244:247], a[124:127], a[84:87], v[244:247]
  v_mfma_f32_16x16x32_bf16 v[244:247], a[120:123], a[52:55], v[244:247]
  v_mfma_f32_16x16x32_bf16 v[244:247], a[116:119], a[20:23], v[244:247]
  v_mfma_f32_16x16x32_bf16 v[244:247], a[112:115], a[144:147], v[244:247]
  buffer_load_dwordx4 a[108:111], v31, s[4:7], s88 offen sc1
  v_mfma_f32_16x16x32_bf16 v[248:251], a[112:115], a[132:135], v[248:251]
  v_mfma_f32_16x16x32_bf16 v[248:251], a[116:119], a[24:27], v[248:251]
  s_add_u32 s89, s89, s79
  v_mfma_f32_16x16x32_bf16 v[248:251], a[120:123], a[56:59], v[248:251]
  s_waitcnt vmcnt(27)
  s_add_u32 m0, s44, 49152
  v_mfma_f32_16x16x32_bf16 v[248:251], a[124:127], a[88:91], v[248:251]
  s_waitcnt vmcnt(26)
  v_mfma_f32_16x16x32_bf16 v[252:255], a[124:127], a[92:95], v[252:255]
  buffer_load_dwordx4 v36, s[4:7], s89 offen offset:0 sc1 lds
  v_mfma_f32_16x16x32_bf16 v[252:255], a[120:123], a[60:63], v[252:255]
  v_mfma_f32_16x16x32_bf16 v[252:255], a[116:119], a[28:31], v[252:255]
  v_mfma_f32_16x16x32_bf16 v[252:255], a[112:115], a[140:143], v[252:255]
  s_waitcnt lgkmcnt(0)
  ds_read_b128 a[184:187], v46 offset:0
  ds_read_b128 a[188:191], v46 offset:9216
  v_mfma_f32_16x16x32_bf16 v[236:239], a[168:171], a[140:143], v[236:239]
  ds_read_b128 a[196:199], v46 offset:18432
  ds_read_b128 a[204:207], v46 offset:27648
  v_mfma_f32_16x16x32_bf16 v[236:239], a[172:175], a[28:31], v[236:239]
  v_mfma_f32_16x16x32_bf16 v[236:239], a[176:179], a[60:63], v[236:239]
  buffer_load_dwordx4 v37, s[4:7], s89 offen offset:1024 sc1 lds
  v_mfma_f32_16x16x32_bf16 v[236:239], a[180:183], a[92:95], v[236:239]
  v_mfma_f32_16x16x32_bf16 v[232:235], a[180:183], a[88:91], v[232:235]
  v_mfma_f32_16x16x32_bf16 v[232:235], a[176:179], a[56:59], v[232:235]
  v_mfma_f32_16x16x32_bf16 v[232:235], a[172:175], a[24:27], v[232:235]
  v_mfma_f32_16x16x32_bf16 v[232:235], a[168:171], a[132:135], v[232:235]
  buffer_load_dwordx4 v38, s[4:7], s89 offen offset:2048 sc1 lds
  v_mfma_f32_16x16x32_bf16 v[228:231], a[168:171], a[144:147], v[228:231]
  v_mfma_f32_16x16x32_bf16 v[228:231], a[172:175], a[20:23], v[228:231]
  v_mfma_f32_16x16x32_bf16 v[228:231], a[176:179], a[52:55], v[228:231]
  v_mfma_f32_16x16x32_bf16 v[228:231], a[180:183], a[84:87], v[228:231]
  v_mfma_f32_16x16x32_bf16 v[224:227], a[180:183], a[80:83], v[224:227]
  buffer_load_dwordx4 v39, s[4:7], s89 offen offset:3072 sc1 lds
  v_mfma_f32_16x16x32_bf16 v[224:227], a[176:179], a[48:51], v[224:227]
  v_mfma_f32_16x16x32_bf16 v[224:227], a[172:175], a[16:19], v[224:227]
  v_mfma_f32_16x16x32_bf16 v[224:227], a[168:171], a[216:219], v[224:227]
  s_waitcnt lgkmcnt(0)
  ds_read_b128 a[212:215], v46 offset:1024
  ds_read_b128 a[220:223], v46 offset:10240
  v_mfma_f32_16x16x32_bf16 v[208:211], a[184:187], a[216:219], v[208:211]
  s_add_u32 m0, s44, 53248
  ds_read_b128 a[128:131], v46 offset:19456
  ds_read_b128 a[136:139], v46 offset:28672
  v_mfma_f32_16x16x32_bf16 v[208:211], a[188:191], a[16:19], v[208:211]
  v_mfma_f32_16x16x32_bf16 v[208:211], a[196:199], a[48:51], v[208:211]
  buffer_load_dwordx4 v40, s[4:7], s89 offen offset:0 sc1 lds
  v_mfma_f32_16x16x32_bf16 v[208:211], a[204:207], a[80:83], v[208:211]
  v_mfma_f32_16x16x32_bf16 v[212:215], a[204:207], a[84:87], v[212:215]
  v_mfma_f32_16x16x32_bf16 v[212:215], a[196:199], a[52:55], v[212:215]
  v_mfma_f32_16x16x32_bf16 v[212:215], a[188:191], a[20:23], v[212:215]
  v_mfma_f32_16x16x32_bf16 v[212:215], a[184:187], a[144:147], v[212:215]
  buffer_load_dwordx4 v41, s[4:7], s89 offen offset:1024 sc1 lds
  v_mfma_f32_16x16x32_bf16 v[216:219], a[184:187], a[132:135], v[216:219]
  v_mfma_f32_16x16x32_bf16 v[216:219], a[188:191], a[24:27], v[216:219]
  v_mfma_f32_16x16x32_bf16 v[216:219], a[196:199], a[56:59], v[216:219]
  v_mfma_f32_16x16x32_bf16 v[216:219], a[204:207], a[88:91], v[216:219]
  v_mfma_f32_16x16x32_bf16 v[220:223], a[204:207], a[92:95], v[220:223]
  buffer_load_dwordx4 v42, s[4:7], s89 offen offset:2048 sc1 lds
  v_mfma_f32_16x16x32_bf16 v[220:223], a[196:199], a[60:63], v[220:223]
  v_mfma_f32_16x16x32_bf16 v[220:223], a[188:191], a[28:31], v[220:223]
  v_mfma_f32_16x16x32_bf16 v[220:223], a[184:187], a[140:143], v[220:223]
  s_waitcnt lgkmcnt(0)
  ds_read_b128 a[112:115], v46 offset:4096
  ds_read_b128 a[116:119], v46 offset:13312
  v_mfma_f32_16x16x32_bf16 v[204:207], a[212:215], a[140:143], v[204:207]
  ds_read_b128 a[120:123], v46 offset:22528
  ds_read_b128 a[124:127], v46 offset:31744
  v_mfma_f32_16x16x32_bf16 v[204:207], a[220:223], a[28:31], v[204:207]
  v_mfma_f32_16x16x32_bf16 v[204:207], a[128:131], a[60:63], v[204:207]
  buffer_load_dwordx4 v43, s[4:7], s89 offen offset:3072 sc1 lds
  v_mfma_f32_16x16x32_bf16 v[204:207], a[136:139], a[92:95], v[204:207]
  v_mfma_f32_16x16x32_bf16 v[200:203], a[136:139], a[88:91], v[200:203]
  s_add_u32 m0, s44, 57344
  v_mfma_f32_16x16x32_bf16 v[200:203], a[128:131], a[56:59], v[200:203]
  v_mfma_f32_16x16x32_bf16 v[200:203], a[220:223], a[24:27], v[200:203]
  v_mfma_f32_16x16x32_bf16 v[200:203], a[212:215], a[132:135], v[200:203]
  buffer_load_dwordx4 v44, s[4:7], s89 offen offset:0 sc1 lds
  v_mfma_f32_16x16x32_bf16 v[196:199], a[212:215], a[144:147], v[196:199]
  s_waitcnt vmcnt(18)
  v_readfirstlane_b32 s73, v59
  s_nop 0
  s_and_b32 s73, s73, s54
  s_cmp_ge_u32 s73, s54
  s_cbranch_scc0 spin_k6
back_k6:
  v_mfma_f32_16x16x32_bf16 v[196:199], a[220:223], a[20:23], v[196:199]
  s_add_u32 s88, s88, s11
  v_mfma_f32_16x16x32_bf16 v[196:199], a[128:131], a[52:55], v[196:199]
  v_mfma_f32_16x16x32_bf16 v[196:199], a[136:139], a[84:87], v[196:199]
  v_mfma_f32_16x16x32_bf16 v[192:195], a[136:139], a[80:83], v[192:195]
  buffer_load_dwordx4 a[224:227], v28, s[4:7], s88 offen sc1
  v_mfma_f32_16x16x32_bf16 v[192:195], a[128:131], a[48:51], v[192:195]
  v_mfma_f32_16x16x32_bf16 v[192:195], a[220:223], a[16:19], v[192:195]
  v_mfma_f32_16x16x32_bf16 v[192:195], a[212:215], a[216:219], v[192:195]
  s_waitcnt lgkmcnt(0)
  ds_read_b128 a[168:171], v46 offset:6144
  ds_read_b128 a[172:175], v46 offset:15360
  v_mfma_f32_16x16x32_bf16 v[176:179], a[112:115], a[216:219], v[176:179]
  ds_read_b128 a[176:179], v46 offset:24576
  ds_read_b128 a[180:183], v46 offset:33792
  v_mfma_f32_16x16x32_bf16 v[176:179], a[116:119], a[16:19], v[176:179]
  v_mfma_f32_16x16x32_bf16 v[176:179], a[120:123], a[48:51], v[176:179]
  buffer_load_dwordx4 a[228:231], v29, s[4:7], s88 offen sc1
  v_mfma_f32_16x16x32_bf16 v[176:179], a[124:127], a[80:83], v[176:179]
  v_mfma_f32_16x16x32_bf16 v[180:183], a[124:127], a[84:87], v[180:183]
  v_mfma_f32_16x16x32_bf16 v[180:183], a[120:123], a[52:55], v[180:183]
  v_mfma_f32_16x16x32_bf16 v[180:183], a[116:119], a[20:23], v[180:183]
  v_mfma_f32_16x16x32_bf16 v[180:183], a[112:115], a[144:147], v[180:183]
  buffer_load_dwordx4 a[232:235], v30, s[4:7], s88 offen sc1
  v_mfma_f32_16x16x32_bf16 v[184:187], a[112:115], a[132:135], v[184:187]
  v_mfma_f32_16x16x32_bf16 v[184:187], a[116:119], a[24:27], v[184:187]
  v_mfma_f32_16x16x32_bf16 v[184:187], a[120:123], a[56:59], v[184:187]
  v_mfma_f32_16x16x32_bf16 v[184:187], a[124:127], a[88:91], v[184:187]
  v_mfma_f32_16x16x32_bf16 v[188:191], a[124:127], a[92:95], v[188:191]
  buffer_load_dwordx4 a[236:239], v31, s[4:7], s88 offen sc1
  v_mfma_f32_16x16x32_bf16 v[188:191], a[120:123], a[60:63], v[188:191]
  v_mfma_f32_16x16x32_bf16 v[188:191], a[116:119], a[28:31], v[188:191]
  v_mfma_f32_16x16x32_bf16 v[188:191], a[112:115], a[140:143], v[188:191]
  s_waitcnt lgkmcnt(0)
  ds_read_b128 a[184:187], v46 offset:5120
  ds_read_b128 a[188:191], v46 offset:14336
  v_mfma_f32_16x16x32_bf16 v[172:175], a[168:171], a[140:143], v[172:175]
  s_add_u32 s88, s88, 4096
  ds_read_b128 a[196:199], v46 offset:23552
  ds_read_b128 a[204:207], v46 offset:32768
  v_mfma_f32_16x16x32_bf16 v[172:175], a[172:175], a[28:31], v[172:175]
  v_mfma_f32_16x16x32_bf16 v[172:175], a[176:179], a[60:63], v[172:175]
  buffer_load_dwordx4 a[240:243], v28, s[4:7], s88 offen sc1
  v_mfma_f32_16x16x32_bf16 v[172:175], a[180:183], a[92:95], v[172:175]
  v_mfma_f32_16x16x32_bf16 v[168:171], a[180:183], a[88:91], v[168:171]
  v_mfma_f32_16x16x32_bf16 v[168:171], a[176:179], a[56:59], v[168:171]
  v_mfma_f32_16x16x32_bf16 v[168:171], a[172:175], a[24:27], v[168:171]
  v_mfma_f32_16x16x32_bf16 v[168:171], a[168:171], a[132:135], v[168:171]
  buffer_load_dwordx4 a[244:247], v29, s[4:7], s88 offen sc1
  v_mfma_f32_16x16x32_bf16 v[164:167], a[168:171], a[144:147], v[164:167]
  v_mfma_f32_16x16x32_bf16 v[164:167], a[172:175], a[20:23], v[164:167]
  v_mfma_f32_16x16x32_bf16 v[164:167], a[176:179], a[52:55], v[164:167]
  v_mfma_f32_16x16x32_bf16 v[164:167], a[180:183], a[84:87], v[164:167]
  v_mfma_f32_16x16x32_bf16 v[160:163], a[180:183], a[80:83], v[160:163]
  buffer_load_dwordx4 a[248:251], v30, s[4:7], s88 offen sc1
  v_mfma_f32_16x16x32_bf16 v[160:163], a[176:179], a[48:51], v[160:163]
  v_mfma_f32_16x16x32_bf16 v[160:163], a[172:175], a[16:19], v[160:163]
  v_mfma_f32_16x16x32_bf16 v[160:163], a[168:171], a[216:219], v[160:163]
  s_waitcnt lgkmcnt(0)
  ds_read_b128 a[212:215], v46 offset:2048
  ds_read_b128 a[220:223], v46 offset:11264
  v_mfma_f32_16x16x32_bf16 v[144:147], a[184:187], a[216:219], v[144:147]
  ds_read_b128 a[128:131], v46 offset:20480
  ds_read_b128 a[136:139], v46 offset:29696
  v_mfma_f32_16x16x32_bf16 v[144:147], a[188:191], a[16:19], v[144:147]
  v_mfma_f32_16x16x32_bf16 v[144:147], a[196:199], a[48:51], v[144:147]
  buffer_load_dwordx4 a[252:255], v31, s[4:7], s88 offen sc1
  v_mfma_f32_16x16x32_bf16 v[144:147], a[204:207], a[80:83], v[144:147]
  v_mfma_f32_16x16x32_bf16 v[148:151], a[204:207], a[84:87], v[148:151]
  s_add_u32 s88, s88, 4096
  v_mfma_f32_16x16x32_bf16 v[148:151], a[196:199], a[52:55], v[148:151]
  v_mfma_f32_16x16x32_bf16 v[148:151], a[188:191], a[20:23], v[148:151]
  v_mfma_f32_16x16x32_bf16 v[148:151], a[184:187], a[144:147], v[148:151]
  buffer_load_dwordx4 a[148:151], v28, s[4:7], s88 offen sc1
  v_mfma_f32_16x16x32_bf16 v[152:155], a[184:187], a[132:135], v[152:155]
  v_mfma_f32_16x16x32_bf16 v[152:155], a[188:191], a[24:27], v[152:155]
  v_mfma_f32_16x16x32_bf16 v[152:155], a[196:199], a[56:59], v[152:155]
  v_mfma_f32_16x16x32_bf16 v[152:155], a[204:207], a[88:91], v[152:155]
  v_mfma_f32_16x16x32_bf16 v[156:159], a[204:207], a[92:95], v[156:159]
  v_mfma_f32_16x16x32_bf16 v[156:159], a[196:199], a[60:63], v[156:159]
  buffer_load_dwordx4 a[152:155], v29, s[4:7], s88 offen sc1
  v_mfma_f32_16x16x32_bf16 v[156:159], a[188:191], a[28:31], v[156:159]
  v_mfma_f32_16x16x32_bf16 v[156:159], a[184:187], a[140:143], v[156:159]
  s_waitcnt lgkmcnt(0)
  ds_read_b128 a[112:115], v46 offset:3072
  ds_read_b128 a[116:119], v46 offset:12288
  v_mfma_f32_16x16x32_bf16 v[140:143], a[212:215], a[140:143], v[140:143]
  ds_read_b128 a[120:123], v46 offset:21504
  ds_read_b128 a[124:127], v46 offset:30720
  v_mfma_f32_16x16x32_bf16 v[140:143], a[220:223], a[28:31], v[140:143]
  v_mfma_f32_16x16x32_bf16 v[140:143], a[128:131], a[60:63], v[140:143]
  buffer_load_dwordx4 a[156:159], v30, s[4:7], s88 offen sc1
  v_mfma_f32_16x16x32_bf16 v[140:143], a[136:139], a[92:95], v[140:143]
  v_mfma_f32_16x16x32_bf16 v[136:139], a[136:139], a[88:91], v[136:139]
  v_mfma_f32_16x16x32_bf16 v[136:139], a[128:131], a[56:59], v[136:139]
  v_mfma_f32_16x16x32_bf16 v[136:139], a[220:223], a[24:27], v[136:139]
  v_mfma_f32_16x16x32_bf16 v[136:139], a[212:215], a[132:135], v[136:139]
  buffer_load_dwordx4 a[160:163], v31, s[4:7], s88 offen sc1
  v_mfma_f32_16x16x32_bf16 v[132:135], a[212:215], a[144:147], v[132:135]
  v_mfma_f32_16x16x32_bf16 v[132:135], a[220:223], a[20:23], v[132:135]
  v_mfma_f32_16x16x32_bf16 v[132:135], a[128:131], a[52:55], v[132:135]
  s_add_u32 s88, s88, 4096
  v_mfma_f32_16x16x32_bf16 v[132:135], a[136:139], a[84:87], v[132:135]
  v_mfma_f32_16x16x32_bf16 v[128:131], a[136:139], a[80:83], v[128:131]
  v_mfma_f32_16x16x32_bf16 v[128:131], a[128:131], a[48:51], v[128:131]
  s_waitcnt lgkmcnt(0)
  s_barrier
  v_mfma_f32_16x16x32_bf16 v[128:131], a[220:223], a[16:19], v[128:131]
  buffer_load_dwordx4 a[164:167], v28, s[4:7], s88 offen sc1
  v_mfma_f32_16x16x32_bf16 v[128:131], a[212:215], a[216:219], v[128:131]
  ds_read_b128 a[168:171], v47 offset:8192
  ds_read_b128 a[172:175], v47 offset:17408
  v_mfma_f32_16x16x32_bf16 v[112:115], a[112:115], a[216:219], v[112:115]
  ds_read_b128 a[176:179], v47 offset:26624
  ds_read_b128 a[180:183], v47 offset:35840
  v_mfma_f32_16x16x32_bf16 v[112:115], a[116:119], a[16:19], v[112:115]
  v_mfma_f32_16x16x32_bf16 v[112:115], a[120:123], a[48:51], v[112:115]
  buffer_load_dwordx4 a[192:195], v29, s[4:7], s88 offen sc1
  v_mfma_f32_16x16x32_bf16 v[112:115], a[124:127], a[80:83], v[112:115]
  v_mfma_f32_16x16x32_bf16 v[116:119], a[124:127], a[84:87], v[116:119]
  v_mfma_f32_16x16x32_bf16 v[116:119], a[120:123], a[52:55], v[116:119]
  v_mfma_f32_16x16x32_bf16 v[116:119], a[116:119], a[20:23], v[116:119]
  v_mfma_f32_16x16x32_bf16 v[116:119], a[112:115], a[144:147], v[116:119]
  buffer_load_dwordx4 a[200:203], v30, s[4:7], s88 offen sc1
  v_mfma_f32_16x16x32_bf16 v[120:123], a[112:115], a[132:135], v[120:123]
  v_mfma_f32_16x16x32_bf16 v[120:123], a[116:119], a[24:27], v[120:123]
  v_mfma_f32_16x16x32_bf16 v[120:123], a[120:123], a[56:59], v[120:123]
  v_mfma_f32_16x16x32_bf16 v[120:123], a[124:127], a[88:91], v[120:123]
  v_mfma_f32_16x16x32_bf16 v[124:127], a[124:127], a[92:95], v[124:127]
  v_mfma_f32_16x16x32_bf16 v[124:127], a[120:123], a[60:63], v[124:127]
  buffer_load_dwordx4 a[208:211], v31, s[4:7], s88 offen sc1
  v_mfma_f32_16x16x32_bf16 v[124:127], a[116:119], a[28:31], v[124:127]
  v_mfma_f32_16x16x32_bf16 v[124:127], a[112:115], a[140:143], v[124:127]
  s_waitcnt lgkmcnt(0)
  ds_read_b128 a[184:187], v47 offset:7168
  ds_read_b128 a[188:191], v47 offset:16384
  s_cmp_eq_u32 s77, 7
  s_cbranch_scc1 p3_end7
  v_mfma_f32_16x16x32_bf16 v[252:255], a[168:171], a[12:15], v[252:255]
  s_waitcnt vmcnt(33)
  ds_read_b128 a[196:199], v47 offset:25600
  ds_read_b128 a[204:207], v47 offset:34816
  v_mfma_f32_16x16x32_bf16 v[252:255], a[172:175], a[44:47], v[252:255]
  s_waitcnt vmcnt(29)
  s_add_u32 s89, s89, s42
  v_mfma_f32_16x16x32_bf16 v[252:255], a[176:179], a[76:79], v[252:255]
  s_waitcnt vmcnt(25)
  s_add_u32 m0, s44, 86016
  v_mfma_f32_16x16x32_bf16 v[252:255], a[180:183], a[108:111], v[252:255]
  v_mfma_f32_16x16x32_bf16 v[248:251], a[180:183], a[104:107], v[248:251]
  buffer_load_dwordx4 v36, s[4:7], s89 offen offset:0 sc1 lds
  v_mfma_f32_16x16x32_bf16 v[248:251], a[176:179], a[72:75], v[248:251]
  v_mfma_f32_16x16x32_bf16 v[248:251], a[172:175], a[40:43], v[248:251]
  v_mfma_f32_16x16x32_bf16 v[248:251], a[168:171], a[8:11], v[248:251]
  v_mfma_f32_16x16x32_bf16 v[244:247], a[168:171], a[4:7], v[244:247]
  v_mfma_f32_16x16x32_bf16 v[244:247], a[172:175], a[36:39], v[244:247]
  buffer_load_dwordx4 v37, s[4:7], s89 offen offset:1024 sc1 lds
  v_mfma_f32_16x16x32_bf16 v[244:247], a[176:179], a[68:71], v[244:247]
  v_mfma_f32_16x16x32_bf16 v[244:247], a[180:183], a[100:103], v[244:247]
  v_mfma_f32_16x16x32_bf16 v[240:243], a[180:183], a[96:99], v[240:243]
  v_mfma_f32_16x16x32_bf16 v[240:243], a[176:179], a[64:67], v[240:243]
  v_mfma_f32_16x16x32_bf16 v[240:243], a[172:175], a[32:35], v[240:243]
  buffer_load_dwordx4 v38, s[4:7], s89 offen offset:2048 sc1 lds
  v_mfma_f32_16x16x32_bf16 v[240:243], a[168:171], a[0:3], v[240:243]
  s_waitcnt lgkmcnt(0)
  ds_read_b128 a[212:215], v47 offset:0
  ds_read_b128 a[220:223], v47 offset:9216
  v_mfma_f32_16x16x32_bf16 v[224:227], a[184:187], a[0:3], v[224:227]
  ds_read_b128 a[128:131], v47 offset:18432
  ds_read_b128 a[136:139], v47 offset:27648
  v_mfma_f32_16x16x32_bf16 v[224:227], a[188:191], a[32:35], v[224:227]
  v_mfma_f32_16x16x32_bf16 v[224:227], a[196:199], a[64:67], v[224:227]
  v_mfma_f32_16x16x32_bf16 v[224:227], a[204:207], a[96:99], v[224:227]
  v_mfma_f32_16x16x32_bf16 v[228:231], a[204:207], a[100:103], v[228:231]
  buffer_load_dwordx4 v39, s[4:7], s89 offen offset:3072 sc1 lds
  v_mfma_f32_16x16x32_bf16 v[228:231], a[196:199], a[68:71], v[228:231]
  v_mfma_f32_16x16x32_bf16 v[228:231], a[188:191], a[36:39], v[228:231]
  s_add_u32 m0, s44, 90112
  v_mfma_f32_16x16x32_bf16 v[228:231], a[184:187], a[4:7], v[228:231]
  v_mfma_f32_16x16x32_bf16 v[232:235], a[184:187], a[8:11], v[232:235]
  v_mfma_f32_16x16x32_bf16 v[232:235], a[188:191], a[40:43], v[232:235]
  buffer_load_dwordx4 v40, s[4:7], s89 offen offset:0 sc1 lds
  v_mfma_f32_16x16x32_bf16 v[232:235], a[196:199], a[72:75], v[232:235]
  v_mfma_f32_16x16x32_bf16 v[232:235], a[204:207], a[104:107], v[232:235]
  v_mfma_f32_16x16x32_bf16 v[236:239], a[204:207], a[108:111], v[236:239]
  v_mfma_f32_16x16x32_bf16 v[236:239], a[196:199], a[76:79], v[236:239]
  v_mfma_f32_16x16x32_bf16 v[236:239], a[188:191], a[44:47], v[236:239]
  v_mfma_f32_16x16x32_bf16 v[236:239], a[184:187], a[12:15], v[236:239]
  s_waitcnt lgkmcnt(0)
  ds_read_b128 a[112:115], v47 offset:1024
  ds_read_b128 a[116:119], v47 offset:10240
  v_mfma_f32_16x16x32_bf16 v[220:223], a[212:215], a[12:15], v[220:223]
  ds_read_b128 a[120:123], v47 offset:19456
  ds_read_b128 a[124:127], v47 offset:28672
  v_mfma_f32_16x16x32_bf16 v[220:223], a[220:223], a[44:47], v[220:223]
  buffer_load_dwordx4 v41, s[4:7], s89 offen offset:1024 sc1 lds
  v_mfma_f32_16x16x32_bf16 v[220:223], a[128:131], a[76:79], v[220:223]
  v_mfma_f32_16x16x32_bf16 v[220:223], a[136:139], a[108:111], v[220:223]
  v_mfma_f32_16x16x32_bf16 v[216:219], a[136:139], a[104:107], v[216:219]
  buffer_load_dwordx4 v42, s[4:7], s89 offen offset:2048 sc1 lds
  v_mfma_f32_16x16x32_bf16 v[216:219], a[128:131], a[72:75], v[216:219]
  v_mfma_f32_16x16x32_bf16 v[216:219], a[220:223], a[40:43], v[216:219]
  v_mfma_f32_16x16x32_bf16 v[216:219], a[212:215], a[8:11], v[216:219]
  v_mfma_f32_16x16x32_bf16 v[212:215], a[212:215], a[4:7], v[212:215]
  v_mfma_f32_16x16x32_bf16 v[212:215], a[220:223], a[36:39], v[212:215]
  buffer_load_dwordx4 v43, s[4:7], s89 offen offset:3072 sc1 lds
  v_mfma_f32_16x16x32_bf16 v[212:215], a[128:131], a[68:71], v[212:215]
  v_mfma_f32_16x16x32_bf16 v[212:215], a[136:139], a[100:103], v[212:215]
  v_mfma_f32_16x16x32_bf16 v[208:211], a[136:139], a[96:99], v[208:211]
  s_add_u32 m0, s44, 94208
  v_mfma_f32_16x16x32_bf16 v[208:211], a[128:131], a[64:67], v[208:211]
  v_mfma_f32_16x16x32_bf16 v[208:211], a[220:223], a[32:35], v[208:211]
  v_mfma_f32_16x16x32_bf16 v[208:211], a[212:215], a[0:3], v[208:211]
  s_waitcnt lgkmcnt(0)
  ds_read_b128 a[168:171], v47 offset:4096
  ds_read_b128 a[172:175], v47 offset:13312
  v_mfma_f32_16x16x32_bf16 v[192:195], a[112:115], a[0:3], v[192:195]
  ds_read_b128 a[176:179], v47 offset:22528
  ds_read_b128 a[180:183], v47 offset:31744
  v_mfma_f32_16x16x32_bf16 v[192:195], a[116:119], a[32:35], v[192:195]
  buffer_load_dwordx4 v44, s[4:7], s89 offen offset:0 sc1 lds
  v_mfma_f32_16x16x32_bf16 v[192:195], a[120:123], a[64:67], v[192:195]
  s_add_u32 s88, s88, 4096
  v_mfma_f32_16x16x32_bf16 v[192:195], a[124:127], a[96:99], v[192:195]
  v_mfma_f32_16x16x32_bf16 v[196:199], a[124:127], a[100:103], v[196:199]
  buffer_load_dwordx4 a[216:219], v28, s[4:7], s88 offen sc1
  v_mfma_f32_16x16x32_bf16 v[196:199], a[120:123], a[68:71], v[196:199]
  v_mfma_f32_16x16x32_bf16 v[196:199], a[116:119], a[36:39], v[196:199]
  v_mfma_f32_16x16x32_bf16 v[196:199], a[112:115], a[4:7], v[196:199]
  v_mfma_f32_16x16x32_bf16 v[200:203], a[112:115], a[8:11], v[200:203]
  v_mfma_f32_16x16x32_bf16 v[200:203], a[116:119], a[40:43], v[200:203]
  v_mfma_f32_16x16x32_bf16 v[200:203], a[120:123], a[72:75], v[200:203]
  buffer_load_dwordx4 a[144:147], v29, s[4:7], s88 offen sc1
  v_mfma_f32_16x16x32_bf16 v[200:203], a[124:127], a[104:107], v[200:203]
  v_mfma_f32_16x16x32_bf16 v[204:207], a[124:127], a[108:111], v[204:207]
  v_mfma_f32_16x16x32_bf16 v[204:207], a[120:123], a[76:79], v[204:207]
  v_mfma_f32_16x16x32_bf16 v[204:207], a[116:119], a[44:47], v[204:207]
  v_mfma_f32_16x16x32_bf16 v[204:207], a[112:115], a[12:15], v[204:207]
  s_waitcnt lgkmcnt(0)
  ds_read_b128 a[184:187], v47 offset:6144
  ds_read_b128 a[188:191], v47 offset:15360
  v_mfma_f32_16x16x32_bf16 v[188:191], a[168:171], a[12:15], v[188:191]
  ds_read_b128 a[196:199], v47 offset:24576
  ds_read_b128 a[204:207], v47 offset:33792
  v_mfma_f32_16x16x32_bf16 v[188:191], a[172:175], a[44:47], v[188:191]
  buffer_load_dwordx4 a[132:135], v30, s[4:7], s88 offen sc1
  v_mfma_f32_16x16x32_bf16 v[188:191], a[176:179], a[76:79], v[188:191]
  v_mfma_f32_16x16x32_bf16 v[188:191], a[180:183], a[108:111], v[188:191]
  v_mfma_f32_16x16x32_bf16 v[184:187], a[180:183], a[104:107], v[184:187]
  buffer_load_dwordx4 a[140:143], v31, s[4:7], s88 offen sc1
  v_mfma_f32_16x16x32_bf16 v[184:187], a[176:179], a[72:75], v[184:187]
  v_mfma_f32_16x16x32_bf16 v[184:187], a[172:175], a[40:43], v[184:187]
  v_mfma_f32_16x16x32_bf16 v[184:187], a[168:171], a[8:11], v[184:187]
  s_add_u32 s88, s88, 4096
  v_mfma_f32_16x16x32_bf16 v[180:183], a[168:171], a[4:7], v[180:183]
  v_mfma_f32_16x16x32_bf16 v[180:183], a[172:175], a[36:39], v[180:183]
  v_mfma_f32_16x16x32_bf16 v[180:183], a[176:179], a[68:71], v[180:183]
  buffer_load_dwordx4 a[16:19], v28, s[4:7], s88 offen sc1
  v_mfma_f32_16x16x32_bf16 v[180:183], a[180:183], a[100:103], v[180:183]
  v_mfma_f32_16x16x32_bf16 v[176:179], a[180:183], a[96:99], v[176:179]
  v_mfma_f32_16x16x32_bf16 v[176:179], a[176:179], a[64:67], v[176:179]
  v_mfma_f32_16x16x32_bf16 v[176:179], a[172:175], a[32:35], v[176:179]
  v_mfma_f32_16x16x32_bf16 v[176:179], a[168:171], a[0:3], v[176:179]
  s_waitcnt lgkmcnt(0)
  ds_read_b128 a[212:215], v47 offset:5120
  ds_read_b128 a[220:223], v47 offset:14336
  v_mfma_f32_16x16x32_bf16 v[160:163], a[184:187], a[0:3], v[160:163]
  ds_read_b128 a[128:131], v47 offset:23552
  ds_read_b128 a[136:139], v47 offset:32768
  v_mfma_f32_16x16x32_bf16 v[160:163], a[188:191], a[32:35], v[160:163]
  buffer_load_dwordx4 a[20:23], v29, s[4:7], s88 offen sc1
  v_mfma_f32_16x16x32_bf16 v[160:163], a[196:199], a[64:67], v[160:163]
  v_mfma_f32_16x16x32_bf16 v[160:163], a[204:207], a[96:99], v[160:163]
  v_mfma_f32_16x16x32_bf16 v[164:167], a[204:207], a[100:103], v[164:167]
  v_mfma_f32_16x16x32_bf16 v[164:167], a[196:199], a[68:71], v[164:167]
  buffer_load_dwordx4 a[24:27], v30, s[4:7], s88 offen sc1
  v_mfma_f32_16x16x32_bf16 v[164:167], a[188:191], a[36:39], v[164:167]
pad_m_18:
  s_cbranch_execz warm_4
  v_mfma_f32_16x16x32_bf16 v[164:167], a[184:187], a[4:7], v[164:167]
  v_mfma_f32_16x16x32_bf16 v[168:171], a[184:187], a[8:11], v[168:171]
  v_mfma_f32_16x16x32_bf16 v[168:171], a[188:191], a[40:43], v[168:171]
  v_mfma_f32_16x16x32_bf16 v[168:171], a[196:199], a[72:75], v[168:171]
  buffer_load_dwordx4 a[28:31], v31, s[4:7], s88 offen sc1
  v_mfma_f32_16x16x32_bf16 v[168:171], a[204:207], a[104:107], v[168:171]
  v_mfma_f32_16x16x32_bf16 v[172:175], a[204:207], a[108:111], v[172:175]
  s_add_u32 s88, s88, 4096
  v_mfma_f32_16x16x32_bf16 v[172:175], a[196:199], a[76:79], v[172:175]
  v_mfma_f32_16x16x32_bf16 v[172:175], a[188:191], a[44:47], v[172:175]
  v_mfma_f32_16x16x32_bf16 v[172:175], a[184:187], a[12:15], v[172:175]
  s_waitcnt lgkmcnt(0)
  ds_read_b128 a[112:115], v47 offset:2048
  ds_read_b128 a[116:119], v47 offset:11264
  v_mfma_f32_16x16x32_bf16 v[156:159], a[212:215], a[12:15], v[156:159]
  ds_read_b128 a[120:123], v47 offset:20480
  ds_read_b128 a[124:127], v47 offset:29696
  v_mfma_f32_16x16x32_bf16 v[156:159], a[220:223], a[44:47], v[156:159]
  buffer_load_dwordx4 a[48:51], v28, s[4:7], s88 offen sc1
  v_mfma_f32_16x16x32_bf16 v[156:159], a[128:131], a[76:79], v[156:159]
  v_mfma_f32_16x16x32_bf16 v[156:159], a[136:139], a[108:111], v[156:159]
  v_mfma_f32_16x16x32_bf16 v[152:155], a[136:139], a[104:107], v[152:155]
  v_mfma_f32_16x16x32_bf16 v[152:155], a[128:131], a[72:75], v[152:155]
  buffer_load_dwordx4 a[52:55], v29, s[4:7], s88 offen sc1
  v_mfma_f32_16x16x32_bf16 v[152:155], a[220:223], a[40:43], v[152:155]
  v_mfma_f32_16x16x32_bf16 v[152:155], a[212:215], a[8:11], v[152:155]
  v_mfma_f32_16x16x32_bf16 v[148:151], a[212:215], a[4:7], v[148:151]
  buffer_load_dword v59, off, s[4:7], s70 sc1
  v_mfma_f32_16x16x32_bf16 v[148:151], a[220:223], a[36:39], v[148:151]
  v_mfma_f32_16x16x32_bf16 v[148:151], a[128:131], a[68:71], v[148:151]
  buffer_load_dwordx4 a[56:59], v30, s[4:7], s88 offen sc1
  v_mfma_f32_16x16x32_bf16 v[148:151], a[136:139], a[100:103], v[148:151]
  v_mfma_f32_16x16x32_bf16 v[144:147], a[136:139], a[96:99], v[144:147]
  v_mfma_f32_16x16x32_bf16 v[144:147], a[128:131], a[64:67], v[144:147]
  v_mfma_f32_16x16x32_bf16 v[144:147], a[220:223], a[32:35], v[144:147]
  v_mfma_f32_16x16x32_bf16 v[144:147], a[212:215], a[0:3], v[144:147]
  s_waitcnt lgkmcnt(0)
  ds_read_b128 a[168:171], v47 offset:3072
  ds_read_b128 a[172:175], v47 offset:12288
  v_mfma_f32_16x16x32_bf16 v[128:131], a[112:115], a[0:3], v[128:131]
  ds_read_b128 a[176:179], v47 offset:21504
  ds_read_b128 a[180:183], v47 offset:30720
  v_mfma_f32_16x16x32_bf16 v[128:131], a[116:119], a[32:35], v[128:131]
  buffer_load_dwordx4 a[60:63], v31, s[4:7], s88 offen sc1
  v_mfma_f32_16x16x32_bf16 v[128:131], a[120:123], a[64:67], v[128:131]
  s_add_u32 s88, s88, 4096
  v_mfma_f32_16x16x32_bf16 v[128:131], a[124:127], a[96:99], v[128:131]
  v_mfma_f32_16x16x32_bf16 v[132:135], a[124:127], a[100:103], v[132:135]
  v_mfma_f32_16x16x32_bf16 v[132:135], a[120:123], a[68:71], v[132:135]
  buffer_load_dwordx4 a[80:83], v28, s[4:7], s88 offen sc1
  v_mfma_f32_16x16x32_bf16 v[132:135], a[116:119], a[36:39], v[132:135]
  v_mfma_f32_16x16x32_bf16 v[132:135], a[112:115], a[4:7], v[132:135]
  v_mfma_f32_16x16x32_bf16 v[136:139], a[112:115], a[8:11], v[136:139]
  v_mfma_f32_16x16x32_bf16 v[136:139], a[116:119], a[40:43], v[136:139]
  v_mfma_f32_16x16x32_bf16 v[136:139], a[120:123], a[72:75], v[136:139]
  buffer_load_dwordx4 a[84:87], v29, s[4:7], s88 offen sc1
  v_mfma_f32_16x16x32_bf16 v[136:139], a[124:127], a[104:107], v[136:139]
  v_mfma_f32_16x16x32_bf16 v[140:143], a[124:127], a[108:111], v[140:143]
  v_mfma_f32_16x16x32_bf16 v[140:143], a[120:123], a[76:79], v[140:143]
  s_waitcnt vmcnt(40) lgkmcnt(0)
  s_barrier
  v_mfma_f32_16x16x32_bf16 v[140:143], a[116:119], a[44:47], v[140:143]
  v_mfma_f32_16x16x32_bf16 v[140:143], a[112:115], a[12:15], v[140:143]
  ds_read_b128 a[184:187], v45 offset:8192
  ds_read_b128 a[188:191], v45 offset:17408
  v_mfma_f32_16x16x32_bf16 v[124:127], a[168:171], a[12:15], v[124:127]
  ds_read_b128 a[196:199], v45 offset:26624
  ds_read_b128 a[204:207], v45 offset:35840
  v_mfma_f32_16x16x32_bf16 v[124:127], a[172:175], a[44:47], v[124:127]
  buffer_load_dwordx4 a[88:91], v30, s[4:7], s88 offen sc1
  v_mfma_f32_16x16x32_bf16 v[124:127], a[176:179], a[76:79], v[124:127]
  v_mfma_f32_16x16x32_bf16 v[124:127], a[180:183], a[108:111], v[124:127]
  v_mfma_f32_16x16x32_bf16 v[120:123], a[180:183], a[104:107], v[120:123]
  v_mfma_f32_16x16x32_bf16 v[120:123], a[176:179], a[72:75], v[120:123]
  buffer_load_dwordx4 a[92:95], v31, s[4:7], s88 offen sc1
  v_mfma_f32_16x16x32_bf16 v[120:123], a[172:175], a[40:43], v[120:123]
  v_mfma_f32_16x16x32_bf16 v[120:123], a[168:171], a[8:11], v[120:123]
  v_mfma_f32_16x16x32_bf16 v[116:119], a[168:171], a[4:7], v[116:119]
  v_mfma_f32_16x16x32_bf16 v[116:119], a[172:175], a[36:39], v[116:119]
  v_mfma_f32_16x16x32_bf16 v[116:119], a[176:179], a[68:71], v[116:119]
  v_mfma_f32_16x16x32_bf16 v[116:119], a[180:183], a[100:103], v[116:119]
  v_mfma_f32_16x16x32_bf16 v[112:115], a[180:183], a[96:99], v[112:115]
  v_mfma_f32_16x16x32_bf16 v[112:115], a[176:179], a[64:67], v[112:115]
  v_mfma_f32_16x16x32_bf16 v[112:115], a[172:175], a[32:35], v[112:115]
  v_mfma_f32_16x16x32_bf16 v[112:115], a[168:171], a[0:3], v[112:115]
  s_waitcnt lgkmcnt(0)
  ds_read_b128 a[212:215], v45 offset:7168
  ds_read_b128 a[220:223], v45 offset:16384
  s_cmp_eq_u32 s77, 8
  s_cbranch_scc1 p3_end8
  s_waitcnt vmcnt(41)
  v_mfma_f32_16x16x32_bf16 v[240:243], a[184:187], a[224:227], v[240:243]
  s_waitcnt vmcnt(37)
  ds_read_b128 a[128:131], v45 offset:25600
  ds_read_b128 a[136:139], v45 offset:34816
  v_mfma_f32_16x16x32_bf16 v[240:243], a[188:191], a[240:243], v[240:243]
  s_waitcnt vmcnt(33)
  s_mov_b32 s89, s47
  v_mfma_f32_16x16x32_bf16 v[240:243], a[196:199], a[148:151], v[240:243]
  s_waitcnt vmcnt(29)
  s_add_u32 m0, s44, 0
  v_mfma_f32_16x16x32_bf16 v[240:243], a[204:207], a[164:167], v[240:243]
  s_waitcnt vmcnt(28)
  v_mfma_f32_16x16x32_bf16 v[244:247], a[204:207], a[192:195], v[244:247]
  buffer_load_dwordx4 v36, s[4:7], s89 offen offset:0 sc1 lds
  v_mfma_f32_16x16x32_bf16 v[244:247], a[196:199], a[152:155], v[244:247]
  v_mfma_f32_16x16x32_bf16 v[244:247], a[188:191], a[244:247], v[244:247]
  v_mfma_f32_16x16x32_bf16 v[244:247], a[184:187], a[228:231], v[244:247]
  v_mfma_f32_16x16x32_bf16 v[248:251], a[184:187], a[232:235], v[248:251]
  v_mfma_f32_16x16x32_bf16 v[248:251], a[188:191], a[248:251], v[248:251]
  buffer_load_dwordx4 v37, s[4:7], s89 offen offset:1024 sc1 lds
  v_mfma_f32_16x16x32_bf16 v[248:251], a[196:199], a[156:159], v[248:251]
  s_waitcnt vmcnt(29)
  v_mfma_f32_16x16x32_bf16 v[248:251], a[204:207], a[200:203], v[248:251]
  s_waitcnt vmcnt(28)
  v_mfma_f32_16x16x32_bf16 v[252:255], a[204:207], a[208:211], v[252:255]
  v_mfma_f32_16x16x32_bf16 v[252:255], a[196:199], a[160:163], v[252:255]
  v_mfma_f32_16x16x32_bf16 v[252:255], a[188:191], a[252:255], v[252:255]
  buffer_load_dwordx4 v38, s[4:7], s89 offen offset:2048 sc1 lds
  v_mfma_f32_16x16x32_bf16 v[252:255], a[184:187], a[236:239], v[252:255]
  s_waitcnt lgkmcnt(0)
  ds_read_b128 a[112:115], v45 offset:0
  ds_read_b128 a[116:119], v45 offset:9216
  v_mfma_f32_16x16x32_bf16 v[236:239], a[212:215], a[236:239], v[236:239]
  ds_read_b128 a[120:123], v45 offset:18432
  ds_read_b128 a[124:127], v45 offset:27648
  v_mfma_f32_16x16x32_bf16 v[236:239], a[220:223], a[252:255], v[236:239]
  v_mfma_f32_16x16x32_bf16 v[236:239], a[128:131], a[160:163], v[236:239]
  v_mfma_f32_16x16x32_bf16 v[236:239], a[136:139], a[208:211], v[236:239]
  v_mfma_f32_16x16x32_bf16 v[232:235], a[136:139], a[200:203], v[232:235]
  buffer_load_dwordx4 v39, s[4:7], s89 offen offset:3072 sc1 lds
  v_mfma_f32_16x16x32_bf16 v[232:235], a[128:131], a[156:159], v[232:235]
  v_mfma_f32_16x16x32_bf16 v[232:235], a[220:223], a[248:251], v[232:235]
  s_add_u32 m0, s44, 4096
  v_mfma_f32_16x16x32_bf16 v[232:235], a[212:215], a[232:235], v[232:235]
  v_mfma_f32_16x16x32_bf16 v[228:231], a[212:215], a[228:231], v[228:231]
  v_mfma_f32_16x16x32_bf16 v[228:231], a[220:223], a[244:247], v[228:231]
  buffer_load_dwordx4 v40, s[4:7], s89 offen offset:0 sc1 lds
  v_mfma_f32_16x16x32_bf16 v[228:231], a[128:131], a[152:155], v[228:231]
  v_mfma_f32_16x16x32_bf16 v[228:231], a[136:139], a[192:195], v[228:231]
  v_mfma_f32_16x16x32_bf16 v[224:227], a[136:139], a[164:167], v[224:227]
  v_mfma_f32_16x16x32_bf16 v[224:227], a[128:131], a[148:151], v[224:227]
  v_mfma_f32_16x16x32_bf16 v[224:227], a[220:223], a[240:243], v[224:227]
  v_mfma_f32_16x16x32_bf16 v[224:227], a[212:215], a[224:227], v[224:227]
  s_waitcnt lgkmcnt(0)
  ds_read_b128 a[168:171], v45 offset:1024
  ds_read_b128 a[172:175], v45 offset:10240
  v_mfma_f32_16x16x32_bf16 v[208:211], a[112:115], a[224:227], v[208:211]
  ds_read_b128 a[176:179], v45 offset:19456
  ds_read_b128 a[180:183], v45 offset:28672
  v_mfma_f32_16x16x32_bf16 v[208:211], a[116:119], a[240:243], v[208:211]
  buffer_load_dwordx4 v41, s[4:7], s89 offen offset:1024 sc1 lds
  v_mfma_f32_16x16x32_bf16 v[208:211], a[120:123], a[148:151], v[208:211]
  v_mfma_f32_16x16x32_bf16 v[208:211], a[124:127], a[164:167], v[208:211]
  v_mfma_f32_16x16x32_bf16 v[212:215], a[124:127], a[192:195], v[212:215]
  buffer_load_dwordx4 v42, s[4:7], s89 offen offset:2048 sc1 lds
  v_mfma_f32_16x16x32_bf16 v[212:215], a[120:123], a[152:155], v[212:215]
  v_mfma_f32_16x16x32_bf16 v[212:215], a[116:119], a[244:247], v[212:215]
  v_mfma_f32_16x16x32_bf16 v[212:215], a[112:115], a[228:231], v[212:215]
  v_mfma_f32_16x16x32_bf16 v[216:219], a[112:115], a[232:235], v[216:219]
  v_mfma_f32_16x16x32_bf16 v[216:219], a[116:119], a[248:251], v[216:219]
  buffer_load_dwordx4 v43, s[4:7], s89 offen offset:3072 sc1 lds
  v_mfma_f32_16x16x32_bf16 v[216:219], a[120:123], a[156:159], v[216:219]
  v_mfma_f32_16x16x32_bf16 v[216:219], a[124:127], a[200:203], v[216:219]
  v_mfma_f32_16x16x32_bf16 v[220:223], a[124:127], a[208:211], v[220:223]
  s_add_u32 m0, s44, 8192
  v_mfma_f32_16x16x32_bf16 v[220:223], a[120:123], a[160:163], v[220:223]
  v_mfma_f32_16x16x32_bf16 v[220:223], a[116:119], a[252:255], v[220:223]
  v_mfma_f32_16x16x32_bf16 v[220:223], a[112:115], a[236:239], v[220:223]
  s_waitcnt lgkmcnt(0)
  ds_read_b128 a[184:187], v45 offset:4096
  ds_read_b128 a[188:191], v45 offset:13312
  v_mfma_f32_16x16x32_bf16 v[204:207], a[168:171], a[236:239], v[204:207]
  s_waitcnt vmcnt(14)
  v_readfirstlane_b32 s73, v59
  s_nop 0
  s_cmp_ge_u32 s73, 524288
  s_cbranch_scc0 spin_k8
back_k8:
  v_mfma_f32_16x16x32_bf16 v[204:207], a[172:175], a[252:255], v[204:207]
  s_mov_b32 s88, s67
  ds_read_b128 a[196:199], v45 offset:22528
  ds_read_b128 a[204:207], v45 offset:31744
  v_mfma_f32_16x16x32_bf16 v[204:207], a[176:179], a[160:163], v[204:207]
  buffer_load_dwordx4 v44, s[4:7], s89 offen offset:0 sc1 lds
  v_mfma_f32_16x16x32_bf16 v[204:207], a[180:183], a[208:211], v[204:207]
  v_mfma_f32_16x16x32_bf16 v[200:203], a[180:183], a[200:203], v[200:203]
  buffer_load_dwordx4 a[0:3], v28, s[4:7], s88 offen sc1
  v_mfma_f32_16x16x32_bf16 v[200:203], a[176:179], a[156:159], v[200:203]
  v_mfma_f32_16x16x32_bf16 v[200:203], a[172:175], a[248:251], v[200:203]
  v_mfma_f32_16x16x32_bf16 v[200:203], a[168:171], a[232:235], v[200:203]
  v_mfma_f32_16x16x32_bf16 v[196:199], a[168:171], a[228:231], v[196:199]
  v_mfma_f32_16x16x32_bf16 v[196:199], a[172:175], a[244:247], v[196:199]
  v_mfma_f32_16x16x32_bf16 v[196:199], a[176:179], a[152:155], v[196:199]
  buffer_load_dwordx4 a[4:7], v29, s[4:7], s88 offen sc1
  v_mfma_f32_16x16x32_bf16 v[196:199], a[180:183], a[192:195], v[196:199]
  v_mfma_f32_16x16x32_bf16 v[192:195], a[180:183], a[164:167], v[192:195]
  v_mfma_f32_16x16x32_bf16 v[192:195], a[176:179], a[148:151], v[192:195]
  v_mfma_f32_16x16x32_bf16 v[192:195], a[172:175], a[240:243], v[192:195]
  v_mfma_f32_16x16x32_bf16 v[192:195], a[168:171], a[224:227], v[192:195]
  s_waitcnt lgkmcnt(0)
  ds_read_b128 a[212:215], v45 offset:6144
  ds_read_b128 a[220:223], v45 offset:15360
  v_mfma_f32_16x16x32_bf16 v[176:179], a[184:187], a[224:227], v[176:179]
  ds_read_b128 a[128:131], v45 offset:24576
  ds_read_b128 a[136:139], v45 offset:33792
  v_mfma_f32_16x16x32_bf16 v[176:179], a[188:191], a[240:243], v[176:179]
  buffer_load_dwordx4 a[8:11], v30, s[4:7], s88 offen sc1
  v_mfma_f32_16x16x32_bf16 v[176:179], a[196:199], a[148:151], v[176:179]
  v_mfma_f32_16x16x32_bf16 v[176:179], a[204:207], a[164:167], v[176:179]
  v_mfma_f32_16x16x32_bf16 v[180:183], a[204:207], a[192:195], v[180:183]
  buffer_load_dwordx4 a[12:15], v31, s[4:7], s88 offen sc1
  v_mfma_f32_16x16x32_bf16 v[180:183], a[196:199], a[152:155], v[180:183]
  v_mfma_f32_16x16x32_bf16 v[180:183], a[188:191], a[244:247], v[180:183]
  v_mfma_f32_16x16x32_bf16 v[180:183], a[184:187], a[228:231], v[180:183]
  s_add_u32 s88, s88, 4096
  v_mfma_f32_16x16x32_bf16 v[184:187], a[184:187], a[232:235], v[184:187]
  v_mfma_f32_16x16x32_bf16 v[184:187], a[188:191], a[248:251], v[184:187]
  v_mfma_f32_16x16x32_bf16 v[184:187], a[196:199], a[156:159], v[184:187]
  buffer_load_dwordx4 a[32:35], v28, s[4:7], s88 offen sc1
  v_mfma_f32_16x16x32_bf16 v[184:187], a[204:207], a[200:203], v[184:187]
  v_mfma_f32_16x16x32_bf16 v[188:191], a[204:207], a[208:211], v[188:191]
  v_mfma_f32_16x16x32_bf16 v[188:191], a[196:199], a[160:163], v[188:191]
  v_mfma_f32_16x16x32_bf16 v[188:191], a[188:191], a[252:255], v[188:191]
  v_mfma_f32_16x16x32_bf16 v[188:191], a[184:187], a[236:239], v[188:191]
  s_waitcnt lgkmcnt(0)
  ds_read_b128 a[112:115], v45 offset:5120
  ds_read_b128 a[116:119], v45 offset:14336
  v_mfma_f32_16x16x32_bf16 v[172:175], a[212:215], a[236:239], v[172:175]
  ds_read_b128 a[120:123], v45 offset:23552
  ds_read_b128 a[124:127], v45 offset:32768
  v_mfma_f32_16x16x32_bf16 v[172:175], a[220:223], a[252:255], v[172:175]
  buffer_load_dwordx4 a[36:39], v29, s[4:7], s88 offen sc1
  v_mfma_f32_16x16x32_bf16 v[172:175], a[128:131], a[160:163], v[172:175]
  v_mfma_f32_16x16x32_bf16 v[172:175], a[136:139], a[208:211], v[172:175]
  v_mfma_f32_16x16x32_bf16 v[168:171], a[136:139], a[200:203], v[168:171]
  v_mfma_f32_16x16x32_bf16 v[168:171], a[128:131], a[156:159], v[168:171]
  buffer_load_dwordx4 a[40:43], v30, s[4:7], s88 offen sc1
  v_mfma_f32_16x16x32_bf16 v[168:171], a[220:223], a[248:251], v[168:171]
  v_mfma_f32_16x16x32_bf16 v[168:171], a[212:215], a[232:235], v[168:171]
  v_mfma_f32_16x16x32_bf16 v[164:167], a[212:215], a[228:231], v[164:167]
  v_mfma_f32_16x16x32_bf16 v[164:167], a[220:223], a[244:247], v[164:167]
  v_mfma_f32_16x16x32_bf16 v[164:167], a[128:131], a[152:155], v[164:167]
  buffer_load_dwordx4 a[44:47], v31, s[4:7], s88 offen sc1
  v_mfma_f32_16x16x32_bf16 v[164:167], a[136:139], a[192:195], v[164:167]
  v_mfma_f32_16x16x32_bf16 v[160:163], a[136:139], a[164:167], v[160:163]
  s_add_u32 s88, s88, 4096
  v_mfma_f32_16x16x32_bf16 v[160:163], a[128:131], a[148:151], v[160:163]
  v_mfma_f32_16x16x32_bf16 v[160:163], a[220:223], a[240:243], v[160:163]
  v_mfma_f32_16x16x32_bf16 v[160:163], a[212:215], a[224:227], v[160:163]
  s_waitcnt lgkmcnt(0)
  ds_read_b128 a[168:171], v45 offset:2048
  ds_read_b128 a[172:175], v45 offset:11264
  v_mfma_f32_16x16x32_bf16 v[144:147], a[112:115], a[224:227], v[144:147]
  ds_read_b128 a[176:179], v45 offset:20480
  ds_read_b128 a[180:183], v45 offset:29696
  v_mfma_f32_16x16x32_bf16 v[144:147], a[116:119], a[240:243], v[144:147]
  buffer_load_dwordx4 a[64:67], v28, s[4:7], s88 offen sc1
  v_mfma_f32_16x16x32_bf16 v[144:147], a[120:123], a[148:151], v[144:147]
  v_mfma_f32_16x16x32_bf16 v[144:147], a[124:127], a[164:167], v[144:147]
  v_mfma_f32_16x16x32_bf16 v[148:151], a[124:127], a[192:195], v[148:151]
  v_mfma_f32_16x16x32_bf16 v[148:151], a[120:123], a[152:155], v[148:151]
  buffer_load_dwordx4 a[68:71], v29, s[4:7], s88 offen sc1
  v_mfma_f32_16x16x32_bf16 v[148:151], a[116:119], a[244:247], v[148:151]
  v_mfma_f32_16x16x32_bf16 v[148:151], a[112:115], a[228:231], v[148:151]
  v_mfma_f32_16x16x32_bf16 v[152:155], a[112:115], a[232:235], v[152:155]
  buffer_load_dword v59, off, s[4:7], s71 sc1
  v_mfma_f32_16x16x32_bf16 v[152:155], a[116:119], a[248:251], v[152:155]
  v_mfma_f32_16x16x32_bf16 v[152:155], a[120:123], a[156:159], v[152:155]
  buffer_load_dwordx4 a[72:75], v30, s[4:7], s88 offen sc1
  v_mfma_f32_16x16x32_bf16 v[152:155], a[124:127], a[200:203], v[152:155]
  v_mfma_f32_16x16x32_bf16 v[156:159], a[124:127], a[208:211], v[156:159]
  v_mfma_f32_16x16x32_bf16 v[156:159], a[120:123], a[160:163], v[156:159]
  v_mfma_f32_16x16x32_bf16 v[156:159], a[116:119], a[252:255], v[156:159]
  v_mfma_f32_16x16x32_bf16 v[156:159], a[112:115], a[236:239], v[156:159]
  s_waitcnt lgkmcnt(0)
  ds_read_b128 a[184:187], v45 offset:3072
  ds_read_b128 a[188:191], v45 offset:12288
  v_mfma_f32_16x16x32_bf16 v[140:143], a[168:171], a[236:239], v[140:143]
  ds_read_b128 a[196:199], v45 offset:21504
  ds_read_b128 a[204:207], v45 offset:30720
  v_mfma_f32_16x16x32_bf16 v[140:143], a[172:175], a[252:255], v[140:143]
  buffer_load_dwordx4 a[76:79], v31, s[4:7], s88 offen sc1
  v_mfma_f32_16x16x32_bf16 v[140:143], a[176:179], a[160:163], v[140:143]
  s_add_u32 s88, s88, 4096
  v_mfma_f32_16x16x32_bf16 v[140:143], a[180:183], a[208:211], v[140:143]
  v_mfma_f32_16x16x32_bf16 v[136:139], a[180:183], a[200:203], v[136:139]
  v_mfma_f32_16x16x32_bf16 v[136:139], a[176:179], a[156:159], v[136:139]
  buffer_load_dwordx4 a[96:99], v28, s[4:7], s88 offen sc1
  v_mfma_f32_16x16x32_bf16 v[136:139], a[172:175], a[248:251], v[136:139]
  v_mfma_f32_16x16x32_bf16 v[136:139], a[168:171], a[232:235], v[136:139]
  v_mfma_f32_16x16x32_bf16 v[132:135], a[168:171], a[228:231], v[132:135]
  v_mfma_f32_16x16x32_bf16 v[132:135], a[172:175], a[244:247], v[132:135]
  v_mfma_f32_16x16x32_bf16 v[132:135], a[176:179], a[152:155], v[132:135]
  buffer_load_dwordx4 a[100:103], v29, s[4:7], s88 offen sc1
  v_mfma_f32_16x16x32_bf16 v[132:135], a[180:183], a[192:195], v[132:135]
  v_mfma_f32_16x16x32_bf16 v[128:131], a[180:183], a[164:167], v[128:131]
  v_mfma_f32_16x16x32_bf16 v[128:131], a[176:179], a[148:151], v[128:131]
  s_waitcnt lgkmcnt(0)
  s_barrier
  v_mfma_f32_16x16x32_bf16 v[128:131], a[172:175], a[240:243], v[128:131]
  v_mfma_f32_16x16x32_bf16 v[128:131], a[168:171], a[224:227], v[128:131]
  ds_read_b128 a[212:215], v46 offset:8192
  ds_read_b128 a[220:223], v46 offset:17408
  v_mfma_f32_16x16x32_bf16 v[112:115], a[184:187], a[224:227], v[112:115]
  ds_read_b128 a[128:131], v46 offset:26624
  ds_read_b128 a[136:139], v46 offset:35840
  v_mfma_f32_16x16x32_bf16 v[112:115], a[188:191], a[240:243], v[112:115]
  buffer_load_dwordx4 a[104:107], v30, s[4:7], s88 offen sc1
  v_mfma_f32_16x16x32_bf16 v[112:115], a[196:199], a[148:151], v[112:115]
  v_mfma_f32_16x16x32_bf16 v[112:115], a[204:207], a[164:167], v[112:115]
  v_mfma_f32_16x16x32_bf16 v[116:119], a[204:207], a[192:195], v[116:119]
  v_mfma_f32_16x16x32_bf16 v[116:119], a[196:199], a[152:155], v[116:119]
  buffer_load_dwordx4 a[108:111], v31, s[4:7], s88 offen sc1
  v_mfma_f32_16x16x32_bf16 v[116:119], a[188:191], a[244:247], v[116:119]
  v_mfma_f32_16x16x32_bf16 v[116:119], a[184:187], a[228:231], v[116:119]
  v_mfma_f32_16x16x32_bf16 v[120:123], a[184:187], a[232:235], v[120:123]
  v_mfma_f32_16x16x32_bf16 v[120:123], a[188:191], a[248:251], v[120:123]
  v_mfma_f32_16x16x32_bf16 v[120:123], a[196:199], a[156:159], v[120:123]
  v_mfma_f32_16x16x32_bf16 v[120:123], a[204:207], a[200:203], v[120:123]
  v_mfma_f32_16x16x32_bf16 v[124:127], a[204:207], a[208:211], v[124:127]
  v_mfma_f32_16x16x32_bf16 v[124:127], a[196:199], a[160:163], v[124:127]
  v_mfma_f32_16x16x32_bf16 v[124:127], a[188:191], a[252:255], v[124:127]
  v_mfma_f32_16x16x32_bf16 v[124:127], a[184:187], a[236:239], v[124:127]
  s_waitcnt lgkmcnt(0)
  ds_read_b128 a[112:115], v46 offset:7168
  ds_read_b128 a[116:119], v46 offset:16384
  s_cmp_eq_u32 s77, 9
  s_cbranch_scc1 p3_end9
  v_mfma_f32_16x16x32_bf16 v[252:255], a[212:215], a[140:143], v[252:255]
  ds_read_b128 a[120:123], v46 offset:25600
  ds_read_b128 a[124:127], v46 offset:34816
  v_mfma_f32_16x16x32_bf16 v[252:255], a[220:223], a[28:31], v[252:255]
  s_waitcnt vmcnt(30)
  s_mov_b32 s89, s69
  v_mfma_f32_16x16x32_bf16 v[252:255], a[128:131], a[60:63], v[252:255]
  s_waitcnt vmcnt(26)
  s_add_u32 m0, s44, 49152
  v_mfma_f32_16x16x32_bf16 v[252:255], a[136:139], a[92:95], v[252:255]
  v_mfma_f32_16x16x32_bf16 v[248:251], a[136:139], a[88:91], v[248:251]
  buffer_load_dwordx4 v36, s[4:7], s89 offen offset:0 sc1 lds
  v_mfma_f32_16x16x32_bf16 v[248:251], a[128:131], a[56:59], v[248:251]
  v_mfma_f32_16x16x32_bf16 v[248:251], a[220:223], a[24:27], v[248:251]
  v_mfma_f32_16x16x32_bf16 v[248:251], a[212:215], a[132:135], v[248:251]
  v_mfma_f32_16x16x32_bf16 v[244:247], a[212:215], a[144:147], v[244:247]
  v_mfma_f32_16x16x32_bf16 v[244:247], a[220:223], a[20:23], v[244:247]
  buffer_load_dwordx4 v37, s[4:7], s89 offen offset:1024 sc1 lds
  v_mfma_f32_16x16x32_bf16 v[244:247], a[128:131], a[52:55], v[244:247]
  v_mfma_f32_16x16x32_bf16 v[244:247], a[136:139], a[84:87], v[244:247]
  v_mfma_f32_16x16x32_bf16 v[240:243], a[136:139], a[80:83], v[240:243]
  v_mfma_f32_16x16x32_bf16 v[240:243], a[128:131], a[48:51], v[240:243]
  v_mfma_f32_16x16x32_bf16 v[240:243], a[220:223], a[16:19], v[240:243]
  buffer_load_dwordx4 v38, s[4:7], s89 offen offset:2048 sc1 lds
  v_mfma_f32_16x16x32_bf16 v[240:243], a[212:215], a[216:219], v[240:243]
  s_waitcnt lgkmcnt(0)
  ds_read_b128 a[168:171], v46 offset:0
  ds_read_b128 a[172:175], v46 offset:9216
  v_mfma_f32_16x16x32_bf16 v[224:227], a[112:115], a[216:219], v[224:227]
  ds_read_b128 a[176:179], v46 offset:18432
  ds_read_b128 a[180:183], v46 offset:27648
  v_mfma_f32_16x16x32_bf16 v[224:227], a[116:119], a[16:19], v[224:227]
  v_mfma_f32_16x16x32_bf16 v[224:227], a[120:123], a[48:51], v[224:227]
  v_mfma_f32_16x16x32_bf16 v[224:227], a[124:127], a[80:83], v[224:227]
  v_mfma_f32_16x16x32_bf16 v[228:231], a[124:127], a[84:87], v[228:231]
  buffer_load_dwordx4 v39, s[4:7], s89 offen offset:3072 sc1 lds
  v_mfma_f32_16x16x32_bf16 v[228:231], a[120:123], a[52:55], v[228:231]
  v_mfma_f32_16x16x32_bf16 v[228:231], a[116:119], a[20:23], v[228:231]
  s_add_u32 m0, s44, 53248
  v_mfma_f32_16x16x32_bf16 v[228:231], a[112:115], a[144:147], v[228:231]
  v_mfma_f32_16x16x32_bf16 v[232:235], a[112:115], a[132:135], v[232:235]
  v_mfma_f32_16x16x32_bf16 v[232:235], a[116:119], a[24:27], v[232:235]
  buffer_load_dwordx4 v40, s[4:7], s89 offen offset:0 sc1 lds
  v_mfma_f32_16x16x32_bf16 v[232:235], a[120:123], a[56:59], v[232:235]
  v_mfma_f32_16x16x32_bf16 v[232:235], a[124:127], a[88:91], v[232:235]
  v_mfma_f32_16x16x32_bf16 v[236:239], a[124:127], a[92:95], v[236:239]
  v_mfma_f32_16x16x32_bf16 v[236:239], a[120:123], a[60:63], v[236:239]
  v_mfma_f32_16x16x32_bf16 v[236:239], a[116:119], a[28:31], v[236:239]
  v_mfma_f32_16x16x32_bf16 v[236:239], a[112:115], a[140:143], v[236:239]
  s_waitcnt lgkmcnt(0)
  ds_read_b128 a[184:187], v46 offset:1024
  ds_read_b128 a[188:191], v46 offset:10240
  v_mfma_f32_16x16x32_bf16 v[220:223], a[168:171], a[140:143], v[220:223]
  ds_read_b128 a[196:199], v46 offset:19456
  ds_read_b128 a[204:207], v46 offset:28672
  v_mfma_f32_16x16x32_bf16 v[220:223], a[172:175], a[28:31], v[220:223]
  buffer_load_dwordx4 v41, s[4:7], s89 offen offset:1024 sc1 lds
  v_mfma_f32_16x16x32_bf16 v[220:223], a[176:179], a[60:63], v[220:223]
  v_mfma_f32_16x16x32_bf16 v[220:223], a[180:183], a[92:95], v[220:223]
  v_mfma_f32_16x16x32_bf16 v[216:219], a[180:183], a[88:91], v[216:219]
  buffer_load_dwordx4 v42, s[4:7], s89 offen offset:2048 sc1 lds
  v_mfma_f32_16x16x32_bf16 v[216:219], a[176:179], a[56:59], v[216:219]
  v_mfma_f32_16x16x32_bf16 v[216:219], a[172:175], a[24:27], v[216:219]
  v_mfma_f32_16x16x32_bf16 v[216:219], a[168:171], a[132:135], v[216:219]
  v_mfma_f32_16x16x32_bf16 v[212:215], a[168:171], a[144:147], v[212:215]
  v_mfma_f32_16x16x32_bf16 v[212:215], a[172:175], a[20:23], v[212:215]
  buffer_load_dwordx4 v43, s[4:7], s89 offen offset:3072 sc1 lds
  v_mfma_f32_16x16x32_bf16 v[212:215], a[176:179], a[52:55], v[212:215]
  v_mfma_f32_16x16x32_bf16 v[212:215], a[180:183], a[84:87], v[212:215]
  v_mfma_f32_16x16x32_bf16 v[208:211], a[180:183], a[80:83], v[208:211]
  s_add_u32 m0, s44, 57344
  v_mfma_f32_16x16x32_bf16 v[208:211], a[176:179], a[48:51], v[208:211]
  v_mfma_f32_16x16x32_bf16 v[208:211], a[172:175], a[16:19], v[208:211]
  v_mfma_f32_16x16x32_bf16 v[208:211], a[168:171], a[216:219], v[208:211]
  s_waitcnt lgkmcnt(0)
  ds_read_b128 a[212:215], v46 offset:4096
  ds_read_b128 a[220:223], v46 offset:13312
  v_mfma_f32_16x16x32_bf16 v[192:195], a[184:187], a[216:219], v[192:195]
  s_waitcnt vmcnt(14)
  v_readfirstlane_b32 s73, v59
  s_nop 0
  s_cmp_ge_u32 s73, 524288
  s_cbranch_scc0 spin_k9
back_k9:
  v_mfma_f32_16x16x32_bf16 v[192:195], a[188:191], a[16:19], v[192:195]
  s_mov_b32 s88, s68
  ds_read_b128 a[128:131], v46 offset:22528
  ds_read_b128 a[136:139], v46 offset:31744
  v_mfma_f32_16x16x32_bf16 v[192:195], a[196:199], a[48:51], v[192:195]
  buffer_load_dwordx4 v44, s[4:7], s89 offen offset:0 sc1 lds
  v_mfma_f32_16x16x32_bf16 v[192:195], a[204:207], a[80:83], v[192:195]
  v_mfma_f32_16x16x32_bf16 v[196:199], a[204:207], a[84:87], v[196:199]
  buffer_load_dwordx4 a[224:227], v28, s[4:7], s88 offen sc1
  v_mfma_f32_16x16x32_bf16 v[196:199], a[196:199], a[52:55], v[196:199]
  v_mfma_f32_16x16x32_bf16 v[196:199], a[188:191], a[20:23], v[196:199]
  v_mfma_f32_16x16x32_bf16 v[196:199], a[184:187], a[144:147], v[196:199]
  v_mfma_f32_16x16x32_bf16 v[200:203], a[184:187], a[132:135], v[200:203]
  v_mfma_f32_16x16x32_bf16 v[200:203], a[188:191], a[24:27], v[200:203]
  v_mfma_f32_16x16x32_bf16 v[200:203], a[196:199], a[56:59], v[200:203]
  buffer_load_dwordx4 a[228:231], v29, s[4:7], s88 offen sc1
  v_mfma_f32_16x16x32_bf16 v[200:203], a[204:207], a[88:91], v[200:203]
  v_mfma_f32_16x16x32_bf16 v[204:207], a[204:207], a[92:95], v[204:207]
  v_mfma_f32_16x16x32_bf16 v[204:207], a[196:199], a[60:63], v[204:207]
  v_mfma_f32_16x16x32_bf16 v[204:207], a[188:191], a[28:31], v[204:207]
  v_mfma_f32_16x16x32_bf16 v[204:207], a[184:187], a[140:143], v[204:207]
  s_waitcnt lgkmcnt(0)
  ds_read_b128 a[112:115], v46 offset:6144
  ds_read_b128 a[116:119], v46 offset:15360
  v_mfma_f32_16x16x32_bf16 v[188:191], a[212:215], a[140:143], v[188:191]
  ds_read_b128 a[120:123], v46 offset:24576
  ds_read_b128 a[124:127], v46 offset:33792
  v_mfma_f32_16x16x32_bf16 v[188:191], a[220:223], a[28:31], v[188:191]
  buffer_load_dwordx4 a[232:235], v30, s[4:7], s88 offen sc1
  v_mfma_f32_16x16x32_bf16 v[188:191], a[128:131], a[60:63], v[188:191]
  v_mfma_f32_16x16x32_bf16 v[188:191], a[136:139], a[92:95], v[188:191]
  v_mfma_f32_16x16x32_bf16 v[184:187], a[136:139], a[88:91], v[184:187]
  buffer_load_dwordx4 a[236:239], v31, s[4:7], s88 offen sc1
  v_mfma_f32_16x16x32_bf16 v[184:187], a[128:131], a[56:59], v[184:187]
  v_mfma_f32_16x16x32_bf16 v[184:187], a[220:223], a[24:27], v[184:187]
  v_mfma_f32_16x16x32_bf16 v[184:187], a[212:215], a[132:135], v[184:187]
  s_add_u32 s88, s88, 4096
  v_mfma_f32_16x16x32_bf16 v[180:183], a[212:215], a[144:147], v[180:183]
  v_mfma_f32_16x16x32_bf16 v[180:183], a[220:223], a[20:23], v[180:183]
  v_mfma_f32_16x16x32_bf16 v[180:183], a[128:131], a[52:55], v[180:183]
  buffer_load_dwordx4 a[240:243], v28, s[4:7], s88 offen sc1
  v_mfma_f32_16x16x32_bf16 v[180:183], a[136:139], a[84:87], v[180:183]
  v_mfma_f32_16x16x32_bf16 v[176:179], a[136:139], a[80:83], v[176:179]
  v_mfma_f32_16x16x32_bf16 v[176:179], a[128:131], a[48:51], v[176:179]
  v_mfma_f32_16x16x32_bf16 v[176:179], a[220:223], a[16:19], v[176:179]
  v_mfma_f32_16x16x32_bf16 v[176:179], a[212:215], a[216:219], v[176:179]
  s_waitcnt lgkmcnt(0)
  ds_read_b128 a[168:171], v46 offset:5120
  ds_read_b128 a[172:175], v46 offset:14336
  v_mfma_f32_16x16x32_bf16 v[160:163], a[112:115], a[216:219], v[160:163]
  ds_read_b128 a[176:179], v46 offset:23552
  ds_read_b128 a[180:183], v46 offset:32768
  v_mfma_f32_16x16x32_bf16 v[160:163], a[116:119], a[16:19], v[160:163]
  buffer_load_dwordx4 a[244:247], v29, s[4:7], s88 offen sc1
  v_mfma_f32_16x16x32_bf16 v[160:163], a[120:123], a[48:51], v[160:163]
  v_mfma_f32_16x16x32_bf16 v[160:163], a[124:127], a[80:83], v[160:163]
  v_mfma_f32_16x16x32_bf16 v[164:167], a[124:127], a[84:87], v[164:167]
  v_mfma_f32_16x16x32_bf16 v[164:167], a[120:123], a[52:55], v[164:167]
  buffer_load_dwordx4 a[248:251], v30, s[4:7], s88 offen sc1
  v_mfma_f32_16x16x32_bf16 v[164:167], a[116:119], a[20:23], v[164:167]
  v_mfma_f32_16x16x32_bf16 v[164:167], a[112:115], a[144:147], v[164:167]
  v_mfma_f32_16x16x32_bf16 v[168:171], a[112:115], a[132:135], v[168:171]
  v_mfma_f32_16x16x32_bf16 v[168:171], a[116:119], a[24:27], v[168:171]
  v_mfma_f32_16x16x32_bf16 v[168:171], a[120:123], a[56:59], v[168:171]
  buffer_load_dwordx4 a[252:255], v31, s[4:7], s88 offen sc1
  v_mfma_f32_16x16x32_bf16 v[168:171], a[124:127], a[88:91], v[168:171]
  v_mfma_f32_16x16x32_bf16 v[172:175], a[124:127], a[92:95], v[172:175]
  s_add_u32 s88, s88, 4096
  v_mfma_f32_16x16x32_bf16 v[172:175], a[120:123], a[60:63], v[172:175]
  v_mfma_f32_16x16x32_bf16 v[172:175], a[116:119], a[28:31], v[172:175]
  v_mfma_f32_16x16x32_bf16 v[172:175], a[112:115], a[140:143], v[172:175]
  s_waitcnt lgkmcnt(0)
  ds_read_b128 a[184:187], v46 offset:2048
  ds_read_b128 a[188:191], v46 offset:11264
  v_mfma_f32_16x16x32_bf16 v[156:159], a[168:171], a[140:143], v[156:159]
  ds_read_b128 a[196:199], v46 offset:20480
  ds_read_b128 a[204:207], v46 offset:29696
  v_mfma_f32_16x16x32_bf16 v[156:159], a[172:175], a[28:31], v[156:159]
  buffer_load_dwordx4 a[148:151], v28, s[4:7], s88 offen sc1
  v_mfma_f32_16x16x32_bf16 v[156:159], a[176:179], a[60:63], v[156:159]
  v_mfma_f32_16x16x32_bf16 v[156:159], a[180:183], a[92:95], v[156:159]
  v_mfma_f32_16x16x32_bf16 v[152:155], a[180:183], a[88:91], v[152:155]
  v_mfma_f32_16x16x32_bf16 v[152:155], a[176:179], a[56:59], v[152:155]
  buffer_load_dwordx4 a[152:155], v29, s[4:7], s88 offen sc1
  v_mfma_f32_16x16x32_bf16 v[152:155], a[172:175], a[24:27], v[152:155]
  v_mfma_f32_16x16x32_bf16 v[152:155], a[168:171], a[132:135], v[152:155]
  v_mfma_f32_16x16x32_bf16 v[148:151], a[168:171], a[144:147], v[148:151]
  v_mfma_f32_16x16x32_bf16 v[148:151], a[172:175], a[20:23], v[148:151]
  v_mfma_f32_16x16x32_bf16 v[148:151], a[176:179], a[52:55], v[148:151]
  buffer_load_dwordx4 a[156:159], v30, s[4:7], s88 offen sc1
  v_mfma_f32_16x16x32_bf16 v[148:151], a[180:183], a[84:87], v[148:151]
  v_mfma_f32_16x16x32_bf16 v[144:147], a[180:183], a[80:83], v[144:147]
  v_mfma_f32_16x16x32_bf16 v[144:147], a[176:179], a[48:51], v[144:147]
  v_mfma_f32_16x16x32_bf16 v[144:147], a[172:175], a[16:19], v[144:147]
  v_mfma_f32_16x16x32_bf16 v[144:147], a[168:171], a[216:219], v[144:147]
  s_waitcnt lgkmcnt(0)
  ds_read_b128 a[212:215], v46 offset:3072
  ds_read_b128 a[220:223], v46 offset:12288
  v_mfma_f32_16x16x32_bf16 v[128:131], a[184:187], a[216:219], v[128:131]
  ds_read_b128 a[128:131], v46 offset:21504
  ds_read_b128 a[136:139], v46 offset:30720
  v_mfma_f32_16x16x32_bf16 v[128:131], a[188:191], a[16:19], v[128:131]
  buffer_load_dwordx4 a[160:163], v31, s[4:7], s88 offen sc1
  v_mfma_f32_16x16x32_bf16 v[128:131], a[196:199], a[48:51], v[128:131]
  s_add_u32 s88, s88, 4096
  v_mfma_f32_16x16x32_bf16 v[128:131], a[204:207], a[80:83], v[128:131]
  v_mfma_f32_16x16x32_bf16 v[132:135], a[204:207], a[84:87], v[132:135]
  v_mfma_f32_16x16x32_bf16 v[132:135], a[196:199], a[52:55], v[132:135]
  buffer_load_dwordx4 a[164:167], v28, s[4:7], s88 offen sc1
  v_mfma_f32_16x16x32_bf16 v[132:135], a[188:191], a[20:23], v[132:135]
  v_mfma_f32_16x16x32_bf16 v[132:135], a[184:187], a[144:147], v[132:135]
  v_mfma_f32_16x16x32_bf16 v[136:139], a[184:187], a[132:135], v[136:139]
  v_mfma_f32_16x16x32_bf16 v[136:139], a[188:191], a[24:27], v[136:139]
  v_mfma_f32_16x16x32_bf16 v[136:139], a[196:199], a[56:59], v[136:139]
  buffer_load_dwordx4 a[192:195], v29, s[4:7], s88 offen sc1
  v_mfma_f32_16x16x32_bf16 v[136:139], a[204:207], a[88:91], v[136:139]
  v_mfma_f32_16x16x32_bf16 v[140:143], a[204:207], a[92:95], v[140:143]
  v_mfma_f32_16x16x32_bf16 v[140:143], a[196:199], a[60:63], v[140:143]
  s_waitcnt lgkmcnt(0)
  s_barrier
  v_mfma_f32_16x16x32_bf16 v[140:143], a[188:191], a[28:31], v[140:143]
  v_mfma_f32_16x16x32_bf16 v[140:143], a[184:187], a[140:143], v[140:143]
  ds_read_b128 a[112:115], v47 offset:8192
  ds_read_b128 a[116:119], v47 offset:17408
  v_mfma_f32_16x16x32_bf16 v[124:127], a[212:215], a[140:143], v[124:127]
pad_m_19:
  s_cbranch_execz warm_4
  ds_read_b128 a[120:123], v47 offset:26624
  ds_read_b128 a[124:127], v47 offset:35840
  v_mfma_f32_16x16x32_bf16 v[124:127], a[220:223], a[28:31], v[124:127]
  buffer_load_dwordx4 a[200:203], v30, s[4:7], s88 offen sc1
  v_mfma_f32_16x16x32_bf16 v[124:127], a[128:131], a[60:63], v[124:127]
  v_mfma_f32_16x16x32_bf16 v[124:127], a[136:139], a[92:95], v[124:127]
  v_mfma_f32_16x16x32_bf16 v[120:123], a[136:139], a[88:91], v[120:123]
  v_mfma_f32_16x16x32_bf16 v[120:123], a[128:131], a[56:59], v[120:123]
  buffer_load_dwordx4 a[208:211], v31, s[4:7], s88 offen sc1
  v_mfma_f32_16x16x32_bf16 v[120:123], a[220:223], a[24:27], v[120:123]
  v_mfma_f32_16x16x32_bf16 v[120:123], a[212:215], a[132:135], v[120:123]
  v_mfma_f32_16x16x32_bf16 v[116:119], a[212:215], a[144:147], v[116:119]
  v_mfma_f32_16x16x32_bf16 v[116:119], a[220:223], a[20:23], v[116:119]
  v_mfma_f32_16x16x32_bf16 v[116:119], a[128:131], a[52:55], v[116:119]
  v_mfma_f32_16x16x32_bf16 v[116:119], a[136:139], a[84:87], v[116:119]
  v_mfma_f32_16x16x32_bf16 v[112:115], a[136:139], a[80:83], v[112:115]
  v_mfma_f32_16x16x32_bf16 v[112:115], a[128:131], a[48:51], v[112:115]
  v_mfma_f32_16x16x32_bf16 v[112:115], a[220:223], a[16:19], v[112:115]
  v_mfma_f32_16x16x32_bf16 v[112:115], a[212:215], a[216:219], v[112:115]
  s_waitcnt lgkmcnt(0)
  ds_read_b128 a[168:171], v47 offset:7168
  ds_read_b128 a[172:175], v47 offset:16384
p3_end10:
pad_p3_end10_0:
  s_cbranch_execz warm_P
  v_mfma_f32_16x16x32_bf16 v[240:243], a[112:115], a[0:3], v[240:243]
  ds_read_b128 a[176:179], v47 offset:25600
  ds_read_b128 a[180:183], v47 offset:34816
  v_mfma_f32_16x16x32_bf16 v[240:243], a[116:119], a[32:35], v[240:243]
  v_mfma_f32_16x16x32_bf16 v[240:243], a[120:123], a[64:67], v[240:243]
  s_waitcnt vmcnt(28)
  v_mfma_f32_16x16x32_bf16 v[240:243], a[124:127], a[96:99], v[240:243]
  s_waitcnt vmcnt(27)
  v_mfma_f32_16x16x32_bf16 v[244:247], a[124:127], a[100:103], v[244:247]
  v_mfma_f32_16x16x32_bf16 v[244:247], a[120:123], a[68:71], v[244:247]
  v_mfma_f32_16x16x32_bf16 v[244:247], a[116:119], a[36:39], v[244:247]
  v_mfma_f32_16x16x32_bf16 v[244:247], a[112:115], a[4:7], v[244:247]
  v_mfma_f32_16x16x32_bf16 v[248:251], a[112:115], a[8:11], v[248:251]
  v_mfma_f32_16x16x32_bf16 v[248:251], a[116:119], a[40:43], v[248:251]
  v_mfma_f32_16x16x32_bf16 v[248:251], a[120:123], a[72:75], v[248:251]
  s_waitcnt vmcnt(26)
  buffer_load_dwordx2 v[98:99], v7, s[36:39], s53 offen
  v_mfma_f32_16x16x32_bf16 v[248:251], a[124:127], a[104:107], v[248:251]
  s_waitcnt vmcnt(26)
  v_mfma_f32_16x16x32_bf16 v[252:255], a[124:127], a[108:111], v[252:255]
  v_mfma_f32_16x16x32_bf16 v[252:255], a[120:123], a[76:79], v[252:255]
  v_mfma_f32_16x16x32_bf16 v[252:255], a[116:119], a[44:47], v[252:255]
  v_mfma_f32_16x16x32_bf16 v[252:255], a[112:115], a[12:15], v[252:255]
  s_waitcnt lgkmcnt(0)
  ds_read_b128 a[184:187], v47 offset:0
  ds_read_b128 a[188:191], v47 offset:9216
  v_mfma_f32_16x16x32_bf16 v[236:239], a[168:171], a[12:15], v[236:239]
  ds_read_b128 a[196:199], v47 offset:18432
  ds_read_b128 a[204:207], v47 offset:27648
  v_mfma_f32_16x16x32_bf16 v[236:239], a[172:175], a[44:47], v[236:239]
  buffer_load_dwordx2 v[100:101], v8, s[36:39], s53 offen
  v_mfma_f32_16x16x32_bf16 v[236:239], a[176:179], a[76:79], v[236:239]
  v_mfma_f32_16x16x32_bf16 v[236:239], a[180:183], a[108:111], v[236:239]
  v_mfma_f32_16x16x32_bf16 v[232:235], a[180:183], a[104:107], v[232:235]
  buffer_load_dwordx2 v[102:103], v9, s[36:39], s53 offen
  v_mfma_f32_16x16x32_bf16 v[232:235], a[176:179], a[72:75], v[232:235]
  v_mfma_f32_16x16x32_bf16 v[232:235], a[172:175], a[40:43], v[232:235]
  v_mfma_f32_16x16x32_bf16 v[232:235], a[168:171], a[8:11], v[232:235]
  v_mfma_f32_16x16x32_bf16 v[228:231], a[168:171], a[4:7], v[228:231]
  v_mfma_f32_16x16x32_bf16 v[228:231], a[172:175], a[36:39], v[228:231]
  s_waitcnt vmcnt(19) lgkmcnt(0)
  s_barrier
  v_mfma_f32_16x16x32_bf16 v[228:231], a[176:179], a[68:71], v[228:231]
  buffer_load_dwordx2 v[104:105], v10, s[36:39], s53 offen
  v_mfma_f32_16x16x32_bf16 v[228:231], a[180:183], a[100:103], v[228:231]
  ds_read_b128 a[212:215], v45 offset:8192
  ds_read_b128 a[220:223], v45 offset:17408
  v_mfma_f32_16x16x32_bf16 v[224:227], a[180:183], a[96:99], v[224:227]
  ds_read_b128 a[128:131], v45 offset:26624
  ds_read_b128 a[136:139], v45 offset:35840
  v_mfma_f32_16x16x32_bf16 v[224:227], a[176:179], a[64:67], v[224:227]
  v_mfma_f32_16x16x32_bf16 v[224:227], a[172:175], a[32:35], v[224:227]
  buffer_load_dwordx2 v[106:107], v11, s[36:39], s53 offen
  v_mfma_f32_16x16x32_bf16 v[224:227], a[168:171], a[0:3], v[224:227]
  v_mfma_f32_16x16x32_bf16 v[212:215], a[184:187], a[4:7], v[212:215]
  v_mfma_f32_16x16x32_bf16 v[212:215], a[188:191], a[36:39], v[212:215]
  v_mfma_f32_16x16x32_bf16 v[212:215], a[196:199], a[68:71], v[212:215]
  v_mfma_f32_16x16x32_bf16 v[212:215], a[204:207], a[100:103], v[212:215]
  v_mfma_f32_16x16x32_bf16 v[216:219], a[204:207], a[104:107], v[216:219]
  v_mfma_f32_16x16x32_bf16 v[216:219], a[196:199], a[72:75], v[216:219]
  v_mfma_f32_16x16x32_bf16 v[216:219], a[188:191], a[40:43], v[216:219]
  v_mfma_f32_16x16x32_bf16 v[216:219], a[184:187], a[8:11], v[216:219]
  v_mfma_f32_16x16x32_bf16 v[220:223], a[184:187], a[12:15], v[220:223]
  v_mfma_f32_16x16x32_bf16 v[220:223], a[188:191], a[44:47], v[220:223]
  v_mfma_f32_16x16x32_bf16 v[220:223], a[196:199], a[76:79], v[220:223]
  v_mfma_f32_16x16x32_bf16 v[220:223], a[204:207], a[108:111], v[220:223]
  s_waitcnt vmcnt(17) lgkmcnt(0)
  ds_read_b128 a[112:115], v47 offset:1024
  ds_read_b128 a[116:119], v47 offset:10240
  v_mfma_f32_16x16x32_bf16 v[252:255], a[212:215], a[236:239], v[252:255]
  s_waitcnt vmcnt(13)
  ds_read_b128 a[120:123], v47 offset:19456
  ds_read_b128 a[124:127], v47 offset:28672
  v_mfma_f32_16x16x32_bf16 v[252:255], a[220:223], a[252:255], v[252:255]
  s_waitcnt vmcnt(9)
  v_mfma_f32_16x16x32_bf16 v[252:255], a[128:131], a[160:163], v[252:255]
  s_waitcnt vmcnt(5)
  v_mfma_f32_16x16x32_bf16 v[252:255], a[136:139], a[208:211], v[252:255]
  v_mfma_f32_16x16x32_bf16 v[248:251], a[136:139], a[200:203], v[248:251]
  v_mfma_f32_16x16x32_bf16 v[248:251], a[128:131], a[156:159], v[248:251]
  v_mfma_f32_16x16x32_bf16 v[248:251], a[220:223], a[248:251], v[248:251]
  v_mfma_f32_16x16x32_bf16 v[248:251], a[212:215], a[232:235], v[248:251]
  v_mfma_f32_16x16x32_bf16 v[244:247], a[212:215], a[228:231], v[244:247]
  s_nop 2
  v_cvt_pk_bf16_f32 v252, v252, v253
  v_mfma_f32_16x16x32_bf16 v[244:247], a[220:223], a[244:247], v[244:247]
  v_cvt_pk_bf16_f32 v253, v254, v255
  v_mfma_f32_16x16x32_bf16 v[244:247], a[128:131], a[152:155], v[244:247]
  v_mfma_f32_16x16x32_bf16 v[244:247], a[136:139], a[192:195], v[244:247]
  ds_read_b128 a[168:171], v45 offset:7168
  ds_read_b128 a[172:175], v45 offset:16384
  v_mfma_f32_16x16x32_bf16 v[240:243], a[136:139], a[164:167], v[240:243]
  ds_read_b128 a[176:179], v45 offset:25600
  ds_read_b128 a[180:183], v45 offset:34816
  v_mfma_f32_16x16x32_bf16 v[240:243], a[128:131], a[148:151], v[240:243]
  v_cvt_pk_bf16_f32 v248, v248, v249
  v_mfma_f32_16x16x32_bf16 v[240:243], a[220:223], a[240:243], v[240:243]
  v_cvt_pk_bf16_f32 v249, v250, v251
  v_mfma_f32_16x16x32_bf16 v[240:243], a[212:215], a[224:227], v[240:243]
  s_waitcnt lgkmcnt(4)
  v_mfma_f32_16x16x32_bf16 v[196:199], a[112:115], a[4:7], v[196:199]
  v_cvt_pk_bf16_f32 v244, v244, v245
  v_mfma_f32_16x16x32_bf16 v[196:199], a[116:119], a[36:39], v[196:199]
  v_cvt_pk_bf16_f32 v245, v246, v247
  v_mfma_f32_16x16x32_bf16 v[196:199], a[120:123], a[68:71], v[196:199]
  v_mfma_f32_16x16x32_bf16 v[196:199], a[124:127], a[100:103], v[196:199]
  v_mfma_f32_16x16x32_bf16 v[200:203], a[124:127], a[104:107], v[200:203]
  v_cvt_pk_bf16_f32 v240, v240, v241
  v_mfma_f32_16x16x32_bf16 v[200:203], a[120:123], a[72:75], v[200:203]
  v_cvt_pk_bf16_f32 v241, v242, v243
  v_mfma_f32_16x16x32_bf16 v[200:203], a[116:119], a[40:43], v[200:203]
  v_mfma_f32_16x16x32_bf16 v[200:203], a[112:115], a[8:11], v[200:203]
  v_mfma_f32_16x16x32_bf16 v[204:207], a[112:115], a[12:15], v[204:207]
  v_mfma_f32_16x16x32_bf16 v[204:207], a[116:119], a[44:47], v[204:207]
  v_mfma_f32_16x16x32_bf16 v[204:207], a[120:123], a[76:79], v[204:207]
  v_mfma_f32_16x16x32_bf16 v[204:207], a[124:127], a[108:111], v[204:207]
  s_waitcnt lgkmcnt(0)
  ds_read_b128 a[184:187], v47 offset:4096
  ds_read_b128 a[188:191], v47 offset:13312
  v_mfma_f32_16x16x32_bf16 v[236:239], a[168:171], a[236:239], v[236:239]
  ds_read_b128 a[196:199], v47 offset:22528
  ds_read_b128 a[204:207], v47 offset:31744
  v_mfma_f32_16x16x32_bf16 v[236:239], a[172:175], a[252:255], v[236:239]
  v_mfma_f32_16x16x32_bf16 v[236:239], a[176:179], a[160:163], v[236:239]
  v_mfma_f32_16x16x32_bf16 v[236:239], a[180:183], a[208:211], v[236:239]
  v_mfma_f32_16x16x32_bf16 v[232:235], a[180:183], a[200:203], v[232:235]
  v_mfma_f32_16x16x32_bf16 v[232:235], a[176:179], a[156:159], v[232:235]
  v_mfma_f32_16x16x32_bf16 v[232:235], a[172:175], a[248:251], v[232:235]
  v_mfma_f32_16x16x32_bf16 v[232:235], a[168:171], a[232:235], v[232:235]
  v_mfma_f32_16x16x32_bf16 v[228:231], a[168:171], a[228:231], v[228:231]
  s_nop 2
  v_cvt_pk_bf16_f32 v254, v236, v237
  v_cvt_pk_bf16_f32 v255, v238, v239
  v_mfma_f32_16x16x32_bf16 v[228:231], a[172:175], a[244:247], v[228:231]
  buffer_store_dwordx4 v[252:255], v50, s[4:7], s98 offen offset:0 sc1
  v_mfma_f32_16x16x32_bf16 v[228:231], a[176:179], a[152:155], v[228:231]
  v_mfma_f32_16x16x32_bf16 v[228:231], a[180:183], a[192:195], v[228:231]
  v_mfma_f32_16x16x32_bf16 v[224:227], a[180:183], a[164:167], v[224:227]
  v_cvt_pk_bf16_f32 v250, v232, v233
  v_cvt_pk_bf16_f32 v251, v234, v235
  v_mfma_f32_16x16x32_bf16 v[224:227], a[176:179], a[148:151], v[224:227]
  buffer_store_dwordx4 v[248:251], v50, s[4:7], s66 offen offset:0 sc1
  v_mfma_f32_16x16x32_bf16 v[224:227], a[172:175], a[240:243], v[224:227]
  v_mfma_f32_16x16x32_bf16 v[224:227], a[168:171], a[224:227], v[224:227]
  s_waitcnt lgkmcnt(0)
  ds_read_b128 a[212:215], v45 offset:0
  ds_read_b128 a[220:223], v45 offset:9216
  v_mfma_f32_16x16x32_bf16 v[176:179], a[184:187], a[0:3], v[176:179]
  ds_read_b128 a[128:131], v45 offset:18432
  ds_read_b128 a[136:139], v45 offset:27648
  v_mfma_f32_16x16x32_bf16 v[176:179], a[188:191], a[32:35], v[176:179]
  v_cvt_pk_bf16_f32 v246, v228, v229
  v_cvt_pk_bf16_f32 v247, v230, v231
  v_mfma_f32_16x16x32_bf16 v[176:179], a[196:199], a[64:67], v[176:179]
  buffer_store_dwordx4 v[244:247], v50, s[4:7], s96 offen offset:0 sc1
  v_mfma_f32_16x16x32_bf16 v[176:179], a[204:207], a[96:99], v[176:179]
  v_mfma_f32_16x16x32_bf16 v[180:183], a[204:207], a[100:103], v[180:183]
  v_cvt_pk_bf16_f32 v242, v224, v225
  v_cvt_pk_bf16_f32 v243, v226, v227
  v_mfma_f32_16x16x32_bf16 v[180:183], a[196:199], a[68:71], v[180:183]
  v_mfma_f32_16x16x32_bf16 v[180:183], a[188:191], a[36:39], v[180:183]
  buffer_store_dwordx4 v[240:243], v50, s[4:7], s94 offen offset:0 sc1
  v_mfma_f32_16x16x32_bf16 v[180:183], a[184:187], a[4:7], v[180:183]
  v_mfma_f32_16x16x32_bf16 v[184:187], a[184:187], a[8:11], v[184:187]
  v_mfma_f32_16x16x32_bf16 v[184:187], a[188:191], a[40:43], v[184:187]
  v_mfma_f32_16x16x32_bf16 v[184:187], a[196:199], a[72:75], v[184:187]
  v_mfma_f32_16x16x32_bf16 v[184:187], a[204:207], a[104:107], v[184:187]
  ds_read_b128 a[112:115], v47 offset:6144
  ds_read_b128 a[116:119], v47 offset:15360
  v_mfma_f32_16x16x32_bf16 v[188:191], a[204:207], a[108:111], v[188:191]
  ds_read_b128 a[120:123], v47 offset:24576
  ds_read_b128 a[124:127], v47 offset:33792
  v_mfma_f32_16x16x32_bf16 v[188:191], a[196:199], a[76:79], v[188:191]
  v_mfma_f32_16x16x32_bf16 v[188:191], a[188:191], a[44:47], v[188:191]
  v_mfma_f32_16x16x32_bf16 v[188:191], a[184:187], a[12:15], v[188:191]
  s_waitcnt lgkmcnt(4)
  v_mfma_f32_16x16x32_bf16 v[220:223], a[212:215], a[236:239], v[220:223]
  v_mfma_f32_16x16x32_bf16 v[220:223], a[220:223], a[252:255], v[220:223]
  v_mfma_f32_16x16x32_bf16 v[220:223], a[128:131], a[160:163], v[220:223]
  v_mfma_f32_16x16x32_bf16 v[220:223], a[136:139], a[208:211], v[220:223]
  v_mfma_f32_16x16x32_bf16 v[216:219], a[136:139], a[200:203], v[216:219]
  v_mfma_f32_16x16x32_bf16 v[216:219], a[128:131], a[156:159], v[216:219]
  v_mfma_f32_16x16x32_bf16 v[216:219], a[220:223], a[248:251], v[216:219]
  v_mfma_f32_16x16x32_bf16 v[216:219], a[212:215], a[232:235], v[216:219]
  v_mfma_f32_16x16x32_bf16 v[212:215], a[212:215], a[228:231], v[212:215]
  s_nop 2
  v_cvt_pk_bf16_f32 v220, v220, v221
  v_mfma_f32_16x16x32_bf16 v[212:215], a[220:223], a[244:247], v[212:215]
  v_cvt_pk_bf16_f32 v221, v222, v223
  v_mfma_f32_16x16x32_bf16 v[212:215], a[128:131], a[152:155], v[212:215]
  v_mfma_f32_16x16x32_bf16 v[212:215], a[136:139], a[192:195], v[212:215]
  s_waitcnt lgkmcnt(0)
  ds_read_b128 a[168:171], v45 offset:1024
  ds_read_b128 a[172:175], v45 offset:10240
  v_mfma_f32_16x16x32_bf16 v[160:163], a[112:115], a[0:3], v[160:163]
  ds_read_b128 a[176:179], v45 offset:19456
  ds_read_b128 a[180:183], v45 offset:28672
  v_mfma_f32_16x16x32_bf16 v[160:163], a[116:119], a[32:35], v[160:163]
  v_cvt_pk_bf16_f32 v216, v216, v217
  v_mfma_f32_16x16x32_bf16 v[160:163], a[120:123], a[64:67], v[160:163]
  v_cvt_pk_bf16_f32 v217, v218, v219
  v_mfma_f32_16x16x32_bf16 v[160:163], a[124:127], a[96:99], v[160:163]
  v_mfma_f32_16x16x32_bf16 v[164:167], a[124:127], a[100:103], v[164:167]
  v_cvt_pk_bf16_f32 v212, v212, v213
  v_mfma_f32_16x16x32_bf16 v[164:167], a[120:123], a[68:71], v[164:167]
  v_cvt_pk_bf16_f32 v213, v214, v215
  v_mfma_f32_16x16x32_bf16 v[164:167], a[116:119], a[36:39], v[164:167]
  v_mfma_f32_16x16x32_bf16 v[164:167], a[112:115], a[4:7], v[164:167]
  v_mfma_f32_16x16x32_bf16 v[168:171], a[112:115], a[8:11], v[168:171]
  v_mfma_f32_16x16x32_bf16 v[168:171], a[116:119], a[40:43], v[168:171]
  v_mfma_f32_16x16x32_bf16 v[168:171], a[120:123], a[72:75], v[168:171]
  v_mfma_f32_16x16x32_bf16 v[168:171], a[124:127], a[104:107], v[168:171]
  ds_read_b128 a[184:187], v47 offset:5120
  ds_read_b128 a[188:191], v47 offset:14336
  v_mfma_f32_16x16x32_bf16 v[172:175], a[124:127], a[108:111], v[172:175]
  ds_read_b128 a[196:199], v47 offset:23552
  ds_read_b128 a[204:207], v47 offset:32768
  v_mfma_f32_16x16x32_bf16 v[172:175], a[120:123], a[76:79], v[172:175]
  v_mfma_f32_16x16x32_bf16 v[172:175], a[116:119], a[44:47], v[172:175]
  v_mfma_f32_16x16x32_bf16 v[172:175], a[112:115], a[12:15], v[172:175]
  s_waitcnt lgkmcnt(4)
  v_mfma_f32_16x16x32_bf16 v[204:207], a[168:171], a[236:239], v[204:207]
  v_mfma_f32_16x16x32_bf16 v[204:207], a[172:175], a[252:255], v[204:207]
  v_mfma_f32_16x16x32_bf16 v[204:207], a[176:179], a[160:163], v[204:207]
  v_mfma_f32_16x16x32_bf16 v[204:207], a[180:183], a[208:211], v[204:207]
  v_mfma_f32_16x16x32_bf16 v[200:203], a[180:183], a[200:203], v[200:203]
  v_mfma_f32_16x16x32_bf16 v[200:203], a[176:179], a[156:159], v[200:203]
  v_mfma_f32_16x16x32_bf16 v[200:203], a[172:175], a[248:251], v[200:203]
  v_mfma_f32_16x16x32_bf16 v[200:203], a[168:171], a[232:235], v[200:203]
  v_mfma_f32_16x16x32_bf16 v[196:199], a[168:171], a[228:231], v[196:199]
  s_nop 2
  v_cvt_pk_bf16_f32 v222, v204, v205
  v_cvt_pk_bf16_f32 v223, v206, v207
  v_mfma_f32_16x16x32_bf16 v[196:199], a[172:175], a[244:247], v[196:199]
  buffer_store_dwordx4 v[220:223], v50, s[4:7], s97 offen offset:0 sc1
  v_mfma_f32_16x16x32_bf16 v[196:199], a[176:179], a[152:155], v[196:199]
  v_mfma_f32_16x16x32_bf16 v[196:199], a[180:183], a[192:195], v[196:199]
  s_waitcnt lgkmcnt(0)
  ds_read_b128 a[212:215], v45 offset:4096
  ds_read_b128 a[220:223], v45 offset:13312
  v_mfma_f32_16x16x32_bf16 v[144:147], a[184:187], a[0:3], v[144:147]
  ds_read_b128 a[128:131], v45 offset:22528
  ds_read_b128 a[136:139], v45 offset:31744
  v_mfma_f32_16x16x32_bf16 v[144:147], a[188:191], a[32:35], v[144:147]
  v_cvt_pk_bf16_f32 v218, v200, v201
  v_cvt_pk_bf16_f32 v219, v202, v203
  v_mfma_f32_16x16x32_bf16 v[144:147], a[196:199], a[64:67], v[144:147]
  buffer_store_dwordx4 v[216:219], v50, s[4:7], s65 offen offset:0 sc1
  v_mfma_f32_16x16x32_bf16 v[144:147], a[204:207], a[96:99], v[144:147]
  v_mfma_f32_16x16x32_bf16 v[148:151], a[204:207], a[100:103], v[148:151]
  v_cvt_pk_bf16_f32 v214, v196, v197
  v_cvt_pk_bf16_f32 v215, v198, v199
  v_mfma_f32_16x16x32_bf16 v[148:151], a[196:199], a[68:71], v[148:151]
  v_mfma_f32_16x16x32_bf16 v[148:151], a[188:191], a[36:39], v[148:151]
  buffer_store_dwordx4 v[212:215], v50, s[4:7], s95 offen offset:0 sc1
  v_mfma_f32_16x16x32_bf16 v[148:151], a[184:187], a[4:7], v[148:151]
  v_mfma_f32_16x16x32_bf16 v[152:155], a[184:187], a[8:11], v[152:155]
  v_mfma_f32_16x16x32_bf16 v[152:155], a[188:191], a[40:43], v[152:155]
  v_mfma_f32_16x16x32_bf16 v[152:155], a[196:199], a[72:75], v[152:155]
  v_mfma_f32_16x16x32_bf16 v[152:155], a[204:207], a[104:107], v[152:155]
  v_mfma_f32_16x16x32_bf16 v[156:159], a[204:207], a[108:111], v[156:159]
  v_mfma_f32_16x16x32_bf16 v[156:159], a[196:199], a[76:79], v[156:159]
  v_mfma_f32_16x16x32_bf16 v[156:159], a[188:191], a[44:47], v[156:159]
  v_mfma_f32_16x16x32_bf16 v[156:159], a[184:187], a[12:15], v[156:159]
  s_waitcnt lgkmcnt(0)
  ds_read_b128 a[112:115], v47 offset:2048
  ds_read_b128 a[116:119], v47 offset:11264
  v_mfma_f32_16x16x32_bf16 v[188:191], a[212:215], a[236:239], v[188:191]
  ds_read_b128 a[120:123], v47 offset:20480
  ds_read_b128 a[124:127], v47 offset:29696
  v_mfma_f32_16x16x32_bf16 v[188:191], a[220:223], a[252:255], v[188:191]
  v_mfma_f32_16x16x32_bf16 v[188:191], a[128:131], a[160:163], v[188:191]
  v_mfma_f32_16x16x32_bf16 v[188:191], a[136:139], a[208:211], v[188:191]
  v_mfma_f32_16x16x32_bf16 v[184:187], a[136:139], a[200:203], v[184:187]
  v_mfma_f32_16x16x32_bf16 v[184:187], a[128:131], a[156:159], v[184:187]
  v_mfma_f32_16x16x32_bf16 v[184:187], a[220:223], a[248:251], v[184:187]
  v_mfma_f32_16x16x32_bf16 v[184:187], a[212:215], a[232:235], v[184:187]
  v_mfma_f32_16x16x32_bf16 v[180:183], a[212:215], a[228:231], v[180:183]
  s_nop 2
  v_cvt_pk_bf16_f32 v188, v188, v189
  v_mfma_f32_16x16x32_bf16 v[180:183], a[220:223], a[244:247], v[180:183]
  v_cvt_pk_bf16_f32 v189, v190, v191
  v_mfma_f32_16x16x32_bf16 v[180:183], a[128:131], a[152:155], v[180:183]
  buffer_store_dwordx2 v[188:189], v33, s[4:7], s98 offen offset:2048 sc1
  v_mfma_f32_16x16x32_bf16 v[180:183], a[136:139], a[192:195], v[180:183]
  ds_read_b128 a[168:171], v45 offset:6144
  ds_read_b128 a[172:175], v45 offset:15360
  v_mfma_f32_16x16x32_bf16 v[176:179], a[136:139], a[164:167], v[176:179]
  ds_read_b128 a[176:179], v45 offset:24576
  ds_read_b128 a[180:183], v45 offset:33792
  v_mfma_f32_16x16x32_bf16 v[176:179], a[128:131], a[148:151], v[176:179]
  v_cvt_pk_bf16_f32 v184, v184, v185
  v_mfma_f32_16x16x32_bf16 v[176:179], a[220:223], a[240:243], v[176:179]
  buffer_store_dwordx2 v[188:189], v32, s[4:7], s97 offen offset:2048 sc1
  v_mfma_f32_16x16x32_bf16 v[176:179], a[212:215], a[224:227], v[176:179]
  s_waitcnt lgkmcnt(4)
  v_cvt_pk_bf16_f32 v185, v186, v187
  v_mfma_f32_16x16x32_bf16 v[132:135], a[112:115], a[4:7], v[132:135]
  v_cvt_pk_bf16_f32 v180, v180, v181
  v_mfma_f32_16x16x32_bf16 v[132:135], a[116:119], a[36:39], v[132:135]
  v_cvt_pk_bf16_f32 v181, v182, v183
  v_mfma_f32_16x16x32_bf16 v[132:135], a[120:123], a[68:71], v[132:135]
  buffer_store_dwordx2 v[184:185], v33, s[4:7], s66 offen offset:2048 sc1
  v_mfma_f32_16x16x32_bf16 v[132:135], a[124:127], a[100:103], v[132:135]
  v_mfma_f32_16x16x32_bf16 v[136:139], a[124:127], a[104:107], v[136:139]
  v_cvt_pk_bf16_f32 v108, v176, v177
  v_cvt_pk_bf16_f32 v109, v178, v179
  v_mfma_f32_16x16x32_bf16 v[136:139], a[120:123], a[72:75], v[136:139]
  v_mfma_f32_16x16x32_bf16 v[136:139], a[116:119], a[40:43], v[136:139]
  buffer_store_dwordx2 v[184:185], v32, s[4:7], s65 offen offset:2048 sc1
  v_mfma_f32_16x16x32_bf16 v[136:139], a[112:115], a[8:11], v[136:139]
  v_mfma_f32_16x16x32_bf16 v[140:143], a[112:115], a[12:15], v[140:143]
  v_mfma_f32_16x16x32_bf16 v[140:143], a[116:119], a[44:47], v[140:143]
  v_mfma_f32_16x16x32_bf16 v[140:143], a[120:123], a[76:79], v[140:143]
  buffer_store_dwordx2 v[180:181], v33, s[4:7], s96 offen offset:2048 sc1
  v_mfma_f32_16x16x32_bf16 v[140:143], a[124:127], a[108:111], v[140:143]
  s_waitcnt lgkmcnt(0)
  ds_read_b128 a[184:187], v47 offset:3072
  ds_read_b128 a[188:191], v47 offset:12288
  v_mfma_f32_16x16x32_bf16 v[172:175], a[168:171], a[236:239], v[172:175]
  ds_read_b128 a[196:199], v47 offset:21504
  ds_read_b128 a[204:207], v47 offset:30720
  v_mfma_f32_16x16x32_bf16 v[172:175], a[172:175], a[252:255], v[172:175]
  v_mfma_f32_16x16x32_bf16 v[172:175], a[176:179], a[160:163], v[172:175]
  buffer_store_dwordx2 v[180:181], v32, s[4:7], s95 offen offset:2048 sc1
  v_mfma_f32_16x16x32_bf16 v[172:175], a[180:183], a[208:211], v[172:175]
  v_mfma_f32_16x16x32_bf16 v[168:171], a[180:183], a[200:203], v[168:171]
  v_mfma_f32_16x16x32_bf16 v[168:171], a[176:179], a[156:159], v[168:171]
  v_mfma_f32_16x16x32_bf16 v[168:171], a[172:175], a[248:251], v[168:171]
  buffer_store_dwordx2 v[108:109], v33, s[4:7], s94 offen offset:2048 sc1
  v_mfma_f32_16x16x32_bf16 v[168:171], a[168:171], a[232:235], v[168:171]
  v_mfma_f32_16x16x32_bf16 v[164:167], a[168:171], a[228:231], v[164:167]
  s_nop 1
  v_cvt_pk_bf16_f32 v172, v172, v173
  v_mfma_f32_16x16x32_bf16 v[164:167], a[172:175], a[244:247], v[164:167]
  v_cvt_pk_bf16_f32 v173, v174, v175
  v_mfma_f32_16x16x32_bf16 v[164:167], a[176:179], a[152:155], v[164:167]
  v_mfma_f32_16x16x32_bf16 v[164:167], a[180:183], a[192:195], v[164:167]
  ds_read_b128 a[212:215], v45 offset:5120
  ds_read_b128 a[220:223], v45 offset:14336
  v_mfma_f32_16x16x32_bf16 v[160:163], a[180:183], a[164:167], v[160:163]
  ds_read_b128 a[128:131], v45 offset:23552
  ds_read_b128 a[136:139], v45 offset:32768
  v_mfma_f32_16x16x32_bf16 v[160:163], a[176:179], a[148:151], v[160:163]
  v_cvt_pk_bf16_f32 v168, v168, v169
  v_mfma_f32_16x16x32_bf16 v[160:163], a[172:175], a[240:243], v[160:163]
  v_cvt_pk_bf16_f32 v169, v170, v171
  v_mfma_f32_16x16x32_bf16 v[160:163], a[168:171], a[224:227], v[160:163]
  s_waitcnt lgkmcnt(4)
  v_mfma_f32_16x16x32_bf16 v[116:119], a[184:187], a[4:7], v[116:119]
  v_cvt_pk_bf16_f32 v164, v164, v165
  v_mfma_f32_16x16x32_bf16 v[116:119], a[188:191], a[36:39], v[116:119]
  v_cvt_pk_bf16_f32 v165, v166, v167
  v_mfma_f32_16x16x32_bf16 v[116:119], a[196:199], a[68:71], v[116:119]
  v_mfma_f32_16x16x32_bf16 v[116:119], a[204:207], a[100:103], v[116:119]
  v_mfma_f32_16x16x32_bf16 v[120:123], a[204:207], a[104:107], v[120:123]
  v_cvt_pk_bf16_f32 v160, v160, v161
  v_mfma_f32_16x16x32_bf16 v[120:123], a[196:199], a[72:75], v[120:123]
  v_cvt_pk_bf16_f32 v161, v162, v163
  v_mfma_f32_16x16x32_bf16 v[120:123], a[188:191], a[40:43], v[120:123]
  v_mfma_f32_16x16x32_bf16 v[120:123], a[184:187], a[8:11], v[120:123]
  v_mfma_f32_16x16x32_bf16 v[124:127], a[184:187], a[12:15], v[124:127]
  v_mfma_f32_16x16x32_bf16 v[124:127], a[188:191], a[44:47], v[124:127]
  v_mfma_f32_16x16x32_bf16 v[124:127], a[196:199], a[76:79], v[124:127]
  v_mfma_f32_16x16x32_bf16 v[124:127], a[204:207], a[108:111], v[124:127]
  s_waitcnt lgkmcnt(0)
  ds_read_b128 a[112:115], v45 offset:2048
  ds_read_b128 a[116:119], v45 offset:11264
  v_mfma_f32_16x16x32_bf16 v[156:159], a[212:215], a[236:239], v[156:159]
  ds_read_b128 a[120:123], v45 offset:20480
  ds_read_b128 a[124:127], v45 offset:29696
  v_mfma_f32_16x16x32_bf16 v[156:159], a[220:223], a[252:255], v[156:159]
  s_waitcnt vmcnt(18)
  v_lshlrev_b32 v240, 16, v98
  v_and_b32 v241, 0xffff0000, v98
  v_mfma_f32_16x16x32_bf16 v[156:159], a[128:131], a[160:163], v[156:159]
  v_lshlrev_b32 v242, 16, v99
  v_and_b32 v243, 0xffff0000, v99
  v_mfma_f32_16x16x32_bf16 v[156:159], a[136:139], a[208:211], v[156:159]
  s_waitcnt vmcnt(17)
  v_lshlrev_b32 v244, 16, v100
  v_and_b32 v245, 0xffff0000, v100
  v_mfma_f32_16x16x32_bf16 v[152:155], a[136:139], a[200:203], v[152:155]
  v_lshlrev_b32 v246, 16, v101
  v_and_b32 v247, 0xffff0000, v101
  v_mfma_f32_16x16x32_bf16 v[152:155], a[128:131], a[156:159], v[152:155]
  s_waitcnt vmcnt(16)
  v_lshlrev_b32 v248, 16, v102
  v_and_b32 v249, 0xffff0000, v102
  v_mfma_f32_16x16x32_bf16 v[152:155], a[220:223], a[248:251], v[152:155]
  buffer_load_dword v59, v13, s[4:7], s48 offen sc1
  v_mfma_f32_16x16x32_bf16 v[152:155], a[212:215], a[232:235], v[152:155]
  v_lshlrev_b32 v250, 16, v103
  v_and_b32 v251, 0xffff0000, v103
  v_mfma_f32_16x16x32_bf16 v[148:151], a[212:215], a[228:231], v[148:151]
  v_cvt_pk_bf16_f32 v174, v156, v157
  v_cvt_pk_bf16_f32 v175, v158, v159
  v_mfma_f32_16x16x32_bf16 v[148:151], a[220:223], a[244:247], v[148:151]
  buffer_store_dwordx4 v[172:175], v50, s[4:7], s98 offen offset:1024 sc1
  v_mfma_f32_16x16x32_bf16 v[148:151], a[128:131], a[152:155], v[148:151]
  s_waitcnt vmcnt(17)
  v_lshlrev_b32 v252, 16, v104
  v_and_b32 v253, 0xffff0000, v104
  v_mfma_f32_16x16x32_bf16 v[148:151], a[136:139], a[192:195], v[148:151]
  ds_read_b128 a[168:171], v45 offset:3072
  ds_read_b128 a[172:175], v45 offset:12288
  v_mfma_f32_16x16x32_bf16 v[144:147], a[136:139], a[164:167], v[144:147]
  ds_read_b128 a[176:179], v45 offset:21504
  ds_read_b128 a[180:183], v45 offset:30720
  v_mfma_f32_16x16x32_bf16 v[144:147], a[128:131], a[148:151], v[144:147]
  v_cvt_pk_bf16_f32 v170, v152, v153
  v_cvt_pk_bf16_f32 v171, v154, v155
  v_mfma_f32_16x16x32_bf16 v[144:147], a[220:223], a[240:243], v[144:147]
  buffer_store_dwordx4 v[168:171], v50, s[4:7], s66 offen offset:1024 sc1
  v_mfma_f32_16x16x32_bf16 v[144:147], a[212:215], a[224:227], v[144:147]
  s_waitcnt lgkmcnt(4)
  v_lshlrev_b32 v254, 16, v105
  v_and_b32 v255, 0xffff0000, v105
  v_mfma_f32_16x16x32_bf16 v[132:135], a[112:115], a[228:231], v[132:135]
  v_cvt_pk_bf16_f32 v166, v148, v149
  v_cvt_pk_bf16_f32 v167, v150, v151
  v_mfma_f32_16x16x32_bf16 v[132:135], a[116:119], a[244:247], v[132:135]
  s_waitcnt vmcnt(17)
  v_lshlrev_b32 v180, 16, v106
  v_and_b32 v181, 0xffff0000, v106
  v_mfma_f32_16x16x32_bf16 v[132:135], a[120:123], a[152:155], v[132:135]
  buffer_store_dwordx4 v[164:167], v50, s[4:7], s96 offen offset:1024 sc1
  v_mfma_f32_16x16x32_bf16 v[132:135], a[124:127], a[192:195], v[132:135]
  v_lshlrev_b32 v182, 16, v107
  v_and_b32 v183, 0xffff0000, v107
  v_mfma_f32_16x16x32_bf16 v[136:139], a[124:127], a[200:203], v[136:139]
  v_cvt_pk_bf16_f32 v162, v144, v145
  v_cvt_pk_bf16_f32 v163, v146, v147
  v_mfma_f32_16x16x32_bf16 v[136:139], a[120:123], a[156:159], v[136:139]
  v_mfma_f32_16x16x32_bf16 v[136:139], a[116:119], a[248:251], v[136:139]
  buffer_store_dwordx4 v[160:163], v50, s[4:7], s94 offen offset:1024 sc1
  v_mfma_f32_16x16x32_bf16 v[136:139], a[112:115], a[232:235], v[136:139]
  ds_read_b128 a[184:187], v47 offset:0
  ds_read_b128 a[188:191], v47 offset:9216
  v_mfma_f32_16x16x32_bf16 v[140:143], a[112:115], a[236:239], v[140:143]
  ds_read_b128 a[196:199], v47 offset:18432
  ds_read_b128 a[204:207], v47 offset:27648
  v_mfma_f32_16x16x32_bf16 v[140:143], a[116:119], a[252:255], v[140:143]
  v_cvt_pk_bf16_f32 v132, v132, v133
  v_mfma_f32_16x16x32_bf16 v[140:143], a[120:123], a[160:163], v[140:143]
  v_cvt_pk_bf16_f32 v133, v134, v135
  v_mfma_f32_16x16x32_bf16 v[140:143], a[124:127], a[208:211], v[140:143]
  s_waitcnt lgkmcnt(4)
  ds_read_b128 a[212:215], v45 offset:0
  ds_read_b128 a[220:223], v45 offset:9216
  v_mfma_f32_16x16x32_bf16 v[124:127], a[168:171], a[236:239], v[124:127]
  ds_read_b128 a[128:131], v45 offset:18432
  ds_read_b128 a[136:139], v45 offset:27648
  v_mfma_f32_16x16x32_bf16 v[124:127], a[172:175], a[252:255], v[124:127]
  v_cvt_pk_bf16_f32 v136, v136, v137
  v_mfma_f32_16x16x32_bf16 v[124:127], a[176:179], a[160:163], v[124:127]
  v_cvt_pk_bf16_f32 v137, v138, v139
  v_mfma_f32_16x16x32_bf16 v[124:127], a[180:183], a[208:211], v[124:127]
  ds_read_b128 a[112:115], v47 offset:1024
  ds_read_b128 a[116:119], v47 offset:10240
  v_mfma_f32_16x16x32_bf16 v[120:123], a[180:183], a[200:203], v[120:123]
  ds_read_b128 a[120:123], v47 offset:19456
  ds_read_b128 a[124:127], v47 offset:28672
  v_mfma_f32_16x16x32_bf16 v[120:123], a[176:179], a[156:159], v[120:123]
  v_cvt_pk_bf16_f32 v140, v140, v141
  v_mfma_f32_16x16x32_bf16 v[120:123], a[172:175], a[248:251], v[120:123]
  v_cvt_pk_bf16_f32 v141, v142, v143
  v_mfma_f32_16x16x32_bf16 v[120:123], a[168:171], a[232:235], v[120:123]
  v_mfma_f32_16x16x32_bf16 v[116:119], a[168:171], a[228:231], v[116:119]
  v_cvt_pk_bf16_f32 v142, v124, v125
  v_cvt_pk_bf16_f32 v143, v126, v127
  v_mfma_f32_16x16x32_bf16 v[116:119], a[172:175], a[244:247], v[116:119]
  buffer_store_dwordx4 v[140:143], v50, s[4:7], s97 offen offset:1024 sc1
  v_mfma_f32_16x16x32_bf16 v[116:119], a[176:179], a[152:155], v[116:119]
  v_mfma_f32_16x16x32_bf16 v[116:119], a[180:183], a[192:195], v[116:119]
  s_waitcnt lgkmcnt(8)
  ds_read_b128 a[168:171], v45 offset:1024
  ds_read_b128 a[172:175], v45 offset:10240
  v_mfma_f32_16x16x32_bf16 v[208:211], a[184:187], a[0:3], v[208:211]
  ds_read_b128 a[176:179], v45 offset:19456
  ds_read_b128 a[180:183], v45 offset:28672
  v_mfma_f32_16x16x32_bf16 v[208:211], a[188:191], a[32:35], v[208:211]
  v_cvt_pk_bf16_f32 v138, v120, v121
  v_cvt_pk_bf16_f32 v139, v122, v123
  v_mfma_f32_16x16x32_bf16 v[208:211], a[196:199], a[64:67], v[208:211]
  buffer_store_dwordx4 v[136:139], v50, s[4:7], s65 offen offset:1024 sc1
  v_mfma_f32_16x16x32_bf16 v[208:211], a[204:207], a[96:99], v[208:211]
  s_waitcnt lgkmcnt(8)
  ds_read_b128 a[184:187], v47 offset:2048
  ds_read_b128 a[188:191], v47 offset:11264
  v_mfma_f32_16x16x32_bf16 v[208:211], a[212:215], a[224:227], v[208:211]
  s_add_u32 s94, s50, 0
  ds_read_b128 a[196:199], v47 offset:20480
  ds_read_b128 a[204:207], v47 offset:29696
  v_mfma_f32_16x16x32_bf16 v[208:211], a[220:223], a[240:243], v[208:211]
  s_add_u32 s96, s50, 5120
  v_cvt_pk_bf16_f32 v134, v116, v117
  v_cvt_pk_bf16_f32 v135, v118, v119
  v_mfma_f32_16x16x32_bf16 v[208:211], a[128:131], a[148:151], v[208:211]
  buffer_store_dwordx4 v[132:135], v50, s[4:7], s95 offen offset:1024 sc1
  v_mfma_f32_16x16x32_bf16 v[208:211], a[136:139], a[164:167], v[208:211]
  s_waitcnt lgkmcnt(8)
  ds_read_b128 a[212:215], v45 offset:2048
  ds_read_b128 a[220:223], v45 offset:11264
  s_waitcnt vmcnt(7)
  v_cmp_ne_u32 vcc, 0, v59
  v_mfma_f32_16x16x32_bf16 v[192:195], a[112:115], a[0:3], v[192:195]
  s_and_b32 s75, vcc_lo, 0xfe
  ds_read_b128 a[128:131], v45 offset:20480
  ds_read_b128 a[136:139], v45 offset:29696
  v_mfma_f32_16x16x32_bf16 v[192:195], a[116:119], a[32:35], v[192:195]
  s_bitcmp1_b32 s75, 1
  s_cselect_b32 s94, s94, 0x70000000
  v_mfma_f32_16x16x32_bf16 v[192:195], a[120:123], a[64:67], v[192:195]
  s_add_u32 s95, s50, 2560
  v_mfma_f32_16x16x32_bf16 v[192:195], a[124:127], a[96:99], v[192:195]
pad_p3_end10_1:
  s_cbranch_execz warm_P
  s_waitcnt lgkmcnt(8)
  ds_read_b128 a[112:115], v47 offset:3072
  ds_read_b128 a[116:119], v47 offset:12288
  v_mfma_f32_16x16x32_bf16 v[192:195], a[168:171], a[224:227], v[192:195]
  s_add_u32 s65, s50, 7680
  ds_read_b128 a[120:123], v47 offset:21504
  ds_read_b128 a[124:127], v47 offset:30720
  v_mfma_f32_16x16x32_bf16 v[192:195], a[172:175], a[240:243], v[192:195]
  buffer_load_dwordx4 v[224:227], v50, s[4:7], s94 offen offset:0 sc1
  v_mfma_f32_16x16x32_bf16 v[192:195], a[176:179], a[148:151], v[192:195]
  s_bitcmp1_b32 s75, 2
  s_cselect_b32 s95, s95, 0x70000000
  v_mfma_f32_16x16x32_bf16 v[192:195], a[180:183], a[164:167], v[192:195]
  s_waitcnt lgkmcnt(8)
  ds_read_b128 a[168:171], v45 offset:3072
  ds_read_b128 a[172:175], v45 offset:12288
  v_mfma_f32_16x16x32_bf16 v[128:131], a[184:187], a[0:3], v[128:131]
  s_add_u32 s66, s50, 10240
  ds_read_b128 a[176:179], v45 offset:21504
  ds_read_b128 a[180:183], v45 offset:30720
  v_mfma_f32_16x16x32_bf16 v[128:131], a[188:191], a[32:35], v[128:131]
  buffer_load_dwordx4 v[196:199], v50, s[4:7], s95 offen offset:0 sc1
  v_mfma_f32_16x16x32_bf16 v[128:131], a[196:199], a[64:67], v[128:131]
  s_bitcmp1_b32 s75, 3
  s_cselect_b32 s96, s96, 0x70000000
  v_mfma_f32_16x16x32_bf16 v[128:131], a[204:207], a[96:99], v[128:131]
  s_waitcnt lgkmcnt(8)
  buffer_load_dwordx4 v[228:231], v50, s[4:7], s96 offen offset:0 sc1
  v_mfma_f32_16x16x32_bf16 v[128:131], a[212:215], a[224:227], v[128:131]
  s_bitcmp1_b32 s75, 4
  s_cselect_b32 s65, s65, 0x70000000
  v_mfma_f32_16x16x32_bf16 v[128:131], a[220:223], a[240:243], v[128:131]
  buffer_load_dwordx4 v[200:203], v50, s[4:7], s65 offen offset:0 sc1
  v_mfma_f32_16x16x32_bf16 v[128:131], a[128:131], a[148:151], v[128:131]
  s_bitcmp1_b32 s75, 5
  s_cselect_b32 s66, s66, 0x70000000
  v_mfma_f32_16x16x32_bf16 v[128:131], a[136:139], a[164:167], v[128:131]
  s_waitcnt lgkmcnt(4)
  buffer_load_dwordx4 v[232:235], v50, s[4:7], s66 offen offset:0 sc1
  v_mfma_f32_16x16x32_bf16 v[112:115], a[112:115], a[0:3], v[112:115]
  s_add_u32 s97, s50, 12800
  v_mfma_f32_16x16x32_bf16 v[112:115], a[116:119], a[32:35], v[112:115]
  s_bitcmp1_b32 s75, 6
  s_cselect_b32 s97, s97, 0x70000000
  v_mfma_f32_16x16x32_bf16 v[112:115], a[120:123], a[64:67], v[112:115]
  s_add_u32 s98, s50, 15360
  v_mfma_f32_16x16x32_bf16 v[112:115], a[124:127], a[96:99], v[112:115]
  s_waitcnt lgkmcnt(0)
  buffer_load_dwordx4 v[204:207], v50, s[4:7], s97 offen offset:0 sc1
  v_mfma_f32_16x16x32_bf16 v[112:115], a[168:171], a[224:227], v[112:115]
  s_bitcmp1_b32 s75, 7
  s_cselect_b32 s98, s98, 0x70000000
  v_mfma_f32_16x16x32_bf16 v[112:115], a[172:175], a[240:243], v[112:115]
  buffer_load_dwordx4 v[236:239], v50, s[4:7], s98 offen offset:0 sc1
  v_mfma_f32_16x16x32_bf16 v[112:115], a[176:179], a[148:151], v[112:115]
  v_mfma_f32_16x16x32_bf16 v[112:115], a[180:183], a[164:167], v[112:115]
  s_branch p3_tail
p3_end6:
pad_p3_end6_0:
  s_cbranch_execz warm_P
  s_waitcnt vmcnt(40)
  v_mfma_f32_16x16x32_bf16 v[240:243], a[112:115], a[216:219], v[240:243]
  s_waitcnt vmcnt(35)
  ds_read_b128 a[176:179], v46 offset:25600
  ds_read_b128 a[180:183], v46 offset:34816
  v_mfma_f32_16x16x32_bf16 v[240:243], a[116:119], a[16:19], v[240:243]
  s_waitcnt vmcnt(31)
  v_mfma_f32_16x16x32_bf16 v[240:243], a[120:123], a[48:51], v[240:243]
  s_waitcnt vmcnt(27)
  buffer_load_dwordx4 a[104:107], v30, s[4:7], s88 offen sc1
  v_mfma_f32_16x16x32_bf16 v[240:243], a[124:127], a[80:83], v[240:243]
  s_waitcnt vmcnt(27)
  v_mfma_f32_16x16x32_bf16 v[244:247], a[124:127], a[84:87], v[244:247]
  v_mfma_f32_16x16x32_bf16 v[244:247], a[120:123], a[52:55], v[244:247]
  v_mfma_f32_16x16x32_bf16 v[244:247], a[116:119], a[20:23], v[244:247]
  v_mfma_f32_16x16x32_bf16 v[244:247], a[112:115], a[144:147], v[244:247]
  buffer_load_dwordx4 a[108:111], v31, s[4:7], s88 offen sc1
  v_mfma_f32_16x16x32_bf16 v[248:251], a[112:115], a[132:135], v[248:251]
  v_mfma_f32_16x16x32_bf16 v[248:251], a[116:119], a[24:27], v[248:251]
  v_mfma_f32_16x16x32_bf16 v[248:251], a[120:123], a[56:59], v[248:251]
  s_waitcnt vmcnt(27)
  buffer_load_dwordx2 v[98:99], v7, s[36:39], s53 offen
  v_mfma_f32_16x16x32_bf16 v[248:251], a[124:127], a[88:91], v[248:251]
  s_waitcnt vmcnt(27)
  v_mfma_f32_16x16x32_bf16 v[252:255], a[124:127], a[92:95], v[252:255]
  v_mfma_f32_16x16x32_bf16 v[252:255], a[120:123], a[60:63], v[252:255]
  v_mfma_f32_16x16x32_bf16 v[252:255], a[116:119], a[28:31], v[252:255]
  v_mfma_f32_16x16x32_bf16 v[252:255], a[112:115], a[140:143], v[252:255]
  s_waitcnt lgkmcnt(0)
  ds_read_b128 a[184:187], v46 offset:0
  ds_read_b128 a[188:191], v46 offset:9216
  v_mfma_f32_16x16x32_bf16 v[236:239], a[168:171], a[140:143], v[236:239]
  ds_read_b128 a[196:199], v46 offset:18432
  ds_read_b128 a[204:207], v46 offset:27648
  v_mfma_f32_16x16x32_bf16 v[236:239], a[172:175], a[28:31], v[236:239]
  buffer_load_dwordx2 v[100:101], v8, s[36:39], s53 offen
  v_mfma_f32_16x16x32_bf16 v[236:239], a[176:179], a[60:63], v[236:239]
  v_mfma_f32_16x16x32_bf16 v[236:239], a[180:183], a[92:95], v[236:239]
  v_mfma_f32_16x16x32_bf16 v[232:235], a[180:183], a[88:91], v[232:235]
  buffer_load_dwordx2 v[102:103], v9, s[36:39], s53 offen
  v_mfma_f32_16x16x32_bf16 v[232:235], a[176:179], a[56:59], v[232:235]
  v_mfma_f32_16x16x32_bf16 v[232:235], a[172:175], a[24:27], v[232:235]
  v_mfma_f32_16x16x32_bf16 v[232:235], a[168:171], a[132:135], v[232:235]
  v_mfma_f32_16x16x32_bf16 v[228:231], a[168:171], a[144:147], v[228:231]
  v_mfma_f32_16x16x32_bf16 v[228:231], a[172:175], a[20:23], v[228:231]
  buffer_load_dwordx2 v[104:105], v10, s[36:39], s53 offen
  v_mfma_f32_16x16x32_bf16 v[228:231], a[176:179], a[52:55], v[228:231]
  v_mfma_f32_16x16x32_bf16 v[228:231], a[180:183], a[84:87], v[228:231]
  ds_read_b128 a[212:215], v46 offset:1024
  ds_read_b128 a[220:223], v46 offset:10240
  v_mfma_f32_16x16x32_bf16 v[224:227], a[180:183], a[80:83], v[224:227]
  ds_read_b128 a[128:131], v46 offset:19456
  ds_read_b128 a[136:139], v46 offset:28672
  v_mfma_f32_16x16x32_bf16 v[224:227], a[176:179], a[48:51], v[224:227]
  v_mfma_f32_16x16x32_bf16 v[224:227], a[172:175], a[16:19], v[224:227]
  buffer_load_dwordx2 v[106:107], v11, s[36:39], s53 offen
  v_mfma_f32_16x16x32_bf16 v[224:227], a[168:171], a[216:219], v[224:227]
  s_waitcnt lgkmcnt(4)
  v_mfma_f32_16x16x32_bf16 v[212:215], a[184:187], a[144:147], v[212:215]
  v_mfma_f32_16x16x32_bf16 v[212:215], a[188:191], a[20:23], v[212:215]
  v_mfma_f32_16x16x32_bf16 v[212:215], a[196:199], a[52:55], v[212:215]
  v_mfma_f32_16x16x32_bf16 v[212:215], a[204:207], a[84:87], v[212:215]
  v_mfma_f32_16x16x32_bf16 v[216:219], a[204:207], a[88:91], v[216:219]
  v_mfma_f32_16x16x32_bf16 v[216:219], a[196:199], a[56:59], v[216:219]
  s_waitcnt vmcnt(22) lgkmcnt(0)
  s_barrier
  v_mfma_f32_16x16x32_bf16 v[216:219], a[188:191], a[24:27], v[216:219]
  v_mfma_f32_16x16x32_bf16 v[216:219], a[184:187], a[132:135], v[216:219]
  ds_read_b128 a[112:115], v47 offset:8192
  ds_read_b128 a[116:119], v47 offset:17408
  v_mfma_f32_16x16x32_bf16 v[220:223], a[184:187], a[140:143], v[220:223]
  ds_read_b128 a[120:123], v47 offset:26624
  ds_read_b128 a[124:127], v47 offset:35840
  v_mfma_f32_16x16x32_bf16 v[220:223], a[188:191], a[28:31], v[220:223]
  v_mfma_f32_16x16x32_bf16 v[220:223], a[196:199], a[60:63], v[220:223]
  v_mfma_f32_16x16x32_bf16 v[220:223], a[204:207], a[92:95], v[220:223]
  v_mfma_f32_16x16x32_bf16 v[204:207], a[212:215], a[140:143], v[204:207]
  v_mfma_f32_16x16x32_bf16 v[204:207], a[220:223], a[28:31], v[204:207]
  v_mfma_f32_16x16x32_bf16 v[204:207], a[128:131], a[60:63], v[204:207]
  v_mfma_f32_16x16x32_bf16 v[204:207], a[136:139], a[92:95], v[204:207]
  v_mfma_f32_16x16x32_bf16 v[200:203], a[136:139], a[88:91], v[200:203]
  v_mfma_f32_16x16x32_bf16 v[200:203], a[128:131], a[56:59], v[200:203]
  v_mfma_f32_16x16x32_bf16 v[200:203], a[220:223], a[24:27], v[200:203]
  v_mfma_f32_16x16x32_bf16 v[200:203], a[212:215], a[132:135], v[200:203]
  v_mfma_f32_16x16x32_bf16 v[196:199], a[212:215], a[144:147], v[196:199]
  v_mfma_f32_16x16x32_bf16 v[196:199], a[220:223], a[20:23], v[196:199]
  v_mfma_f32_16x16x32_bf16 v[196:199], a[128:131], a[52:55], v[196:199]
  v_mfma_f32_16x16x32_bf16 v[196:199], a[136:139], a[84:87], v[196:199]
  s_waitcnt vmcnt(21) lgkmcnt(0)
  ds_read_b128 a[168:171], v46 offset:4096
  ds_read_b128 a[172:175], v46 offset:13312
  v_mfma_f32_16x16x32_bf16 v[240:243], a[112:115], a[0:3], v[240:243]
  s_waitcnt vmcnt(17)
  ds_read_b128 a[176:179], v46 offset:22528
  ds_read_b128 a[180:183], v46 offset:31744
  v_mfma_f32_16x16x32_bf16 v[240:243], a[116:119], a[32:35], v[240:243]
  s_waitcnt vmcnt(12)
  v_mfma_f32_16x16x32_bf16 v[240:243], a[120:123], a[64:67], v[240:243]
  s_waitcnt vmcnt(8)
  v_mfma_f32_16x16x32_bf16 v[240:243], a[124:127], a[96:99], v[240:243]
  s_waitcnt vmcnt(7)
  v_mfma_f32_16x16x32_bf16 v[244:247], a[124:127], a[100:103], v[244:247]
  v_mfma_f32_16x16x32_bf16 v[244:247], a[120:123], a[68:71], v[244:247]
  v_mfma_f32_16x16x32_bf16 v[244:247], a[116:119], a[36:39], v[244:247]
  v_mfma_f32_16x16x32_bf16 v[244:247], a[112:115], a[4:7], v[244:247]
  v_mfma_f32_16x16x32_bf16 v[248:251], a[112:115], a[8:11], v[248:251]
  s_nop 1
  v_cvt_pk_bf16_f32 v240, v240, v241
  v_mfma_f32_16x16x32_bf16 v[248:251], a[116:119], a[40:43], v[248:251]
  v_cvt_pk_bf16_f32 v241, v242, v243
  v_mfma_f32_16x16x32_bf16 v[248:251], a[120:123], a[72:75], v[248:251]
  s_waitcnt vmcnt(6)
  v_mfma_f32_16x16x32_bf16 v[248:251], a[124:127], a[104:107], v[248:251]
  s_waitcnt vmcnt(5)
  v_mfma_f32_16x16x32_bf16 v[252:255], a[124:127], a[108:111], v[252:255]
  v_cvt_pk_bf16_f32 v244, v244, v245
  v_mfma_f32_16x16x32_bf16 v[252:255], a[120:123], a[76:79], v[252:255]
  v_cvt_pk_bf16_f32 v245, v246, v247
  v_mfma_f32_16x16x32_bf16 v[252:255], a[116:119], a[44:47], v[252:255]
  v_mfma_f32_16x16x32_bf16 v[252:255], a[112:115], a[12:15], v[252:255]
  s_waitcnt lgkmcnt(0)
  ds_read_b128 a[184:187], v47 offset:7168
  ds_read_b128 a[188:191], v47 offset:16384
  v_mfma_f32_16x16x32_bf16 v[188:191], a[168:171], a[140:143], v[188:191]
  ds_read_b128 a[196:199], v47 offset:25600
  ds_read_b128 a[204:207], v47 offset:34816
  v_mfma_f32_16x16x32_bf16 v[188:191], a[172:175], a[28:31], v[188:191]
  v_cvt_pk_bf16_f32 v248, v248, v249
  v_mfma_f32_16x16x32_bf16 v[188:191], a[176:179], a[60:63], v[188:191]
  v_cvt_pk_bf16_f32 v249, v250, v251
  v_mfma_f32_16x16x32_bf16 v[188:191], a[180:183], a[92:95], v[188:191]
  v_mfma_f32_16x16x32_bf16 v[184:187], a[180:183], a[88:91], v[184:187]
  v_cvt_pk_bf16_f32 v252, v252, v253
  v_mfma_f32_16x16x32_bf16 v[184:187], a[176:179], a[56:59], v[184:187]
  v_cvt_pk_bf16_f32 v253, v254, v255
  v_mfma_f32_16x16x32_bf16 v[184:187], a[172:175], a[24:27], v[184:187]
  v_mfma_f32_16x16x32_bf16 v[184:187], a[168:171], a[132:135], v[184:187]
  v_mfma_f32_16x16x32_bf16 v[180:183], a[168:171], a[144:147], v[180:183]
  v_mfma_f32_16x16x32_bf16 v[180:183], a[172:175], a[20:23], v[180:183]
  v_mfma_f32_16x16x32_bf16 v[180:183], a[176:179], a[52:55], v[180:183]
  v_mfma_f32_16x16x32_bf16 v[180:183], a[180:183], a[84:87], v[180:183]
  v_mfma_f32_16x16x32_bf16 v[176:179], a[180:183], a[80:83], v[176:179]
  v_mfma_f32_16x16x32_bf16 v[176:179], a[176:179], a[48:51], v[176:179]
  v_mfma_f32_16x16x32_bf16 v[176:179], a[172:175], a[16:19], v[176:179]
  v_mfma_f32_16x16x32_bf16 v[176:179], a[168:171], a[216:219], v[176:179]
  s_waitcnt lgkmcnt(0)
  ds_read_b128 a[212:215], v46 offset:6144
  ds_read_b128 a[220:223], v46 offset:15360
  v_mfma_f32_16x16x32_bf16 v[224:227], a[184:187], a[0:3], v[224:227]
  ds_read_b128 a[128:131], v46 offset:24576
  ds_read_b128 a[136:139], v46 offset:33792
  v_mfma_f32_16x16x32_bf16 v[224:227], a[188:191], a[32:35], v[224:227]
  v_mfma_f32_16x16x32_bf16 v[224:227], a[196:199], a[64:67], v[224:227]
  v_mfma_f32_16x16x32_bf16 v[224:227], a[204:207], a[96:99], v[224:227]
  v_mfma_f32_16x16x32_bf16 v[228:231], a[204:207], a[100:103], v[228:231]
  v_mfma_f32_16x16x32_bf16 v[228:231], a[196:199], a[68:71], v[228:231]
  v_mfma_f32_16x16x32_bf16 v[228:231], a[188:191], a[36:39], v[228:231]
  v_mfma_f32_16x16x32_bf16 v[228:231], a[184:187], a[4:7], v[228:231]
  v_mfma_f32_16x16x32_bf16 v[232:235], a[184:187], a[8:11], v[232:235]
  s_nop 2
  v_cvt_pk_bf16_f32 v242, v224, v225
  v_cvt_pk_bf16_f32 v243, v226, v227
  v_mfma_f32_16x16x32_bf16 v[232:235], a[188:191], a[40:43], v[232:235]
  buffer_store_dwordx4 v[240:243], v50, s[4:7], s94 offen offset:0 sc1
  v_mfma_f32_16x16x32_bf16 v[232:235], a[196:199], a[72:75], v[232:235]
  v_mfma_f32_16x16x32_bf16 v[232:235], a[204:207], a[104:107], v[232:235]
  v_mfma_f32_16x16x32_bf16 v[236:239], a[204:207], a[108:111], v[236:239]
  v_cvt_pk_bf16_f32 v246, v228, v229
  v_cvt_pk_bf16_f32 v247, v230, v231
  v_mfma_f32_16x16x32_bf16 v[236:239], a[196:199], a[76:79], v[236:239]
  buffer_store_dwordx4 v[244:247], v50, s[4:7], s96 offen offset:0 sc1
  v_mfma_f32_16x16x32_bf16 v[236:239], a[188:191], a[44:47], v[236:239]
  v_mfma_f32_16x16x32_bf16 v[236:239], a[184:187], a[12:15], v[236:239]
  s_waitcnt lgkmcnt(0)
  ds_read_b128 a[112:115], v47 offset:0
  ds_read_b128 a[116:119], v47 offset:9216
  v_mfma_f32_16x16x32_bf16 v[172:175], a[212:215], a[140:143], v[172:175]
  ds_read_b128 a[120:123], v47 offset:18432
  ds_read_b128 a[124:127], v47 offset:27648
  v_mfma_f32_16x16x32_bf16 v[172:175], a[220:223], a[28:31], v[172:175]
  v_cvt_pk_bf16_f32 v250, v232, v233
  v_cvt_pk_bf16_f32 v251, v234, v235
  v_mfma_f32_16x16x32_bf16 v[172:175], a[128:131], a[60:63], v[172:175]
  buffer_store_dwordx4 v[248:251], v50, s[4:7], s66 offen offset:0 sc1
  v_mfma_f32_16x16x32_bf16 v[172:175], a[136:139], a[92:95], v[172:175]
  v_mfma_f32_16x16x32_bf16 v[168:171], a[136:139], a[88:91], v[168:171]
  v_cvt_pk_bf16_f32 v254, v236, v237
  v_cvt_pk_bf16_f32 v255, v238, v239
  v_mfma_f32_16x16x32_bf16 v[168:171], a[128:131], a[56:59], v[168:171]
  v_mfma_f32_16x16x32_bf16 v[168:171], a[220:223], a[24:27], v[168:171]
  buffer_store_dwordx4 v[252:255], v50, s[4:7], s98 offen offset:0 sc1
  v_mfma_f32_16x16x32_bf16 v[168:171], a[212:215], a[132:135], v[168:171]
  v_mfma_f32_16x16x32_bf16 v[164:167], a[212:215], a[144:147], v[164:167]
  v_mfma_f32_16x16x32_bf16 v[164:167], a[220:223], a[20:23], v[164:167]
  v_mfma_f32_16x16x32_bf16 v[164:167], a[128:131], a[52:55], v[164:167]
  v_mfma_f32_16x16x32_bf16 v[164:167], a[136:139], a[84:87], v[164:167]
  ds_read_b128 a[168:171], v46 offset:5120
  ds_read_b128 a[172:175], v46 offset:14336
  v_mfma_f32_16x16x32_bf16 v[160:163], a[136:139], a[80:83], v[160:163]
  ds_read_b128 a[176:179], v46 offset:23552
  ds_read_b128 a[180:183], v46 offset:32768
  v_mfma_f32_16x16x32_bf16 v[160:163], a[128:131], a[48:51], v[160:163]
  v_mfma_f32_16x16x32_bf16 v[160:163], a[220:223], a[16:19], v[160:163]
  v_mfma_f32_16x16x32_bf16 v[160:163], a[212:215], a[216:219], v[160:163]
  s_waitcnt lgkmcnt(4)
  v_mfma_f32_16x16x32_bf16 v[212:215], a[112:115], a[4:7], v[212:215]
  v_mfma_f32_16x16x32_bf16 v[212:215], a[116:119], a[36:39], v[212:215]
  v_mfma_f32_16x16x32_bf16 v[212:215], a[120:123], a[68:71], v[212:215]
  v_mfma_f32_16x16x32_bf16 v[212:215], a[124:127], a[100:103], v[212:215]
  v_mfma_f32_16x16x32_bf16 v[216:219], a[124:127], a[104:107], v[216:219]
  v_mfma_f32_16x16x32_bf16 v[216:219], a[120:123], a[72:75], v[216:219]
  v_mfma_f32_16x16x32_bf16 v[216:219], a[116:119], a[40:43], v[216:219]
  v_mfma_f32_16x16x32_bf16 v[216:219], a[112:115], a[8:11], v[216:219]
  v_mfma_f32_16x16x32_bf16 v[220:223], a[112:115], a[12:15], v[220:223]
  s_nop 2
  v_cvt_pk_bf16_f32 v212, v212, v213
  v_mfma_f32_16x16x32_bf16 v[220:223], a[116:119], a[44:47], v[220:223]
  v_cvt_pk_bf16_f32 v213, v214, v215
  v_mfma_f32_16x16x32_bf16 v[220:223], a[120:123], a[76:79], v[220:223]
  v_mfma_f32_16x16x32_bf16 v[220:223], a[124:127], a[108:111], v[220:223]
  s_waitcnt lgkmcnt(0)
  ds_read_b128 a[184:187], v47 offset:1024
  ds_read_b128 a[188:191], v47 offset:10240
  v_mfma_f32_16x16x32_bf16 v[156:159], a[168:171], a[140:143], v[156:159]
  ds_read_b128 a[196:199], v47 offset:19456
  ds_read_b128 a[204:207], v47 offset:28672
  v_mfma_f32_16x16x32_bf16 v[156:159], a[172:175], a[28:31], v[156:159]
  v_cvt_pk_bf16_f32 v216, v216, v217
  v_mfma_f32_16x16x32_bf16 v[156:159], a[176:179], a[60:63], v[156:159]
  v_cvt_pk_bf16_f32 v217, v218, v219
  v_mfma_f32_16x16x32_bf16 v[156:159], a[180:183], a[92:95], v[156:159]
  v_mfma_f32_16x16x32_bf16 v[152:155], a[180:183], a[88:91], v[152:155]
  v_cvt_pk_bf16_f32 v220, v220, v221
  v_mfma_f32_16x16x32_bf16 v[152:155], a[176:179], a[56:59], v[152:155]
  v_cvt_pk_bf16_f32 v221, v222, v223
  v_mfma_f32_16x16x32_bf16 v[152:155], a[172:175], a[24:27], v[152:155]
  v_mfma_f32_16x16x32_bf16 v[152:155], a[168:171], a[132:135], v[152:155]
  v_mfma_f32_16x16x32_bf16 v[148:151], a[168:171], a[144:147], v[148:151]
  v_mfma_f32_16x16x32_bf16 v[148:151], a[172:175], a[20:23], v[148:151]
  v_mfma_f32_16x16x32_bf16 v[148:151], a[176:179], a[52:55], v[148:151]
  v_mfma_f32_16x16x32_bf16 v[148:151], a[180:183], a[84:87], v[148:151]
  ds_read_b128 a[212:215], v46 offset:2048
  ds_read_b128 a[220:223], v46 offset:11264
  v_mfma_f32_16x16x32_bf16 v[144:147], a[180:183], a[80:83], v[144:147]
  ds_read_b128 a[128:131], v46 offset:20480
  ds_read_b128 a[136:139], v46 offset:29696
  v_mfma_f32_16x16x32_bf16 v[144:147], a[176:179], a[48:51], v[144:147]
  v_mfma_f32_16x16x32_bf16 v[144:147], a[172:175], a[16:19], v[144:147]
  v_mfma_f32_16x16x32_bf16 v[144:147], a[168:171], a[216:219], v[144:147]
  s_waitcnt lgkmcnt(4)
  v_mfma_f32_16x16x32_bf16 v[196:199], a[184:187], a[4:7], v[196:199]
  v_mfma_f32_16x16x32_bf16 v[196:199], a[188:191], a[36:39], v[196:199]
  v_mfma_f32_16x16x32_bf16 v[196:199], a[196:199], a[68:71], v[196:199]
  v_mfma_f32_16x16x32_bf16 v[196:199], a[204:207], a[100:103], v[196:199]
  v_mfma_f32_16x16x32_bf16 v[200:203], a[204:207], a[104:107], v[200:203]
  v_mfma_f32_16x16x32_bf16 v[200:203], a[196:199], a[72:75], v[200:203]
  v_mfma_f32_16x16x32_bf16 v[200:203], a[188:191], a[40:43], v[200:203]
  v_mfma_f32_16x16x32_bf16 v[200:203], a[184:187], a[8:11], v[200:203]
  ds_read_b128 a[112:115], v47 offset:4096
  ds_read_b128 a[116:119], v47 offset:13312
  v_mfma_f32_16x16x32_bf16 v[204:207], a[184:187], a[12:15], v[204:207]
  ds_read_b128 a[120:123], v47 offset:22528
  ds_read_b128 a[124:127], v47 offset:31744
  v_mfma_f32_16x16x32_bf16 v[204:207], a[188:191], a[44:47], v[204:207]
  v_cvt_pk_bf16_f32 v214, v196, v197
  v_cvt_pk_bf16_f32 v215, v198, v199
  v_mfma_f32_16x16x32_bf16 v[204:207], a[196:199], a[76:79], v[204:207]
  buffer_store_dwordx4 v[212:215], v50, s[4:7], s95 offen offset:0 sc1
  v_mfma_f32_16x16x32_bf16 v[204:207], a[204:207], a[108:111], v[204:207]
  s_waitcnt lgkmcnt(4)
  v_mfma_f32_16x16x32_bf16 v[140:143], a[212:215], a[140:143], v[140:143]
  v_cvt_pk_bf16_f32 v218, v200, v201
  v_cvt_pk_bf16_f32 v219, v202, v203
  v_mfma_f32_16x16x32_bf16 v[140:143], a[220:223], a[28:31], v[140:143]
  v_mfma_f32_16x16x32_bf16 v[140:143], a[128:131], a[60:63], v[140:143]
  buffer_store_dwordx4 v[216:219], v50, s[4:7], s65 offen offset:0 sc1
  v_mfma_f32_16x16x32_bf16 v[140:143], a[136:139], a[92:95], v[140:143]
  v_mfma_f32_16x16x32_bf16 v[136:139], a[136:139], a[88:91], v[136:139]
  v_cvt_pk_bf16_f32 v222, v204, v205
  v_cvt_pk_bf16_f32 v223, v206, v207
  v_mfma_f32_16x16x32_bf16 v[136:139], a[128:131], a[56:59], v[136:139]
  v_mfma_f32_16x16x32_bf16 v[136:139], a[220:223], a[24:27], v[136:139]
  buffer_store_dwordx4 v[220:223], v50, s[4:7], s97 offen offset:0 sc1
  v_mfma_f32_16x16x32_bf16 v[136:139], a[212:215], a[132:135], v[136:139]
  v_mfma_f32_16x16x32_bf16 v[132:135], a[212:215], a[144:147], v[132:135]
  v_mfma_f32_16x16x32_bf16 v[132:135], a[220:223], a[20:23], v[132:135]
  v_mfma_f32_16x16x32_bf16 v[132:135], a[128:131], a[52:55], v[132:135]
  v_mfma_f32_16x16x32_bf16 v[132:135], a[136:139], a[84:87], v[132:135]
  s_waitcnt lgkmcnt(0)
  ds_read_b128 a[168:171], v46 offset:3072
  ds_read_b128 a[172:175], v46 offset:12288
  v_mfma_f32_16x16x32_bf16 v[176:179], a[112:115], a[0:3], v[176:179]
  ds_read_b128 a[176:179], v46 offset:21504
  ds_read_b128 a[180:183], v46 offset:30720
  v_mfma_f32_16x16x32_bf16 v[176:179], a[116:119], a[32:35], v[176:179]
  v_mfma_f32_16x16x32_bf16 v[176:179], a[120:123], a[64:67], v[176:179]
  v_mfma_f32_16x16x32_bf16 v[176:179], a[124:127], a[96:99], v[176:179]
  v_mfma_f32_16x16x32_bf16 v[180:183], a[124:127], a[100:103], v[180:183]
  v_mfma_f32_16x16x32_bf16 v[180:183], a[120:123], a[68:71], v[180:183]
  v_mfma_f32_16x16x32_bf16 v[180:183], a[116:119], a[36:39], v[180:183]
  v_mfma_f32_16x16x32_bf16 v[180:183], a[112:115], a[4:7], v[180:183]
  v_mfma_f32_16x16x32_bf16 v[184:187], a[112:115], a[8:11], v[184:187]
  s_nop 2
  v_cvt_pk_bf16_f32 v108, v176, v177
  v_cvt_pk_bf16_f32 v109, v178, v179
  v_mfma_f32_16x16x32_bf16 v[184:187], a[116:119], a[40:43], v[184:187]
  buffer_store_dwordx2 v[108:109], v33, s[4:7], s94 offen offset:2048 sc1
  v_mfma_f32_16x16x32_bf16 v[184:187], a[120:123], a[72:75], v[184:187]
  v_mfma_f32_16x16x32_bf16 v[184:187], a[124:127], a[104:107], v[184:187]
  ds_read_b128 a[184:187], v47 offset:6144
  ds_read_b128 a[188:191], v47 offset:15360
  v_mfma_f32_16x16x32_bf16 v[188:191], a[124:127], a[108:111], v[188:191]
  ds_read_b128 a[196:199], v47 offset:24576
  ds_read_b128 a[204:207], v47 offset:33792
  v_mfma_f32_16x16x32_bf16 v[188:191], a[120:123], a[76:79], v[188:191]
  v_cvt_pk_bf16_f32 v180, v180, v181
  v_mfma_f32_16x16x32_bf16 v[188:191], a[116:119], a[44:47], v[188:191]
  v_cvt_pk_bf16_f32 v181, v182, v183
  v_mfma_f32_16x16x32_bf16 v[188:191], a[112:115], a[12:15], v[188:191]
  s_waitcnt lgkmcnt(4)
  buffer_store_dwordx2 v[180:181], v33, s[4:7], s96 offen offset:2048 sc1
  v_mfma_f32_16x16x32_bf16 v[124:127], a[168:171], a[140:143], v[124:127]
  v_cvt_pk_bf16_f32 v184, v184, v185
  v_mfma_f32_16x16x32_bf16 v[124:127], a[172:175], a[28:31], v[124:127]
  v_cvt_pk_bf16_f32 v185, v186, v187
  v_mfma_f32_16x16x32_bf16 v[124:127], a[176:179], a[60:63], v[124:127]
  v_mfma_f32_16x16x32_bf16 v[124:127], a[180:183], a[92:95], v[124:127]
  buffer_store_dwordx2 v[180:181], v32, s[4:7], s95 offen offset:2048 sc1
  v_mfma_f32_16x16x32_bf16 v[120:123], a[180:183], a[88:91], v[120:123]
  v_cvt_pk_bf16_f32 v188, v188, v189
  v_mfma_f32_16x16x32_bf16 v[120:123], a[176:179], a[56:59], v[120:123]
  v_cvt_pk_bf16_f32 v189, v190, v191
  v_mfma_f32_16x16x32_bf16 v[120:123], a[172:175], a[24:27], v[120:123]
  v_mfma_f32_16x16x32_bf16 v[120:123], a[168:171], a[132:135], v[120:123]
  buffer_store_dwordx2 v[184:185], v33, s[4:7], s66 offen offset:2048 sc1
  v_mfma_f32_16x16x32_bf16 v[116:119], a[168:171], a[144:147], v[116:119]
  v_mfma_f32_16x16x32_bf16 v[116:119], a[172:175], a[20:23], v[116:119]
  v_mfma_f32_16x16x32_bf16 v[116:119], a[176:179], a[52:55], v[116:119]
  v_mfma_f32_16x16x32_bf16 v[116:119], a[180:183], a[84:87], v[116:119]
  s_waitcnt lgkmcnt(0)
  buffer_store_dwordx2 v[184:185], v32, s[4:7], s65 offen offset:2048 sc1
  v_mfma_f32_16x16x32_bf16 v[160:163], a[184:187], a[0:3], v[160:163]
  ds_read_b128 a[212:215], v47 offset:5120
  ds_read_b128 a[220:223], v47 offset:14336
  v_mfma_f32_16x16x32_bf16 v[160:163], a[188:191], a[32:35], v[160:163]
  ds_read_b128 a[128:131], v47 offset:23552
  ds_read_b128 a[136:139], v47 offset:32768
  v_mfma_f32_16x16x32_bf16 v[160:163], a[196:199], a[64:67], v[160:163]
  v_mfma_f32_16x16x32_bf16 v[160:163], a[204:207], a[96:99], v[160:163]
  buffer_store_dwordx2 v[188:189], v33, s[4:7], s98 offen offset:2048 sc1
  v_mfma_f32_16x16x32_bf16 v[164:167], a[204:207], a[100:103], v[164:167]
  v_mfma_f32_16x16x32_bf16 v[164:167], a[196:199], a[68:71], v[164:167]
  v_mfma_f32_16x16x32_bf16 v[164:167], a[188:191], a[36:39], v[164:167]
  v_mfma_f32_16x16x32_bf16 v[164:167], a[184:187], a[4:7], v[164:167]
  buffer_store_dwordx2 v[188:189], v32, s[4:7], s97 offen offset:2048 sc1
  v_mfma_f32_16x16x32_bf16 v[168:171], a[184:187], a[8:11], v[168:171]
  s_nop 0
  v_cvt_pk_bf16_f32 v160, v160, v161
  v_mfma_f32_16x16x32_bf16 v[168:171], a[188:191], a[40:43], v[168:171]
  v_cvt_pk_bf16_f32 v161, v162, v163
  v_mfma_f32_16x16x32_bf16 v[168:171], a[196:199], a[72:75], v[168:171]
  v_mfma_f32_16x16x32_bf16 v[168:171], a[204:207], a[104:107], v[168:171]
  v_mfma_f32_16x16x32_bf16 v[172:175], a[204:207], a[108:111], v[172:175]
  v_cvt_pk_bf16_f32 v164, v164, v165
  v_mfma_f32_16x16x32_bf16 v[172:175], a[196:199], a[76:79], v[172:175]
  v_cvt_pk_bf16_f32 v165, v166, v167
  v_mfma_f32_16x16x32_bf16 v[172:175], a[188:191], a[44:47], v[172:175]
  v_mfma_f32_16x16x32_bf16 v[172:175], a[184:187], a[12:15], v[172:175]
  s_waitcnt lgkmcnt(0)
  ds_read_b128 a[112:115], v47 offset:2048
  ds_read_b128 a[116:119], v47 offset:11264
  v_mfma_f32_16x16x32_bf16 v[156:159], a[212:215], a[12:15], v[156:159]
  ds_read_b128 a[120:123], v47 offset:20480
  ds_read_b128 a[124:127], v47 offset:29696
  v_mfma_f32_16x16x32_bf16 v[156:159], a[220:223], a[44:47], v[156:159]
  v_cvt_pk_bf16_f32 v168, v168, v169
  s_waitcnt vmcnt(18)
  v_lshlrev_b32 v240, 16, v98
  v_mfma_f32_16x16x32_bf16 v[156:159], a[128:131], a[76:79], v[156:159]
  v_cvt_pk_bf16_f32 v169, v170, v171
  v_and_b32 v241, 0xffff0000, v98
  v_mfma_f32_16x16x32_bf16 v[156:159], a[136:139], a[108:111], v[156:159]
  v_lshlrev_b32 v242, 16, v99
  v_and_b32 v243, 0xffff0000, v99
  v_mfma_f32_16x16x32_bf16 v[152:155], a[136:139], a[104:107], v[152:155]
  v_cvt_pk_bf16_f32 v172, v172, v173
  s_waitcnt vmcnt(17)
  v_lshlrev_b32 v244, 16, v100
  v_mfma_f32_16x16x32_bf16 v[152:155], a[128:131], a[72:75], v[152:155]
  v_cvt_pk_bf16_f32 v173, v174, v175
  v_and_b32 v245, 0xffff0000, v100
  v_mfma_f32_16x16x32_bf16 v[152:155], a[220:223], a[40:43], v[152:155]
  buffer_load_dword v59, v13, s[4:7], s48 offen sc1
  v_mfma_f32_16x16x32_bf16 v[152:155], a[212:215], a[8:11], v[152:155]
  v_lshlrev_b32 v246, 16, v101
  v_and_b32 v247, 0xffff0000, v101
  v_mfma_f32_16x16x32_bf16 v[148:151], a[212:215], a[4:7], v[148:151]
  v_cvt_pk_bf16_f32 v174, v156, v157
  v_cvt_pk_bf16_f32 v175, v158, v159
  v_mfma_f32_16x16x32_bf16 v[148:151], a[220:223], a[36:39], v[148:151]
  buffer_store_dwordx4 v[172:175], v50, s[4:7], s98 offen offset:1024 sc1
  v_mfma_f32_16x16x32_bf16 v[148:151], a[128:131], a[68:71], v[148:151]
  s_waitcnt vmcnt(18)
  v_lshlrev_b32 v248, 16, v102
  v_and_b32 v249, 0xffff0000, v102
  v_mfma_f32_16x16x32_bf16 v[148:151], a[136:139], a[100:103], v[148:151]
  ds_read_b128 a[168:171], v47 offset:3072
  ds_read_b128 a[172:175], v47 offset:12288
  v_mfma_f32_16x16x32_bf16 v[144:147], a[136:139], a[96:99], v[144:147]
  ds_read_b128 a[176:179], v47 offset:21504
  ds_read_b128 a[180:183], v47 offset:30720
  v_mfma_f32_16x16x32_bf16 v[144:147], a[128:131], a[64:67], v[144:147]
  v_cvt_pk_bf16_f32 v170, v152, v153
  v_cvt_pk_bf16_f32 v171, v154, v155
  v_mfma_f32_16x16x32_bf16 v[144:147], a[220:223], a[32:35], v[144:147]
  buffer_store_dwordx4 v[168:171], v50, s[4:7], s66 offen offset:1024 sc1
  v_mfma_f32_16x16x32_bf16 v[144:147], a[212:215], a[0:3], v[144:147]
  s_waitcnt lgkmcnt(4)
  v_lshlrev_b32 v250, 16, v103
  v_and_b32 v251, 0xffff0000, v103
  v_mfma_f32_16x16x32_bf16 v[132:135], a[112:115], a[4:7], v[132:135]
  v_cvt_pk_bf16_f32 v166, v148, v149
  v_cvt_pk_bf16_f32 v167, v150, v151
  v_mfma_f32_16x16x32_bf16 v[132:135], a[116:119], a[36:39], v[132:135]
  s_waitcnt vmcnt(18)
  v_lshlrev_b32 v252, 16, v104
  v_and_b32 v253, 0xffff0000, v104
  v_mfma_f32_16x16x32_bf16 v[132:135], a[120:123], a[68:71], v[132:135]
  buffer_store_dwordx4 v[164:167], v50, s[4:7], s96 offen offset:1024 sc1
  v_mfma_f32_16x16x32_bf16 v[132:135], a[124:127], a[100:103], v[132:135]
  v_lshlrev_b32 v254, 16, v105
  v_and_b32 v255, 0xffff0000, v105
  v_mfma_f32_16x16x32_bf16 v[136:139], a[124:127], a[104:107], v[136:139]
  v_cvt_pk_bf16_f32 v162, v144, v145
  v_cvt_pk_bf16_f32 v163, v146, v147
  v_mfma_f32_16x16x32_bf16 v[136:139], a[120:123], a[72:75], v[136:139]
  s_waitcnt vmcnt(18)
  v_lshlrev_b32 v180, 16, v106
  v_and_b32 v181, 0xffff0000, v106
  v_mfma_f32_16x16x32_bf16 v[136:139], a[116:119], a[40:43], v[136:139]
  buffer_store_dwordx4 v[160:163], v50, s[4:7], s94 offen offset:1024 sc1
  v_mfma_f32_16x16x32_bf16 v[136:139], a[112:115], a[8:11], v[136:139]
  ds_read_b128 a[184:187], v46 offset:0
  ds_read_b128 a[188:191], v46 offset:9216
  v_mfma_f32_16x16x32_bf16 v[140:143], a[112:115], a[12:15], v[140:143]
  ds_read_b128 a[196:199], v46 offset:18432
  ds_read_b128 a[204:207], v46 offset:27648
  v_mfma_f32_16x16x32_bf16 v[140:143], a[116:119], a[44:47], v[140:143]
  v_cvt_pk_bf16_f32 v132, v132, v133
  v_lshlrev_b32 v182, 16, v107
  v_mfma_f32_16x16x32_bf16 v[140:143], a[120:123], a[76:79], v[140:143]
  v_cvt_pk_bf16_f32 v133, v134, v135
  v_and_b32 v183, 0xffff0000, v107
  v_mfma_f32_16x16x32_bf16 v[140:143], a[124:127], a[108:111], v[140:143]
  s_waitcnt lgkmcnt(4)
  ds_read_b128 a[212:215], v47 offset:0
  ds_read_b128 a[220:223], v47 offset:9216
  v_mfma_f32_16x16x32_bf16 v[124:127], a[168:171], a[12:15], v[124:127]
  ds_read_b128 a[128:131], v47 offset:18432
  ds_read_b128 a[136:139], v47 offset:27648
  v_mfma_f32_16x16x32_bf16 v[124:127], a[172:175], a[44:47], v[124:127]
  v_cvt_pk_bf16_f32 v136, v136, v137
  v_mfma_f32_16x16x32_bf16 v[124:127], a[176:179], a[76:79], v[124:127]
  v_cvt_pk_bf16_f32 v137, v138, v139
  v_mfma_f32_16x16x32_bf16 v[124:127], a[180:183], a[108:111], v[124:127]
  ds_read_b128 a[112:115], v46 offset:1024
  ds_read_b128 a[116:119], v46 offset:10240
  v_mfma_f32_16x16x32_bf16 v[120:123], a[180:183], a[104:107], v[120:123]
  ds_read_b128 a[120:123], v46 offset:19456
  ds_read_b128 a[124:127], v46 offset:28672
  v_mfma_f32_16x16x32_bf16 v[120:123], a[176:179], a[72:75], v[120:123]
  v_cvt_pk_bf16_f32 v140, v140, v141
  v_mfma_f32_16x16x32_bf16 v[120:123], a[172:175], a[40:43], v[120:123]
  v_cvt_pk_bf16_f32 v141, v142, v143
  v_mfma_f32_16x16x32_bf16 v[120:123], a[168:171], a[8:11], v[120:123]
  v_mfma_f32_16x16x32_bf16 v[116:119], a[168:171], a[4:7], v[116:119]
  v_cvt_pk_bf16_f32 v142, v124, v125
  v_cvt_pk_bf16_f32 v143, v126, v127
  v_mfma_f32_16x16x32_bf16 v[116:119], a[172:175], a[36:39], v[116:119]
  buffer_store_dwordx4 v[140:143], v50, s[4:7], s97 offen offset:1024 sc1
  v_mfma_f32_16x16x32_bf16 v[116:119], a[176:179], a[68:71], v[116:119]
  v_mfma_f32_16x16x32_bf16 v[116:119], a[180:183], a[100:103], v[116:119]
  s_waitcnt lgkmcnt(8)
  ds_read_b128 a[168:171], v47 offset:1024
  ds_read_b128 a[172:175], v47 offset:10240
  v_mfma_f32_16x16x32_bf16 v[208:211], a[184:187], a[216:219], v[208:211]
pad_p3_end6_1:
  s_cbranch_execz warm_P
  ds_read_b128 a[176:179], v47 offset:19456
  ds_read_b128 a[180:183], v47 offset:28672
  v_mfma_f32_16x16x32_bf16 v[208:211], a[188:191], a[16:19], v[208:211]
  v_cvt_pk_bf16_f32 v138, v120, v121
  v_cvt_pk_bf16_f32 v139, v122, v123
  v_mfma_f32_16x16x32_bf16 v[208:211], a[196:199], a[48:51], v[208:211]
  buffer_store_dwordx4 v[136:139], v50, s[4:7], s65 offen offset:1024 sc1
  v_mfma_f32_16x16x32_bf16 v[208:211], a[204:207], a[80:83], v[208:211]
  s_waitcnt lgkmcnt(8)
  ds_read_b128 a[184:187], v46 offset:2048
  ds_read_b128 a[188:191], v46 offset:11264
  v_mfma_f32_16x16x32_bf16 v[208:211], a[212:215], a[0:3], v[208:211]
  s_add_u32 s94, s50, 0
  ds_read_b128 a[196:199], v46 offset:20480
  ds_read_b128 a[204:207], v46 offset:29696
  v_mfma_f32_16x16x32_bf16 v[208:211], a[220:223], a[32:35], v[208:211]
  s_add_u32 s96, s50, 5120
  v_cvt_pk_bf16_f32 v134, v116, v117
  v_cvt_pk_bf16_f32 v135, v118, v119
  v_mfma_f32_16x16x32_bf16 v[208:211], a[128:131], a[64:67], v[208:211]
  buffer_store_dwordx4 v[132:135], v50, s[4:7], s95 offen offset:1024 sc1
  v_mfma_f32_16x16x32_bf16 v[208:211], a[136:139], a[96:99], v[208:211]
  s_waitcnt lgkmcnt(8)
  ds_read_b128 a[212:215], v47 offset:2048
  ds_read_b128 a[220:223], v47 offset:11264
  s_waitcnt vmcnt(7)
  v_cmp_ne_u32 vcc, 0, v59
  v_mfma_f32_16x16x32_bf16 v[192:195], a[112:115], a[216:219], v[192:195]
  s_and_b32 s75, vcc_lo, 0xfe
  ds_read_b128 a[128:131], v47 offset:20480
  ds_read_b128 a[136:139], v47 offset:29696
  v_mfma_f32_16x16x32_bf16 v[192:195], a[116:119], a[16:19], v[192:195]
  s_bitcmp1_b32 s75, 1
  s_cselect_b32 s94, s94, 0x70000000
  v_mfma_f32_16x16x32_bf16 v[192:195], a[120:123], a[48:51], v[192:195]
  s_add_u32 s95, s50, 2560
  v_mfma_f32_16x16x32_bf16 v[192:195], a[124:127], a[80:83], v[192:195]
  s_waitcnt lgkmcnt(8)
  ds_read_b128 a[112:115], v46 offset:3072
  ds_read_b128 a[116:119], v46 offset:12288
  v_mfma_f32_16x16x32_bf16 v[192:195], a[168:171], a[0:3], v[192:195]
  s_add_u32 s65, s50, 7680
  ds_read_b128 a[120:123], v46 offset:21504
  ds_read_b128 a[124:127], v46 offset:30720
  v_mfma_f32_16x16x32_bf16 v[192:195], a[172:175], a[32:35], v[192:195]
  buffer_load_dwordx4 v[224:227], v50, s[4:7], s94 offen offset:0 sc1
  v_mfma_f32_16x16x32_bf16 v[192:195], a[176:179], a[64:67], v[192:195]
  s_bitcmp1_b32 s75, 2
  s_cselect_b32 s95, s95, 0x70000000
  v_mfma_f32_16x16x32_bf16 v[192:195], a[180:183], a[96:99], v[192:195]
  s_waitcnt lgkmcnt(8)
  ds_read_b128 a[168:171], v47 offset:3072
  ds_read_b128 a[172:175], v47 offset:12288
  v_mfma_f32_16x16x32_bf16 v[128:131], a[184:187], a[216:219], v[128:131]
  s_add_u32 s66, s50, 10240
  ds_read_b128 a[176:179], v47 offset:21504
  ds_read_b128 a[180:183], v47 offset:30720
  v_mfma_f32_16x16x32_bf16 v[128:131], a[188:191], a[16:19], v[128:131]
  buffer_load_dwordx4 v[196:199], v50, s[4:7], s95 offen offset:0 sc1
  v_mfma_f32_16x16x32_bf16 v[128:131], a[196:199], a[48:51], v[128:131]
  s_bitcmp1_b32 s75, 3
  s_cselect_b32 s96, s96, 0x70000000
  v_mfma_f32_16x16x32_bf16 v[128:131], a[204:207], a[80:83], v[128:131]
  s_waitcnt lgkmcnt(8)
  buffer_load_dwordx4 v[228:231], v50, s[4:7], s96 offen offset:0 sc1
  v_mfma_f32_16x16x32_bf16 v[128:131], a[212:215], a[0:3], v[128:131]
  s_bitcmp1_b32 s75, 4
  s_cselect_b32 s65, s65, 0x70000000
  v_mfma_f32_16x16x32_bf16 v[128:131], a[220:223], a[32:35], v[128:131]
  buffer_load_dwordx4 v[200:203], v50, s[4:7], s65 offen offset:0 sc1
  v_mfma_f32_16x16x32_bf16 v[128:131], a[128:131], a[64:67], v[128:131]
  s_bitcmp1_b32 s75, 5
  s_cselect_b32 s66, s66, 0x70000000
  v_mfma_f32_16x16x32_bf16 v[128:131], a[136:139], a[96:99], v[128:131]
  s_waitcnt lgkmcnt(4)
  buffer_load_dwordx4 v[232:235], v50, s[4:7], s66 offen offset:0 sc1
  v_mfma_f32_16x16x32_bf16 v[112:115], a[112:115], a[216:219], v[112:115]
  s_add_u32 s97, s50, 12800
  v_mfma_f32_16x16x32_bf16 v[112:115], a[116:119], a[16:19], v[112:115]
  s_bitcmp1_b32 s75, 6
  s_cselect_b32 s97, s97, 0x70000000
  v_mfma_f32_16x16x32_bf16 v[112:115], a[120:123], a[48:51], v[112:115]
  s_add_u32 s98, s50, 15360
  v_mfma_f32_16x16x32_bf16 v[112:115], a[124:127], a[80:83], v[112:115]
  s_waitcnt lgkmcnt(0)
  buffer_load_dwordx4 v[204:207], v50, s[4:7], s97 offen offset:0 sc1
  v_mfma_f32_16x16x32_bf16 v[112:115], a[168:171], a[0:3], v[112:115]
  s_bitcmp1_b32 s75, 7
  s_cselect_b32 s98, s98, 0x70000000
  v_mfma_f32_16x16x32_bf16 v[112:115], a[172:175], a[32:35], v[112:115]
  buffer_load_dwordx4 v[236:239], v50, s[4:7], s98 offen offset:0 sc1
  v_mfma_f32_16x16x32_bf16 v[112:115], a[176:179], a[64:67], v[112:115]
  v_mfma_f32_16x16x32_bf16 v[112:115], a[180:183], a[96:99], v[112:115]
  s_branch p3_tail
p3_end7:
pad_p3_end7_0:
  s_cbranch_execz warm_P
  v_mfma_f32_16x16x32_bf16 v[252:255], a[168:171], a[12:15], v[252:255]
  s_waitcnt vmcnt(33)
  ds_read_b128 a[196:199], v47 offset:25600
  ds_read_b128 a[204:207], v47 offset:34816
  v_mfma_f32_16x16x32_bf16 v[252:255], a[172:175], a[44:47], v[252:255]
  s_waitcnt vmcnt(29)
  v_mfma_f32_16x16x32_bf16 v[252:255], a[176:179], a[76:79], v[252:255]
  s_waitcnt vmcnt(25)
  v_mfma_f32_16x16x32_bf16 v[252:255], a[180:183], a[108:111], v[252:255]
  v_mfma_f32_16x16x32_bf16 v[248:251], a[180:183], a[104:107], v[248:251]
  v_mfma_f32_16x16x32_bf16 v[248:251], a[176:179], a[72:75], v[248:251]
  v_mfma_f32_16x16x32_bf16 v[248:251], a[172:175], a[40:43], v[248:251]
  v_mfma_f32_16x16x32_bf16 v[248:251], a[168:171], a[8:11], v[248:251]
  v_mfma_f32_16x16x32_bf16 v[244:247], a[168:171], a[4:7], v[244:247]
  v_mfma_f32_16x16x32_bf16 v[244:247], a[172:175], a[36:39], v[244:247]
  v_mfma_f32_16x16x32_bf16 v[244:247], a[176:179], a[68:71], v[244:247]
  buffer_load_dwordx2 v[98:99], v7, s[36:39], s53 offen
  v_mfma_f32_16x16x32_bf16 v[244:247], a[180:183], a[100:103], v[244:247]
  v_mfma_f32_16x16x32_bf16 v[240:243], a[180:183], a[96:99], v[240:243]
  v_mfma_f32_16x16x32_bf16 v[240:243], a[176:179], a[64:67], v[240:243]
  v_mfma_f32_16x16x32_bf16 v[240:243], a[172:175], a[32:35], v[240:243]
  v_mfma_f32_16x16x32_bf16 v[240:243], a[168:171], a[0:3], v[240:243]
  s_waitcnt lgkmcnt(0)
  ds_read_b128 a[212:215], v47 offset:0
  ds_read_b128 a[220:223], v47 offset:9216
  v_mfma_f32_16x16x32_bf16 v[224:227], a[184:187], a[0:3], v[224:227]
  ds_read_b128 a[128:131], v47 offset:18432
  ds_read_b128 a[136:139], v47 offset:27648
  v_mfma_f32_16x16x32_bf16 v[224:227], a[188:191], a[32:35], v[224:227]
  buffer_load_dwordx2 v[100:101], v8, s[36:39], s53 offen
  v_mfma_f32_16x16x32_bf16 v[224:227], a[196:199], a[64:67], v[224:227]
  v_mfma_f32_16x16x32_bf16 v[224:227], a[204:207], a[96:99], v[224:227]
  v_mfma_f32_16x16x32_bf16 v[228:231], a[204:207], a[100:103], v[228:231]
  buffer_load_dwordx2 v[102:103], v9, s[36:39], s53 offen
  v_mfma_f32_16x16x32_bf16 v[228:231], a[196:199], a[68:71], v[228:231]
  v_mfma_f32_16x16x32_bf16 v[228:231], a[188:191], a[36:39], v[228:231]
  v_mfma_f32_16x16x32_bf16 v[228:231], a[184:187], a[4:7], v[228:231]
  v_mfma_f32_16x16x32_bf16 v[232:235], a[184:187], a[8:11], v[232:235]
  v_mfma_f32_16x16x32_bf16 v[232:235], a[188:191], a[40:43], v[232:235]
  s_waitcnt vmcnt(19) lgkmcnt(0)
  s_barrier
  v_mfma_f32_16x16x32_bf16 v[232:235], a[196:199], a[72:75], v[232:235]
  buffer_load_dwordx2 v[104:105], v10, s[36:39], s53 offen
  v_mfma_f32_16x16x32_bf16 v[232:235], a[204:207], a[104:107], v[232:235]
  ds_read_b128 a[112:115], v45 offset:8192
  ds_read_b128 a[116:119], v45 offset:17408
  v_mfma_f32_16x16x32_bf16 v[236:239], a[204:207], a[108:111], v[236:239]
  ds_read_b128 a[120:123], v45 offset:26624
  ds_read_b128 a[124:127], v45 offset:35840
  v_mfma_f32_16x16x32_bf16 v[236:239], a[196:199], a[76:79], v[236:239]
  v_mfma_f32_16x16x32_bf16 v[236:239], a[188:191], a[44:47], v[236:239]
  buffer_load_dwordx2 v[106:107], v11, s[36:39], s53 offen
  v_mfma_f32_16x16x32_bf16 v[236:239], a[184:187], a[12:15], v[236:239]
  v_mfma_f32_16x16x32_bf16 v[220:223], a[212:215], a[12:15], v[220:223]
  v_mfma_f32_16x16x32_bf16 v[220:223], a[220:223], a[44:47], v[220:223]
  v_mfma_f32_16x16x32_bf16 v[220:223], a[128:131], a[76:79], v[220:223]
  v_mfma_f32_16x16x32_bf16 v[220:223], a[136:139], a[108:111], v[220:223]
  v_mfma_f32_16x16x32_bf16 v[216:219], a[136:139], a[104:107], v[216:219]
  v_mfma_f32_16x16x32_bf16 v[216:219], a[128:131], a[72:75], v[216:219]
  v_mfma_f32_16x16x32_bf16 v[216:219], a[220:223], a[40:43], v[216:219]
  v_mfma_f32_16x16x32_bf16 v[216:219], a[212:215], a[8:11], v[216:219]
  v_mfma_f32_16x16x32_bf16 v[212:215], a[212:215], a[4:7], v[212:215]
  v_mfma_f32_16x16x32_bf16 v[212:215], a[220:223], a[36:39], v[212:215]
  v_mfma_f32_16x16x32_bf16 v[212:215], a[128:131], a[68:71], v[212:215]
  v_mfma_f32_16x16x32_bf16 v[212:215], a[136:139], a[100:103], v[212:215]
  s_waitcnt vmcnt(20) lgkmcnt(0)
  ds_read_b128 a[168:171], v47 offset:1024
  ds_read_b128 a[172:175], v47 offset:10240
  v_mfma_f32_16x16x32_bf16 v[240:243], a[112:115], a[224:227], v[240:243]
  s_waitcnt vmcnt(16)
  ds_read_b128 a[176:179], v47 offset:19456
  ds_read_b128 a[180:183], v47 offset:28672
  v_mfma_f32_16x16x32_bf16 v[240:243], a[116:119], a[240:243], v[240:243]
  s_waitcnt vmcnt(12)
  v_mfma_f32_16x16x32_bf16 v[240:243], a[120:123], a[148:151], v[240:243]
  s_waitcnt vmcnt(8)
  v_mfma_f32_16x16x32_bf16 v[240:243], a[124:127], a[164:167], v[240:243]
  s_waitcnt vmcnt(7)
  v_mfma_f32_16x16x32_bf16 v[244:247], a[124:127], a[192:195], v[244:247]
  v_mfma_f32_16x16x32_bf16 v[244:247], a[120:123], a[152:155], v[244:247]
  v_mfma_f32_16x16x32_bf16 v[244:247], a[116:119], a[244:247], v[244:247]
  v_mfma_f32_16x16x32_bf16 v[244:247], a[112:115], a[228:231], v[244:247]
  v_mfma_f32_16x16x32_bf16 v[248:251], a[112:115], a[232:235], v[248:251]
  s_nop 1
  v_cvt_pk_bf16_f32 v240, v240, v241
  v_mfma_f32_16x16x32_bf16 v[248:251], a[116:119], a[248:251], v[248:251]
  v_cvt_pk_bf16_f32 v241, v242, v243
  v_mfma_f32_16x16x32_bf16 v[248:251], a[120:123], a[156:159], v[248:251]
  s_waitcnt vmcnt(6)
  v_mfma_f32_16x16x32_bf16 v[248:251], a[124:127], a[200:203], v[248:251]
  s_waitcnt vmcnt(5)
  ds_read_b128 a[184:187], v45 offset:7168
  ds_read_b128 a[188:191], v45 offset:16384
  v_mfma_f32_16x16x32_bf16 v[252:255], a[124:127], a[208:211], v[252:255]
  ds_read_b128 a[196:199], v45 offset:25600
  ds_read_b128 a[204:207], v45 offset:34816
  v_mfma_f32_16x16x32_bf16 v[252:255], a[120:123], a[160:163], v[252:255]
  v_cvt_pk_bf16_f32 v244, v244, v245
  v_mfma_f32_16x16x32_bf16 v[252:255], a[116:119], a[252:255], v[252:255]
  v_cvt_pk_bf16_f32 v245, v246, v247
  v_mfma_f32_16x16x32_bf16 v[252:255], a[112:115], a[236:239], v[252:255]
  s_waitcnt lgkmcnt(4)
  v_mfma_f32_16x16x32_bf16 v[204:207], a[168:171], a[12:15], v[204:207]
  v_cvt_pk_bf16_f32 v248, v248, v249
  v_mfma_f32_16x16x32_bf16 v[204:207], a[172:175], a[44:47], v[204:207]
  v_cvt_pk_bf16_f32 v249, v250, v251
  v_mfma_f32_16x16x32_bf16 v[204:207], a[176:179], a[76:79], v[204:207]
  v_mfma_f32_16x16x32_bf16 v[204:207], a[180:183], a[108:111], v[204:207]
  v_mfma_f32_16x16x32_bf16 v[200:203], a[180:183], a[104:107], v[200:203]
  v_cvt_pk_bf16_f32 v252, v252, v253
  v_mfma_f32_16x16x32_bf16 v[200:203], a[176:179], a[72:75], v[200:203]
  v_cvt_pk_bf16_f32 v253, v254, v255
  v_mfma_f32_16x16x32_bf16 v[200:203], a[172:175], a[40:43], v[200:203]
  v_mfma_f32_16x16x32_bf16 v[200:203], a[168:171], a[8:11], v[200:203]
  v_mfma_f32_16x16x32_bf16 v[196:199], a[168:171], a[4:7], v[196:199]
  v_mfma_f32_16x16x32_bf16 v[196:199], a[172:175], a[36:39], v[196:199]
  v_mfma_f32_16x16x32_bf16 v[196:199], a[176:179], a[68:71], v[196:199]
  v_mfma_f32_16x16x32_bf16 v[196:199], a[180:183], a[100:103], v[196:199]
  s_waitcnt lgkmcnt(0)
  ds_read_b128 a[212:215], v47 offset:4096
  ds_read_b128 a[220:223], v47 offset:13312
  v_mfma_f32_16x16x32_bf16 v[224:227], a[184:187], a[224:227], v[224:227]
  ds_read_b128 a[128:131], v47 offset:22528
  ds_read_b128 a[136:139], v47 offset:31744
  v_mfma_f32_16x16x32_bf16 v[224:227], a[188:191], a[240:243], v[224:227]
  v_mfma_f32_16x16x32_bf16 v[224:227], a[196:199], a[148:151], v[224:227]
  v_mfma_f32_16x16x32_bf16 v[224:227], a[204:207], a[164:167], v[224:227]
  v_mfma_f32_16x16x32_bf16 v[228:231], a[204:207], a[192:195], v[228:231]
  v_mfma_f32_16x16x32_bf16 v[228:231], a[196:199], a[152:155], v[228:231]
  v_mfma_f32_16x16x32_bf16 v[228:231], a[188:191], a[244:247], v[228:231]
  v_mfma_f32_16x16x32_bf16 v[228:231], a[184:187], a[228:231], v[228:231]
  v_mfma_f32_16x16x32_bf16 v[232:235], a[184:187], a[232:235], v[232:235]
  s_nop 2
  v_cvt_pk_bf16_f32 v242, v224, v225
  v_cvt_pk_bf16_f32 v243, v226, v227
  v_mfma_f32_16x16x32_bf16 v[232:235], a[188:191], a[248:251], v[232:235]
  buffer_store_dwordx4 v[240:243], v50, s[4:7], s94 offen offset:0 sc1
  v_mfma_f32_16x16x32_bf16 v[232:235], a[196:199], a[156:159], v[232:235]
  v_mfma_f32_16x16x32_bf16 v[232:235], a[204:207], a[200:203], v[232:235]
  v_mfma_f32_16x16x32_bf16 v[236:239], a[204:207], a[208:211], v[236:239]
  v_cvt_pk_bf16_f32 v246, v228, v229
  v_cvt_pk_bf16_f32 v247, v230, v231
  v_mfma_f32_16x16x32_bf16 v[236:239], a[196:199], a[160:163], v[236:239]
  buffer_store_dwordx4 v[244:247], v50, s[4:7], s96 offen offset:0 sc1
  v_mfma_f32_16x16x32_bf16 v[236:239], a[188:191], a[252:255], v[236:239]
  v_mfma_f32_16x16x32_bf16 v[236:239], a[184:187], a[236:239], v[236:239]
  s_waitcnt lgkmcnt(0)
  ds_read_b128 a[112:115], v45 offset:0
  ds_read_b128 a[116:119], v45 offset:9216
  v_mfma_f32_16x16x32_bf16 v[188:191], a[212:215], a[12:15], v[188:191]
  ds_read_b128 a[120:123], v45 offset:18432
  ds_read_b128 a[124:127], v45 offset:27648
  v_mfma_f32_16x16x32_bf16 v[188:191], a[220:223], a[44:47], v[188:191]
  v_cvt_pk_bf16_f32 v250, v232, v233
  v_cvt_pk_bf16_f32 v251, v234, v235
  v_mfma_f32_16x16x32_bf16 v[188:191], a[128:131], a[76:79], v[188:191]
  buffer_store_dwordx4 v[248:251], v50, s[4:7], s66 offen offset:0 sc1
  v_mfma_f32_16x16x32_bf16 v[188:191], a[136:139], a[108:111], v[188:191]
  v_mfma_f32_16x16x32_bf16 v[184:187], a[136:139], a[104:107], v[184:187]
  v_cvt_pk_bf16_f32 v254, v236, v237
  v_cvt_pk_bf16_f32 v255, v238, v239
  v_mfma_f32_16x16x32_bf16 v[184:187], a[128:131], a[72:75], v[184:187]
  v_mfma_f32_16x16x32_bf16 v[184:187], a[220:223], a[40:43], v[184:187]
  buffer_store_dwordx4 v[252:255], v50, s[4:7], s98 offen offset:0 sc1
  v_mfma_f32_16x16x32_bf16 v[184:187], a[212:215], a[8:11], v[184:187]
  v_mfma_f32_16x16x32_bf16 v[180:183], a[212:215], a[4:7], v[180:183]
  v_mfma_f32_16x16x32_bf16 v[180:183], a[220:223], a[36:39], v[180:183]
  v_mfma_f32_16x16x32_bf16 v[180:183], a[128:131], a[68:71], v[180:183]
  v_mfma_f32_16x16x32_bf16 v[180:183], a[136:139], a[100:103], v[180:183]
  ds_read_b128 a[168:171], v47 offset:6144
  ds_read_b128 a[172:175], v47 offset:15360
  v_mfma_f32_16x16x32_bf16 v[176:179], a[136:139], a[96:99], v[176:179]
  ds_read_b128 a[176:179], v47 offset:24576
  ds_read_b128 a[180:183], v47 offset:33792
  v_mfma_f32_16x16x32_bf16 v[176:179], a[128:131], a[64:67], v[176:179]
  v_mfma_f32_16x16x32_bf16 v[176:179], a[220:223], a[32:35], v[176:179]
  v_mfma_f32_16x16x32_bf16 v[176:179], a[212:215], a[0:3], v[176:179]
  s_waitcnt lgkmcnt(4)
  v_mfma_f32_16x16x32_bf16 v[212:215], a[112:115], a[228:231], v[212:215]
  v_mfma_f32_16x16x32_bf16 v[212:215], a[116:119], a[244:247], v[212:215]
  v_mfma_f32_16x16x32_bf16 v[212:215], a[120:123], a[152:155], v[212:215]
  v_mfma_f32_16x16x32_bf16 v[212:215], a[124:127], a[192:195], v[212:215]
  v_mfma_f32_16x16x32_bf16 v[216:219], a[124:127], a[200:203], v[216:219]
  v_mfma_f32_16x16x32_bf16 v[216:219], a[120:123], a[156:159], v[216:219]
  v_mfma_f32_16x16x32_bf16 v[216:219], a[116:119], a[248:251], v[216:219]
  v_mfma_f32_16x16x32_bf16 v[216:219], a[112:115], a[232:235], v[216:219]
  v_mfma_f32_16x16x32_bf16 v[220:223], a[112:115], a[236:239], v[220:223]
  s_nop 2
  v_cvt_pk_bf16_f32 v212, v212, v213
  v_mfma_f32_16x16x32_bf16 v[220:223], a[116:119], a[252:255], v[220:223]
  v_cvt_pk_bf16_f32 v213, v214, v215
  v_mfma_f32_16x16x32_bf16 v[220:223], a[120:123], a[160:163], v[220:223]
  v_mfma_f32_16x16x32_bf16 v[220:223], a[124:127], a[208:211], v[220:223]
  s_waitcnt lgkmcnt(0)
  ds_read_b128 a[184:187], v45 offset:1024
  ds_read_b128 a[188:191], v45 offset:10240
  v_mfma_f32_16x16x32_bf16 v[172:175], a[168:171], a[12:15], v[172:175]
  ds_read_b128 a[196:199], v45 offset:19456
  ds_read_b128 a[204:207], v45 offset:28672
  v_mfma_f32_16x16x32_bf16 v[172:175], a[172:175], a[44:47], v[172:175]
  v_cvt_pk_bf16_f32 v216, v216, v217
  v_mfma_f32_16x16x32_bf16 v[172:175], a[176:179], a[76:79], v[172:175]
  v_cvt_pk_bf16_f32 v217, v218, v219
  v_mfma_f32_16x16x32_bf16 v[172:175], a[180:183], a[108:111], v[172:175]
  v_mfma_f32_16x16x32_bf16 v[168:171], a[180:183], a[104:107], v[168:171]
  v_cvt_pk_bf16_f32 v220, v220, v221
  v_mfma_f32_16x16x32_bf16 v[168:171], a[176:179], a[72:75], v[168:171]
  v_cvt_pk_bf16_f32 v221, v222, v223
  v_mfma_f32_16x16x32_bf16 v[168:171], a[172:175], a[40:43], v[168:171]
  v_mfma_f32_16x16x32_bf16 v[168:171], a[168:171], a[8:11], v[168:171]
  v_mfma_f32_16x16x32_bf16 v[164:167], a[168:171], a[4:7], v[164:167]
  v_mfma_f32_16x16x32_bf16 v[164:167], a[172:175], a[36:39], v[164:167]
  v_mfma_f32_16x16x32_bf16 v[164:167], a[176:179], a[68:71], v[164:167]
  v_mfma_f32_16x16x32_bf16 v[164:167], a[180:183], a[100:103], v[164:167]
  ds_read_b128 a[212:215], v47 offset:5120
  ds_read_b128 a[220:223], v47 offset:14336
  v_mfma_f32_16x16x32_bf16 v[160:163], a[180:183], a[96:99], v[160:163]
  ds_read_b128 a[128:131], v47 offset:23552
  ds_read_b128 a[136:139], v47 offset:32768
  v_mfma_f32_16x16x32_bf16 v[160:163], a[176:179], a[64:67], v[160:163]
  v_mfma_f32_16x16x32_bf16 v[160:163], a[172:175], a[32:35], v[160:163]
  v_mfma_f32_16x16x32_bf16 v[160:163], a[168:171], a[0:3], v[160:163]
  s_waitcnt lgkmcnt(4)
  v_mfma_f32_16x16x32_bf16 v[196:199], a[184:187], a[228:231], v[196:199]
  v_mfma_f32_16x16x32_bf16 v[196:199], a[188:191], a[244:247], v[196:199]
  v_mfma_f32_16x16x32_bf16 v[196:199], a[196:199], a[152:155], v[196:199]
  v_mfma_f32_16x16x32_bf16 v[196:199], a[204:207], a[192:195], v[196:199]
  v_mfma_f32_16x16x32_bf16 v[200:203], a[204:207], a[200:203], v[200:203]
  v_mfma_f32_16x16x32_bf16 v[200:203], a[196:199], a[156:159], v[200:203]
  v_mfma_f32_16x16x32_bf16 v[200:203], a[188:191], a[248:251], v[200:203]
  v_mfma_f32_16x16x32_bf16 v[200:203], a[184:187], a[232:235], v[200:203]
  v_mfma_f32_16x16x32_bf16 v[204:207], a[184:187], a[236:239], v[204:207]
  s_nop 2
  v_cvt_pk_bf16_f32 v214, v196, v197
  v_cvt_pk_bf16_f32 v215, v198, v199
  v_mfma_f32_16x16x32_bf16 v[204:207], a[188:191], a[252:255], v[204:207]
  buffer_store_dwordx4 v[212:215], v50, s[4:7], s95 offen offset:0 sc1
  v_mfma_f32_16x16x32_bf16 v[204:207], a[196:199], a[160:163], v[204:207]
  v_mfma_f32_16x16x32_bf16 v[204:207], a[204:207], a[208:211], v[204:207]
  s_waitcnt lgkmcnt(0)
  ds_read_b128 a[112:115], v45 offset:4096
  ds_read_b128 a[116:119], v45 offset:13312
  v_mfma_f32_16x16x32_bf16 v[156:159], a[212:215], a[12:15], v[156:159]
  ds_read_b128 a[120:123], v45 offset:22528
  ds_read_b128 a[124:127], v45 offset:31744
  v_mfma_f32_16x16x32_bf16 v[156:159], a[220:223], a[44:47], v[156:159]
  v_cvt_pk_bf16_f32 v218, v200, v201
  v_cvt_pk_bf16_f32 v219, v202, v203
  v_mfma_f32_16x16x32_bf16 v[156:159], a[128:131], a[76:79], v[156:159]
  buffer_store_dwordx4 v[216:219], v50, s[4:7], s65 offen offset:0 sc1
  v_mfma_f32_16x16x32_bf16 v[156:159], a[136:139], a[108:111], v[156:159]
  v_mfma_f32_16x16x32_bf16 v[152:155], a[136:139], a[104:107], v[152:155]
  v_cvt_pk_bf16_f32 v222, v204, v205
  v_cvt_pk_bf16_f32 v223, v206, v207
  v_mfma_f32_16x16x32_bf16 v[152:155], a[128:131], a[72:75], v[152:155]
  v_mfma_f32_16x16x32_bf16 v[152:155], a[220:223], a[40:43], v[152:155]
  buffer_store_dwordx4 v[220:223], v50, s[4:7], s97 offen offset:0 sc1
  v_mfma_f32_16x16x32_bf16 v[152:155], a[212:215], a[8:11], v[152:155]
  v_mfma_f32_16x16x32_bf16 v[148:151], a[212:215], a[4:7], v[148:151]
  v_mfma_f32_16x16x32_bf16 v[148:151], a[220:223], a[36:39], v[148:151]
  v_mfma_f32_16x16x32_bf16 v[148:151], a[128:131], a[68:71], v[148:151]
  v_mfma_f32_16x16x32_bf16 v[148:151], a[136:139], a[100:103], v[148:151]
  v_mfma_f32_16x16x32_bf16 v[144:147], a[136:139], a[96:99], v[144:147]
  v_mfma_f32_16x16x32_bf16 v[144:147], a[128:131], a[64:67], v[144:147]
  v_mfma_f32_16x16x32_bf16 v[144:147], a[220:223], a[32:35], v[144:147]
  v_mfma_f32_16x16x32_bf16 v[144:147], a[212:215], a[0:3], v[144:147]
  s_waitcnt lgkmcnt(0)
  ds_read_b128 a[168:171], v47 offset:2048
  ds_read_b128 a[172:175], v47 offset:11264
  v_mfma_f32_16x16x32_bf16 v[176:179], a[112:115], a[224:227], v[176:179]
  ds_read_b128 a[176:179], v47 offset:20480
  ds_read_b128 a[180:183], v47 offset:29696
  v_mfma_f32_16x16x32_bf16 v[176:179], a[116:119], a[240:243], v[176:179]
  v_mfma_f32_16x16x32_bf16 v[176:179], a[120:123], a[148:151], v[176:179]
  v_mfma_f32_16x16x32_bf16 v[176:179], a[124:127], a[164:167], v[176:179]
  v_mfma_f32_16x16x32_bf16 v[180:183], a[124:127], a[192:195], v[180:183]
  v_mfma_f32_16x16x32_bf16 v[180:183], a[120:123], a[152:155], v[180:183]
  v_mfma_f32_16x16x32_bf16 v[180:183], a[116:119], a[244:247], v[180:183]
  v_mfma_f32_16x16x32_bf16 v[180:183], a[112:115], a[228:231], v[180:183]
  v_mfma_f32_16x16x32_bf16 v[184:187], a[112:115], a[232:235], v[184:187]
  s_nop 2
  v_cvt_pk_bf16_f32 v108, v176, v177
  v_cvt_pk_bf16_f32 v109, v178, v179
  v_mfma_f32_16x16x32_bf16 v[184:187], a[116:119], a[248:251], v[184:187]
  buffer_store_dwordx2 v[108:109], v33, s[4:7], s94 offen offset:2048 sc1
  v_mfma_f32_16x16x32_bf16 v[184:187], a[120:123], a[156:159], v[184:187]
  v_mfma_f32_16x16x32_bf16 v[184:187], a[124:127], a[200:203], v[184:187]
  ds_read_b128 a[184:187], v45 offset:6144
  ds_read_b128 a[188:191], v45 offset:15360
  v_mfma_f32_16x16x32_bf16 v[188:191], a[124:127], a[208:211], v[188:191]
  ds_read_b128 a[196:199], v45 offset:24576
  ds_read_b128 a[204:207], v45 offset:33792
  v_mfma_f32_16x16x32_bf16 v[188:191], a[120:123], a[160:163], v[188:191]
  v_cvt_pk_bf16_f32 v180, v180, v181
  v_mfma_f32_16x16x32_bf16 v[188:191], a[116:119], a[252:255], v[188:191]
  v_cvt_pk_bf16_f32 v181, v182, v183
  v_mfma_f32_16x16x32_bf16 v[188:191], a[112:115], a[236:239], v[188:191]
  s_waitcnt lgkmcnt(4)
  buffer_store_dwordx2 v[180:181], v33, s[4:7], s96 offen offset:2048 sc1
  v_mfma_f32_16x16x32_bf16 v[140:143], a[168:171], a[12:15], v[140:143]
  v_cvt_pk_bf16_f32 v184, v184, v185
  v_mfma_f32_16x16x32_bf16 v[140:143], a[172:175], a[44:47], v[140:143]
  v_cvt_pk_bf16_f32 v185, v186, v187
  v_mfma_f32_16x16x32_bf16 v[140:143], a[176:179], a[76:79], v[140:143]
  v_mfma_f32_16x16x32_bf16 v[140:143], a[180:183], a[108:111], v[140:143]
  buffer_store_dwordx2 v[180:181], v32, s[4:7], s95 offen offset:2048 sc1
  v_mfma_f32_16x16x32_bf16 v[136:139], a[180:183], a[104:107], v[136:139]
  v_cvt_pk_bf16_f32 v188, v188, v189
  v_mfma_f32_16x16x32_bf16 v[136:139], a[176:179], a[72:75], v[136:139]
  v_cvt_pk_bf16_f32 v189, v190, v191
  v_mfma_f32_16x16x32_bf16 v[136:139], a[172:175], a[40:43], v[136:139]
  v_mfma_f32_16x16x32_bf16 v[136:139], a[168:171], a[8:11], v[136:139]
  buffer_store_dwordx2 v[184:185], v33, s[4:7], s66 offen offset:2048 sc1
  v_mfma_f32_16x16x32_bf16 v[132:135], a[168:171], a[4:7], v[132:135]
  v_mfma_f32_16x16x32_bf16 v[132:135], a[172:175], a[36:39], v[132:135]
  v_mfma_f32_16x16x32_bf16 v[132:135], a[176:179], a[68:71], v[132:135]
  v_mfma_f32_16x16x32_bf16 v[132:135], a[180:183], a[100:103], v[132:135]
  s_waitcnt lgkmcnt(0)
  buffer_store_dwordx2 v[184:185], v32, s[4:7], s65 offen offset:2048 sc1
  v_mfma_f32_16x16x32_bf16 v[160:163], a[184:187], a[224:227], v[160:163]
  ds_read_b128 a[212:215], v47 offset:3072
  ds_read_b128 a[220:223], v47 offset:12288
  v_mfma_f32_16x16x32_bf16 v[160:163], a[188:191], a[240:243], v[160:163]
  ds_read_b128 a[128:131], v47 offset:21504
  ds_read_b128 a[136:139], v47 offset:30720
  v_mfma_f32_16x16x32_bf16 v[160:163], a[196:199], a[148:151], v[160:163]
  v_mfma_f32_16x16x32_bf16 v[160:163], a[204:207], a[164:167], v[160:163]
  buffer_store_dwordx2 v[188:189], v33, s[4:7], s98 offen offset:2048 sc1
  v_mfma_f32_16x16x32_bf16 v[164:167], a[204:207], a[192:195], v[164:167]
  v_mfma_f32_16x16x32_bf16 v[164:167], a[196:199], a[152:155], v[164:167]
  v_mfma_f32_16x16x32_bf16 v[164:167], a[188:191], a[244:247], v[164:167]
  v_mfma_f32_16x16x32_bf16 v[164:167], a[184:187], a[228:231], v[164:167]
  buffer_store_dwordx2 v[188:189], v32, s[4:7], s97 offen offset:2048 sc1
  v_mfma_f32_16x16x32_bf16 v[168:171], a[184:187], a[232:235], v[168:171]
  s_nop 0
  v_cvt_pk_bf16_f32 v160, v160, v161
  v_mfma_f32_16x16x32_bf16 v[168:171], a[188:191], a[248:251], v[168:171]
  v_cvt_pk_bf16_f32 v161, v162, v163
  v_mfma_f32_16x16x32_bf16 v[168:171], a[196:199], a[156:159], v[168:171]
  v_mfma_f32_16x16x32_bf16 v[168:171], a[204:207], a[200:203], v[168:171]
  ds_read_b128 a[112:115], v45 offset:5120
  ds_read_b128 a[116:119], v45 offset:14336
  v_mfma_f32_16x16x32_bf16 v[172:175], a[204:207], a[208:211], v[172:175]
  ds_read_b128 a[120:123], v45 offset:23552
  ds_read_b128 a[124:127], v45 offset:32768
  v_mfma_f32_16x16x32_bf16 v[172:175], a[196:199], a[160:163], v[172:175]
  v_cvt_pk_bf16_f32 v164, v164, v165
  v_mfma_f32_16x16x32_bf16 v[172:175], a[188:191], a[252:255], v[172:175]
  v_cvt_pk_bf16_f32 v165, v166, v167
  v_mfma_f32_16x16x32_bf16 v[172:175], a[184:187], a[236:239], v[172:175]
  s_waitcnt lgkmcnt(4)
  v_mfma_f32_16x16x32_bf16 v[124:127], a[212:215], a[12:15], v[124:127]
  v_cvt_pk_bf16_f32 v168, v168, v169
  v_mfma_f32_16x16x32_bf16 v[124:127], a[220:223], a[44:47], v[124:127]
  v_cvt_pk_bf16_f32 v169, v170, v171
  v_mfma_f32_16x16x32_bf16 v[124:127], a[128:131], a[76:79], v[124:127]
  v_mfma_f32_16x16x32_bf16 v[124:127], a[136:139], a[108:111], v[124:127]
  v_mfma_f32_16x16x32_bf16 v[120:123], a[136:139], a[104:107], v[120:123]
  v_cvt_pk_bf16_f32 v172, v172, v173
  v_mfma_f32_16x16x32_bf16 v[120:123], a[128:131], a[72:75], v[120:123]
  v_cvt_pk_bf16_f32 v173, v174, v175
  v_mfma_f32_16x16x32_bf16 v[120:123], a[220:223], a[40:43], v[120:123]
  v_mfma_f32_16x16x32_bf16 v[120:123], a[212:215], a[8:11], v[120:123]
  v_mfma_f32_16x16x32_bf16 v[116:119], a[212:215], a[4:7], v[116:119]
  v_mfma_f32_16x16x32_bf16 v[116:119], a[220:223], a[36:39], v[116:119]
  v_mfma_f32_16x16x32_bf16 v[116:119], a[128:131], a[68:71], v[116:119]
  v_mfma_f32_16x16x32_bf16 v[116:119], a[136:139], a[100:103], v[116:119]
  s_waitcnt lgkmcnt(0)
  ds_read_b128 a[168:171], v45 offset:2048
  ds_read_b128 a[172:175], v45 offset:11264
  v_mfma_f32_16x16x32_bf16 v[144:147], a[112:115], a[224:227], v[144:147]
  ds_read_b128 a[176:179], v45 offset:20480
  ds_read_b128 a[180:183], v45 offset:29696
  v_mfma_f32_16x16x32_bf16 v[144:147], a[116:119], a[240:243], v[144:147]
  s_waitcnt vmcnt(18)
  v_lshlrev_b32 v240, 16, v98
  v_and_b32 v241, 0xffff0000, v98
  v_mfma_f32_16x16x32_bf16 v[144:147], a[120:123], a[148:151], v[144:147]
  v_lshlrev_b32 v242, 16, v99
  v_and_b32 v243, 0xffff0000, v99
  v_mfma_f32_16x16x32_bf16 v[144:147], a[124:127], a[164:167], v[144:147]
  s_waitcnt vmcnt(17)
  v_lshlrev_b32 v244, 16, v100
  v_and_b32 v245, 0xffff0000, v100
  v_mfma_f32_16x16x32_bf16 v[148:151], a[124:127], a[192:195], v[148:151]
  v_lshlrev_b32 v246, 16, v101
  v_and_b32 v247, 0xffff0000, v101
  v_mfma_f32_16x16x32_bf16 v[148:151], a[120:123], a[152:155], v[148:151]
  s_waitcnt vmcnt(16)
  v_lshlrev_b32 v248, 16, v102
  v_and_b32 v249, 0xffff0000, v102
  v_mfma_f32_16x16x32_bf16 v[148:151], a[116:119], a[244:247], v[148:151]
  buffer_load_dword v59, v13, s[4:7], s48 offen sc1
  v_mfma_f32_16x16x32_bf16 v[148:151], a[112:115], a[228:231], v[148:151]
  v_lshlrev_b32 v250, 16, v103
  v_and_b32 v251, 0xffff0000, v103
  v_mfma_f32_16x16x32_bf16 v[152:155], a[112:115], a[232:235], v[152:155]
  v_cvt_pk_bf16_f32 v162, v144, v145
  v_cvt_pk_bf16_f32 v163, v146, v147
  v_mfma_f32_16x16x32_bf16 v[152:155], a[116:119], a[248:251], v[152:155]
  buffer_store_dwordx4 v[160:163], v50, s[4:7], s94 offen offset:1024 sc1
  v_mfma_f32_16x16x32_bf16 v[152:155], a[120:123], a[156:159], v[152:155]
  s_waitcnt vmcnt(17)
  v_lshlrev_b32 v252, 16, v104
  v_and_b32 v253, 0xffff0000, v104
  v_mfma_f32_16x16x32_bf16 v[152:155], a[124:127], a[200:203], v[152:155]
  ds_read_b128 a[184:187], v45 offset:3072
  ds_read_b128 a[188:191], v45 offset:12288
  v_mfma_f32_16x16x32_bf16 v[156:159], a[124:127], a[208:211], v[156:159]
  ds_read_b128 a[196:199], v45 offset:21504
  ds_read_b128 a[204:207], v45 offset:30720
  v_mfma_f32_16x16x32_bf16 v[156:159], a[120:123], a[160:163], v[156:159]
  v_cvt_pk_bf16_f32 v166, v148, v149
  v_cvt_pk_bf16_f32 v167, v150, v151
  v_mfma_f32_16x16x32_bf16 v[156:159], a[116:119], a[252:255], v[156:159]
  buffer_store_dwordx4 v[164:167], v50, s[4:7], s96 offen offset:1024 sc1
  v_mfma_f32_16x16x32_bf16 v[156:159], a[112:115], a[236:239], v[156:159]
  s_waitcnt lgkmcnt(4)
  v_lshlrev_b32 v254, 16, v105
  v_and_b32 v255, 0xffff0000, v105
  v_mfma_f32_16x16x32_bf16 v[140:143], a[168:171], a[236:239], v[140:143]
  v_cvt_pk_bf16_f32 v170, v152, v153
  v_cvt_pk_bf16_f32 v171, v154, v155
  v_mfma_f32_16x16x32_bf16 v[140:143], a[172:175], a[252:255], v[140:143]
  s_waitcnt vmcnt(17)
  v_lshlrev_b32 v180, 16, v106
  v_and_b32 v181, 0xffff0000, v106
  v_mfma_f32_16x16x32_bf16 v[140:143], a[176:179], a[160:163], v[140:143]
  buffer_store_dwordx4 v[168:171], v50, s[4:7], s66 offen offset:1024 sc1
  v_mfma_f32_16x16x32_bf16 v[140:143], a[180:183], a[208:211], v[140:143]
  v_lshlrev_b32 v182, 16, v107
  v_and_b32 v183, 0xffff0000, v107
  v_mfma_f32_16x16x32_bf16 v[136:139], a[180:183], a[200:203], v[136:139]
  v_cvt_pk_bf16_f32 v174, v156, v157
  v_cvt_pk_bf16_f32 v175, v158, v159
  v_mfma_f32_16x16x32_bf16 v[136:139], a[176:179], a[156:159], v[136:139]
  v_mfma_f32_16x16x32_bf16 v[136:139], a[172:175], a[248:251], v[136:139]
  buffer_store_dwordx4 v[172:175], v50, s[4:7], s98 offen offset:1024 sc1
  v_mfma_f32_16x16x32_bf16 v[136:139], a[168:171], a[232:235], v[136:139]
  ds_read_b128 a[212:215], v47 offset:0
  ds_read_b128 a[220:223], v47 offset:9216
  v_mfma_f32_16x16x32_bf16 v[132:135], a[168:171], a[228:231], v[132:135]
  ds_read_b128 a[128:131], v47 offset:18432
  ds_read_b128 a[136:139], v47 offset:27648
  v_mfma_f32_16x16x32_bf16 v[132:135], a[172:175], a[244:247], v[132:135]
  v_cvt_pk_bf16_f32 v140, v140, v141
  v_mfma_f32_16x16x32_bf16 v[132:135], a[176:179], a[152:155], v[132:135]
  v_cvt_pk_bf16_f32 v141, v142, v143
  v_mfma_f32_16x16x32_bf16 v[132:135], a[180:183], a[192:195], v[132:135]
  s_waitcnt lgkmcnt(4)
  ds_read_b128 a[112:115], v45 offset:0
  ds_read_b128 a[116:119], v45 offset:9216
  v_mfma_f32_16x16x32_bf16 v[116:119], a[184:187], a[228:231], v[116:119]
pad_p3_end7_1:
  s_cbranch_execz warm_P
  ds_read_b128 a[120:123], v45 offset:18432
  ds_read_b128 a[124:127], v45 offset:27648
  v_mfma_f32_16x16x32_bf16 v[116:119], a[188:191], a[244:247], v[116:119]
  v_cvt_pk_bf16_f32 v136, v136, v137
  v_mfma_f32_16x16x32_bf16 v[116:119], a[196:199], a[152:155], v[116:119]
  v_cvt_pk_bf16_f32 v137, v138, v139
  v_mfma_f32_16x16x32_bf16 v[116:119], a[204:207], a[192:195], v[116:119]
  ds_read_b128 a[168:171], v47 offset:1024
  ds_read_b128 a[172:175], v47 offset:10240
  v_mfma_f32_16x16x32_bf16 v[120:123], a[204:207], a[200:203], v[120:123]
  ds_read_b128 a[176:179], v47 offset:19456
  ds_read_b128 a[180:183], v47 offset:28672
  v_mfma_f32_16x16x32_bf16 v[120:123], a[196:199], a[156:159], v[120:123]
  v_cvt_pk_bf16_f32 v132, v132, v133
  v_mfma_f32_16x16x32_bf16 v[120:123], a[188:191], a[248:251], v[120:123]
  v_cvt_pk_bf16_f32 v133, v134, v135
  v_mfma_f32_16x16x32_bf16 v[120:123], a[184:187], a[232:235], v[120:123]
  v_mfma_f32_16x16x32_bf16 v[124:127], a[184:187], a[236:239], v[124:127]
  v_cvt_pk_bf16_f32 v134, v116, v117
  v_cvt_pk_bf16_f32 v135, v118, v119
  v_mfma_f32_16x16x32_bf16 v[124:127], a[188:191], a[252:255], v[124:127]
  buffer_store_dwordx4 v[132:135], v50, s[4:7], s95 offen offset:1024 sc1
  v_mfma_f32_16x16x32_bf16 v[124:127], a[196:199], a[160:163], v[124:127]
  v_mfma_f32_16x16x32_bf16 v[124:127], a[204:207], a[208:211], v[124:127]
  s_waitcnt lgkmcnt(8)
  ds_read_b128 a[184:187], v45 offset:1024
  ds_read_b128 a[188:191], v45 offset:10240
  v_mfma_f32_16x16x32_bf16 v[208:211], a[212:215], a[0:3], v[208:211]
  ds_read_b128 a[196:199], v45 offset:19456
  ds_read_b128 a[204:207], v45 offset:28672
  v_mfma_f32_16x16x32_bf16 v[208:211], a[220:223], a[32:35], v[208:211]
  v_cvt_pk_bf16_f32 v138, v120, v121
  v_cvt_pk_bf16_f32 v139, v122, v123
  v_mfma_f32_16x16x32_bf16 v[208:211], a[128:131], a[64:67], v[208:211]
  buffer_store_dwordx4 v[136:139], v50, s[4:7], s65 offen offset:1024 sc1
  v_mfma_f32_16x16x32_bf16 v[208:211], a[136:139], a[96:99], v[208:211]
  s_waitcnt lgkmcnt(8)
  ds_read_b128 a[212:215], v47 offset:2048
  ds_read_b128 a[220:223], v47 offset:11264
  v_mfma_f32_16x16x32_bf16 v[208:211], a[112:115], a[224:227], v[208:211]
  s_add_u32 s94, s50, 0
  ds_read_b128 a[128:131], v47 offset:20480
  ds_read_b128 a[136:139], v47 offset:29696
  v_mfma_f32_16x16x32_bf16 v[208:211], a[116:119], a[240:243], v[208:211]
  s_add_u32 s95, s50, 2560
  v_cvt_pk_bf16_f32 v142, v124, v125
  v_cvt_pk_bf16_f32 v143, v126, v127
  v_mfma_f32_16x16x32_bf16 v[208:211], a[120:123], a[148:151], v[208:211]
  buffer_store_dwordx4 v[140:143], v50, s[4:7], s97 offen offset:1024 sc1
  v_mfma_f32_16x16x32_bf16 v[208:211], a[124:127], a[164:167], v[208:211]
  s_waitcnt lgkmcnt(8)
  ds_read_b128 a[112:115], v45 offset:2048
  ds_read_b128 a[116:119], v45 offset:11264
  s_waitcnt vmcnt(7)
  v_cmp_ne_u32 vcc, 0, v59
  v_mfma_f32_16x16x32_bf16 v[192:195], a[168:171], a[0:3], v[192:195]
  s_and_b32 s75, vcc_lo, 0xfe
  ds_read_b128 a[120:123], v45 offset:20480
  ds_read_b128 a[124:127], v45 offset:29696
  v_mfma_f32_16x16x32_bf16 v[192:195], a[172:175], a[32:35], v[192:195]
  s_bitcmp1_b32 s75, 1
  s_cselect_b32 s94, s94, 0x70000000
  v_mfma_f32_16x16x32_bf16 v[192:195], a[176:179], a[64:67], v[192:195]
  s_bitcmp1_b32 s75, 2
  s_cselect_b32 s95, s95, 0x70000000
  v_mfma_f32_16x16x32_bf16 v[192:195], a[180:183], a[96:99], v[192:195]
  s_waitcnt lgkmcnt(8)
  ds_read_b128 a[168:171], v47 offset:3072
  ds_read_b128 a[172:175], v47 offset:12288
  v_mfma_f32_16x16x32_bf16 v[192:195], a[184:187], a[224:227], v[192:195]
  s_add_u32 s96, s50, 5120
  ds_read_b128 a[176:179], v47 offset:21504
  ds_read_b128 a[180:183], v47 offset:30720
  v_mfma_f32_16x16x32_bf16 v[192:195], a[188:191], a[240:243], v[192:195]
  buffer_load_dwordx4 v[224:227], v50, s[4:7], s94 offen offset:0 sc1
  v_mfma_f32_16x16x32_bf16 v[192:195], a[196:199], a[148:151], v[192:195]
  s_bitcmp1_b32 s75, 3
  s_cselect_b32 s96, s96, 0x70000000
  v_mfma_f32_16x16x32_bf16 v[192:195], a[204:207], a[164:167], v[192:195]
  s_waitcnt lgkmcnt(8)
  ds_read_b128 a[184:187], v45 offset:3072
  ds_read_b128 a[188:191], v45 offset:12288
  v_mfma_f32_16x16x32_bf16 v[128:131], a[212:215], a[0:3], v[128:131]
  s_add_u32 s65, s50, 7680
  ds_read_b128 a[196:199], v45 offset:21504
  ds_read_b128 a[204:207], v45 offset:30720
  v_mfma_f32_16x16x32_bf16 v[128:131], a[220:223], a[32:35], v[128:131]
  buffer_load_dwordx4 v[196:199], v50, s[4:7], s95 offen offset:0 sc1
  v_mfma_f32_16x16x32_bf16 v[128:131], a[128:131], a[64:67], v[128:131]
  s_bitcmp1_b32 s75, 4
  s_cselect_b32 s65, s65, 0x70000000
  v_mfma_f32_16x16x32_bf16 v[128:131], a[136:139], a[96:99], v[128:131]
  s_waitcnt lgkmcnt(8)
  buffer_load_dwordx4 v[228:231], v50, s[4:7], s96 offen offset:0 sc1
  v_mfma_f32_16x16x32_bf16 v[128:131], a[112:115], a[224:227], v[128:131]
  s_add_u32 s66, s50, 10240
  v_mfma_f32_16x16x32_bf16 v[128:131], a[116:119], a[240:243], v[128:131]
  buffer_load_dwordx4 v[200:203], v50, s[4:7], s65 offen offset:0 sc1
  v_mfma_f32_16x16x32_bf16 v[128:131], a[120:123], a[148:151], v[128:131]
  s_bitcmp1_b32 s75, 5
  s_cselect_b32 s66, s66, 0x70000000
  v_mfma_f32_16x16x32_bf16 v[128:131], a[124:127], a[164:167], v[128:131]
  s_waitcnt lgkmcnt(4)
  buffer_load_dwordx4 v[232:235], v50, s[4:7], s66 offen offset:0 sc1
  v_mfma_f32_16x16x32_bf16 v[112:115], a[168:171], a[0:3], v[112:115]
  s_add_u32 s97, s50, 12800
  v_mfma_f32_16x16x32_bf16 v[112:115], a[172:175], a[32:35], v[112:115]
  s_bitcmp1_b32 s75, 6
  s_cselect_b32 s97, s97, 0x70000000
  v_mfma_f32_16x16x32_bf16 v[112:115], a[176:179], a[64:67], v[112:115]
  s_add_u32 s98, s50, 15360
  v_mfma_f32_16x16x32_bf16 v[112:115], a[180:183], a[96:99], v[112:115]
  s_waitcnt lgkmcnt(0)
  buffer_load_dwordx4 v[204:207], v50, s[4:7], s97 offen offset:0 sc1
  v_mfma_f32_16x16x32_bf16 v[112:115], a[184:187], a[224:227], v[112:115]
  s_bitcmp1_b32 s75, 7
  s_cselect_b32 s98, s98, 0x70000000
  v_mfma_f32_16x16x32_bf16 v[112:115], a[188:191], a[240:243], v[112:115]
  buffer_load_dwordx4 v[236:239], v50, s[4:7], s98 offen offset:0 sc1
  v_mfma_f32_16x16x32_bf16 v[112:115], a[196:199], a[148:151], v[112:115]
  v_mfma_f32_16x16x32_bf16 v[112:115], a[204:207], a[164:167], v[112:115]
  s_branch p3_tail
p3_end8:
pad_p3_end8_0:
  s_cbranch_execz warm_P
  s_waitcnt vmcnt(41)
  v_mfma_f32_16x16x32_bf16 v[240:243], a[184:187], a[224:227], v[240:243]
  s_waitcnt vmcnt(37)
  ds_read_b128 a[128:131], v45 offset:25600
  ds_read_b128 a[136:139], v45 offset:34816
  v_mfma_f32_16x16x32_bf16 v[240:243], a[188:191], a[240:243], v[240:243]
  s_waitcnt vmcnt(33)
  v_mfma_f32_16x16x32_bf16 v[240:243], a[196:199], a[148:151], v[240:243]
  s_waitcnt vmcnt(29)
  v_mfma_f32_16x16x32_bf16 v[240:243], a[204:207], a[164:167], v[240:243]
  s_waitcnt vmcnt(28)
  v_mfma_f32_16x16x32_bf16 v[244:247], a[204:207], a[192:195], v[244:247]
  v_mfma_f32_16x16x32_bf16 v[244:247], a[196:199], a[152:155], v[244:247]
  v_mfma_f32_16x16x32_bf16 v[244:247], a[188:191], a[244:247], v[244:247]
  v_mfma_f32_16x16x32_bf16 v[244:247], a[184:187], a[228:231], v[244:247]
  v_mfma_f32_16x16x32_bf16 v[248:251], a[184:187], a[232:235], v[248:251]
  v_mfma_f32_16x16x32_bf16 v[248:251], a[188:191], a[248:251], v[248:251]
  v_mfma_f32_16x16x32_bf16 v[248:251], a[196:199], a[156:159], v[248:251]
  s_waitcnt vmcnt(27)
  buffer_load_dwordx2 v[98:99], v7, s[36:39], s53 offen
  v_mfma_f32_16x16x32_bf16 v[248:251], a[204:207], a[200:203], v[248:251]
  s_waitcnt vmcnt(27)
  v_mfma_f32_16x16x32_bf16 v[252:255], a[204:207], a[208:211], v[252:255]
  v_mfma_f32_16x16x32_bf16 v[252:255], a[196:199], a[160:163], v[252:255]
  v_mfma_f32_16x16x32_bf16 v[252:255], a[188:191], a[252:255], v[252:255]
  v_mfma_f32_16x16x32_bf16 v[252:255], a[184:187], a[236:239], v[252:255]
  s_waitcnt lgkmcnt(0)
  ds_read_b128 a[112:115], v45 offset:0
  ds_read_b128 a[116:119], v45 offset:9216
  v_mfma_f32_16x16x32_bf16 v[236:239], a[212:215], a[236:239], v[236:239]
  ds_read_b128 a[120:123], v45 offset:18432
  ds_read_b128 a[124:127], v45 offset:27648
  v_mfma_f32_16x16x32_bf16 v[236:239], a[220:223], a[252:255], v[236:239]
  buffer_load_dwordx2 v[100:101], v8, s[36:39], s53 offen
  v_mfma_f32_16x16x32_bf16 v[236:239], a[128:131], a[160:163], v[236:239]
  v_mfma_f32_16x16x32_bf16 v[236:239], a[136:139], a[208:211], v[236:239]
  v_mfma_f32_16x16x32_bf16 v[232:235], a[136:139], a[200:203], v[232:235]
  buffer_load_dwordx2 v[102:103], v9, s[36:39], s53 offen
  v_mfma_f32_16x16x32_bf16 v[232:235], a[128:131], a[156:159], v[232:235]
  v_mfma_f32_16x16x32_bf16 v[232:235], a[220:223], a[248:251], v[232:235]
  v_mfma_f32_16x16x32_bf16 v[232:235], a[212:215], a[232:235], v[232:235]
  v_mfma_f32_16x16x32_bf16 v[228:231], a[212:215], a[228:231], v[228:231]
  v_mfma_f32_16x16x32_bf16 v[228:231], a[220:223], a[244:247], v[228:231]
  s_waitcnt vmcnt(20) lgkmcnt(0)
  s_barrier
  v_mfma_f32_16x16x32_bf16 v[228:231], a[128:131], a[152:155], v[228:231]
  buffer_load_dwordx2 v[104:105], v10, s[36:39], s53 offen
  v_mfma_f32_16x16x32_bf16 v[228:231], a[136:139], a[192:195], v[228:231]
  ds_read_b128 a[168:171], v46 offset:8192
  ds_read_b128 a[172:175], v46 offset:17408
  v_mfma_f32_16x16x32_bf16 v[224:227], a[136:139], a[164:167], v[224:227]
  ds_read_b128 a[176:179], v46 offset:26624
  ds_read_b128 a[180:183], v46 offset:35840
  v_mfma_f32_16x16x32_bf16 v[224:227], a[128:131], a[148:151], v[224:227]
  v_mfma_f32_16x16x32_bf16 v[224:227], a[220:223], a[240:243], v[224:227]
  buffer_load_dwordx2 v[106:107], v11, s[36:39], s53 offen
  v_mfma_f32_16x16x32_bf16 v[224:227], a[212:215], a[224:227], v[224:227]
  v_mfma_f32_16x16x32_bf16 v[212:215], a[112:115], a[228:231], v[212:215]
  v_mfma_f32_16x16x32_bf16 v[212:215], a[116:119], a[244:247], v[212:215]
  v_mfma_f32_16x16x32_bf16 v[212:215], a[120:123], a[152:155], v[212:215]
  v_mfma_f32_16x16x32_bf16 v[212:215], a[124:127], a[192:195], v[212:215]
  v_mfma_f32_16x16x32_bf16 v[216:219], a[124:127], a[200:203], v[216:219]
  v_mfma_f32_16x16x32_bf16 v[216:219], a[120:123], a[156:159], v[216:219]
  v_mfma_f32_16x16x32_bf16 v[216:219], a[116:119], a[248:251], v[216:219]
  v_mfma_f32_16x16x32_bf16 v[216:219], a[112:115], a[232:235], v[216:219]
  v_mfma_f32_16x16x32_bf16 v[220:223], a[112:115], a[236:239], v[220:223]
  v_mfma_f32_16x16x32_bf16 v[220:223], a[116:119], a[252:255], v[220:223]
  v_mfma_f32_16x16x32_bf16 v[220:223], a[120:123], a[160:163], v[220:223]
  v_mfma_f32_16x16x32_bf16 v[220:223], a[124:127], a[208:211], v[220:223]
  s_waitcnt vmcnt(18) lgkmcnt(0)
  ds_read_b128 a[184:187], v45 offset:1024
  ds_read_b128 a[188:191], v45 offset:10240
  v_mfma_f32_16x16x32_bf16 v[252:255], a[168:171], a[140:143], v[252:255]
  s_waitcnt vmcnt(14)
  ds_read_b128 a[196:199], v45 offset:19456
  ds_read_b128 a[204:207], v45 offset:28672
  v_mfma_f32_16x16x32_bf16 v[252:255], a[172:175], a[28:31], v[252:255]
  s_waitcnt vmcnt(9)
  v_mfma_f32_16x16x32_bf16 v[252:255], a[176:179], a[60:63], v[252:255]
  s_waitcnt vmcnt(5)
  v_mfma_f32_16x16x32_bf16 v[252:255], a[180:183], a[92:95], v[252:255]
  v_mfma_f32_16x16x32_bf16 v[248:251], a[180:183], a[88:91], v[248:251]
  v_mfma_f32_16x16x32_bf16 v[248:251], a[176:179], a[56:59], v[248:251]
  v_mfma_f32_16x16x32_bf16 v[248:251], a[172:175], a[24:27], v[248:251]
  v_mfma_f32_16x16x32_bf16 v[248:251], a[168:171], a[132:135], v[248:251]
  v_mfma_f32_16x16x32_bf16 v[244:247], a[168:171], a[144:147], v[244:247]
  s_nop 2
  v_cvt_pk_bf16_f32 v252, v252, v253
  v_mfma_f32_16x16x32_bf16 v[244:247], a[172:175], a[20:23], v[244:247]
  v_cvt_pk_bf16_f32 v253, v254, v255
  v_mfma_f32_16x16x32_bf16 v[244:247], a[176:179], a[52:55], v[244:247]
  v_mfma_f32_16x16x32_bf16 v[244:247], a[180:183], a[84:87], v[244:247]
  ds_read_b128 a[212:215], v46 offset:7168
  ds_read_b128 a[220:223], v46 offset:16384
  v_mfma_f32_16x16x32_bf16 v[240:243], a[180:183], a[80:83], v[240:243]
  ds_read_b128 a[128:131], v46 offset:25600
  ds_read_b128 a[136:139], v46 offset:34816
  v_mfma_f32_16x16x32_bf16 v[240:243], a[176:179], a[48:51], v[240:243]
  v_cvt_pk_bf16_f32 v248, v248, v249
  v_mfma_f32_16x16x32_bf16 v[240:243], a[172:175], a[16:19], v[240:243]
  v_cvt_pk_bf16_f32 v249, v250, v251
  v_mfma_f32_16x16x32_bf16 v[240:243], a[168:171], a[216:219], v[240:243]
  s_waitcnt lgkmcnt(4)
  v_mfma_f32_16x16x32_bf16 v[196:199], a[184:187], a[228:231], v[196:199]
  v_cvt_pk_bf16_f32 v244, v244, v245
  v_mfma_f32_16x16x32_bf16 v[196:199], a[188:191], a[244:247], v[196:199]
  v_cvt_pk_bf16_f32 v245, v246, v247
  v_mfma_f32_16x16x32_bf16 v[196:199], a[196:199], a[152:155], v[196:199]
  v_mfma_f32_16x16x32_bf16 v[196:199], a[204:207], a[192:195], v[196:199]
  v_mfma_f32_16x16x32_bf16 v[200:203], a[204:207], a[200:203], v[200:203]
  v_cvt_pk_bf16_f32 v240, v240, v241
  v_mfma_f32_16x16x32_bf16 v[200:203], a[196:199], a[156:159], v[200:203]
  v_cvt_pk_bf16_f32 v241, v242, v243
  v_mfma_f32_16x16x32_bf16 v[200:203], a[188:191], a[248:251], v[200:203]
  v_mfma_f32_16x16x32_bf16 v[200:203], a[184:187], a[232:235], v[200:203]
  v_mfma_f32_16x16x32_bf16 v[204:207], a[184:187], a[236:239], v[204:207]
  v_mfma_f32_16x16x32_bf16 v[204:207], a[188:191], a[252:255], v[204:207]
  v_mfma_f32_16x16x32_bf16 v[204:207], a[196:199], a[160:163], v[204:207]
  v_mfma_f32_16x16x32_bf16 v[204:207], a[204:207], a[208:211], v[204:207]
  s_waitcnt lgkmcnt(0)
  ds_read_b128 a[112:115], v45 offset:4096
  ds_read_b128 a[116:119], v45 offset:13312
  v_mfma_f32_16x16x32_bf16 v[236:239], a[212:215], a[140:143], v[236:239]
  ds_read_b128 a[120:123], v45 offset:22528
  ds_read_b128 a[124:127], v45 offset:31744
  v_mfma_f32_16x16x32_bf16 v[236:239], a[220:223], a[28:31], v[236:239]
  v_mfma_f32_16x16x32_bf16 v[236:239], a[128:131], a[60:63], v[236:239]
  v_mfma_f32_16x16x32_bf16 v[236:239], a[136:139], a[92:95], v[236:239]
  v_mfma_f32_16x16x32_bf16 v[232:235], a[136:139], a[88:91], v[232:235]
  v_mfma_f32_16x16x32_bf16 v[232:235], a[128:131], a[56:59], v[232:235]
  v_mfma_f32_16x16x32_bf16 v[232:235], a[220:223], a[24:27], v[232:235]
  v_mfma_f32_16x16x32_bf16 v[232:235], a[212:215], a[132:135], v[232:235]
  v_mfma_f32_16x16x32_bf16 v[228:231], a[212:215], a[144:147], v[228:231]
  s_nop 2
  v_cvt_pk_bf16_f32 v254, v236, v237
  v_cvt_pk_bf16_f32 v255, v238, v239
  v_mfma_f32_16x16x32_bf16 v[228:231], a[220:223], a[20:23], v[228:231]
  buffer_store_dwordx4 v[252:255], v50, s[4:7], s98 offen offset:0 sc1
  v_mfma_f32_16x16x32_bf16 v[228:231], a[128:131], a[52:55], v[228:231]
  v_mfma_f32_16x16x32_bf16 v[228:231], a[136:139], a[84:87], v[228:231]
  v_mfma_f32_16x16x32_bf16 v[224:227], a[136:139], a[80:83], v[224:227]
  v_cvt_pk_bf16_f32 v250, v232, v233
  v_cvt_pk_bf16_f32 v251, v234, v235
  v_mfma_f32_16x16x32_bf16 v[224:227], a[128:131], a[48:51], v[224:227]
  buffer_store_dwordx4 v[248:251], v50, s[4:7], s66 offen offset:0 sc1
  v_mfma_f32_16x16x32_bf16 v[224:227], a[220:223], a[16:19], v[224:227]
  v_mfma_f32_16x16x32_bf16 v[224:227], a[212:215], a[216:219], v[224:227]
  s_waitcnt lgkmcnt(0)
  ds_read_b128 a[168:171], v46 offset:0
  ds_read_b128 a[172:175], v46 offset:9216
  v_mfma_f32_16x16x32_bf16 v[176:179], a[112:115], a[224:227], v[176:179]
  ds_read_b128 a[176:179], v46 offset:18432
  ds_read_b128 a[180:183], v46 offset:27648
  v_mfma_f32_16x16x32_bf16 v[176:179], a[116:119], a[240:243], v[176:179]
  v_cvt_pk_bf16_f32 v246, v228, v229
  v_cvt_pk_bf16_f32 v247, v230, v231
  v_mfma_f32_16x16x32_bf16 v[176:179], a[120:123], a[148:151], v[176:179]
  buffer_store_dwordx4 v[244:247], v50, s[4:7], s96 offen offset:0 sc1
  v_mfma_f32_16x16x32_bf16 v[176:179], a[124:127], a[164:167], v[176:179]
  v_mfma_f32_16x16x32_bf16 v[180:183], a[124:127], a[192:195], v[180:183]
  v_cvt_pk_bf16_f32 v242, v224, v225
  v_cvt_pk_bf16_f32 v243, v226, v227
  v_mfma_f32_16x16x32_bf16 v[180:183], a[120:123], a[152:155], v[180:183]
  v_mfma_f32_16x16x32_bf16 v[180:183], a[116:119], a[244:247], v[180:183]
  buffer_store_dwordx4 v[240:243], v50, s[4:7], s94 offen offset:0 sc1
  v_mfma_f32_16x16x32_bf16 v[180:183], a[112:115], a[228:231], v[180:183]
  v_mfma_f32_16x16x32_bf16 v[184:187], a[112:115], a[232:235], v[184:187]
  v_mfma_f32_16x16x32_bf16 v[184:187], a[116:119], a[248:251], v[184:187]
  v_mfma_f32_16x16x32_bf16 v[184:187], a[120:123], a[156:159], v[184:187]
  v_mfma_f32_16x16x32_bf16 v[184:187], a[124:127], a[200:203], v[184:187]
  ds_read_b128 a[184:187], v45 offset:6144
  ds_read_b128 a[188:191], v45 offset:15360
  v_mfma_f32_16x16x32_bf16 v[188:191], a[124:127], a[208:211], v[188:191]
  ds_read_b128 a[196:199], v45 offset:24576
  ds_read_b128 a[204:207], v45 offset:33792
  v_mfma_f32_16x16x32_bf16 v[188:191], a[120:123], a[160:163], v[188:191]
  v_mfma_f32_16x16x32_bf16 v[188:191], a[116:119], a[252:255], v[188:191]
  v_mfma_f32_16x16x32_bf16 v[188:191], a[112:115], a[236:239], v[188:191]
  s_waitcnt lgkmcnt(4)
  v_mfma_f32_16x16x32_bf16 v[220:223], a[168:171], a[140:143], v[220:223]
  v_mfma_f32_16x16x32_bf16 v[220:223], a[172:175], a[28:31], v[220:223]
  v_mfma_f32_16x16x32_bf16 v[220:223], a[176:179], a[60:63], v[220:223]
  v_mfma_f32_16x16x32_bf16 v[220:223], a[180:183], a[92:95], v[220:223]
  v_mfma_f32_16x16x32_bf16 v[216:219], a[180:183], a[88:91], v[216:219]
  v_mfma_f32_16x16x32_bf16 v[216:219], a[176:179], a[56:59], v[216:219]
  v_mfma_f32_16x16x32_bf16 v[216:219], a[172:175], a[24:27], v[216:219]
  v_mfma_f32_16x16x32_bf16 v[216:219], a[168:171], a[132:135], v[216:219]
  v_mfma_f32_16x16x32_bf16 v[212:215], a[168:171], a[144:147], v[212:215]
  s_nop 2
  v_cvt_pk_bf16_f32 v220, v220, v221
  v_mfma_f32_16x16x32_bf16 v[212:215], a[172:175], a[20:23], v[212:215]
  v_cvt_pk_bf16_f32 v221, v222, v223
  v_mfma_f32_16x16x32_bf16 v[212:215], a[176:179], a[52:55], v[212:215]
  v_mfma_f32_16x16x32_bf16 v[212:215], a[180:183], a[84:87], v[212:215]
  s_waitcnt lgkmcnt(0)
  ds_read_b128 a[212:215], v46 offset:1024
  ds_read_b128 a[220:223], v46 offset:10240
  v_mfma_f32_16x16x32_bf16 v[160:163], a[184:187], a[224:227], v[160:163]
  ds_read_b128 a[128:131], v46 offset:19456
  ds_read_b128 a[136:139], v46 offset:28672
  v_mfma_f32_16x16x32_bf16 v[160:163], a[188:191], a[240:243], v[160:163]
  v_cvt_pk_bf16_f32 v216, v216, v217
  v_mfma_f32_16x16x32_bf16 v[160:163], a[196:199], a[148:151], v[160:163]
  v_cvt_pk_bf16_f32 v217, v218, v219
  v_mfma_f32_16x16x32_bf16 v[160:163], a[204:207], a[164:167], v[160:163]
  v_mfma_f32_16x16x32_bf16 v[164:167], a[204:207], a[192:195], v[164:167]
  v_cvt_pk_bf16_f32 v212, v212, v213
  v_mfma_f32_16x16x32_bf16 v[164:167], a[196:199], a[152:155], v[164:167]
  v_cvt_pk_bf16_f32 v213, v214, v215
  v_mfma_f32_16x16x32_bf16 v[164:167], a[188:191], a[244:247], v[164:167]
  v_mfma_f32_16x16x32_bf16 v[164:167], a[184:187], a[228:231], v[164:167]
  v_mfma_f32_16x16x32_bf16 v[168:171], a[184:187], a[232:235], v[168:171]
  v_mfma_f32_16x16x32_bf16 v[168:171], a[188:191], a[248:251], v[168:171]
  v_mfma_f32_16x16x32_bf16 v[168:171], a[196:199], a[156:159], v[168:171]
  v_mfma_f32_16x16x32_bf16 v[168:171], a[204:207], a[200:203], v[168:171]
  ds_read_b128 a[112:115], v45 offset:5120
  ds_read_b128 a[116:119], v45 offset:14336
  v_mfma_f32_16x16x32_bf16 v[172:175], a[204:207], a[208:211], v[172:175]
  ds_read_b128 a[120:123], v45 offset:23552
  ds_read_b128 a[124:127], v45 offset:32768
  v_mfma_f32_16x16x32_bf16 v[172:175], a[196:199], a[160:163], v[172:175]
  v_mfma_f32_16x16x32_bf16 v[172:175], a[188:191], a[252:255], v[172:175]
  v_mfma_f32_16x16x32_bf16 v[172:175], a[184:187], a[236:239], v[172:175]
  s_waitcnt lgkmcnt(4)
  v_mfma_f32_16x16x32_bf16 v[204:207], a[212:215], a[140:143], v[204:207]
  v_mfma_f32_16x16x32_bf16 v[204:207], a[220:223], a[28:31], v[204:207]
  v_mfma_f32_16x16x32_bf16 v[204:207], a[128:131], a[60:63], v[204:207]
  v_mfma_f32_16x16x32_bf16 v[204:207], a[136:139], a[92:95], v[204:207]
  v_mfma_f32_16x16x32_bf16 v[200:203], a[136:139], a[88:91], v[200:203]
  v_mfma_f32_16x16x32_bf16 v[200:203], a[128:131], a[56:59], v[200:203]
  v_mfma_f32_16x16x32_bf16 v[200:203], a[220:223], a[24:27], v[200:203]
  v_mfma_f32_16x16x32_bf16 v[200:203], a[212:215], a[132:135], v[200:203]
  v_mfma_f32_16x16x32_bf16 v[196:199], a[212:215], a[144:147], v[196:199]
  s_nop 2
  v_cvt_pk_bf16_f32 v222, v204, v205
  v_cvt_pk_bf16_f32 v223, v206, v207
  v_mfma_f32_16x16x32_bf16 v[196:199], a[220:223], a[20:23], v[196:199]
  buffer_store_dwordx4 v[220:223], v50, s[4:7], s97 offen offset:0 sc1
  v_mfma_f32_16x16x32_bf16 v[196:199], a[128:131], a[52:55], v[196:199]
  v_mfma_f32_16x16x32_bf16 v[196:199], a[136:139], a[84:87], v[196:199]
  s_waitcnt lgkmcnt(0)
  ds_read_b128 a[168:171], v46 offset:4096
  ds_read_b128 a[172:175], v46 offset:13312
  v_mfma_f32_16x16x32_bf16 v[144:147], a[112:115], a[224:227], v[144:147]
  ds_read_b128 a[176:179], v46 offset:22528
  ds_read_b128 a[180:183], v46 offset:31744
  v_mfma_f32_16x16x32_bf16 v[144:147], a[116:119], a[240:243], v[144:147]
  v_cvt_pk_bf16_f32 v218, v200, v201
  v_cvt_pk_bf16_f32 v219, v202, v203
  v_mfma_f32_16x16x32_bf16 v[144:147], a[120:123], a[148:151], v[144:147]
  buffer_store_dwordx4 v[216:219], v50, s[4:7], s65 offen offset:0 sc1
  v_mfma_f32_16x16x32_bf16 v[144:147], a[124:127], a[164:167], v[144:147]
  v_mfma_f32_16x16x32_bf16 v[148:151], a[124:127], a[192:195], v[148:151]
  v_cvt_pk_bf16_f32 v214, v196, v197
  v_cvt_pk_bf16_f32 v215, v198, v199
  v_mfma_f32_16x16x32_bf16 v[148:151], a[120:123], a[152:155], v[148:151]
  v_mfma_f32_16x16x32_bf16 v[148:151], a[116:119], a[244:247], v[148:151]
  buffer_store_dwordx4 v[212:215], v50, s[4:7], s95 offen offset:0 sc1
  v_mfma_f32_16x16x32_bf16 v[148:151], a[112:115], a[228:231], v[148:151]
  v_mfma_f32_16x16x32_bf16 v[152:155], a[112:115], a[232:235], v[152:155]
  v_mfma_f32_16x16x32_bf16 v[152:155], a[116:119], a[248:251], v[152:155]
  v_mfma_f32_16x16x32_bf16 v[152:155], a[120:123], a[156:159], v[152:155]
  v_mfma_f32_16x16x32_bf16 v[152:155], a[124:127], a[200:203], v[152:155]
  v_mfma_f32_16x16x32_bf16 v[156:159], a[124:127], a[208:211], v[156:159]
  v_mfma_f32_16x16x32_bf16 v[156:159], a[120:123], a[160:163], v[156:159]
  v_mfma_f32_16x16x32_bf16 v[156:159], a[116:119], a[252:255], v[156:159]
  v_mfma_f32_16x16x32_bf16 v[156:159], a[112:115], a[236:239], v[156:159]
  s_waitcnt lgkmcnt(0)
  ds_read_b128 a[184:187], v45 offset:2048
  ds_read_b128 a[188:191], v45 offset:11264
  v_mfma_f32_16x16x32_bf16 v[188:191], a[168:171], a[140:143], v[188:191]
  ds_read_b128 a[196:199], v45 offset:20480
  ds_read_b128 a[204:207], v45 offset:29696
  v_mfma_f32_16x16x32_bf16 v[188:191], a[172:175], a[28:31], v[188:191]
  v_mfma_f32_16x16x32_bf16 v[188:191], a[176:179], a[60:63], v[188:191]
  v_mfma_f32_16x16x32_bf16 v[188:191], a[180:183], a[92:95], v[188:191]
  v_mfma_f32_16x16x32_bf16 v[184:187], a[180:183], a[88:91], v[184:187]
  v_mfma_f32_16x16x32_bf16 v[184:187], a[176:179], a[56:59], v[184:187]
  v_mfma_f32_16x16x32_bf16 v[184:187], a[172:175], a[24:27], v[184:187]
  v_mfma_f32_16x16x32_bf16 v[184:187], a[168:171], a[132:135], v[184:187]
  v_mfma_f32_16x16x32_bf16 v[180:183], a[168:171], a[144:147], v[180:183]
  s_nop 2
  v_cvt_pk_bf16_f32 v188, v188, v189
  v_mfma_f32_16x16x32_bf16 v[180:183], a[172:175], a[20:23], v[180:183]
  v_cvt_pk_bf16_f32 v189, v190, v191
  v_mfma_f32_16x16x32_bf16 v[180:183], a[176:179], a[52:55], v[180:183]
  buffer_store_dwordx2 v[188:189], v33, s[4:7], s98 offen offset:2048 sc1
  v_mfma_f32_16x16x32_bf16 v[180:183], a[180:183], a[84:87], v[180:183]
  ds_read_b128 a[212:215], v46 offset:6144
  ds_read_b128 a[220:223], v46 offset:15360
  v_mfma_f32_16x16x32_bf16 v[176:179], a[180:183], a[80:83], v[176:179]
  ds_read_b128 a[128:131], v46 offset:24576
  ds_read_b128 a[136:139], v46 offset:33792
  v_mfma_f32_16x16x32_bf16 v[176:179], a[176:179], a[48:51], v[176:179]
  v_cvt_pk_bf16_f32 v184, v184, v185
  v_mfma_f32_16x16x32_bf16 v[176:179], a[172:175], a[16:19], v[176:179]
  buffer_store_dwordx2 v[188:189], v32, s[4:7], s97 offen offset:2048 sc1
  v_mfma_f32_16x16x32_bf16 v[176:179], a[168:171], a[216:219], v[176:179]
  s_waitcnt lgkmcnt(4)
  v_cvt_pk_bf16_f32 v185, v186, v187
  v_mfma_f32_16x16x32_bf16 v[132:135], a[184:187], a[228:231], v[132:135]
  v_cvt_pk_bf16_f32 v180, v180, v181
  v_mfma_f32_16x16x32_bf16 v[132:135], a[188:191], a[244:247], v[132:135]
  v_cvt_pk_bf16_f32 v181, v182, v183
  v_mfma_f32_16x16x32_bf16 v[132:135], a[196:199], a[152:155], v[132:135]
  buffer_store_dwordx2 v[184:185], v33, s[4:7], s66 offen offset:2048 sc1
  v_mfma_f32_16x16x32_bf16 v[132:135], a[204:207], a[192:195], v[132:135]
  v_mfma_f32_16x16x32_bf16 v[136:139], a[204:207], a[200:203], v[136:139]
  v_cvt_pk_bf16_f32 v108, v176, v177
  v_cvt_pk_bf16_f32 v109, v178, v179
  v_mfma_f32_16x16x32_bf16 v[136:139], a[196:199], a[156:159], v[136:139]
  v_mfma_f32_16x16x32_bf16 v[136:139], a[188:191], a[248:251], v[136:139]
  buffer_store_dwordx2 v[184:185], v32, s[4:7], s65 offen offset:2048 sc1
  v_mfma_f32_16x16x32_bf16 v[136:139], a[184:187], a[232:235], v[136:139]
  v_mfma_f32_16x16x32_bf16 v[140:143], a[184:187], a[236:239], v[140:143]
  v_mfma_f32_16x16x32_bf16 v[140:143], a[188:191], a[252:255], v[140:143]
  v_mfma_f32_16x16x32_bf16 v[140:143], a[196:199], a[160:163], v[140:143]
  buffer_store_dwordx2 v[180:181], v33, s[4:7], s96 offen offset:2048 sc1
  v_mfma_f32_16x16x32_bf16 v[140:143], a[204:207], a[208:211], v[140:143]
  s_waitcnt lgkmcnt(0)
  ds_read_b128 a[112:115], v45 offset:3072
  ds_read_b128 a[116:119], v45 offset:12288
  v_mfma_f32_16x16x32_bf16 v[172:175], a[212:215], a[140:143], v[172:175]
  ds_read_b128 a[120:123], v45 offset:21504
  ds_read_b128 a[124:127], v45 offset:30720
  v_mfma_f32_16x16x32_bf16 v[172:175], a[220:223], a[28:31], v[172:175]
  v_mfma_f32_16x16x32_bf16 v[172:175], a[128:131], a[60:63], v[172:175]
  buffer_store_dwordx2 v[180:181], v32, s[4:7], s95 offen offset:2048 sc1
  v_mfma_f32_16x16x32_bf16 v[172:175], a[136:139], a[92:95], v[172:175]
  v_mfma_f32_16x16x32_bf16 v[168:171], a[136:139], a[88:91], v[168:171]
  v_mfma_f32_16x16x32_bf16 v[168:171], a[128:131], a[56:59], v[168:171]
  v_mfma_f32_16x16x32_bf16 v[168:171], a[220:223], a[24:27], v[168:171]
  buffer_store_dwordx2 v[108:109], v33, s[4:7], s94 offen offset:2048 sc1
  v_mfma_f32_16x16x32_bf16 v[168:171], a[212:215], a[132:135], v[168:171]
  v_mfma_f32_16x16x32_bf16 v[164:167], a[212:215], a[144:147], v[164:167]
  s_nop 1
  v_cvt_pk_bf16_f32 v172, v172, v173
  v_mfma_f32_16x16x32_bf16 v[164:167], a[220:223], a[20:23], v[164:167]
  v_cvt_pk_bf16_f32 v173, v174, v175
  v_mfma_f32_16x16x32_bf16 v[164:167], a[128:131], a[52:55], v[164:167]
  v_mfma_f32_16x16x32_bf16 v[164:167], a[136:139], a[84:87], v[164:167]
  ds_read_b128 a[168:171], v46 offset:5120
  ds_read_b128 a[172:175], v46 offset:14336
  v_mfma_f32_16x16x32_bf16 v[160:163], a[136:139], a[80:83], v[160:163]
  ds_read_b128 a[176:179], v46 offset:23552
  ds_read_b128 a[180:183], v46 offset:32768
  v_mfma_f32_16x16x32_bf16 v[160:163], a[128:131], a[48:51], v[160:163]
  v_cvt_pk_bf16_f32 v168, v168, v169
  v_mfma_f32_16x16x32_bf16 v[160:163], a[220:223], a[16:19], v[160:163]
  v_cvt_pk_bf16_f32 v169, v170, v171
  v_mfma_f32_16x16x32_bf16 v[160:163], a[212:215], a[216:219], v[160:163]
  s_waitcnt lgkmcnt(4)
  v_mfma_f32_16x16x32_bf16 v[116:119], a[112:115], a[228:231], v[116:119]
  v_cvt_pk_bf16_f32 v164, v164, v165
  v_mfma_f32_16x16x32_bf16 v[116:119], a[116:119], a[244:247], v[116:119]
  v_cvt_pk_bf16_f32 v165, v166, v167
  v_mfma_f32_16x16x32_bf16 v[116:119], a[120:123], a[152:155], v[116:119]
  v_mfma_f32_16x16x32_bf16 v[116:119], a[124:127], a[192:195], v[116:119]
  v_mfma_f32_16x16x32_bf16 v[120:123], a[124:127], a[200:203], v[120:123]
  v_cvt_pk_bf16_f32 v160, v160, v161
  v_mfma_f32_16x16x32_bf16 v[120:123], a[120:123], a[156:159], v[120:123]
  v_cvt_pk_bf16_f32 v161, v162, v163
  v_mfma_f32_16x16x32_bf16 v[120:123], a[116:119], a[248:251], v[120:123]
  v_mfma_f32_16x16x32_bf16 v[120:123], a[112:115], a[232:235], v[120:123]
  v_mfma_f32_16x16x32_bf16 v[124:127], a[112:115], a[236:239], v[124:127]
  v_mfma_f32_16x16x32_bf16 v[124:127], a[116:119], a[252:255], v[124:127]
  v_mfma_f32_16x16x32_bf16 v[124:127], a[120:123], a[160:163], v[124:127]
  v_mfma_f32_16x16x32_bf16 v[124:127], a[124:127], a[208:211], v[124:127]
  s_waitcnt lgkmcnt(0)
  ds_read_b128 a[184:187], v46 offset:2048
  ds_read_b128 a[188:191], v46 offset:11264
  v_mfma_f32_16x16x32_bf16 v[156:159], a[168:171], a[140:143], v[156:159]
  ds_read_b128 a[196:199], v46 offset:20480
  ds_read_b128 a[204:207], v46 offset:29696
  v_mfma_f32_16x16x32_bf16 v[156:159], a[172:175], a[28:31], v[156:159]
  s_waitcnt vmcnt(18)
  v_lshlrev_b32 v240, 16, v98
  v_and_b32 v241, 0xffff0000, v98
  v_mfma_f32_16x16x32_bf16 v[156:159], a[176:179], a[60:63], v[156:159]
  v_lshlrev_b32 v242, 16, v99
  v_and_b32 v243, 0xffff0000, v99
  v_mfma_f32_16x16x32_bf16 v[156:159], a[180:183], a[92:95], v[156:159]
  s_waitcnt vmcnt(17)
  v_lshlrev_b32 v244, 16, v100
  v_and_b32 v245, 0xffff0000, v100
  v_mfma_f32_16x16x32_bf16 v[152:155], a[180:183], a[88:91], v[152:155]
  v_lshlrev_b32 v246, 16, v101
  v_and_b32 v247, 0xffff0000, v101
  v_mfma_f32_16x16x32_bf16 v[152:155], a[176:179], a[56:59], v[152:155]
  s_waitcnt vmcnt(16)
  v_lshlrev_b32 v248, 16, v102
  v_and_b32 v249, 0xffff0000, v102
  v_mfma_f32_16x16x32_bf16 v[152:155], a[172:175], a[24:27], v[152:155]
  buffer_load_dword v59, v13, s[4:7], s48 offen sc1
  v_mfma_f32_16x16x32_bf16 v[152:155], a[168:171], a[132:135], v[152:155]
  v_lshlrev_b32 v250, 16, v103
  v_and_b32 v251, 0xffff0000, v103
  v_mfma_f32_16x16x32_bf16 v[148:151], a[168:171], a[144:147], v[148:151]
  v_cvt_pk_bf16_f32 v174, v156, v157
  v_cvt_pk_bf16_f32 v175, v158, v159
  v_mfma_f32_16x16x32_bf16 v[148:151], a[172:175], a[20:23], v[148:151]
  buffer_store_dwordx4 v[172:175], v50, s[4:7], s98 offen offset:1024 sc1
  v_mfma_f32_16x16x32_bf16 v[148:151], a[176:179], a[52:55], v[148:151]
  s_waitcnt vmcnt(17)
  v_lshlrev_b32 v252, 16, v104
  v_and_b32 v253, 0xffff0000, v104
  v_mfma_f32_16x16x32_bf16 v[148:151], a[180:183], a[84:87], v[148:151]
  ds_read_b128 a[212:215], v46 offset:3072
  ds_read_b128 a[220:223], v46 offset:12288
  v_mfma_f32_16x16x32_bf16 v[144:147], a[180:183], a[80:83], v[144:147]
  ds_read_b128 a[128:131], v46 offset:21504
  ds_read_b128 a[136:139], v46 offset:30720
  v_mfma_f32_16x16x32_bf16 v[144:147], a[176:179], a[48:51], v[144:147]
  v_cvt_pk_bf16_f32 v170, v152, v153
  v_cvt_pk_bf16_f32 v171, v154, v155
  v_mfma_f32_16x16x32_bf16 v[144:147], a[172:175], a[16:19], v[144:147]
  buffer_store_dwordx4 v[168:171], v50, s[4:7], s66 offen offset:1024 sc1
  v_mfma_f32_16x16x32_bf16 v[144:147], a[168:171], a[216:219], v[144:147]
pad_p3_end8_1:
  s_cbranch_execz warm_P
  s_waitcnt lgkmcnt(4)
  v_lshlrev_b32 v254, 16, v105
  v_and_b32 v255, 0xffff0000, v105
  v_mfma_f32_16x16x32_bf16 v[132:135], a[184:187], a[144:147], v[132:135]
  v_cvt_pk_bf16_f32 v166, v148, v149
  v_cvt_pk_bf16_f32 v167, v150, v151
  v_mfma_f32_16x16x32_bf16 v[132:135], a[188:191], a[20:23], v[132:135]
  s_waitcnt vmcnt(17)
  v_lshlrev_b32 v180, 16, v106
  v_and_b32 v181, 0xffff0000, v106
  v_mfma_f32_16x16x32_bf16 v[132:135], a[196:199], a[52:55], v[132:135]
  buffer_store_dwordx4 v[164:167], v50, s[4:7], s96 offen offset:1024 sc1
  v_mfma_f32_16x16x32_bf16 v[132:135], a[204:207], a[84:87], v[132:135]
  v_lshlrev_b32 v182, 16, v107
  v_and_b32 v183, 0xffff0000, v107
  v_mfma_f32_16x16x32_bf16 v[136:139], a[204:207], a[88:91], v[136:139]
  v_cvt_pk_bf16_f32 v162, v144, v145
  v_cvt_pk_bf16_f32 v163, v146, v147
  v_mfma_f32_16x16x32_bf16 v[136:139], a[196:199], a[56:59], v[136:139]
  v_mfma_f32_16x16x32_bf16 v[136:139], a[188:191], a[24:27], v[136:139]
  buffer_store_dwordx4 v[160:163], v50, s[4:7], s94 offen offset:1024 sc1
  v_mfma_f32_16x16x32_bf16 v[136:139], a[184:187], a[132:135], v[136:139]
  ds_read_b128 a[112:115], v45 offset:0
  ds_read_b128 a[116:119], v45 offset:9216
  v_mfma_f32_16x16x32_bf16 v[140:143], a[184:187], a[140:143], v[140:143]
  ds_read_b128 a[120:123], v45 offset:18432
  ds_read_b128 a[124:127], v45 offset:27648
  v_mfma_f32_16x16x32_bf16 v[140:143], a[188:191], a[28:31], v[140:143]
  v_cvt_pk_bf16_f32 v132, v132, v133
  v_mfma_f32_16x16x32_bf16 v[140:143], a[196:199], a[60:63], v[140:143]
  v_cvt_pk_bf16_f32 v133, v134, v135
  v_mfma_f32_16x16x32_bf16 v[140:143], a[204:207], a[92:95], v[140:143]
  s_waitcnt lgkmcnt(4)
  ds_read_b128 a[168:171], v46 offset:0
  ds_read_b128 a[172:175], v46 offset:9216
  v_mfma_f32_16x16x32_bf16 v[124:127], a[212:215], a[140:143], v[124:127]
  ds_read_b128 a[176:179], v46 offset:18432
  ds_read_b128 a[180:183], v46 offset:27648
  v_mfma_f32_16x16x32_bf16 v[124:127], a[220:223], a[28:31], v[124:127]
  v_cvt_pk_bf16_f32 v136, v136, v137
  v_mfma_f32_16x16x32_bf16 v[124:127], a[128:131], a[60:63], v[124:127]
  v_cvt_pk_bf16_f32 v137, v138, v139
  v_mfma_f32_16x16x32_bf16 v[124:127], a[136:139], a[92:95], v[124:127]
  ds_read_b128 a[184:187], v45 offset:1024
  ds_read_b128 a[188:191], v45 offset:10240
  v_mfma_f32_16x16x32_bf16 v[120:123], a[136:139], a[88:91], v[120:123]
  ds_read_b128 a[196:199], v45 offset:19456
  ds_read_b128 a[204:207], v45 offset:28672
  v_mfma_f32_16x16x32_bf16 v[120:123], a[128:131], a[56:59], v[120:123]
  v_cvt_pk_bf16_f32 v140, v140, v141
  v_mfma_f32_16x16x32_bf16 v[120:123], a[220:223], a[24:27], v[120:123]
  v_cvt_pk_bf16_f32 v141, v142, v143
  v_mfma_f32_16x16x32_bf16 v[120:123], a[212:215], a[132:135], v[120:123]
  v_mfma_f32_16x16x32_bf16 v[116:119], a[212:215], a[144:147], v[116:119]
  v_cvt_pk_bf16_f32 v142, v124, v125
  v_cvt_pk_bf16_f32 v143, v126, v127
  v_mfma_f32_16x16x32_bf16 v[116:119], a[220:223], a[20:23], v[116:119]
  buffer_store_dwordx4 v[140:143], v50, s[4:7], s97 offen offset:1024 sc1
  v_mfma_f32_16x16x32_bf16 v[116:119], a[128:131], a[52:55], v[116:119]
  v_mfma_f32_16x16x32_bf16 v[116:119], a[136:139], a[84:87], v[116:119]
  s_waitcnt lgkmcnt(8)
  ds_read_b128 a[212:215], v46 offset:1024
  ds_read_b128 a[220:223], v46 offset:10240
  v_mfma_f32_16x16x32_bf16 v[208:211], a[112:115], a[224:227], v[208:211]
  ds_read_b128 a[128:131], v46 offset:19456
  ds_read_b128 a[136:139], v46 offset:28672
  v_mfma_f32_16x16x32_bf16 v[208:211], a[116:119], a[240:243], v[208:211]
  v_cvt_pk_bf16_f32 v138, v120, v121
  v_cvt_pk_bf16_f32 v139, v122, v123
  v_mfma_f32_16x16x32_bf16 v[208:211], a[120:123], a[148:151], v[208:211]
  buffer_store_dwordx4 v[136:139], v50, s[4:7], s65 offen offset:1024 sc1
  v_mfma_f32_16x16x32_bf16 v[208:211], a[124:127], a[164:167], v[208:211]
  s_waitcnt lgkmcnt(8)
  ds_read_b128 a[112:115], v45 offset:2048
  ds_read_b128 a[116:119], v45 offset:11264
  v_mfma_f32_16x16x32_bf16 v[208:211], a[168:171], a[216:219], v[208:211]
  s_add_u32 s94, s50, 0
  ds_read_b128 a[120:123], v45 offset:20480
  ds_read_b128 a[124:127], v45 offset:29696
  v_mfma_f32_16x16x32_bf16 v[208:211], a[172:175], a[16:19], v[208:211]
  s_add_u32 s96, s50, 5120
  v_cvt_pk_bf16_f32 v134, v116, v117
  v_cvt_pk_bf16_f32 v135, v118, v119
  v_mfma_f32_16x16x32_bf16 v[208:211], a[176:179], a[48:51], v[208:211]
  buffer_store_dwordx4 v[132:135], v50, s[4:7], s95 offen offset:1024 sc1
  v_mfma_f32_16x16x32_bf16 v[208:211], a[180:183], a[80:83], v[208:211]
  s_waitcnt lgkmcnt(8)
  ds_read_b128 a[168:171], v46 offset:2048
  ds_read_b128 a[172:175], v46 offset:11264
  s_waitcnt vmcnt(7)
  v_cmp_ne_u32 vcc, 0, v59
  v_mfma_f32_16x16x32_bf16 v[192:195], a[184:187], a[224:227], v[192:195]
  s_and_b32 s75, vcc_lo, 0xfe
  ds_read_b128 a[176:179], v46 offset:20480
  ds_read_b128 a[180:183], v46 offset:29696
  v_mfma_f32_16x16x32_bf16 v[192:195], a[188:191], a[240:243], v[192:195]
  s_bitcmp1_b32 s75, 1
  s_cselect_b32 s94, s94, 0x70000000
  v_mfma_f32_16x16x32_bf16 v[192:195], a[196:199], a[148:151], v[192:195]
  s_add_u32 s95, s50, 2560
  v_mfma_f32_16x16x32_bf16 v[192:195], a[204:207], a[164:167], v[192:195]
  s_waitcnt lgkmcnt(8)
  ds_read_b128 a[184:187], v45 offset:3072
  ds_read_b128 a[188:191], v45 offset:12288
  v_mfma_f32_16x16x32_bf16 v[192:195], a[212:215], a[216:219], v[192:195]
  s_add_u32 s65, s50, 7680
  ds_read_b128 a[196:199], v45 offset:21504
  ds_read_b128 a[204:207], v45 offset:30720
  v_mfma_f32_16x16x32_bf16 v[192:195], a[220:223], a[16:19], v[192:195]
  buffer_load_dwordx4 v[224:227], v50, s[4:7], s94 offen offset:0 sc1
  v_mfma_f32_16x16x32_bf16 v[192:195], a[128:131], a[48:51], v[192:195]
  s_bitcmp1_b32 s75, 2
  s_cselect_b32 s95, s95, 0x70000000
  v_mfma_f32_16x16x32_bf16 v[192:195], a[136:139], a[80:83], v[192:195]
  s_waitcnt lgkmcnt(8)
  ds_read_b128 a[212:215], v46 offset:3072
  ds_read_b128 a[220:223], v46 offset:12288
  v_mfma_f32_16x16x32_bf16 v[128:131], a[112:115], a[224:227], v[128:131]
  s_add_u32 s66, s50, 10240
  ds_read_b128 a[128:131], v46 offset:21504
  ds_read_b128 a[136:139], v46 offset:30720
  v_mfma_f32_16x16x32_bf16 v[128:131], a[116:119], a[240:243], v[128:131]
  buffer_load_dwordx4 v[196:199], v50, s[4:7], s95 offen offset:0 sc1
  v_mfma_f32_16x16x32_bf16 v[128:131], a[120:123], a[148:151], v[128:131]
  s_bitcmp1_b32 s75, 3
  s_cselect_b32 s96, s96, 0x70000000
  v_mfma_f32_16x16x32_bf16 v[128:131], a[124:127], a[164:167], v[128:131]
  s_waitcnt lgkmcnt(8)
  buffer_load_dwordx4 v[228:231], v50, s[4:7], s96 offen offset:0 sc1
  v_mfma_f32_16x16x32_bf16 v[128:131], a[168:171], a[216:219], v[128:131]
  s_bitcmp1_b32 s75, 4
  s_cselect_b32 s65, s65, 0x70000000
  v_mfma_f32_16x16x32_bf16 v[128:131], a[172:175], a[16:19], v[128:131]
  buffer_load_dwordx4 v[200:203], v50, s[4:7], s65 offen offset:0 sc1
  v_mfma_f32_16x16x32_bf16 v[128:131], a[176:179], a[48:51], v[128:131]
  s_bitcmp1_b32 s75, 5
  s_cselect_b32 s66, s66, 0x70000000
  v_mfma_f32_16x16x32_bf16 v[128:131], a[180:183], a[80:83], v[128:131]
  s_waitcnt lgkmcnt(4)
  buffer_load_dwordx4 v[232:235], v50, s[4:7], s66 offen offset:0 sc1
  v_mfma_f32_16x16x32_bf16 v[112:115], a[184:187], a[224:227], v[112:115]
  s_add_u32 s97, s50, 12800
  v_mfma_f32_16x16x32_bf16 v[112:115], a[188:191], a[240:243], v[112:115]
  s_bitcmp1_b32 s75, 6
  s_cselect_b32 s97, s97, 0x70000000
  v_mfma_f32_16x16x32_bf16 v[112:115], a[196:199], a[148:151], v[112:115]
  s_add_u32 s98, s50, 15360
  v_mfma_f32_16x16x32_bf16 v[112:115], a[204:207], a[164:167], v[112:115]
  s_waitcnt lgkmcnt(0)
  buffer_load_dwordx4 v[204:207], v50, s[4:7], s97 offen offset:0 sc1
  v_mfma_f32_16x16x32_bf16 v[112:115], a[212:215], a[216:219], v[112:115]
  s_bitcmp1_b32 s75, 7
  s_cselect_b32 s98, s98, 0x70000000
  v_mfma_f32_16x16x32_bf16 v[112:115], a[220:223], a[16:19], v[112:115]
  buffer_load_dwordx4 v[236:239], v50, s[4:7], s98 offen offset:0 sc1
  v_mfma_f32_16x16x32_bf16 v[112:115], a[128:131], a[48:51], v[112:115]
  v_mfma_f32_16x16x32_bf16 v[112:115], a[136:139], a[80:83], v[112:115]
  s_branch p3_tail
p3_end9:
pad_p3_end9_0:
  s_cbranch_execz warm_P
  v_mfma_f32_16x16x32_bf16 v[252:255], a[212:215], a[140:143], v[252:255]
  ds_read_b128 a[120:123], v46 offset:25600
  ds_read_b128 a[124:127], v46 offset:34816
  v_mfma_f32_16x16x32_bf16 v[252:255], a[220:223], a[28:31], v[252:255]
  s_waitcnt vmcnt(30)
  v_mfma_f32_16x16x32_bf16 v[252:255], a[128:131], a[60:63], v[252:255]
  s_waitcnt vmcnt(26)
  v_mfma_f32_16x16x32_bf16 v[252:255], a[136:139], a[92:95], v[252:255]
  v_mfma_f32_16x16x32_bf16 v[248:251], a[136:139], a[88:91], v[248:251]
  v_mfma_f32_16x16x32_bf16 v[248:251], a[128:131], a[56:59], v[248:251]
  v_mfma_f32_16x16x32_bf16 v[248:251], a[220:223], a[24:27], v[248:251]
  v_mfma_f32_16x16x32_bf16 v[248:251], a[212:215], a[132:135], v[248:251]
  v_mfma_f32_16x16x32_bf16 v[244:247], a[212:215], a[144:147], v[244:247]
  v_mfma_f32_16x16x32_bf16 v[244:247], a[220:223], a[20:23], v[244:247]
  v_mfma_f32_16x16x32_bf16 v[244:247], a[128:131], a[52:55], v[244:247]
  buffer_load_dwordx2 v[98:99], v7, s[36:39], s53 offen
  v_mfma_f32_16x16x32_bf16 v[244:247], a[136:139], a[84:87], v[244:247]
  v_mfma_f32_16x16x32_bf16 v[240:243], a[136:139], a[80:83], v[240:243]
  v_mfma_f32_16x16x32_bf16 v[240:243], a[128:131], a[48:51], v[240:243]
  v_mfma_f32_16x16x32_bf16 v[240:243], a[220:223], a[16:19], v[240:243]
  v_mfma_f32_16x16x32_bf16 v[240:243], a[212:215], a[216:219], v[240:243]
  s_waitcnt lgkmcnt(0)
  ds_read_b128 a[168:171], v46 offset:0
  ds_read_b128 a[172:175], v46 offset:9216
  v_mfma_f32_16x16x32_bf16 v[224:227], a[112:115], a[216:219], v[224:227]
  ds_read_b128 a[176:179], v46 offset:18432
  ds_read_b128 a[180:183], v46 offset:27648
  v_mfma_f32_16x16x32_bf16 v[224:227], a[116:119], a[16:19], v[224:227]
  buffer_load_dwordx2 v[100:101], v8, s[36:39], s53 offen
  v_mfma_f32_16x16x32_bf16 v[224:227], a[120:123], a[48:51], v[224:227]
  v_mfma_f32_16x16x32_bf16 v[224:227], a[124:127], a[80:83], v[224:227]
  v_mfma_f32_16x16x32_bf16 v[228:231], a[124:127], a[84:87], v[228:231]
  buffer_load_dwordx2 v[102:103], v9, s[36:39], s53 offen
  v_mfma_f32_16x16x32_bf16 v[228:231], a[120:123], a[52:55], v[228:231]
  v_mfma_f32_16x16x32_bf16 v[228:231], a[116:119], a[20:23], v[228:231]
  v_mfma_f32_16x16x32_bf16 v[228:231], a[112:115], a[144:147], v[228:231]
  v_mfma_f32_16x16x32_bf16 v[232:235], a[112:115], a[132:135], v[232:235]
  v_mfma_f32_16x16x32_bf16 v[232:235], a[116:119], a[24:27], v[232:235]
  s_waitcnt vmcnt(20) lgkmcnt(0)
  s_barrier
  v_mfma_f32_16x16x32_bf16 v[232:235], a[120:123], a[56:59], v[232:235]
  buffer_load_dwordx2 v[104:105], v10, s[36:39], s53 offen
  v_mfma_f32_16x16x32_bf16 v[232:235], a[124:127], a[88:91], v[232:235]
  ds_read_b128 a[184:187], v47 offset:8192
  ds_read_b128 a[188:191], v47 offset:17408
  v_mfma_f32_16x16x32_bf16 v[236:239], a[124:127], a[92:95], v[236:239]
  ds_read_b128 a[196:199], v47 offset:26624
  ds_read_b128 a[204:207], v47 offset:35840
  v_mfma_f32_16x16x32_bf16 v[236:239], a[120:123], a[60:63], v[236:239]
  v_mfma_f32_16x16x32_bf16 v[236:239], a[116:119], a[28:31], v[236:239]
  buffer_load_dwordx2 v[106:107], v11, s[36:39], s53 offen
  v_mfma_f32_16x16x32_bf16 v[236:239], a[112:115], a[140:143], v[236:239]
  v_mfma_f32_16x16x32_bf16 v[220:223], a[168:171], a[140:143], v[220:223]
  v_mfma_f32_16x16x32_bf16 v[220:223], a[172:175], a[28:31], v[220:223]
  v_mfma_f32_16x16x32_bf16 v[220:223], a[176:179], a[60:63], v[220:223]
  v_mfma_f32_16x16x32_bf16 v[220:223], a[180:183], a[92:95], v[220:223]
  v_mfma_f32_16x16x32_bf16 v[216:219], a[180:183], a[88:91], v[216:219]
  v_mfma_f32_16x16x32_bf16 v[216:219], a[176:179], a[56:59], v[216:219]
  v_mfma_f32_16x16x32_bf16 v[216:219], a[172:175], a[24:27], v[216:219]
  v_mfma_f32_16x16x32_bf16 v[216:219], a[168:171], a[132:135], v[216:219]
  v_mfma_f32_16x16x32_bf16 v[212:215], a[168:171], a[144:147], v[212:215]
  v_mfma_f32_16x16x32_bf16 v[212:215], a[172:175], a[20:23], v[212:215]
  v_mfma_f32_16x16x32_bf16 v[212:215], a[176:179], a[52:55], v[212:215]
  v_mfma_f32_16x16x32_bf16 v[212:215], a[180:183], a[84:87], v[212:215]
  s_waitcnt vmcnt(21) lgkmcnt(0)
  ds_read_b128 a[212:215], v46 offset:1024
  ds_read_b128 a[220:223], v46 offset:10240
  v_mfma_f32_16x16x32_bf16 v[240:243], a[184:187], a[0:3], v[240:243]
  s_waitcnt vmcnt(17)
  ds_read_b128 a[128:131], v46 offset:19456
  ds_read_b128 a[136:139], v46 offset:28672
  v_mfma_f32_16x16x32_bf16 v[240:243], a[188:191], a[32:35], v[240:243]
  s_waitcnt vmcnt(13)
  v_mfma_f32_16x16x32_bf16 v[240:243], a[196:199], a[64:67], v[240:243]
  s_waitcnt vmcnt(8)
  v_mfma_f32_16x16x32_bf16 v[240:243], a[204:207], a[96:99], v[240:243]
  s_waitcnt vmcnt(7)
  v_mfma_f32_16x16x32_bf16 v[244:247], a[204:207], a[100:103], v[244:247]
  v_mfma_f32_16x16x32_bf16 v[244:247], a[196:199], a[68:71], v[244:247]
  v_mfma_f32_16x16x32_bf16 v[244:247], a[188:191], a[36:39], v[244:247]
  v_mfma_f32_16x16x32_bf16 v[244:247], a[184:187], a[4:7], v[244:247]
  v_mfma_f32_16x16x32_bf16 v[248:251], a[184:187], a[8:11], v[248:251]
  s_nop 1
  v_cvt_pk_bf16_f32 v240, v240, v241
  v_mfma_f32_16x16x32_bf16 v[248:251], a[188:191], a[40:43], v[248:251]
  v_cvt_pk_bf16_f32 v241, v242, v243
  v_mfma_f32_16x16x32_bf16 v[248:251], a[196:199], a[72:75], v[248:251]
  s_waitcnt vmcnt(6)
  v_mfma_f32_16x16x32_bf16 v[248:251], a[204:207], a[104:107], v[248:251]
  s_waitcnt vmcnt(5)
  ds_read_b128 a[112:115], v47 offset:7168
  ds_read_b128 a[116:119], v47 offset:16384
  v_mfma_f32_16x16x32_bf16 v[252:255], a[204:207], a[108:111], v[252:255]
  ds_read_b128 a[120:123], v47 offset:25600
  ds_read_b128 a[124:127], v47 offset:34816
  v_mfma_f32_16x16x32_bf16 v[252:255], a[196:199], a[76:79], v[252:255]
  v_cvt_pk_bf16_f32 v244, v244, v245
  v_mfma_f32_16x16x32_bf16 v[252:255], a[188:191], a[44:47], v[252:255]
  v_cvt_pk_bf16_f32 v245, v246, v247
  v_mfma_f32_16x16x32_bf16 v[252:255], a[184:187], a[12:15], v[252:255]
  s_waitcnt lgkmcnt(4)
  v_mfma_f32_16x16x32_bf16 v[204:207], a[212:215], a[140:143], v[204:207]
  v_cvt_pk_bf16_f32 v248, v248, v249
  v_mfma_f32_16x16x32_bf16 v[204:207], a[220:223], a[28:31], v[204:207]
  v_cvt_pk_bf16_f32 v249, v250, v251
  v_mfma_f32_16x16x32_bf16 v[204:207], a[128:131], a[60:63], v[204:207]
  v_mfma_f32_16x16x32_bf16 v[204:207], a[136:139], a[92:95], v[204:207]
  v_mfma_f32_16x16x32_bf16 v[200:203], a[136:139], a[88:91], v[200:203]
  v_cvt_pk_bf16_f32 v252, v252, v253
  v_mfma_f32_16x16x32_bf16 v[200:203], a[128:131], a[56:59], v[200:203]
  v_cvt_pk_bf16_f32 v253, v254, v255
  v_mfma_f32_16x16x32_bf16 v[200:203], a[220:223], a[24:27], v[200:203]
  v_mfma_f32_16x16x32_bf16 v[200:203], a[212:215], a[132:135], v[200:203]
  v_mfma_f32_16x16x32_bf16 v[196:199], a[212:215], a[144:147], v[196:199]
  v_mfma_f32_16x16x32_bf16 v[196:199], a[220:223], a[20:23], v[196:199]
  v_mfma_f32_16x16x32_bf16 v[196:199], a[128:131], a[52:55], v[196:199]
  v_mfma_f32_16x16x32_bf16 v[196:199], a[136:139], a[84:87], v[196:199]
  s_waitcnt lgkmcnt(0)
  ds_read_b128 a[168:171], v46 offset:4096
  ds_read_b128 a[172:175], v46 offset:13312
  v_mfma_f32_16x16x32_bf16 v[224:227], a[112:115], a[0:3], v[224:227]
  ds_read_b128 a[176:179], v46 offset:22528
  ds_read_b128 a[180:183], v46 offset:31744
  v_mfma_f32_16x16x32_bf16 v[224:227], a[116:119], a[32:35], v[224:227]
  v_mfma_f32_16x16x32_bf16 v[224:227], a[120:123], a[64:67], v[224:227]
  v_mfma_f32_16x16x32_bf16 v[224:227], a[124:127], a[96:99], v[224:227]
  v_mfma_f32_16x16x32_bf16 v[228:231], a[124:127], a[100:103], v[228:231]
  v_mfma_f32_16x16x32_bf16 v[228:231], a[120:123], a[68:71], v[228:231]
  v_mfma_f32_16x16x32_bf16 v[228:231], a[116:119], a[36:39], v[228:231]
  v_mfma_f32_16x16x32_bf16 v[228:231], a[112:115], a[4:7], v[228:231]
  v_mfma_f32_16x16x32_bf16 v[232:235], a[112:115], a[8:11], v[232:235]
  s_nop 2
  v_cvt_pk_bf16_f32 v242, v224, v225
  v_cvt_pk_bf16_f32 v243, v226, v227
  v_mfma_f32_16x16x32_bf16 v[232:235], a[116:119], a[40:43], v[232:235]
  buffer_store_dwordx4 v[240:243], v50, s[4:7], s94 offen offset:0 sc1
  v_mfma_f32_16x16x32_bf16 v[232:235], a[120:123], a[72:75], v[232:235]
  v_mfma_f32_16x16x32_bf16 v[232:235], a[124:127], a[104:107], v[232:235]
  v_mfma_f32_16x16x32_bf16 v[236:239], a[124:127], a[108:111], v[236:239]
  v_cvt_pk_bf16_f32 v246, v228, v229
  v_cvt_pk_bf16_f32 v247, v230, v231
  v_mfma_f32_16x16x32_bf16 v[236:239], a[120:123], a[76:79], v[236:239]
  buffer_store_dwordx4 v[244:247], v50, s[4:7], s96 offen offset:0 sc1
  v_mfma_f32_16x16x32_bf16 v[236:239], a[116:119], a[44:47], v[236:239]
  v_mfma_f32_16x16x32_bf16 v[236:239], a[112:115], a[12:15], v[236:239]
  s_waitcnt lgkmcnt(0)
  ds_read_b128 a[184:187], v47 offset:0
  ds_read_b128 a[188:191], v47 offset:9216
  v_mfma_f32_16x16x32_bf16 v[188:191], a[168:171], a[140:143], v[188:191]
  ds_read_b128 a[196:199], v47 offset:18432
  ds_read_b128 a[204:207], v47 offset:27648
  v_mfma_f32_16x16x32_bf16 v[188:191], a[172:175], a[28:31], v[188:191]
  v_cvt_pk_bf16_f32 v250, v232, v233
  v_cvt_pk_bf16_f32 v251, v234, v235
  v_mfma_f32_16x16x32_bf16 v[188:191], a[176:179], a[60:63], v[188:191]
  buffer_store_dwordx4 v[248:251], v50, s[4:7], s66 offen offset:0 sc1
  v_mfma_f32_16x16x32_bf16 v[188:191], a[180:183], a[92:95], v[188:191]
  v_mfma_f32_16x16x32_bf16 v[184:187], a[180:183], a[88:91], v[184:187]
  v_cvt_pk_bf16_f32 v254, v236, v237
  v_cvt_pk_bf16_f32 v255, v238, v239
  v_mfma_f32_16x16x32_bf16 v[184:187], a[176:179], a[56:59], v[184:187]
  v_mfma_f32_16x16x32_bf16 v[184:187], a[172:175], a[24:27], v[184:187]
  buffer_store_dwordx4 v[252:255], v50, s[4:7], s98 offen offset:0 sc1
  v_mfma_f32_16x16x32_bf16 v[184:187], a[168:171], a[132:135], v[184:187]
  v_mfma_f32_16x16x32_bf16 v[180:183], a[168:171], a[144:147], v[180:183]
  v_mfma_f32_16x16x32_bf16 v[180:183], a[172:175], a[20:23], v[180:183]
  v_mfma_f32_16x16x32_bf16 v[180:183], a[176:179], a[52:55], v[180:183]
  v_mfma_f32_16x16x32_bf16 v[180:183], a[180:183], a[84:87], v[180:183]
  ds_read_b128 a[212:215], v46 offset:6144
  ds_read_b128 a[220:223], v46 offset:15360
  v_mfma_f32_16x16x32_bf16 v[176:179], a[180:183], a[80:83], v[176:179]
  ds_read_b128 a[128:131], v46 offset:24576
  ds_read_b128 a[136:139], v46 offset:33792
  v_mfma_f32_16x16x32_bf16 v[176:179], a[176:179], a[48:51], v[176:179]
  v_mfma_f32_16x16x32_bf16 v[176:179], a[172:175], a[16:19], v[176:179]
  v_mfma_f32_16x16x32_bf16 v[176:179], a[168:171], a[216:219], v[176:179]
  s_waitcnt lgkmcnt(4)
  v_mfma_f32_16x16x32_bf16 v[212:215], a[184:187], a[4:7], v[212:215]
  v_mfma_f32_16x16x32_bf16 v[212:215], a[188:191], a[36:39], v[212:215]
  v_mfma_f32_16x16x32_bf16 v[212:215], a[196:199], a[68:71], v[212:215]
  v_mfma_f32_16x16x32_bf16 v[212:215], a[204:207], a[100:103], v[212:215]
  v_mfma_f32_16x16x32_bf16 v[216:219], a[204:207], a[104:107], v[216:219]
  v_mfma_f32_16x16x32_bf16 v[216:219], a[196:199], a[72:75], v[216:219]
  v_mfma_f32_16x16x32_bf16 v[216:219], a[188:191], a[40:43], v[216:219]
  v_mfma_f32_16x16x32_bf16 v[216:219], a[184:187], a[8:11], v[216:219]
  v_mfma_f32_16x16x32_bf16 v[220:223], a[184:187], a[12:15], v[220:223]
  s_nop 2
  v_cvt_pk_bf16_f32 v212, v212, v213
  v_mfma_f32_16x16x32_bf16 v[220:223], a[188:191], a[44:47], v[220:223]
  v_cvt_pk_bf16_f32 v213, v214, v215
  v_mfma_f32_16x16x32_bf16 v[220:223], a[196:199], a[76:79], v[220:223]
  v_mfma_f32_16x16x32_bf16 v[220:223], a[204:207], a[108:111], v[220:223]
  s_waitcnt lgkmcnt(0)
  ds_read_b128 a[112:115], v47 offset:1024
  ds_read_b128 a[116:119], v47 offset:10240
  v_mfma_f32_16x16x32_bf16 v[172:175], a[212:215], a[140:143], v[172:175]
  ds_read_b128 a[120:123], v47 offset:19456
  ds_read_b128 a[124:127], v47 offset:28672
  v_mfma_f32_16x16x32_bf16 v[172:175], a[220:223], a[28:31], v[172:175]
  v_cvt_pk_bf16_f32 v216, v216, v217
  v_mfma_f32_16x16x32_bf16 v[172:175], a[128:131], a[60:63], v[172:175]
  v_cvt_pk_bf16_f32 v217, v218, v219
  v_mfma_f32_16x16x32_bf16 v[172:175], a[136:139], a[92:95], v[172:175]
  v_mfma_f32_16x16x32_bf16 v[168:171], a[136:139], a[88:91], v[168:171]
  v_cvt_pk_bf16_f32 v220, v220, v221
  v_mfma_f32_16x16x32_bf16 v[168:171], a[128:131], a[56:59], v[168:171]
  v_cvt_pk_bf16_f32 v221, v222, v223
  v_mfma_f32_16x16x32_bf16 v[168:171], a[220:223], a[24:27], v[168:171]
  v_mfma_f32_16x16x32_bf16 v[168:171], a[212:215], a[132:135], v[168:171]
  v_mfma_f32_16x16x32_bf16 v[164:167], a[212:215], a[144:147], v[164:167]
  v_mfma_f32_16x16x32_bf16 v[164:167], a[220:223], a[20:23], v[164:167]
  v_mfma_f32_16x16x32_bf16 v[164:167], a[128:131], a[52:55], v[164:167]
  v_mfma_f32_16x16x32_bf16 v[164:167], a[136:139], a[84:87], v[164:167]
  ds_read_b128 a[168:171], v46 offset:5120
  ds_read_b128 a[172:175], v46 offset:14336
  v_mfma_f32_16x16x32_bf16 v[160:163], a[136:139], a[80:83], v[160:163]
  ds_read_b128 a[176:179], v46 offset:23552
  ds_read_b128 a[180:183], v46 offset:32768
  v_mfma_f32_16x16x32_bf16 v[160:163], a[128:131], a[48:51], v[160:163]
  v_mfma_f32_16x16x32_bf16 v[160:163], a[220:223], a[16:19], v[160:163]
  v_mfma_f32_16x16x32_bf16 v[160:163], a[212:215], a[216:219], v[160:163]
  s_waitcnt lgkmcnt(4)
  v_mfma_f32_16x16x32_bf16 v[196:199], a[112:115], a[4:7], v[196:199]
  v_mfma_f32_16x16x32_bf16 v[196:199], a[116:119], a[36:39], v[196:199]
  v_mfma_f32_16x16x32_bf16 v[196:199], a[120:123], a[68:71], v[196:199]
  v_mfma_f32_16x16x32_bf16 v[196:199], a[124:127], a[100:103], v[196:199]
  v_mfma_f32_16x16x32_bf16 v[200:203], a[124:127], a[104:107], v[200:203]
  v_mfma_f32_16x16x32_bf16 v[200:203], a[120:123], a[72:75], v[200:203]
  v_mfma_f32_16x16x32_bf16 v[200:203], a[116:119], a[40:43], v[200:203]
  v_mfma_f32_16x16x32_bf16 v[200:203], a[112:115], a[8:11], v[200:203]
  v_mfma_f32_16x16x32_bf16 v[204:207], a[112:115], a[12:15], v[204:207]
  s_nop 2
  v_cvt_pk_bf16_f32 v214, v196, v197
  v_cvt_pk_bf16_f32 v215, v198, v199
  v_mfma_f32_16x16x32_bf16 v[204:207], a[116:119], a[44:47], v[204:207]
  buffer_store_dwordx4 v[212:215], v50, s[4:7], s95 offen offset:0 sc1
  v_mfma_f32_16x16x32_bf16 v[204:207], a[120:123], a[76:79], v[204:207]
  v_mfma_f32_16x16x32_bf16 v[204:207], a[124:127], a[108:111], v[204:207]
  s_waitcnt lgkmcnt(0)
  ds_read_b128 a[184:187], v47 offset:4096
  ds_read_b128 a[188:191], v47 offset:13312
  v_mfma_f32_16x16x32_bf16 v[156:159], a[168:171], a[140:143], v[156:159]
  ds_read_b128 a[196:199], v47 offset:22528
  ds_read_b128 a[204:207], v47 offset:31744
  v_mfma_f32_16x16x32_bf16 v[156:159], a[172:175], a[28:31], v[156:159]
  v_cvt_pk_bf16_f32 v218, v200, v201
  v_cvt_pk_bf16_f32 v219, v202, v203
  v_mfma_f32_16x16x32_bf16 v[156:159], a[176:179], a[60:63], v[156:159]
  buffer_store_dwordx4 v[216:219], v50, s[4:7], s65 offen offset:0 sc1
  v_mfma_f32_16x16x32_bf16 v[156:159], a[180:183], a[92:95], v[156:159]
  v_mfma_f32_16x16x32_bf16 v[152:155], a[180:183], a[88:91], v[152:155]
  v_cvt_pk_bf16_f32 v222, v204, v205
  v_cvt_pk_bf16_f32 v223, v206, v207
  v_mfma_f32_16x16x32_bf16 v[152:155], a[176:179], a[56:59], v[152:155]
  v_mfma_f32_16x16x32_bf16 v[152:155], a[172:175], a[24:27], v[152:155]
  buffer_store_dwordx4 v[220:223], v50, s[4:7], s97 offen offset:0 sc1
  v_mfma_f32_16x16x32_bf16 v[152:155], a[168:171], a[132:135], v[152:155]
  v_mfma_f32_16x16x32_bf16 v[148:151], a[168:171], a[144:147], v[148:151]
  v_mfma_f32_16x16x32_bf16 v[148:151], a[172:175], a[20:23], v[148:151]
  v_mfma_f32_16x16x32_bf16 v[148:151], a[176:179], a[52:55], v[148:151]
  v_mfma_f32_16x16x32_bf16 v[148:151], a[180:183], a[84:87], v[148:151]
  v_mfma_f32_16x16x32_bf16 v[144:147], a[180:183], a[80:83], v[144:147]
  v_mfma_f32_16x16x32_bf16 v[144:147], a[176:179], a[48:51], v[144:147]
  v_mfma_f32_16x16x32_bf16 v[144:147], a[172:175], a[16:19], v[144:147]
  v_mfma_f32_16x16x32_bf16 v[144:147], a[168:171], a[216:219], v[144:147]
  s_waitcnt lgkmcnt(0)
  ds_read_b128 a[212:215], v46 offset:2048
  ds_read_b128 a[220:223], v46 offset:11264
  v_mfma_f32_16x16x32_bf16 v[176:179], a[184:187], a[0:3], v[176:179]
  ds_read_b128 a[128:131], v46 offset:20480
  ds_read_b128 a[136:139], v46 offset:29696
  v_mfma_f32_16x16x32_bf16 v[176:179], a[188:191], a[32:35], v[176:179]
  v_mfma_f32_16x16x32_bf16 v[176:179], a[196:199], a[64:67], v[176:179]
  v_mfma_f32_16x16x32_bf16 v[176:179], a[204:207], a[96:99], v[176:179]
  v_mfma_f32_16x16x32_bf16 v[180:183], a[204:207], a[100:103], v[180:183]
  v_mfma_f32_16x16x32_bf16 v[180:183], a[196:199], a[68:71], v[180:183]
  v_mfma_f32_16x16x32_bf16 v[180:183], a[188:191], a[36:39], v[180:183]
  v_mfma_f32_16x16x32_bf16 v[180:183], a[184:187], a[4:7], v[180:183]
  v_mfma_f32_16x16x32_bf16 v[184:187], a[184:187], a[8:11], v[184:187]
  s_nop 2
  v_cvt_pk_bf16_f32 v108, v176, v177
  v_cvt_pk_bf16_f32 v109, v178, v179
  v_mfma_f32_16x16x32_bf16 v[184:187], a[188:191], a[40:43], v[184:187]
  buffer_store_dwordx2 v[108:109], v33, s[4:7], s94 offen offset:2048 sc1
  v_mfma_f32_16x16x32_bf16 v[184:187], a[196:199], a[72:75], v[184:187]
  v_mfma_f32_16x16x32_bf16 v[184:187], a[204:207], a[104:107], v[184:187]
  ds_read_b128 a[112:115], v47 offset:6144
  ds_read_b128 a[116:119], v47 offset:15360
  v_mfma_f32_16x16x32_bf16 v[188:191], a[204:207], a[108:111], v[188:191]
  ds_read_b128 a[120:123], v47 offset:24576
  ds_read_b128 a[124:127], v47 offset:33792
  v_mfma_f32_16x16x32_bf16 v[188:191], a[196:199], a[76:79], v[188:191]
  v_cvt_pk_bf16_f32 v180, v180, v181
  v_mfma_f32_16x16x32_bf16 v[188:191], a[188:191], a[44:47], v[188:191]
  v_cvt_pk_bf16_f32 v181, v182, v183
  v_mfma_f32_16x16x32_bf16 v[188:191], a[184:187], a[12:15], v[188:191]
  s_waitcnt lgkmcnt(4)
  buffer_store_dwordx2 v[180:181], v33, s[4:7], s96 offen offset:2048 sc1
  v_mfma_f32_16x16x32_bf16 v[140:143], a[212:215], a[140:143], v[140:143]
  v_cvt_pk_bf16_f32 v184, v184, v185
  v_mfma_f32_16x16x32_bf16 v[140:143], a[220:223], a[28:31], v[140:143]
  v_cvt_pk_bf16_f32 v185, v186, v187
  v_mfma_f32_16x16x32_bf16 v[140:143], a[128:131], a[60:63], v[140:143]
  v_mfma_f32_16x16x32_bf16 v[140:143], a[136:139], a[92:95], v[140:143]
  buffer_store_dwordx2 v[180:181], v32, s[4:7], s95 offen offset:2048 sc1
  v_mfma_f32_16x16x32_bf16 v[136:139], a[136:139], a[88:91], v[136:139]
  v_cvt_pk_bf16_f32 v188, v188, v189
  v_mfma_f32_16x16x32_bf16 v[136:139], a[128:131], a[56:59], v[136:139]
  v_cvt_pk_bf16_f32 v189, v190, v191
  v_mfma_f32_16x16x32_bf16 v[136:139], a[220:223], a[24:27], v[136:139]
  v_mfma_f32_16x16x32_bf16 v[136:139], a[212:215], a[132:135], v[136:139]
  buffer_store_dwordx2 v[184:185], v33, s[4:7], s66 offen offset:2048 sc1
  v_mfma_f32_16x16x32_bf16 v[132:135], a[212:215], a[144:147], v[132:135]
  v_mfma_f32_16x16x32_bf16 v[132:135], a[220:223], a[20:23], v[132:135]
  v_mfma_f32_16x16x32_bf16 v[132:135], a[128:131], a[52:55], v[132:135]
  v_mfma_f32_16x16x32_bf16 v[132:135], a[136:139], a[84:87], v[132:135]
  s_waitcnt lgkmcnt(0)
  buffer_store_dwordx2 v[184:185], v32, s[4:7], s65 offen offset:2048 sc1
  v_mfma_f32_16x16x32_bf16 v[160:163], a[112:115], a[0:3], v[160:163]
  ds_read_b128 a[168:171], v46 offset:3072
  ds_read_b128 a[172:175], v46 offset:12288
  v_mfma_f32_16x16x32_bf16 v[160:163], a[116:119], a[32:35], v[160:163]
  ds_read_b128 a[176:179], v46 offset:21504
  ds_read_b128 a[180:183], v46 offset:30720
  v_mfma_f32_16x16x32_bf16 v[160:163], a[120:123], a[64:67], v[160:163]
  v_mfma_f32_16x16x32_bf16 v[160:163], a[124:127], a[96:99], v[160:163]
  buffer_store_dwordx2 v[188:189], v33, s[4:7], s98 offen offset:2048 sc1
  v_mfma_f32_16x16x32_bf16 v[164:167], a[124:127], a[100:103], v[164:167]
  v_mfma_f32_16x16x32_bf16 v[164:167], a[120:123], a[68:71], v[164:167]
  v_mfma_f32_16x16x32_bf16 v[164:167], a[116:119], a[36:39], v[164:167]
  v_mfma_f32_16x16x32_bf16 v[164:167], a[112:115], a[4:7], v[164:167]
  buffer_store_dwordx2 v[188:189], v32, s[4:7], s97 offen offset:2048 sc1
  v_mfma_f32_16x16x32_bf16 v[168:171], a[112:115], a[8:11], v[168:171]
  s_nop 0
  v_cvt_pk_bf16_f32 v160, v160, v161
  v_mfma_f32_16x16x32_bf16 v[168:171], a[116:119], a[40:43], v[168:171]
  v_cvt_pk_bf16_f32 v161, v162, v163
  v_mfma_f32_16x16x32_bf16 v[168:171], a[120:123], a[72:75], v[168:171]
  v_mfma_f32_16x16x32_bf16 v[168:171], a[124:127], a[104:107], v[168:171]
  ds_read_b128 a[184:187], v47 offset:5120
  ds_read_b128 a[188:191], v47 offset:14336
  v_mfma_f32_16x16x32_bf16 v[172:175], a[124:127], a[108:111], v[172:175]
  ds_read_b128 a[196:199], v47 offset:23552
  ds_read_b128 a[204:207], v47 offset:32768
  v_mfma_f32_16x16x32_bf16 v[172:175], a[120:123], a[76:79], v[172:175]
  v_cvt_pk_bf16_f32 v164, v164, v165
  v_mfma_f32_16x16x32_bf16 v[172:175], a[116:119], a[44:47], v[172:175]
  v_cvt_pk_bf16_f32 v165, v166, v167
  v_mfma_f32_16x16x32_bf16 v[172:175], a[112:115], a[12:15], v[172:175]
  s_waitcnt lgkmcnt(4)
  v_mfma_f32_16x16x32_bf16 v[124:127], a[168:171], a[140:143], v[124:127]
  v_cvt_pk_bf16_f32 v168, v168, v169
  v_mfma_f32_16x16x32_bf16 v[124:127], a[172:175], a[28:31], v[124:127]
  v_cvt_pk_bf16_f32 v169, v170, v171
  v_mfma_f32_16x16x32_bf16 v[124:127], a[176:179], a[60:63], v[124:127]
  v_mfma_f32_16x16x32_bf16 v[124:127], a[180:183], a[92:95], v[124:127]
  v_mfma_f32_16x16x32_bf16 v[120:123], a[180:183], a[88:91], v[120:123]
  v_cvt_pk_bf16_f32 v172, v172, v173
  v_mfma_f32_16x16x32_bf16 v[120:123], a[176:179], a[56:59], v[120:123]
  v_cvt_pk_bf16_f32 v173, v174, v175
  v_mfma_f32_16x16x32_bf16 v[120:123], a[172:175], a[24:27], v[120:123]
  v_mfma_f32_16x16x32_bf16 v[120:123], a[168:171], a[132:135], v[120:123]
  v_mfma_f32_16x16x32_bf16 v[116:119], a[168:171], a[144:147], v[116:119]
  v_mfma_f32_16x16x32_bf16 v[116:119], a[172:175], a[20:23], v[116:119]
  v_mfma_f32_16x16x32_bf16 v[116:119], a[176:179], a[52:55], v[116:119]
  v_mfma_f32_16x16x32_bf16 v[116:119], a[180:183], a[84:87], v[116:119]
  s_waitcnt lgkmcnt(0)
  ds_read_b128 a[212:215], v47 offset:2048
  ds_read_b128 a[220:223], v47 offset:11264
  v_mfma_f32_16x16x32_bf16 v[144:147], a[184:187], a[0:3], v[144:147]
  ds_read_b128 a[128:131], v47 offset:20480
  ds_read_b128 a[136:139], v47 offset:29696
  v_mfma_f32_16x16x32_bf16 v[144:147], a[188:191], a[32:35], v[144:147]
  s_waitcnt vmcnt(18)
  v_lshlrev_b32 v240, 16, v98
  v_and_b32 v241, 0xffff0000, v98
  v_mfma_f32_16x16x32_bf16 v[144:147], a[196:199], a[64:67], v[144:147]
  v_lshlrev_b32 v242, 16, v99
  v_and_b32 v243, 0xffff0000, v99
  v_mfma_f32_16x16x32_bf16 v[144:147], a[204:207], a[96:99], v[144:147]
  s_waitcnt vmcnt(17)
  v_lshlrev_b32 v244, 16, v100
  v_and_b32 v245, 0xffff0000, v100
  v_mfma_f32_16x16x32_bf16 v[148:151], a[204:207], a[100:103], v[148:151]
pad_p3_end9_1:
  s_cbranch_execz warm_P
  v_lshlrev_b32 v246, 16, v101
  v_and_b32 v247, 0xffff0000, v101
  v_mfma_f32_16x16x32_bf16 v[148:151], a[196:199], a[68:71], v[148:151]
  s_waitcnt vmcnt(16)
  v_lshlrev_b32 v248, 16, v102
  v_and_b32 v249, 0xffff0000, v102
  v_mfma_f32_16x16x32_bf16 v[148:151], a[188:191], a[36:39], v[148:151]
  buffer_load_dword v59, v13, s[4:7], s48 offen sc1
  v_mfma_f32_16x16x32_bf16 v[148:151], a[184:187], a[4:7], v[148:151]
  v_lshlrev_b32 v250, 16, v103
  v_and_b32 v251, 0xffff0000, v103
  v_mfma_f32_16x16x32_bf16 v[152:155], a[184:187], a[8:11], v[152:155]
  v_cvt_pk_bf16_f32 v162, v144, v145
  v_cvt_pk_bf16_f32 v163, v146, v147
  v_mfma_f32_16x16x32_bf16 v[152:155], a[188:191], a[40:43], v[152:155]
  buffer_store_dwordx4 v[160:163], v50, s[4:7], s94 offen offset:1024 sc1
  v_mfma_f32_16x16x32_bf16 v[152:155], a[196:199], a[72:75], v[152:155]
  s_waitcnt vmcnt(17)
  v_lshlrev_b32 v252, 16, v104
  v_and_b32 v253, 0xffff0000, v104
  v_mfma_f32_16x16x32_bf16 v[152:155], a[204:207], a[104:107], v[152:155]
  ds_read_b128 a[112:115], v47 offset:3072
  ds_read_b128 a[116:119], v47 offset:12288
  v_mfma_f32_16x16x32_bf16 v[156:159], a[204:207], a[108:111], v[156:159]
  ds_read_b128 a[120:123], v47 offset:21504
  ds_read_b128 a[124:127], v47 offset:30720
  v_mfma_f32_16x16x32_bf16 v[156:159], a[196:199], a[76:79], v[156:159]
  v_cvt_pk_bf16_f32 v166, v148, v149
  v_cvt_pk_bf16_f32 v167, v150, v151
  v_mfma_f32_16x16x32_bf16 v[156:159], a[188:191], a[44:47], v[156:159]
  buffer_store_dwordx4 v[164:167], v50, s[4:7], s96 offen offset:1024 sc1
  v_mfma_f32_16x16x32_bf16 v[156:159], a[184:187], a[12:15], v[156:159]
  s_waitcnt lgkmcnt(4)
  v_lshlrev_b32 v254, 16, v105
  v_and_b32 v255, 0xffff0000, v105
  v_mfma_f32_16x16x32_bf16 v[140:143], a[212:215], a[12:15], v[140:143]
  v_cvt_pk_bf16_f32 v170, v152, v153
  v_cvt_pk_bf16_f32 v171, v154, v155
  v_mfma_f32_16x16x32_bf16 v[140:143], a[220:223], a[44:47], v[140:143]
  s_waitcnt vmcnt(17)
  v_lshlrev_b32 v180, 16, v106
  v_and_b32 v181, 0xffff0000, v106
  v_mfma_f32_16x16x32_bf16 v[140:143], a[128:131], a[76:79], v[140:143]
  buffer_store_dwordx4 v[168:171], v50, s[4:7], s66 offen offset:1024 sc1
  v_mfma_f32_16x16x32_bf16 v[140:143], a[136:139], a[108:111], v[140:143]
  v_lshlrev_b32 v182, 16, v107
  v_and_b32 v183, 0xffff0000, v107
  v_mfma_f32_16x16x32_bf16 v[136:139], a[136:139], a[104:107], v[136:139]
  v_cvt_pk_bf16_f32 v174, v156, v157
  v_cvt_pk_bf16_f32 v175, v158, v159
  v_mfma_f32_16x16x32_bf16 v[136:139], a[128:131], a[72:75], v[136:139]
  v_mfma_f32_16x16x32_bf16 v[136:139], a[220:223], a[40:43], v[136:139]
  buffer_store_dwordx4 v[172:175], v50, s[4:7], s98 offen offset:1024 sc1
  v_mfma_f32_16x16x32_bf16 v[136:139], a[212:215], a[8:11], v[136:139]
  ds_read_b128 a[168:171], v46 offset:0
  ds_read_b128 a[172:175], v46 offset:9216
  v_mfma_f32_16x16x32_bf16 v[132:135], a[212:215], a[4:7], v[132:135]
  ds_read_b128 a[176:179], v46 offset:18432
  ds_read_b128 a[180:183], v46 offset:27648
  v_mfma_f32_16x16x32_bf16 v[132:135], a[220:223], a[36:39], v[132:135]
  v_cvt_pk_bf16_f32 v140, v140, v141
  v_mfma_f32_16x16x32_bf16 v[132:135], a[128:131], a[68:71], v[132:135]
  v_cvt_pk_bf16_f32 v141, v142, v143
  v_mfma_f32_16x16x32_bf16 v[132:135], a[136:139], a[100:103], v[132:135]
  s_waitcnt lgkmcnt(4)
  ds_read_b128 a[184:187], v47 offset:0
  ds_read_b128 a[188:191], v47 offset:9216
  v_mfma_f32_16x16x32_bf16 v[116:119], a[112:115], a[4:7], v[116:119]
  ds_read_b128 a[196:199], v47 offset:18432
  ds_read_b128 a[204:207], v47 offset:27648
  v_mfma_f32_16x16x32_bf16 v[116:119], a[116:119], a[36:39], v[116:119]
  v_cvt_pk_bf16_f32 v136, v136, v137
  v_mfma_f32_16x16x32_bf16 v[116:119], a[120:123], a[68:71], v[116:119]
  v_cvt_pk_bf16_f32 v137, v138, v139
  v_mfma_f32_16x16x32_bf16 v[116:119], a[124:127], a[100:103], v[116:119]
  ds_read_b128 a[212:215], v46 offset:1024
  ds_read_b128 a[220:223], v46 offset:10240
  v_mfma_f32_16x16x32_bf16 v[120:123], a[124:127], a[104:107], v[120:123]
  ds_read_b128 a[128:131], v46 offset:19456
  ds_read_b128 a[136:139], v46 offset:28672
  v_mfma_f32_16x16x32_bf16 v[120:123], a[120:123], a[72:75], v[120:123]
  v_cvt_pk_bf16_f32 v132, v132, v133
  v_mfma_f32_16x16x32_bf16 v[120:123], a[116:119], a[40:43], v[120:123]
  v_cvt_pk_bf16_f32 v133, v134, v135
  v_mfma_f32_16x16x32_bf16 v[120:123], a[112:115], a[8:11], v[120:123]
  v_mfma_f32_16x16x32_bf16 v[124:127], a[112:115], a[12:15], v[124:127]
  v_cvt_pk_bf16_f32 v134, v116, v117
  v_cvt_pk_bf16_f32 v135, v118, v119
  v_mfma_f32_16x16x32_bf16 v[124:127], a[116:119], a[44:47], v[124:127]
  buffer_store_dwordx4 v[132:135], v50, s[4:7], s95 offen offset:1024 sc1
  v_mfma_f32_16x16x32_bf16 v[124:127], a[120:123], a[76:79], v[124:127]
  v_mfma_f32_16x16x32_bf16 v[124:127], a[124:127], a[108:111], v[124:127]
  s_waitcnt lgkmcnt(8)
  ds_read_b128 a[112:115], v47 offset:1024
  ds_read_b128 a[116:119], v47 offset:10240
  v_mfma_f32_16x16x32_bf16 v[208:211], a[168:171], a[216:219], v[208:211]
  ds_read_b128 a[120:123], v47 offset:19456
  ds_read_b128 a[124:127], v47 offset:28672
  v_mfma_f32_16x16x32_bf16 v[208:211], a[172:175], a[16:19], v[208:211]
  v_cvt_pk_bf16_f32 v138, v120, v121
  v_cvt_pk_bf16_f32 v139, v122, v123
  v_mfma_f32_16x16x32_bf16 v[208:211], a[176:179], a[48:51], v[208:211]
  buffer_store_dwordx4 v[136:139], v50, s[4:7], s65 offen offset:1024 sc1
  v_mfma_f32_16x16x32_bf16 v[208:211], a[180:183], a[80:83], v[208:211]
  s_waitcnt lgkmcnt(8)
  ds_read_b128 a[168:171], v46 offset:2048
  ds_read_b128 a[172:175], v46 offset:11264
  v_mfma_f32_16x16x32_bf16 v[208:211], a[184:187], a[0:3], v[208:211]
  s_add_u32 s94, s50, 0
  ds_read_b128 a[176:179], v46 offset:20480
  ds_read_b128 a[180:183], v46 offset:29696
  v_mfma_f32_16x16x32_bf16 v[208:211], a[188:191], a[32:35], v[208:211]
  s_add_u32 s95, s50, 2560
  v_cvt_pk_bf16_f32 v142, v124, v125
  v_cvt_pk_bf16_f32 v143, v126, v127
  v_mfma_f32_16x16x32_bf16 v[208:211], a[196:199], a[64:67], v[208:211]
  buffer_store_dwordx4 v[140:143], v50, s[4:7], s97 offen offset:1024 sc1
  v_mfma_f32_16x16x32_bf16 v[208:211], a[204:207], a[96:99], v[208:211]
  s_waitcnt lgkmcnt(8)
  ds_read_b128 a[184:187], v47 offset:2048
  ds_read_b128 a[188:191], v47 offset:11264
  s_waitcnt vmcnt(7)
  v_cmp_ne_u32 vcc, 0, v59
  v_mfma_f32_16x16x32_bf16 v[192:195], a[212:215], a[216:219], v[192:195]
  s_and_b32 s75, vcc_lo, 0xfe
  ds_read_b128 a[196:199], v47 offset:20480
  ds_read_b128 a[204:207], v47 offset:29696
  v_mfma_f32_16x16x32_bf16 v[192:195], a[220:223], a[16:19], v[192:195]
  s_bitcmp1_b32 s75, 1
  s_cselect_b32 s94, s94, 0x70000000
  v_mfma_f32_16x16x32_bf16 v[192:195], a[128:131], a[48:51], v[192:195]
  s_bitcmp1_b32 s75, 2
  s_cselect_b32 s95, s95, 0x70000000
  v_mfma_f32_16x16x32_bf16 v[192:195], a[136:139], a[80:83], v[192:195]
  s_waitcnt lgkmcnt(8)
  ds_read_b128 a[212:215], v46 offset:3072
  ds_read_b128 a[220:223], v46 offset:12288
  v_mfma_f32_16x16x32_bf16 v[192:195], a[112:115], a[0:3], v[192:195]
  s_add_u32 s96, s50, 5120
  ds_read_b128 a[128:131], v46 offset:21504
  ds_read_b128 a[136:139], v46 offset:30720
  v_mfma_f32_16x16x32_bf16 v[192:195], a[116:119], a[32:35], v[192:195]
  buffer_load_dwordx4 v[224:227], v50, s[4:7], s94 offen offset:0 sc1
  v_mfma_f32_16x16x32_bf16 v[192:195], a[120:123], a[64:67], v[192:195]
  s_bitcmp1_b32 s75, 3
  s_cselect_b32 s96, s96, 0x70000000
  v_mfma_f32_16x16x32_bf16 v[192:195], a[124:127], a[96:99], v[192:195]
  s_waitcnt lgkmcnt(8)
  ds_read_b128 a[112:115], v47 offset:3072
  ds_read_b128 a[116:119], v47 offset:12288
  v_mfma_f32_16x16x32_bf16 v[128:131], a[168:171], a[216:219], v[128:131]
  s_add_u32 s65, s50, 7680
  ds_read_b128 a[120:123], v47 offset:21504
  ds_read_b128 a[124:127], v47 offset:30720
  v_mfma_f32_16x16x32_bf16 v[128:131], a[172:175], a[16:19], v[128:131]
  buffer_load_dwordx4 v[196:199], v50, s[4:7], s95 offen offset:0 sc1
  v_mfma_f32_16x16x32_bf16 v[128:131], a[176:179], a[48:51], v[128:131]
  s_bitcmp1_b32 s75, 4
  s_cselect_b32 s65, s65, 0x70000000
  v_mfma_f32_16x16x32_bf16 v[128:131], a[180:183], a[80:83], v[128:131]
  s_waitcnt lgkmcnt(8)
  buffer_load_dwordx4 v[228:231], v50, s[4:7], s96 offen offset:0 sc1
  v_mfma_f32_16x16x32_bf16 v[128:131], a[184:187], a[0:3], v[128:131]
  s_add_u32 s66, s50, 10240
  v_mfma_f32_16x16x32_bf16 v[128:131], a[188:191], a[32:35], v[128:131]
  buffer_load_dwordx4 v[200:203], v50, s[4:7], s65 offen offset:0 sc1
  v_mfma_f32_16x16x32_bf16 v[128:131], a[196:199], a[64:67], v[128:131]
  s_bitcmp1_b32 s75, 5
  s_cselect_b32 s66, s66, 0x70000000
  v_mfma_f32_16x16x32_bf16 v[128:131], a[204:207], a[96:99], v[128:131]
  s_waitcnt lgkmcnt(4)
  buffer_load_dwordx4 v[232:235], v50, s[4:7], s66 offen offset:0 sc1
  v_mfma_f32_16x16x32_bf16 v[112:115], a[212:215], a[216:219], v[112:115]
  s_add_u32 s97, s50, 12800
  v_mfma_f32_16x16x32_bf16 v[112:115], a[220:223], a[16:19], v[112:115]
  s_bitcmp1_b32 s75, 6
  s_cselect_b32 s97, s97, 0x70000000
  v_mfma_f32_16x16x32_bf16 v[112:115], a[128:131], a[48:51], v[112:115]
  s_add_u32 s98, s50, 15360
  v_mfma_f32_16x16x32_bf16 v[112:115], a[136:139], a[80:83], v[112:115]
  s_waitcnt lgkmcnt(0)
  buffer_load_dwordx4 v[204:207], v50, s[4:7], s97 offen offset:0 sc1
  v_mfma_f32_16x16x32_bf16 v[112:115], a[112:115], a[0:3], v[112:115]
  s_bitcmp1_b32 s75, 7
  s_cselect_b32 s98, s98, 0x70000000
  v_mfma_f32_16x16x32_bf16 v[112:115], a[116:119], a[32:35], v[112:115]
  buffer_load_dwordx4 v[236:239], v50, s[4:7], s98 offen offset:0 sc1
  v_mfma_f32_16x16x32_bf16 v[112:115], a[120:123], a[64:67], v[112:115]
  v_mfma_f32_16x16x32_bf16 v[112:115], a[124:127], a[96:99], v[112:115]
p3_tail:
pad_p3_tail_0:
  s_cbranch_execz warm_P
  v_mov_b32 v58, 1
  s_mov_b32 s90, 100000
  s_waitcnt vmcnt(7)
  s_mov_b64 exec, 0xfe
  buffer_store_dword v58, v12, s[4:7], s48 offen sc1
  s_mov_b64 exec, -1
  buffer_load_dwordx4 v[144:147], v50, s[4:7], s94 offen offset:1024 sc1
  buffer_load_dwordx2 v[64:65], v32, s[4:7], s94 offen offset:2048 sc1
  buffer_load_dwordx4 v[116:119], v50, s[4:7], s95 offen offset:1024 sc1
  buffer_load_dwordx2 v[66:67], v32, s[4:7], s95 offen offset:2048 sc1
  buffer_load_dwordx4 v[148:151], v50, s[4:7], s96 offen offset:1024 sc1
  buffer_load_dwordx2 v[68:69], v32, s[4:7], s96 offen offset:2048 sc1
  buffer_load_dwordx4 v[120:123], v50, s[4:7], s65 offen offset:1024 sc1
  buffer_load_dwordx2 v[70:71], v32, s[4:7], s65 offen offset:2048 sc1
  buffer_load_dwordx4 v[152:155], v50, s[4:7], s66 offen offset:1024 sc1
  buffer_load_dwordx2 v[72:73], v32, s[4:7], s66 offen offset:2048 sc1
  buffer_load_dwordx4 v[124:127], v50, s[4:7], s97 offen offset:1024 sc1
  buffer_load_dwordx2 v[74:75], v32, s[4:7], s97 offen offset:2048 sc1
  buffer_load_dwordx4 v[156:159], v50, s[4:7], s98 offen offset:1024 sc1
  buffer_load_dwordx2 v[76:77], v32, s[4:7], s98 offen offset:2048 sc1
  buffer_load_dword v59, v13, s[4:7], s48 offen sc1
  s_waitcnt vmcnt(13)
  s_bitcmp1_b32 s75, 1
  s_cbranch_scc0 early_a1
  v_lshlrev_b32 v16, 16, v224
  v_and_b32 v17, 0xffff0000, v224
  v_pk_add_f32 v[78:79], v[78:79], v[16:17]
  v_lshlrev_b32 v18, 16, v225
  v_and_b32 v19, 0xffff0000, v225
  v_pk_add_f32 v[80:81], v[80:81], v[18:19]
  v_lshlrev_b32 v20, 16, v226
  v_and_b32 v21, 0xffff0000, v226
  v_pk_add_f32 v[82:83], v[82:83], v[20:21]
  v_lshlrev_b32 v22, 16, v227
  v_and_b32 v23, 0xffff0000, v227
  v_pk_add_f32 v[84:85], v[84:85], v[22:23]
  v_lshlrev_b32 v16, 16, v144
  v_and_b32 v17, 0xffff0000, v144
  v_pk_add_f32 v[86:87], v[86:87], v[16:17]
  v_lshlrev_b32 v18, 16, v145
  v_and_b32 v19, 0xffff0000, v145
  v_pk_add_f32 v[88:89], v[88:89], v[18:19]
  v_lshlrev_b32 v20, 16, v146
  v_and_b32 v21, 0xffff0000, v146
  v_pk_add_f32 v[90:91], v[90:91], v[20:21]
  v_lshlrev_b32 v22, 16, v147
  v_and_b32 v23, 0xffff0000, v147
  v_pk_add_f32 v[92:93], v[92:93], v[22:23]
  v_lshlrev_b32 v16, 16, v64
  v_and_b32 v17, 0xffff0000, v64
  v_pk_add_f32 v[94:95], v[94:95], v[16:17]
  v_lshlrev_b32 v18, 16, v65
  v_and_b32 v19, 0xffff0000, v65
  v_pk_add_f32 v[96:97], v[96:97], v[18:19]
early_a1:
  s_waitcnt vmcnt(11)
  s_bitcmp1_b32 s75, 2
  s_cbranch_scc0 early_a2
  v_lshlrev_b32 v16, 16, v196
  v_and_b32 v17, 0xffff0000, v196
  v_pk_add_f32 v[208:209], v[208:209], v[16:17]
  v_lshlrev_b32 v18, 16, v197
  v_and_b32 v19, 0xffff0000, v197
  v_pk_add_f32 v[210:211], v[210:211], v[18:19]
  v_lshlrev_b32 v20, 16, v198
  v_and_b32 v21, 0xffff0000, v198
  v_pk_add_f32 v[192:193], v[192:193], v[20:21]
  v_lshlrev_b32 v22, 16, v199
  v_and_b32 v23, 0xffff0000, v199
  v_pk_add_f32 v[194:195], v[194:195], v[22:23]
  v_lshlrev_b32 v16, 16, v116
  v_and_b32 v17, 0xffff0000, v116
  v_pk_add_f32 v[128:129], v[128:129], v[16:17]
  v_lshlrev_b32 v18, 16, v117
  v_and_b32 v19, 0xffff0000, v117
  v_pk_add_f32 v[130:131], v[130:131], v[18:19]
  v_lshlrev_b32 v20, 16, v118
  v_and_b32 v21, 0xffff0000, v118
  v_pk_add_f32 v[112:113], v[112:113], v[20:21]
  v_lshlrev_b32 v22, 16, v119
  v_and_b32 v23, 0xffff0000, v119
  v_pk_add_f32 v[114:115], v[114:115], v[22:23]
  v_lshlrev_b32 v16, 16, v66
  v_and_b32 v17, 0xffff0000, v66
  v_pk_add_f32 v[176:177], v[176:177], v[16:17]
  v_lshlrev_b32 v18, 16, v67
  v_and_b32 v19, 0xffff0000, v67
  v_pk_add_f32 v[178:179], v[178:179], v[18:19]
early_a2:
  s_waitcnt vmcnt(9)
  s_bitcmp1_b32 s75, 3
  s_cbranch_scc0 early_a3
  v_lshlrev_b32 v16, 16, v228
  v_and_b32 v17, 0xffff0000, v228
  v_pk_add_f32 v[78:79], v[78:79], v[16:17]
  v_lshlrev_b32 v18, 16, v229
  v_and_b32 v19, 0xffff0000, v229
  v_pk_add_f32 v[80:81], v[80:81], v[18:19]
  v_lshlrev_b32 v20, 16, v230
  v_and_b32 v21, 0xffff0000, v230
  v_pk_add_f32 v[82:83], v[82:83], v[20:21]
  v_lshlrev_b32 v22, 16, v231
  v_and_b32 v23, 0xffff0000, v231
  v_pk_add_f32 v[84:85], v[84:85], v[22:23]
  v_lshlrev_b32 v16, 16, v148
  v_and_b32 v17, 0xffff0000, v148
  v_pk_add_f32 v[86:87], v[86:87], v[16:17]
  v_lshlrev_b32 v18, 16, v149
  v_and_b32 v19, 0xffff0000, v149
  v_pk_add_f32 v[88:89], v[88:89], v[18:19]
  v_lshlrev_b32 v20, 16, v150
  v_and_b32 v21, 0xffff0000, v150
  v_pk_add_f32 v[90:91], v[90:91], v[20:21]
  v_lshlrev_b32 v22, 16, v151
  v_and_b32 v23, 0xffff0000, v151
  v_pk_add_f32 v[92:93], v[92:93], v[22:23]
  v_lshlrev_b32 v16, 16, v68
  v_and_b32 v17, 0xffff0000, v68
  v_pk_add_f32 v[94:95], v[94:95], v[16:17]
  v_lshlrev_b32 v18, 16, v69
  v_and_b32 v19, 0xffff0000, v69
  v_pk_add_f32 v[96:97], v[96:97], v[18:19]
early_a3:
  s_waitcnt vmcnt(7)
  s_bitcmp1_b32 s75, 4
  s_cbranch_scc0 early_a4
  v_lshlrev_b32 v16, 16, v200
  v_and_b32 v17, 0xffff0000, v200
  v_pk_add_f32 v[208:209], v[208:209], v[16:17]
  v_lshlrev_b32 v18, 16, v201
  v_and_b32 v19, 0xffff0000, v201
  v_pk_add_f32 v[210:211], v[210:211], v[18:19]
  v_lshlrev_b32 v20, 16, v202
  v_and_b32 v21, 0xffff0000, v202
  v_pk_add_f32 v[192:193], v[192:193], v[20:21]
  v_lshlrev_b32 v22, 16, v203
  v_and_b32 v23, 0xffff0000, v203
  v_pk_add_f32 v[194:195], v[194:195], v[22:23]
  v_lshlrev_b32 v16, 16, v120
  v_and_b32 v17, 0xffff0000, v120
  v_pk_add_f32 v[128:129], v[128:129], v[16:17]
  v_lshlrev_b32 v18, 16, v121
  v_and_b32 v19, 0xffff0000, v121
  v_pk_add_f32 v[130:131], v[130:131], v[18:19]
  v_lshlrev_b32 v20, 16, v122
  v_and_b32 v21, 0xffff0000, v122
  v_pk_add_f32 v[112:113], v[112:113], v[20:21]
  v_lshlrev_b32 v22, 16, v123
  v_and_b32 v23, 0xffff0000, v123
  v_pk_add_f32 v[114:115], v[114:115], v[22:23]
  v_lshlrev_b32 v16, 16, v70
  v_and_b32 v17, 0xffff0000, v70
  v_pk_add_f32 v[176:177], v[176:177], v[16:17]
  v_lshlrev_b32 v18, 16, v71
  v_and_b32 v19, 0xffff0000, v71
  v_pk_add_f32 v[178:179], v[178:179], v[18:19]
early_a4:
  s_waitcnt vmcnt(5)
  s_bitcmp1_b32 s75, 5
  s_cbranch_scc0 early_a5
  v_lshlrev_b32 v16, 16, v232
  v_and_b32 v17, 0xffff0000, v232
  v_pk_add_f32 v[78:79], v[78:79], v[16:17]
  v_lshlrev_b32 v18, 16, v233
  v_and_b32 v19, 0xffff0000, v233
  v_pk_add_f32 v[80:81], v[80:81], v[18:19]
  v_lshlrev_b32 v20, 16, v234
  v_and_b32 v21, 0xffff0000, v234
  v_pk_add_f32 v[82:83], v[82:83], v[20:21]
  v_lshlrev_b32 v22, 16, v235
  v_and_b32 v23, 0xffff0000, v235
  v_pk_add_f32 v[84:85], v[84:85], v[22:23]
  v_lshlrev_b32 v16, 16, v152
  v_and_b32 v17, 0xffff0000, v152
  v_pk_add_f32 v[86:87], v[86:87], v[16:17]
  v_lshlrev_b32 v18, 16, v153
  v_and_b32 v19, 0xffff0000, v153
  v_pk_add_f32 v[88:89], v[88:89], v[18:19]
  v_lshlrev_b32 v20, 16, v154
  v_and_b32 v21, 0xffff0000, v154
  v_pk_add_f32 v[90:91], v[90:91], v[20:21]
  v_lshlrev_b32 v22, 16, v155
  v_and_b32 v23, 0xffff0000, v155
  v_pk_add_f32 v[92:93], v[92:93], v[22:23]
  v_lshlrev_b32 v16, 16, v72
  v_and_b32 v17, 0xffff0000, v72
  v_pk_add_f32 v[94:95], v[94:95], v[16:17]
  v_lshlrev_b32 v18, 16, v73
  v_and_b32 v19, 0xffff0000, v73
  v_pk_add_f32 v[96:97], v[96:97], v[18:19]
early_a5:
  s_waitcnt vmcnt(3)
  s_bitcmp1_b32 s75, 6
  s_cbranch_scc0 early_a6
  v_lshlrev_b32 v16, 16, v204
  v_and_b32 v17, 0xffff0000, v204
  v_pk_add_f32 v[208:209], v[208:209], v[16:17]
  v_lshlrev_b32 v18, 16, v205
  v_and_b32 v19, 0xffff0000, v205
  v_pk_add_f32 v[210:211], v[210:211], v[18:19]
  v_lshlrev_b32 v20, 16, v206
  v_and_b32 v21, 0xffff0000, v206
  v_pk_add_f32 v[192:193], v[192:193], v[20:21]
  v_lshlrev_b32 v22, 16, v207
  v_and_b32 v23, 0xffff0000, v207
  v_pk_add_f32 v[194:195], v[194:195], v[22:23]
  v_lshlrev_b32 v16, 16, v124
  v_and_b32 v17, 0xffff0000, v124
  v_pk_add_f32 v[128:129], v[128:129], v[16:17]
  v_lshlrev_b32 v18, 16, v125
  v_and_b32 v19, 0xffff0000, v125
  v_pk_add_f32 v[130:131], v[130:131], v[18:19]
  v_lshlrev_b32 v20, 16, v126
  v_and_b32 v21, 0xffff0000, v126
  v_pk_add_f32 v[112:113], v[112:113], v[20:21]
  v_lshlrev_b32 v22, 16, v127
  v_and_b32 v23, 0xffff0000, v127
  v_pk_add_f32 v[114:115], v[114:115], v[22:23]
  v_lshlrev_b32 v16, 16, v74
  v_and_b32 v17, 0xffff0000, v74
  v_pk_add_f32 v[176:177], v[176:177], v[16:17]
  v_lshlrev_b32 v18, 16, v75
  v_and_b32 v19, 0xffff0000, v75
  v_pk_add_f32 v[178:179], v[178:179], v[18:19]
early_a6:
  s_waitcnt vmcnt(1)
  s_bitcmp1_b32 s75, 7
  s_cbranch_scc0 early_a7
  v_lshlrev_b32 v16, 16, v236
  v_and_b32 v17, 0xffff0000, v236
  v_pk_add_f32 v[78:79], v[78:79], v[16:17]
  v_lshlrev_b32 v18, 16, v237
  v_and_b32 v19, 0xffff0000, v237
  v_pk_add_f32 v[80:81], v[80:81], v[18:19]
  v_lshlrev_b32 v20, 16, v238
  v_and_b32 v21, 0xffff0000, v238
  v_pk_add_f32 v[82:83], v[82:83], v[20:21]
  v_lshlrev_b32 v22, 16, v239
  v_and_b32 v23, 0xffff0000, v239
  v_pk_add_f32 v[84:85], v[84:85], v[22:23]
  v_lshlrev_b32 v16, 16, v156
  v_and_b32 v17, 0xffff0000, v156
  v_pk_add_f32 v[86:87], v[86:87], v[16:17]
  v_lshlrev_b32 v18, 16, v157
  v_and_b32 v19, 0xffff0000, v157
  v_pk_add_f32 v[88:89], v[88:89], v[18:19]
  v_lshlrev_b32 v20, 16, v158
  v_and_b32 v21, 0xffff0000, v158
  v_pk_add_f32 v[90:91], v[90:91], v[20:21]
  v_lshlrev_b32 v22, 16, v159
  v_and_b32 v23, 0xffff0000, v159
  v_pk_add_f32 v[92:93], v[92:93], v[22:23]
  v_lshlrev_b32 v16, 16, v76
  v_and_b32 v17, 0xffff0000, v76
  v_pk_add_f32 v[94:95], v[94:95], v[16:17]
  v_lshlrev_b32 v18, 16, v77
  v_and_b32 v19, 0xffff0000, v77
  v_pk_add_f32 v[96:97], v[96:97], v[18:19]
early_a7:
  s_cmp_eq_u32 s75, 0xfe
  s_cbranch_scc0 late
have_all:
  s_cmp_eq_u32 s51, 0
  s_cselect_b64 vcc, -1, 0
  v_cndmask_b32 v160, v78, v208, vcc
  v_cndmask_b32 v161, v79, v209, vcc
  v_cndmask_b32 v162, v80, v210, vcc
  v_cndmask_b32 v163, v81, v211, vcc
  v_mul_f32 v160, s72, v160
  v_mul_f32 v161, s72, v161
  v_mul_f32 v162, s72, v162
  v_mul_f32 v163, s72, v163
  v_exp_f32 v160, v160
  v_exp_f32 v161, v161
  v_exp_f32 v162, v162
  v_exp_f32 v163, v163
  v_pk_mul_f32 v[208:209], v[208:209], v[78:79]
  v_pk_mul_f32 v[210:211], v[210:211], v[80:81]
  v_pk_add_f32 v[160:161], v[160:161], 1.0 op_sel_hi:[1,0]
  v_pk_add_f32 v[162:163], v[162:163], 1.0 op_sel_hi:[1,0]
  v_rcp_f32 v160, v160
  v_rcp_f32 v161, v161
  v_rcp_f32 v162, v162
  v_rcp_f32 v163, v163
  v_pk_fma_f32 v[240:241], v[208:209], v[160:161], v[240:241]
  v_pk_fma_f32 v[242:243], v[210:211], v[162:163], v[242:243]
  v_cvt_pk_bf16_f32 v98, v240, v241
  v_cvt_pk_bf16_f32 v99, v242, v243
  ds_write_b64 v14, v[98:99] offset:0
  v_cndmask_b32 v164, v82, v192, vcc
  v_cndmask_b32 v165, v83, v193, vcc
  v_cndmask_b32 v166, v84, v194, vcc
  v_cndmask_b32 v167, v85, v195, vcc
  v_mul_f32 v164, s72, v164
  v_mul_f32 v165, s72, v165
  v_mul_f32 v166, s72, v166
  v_mul_f32 v167, s72, v167
  v_exp_f32 v164, v164
  v_exp_f32 v165, v165
  v_exp_f32 v166, v166
  v_exp_f32 v167, v167
  v_pk_mul_f32 v[192:193], v[192:193], v[82:83]
  v_pk_mul_f32 v[194:195], v[194:195], v[84:85]
  v_pk_add_f32 v[164:165], v[164:165], 1.0 op_sel_hi:[1,0]
  v_pk_add_f32 v[166:167], v[166:167], 1.0 op_sel_hi:[1,0]
  v_rcp_f32 v164, v164
  v_rcp_f32 v165, v165
  v_rcp_f32 v166, v166
  v_rcp_f32 v167, v167
  v_pk_fma_f32 v[244:245], v[192:193], v[164:165], v[244:245]
  v_pk_fma_f32 v[246:247], v[194:195], v[166:167], v[246:247]
  v_cvt_pk_bf16_f32 v100, v244, v245
  v_cvt_pk_bf16_f32 v101, v246, v247
  ds_write_b64 v14, v[100:101] offset:32
  v_cndmask_b32 v168, v86, v128, vcc
  v_cndmask_b32 v169, v87, v129, vcc
  v_cndmask_b32 v170, v88, v130, vcc
  v_cndmask_b32 v171, v89, v131, vcc
  v_mul_f32 v168, s72, v168
  v_mul_f32 v169, s72, v169
  v_mul_f32 v170, s72, v170
  v_mul_f32 v171, s72, v171
  v_exp_f32 v168, v168
  v_exp_f32 v169, v169
  v_exp_f32 v170, v170
  v_exp_f32 v171, v171
  v_pk_mul_f32 v[128:129], v[128:129], v[86:87]
  v_pk_mul_f32 v[130:131], v[130:131], v[88:89]
  v_pk_add_f32 v[168:169], v[168:169], 1.0 op_sel_hi:[1,0]
  v_pk_add_f32 v[170:171], v[170:171], 1.0 op_sel_hi:[1,0]
  v_rcp_f32 v168, v168
  v_rcp_f32 v169, v169
  v_rcp_f32 v170, v170
  v_rcp_f32 v171, v171
  v_pk_fma_f32 v[248:249], v[128:129], v[168:169], v[248:249]
  v_pk_fma_f32 v[250:251], v[130:131], v[170:171], v[250:251]
  v_cvt_pk_bf16_f32 v102, v248, v249
  v_cvt_pk_bf16_f32 v103, v250, v251
  ds_write_b64 v14, v[102:103] offset:64
  v_cndmask_b32 v172, v90, v112, vcc
  v_cndmask_b32 v173, v91, v113, vcc
  v_cndmask_b32 v174, v92, v114, vcc
  v_cndmask_b32 v175, v93, v115, vcc
  v_mul_f32 v172, s72, v172
  v_mul_f32 v173, s72, v173
  v_mul_f32 v174, s72, v174
  v_mul_f32 v175, s72, v175
  v_exp_f32 v172, v172
  v_exp_f32 v173, v173
  v_exp_f32 v174, v174
  v_exp_f32 v175, v175
  v_pk_mul_f32 v[112:113], v[112:113], v[90:91]
  v_pk_mul_f32 v[114:115], v[114:115], v[92:93]
  v_pk_add_f32 v[172:173], v[172:173], 1.0 op_sel_hi:[1,0]
  v_pk_add_f32 v[174:175], v[174:175], 1.0 op_sel_hi:[1,0]
  v_rcp_f32 v172, v172
  v_rcp_f32 v173, v173
  v_rcp_f32 v174, v174
  v_rcp_f32 v175, v175
  v_pk_fma_f32 v[252:253], v[112:113], v[172:173], v[252:253]
  v_pk_fma_f32 v[254:255], v[114:115], v[174:175], v[254:255]
  v_cvt_pk_bf16_f32 v104, v252, v253
  v_cvt_pk_bf16_f32 v105, v254, v255
  ds_write_b64 v14, v[104:105] offset:96
  v_cndmask_b32 v184, v94, v176, vcc
  v_cndmask_b32 v185, v95, v177, vcc
  v_cndmask_b32 v186, v96, v178, vcc
  v_cndmask_b32 v187, v97, v179, vcc
  v_mul_f32 v184, s72, v184
  v_mul_f32 v185, s72, v185
  v_mul_f32 v186, s72, v186
  v_mul_f32 v187, s72, v187
  v_exp_f32 v184, v184
  v_exp_f32 v185, v185
  v_exp_f32 v186, v186
  v_exp_f32 v187, v187
  v_pk_mul_f32 v[176:177], v[176:177], v[94:95]
  v_pk_mul_f32 v[178:179], v[178:179], v[96:97]
  v_pk_add_f32 v[184:185], v[184:185], 1.0 op_sel_hi:[1,0]
  v_pk_add_f32 v[186:187], v[186:187], 1.0 op_sel_hi:[1,0]
  v_rcp_f32 v184, v184
  v_rcp_f32 v185, v185
  v_rcp_f32 v186, v186
  v_rcp_f32 v187, v187
  v_pk_fma_f32 v[180:181], v[176:177], v[184:185], v[180:181]
  v_pk_fma_f32 v[182:183], v[178:179], v[186:187], v[182:183]
  v_cvt_pk_bf16_f32 v106, v180, v181
  v_cvt_pk_bf16_f32 v107, v182, v183
  ds_write_b64 v14, v[106:107] offset:128
  ds_read_b128 v[240:243], v24
  ds_read_b128 v[244:247], v25
  ds_read_b128 v[248:251], v26
  s_waitcnt lgkmcnt(2)
  buffer_store_dwordx4 v[240:243], v52, s[20:23], s1 offen sc1
  s_waitcnt lgkmcnt(1)
  buffer_store_dwordx4 v[244:247], v53, s[20:23], s1 offen sc1
  s_waitcnt lgkmcnt(0)
  buffer_store_dwordx4 v[248:251], v54, s[20:23], s1 offen sc1
  s_endpgm
late_poll:
pad_p3_tail_1:
  s_cbranch_execz warm_P
  buffer_load_dword v59, v13, s[4:7], s48 offen sc1
late:
  s_waitcnt vmcnt(0)
  v_cmp_ne_u32 vcc, 0, v59
  s_sub_u32 s90, s90, 1
  s_cmp_eq_u32 s90, 0
  s_cbranch_scc1 have_all
  s_andn2_b32 s73, vcc_lo, s75
  s_and_b32 s73, s73, 0xfe
  s_cbranch_scc0 late_poll
  s_bitcmp1_b32 s73, 1
  s_cbranch_scc0 late_l1
  s_add_u32 s61, s50, 0
  buffer_load_dwordx4 v[224:227], v50, s[4:7], s61 offen offset:0 sc1
  buffer_load_dwordx4 v[144:147], v50, s[4:7], s61 offen offset:1024 sc1
  buffer_load_dwordx2 v[64:65], v32, s[4:7], s61 offen offset:2048 sc1
late_l1:
  s_bitcmp1_b32 s73, 2
  s_cbranch_scc0 late_l2
  s_add_u32 s61, s50, 2560
  buffer_load_dwordx4 v[196:199], v50, s[4:7], s61 offen offset:0 sc1
  buffer_load_dwordx4 v[116:119], v50, s[4:7], s61 offen offset:1024 sc1
  buffer_load_dwordx2 v[66:67], v32, s[4:7], s61 offen offset:2048 sc1
late_l2:
  s_bitcmp1_b32 s73, 3
  s_cbranch_scc0 late_l3
  s_add_u32 s61, s50, 5120
  buffer_load_dwordx4 v[228:231], v50, s[4:7], s61 offen offset:0 sc1
  buffer_load_dwordx4 v[148:151], v50, s[4:7], s61 offen offset:1024 sc1
  buffer_load_dwordx2 v[68:69], v32, s[4:7], s61 offen offset:2048 sc1
late_l3:
  s_bitcmp1_b32 s73, 4
  s_cbranch_scc0 late_l4
  s_add_u32 s61, s50, 7680
  buffer_load_dwordx4 v[200:203], v50, s[4:7], s61 offen offset:0 sc1
  buffer_load_dwordx4 v[120:123], v50, s[4:7], s61 offen offset:1024 sc1
  buffer_load_dwordx2 v[70:71], v32, s[4:7], s61 offen offset:2048 sc1
late_l4:
  s_bitcmp1_b32 s73, 5
  s_cbranch_scc0 late_l5
  s_add_u32 s61, s50, 10240
  buffer_load_dwordx4 v[232:235], v50, s[4:7], s61 offen offset:0 sc1
  buffer_load_dwordx4 v[152:155], v50, s[4:7], s61 offen offset:1024 sc1
  buffer_load_dwordx2 v[72:73], v32, s[4:7], s61 offen offset:2048 sc1
late_l5:
  s_bitcmp1_b32 s73, 6
  s_cbranch_scc0 late_l6
  s_add_u32 s61, s50, 12800
  buffer_load_dwordx4 v[204:207], v50, s[4:7], s61 offen offset:0 sc1
  buffer_load_dwordx4 v[124:127], v50, s[4:7], s61 offen offset:1024 sc1
  buffer_load_dwordx2 v[74:75], v32, s[4:7], s61 offen offset:2048 sc1
late_l6:
  s_bitcmp1_b32 s73, 7
  s_cbranch_scc0 late_l7
  s_add_u32 s61, s50, 15360
  buffer_load_dwordx4 v[236:239], v50, s[4:7], s61 offen offset:0 sc1
pad_p3_tail_2:
  s_cbranch_execz warm_P
  buffer_load_dwordx4 v[156:159], v50, s[4:7], s61 offen offset:1024 sc1
  buffer_load_dwordx2 v[76:77], v32, s[4:7], s61 offen offset:2048 sc1
late_l7:
  buffer_load_dword v59, v13, s[4:7], s48 offen sc1
  s_waitcnt vmcnt(1)
  s_bitcmp1_b32 s73, 1
  s_cbranch_scc0 late_a1
  v_lshlrev_b32 v16, 16, v224
  v_and_b32 v17, 0xffff0000, v224
  v_pk_add_f32 v[78:79], v[78:79], v[16:17]
  v_lshlrev_b32 v18, 16, v225
  v_and_b32 v19, 0xffff0000, v225
  v_pk_add_f32 v[80:81], v[80:81], v[18:19]
  v_lshlrev_b32 v20, 16, v226
  v_and_b32 v21, 0xffff0000, v226
  v_pk_add_f32 v[82:83], v[82:83], v[20:21]
  v_lshlrev_b32 v22, 16, v227
  v_and_b32 v23, 0xffff0000, v227
  v_pk_add_f32 v[84:85], v[84:85], v[22:23]
  v_lshlrev_b32 v16, 16, v144
  v_and_b32 v17, 0xffff0000, v144
  v_pk_add_f32 v[86:87], v[86:87], v[16:17]
  v_lshlrev_b32 v18, 16, v145
  v_and_b32 v19, 0xffff0000, v145
  v_pk_add_f32 v[88:89], v[88:89], v[18:19]
  v_lshlrev_b32 v20, 16, v146
  v_and_b32 v21, 0xffff0000, v146
  v_pk_add_f32 v[90:91], v[90:91], v[20:21]
  v_lshlrev_b32 v22, 16, v147
  v_and_b32 v23, 0xffff0000, v147
  v_pk_add_f32 v[92:93], v[92:93], v[22:23]
  v_lshlrev_b32 v16, 16, v64
  v_and_b32 v17, 0xffff0000, v64
  v_pk_add_f32 v[94:95], v[94:95], v[16:17]
  v_lshlrev_b32 v18, 16, v65
  v_and_b32 v19, 0xffff0000, v65
  v_pk_add_f32 v[96:97], v[96:97], v[18:19]
late_a1:
  s_bitcmp1_b32 s73, 2
  s_cbranch_scc0 late_a2
  v_lshlrev_b32 v16, 16, v196
  v_and_b32 v17, 0xffff0000, v196
  v_pk_add_f32 v[208:209], v[208:209], v[16:17]
  v_lshlrev_b32 v18, 16, v197
  v_and_b32 v19, 0xffff0000, v197
  v_pk_add_f32 v[210:211], v[210:211], v[18:19]
  v_lshlrev_b32 v20, 16, v198
  v_and_b32 v21, 0xffff0000, v198
  v_pk_add_f32 v[192:193], v[192:193], v[20:21]
  v_lshlrev_b32 v22, 16, v199
  v_and_b32 v23, 0xffff0000, v199
  v_pk_add_f32 v[194:195], v[194:195], v[22:23]
  v_lshlrev_b32 v16, 16, v116
  v_and_b32 v17, 0xffff0000, v116
  v_pk_add_f32 v[128:129], v[128:129], v[16:17]
  v_lshlrev_b32 v18, 16, v117
  v_and_b32 v19, 0xffff0000, v117
  v_pk_add_f32 v[130:131], v[130:131], v[18:19]
  v_lshlrev_b32 v20, 16, v118
  v_and_b32 v21, 0xffff0000, v118
  v_pk_add_f32 v[112:113], v[112:113], v[20:21]
  v_lshlrev_b32 v22, 16, v119
  v_and_b32 v23, 0xffff0000, v119
  v_pk_add_f32 v[114:115], v[114:115], v[22:23]
  v_lshlrev_b32 v16, 16, v66
  v_and_b32 v17, 0xffff0000, v66
  v_pk_add_f32 v[176:177], v[176:177], v[16:17]
  v_lshlrev_b32 v18, 16, v67
  v_and_b32 v19, 0xffff0000, v67
  v_pk_add_f32 v[178:179], v[178:179], v[18:19]
late_a2:
  s_bitcmp1_b32 s73, 3
  s_cbranch_scc0 late_a3
  v_lshlrev_b32 v16, 16, v228
  v_and_b32 v17, 0xffff0000, v228
  v_pk_add_f32 v[78:79], v[78:79], v[16:17]
  v_lshlrev_b32 v18, 16, v229
  v_and_b32 v19, 0xffff0000, v229
  v_pk_add_f32 v[80:81], v[80:81], v[18:19]
  v_lshlrev_b32 v20, 16, v230
  v_and_b32 v21, 0xffff0000, v230
  v_pk_add_f32 v[82:83], v[82:83], v[20:21]
  v_lshlrev_b32 v22, 16, v231
  v_and_b32 v23, 0xffff0000, v231
  v_pk_add_f32 v[84:85], v[84:85], v[22:23]
  v_lshlrev_b32 v16, 16, v148
  v_and_b32 v17, 0xffff0000, v148
  v_pk_add_f32 v[86:87], v[86:87], v[16:17]
  v_lshlrev_b32 v18, 16, v149
  v_and_b32 v19, 0xffff0000, v149
  v_pk_add_f32 v[88:89], v[88:89], v[18:19]
  v_lshlrev_b32 v20, 16, v150
  v_and_b32 v21, 0xffff0000, v150
  v_pk_add_f32 v[90:91], v[90:91], v[20:21]
  v_lshlrev_b32 v22, 16, v151
  v_and_b32 v23, 0xffff0000, v151
  v_pk_add_f32 v[92:93], v[92:93], v[22:23]
  v_lshlrev_b32 v16, 16, v68
  v_and_b32 v17, 0xffff0000, v68
  v_pk_add_f32 v[94:95], v[94:95], v[16:17]
  v_lshlrev_b32 v18, 16, v69
  v_and_b32 v19, 0xffff0000, v69
  v_pk_add_f32 v[96:97], v[96:97], v[18:19]
late_a3:
  s_bitcmp1_b32 s73, 4
  s_cbranch_scc0 late_a4
  v_lshlrev_b32 v16, 16, v200
  v_and_b32 v17, 0xffff0000, v200
  v_pk_add_f32 v[208:209], v[208:209], v[16:17]
  v_lshlrev_b32 v18, 16, v201
  v_and_b32 v19, 0xffff0000, v201
  v_pk_add_f32 v[210:211], v[210:211], v[18:19]
  v_lshlrev_b32 v20, 16, v202
  v_and_b32 v21, 0xffff0000, v202
  v_pk_add_f32 v[192:193], v[192:193], v[20:21]
  v_lshlrev_b32 v22, 16, v203
  v_and_b32 v23, 0xffff0000, v203
  v_pk_add_f32 v[194:195], v[194:195], v[22:23]
  v_lshlrev_b32 v16, 16, v120
  v_and_b32 v17, 0xffff0000, v120
  v_pk_add_f32 v[128:129], v[128:129], v[16:17]
  v_lshlrev_b32 v18, 16, v121
  v_and_b32 v19, 0xffff0000, v121
  v_pk_add_f32 v[130:131], v[130:131], v[18:19]
  v_lshlrev_b32 v20, 16, v122
  v_and_b32 v21, 0xffff0000, v122
  v_pk_add_f32 v[112:113], v[112:113], v[20:21]
  v_lshlrev_b32 v22, 16, v123
  v_and_b32 v23, 0xffff0000, v123
  v_pk_add_f32 v[114:115], v[114:115], v[22:23]
  v_lshlrev_b32 v16, 16, v70
  v_and_b32 v17, 0xffff0000, v70
  v_pk_add_f32 v[176:177], v[176:177], v[16:17]
  v_lshlrev_b32 v18, 16, v71
  v_and_b32 v19, 0xffff0000, v71
  v_pk_add_f32 v[178:179], v[178:179], v[18:19]
late_a4:
  s_bitcmp1_b32 s73, 5
  s_cbranch_scc0 late_a5
  v_lshlrev_b32 v16, 16, v232
  v_and_b32 v17, 0xffff0000, v232
  v_pk_add_f32 v[78:79], v[78:79], v[16:17]
  v_lshlrev_b32 v18, 16, v233
  v_and_b32 v19, 0xffff0000, v233
  v_pk_add_f32 v[80:81], v[80:81], v[18:19]
  v_lshlrev_b32 v20, 16, v234
  v_and_b32 v21, 0xffff0000, v234
  v_pk_add_f32 v[82:83], v[82:83], v[20:21]
  v_lshlrev_b32 v22, 16, v235
  v_and_b32 v23, 0xffff0000, v235
  v_pk_add_f32 v[84:85], v[84:85], v[22:23]
  v_lshlrev_b32 v16, 16, v152
  v_and_b32 v17, 0xffff0000, v152
  v_pk_add_f32 v[86:87], v[86:87], v[16:17]
  v_lshlrev_b32 v18, 16, v153
  v_and_b32 v19, 0xffff0000, v153
  v_pk_add_f32 v[88:89], v[88:89], v[18:19]
  v_lshlrev_b32 v20, 16, v154
  v_and_b32 v21, 0xffff0000, v154
  v_pk_add_f32 v[90:91], v[90:91], v[20:21]
  v_lshlrev_b32 v22, 16, v155
  v_and_b32 v23, 0xffff0000, v155
  v_pk_add_f32 v[92:93], v[92:93], v[22:23]
  v_lshlrev_b32 v16, 16, v72
  v_and_b32 v17, 0xffff0000, v72
  v_pk_add_f32 v[94:95], v[94:95], v[16:17]
  v_lshlrev_b32 v18, 16, v73
  v_and_b32 v19, 0xffff0000, v73
  v_pk_add_f32 v[96:97], v[96:97], v[18:19]
late_a5:
  s_bitcmp1_b32 s73, 6
  s_cbranch_scc0 late_a6
  v_lshlrev_b32 v16, 16, v204
  v_and_b32 v17, 0xffff0000, v204
  v_pk_add_f32 v[208:209], v[208:209], v[16:17]
  v_lshlrev_b32 v18, 16, v205
  v_and_b32 v19, 0xffff0000, v205
  v_pk_add_f32 v[210:211], v[210:211], v[18:19]
  v_lshlrev_b32 v20, 16, v206
  v_and_b32 v21, 0xffff0000, v206
  v_pk_add_f32 v[192:193], v[192:193], v[20:21]
  v_lshlrev_b32 v22, 16, v207
  v_and_b32 v23, 0xffff0000, v207
  v_pk_add_f32 v[194:195], v[194:195], v[22:23]
  v_lshlrev_b32 v16, 16, v124
  v_and_b32 v17, 0xffff0000, v124
  v_pk_add_f32 v[128:129], v[128:129], v[16:17]
  v_lshlrev_b32 v18, 16, v125
  v_and_b32 v19, 0xffff0000, v125
  v_pk_add_f32 v[130:131], v[130:131], v[18:19]
  v_lshlrev_b32 v20, 16, v126
  v_and_b32 v21, 0xffff0000, v126
  v_pk_add_f32 v[112:113], v[112:113], v[20:21]
  v_lshlrev_b32 v22, 16, v127
  v_and_b32 v23, 0xffff0000, v127
  v_pk_add_f32 v[114:115], v[114:115], v[22:23]
  v_lshlrev_b32 v16, 16, v74
  v_and_b32 v17, 0xffff0000, v74
  v_pk_add_f32 v[176:177], v[176:177], v[16:17]
  v_lshlrev_b32 v18, 16, v75
  v_and_b32 v19, 0xffff0000, v75
  v_pk_add_f32 v[178:179], v[178:179], v[18:19]
late_a6:
  s_bitcmp1_b32 s73, 7
  s_cbranch_scc0 late_a7
  v_lshlrev_b32 v16, 16, v236
  v_and_b32 v17, 0xffff0000, v236
  v_pk_add_f32 v[78:79], v[78:79], v[16:17]
  v_lshlrev_b32 v18, 16, v237
  v_and_b32 v19, 0xffff0000, v237
  v_pk_add_f32 v[80:81], v[80:81], v[18:19]
  v_lshlrev_b32 v20, 16, v238
  v_and_b32 v21, 0xffff0000, v238
  v_pk_add_f32 v[82:83], v[82:83], v[20:21]
  v_lshlrev_b32 v22, 16, v239
  v_and_b32 v23, 0xffff0000, v239
  v_pk_add_f32 v[84:85], v[84:85], v[22:23]
  v_lshlrev_b32 v16, 16, v156
  v_and_b32 v17, 0xffff0000, v156
  v_pk_add_f32 v[86:87], v[86:87], v[16:17]
  v_lshlrev_b32 v18, 16, v157
  v_and_b32 v19, 0xffff0000, v157
  v_pk_add_f32 v[88:89], v[88:89], v[18:19]
  v_lshlrev_b32 v20, 16, v158
  v_and_b32 v21, 0xffff0000, v158
  v_pk_add_f32 v[90:91], v[90:91], v[20:21]
  v_lshlrev_b32 v22, 16, v159
  v_and_b32 v23, 0xffff0000, v159
  v_pk_add_f32 v[92:93], v[92:93], v[22:23]
  v_lshlrev_b32 v16, 16, v76
  v_and_b32 v17, 0xffff0000, v76
  v_pk_add_f32 v[94:95], v[94:95], v[16:17]
  v_lshlrev_b32 v18, 16, v77
  v_and_b32 v19, 0xffff0000, v77
  v_pk_add_f32 v[96:97], v[96:97], v[18:19]
late_a7:
  s_or_b32 s75, s75, s73
  s_cmp_eq_u32 s75, 0xfe
  s_cbranch_scc0 late
  s_branch have_all
att_retry:
  s_mov_b32 s79, 1
  s_mov_b32 s55, 64
  s_mov_b32 s69, 0
  s_mov_b32 s71, 32
  s_waitcnt vmcnt(0)
  v_subrev_co_u32 v60, vcc, (att_retry-att_last-8192)/36*4*2, v60
  s_nop 1
  v_subbrev_co_u32 v61, vcc, 0, v61, vcc
  v_mov_b32 v52, 0xff800000
  v_mov_b32 v53, 0xff800000
  v_mov_b32 v54, 0xff800000
  v_mov_b32 v55, 0xff800000
att_maxloop:
  s_barrier
  s_add_u32 m0, s67, 0
  s_nop 0
  buffer_load_dwordx4 v28, s[20:23], s69 offen offset:0 lds
  buffer_load_dwordx4 v29, s[20:23], s69 offen offset:1024 lds
  buffer_load_dwordx4 v30, s[20:23], s69 offen offset:2048 lds
  buffer_load_dwordx4 v31, s[20:23], s69 offen offset:3072 lds
  s_add_u32 s69, s69, 16384
  s_waitcnt vmcnt(0)
  s_barrier
  ds_read_b128 a[160:163], v34 offset:0
  ds_read_b128 a[164:167], v35 offset:0
  ds_read_b128 a[168:171], v36 offset:0
  ds_read_b128 a[172:175], v37 offset:0
  s_waitcnt lgkmcnt(3)
  v_mfma_f32_16x16x32_bf16 v[68:71], a[160:163], v[64:67], 0
  s_waitcnt lgkmcnt(2)
  v_mfma_f32_16x16x32_bf16 v[68:71], a[164:167], v[96:99], v[68:71]
  s_waitcnt lgkmcnt(1)
  v_mfma_f32_16x16x32_bf16 v[68:71], a[168:171], v[128:131], v[68:71]
  s_waitcnt lgkmcnt(0)
  v_mfma_f32_16x16x32_bf16 v[68:71], a[172:175], v[160:163], v[68:71]
  v_mfma_f32_16x16x32_bf16 v[76:79], a[160:163], v[72:75], 0
  v_mfma_f32_16x16x32_bf16 v[76:79], a[164:167], v[104:107], v[76:79]
  v_mfma_f32_16x16x32_bf16 v[76:79], a[168:171], v[136:139], v[76:79]
  v_mfma_f32_16x16x32_bf16 v[76:79], a[172:175], v[168:171], v[76:79]
  v_mfma_f32_16x16x32_bf16 v[84:87], a[160:163], v[80:83], 0
  v_mfma_f32_16x16x32_bf16 v[84:87], a[164:167], v[112:115], v[84:87]
  v_mfma_f32_16x16x32_bf16 v[84:87], a[168:171], v[144:147], v[84:87]
  v_mfma_f32_16x16x32_bf16 v[84:87], a[172:175], v[176:179], v[84:87]
  v_mfma_f32_16x16x32_bf16 v[92:95], a[160:163], v[88:91], 0
  v_mfma_f32_16x16x32_bf16 v[92:95], a[164:167], v[120:123], v[92:95]
  v_mfma_f32_16x16x32_bf16 v[92:95], a[168:171], v[152:155], v[92:95]
  v_mfma_f32_16x16x32_bf16 v[92:95], a[172:175], v[184:187], v[92:95]
  v_max3_f32 v52, v52, v68, v69
  v_max3_f32 v52, v52, v70, v71
  v_max3_f32 v53, v53, v76, v77
  v_max3_f32 v53, v53, v78, v79
  v_max3_f32 v54, v54, v84, v85
  v_max3_f32 v54, v54, v86, v87
  s_nop 1
  v_max3_f32 v55, v55, v92, v93
  v_max3_f32 v55, v55, v94, v95
  ds_read_b128 a[176:179], v34 offset:4096
  ds_read_b128 a[180:183], v35 offset:4096
  ds_read_b128 a[184:187], v36 offset:4096
  ds_read_b128 a[188:191], v37 offset:4096
  s_waitcnt lgkmcnt(3)
  v_mfma_f32_16x16x32_bf16 v[68:71], a[176:179], v[64:67], 0
  s_waitcnt lgkmcnt(2)
  v_mfma_f32_16x16x32_bf16 v[68:71], a[180:183], v[96:99], v[68:71]
  s_waitcnt lgkmcnt(1)
  v_mfma_f32_16x16x32_bf16 v[68:71], a[184:187], v[128:131], v[68:71]
  s_waitcnt lgkmcnt(0)
  v_mfma_f32_16x16x32_bf16 v[68:71], a[188:191], v[160:163], v[68:71]
  v_mfma_f32_16x16x32_bf16 v[76:79], a[176:179], v[72:75], 0
  v_mfma_f32_16x16x32_bf16 v[76:79], a[180:183], v[104:107], v[76:79]
  v_mfma_f32_16x16x32_bf16 v[76:79], a[184:187], v[136:139], v[76:79]
  v_mfma_f32_16x16x32_bf16 v[76:79], a[188:191], v[168:171], v[76:79]
  v_mfma_f32_16x16x32_bf16 v[84:87], a[176:179], v[80:83], 0
  v_mfma_f32_16x16x32_bf16 v[84:87], a[180:183], v[112:115], v[84:87]
  v_mfma_f32_16x16x32_bf16 v[84:87], a[184:187], v[144:147], v[84:87]
  v_mfma_f32_16x16x32_bf16 v[84:87], a[188:191], v[176:179], v[84:87]
  v_mfma_f32_16x16x32_bf16 v[92:95], a[176:179], v[88:91], 0
  v_mfma_f32_16x16x32_bf16 v[92:95], a[180:183], v[120:123], v[92:95]
  v_mfma_f32_16x16x32_bf16 v[92:95], a[184:187], v[152:155], v[92:95]
  v_mfma_f32_16x16x32_bf16 v[92:95], a[188:191], v[184:187], v[92:95]
  v_max3_f32 v52, v52, v68, v69
  v_max3_f32 v52, v52, v70, v71
  v_max3_f32 v53, v53, v76, v77
  v_max3_f32 v53, v53, v78, v79
  v_max3_f32 v54, v54, v84, v85
  v_max3_f32 v54, v54, v86, v87
  s_nop 1
  v_max3_f32 v55, v55, v92, v93
  v_max3_f32 v55, v55, v94, v95
  ds_read_b128 a[160:163], v34 offset:8192
  ds_read_b128 a[164:167], v35 offset:8192
  ds_read_b128 a[168:171], v36 offset:8192
  ds_read_b128 a[172:175], v37 offset:8192
  s_waitcnt lgkmcnt(3)
  v_mfma_f32_16x16x32_bf16 v[68:71], a[160:163], v[64:67], 0
  s_waitcnt lgkmcnt(2)
  v_mfma_f32_16x16x32_bf16 v[68:71], a[164:167], v[96:99], v[68:71]
  s_waitcnt lgkmcnt(1)
  v_mfma_f32_16x16x32_bf16 v[68:71], a[168:171], v[128:131], v[68:71]
  s_waitcnt lgkmcnt(0)
  v_mfma_f32_16x16x32_bf16 v[68:71], a[172:175], v[160:163], v[68:71]
  v_mfma_f32_16x16x32_bf16 v[76:79], a[160:163], v[72:75], 0
  v_mfma_f32_16x16x32_bf16 v[76:79], a[164:167], v[104:107], v[76:79]
  v_mfma_f32_16x16x32_bf16 v[76:79], a[168:171], v[136:139], v[76:79]
  v_mfma_f32_16x16x32_bf16 v[76:79], a[172:175], v[168:171], v[76:79]
  v_mfma_f32_16x16x32_bf16 v[84:87], a[160:163], v[80:83], 0
  v_mfma_f32_16x16x32_bf16 v[84:87], a[164:167], v[112:115], v[84:87]
  v_mfma_f32_16x16x32_bf16 v[84:87], a[168:171], v[144:147], v[84:87]
  v_mfma_f32_16x16x32_bf16 v[84:87], a[172:175], v[176:179], v[84:87]
  v_mfma_f32_16x16x32_bf16 v[92:95], a[160:163], v[88:91], 0
  v_mfma_f32_16x16x32_bf16 v[92:95], a[164:167], v[120:123], v[92:95]
  v_mfma_f32_16x16x32_bf16 v[92:95], a[168:171], v[152:155], v[92:95]
  v_mfma_f32_16x16x32_bf16 v[92:95], a[172:175], v[184:187], v[92:95]
  v_max3_f32 v52, v52, v68, v69
  v_max3_f32 v52, v52, v70, v71
  v_max3_f32 v53, v53, v76, v77
  v_max3_f32 v53, v53, v78, v79
  v_max3_f32 v54, v54, v84, v85
  v_max3_f32 v54, v54, v86, v87
  s_nop 1
  v_max3_f32 v55, v55, v92, v93
  v_max3_f32 v55, v55, v94, v95
  ds_read_b128 a[176:179], v34 offset:12288
  ds_read_b128 a[180:183], v35 offset:12288
  ds_read_b128 a[184:187], v36 offset:12288
  ds_read_b128 a[188:191], v37 offset:12288
  s_waitcnt lgkmcnt(3)
  v_mfma_f32_16x16x32_bf16 v[68:71], a[176:179], v[64:67], 0
  s_waitcnt lgkmcnt(2)
  v_mfma_f32_16x16x32_bf16 v[68:71], a[180:183], v[96:99], v[68:71]
  s_waitcnt lgkmcnt(1)
  v_mfma_f32_16x16x32_bf16 v[68:71], a[184:187], v[128:131], v[68:71]
  s_waitcnt lgkmcnt(0)
  v_mfma_f32_16x16x32_bf16 v[68:71], a[188:191], v[160:163], v[68:71]
  v_mfma_f32_16x16x32_bf16 v[76:79], a[176:179], v[72:75], 0
  v_mfma_f32_16x16x32_bf16 v[76:79], a[180:183], v[104:107], v[76:79]
  v_mfma_f32_16x16x32_bf16 v[76:79], a[184:187], v[136:139], v[76:79]
  v_mfma_f32_16x16x32_bf16 v[76:79], a[188:191], v[168:171], v[76:79]
  v_mfma_f32_16x16x32_bf16 v[84:87], a[176:179], v[80:83], 0
  v_mfma_f32_16x16x32_bf16 v[84:87], a[180:183], v[112:115], v[84:87]
  v_mfma_f32_16x16x32_bf16 v[84:87], a[184:187], v[144:147], v[84:87]
  v_mfma_f32_16x16x32_bf16 v[84:87], a[188:191], v[176:179], v[84:87]
  v_mfma_f32_16x16x32_bf16 v[92:95], a[176:179], v[88:91], 0
  v_mfma_f32_16x16x32_bf16 v[92:95], a[180:183], v[120:123], v[92:95]
  v_mfma_f32_16x16x32_bf16 v[92:95], a[184:187], v[152:155], v[92:95]
  v_mfma_f32_16x16x32_bf16 v[92:95], a[188:191], v[184:187], v[92:95]
  v_max3_f32 v52, v52, v68, v69
  v_max3_f32 v52, v52, v70, v71
  v_max3_f32 v53, v53, v76, v77
  v_max3_f32 v53, v53, v78, v79
  v_max3_f32 v54, v54, v84, v85
  v_max3_f32 v54, v54, v86, v87
  s_nop 1
  v_max3_f32 v55, v55, v92, v93
  v_max3_f32 v55, v55, v94, v95
  s_sub_u32 s71, s71, 1
  s_cmp_lg_u32 s71, 0
  s_cbranch_scc1 att_maxloop
  s_barrier
  s_mov_b32 s69, 0
  s_mov_b32 s70, 0
  s_add_u32 m0, s67, 0
  s_nop 0
  buffer_load_dwordx4 v28, s[20:23], s69 offen offset:0 lds
  buffer_load_dwordx4 v29, s[20:23], s69 offen offset:1024 lds
  buffer_load_dwordx4 v30, s[20:23], s69 offen offset:2048 lds
  buffer_load_dwordx4 v31, s[20:23], s69 offen offset:3072 lds
  s_add_u32 s69, s69, 16384
  s_add_u32 m0, s68, 49152
  s_nop 0
  buffer_load_dwordx4 v32, s[24:27], s70 offen offset:0 lds
  buffer_load_dwordx4 v33, s[24:27], s70 offen offset:1024 lds
  buffer_load_dwordx4 v32, s[24:27], s70 offen offset:2048 lds
  buffer_load_dwordx4 v33, s[24:27], s70 offen offset:3072 lds
  s_add_u32 s70, s70, 16384
  s_add_u32 m0, s67, 16384
  s_nop 0
  buffer_load_dwordx4 v28, s[20:23], s69 offen offset:0 lds
  buffer_load_dwordx4 v29, s[20:23], s69 offen offset:1024 lds
  buffer_load_dwordx4 v30, s[20:23], s69 offen offset:2048 lds
  buffer_load_dwordx4 v31, s[20:23], s69 offen offset:3072 lds
  s_add_u32 s69, s69, 16384
  s_waitcnt vmcnt(0)
  s_barrier
  ds_read_b128 a[160:163], v34 offset:0
  ds_read_b128 a[164:167], v35 offset:0
  ds_read_b128 a[168:171], v36 offset:0
  ds_read_b128 a[172:175], v37 offset:0
  ds_read_b128 a[176:179], v34 offset:4096
  ds_read_b128 a[180:183], v35 offset:4096
  ds_read_b128 a[184:187], v36 offset:4096
  ds_read_b128 a[188:191], v37 offset:4096
  s_waitcnt lgkmcnt(7)
  v_mfma_f32_16x16x32_bf16 v[68:71], a[160:163], v[64:67], 0
  s_waitcnt lgkmcnt(6)
  v_mfma_f32_16x16x32_bf16 v[68:71], a[164:167], v[96:99], v[68:71]
  s_waitcnt lgkmcnt(5)
  v_mfma_f32_16x16x32_bf16 v[68:71], a[168:171], v[128:131], v[68:71]
  s_waitcnt lgkmcnt(4)
  v_mfma_f32_16x16x32_bf16 v[68:71], a[172:175], v[160:163], v[68:71]
  v_mfma_f32_16x16x32_bf16 v[76:79], a[172:175], v[168:171], 0
  v_mfma_f32_16x16x32_bf16 v[76:79], a[168:171], v[136:139], v[76:79]
  v_mfma_f32_16x16x32_bf16 v[76:79], a[164:167], v[104:107], v[76:79]
  v_mfma_f32_16x16x32_bf16 v[76:79], a[160:163], v[72:75], v[76:79]
  v_mfma_f32_16x16x32_bf16 v[84:87], a[160:163], v[80:83], 0
  v_mfma_f32_16x16x32_bf16 v[84:87], a[164:167], v[112:115], v[84:87]
  v_mfma_f32_16x16x32_bf16 v[84:87], a[168:171], v[144:147], v[84:87]
  v_mfma_f32_16x16x32_bf16 v[84:87], a[172:175], v[176:179], v[84:87]
  v_mfma_f32_16x16x32_bf16 v[92:95], a[172:175], v[184:187], 0
  v_mfma_f32_16x16x32_bf16 v[92:95], a[168:171], v[152:155], v[92:95]
  v_mfma_f32_16x16x32_bf16 v[92:95], a[164:167], v[120:123], v[92:95]
  v_mfma_f32_16x16x32_bf16 v[92:95], a[160:163], v[88:91], v[92:95]
  s_waitcnt lgkmcnt(0)
  s_branch att_restart
att_end:
  s_endpgm
.section .rodata,"a"
.p2align 6
.amdhsa_kernel recurrent_scan__mha_block_cached__glu_gated_glu__prompt_kernel
  .amdhsa_next_free_vgpr 512
  .amdhsa_next_free_sgpr 102
  .amdhsa_accum_offset 256
  .amdhsa_group_segment_fixed_size 0
  .amdhsa_kernarg_size 96
  .amdhsa_user_sgpr_count 2
  .amdhsa_user_sgpr_kernarg_segment_ptr 1
  .amdhsa_system_sgpr_workgroup_id_x 1
.end_amdhsa_kernel
```
